```python
import torch

def _softmax(x, axis=-1):
    return torch.softmax(x, dim=axis)
def _gelu(x):
    return torch.nn.functional.gelu(x, approximate="tanh")
def _silu(x):
    return torch.nn.functional.silu(x)
def _sigmoid(x):
    return torch.sigmoid(x)
def _layernorm(x, axis=-1, eps=1e-5):
    m = x.mean(dim=axis, keepdim=True)
    v = x.var(dim=axis, keepdim=True, unbiased=False)
    return (x - m) / torch.sqrt(v + eps)
def _scatter_add(tgt, idx, src, axis=0):
    return tgt.clone().index_add_(axis, idx, src)
def _segment_sum(src, seg, n):
    out = torch.zeros((n,) + src.shape[1:], dtype=src.dtype)
    return out.index_add_(0, seg, src)
def _pad(x, pw):
    flat = tuple(v for pair in reversed(pw) for v in pair)
    return torch.nn.functional.pad(x, flat)

kernel_name = 'standalone__deformable_dcnv1__vision'

def setup_inputs():

    _w = (lambda a: (lambda t: t.to(torch.bfloat16) if t.is_floating_point() else t)(torch.as_tensor(a)))
    H = W = 224
    C = 96
    K = 3
    return {
        "x": _w((lambda *s: torch.randn(*s, dtype=torch.bfloat16) * 0.05)(1, H, W, C)),
        "offset": _w((lambda *s: torch.randn(*s, dtype=torch.bfloat16) * 0.05)(1, H, W, 2 * K * K) * 0.5),
        "w": _w((lambda *s: torch.randn(*s, dtype=torch.bfloat16) * 0.05)(K, K, C, C) * (K * K * C) ** -0.5),
    }

def reference(x, offset, w):
    B, H, W, C = x.shape
    K = 3
    hh = (lambda x, dt: x.to(dt))(torch.arange(H), x.dtype).reshape(1, H, 1)
    ww = (lambda x, dt: x.to(dt))(torch.arange(W), x.dtype).reshape(1, 1, W)
    xf = x.reshape(B, H * W, C)
    def _gather(yi, xi):
        lin = (yi * W + xi).reshape(B, H * W)
        idx = (lambda x, n, axis: torch.repeat_interleave(x, n, dim=axis))(lin[..., None], C, axis=-1)
        return (lambda x, i, axis: torch.take_along_dim(x, i, dim=axis))(xf, idx, axis=1).reshape(B, H, W, C)
    taps = []
    for ki in range(K):
        for kj in range(K):
            t = ki * K + kj
            dy = offset[..., 2 * t]
            dx = offset[..., 2 * t + 1]
            py = torch.clip(hh + (ki - 0.5 * (K - 1)) + dy, 0.0, H - 1.0)
            px = torch.clip(ww + (kj - 0.5 * (K - 1)) + dx, 0.0, W - 1.0)
            y0 = torch.floor(py)
            x0 = torch.floor(px)
            y1 = torch.clip(y0 + 1.0, 0.0, H - 1.0)
            x1 = torch.clip(x0 + 1.0, 0.0, W - 1.0)
            wy = (py - y0)[..., None]
            wx = (px - x0)[..., None]
            y0i = (lambda x, dt: x.to(dt))(y0, torch.int64)
            y1i = (lambda x, dt: x.to(dt))(y1, torch.int64)
            x0i = (lambda x, dt: x.to(dt))(x0, torch.int64)
            x1i = (lambda x, dt: x.to(dt))(x1, torch.int64)
            v = (1 - wy) * (1 - wx) * _gather(y0i, x0i) + (1 - wy) * wx * _gather(y0i, x1i) + wy * (1 - wx) * _gather(y1i, x0i) + wy * wx * _gather(y1i, x1i)
            taps.append(v)
    samp = torch.stack(taps, 3)
    return torch.einsum("bhwkc,kco->bhwo", samp, w.reshape(K * K, C, C))
```

```asm
; @launch grid=(256,1,1) block=(256,1,1) lds=162304
.amdgcn_target "amdgcn-amd-amdhsa--gfx950"
.text
.globl standalone__deformable_dcnv1__vision_kernel
.p2align 8
.type standalone__deformable_dcnv1__vision_kernel,@function
standalone__deformable_dcnv1__vision_kernel:
    s_cmp_ge_u32 s2, 256
    s_cbranch_scc1 L_end
    s_load_dwordx4 s[4:7], s[0:1], 0
    s_load_dwordx4 s[24:27], s[0:1], 16
    s_getpc_b64 s[32:33]
L_pc:
    v_lshlrev_b32 v98, 7, v0
    global_load_dword v97, v98, s[32:33]
    v_min_u32 v98, 32, v0
    v_lshlrev_b32 v98, 7, v98
    v_add_u32 v98, 32768, v98
    global_load_dword v97, v98, s[32:33]
    s_lshl_b32 s34, s2, 3
    s_add_u32 s34, s34, L_table-L_pc
    s_add_u32 s36, s32, s34
    s_addc_u32 s37, s33, 0
    s_load_dwordx2 s[28:29], s[36:37], 0
    v_and_b32 v1, 63, v0
    v_lshrrev_b32 v160, 6, v0
    v_and_b32 v2, 15, v1
    v_readfirstlane_b32 s3, v160
    v_lshrrev_b32 v3, 4, v1
    v_mov_b32 v160, 162240
    v_mov_b32 v164, 0
    v_mov_b32 v165, 0
    ds_write_b64 v160, v[164:165]
    v_lshlrev_b32 v4, 4, v3
    s_and_b32 s81, s3, 1
    s_lshr_b32 s82, s3, 1
    s_mov_b32 s30, 0x435f0000
    v_add_u32 v160, 0, v1
    v_mul_u32_u24 v161, 5462, v160
    v_lshrrev_b32 v161, 16, v161
    v_mul_u32_u24 v162, 12, v161
    v_sub_u32 v162, v160, v162
    v_lshrrev_b32 v160, 1, v161
    v_and_b32 v160, 2, v160
    v_xor_b32 v160, v162, v160
    v_sub_u32 v160, v160, v162
    v_add_u32 v160, v160, v1
    v_lshlrev_b32 v5, 4, v160
    v_lshrrev_b32 v160, 2, v161
    v_and_b32 v160, 2, v160
    v_xor_b32 v160, v162, v160
    v_sub_u32 v160, v160, v162
    v_add_u32 v160, v160, v1
    v_lshlrev_b32 v11, 4, v160
    v_add_u32 v160, 64, v1
    v_mul_u32_u24 v161, 5462, v160
    v_lshrrev_b32 v161, 16, v161
    v_mul_u32_u24 v162, 12, v161
    v_sub_u32 v162, v160, v162
    v_lshrrev_b32 v160, 1, v161
    v_and_b32 v160, 2, v160
    v_xor_b32 v160, v162, v160
    v_sub_u32 v160, v160, v162
    v_add_u32 v160, v160, v1
    v_lshlrev_b32 v6, 4, v160
    v_lshrrev_b32 v160, 2, v161
    v_and_b32 v160, 2, v160
    v_xor_b32 v160, v162, v160
    v_sub_u32 v160, v160, v162
    v_add_u32 v160, v160, v1
    v_lshlrev_b32 v12, 4, v160
    v_add_u32 v160, 128, v1
    v_mul_u32_u24 v161, 5462, v160
    v_lshrrev_b32 v161, 16, v161
    v_mul_u32_u24 v162, 12, v161
    v_sub_u32 v162, v160, v162
    v_lshrrev_b32 v160, 1, v161
    v_and_b32 v160, 2, v160
    v_xor_b32 v160, v162, v160
    v_sub_u32 v160, v160, v162
    v_add_u32 v160, v160, v1
    v_lshlrev_b32 v7, 4, v160
    v_lshrrev_b32 v160, 2, v161
    v_and_b32 v160, 2, v160
    v_xor_b32 v160, v162, v160
    v_sub_u32 v160, v160, v162
    v_add_u32 v160, v160, v1
    v_lshlrev_b32 v13, 4, v160
    v_add_u32 v160, 192, v1
    v_mul_u32_u24 v161, 5462, v160
    v_lshrrev_b32 v161, 16, v161
    v_mul_u32_u24 v162, 12, v161
    v_sub_u32 v162, v160, v162
    v_lshrrev_b32 v160, 1, v161
    v_and_b32 v160, 2, v160
    v_xor_b32 v160, v162, v160
    v_sub_u32 v160, v160, v162
    v_add_u32 v160, v160, v1
    v_lshlrev_b32 v8, 4, v160
    v_cmp_gt_u32 vcc, 12, v1
    s_waitcnt lgkmcnt(0)
    s_barrier
    v_cndmask_b32 v9, 0, 1, vcc
    v_cndmask_b32 v10, 1, 0, vcc
    s_mov_b32 s12, s6
    s_and_b32 s13, s7, 0xffff
    s_mov_b32 s14, 1806336
    s_mov_b32 s15, 0x20000
    s_mov_b32 s8, s4
    s_and_b32 s9, s5, 0xffff
    s_mov_b32 s10, 9633792
    s_mov_b32 s11, 0x20000
    s_mov_b32 s16, s24
    s_and_b32 s17, s25, 0xffff
    s_mov_b32 s18, 165888
    s_mov_b32 s19, 0x20000
    s_mov_b32 s20, s26
    s_and_b32 s21, s27, 0xffff
    s_mov_b32 s22, 9633792
    s_mov_b32 s23, 0x20000
    s_sub_u32 s64, s4, 192
    s_subb_u32 s65, s5, 0
    s_and_b32 s65, s65, 0xffff
    s_mov_b32 s66, 9633984
    s_mov_b32 s67, 0x20000
    s_cmp_lg_u32 s3, 3
    s_cbranch_scc1 L_nopf
    s_bfe_u32 s34, s2, 0x30003
    s_mul_i32 s34, s34, 20736
    v_lshlrev_b32 v174, 7, v1
    buffer_load_dword v97, v174, s[16:19], s34 offen
    s_add_u32 s34, s34, 8192
    buffer_load_dword v97, v174, s[16:19], s34 offen
    s_add_u32 s34, s34, 8192
    buffer_load_dword v97, v174, s[16:19], s34 offen
L_nopf:
    s_and_b32 s68, s28, 15
    s_lshl_b32 s68, s68, 4
    s_bfe_u32 s69, s28, 0x80004
    s_bfe_u32 s70, s28, 0x4000c
    s_bfe_u32 s73, s28, 0x40010
    s_lshl_b32 s73, s73, 4
    s_bfe_u32 s74, s28, 0x80014
    s_bfe_u32 s72, s28, 0x1001c
    s_and_b32 s76, s29, 15
    s_lshl_b32 s76, s76, 4
    s_bfe_u32 s77, s29, 0x80004
    s_bfe_u32 s75, s29, 0x1000c
    s_add_u32 s71, s70, 1
    s_lshr_b32 s71, s71, 1
    s_add_u32 s78, s70, 2
    s_mul_i32 s32, s72, 3
    s_add_u32 s79, s78, s32
    v_lshl_add_u32 v18, s3, 2, v3
    v_cmp_le_u32 vcc, 7, v18
    s_sub_u32 s32, s70, s71
    s_nop 0
    v_cndmask_b32 v160, 0, 1, vcc
    v_mul_u32_u24 v161, 7, v160
    v_sub_u32 v161, v18, v161
    s_sub_i32 s33, s32, s71
    v_mul_i32_i24 v162, s33, v160
    v_add_u32 v162, s71, v162
    s_sub_i32 s33, s77, s74
    v_mul_i32_i24 v164, s33, v160
    v_add_u32 v164, s74, v164
    s_sub_i32 s33, s76, s73
    v_mul_i32_i24 v165, s33, v160
    v_add_u32 v165, s73, v165
    s_sub_i32 s33, s75, s72
    v_mul_i32_i24 v163, s33, v160
    v_add_u32 v163, s72, v163
    v_lshl_add_u32 v94, v161, 1, v160
    v_add_u32 v92, s69, v94
    v_mov_b32 v93, s68
    v_cmp_lt_u32 vcc, v161, v162
    v_cmp_eq_u32 s[60:61], v161, v162
    v_cmp_gt_u32 s[24:25], 3, v161
    v_cndmask_b32 v92, v164, v92, vcc
    v_cndmask_b32 v93, v165, v93, vcc
    v_cndmask_b32 v19, 0, v163, s[60:61]
    v_cndmask_b32 v96, 0, 1, vcc
    v_cndmask_b32 v19, v19, 1, vcc
    v_cmp_gt_u32 vcc, 14, v18
    v_add_u32 v95, v93, v2
    v_mul_u32_u24 v73, 224, v92
    v_cndmask_b32 v19, 0, v19, vcc
    v_add_u32 v73, v73, v95
    v_mul_lo_u32 v73, v73, v19
    v_mul_u32_u24 v173, 36, v73
    buffer_load_dwordx4 v[20:23], v173, s[12:15], 0 offen nt
    buffer_load_dwordx4 v[24:27], v173, s[12:15], 0 offen offset:16 nt
    buffer_load_dword v28, v173, s[12:15], 0 offen offset:32 nt
    s_cmp_eq_u32 s68, 0
    s_cselect_b32 s33, 192, 0
    v_mad_u32_u24 v90, v9, s33, v5
    s_cmp_eq_u32 s68, 208
    s_cselect_b32 s33, 192, 0
    v_mul_u32_u24 v91, s33, v10
    v_sub_u32 v91, v8, v91
    s_mul_i32 s34, s68, 192
    s_cmp_eq_u32 s3, 3
    s_cselect_b32 s36, 6, s3
    s_cselect_b32 s62, 1, 3
    s_add_u32 s32, s69, s36
    s_sub_i32 s32, s32, 1
    s_max_i32 s32, s32, 0
    s_min_i32 s32, s32, 223
    s_mul_i32 s32, s32, 43008
    s_mul_i32 m0, s36, 3456
    s_add_u32 s32, s32, s34
    buffer_load_dwordx4 v90, s[64:67], s32 offen nt lds
    buffer_load_dwordx4 v6, s[64:67], s32 offen offset:1024 nt lds
    buffer_load_dwordx4 v7, s[64:67], s32 offen offset:2048 nt lds
    s_mov_b64 exec, 0xffffff
    buffer_load_dwordx4 v91, s[64:67], s32 offen offset:3072 nt lds
    s_mov_b64 exec, -1
    s_add_u32 s36, s36, s62
    s_add_u32 s32, s69, s36
    s_sub_i32 s32, s32, 1
    s_max_i32 s32, s32, 0
    s_min_i32 s32, s32, 223
    s_mul_i32 s32, s32, 43008
    s_mul_i32 m0, s36, 3456
    s_add_u32 s32, s32, s34
    buffer_load_dwordx4 v90, s[64:67], s32 offen nt lds
    buffer_load_dwordx4 v6, s[64:67], s32 offen offset:1024 nt lds
    buffer_load_dwordx4 v7, s[64:67], s32 offen offset:2048 nt lds
    s_mov_b64 exec, 0xffffff
    buffer_load_dwordx4 v91, s[64:67], s32 offen offset:3072 nt lds
    s_mov_b64 exec, -1
    s_mul_i32 s32, s75, 3
    s_add_u32 s80, s79, s32
    s_add_u32 s32, s71, s72
    s_sub_u32 s33, s70, s71
    s_add_u32 s33, s33, s75
    s_cmp_eq_u32 s82, 0
    s_cselect_b32 s83, s32, s33
    s_sub_i32 s33, s79, s78
    v_mul_i32_i24 v166, s33, v160
    v_add_u32 v166, s78, v166
    v_cmp_ne_u32 vcc, 0, v96
    s_lshl_b32 s32, s78, 13
    s_or_b32 s32, s32, s69
    v_lshl_or_b32 v85, v166, 8, v164
    v_or_b32 v85, 0x6000, v85
    v_mov_b32 v174, s32
    v_cndmask_b32 v85, v85, v174, vcc
    v_lshl_or_b32 v85, v93, 18, v85
    v_cndmask_b32 v94, v166, v94, vcc
    v_add_u32 v174, -1, v92
    v_cvt_f32_i32 v30, v174
    v_add_u32 v174, -1, v95
    v_cvt_f32_i32 v33, v174
    v_med3_f32 v36, v30, 0, s30
    v_med3_f32 v39, v33, 0, s30
    v_add_u32 v174, 0, v94
    v_mul_u32_u24 v42, 3456, v174
    v_add_u32 v174, 0, v2
    v_and_b32 v175, 4, v174
    v_lshlrev_b32 v175, 3, v175
    v_mul_u32_u24 v174, 192, v174
    v_add_u32 v45, v174, v175
    v_add_u32 v174, 0, v92
    v_cvt_f32_i32 v31, v174
    v_add_u32 v174, 0, v95
    v_cvt_f32_i32 v34, v174
    v_med3_f32 v37, v31, 0, s30
    v_med3_f32 v40, v34, 0, s30
    v_add_u32 v174, 1, v94
    v_mul_u32_u24 v43, 3456, v174
    v_add_u32 v174, 1, v2
    v_and_b32 v175, 4, v174
    v_lshlrev_b32 v175, 3, v175
    v_mul_u32_u24 v174, 192, v174
    v_add_u32 v46, v174, v175
    v_add_u32 v174, 1, v92
    v_cvt_f32_i32 v32, v174
    v_add_u32 v174, 1, v95
    v_cvt_f32_i32 v35, v174
    v_med3_f32 v38, v32, 0, s30
    v_med3_f32 v41, v35, 0, s30
    v_add_u32 v174, 2, v94
    v_mul_u32_u24 v44, 3456, v174
    v_add_u32 v174, 2, v2
    v_and_b32 v175, 4, v174
    v_lshlrev_b32 v175, 3, v175
    v_mul_u32_u24 v174, 192, v174
    v_add_u32 v47, v174, v175
    v_cvt_pk_bf16_f32 v76, v36, v39
    v_add_u32 v60, v42, v45
    v_cvt_pk_bf16_f32 v77, v36, v40
    v_add_u32 v61, v42, v46
    v_cvt_pk_bf16_f32 v78, v36, v41
    v_add_u32 v62, v42, v47
    v_cvt_pk_bf16_f32 v79, v37, v39
    v_add_u32 v63, v43, v45
    v_cvt_pk_bf16_f32 v80, v37, v40
    v_add_u32 v64, v43, v46
    v_cvt_pk_bf16_f32 v81, v37, v41
    v_add_u32 v65, v43, v47
    v_cvt_pk_bf16_f32 v82, v38, v39
    v_add_u32 v66, v44, v45
    v_cvt_pk_bf16_f32 v83, v38, v40
    v_add_u32 v67, v44, v46
    v_cvt_pk_bf16_f32 v84, v38, v41
    v_add_u32 v68, v44, v47
    v_mul_u32_u24 v69, 192, v73
    v_mov_b32 v174, 43776
    v_mov_b32 v175, 143616
    v_cndmask_b32 v88, v174, v175, s[24:25]
    v_mov_b32 v87, 162048
    s_mov_b32 s5, 192
    s_mul_i32 s32, s81, 96
    v_and_b32 v163, 1, v3
    v_lshlrev_b32 v163, 5, v163
    v_lshrrev_b32 v164, 1, v3
    v_lshl_add_u32 v163, v164, 4, v163
    v_add_u32 v58, s32, v163
    s_add_u32 s32, s32, 64
    v_lshlrev_b32 v59, 3, v3
    v_add_u32 v59, s32, v59
    v_mul_u32_u24 v72, 48, v2
    s_mul_i32 s32, s82, 5376
    s_add_u32 s32, s32, 117504
    v_add_u32 v72, s32, v72
    v_mul_u32_u24 v74, 5462, v1
    v_lshrrev_b32 v74, 16, v74
    v_mul_u32_u24 v75, 12, v74
    v_sub_u32 v75, v1, v75
    v_min_u32 v74, 4, v74
    v_lshlrev_b32 v75, 4, v75
    v_and_b32 v14, 0x30, v75
    v_and_b32 v29, 0xc0, v75
    v_mul_u32_u24 v160, 768, v18
    v_mul_u32_u24 v161, 48, v2
    v_add_u32 v160, v160, v161
    v_add_u32 v57, 117504, v160
    v_lshrrev_b32 v160, 2, v1
    v_and_b32 v160, 3, v160
    v_lshl_add_u32 v160, v3, 3, v160
    v_mul_u32_u24 v160, 192, v160
    v_and_b32 v161, 3, v1
    v_lshl_add_u32 v160, v161, 3, v160
    v_add_u32 v160, 62208, v160
    s_mul_i32 s32, s81, 3
    s_add_u32 s33, s32, 0
    v_and_b32 v162, 1, v3
    v_xor_b32 v162, s33, v162
    v_lshl_add_u32 v15, v162, 5, v160
    s_add_u32 s33, s32, 1
    v_and_b32 v162, 1, v3
    v_xor_b32 v162, s33, v162
    v_lshl_add_u32 v16, v162, 5, v160
    s_add_u32 s33, s32, 2
    v_and_b32 v162, 1, v3
    v_xor_b32 v162, s33, v162
    v_lshl_add_u32 v17, v162, 5, v160
    v_mov_b32 v98, 0
    s_mul_i32 s4, s3, 6144
    s_add_u32 s27, s4, 62208
    s_cmp_eq_u32 s3, 3
    s_cbranch_scc1 L_ow3
    s_add_u32 m0, s27, 0
    s_add_u32 s32, s4, 0
    buffer_load_dwordx4 v11, s[16:19], s32 offen offset:0 lds
    buffer_load_dwordx4 v12, s[16:19], s32 offen offset:1024 lds
    buffer_load_dwordx4 v13, s[16:19], s32 offen offset:2048 lds
    s_add_u32 m0, s27, 3072
    s_add_u32 s32, s4, 3072
    buffer_load_dwordx4 v11, s[16:19], s32 offen offset:0 lds
    buffer_load_dwordx4 v12, s[16:19], s32 offen offset:1024 lds
    buffer_load_dwordx4 v13, s[16:19], s32 offen offset:2048 lds
    s_waitcnt vmcnt(14)
    s_branch L_ow
L_ow3:
    s_waitcnt vmcnt(8)
L_ow:
    v_cmp_ne_u32 vcc, 0, v19
    s_and_saveexec_b64 s[58:59], vcc
    s_cbranch_execz L_posdone
    s_mov_b32 s35, 0x435f435f
    v_lshlrev_b32 v160, 16, v20
    v_and_b32 v161, 0xffff0000, v20
    v_add_f32 v160, v30, v160
    v_add_f32 v161, v33, v161
    v_cvt_pk_bf16_f32 v48, v160, v161
    v_pk_max_i16 v48, v48, 0
    v_pk_min_i16 v48, v48, s35
    v_cmp_ne_u32 s[40:41], v48, v76
    v_lshlrev_b32 v162, 16, v21
    v_and_b32 v163, 0xffff0000, v21
    v_add_f32 v162, v30, v162
    v_add_f32 v163, v34, v163
    v_cvt_pk_bf16_f32 v49, v162, v163
    v_pk_max_i16 v49, v49, 0
    v_pk_min_i16 v49, v49, s35
    v_cmp_ne_u32 s[42:43], v49, v77
    v_lshlrev_b32 v160, 16, v22
    v_and_b32 v161, 0xffff0000, v22
    v_add_f32 v160, v30, v160
    v_add_f32 v161, v35, v161
    v_cvt_pk_bf16_f32 v50, v160, v161
    v_pk_max_i16 v50, v50, 0
    v_pk_min_i16 v50, v50, s35
    v_cmp_ne_u32 s[44:45], v50, v78
    v_lshlrev_b32 v162, 16, v23
    v_and_b32 v163, 0xffff0000, v23
    v_add_f32 v162, v31, v162
    v_add_f32 v163, v33, v163
    v_cvt_pk_bf16_f32 v51, v162, v163
    v_pk_max_i16 v51, v51, 0
    v_pk_min_i16 v51, v51, s35
    v_cmp_ne_u32 s[46:47], v51, v79
    v_lshlrev_b32 v160, 16, v24
    v_and_b32 v161, 0xffff0000, v24
    v_add_f32 v160, v31, v160
    v_add_f32 v161, v34, v161
    v_cvt_pk_bf16_f32 v52, v160, v161
    v_pk_max_i16 v52, v52, 0
    v_pk_min_i16 v52, v52, s35
    v_cmp_ne_u32 s[48:49], v52, v80
    v_lshlrev_b32 v162, 16, v25
    v_and_b32 v163, 0xffff0000, v25
    v_add_f32 v162, v31, v162
    v_add_f32 v163, v35, v163
    v_cvt_pk_bf16_f32 v53, v162, v163
    v_pk_max_i16 v53, v53, 0
    v_pk_min_i16 v53, v53, s35
    v_cmp_ne_u32 s[50:51], v53, v81
    v_lshlrev_b32 v160, 16, v26
    v_and_b32 v161, 0xffff0000, v26
    v_add_f32 v160, v32, v160
    v_add_f32 v161, v33, v161
    v_cvt_pk_bf16_f32 v54, v160, v161
    v_pk_max_i16 v54, v54, 0
    v_pk_min_i16 v54, v54, s35
    v_cmp_ne_u32 s[52:53], v54, v82
    v_lshlrev_b32 v162, 16, v27
    v_and_b32 v163, 0xffff0000, v27
    v_add_f32 v162, v32, v162
    v_add_f32 v163, v34, v163
    v_cvt_pk_bf16_f32 v55, v162, v163
    v_pk_max_i16 v55, v55, 0
    v_pk_min_i16 v55, v55, s35
    v_cmp_ne_u32 s[54:55], v55, v83
    v_lshlrev_b32 v160, 16, v28
    v_and_b32 v161, 0xffff0000, v28
    v_add_f32 v160, v32, v160
    v_add_f32 v161, v35, v161
    v_cvt_pk_bf16_f32 v56, v160, v161
    v_pk_max_i16 v56, v56, 0
    v_pk_min_i16 v56, v56, s35
    v_cmp_ne_u32 s[56:57], v56, v84
    s_or_b64 s[60:61], s[40:41], s[42:43]
    s_or_b64 s[60:61], s[60:61], s[44:45]
    s_or_b64 s[60:61], s[60:61], s[46:47]
    s_or_b64 s[60:61], s[60:61], s[48:49]
    s_or_b64 s[60:61], s[60:61], s[50:51]
    s_or_b64 s[60:61], s[60:61], s[52:53]
    s_or_b64 s[60:61], s[60:61], s[54:55]
    s_or_b64 s[60:61], s[60:61], s[56:57]
    s_cbranch_scc0 L_nolist
    s_mov_b64 s[60:61], exec
    s_mov_b64 exec, -1
    v_mov_b32 v89, 0
    v_mbcnt_lo_u32_b32 v89, s40, v89
    v_mbcnt_hi_u32_b32 v89, s41, v89
    v_addc_co_u32_e64 v98, vcc, v98, 0, s[40:41]
    v_mbcnt_lo_u32_b32 v89, s42, v89
    v_mbcnt_hi_u32_b32 v89, s43, v89
    v_addc_co_u32_e64 v98, vcc, v98, 0, s[42:43]
    v_mbcnt_lo_u32_b32 v89, s44, v89
    v_mbcnt_hi_u32_b32 v89, s45, v89
    v_addc_co_u32_e64 v98, vcc, v98, 0, s[44:45]
    v_mbcnt_lo_u32_b32 v89, s46, v89
    v_mbcnt_hi_u32_b32 v89, s47, v89
    v_addc_co_u32_e64 v98, vcc, v98, 0, s[46:47]
    v_mbcnt_lo_u32_b32 v89, s48, v89
    v_mbcnt_hi_u32_b32 v89, s49, v89
    v_addc_co_u32_e64 v98, vcc, v98, 0, s[48:49]
    v_mbcnt_lo_u32_b32 v89, s50, v89
    v_mbcnt_hi_u32_b32 v89, s51, v89
    v_addc_co_u32_e64 v98, vcc, v98, 0, s[50:51]
    v_mbcnt_lo_u32_b32 v89, s52, v89
    v_mbcnt_hi_u32_b32 v89, s53, v89
    v_addc_co_u32_e64 v98, vcc, v98, 0, s[52:53]
    v_mbcnt_lo_u32_b32 v89, s54, v89
    v_mbcnt_hi_u32_b32 v89, s55, v89
    v_addc_co_u32_e64 v98, vcc, v98, 0, s[54:55]
    v_mbcnt_lo_u32_b32 v89, s56, v89
    v_mbcnt_hi_u32_b32 v89, s57, v89
    v_addc_co_u32_e64 v98, vcc, v98, 0, s[56:57]
    s_cmp_eq_u32 s3, 2
    s_cselect_b32 s7, 32, 48
    v_add_u32 v98, v98, v89
    s_cmp_eq_u32 s3, 3
    s_cselect_b32 s7, 0, s7
    v_readlane_b32 s6, v98, 63
    v_readlane_b32 s32, v89, s7
    s_mov_b64 exec, s[60:61]
    s_sub_u32 s33, s6, s32
    s_cmp_eq_u32 s3, 1
    s_cselect_b32 s31, s33, s32
    s_cselect_b32 s38, s32, s33
    v_mov_b32 v160, 162240
    v_mov_b32 v162, s31
    v_mov_b32 v163, s38
    s_ff1_i32_b64 s32, exec
    s_lshl_b64 exec, 1, s32
    ds_add_rtn_u64 v[164:165], v160, v[162:163]
    s_cmp_eq_u32 s3, 1
    s_cselect_b32 s34, s38, 0
    s_cselect_b32 s35, 0, s31
    s_waitcnt lgkmcnt(0)
    v_readfirstlane_b32 s37, v164
    v_readfirstlane_b32 s26, v165
    s_mov_b64 exec, s[60:61]
    s_add_u32 s32, s37, s31
    s_add_u32 s33, s26, s38
    s_sub_i32 s32, s32, 96
    s_sub_i32 s33, s33, 288
    s_max_i32 s32, s32, s33
    s_cmp_gt_i32 s32, 0
    s_cbranch_scc1 L_nolist
    s_add_u32 s26, s26, 96
    s_sub_u32 s37, s37, s34
    s_sub_u32 s26, s26, s35
    v_mov_b32 v160, s26
    v_mov_b32 v161, s37
    s_mov_b32 s34, 128256
    v_cndmask_b32 v160, v160, v161, s[24:25]
    v_add_u32 v86, v89, v160
    v_mad_u32_u24 v160, v86, s5, v88
    v_lshl_add_u32 v161, v86, 3, s34
    v_cndmask_b32 v60, v60, v160, s[40:41]
    v_cndmask_b32 v161, v87, v161, s[40:41]
    v_addc_co_u32_e64 v86, vcc, v86, 0, s[40:41]
    ds_write2_b32 v161, v48, v85 offset0:0 offset1:1
    v_mad_u32_u24 v162, v86, s5, v88
    v_lshl_add_u32 v163, v86, 3, s34
    v_cndmask_b32 v61, v61, v162, s[42:43]
    v_cndmask_b32 v163, v87, v163, s[42:43]
    v_addc_co_u32_e64 v86, vcc, v86, 0, s[42:43]
    ds_write2_b32 v163, v49, v85 offset0:0 offset1:1
    v_mad_u32_u24 v160, v86, s5, v88
    v_lshl_add_u32 v161, v86, 3, s34
    v_cndmask_b32 v62, v62, v160, s[44:45]
    v_cndmask_b32 v161, v87, v161, s[44:45]
    v_addc_co_u32_e64 v86, vcc, v86, 0, s[44:45]
    ds_write2_b32 v161, v50, v85 offset0:0 offset1:1
    v_mad_u32_u24 v162, v86, s5, v88
    v_lshl_add_u32 v163, v86, 3, s34
    v_cndmask_b32 v63, v63, v162, s[46:47]
    v_cndmask_b32 v163, v87, v163, s[46:47]
    v_addc_co_u32_e64 v86, vcc, v86, 0, s[46:47]
    ds_write2_b32 v163, v51, v85 offset0:0 offset1:1
    v_mad_u32_u24 v160, v86, s5, v88
    v_lshl_add_u32 v161, v86, 3, s34
    v_cndmask_b32 v64, v64, v160, s[48:49]
    v_cndmask_b32 v161, v87, v161, s[48:49]
    v_addc_co_u32_e64 v86, vcc, v86, 0, s[48:49]
    ds_write2_b32 v161, v52, v85 offset0:0 offset1:1
    v_mad_u32_u24 v162, v86, s5, v88
    v_lshl_add_u32 v163, v86, 3, s34
    v_cndmask_b32 v65, v65, v162, s[50:51]
    v_cndmask_b32 v163, v87, v163, s[50:51]
    v_addc_co_u32_e64 v86, vcc, v86, 0, s[50:51]
    ds_write2_b32 v163, v53, v85 offset0:0 offset1:1
    v_mad_u32_u24 v160, v86, s5, v88
    v_lshl_add_u32 v161, v86, 3, s34
    v_cndmask_b32 v66, v66, v160, s[52:53]
    v_cndmask_b32 v161, v87, v161, s[52:53]
    v_addc_co_u32_e64 v86, vcc, v86, 0, s[52:53]
    ds_write2_b32 v161, v54, v85 offset0:0 offset1:1
    v_mad_u32_u24 v162, v86, s5, v88
    v_lshl_add_u32 v163, v86, 3, s34
    v_cndmask_b32 v67, v67, v162, s[54:55]
    v_cndmask_b32 v163, v87, v163, s[54:55]
    v_addc_co_u32_e64 v86, vcc, v86, 0, s[54:55]
    ds_write2_b32 v163, v55, v85 offset0:0 offset1:1
    v_mad_u32_u24 v160, v86, s5, v88
    v_lshl_add_u32 v161, v86, 3, s34
    v_cndmask_b32 v68, v68, v160, s[56:57]
    v_cndmask_b32 v161, v87, v161, s[56:57]
    v_addc_co_u32_e64 v86, vcc, v86, 0, s[56:57]
    ds_write2_b32 v161, v56, v85 offset0:0 offset1:1
L_nolist:
    ds_write_b128 v57, v[60:63]
    ds_write_b128 v57, v[64:67] offset:16
    ds_write_b64 v57, v[68:69] offset:32
L_posdone:
    s_mov_b64 exec, s[58:59]
    s_cmp_eq_u32 s3, 3
    s_cbranch_scc1 L_w12x
    s_add_u32 m0, s27, 18432
    s_add_u32 s32, s4, 18432
    buffer_load_dwordx4 v11, s[16:19], s32 offen offset:0 lds
    buffer_load_dwordx4 v12, s[16:19], s32 offen offset:1024 lds
    buffer_load_dwordx4 v13, s[16:19], s32 offen offset:2048 lds
    s_add_u32 m0, s27, 21504
    s_add_u32 s32, s4, 21504
    buffer_load_dwordx4 v11, s[16:19], s32 offen offset:0 lds
    buffer_load_dwordx4 v12, s[16:19], s32 offen offset:1024 lds
    buffer_load_dwordx4 v13, s[16:19], s32 offen offset:2048 lds
    s_branch L_w12
L_w12x:
    s_mov_b32 s44, s74
    s_mul_i32 s45, s73, 192
    s_sub_i32 s45, s45, 384
    s_max_i32 s45, s45, 0
    s_mov_b32 s46, s77
    s_mul_i32 s47, s76, 192
    s_sub_i32 s47, s47, 384
    s_max_i32 s47, s47, 0
    v_add_u32 v166, 8, v1
    s_sub_u32 s32, s77, s79
    s_sub_u32 s33, s74, s78
    v_cmp_gt_u32 vcc, s79, v166
    v_mov_b32 v167, s32
    v_mov_b32 v169, s33
    v_cndmask_b32 v167, v167, v169, vcc
    v_mov_b32 v168, s76
    v_mov_b32 v169, s73
    v_cndmask_b32 v168, v168, v169, vcc
    v_cmp_gt_u32 vcc, s78, v166
    v_mov_b32 v169, s69
    s_nop 0
    v_cndmask_b32 v167, v167, v169, vcc
    v_mov_b32 v169, s68
    v_cndmask_b32 v168, v168, v169, vcc
    v_add_u32 v167, v167, v166
    v_add_u32 v167, -1, v167
    v_max_i32 v167, 0, v167
    v_min_i32 v167, 223, v167
    v_mul_u32_u24 v167, 43008, v167
    v_cmp_eq_u32 s[56:57], 0, v168
    v_mov_b32 v169, 208
    v_mad_u32_u24 v167, v168, s5, v167
    v_cmp_eq_u32 s[100:101], v169, v168
    s_nop 0
    v_readlane_b32 s68, v167, 0
    v_readlane_b32 s69, v167, 1
    v_readlane_b32 s73, v167, 2
    v_readlane_b32 s74, v167, 3
    v_readlane_b32 s76, v167, 4
    v_readlane_b32 s77, v167, 5
    v_readlane_b32 s78, v167, 6
    v_readlane_b32 s79, v167, 7
    v_readlane_b32 s54, v167, 8
    v_readlane_b32 s55, v167, 9
L_w12:
    s_waitcnt lgkmcnt(0)
    s_barrier
    v_mov_b32 v160, 162240
    ds_read_b64 v[162:163], v160
    s_cmp_lg_u32 s3, 3
    s_cbranch_scc1 L_xdone
    s_bitcmp1_b64 s[56:57], 0
    s_cselect_b32 s33, 192, 0
    v_mad_u32_u24 v170, v9, s33, v5
    s_bitcmp1_b64 s[100:101], 0
    s_cselect_b32 s33, 192, 0
    v_mul_u32_u24 v171, s33, v10
    s_mov_b32 m0, 27648
    v_sub_u32 v171, v8, v171
    buffer_load_dwordx4 v170, s[64:67], s68 offen nt lds
    buffer_load_dwordx4 v6, s[64:67], s68 offen offset:1024 nt lds
    buffer_load_dwordx4 v7, s[64:67], s68 offen offset:2048 nt lds
    s_mov_b64 exec, 0xffffff
    buffer_load_dwordx4 v171, s[64:67], s68 offen offset:3072 nt lds
    s_mov_b64 exec, -1
    s_bitcmp1_b64 s[56:57], 1
    s_cselect_b32 s33, 192, 0
    v_mad_u32_u24 v170, v9, s33, v5
    s_bitcmp1_b64 s[100:101], 1
    s_cselect_b32 s33, 192, 0
    v_mul_u32_u24 v171, s33, v10
    s_mov_b32 m0, 31104
    v_sub_u32 v171, v8, v171
    buffer_load_dwordx4 v170, s[64:67], s69 offen nt lds
    buffer_load_dwordx4 v6, s[64:67], s69 offen offset:1024 nt lds
    buffer_load_dwordx4 v7, s[64:67], s69 offen offset:2048 nt lds
    s_mov_b64 exec, 0xffffff
    buffer_load_dwordx4 v171, s[64:67], s69 offen offset:3072 nt lds
    s_mov_b64 exec, -1
    s_bitcmp1_b64 s[56:57], 2
    s_cselect_b32 s33, 192, 0
    v_mad_u32_u24 v170, v9, s33, v5
    s_bitcmp1_b64 s[100:101], 2
    s_cselect_b32 s33, 192, 0
    v_mul_u32_u24 v171, s33, v10
    s_mov_b32 m0, 34560
    v_sub_u32 v171, v8, v171
    buffer_load_dwordx4 v170, s[64:67], s73 offen nt lds
    buffer_load_dwordx4 v6, s[64:67], s73 offen offset:1024 nt lds
    buffer_load_dwordx4 v7, s[64:67], s73 offen offset:2048 nt lds
    s_mov_b64 exec, 0xffffff
    buffer_load_dwordx4 v171, s[64:67], s73 offen offset:3072 nt lds
    s_mov_b64 exec, -1
    s_bitcmp1_b64 s[56:57], 3
    s_cselect_b32 s33, 192, 0
    v_mad_u32_u24 v170, v9, s33, v5
    s_bitcmp1_b64 s[100:101], 3
    s_cselect_b32 s33, 192, 0
    v_mul_u32_u24 v171, s33, v10
    s_mov_b32 m0, 38016
    v_sub_u32 v171, v8, v171
    buffer_load_dwordx4 v170, s[64:67], s74 offen nt lds
    buffer_load_dwordx4 v6, s[64:67], s74 offen offset:1024 nt lds
    buffer_load_dwordx4 v7, s[64:67], s74 offen offset:2048 nt lds
    s_mov_b64 exec, 0xffffff
    buffer_load_dwordx4 v171, s[64:67], s74 offen offset:3072 nt lds
    s_mov_b64 exec, -1
    v_lshlrev_b32 v172, 7, v1
    s_mov_b64 exec, 0x7fffffff
    s_add_i32 s32, s44, -2
    s_max_i32 s32, s32, 0
    s_min_i32 s32, s32, 223
    s_mul_i32 s32, s32, 43008
    s_add_u32 s32, s32, s45
    buffer_load_dword v44, v172, s[8:11], s32 offen
    s_add_i32 s32, s44, 2
    s_max_i32 s32, s32, 0
    s_min_i32 s32, s32, 223
    s_mul_i32 s32, s32, 43008
    s_add_u32 s32, s32, s45
    buffer_load_dword v44, v172, s[8:11], s32 offen
    s_add_i32 s32, s46, -2
    s_max_i32 s32, s32, 0
    s_min_i32 s32, s32, 223
    s_mul_i32 s32, s32, 43008
    s_add_u32 s32, s32, s47
    buffer_load_dword v44, v172, s[8:11], s32 offen
    s_add_i32 s32, s46, 2
    s_max_i32 s32, s32, 0
    s_min_i32 s32, s32, 223
    s_mul_i32 s32, s32, 43008
    s_add_u32 s32, s32, s47
    buffer_load_dword v44, v172, s[8:11], s32 offen
    s_mov_b64 exec, -1
L_xdone:
    s_waitcnt lgkmcnt(0)
    v_readfirstlane_b32 s31, v162
    v_readfirstlane_b32 s38, v163
    s_mov_b32 s40, 0
    s_mov_b32 s41, 0
    s_sub_i32 s32, s31, 96
    s_sub_i32 s33, s38, 288
    s_max_i32 s32, s32, s33
    s_cmp_gt_i32 s32, 0
    s_cbranch_scc1 L_slow
    s_mov_b32 s42, 0
    s_cmp_eq_u32 s31, 0
    s_cbranch_scc1 L_noearly_a
    s_cmp_eq_u32 s3, 3
    s_cbranch_scc1 L_noearly_a
    v_mul_u32_u24 v112, 3, v1
    v_add_u32 v112, s3, v112
    s_mov_b32 s35, 0
L_dt_1:
    v_cmp_gt_u32 vcc, s31, v112
    s_and_saveexec_b64 s[58:59], vcc
    s_cbranch_execz L_dd_2
    v_lshlrev_b32 v135, 3, v112
    v_add_u32 v135, 128256, v135
    ds_read_b64 v[114:115], v135
    v_mul_u32_u24 v132, 192, v112
    v_add_u32 v132, 143616, v132
    s_waitcnt lgkmcnt(0)
    v_lshlrev_b32 v116, 16, v114
    v_and_b32 v117, 0xffff0000, v114
    v_floor_f32 v118, v116
    v_floor_f32 v119, v117
    v_sub_f32 v120, v116, v118
    v_sub_f32 v121, v117, v119
    v_cvt_u32_f32 v118, v118
    v_cvt_u32_f32 v119, v119
    v_cmp_eq_f32 s[44:45], 0, v121
    v_cmp_neq_f32 s[46:47], 0, v120
    v_sub_f32 v116, 1.0, v120
    v_sub_f32 v117, 1.0, v121
    v_cvt_pk_bf16_f32 v135, v116, v117
    v_sub_u32 v123, 223, v119
    v_sub_u32 v124, 223, v118
    v_lshlrev_b32 v116, 16, v135
    v_and_b32 v117, 0xffff0000, v135
    v_min_u32 v123, 1, v123
    v_min_u32 v124, 1, v124
    v_mul_f32 v125, v116, v117
    v_mul_f32 v126, v116, v121
    v_mul_f32 v127, v120, v117
    v_mul_f32 v128, v120, v121
    v_cndmask_b32 v133, 0, 1, s[46:47]
    v_cvt_pk_bf16_f32 v129, v125, v126
    v_cvt_pk_bf16_f32 v130, v125, v127
    v_cvt_pk_bf16_f32 v131, v127, v128
    v_cndmask_b32 v133, v133, 0, s[44:45]
    v_cndmask_b32 v134, v129, v130, s[44:45]
    v_mul_u32_u24 v122, 43008, v118
    v_mul_u32_u24 v139, 192, v123
    v_mul_u32_u24 v140, 43008, v124
    v_mad_u32_u24 v144, v119, s5, v122
    v_cndmask_b32 v135, v139, v140, s[44:45]
    v_add_u32 v148, v144, v140
    v_add_u32 v145, v144, v135
    v_add_u32 v149, v148, v139
    v_mov_b32 v146, v134
    v_lshl_or_b32 v147, v133, 31, v132
    v_mul_lo_u32 v150, v131, v133
    v_mov_b32 v151, 0
    v_mbcnt_lo_u32_b32 v136, exec_lo, 0
    v_mbcnt_hi_u32_b32 v136, exec_hi, v136
    s_mul_i32 s32, s3, 1024
    s_add_u32 s33, s32, 132320
    v_add_u32 v136, s41, v136
    v_lshlrev_b32 v136, 5, v136
    v_sub_u32 v136, s33, v136
    s_bcnt1_i32_b64 s32, exec
    s_add_u32 s41, s41, s32
    ds_write_b128 v136, v[144:147]
    ds_write_b128 v136, v[148:151] offset:16
    s_mov_b64 exec, s[58:59]
L_dd_2:
    s_mov_b64 exec, s[58:59]
    s_mov_b32 s42, s41
    s_mov_b32 s41, 0
    s_mul_i32 s43, s3, 1024
    s_add_u32 s43, s43, 132320
    s_mov_b32 s36, 0
    s_cmp_eq_u32 s42, 0
    s_cbranch_scc1 L_noearly_a
    s_waitcnt lgkmcnt(0)
    s_sub_u32 s33, s42, 1
    s_add_u32 s32, s36, 0
    v_add_u32 v48, s32, v74
    v_min_u32 v48, s33, v48
    v_lshlrev_b32 v48, 5, v48
    v_sub_u32 v48, s43, v48
    ds_read_b128 v[20:23], v48
    ds_read_b128 v[24:27], v48 offset:16
    s_add_u32 s32, s36, 5
    v_add_u32 v49, s32, v74
    v_min_u32 v49, s33, v49
    v_lshlrev_b32 v49, 5, v49
    v_sub_u32 v49, s43, v49
    ds_read_b128 v[36:39], v49
    ds_read_b128 v[40:43], v49 offset:16
    s_waitcnt lgkmcnt(0)
    v_cmp_gt_i32 vcc, 0, v23
    v_add_u32 v20, v20, v75
    v_add_u32 v21, v21, v75
    buffer_load_dwordx4 v[76:79], v20, s[8:11], 0 offen
    buffer_load_dwordx4 v[80:83], v21, s[8:11], 0 offen
    s_cmp_lg_u64 vcc, 0
    s_cselect_b32 s52, 1, 0
    s_cbranch_scc0 L_g2_3
    v_add_u32 v24, v24, v75
    v_add_u32 v25, v25, v75
    buffer_load_dwordx4 v[84:87], v24, s[8:11], 0 offen
    buffer_load_dwordx4 v[88:91], v25, s[8:11], 0 offen
L_g2_3:
    s_mov_b32 s53, 0
    s_add_u32 s32, s36, 5
    s_cmp_ge_u32 s32, s42
    s_cbranch_scc1 L_e1_b
    v_cmp_gt_i32 vcc, 0, v39
    v_add_u32 v36, v36, v75
    v_add_u32 v37, v37, v75
    buffer_load_dwordx4 v[92:95], v36, s[8:11], 0 offen
    buffer_load_dwordx4 v[96:99], v37, s[8:11], 0 offen
    s_cmp_lg_u64 vcc, 0
    s_cselect_b32 s53, 1, 0
    s_cbranch_scc0 L_g2_4
    v_add_u32 v40, v40, v75
    v_add_u32 v41, v41, v75
    buffer_load_dwordx4 v[100:103], v40, s[8:11], 0 offen
    buffer_load_dwordx4 v[104:107], v41, s[8:11], 0 offen
L_g2_4:
L_e1_b:
L_noearly_a:
L_nodesc:
    ds_read_b128 v[158:161], v72 offset:0
    ds_read_b128 v[162:165], v72 offset:16
    ds_read_b64 v[166:167], v72 offset:32
    ds_read_b128 v[168:171], v72 offset:768
    ds_read_b128 v[172:175], v72 offset:784
    ds_read_b64 v[176:177], v72 offset:800
    ds_read_b128 v[178:181], v72 offset:1536
    ds_read_b128 v[182:185], v72 offset:1552
    ds_read_b64 v[186:187], v72 offset:1568
    s_cmp_eq_u32 s3, 3
    s_cbranch_scc1 L_b1
    s_add_u32 m0, s27, 36864
    s_add_u32 s32, s4, 36864
    buffer_load_dwordx4 v11, s[16:19], s32 offen offset:0 lds
    buffer_load_dwordx4 v12, s[16:19], s32 offen offset:1024 lds
    buffer_load_dwordx4 v13, s[16:19], s32 offen offset:2048 lds
    s_add_u32 m0, s27, 39936
    s_add_u32 s32, s4, 39936
    buffer_load_dwordx4 v11, s[16:19], s32 offen offset:0 lds
    buffer_load_dwordx4 v12, s[16:19], s32 offen offset:1024 lds
    buffer_load_dwordx4 v13, s[16:19], s32 offen offset:2048 lds
L_b1:
    s_waitcnt lgkmcnt(0)
    v_xor_b32 v128, v158, v4
    v_xor_b32 v129, v159, v4
    v_xor_b32 v130, v160, v4
    v_xor_b32 v131, v161, v4
    v_xor_b32 v132, v162, v4
    v_xor_b32 v133, v163, v4
    v_xor_b32 v134, v164, v4
    v_xor_b32 v135, v165, v4
    v_xor_b32 v136, v166, v4
    v_xor_b32 v137, v168, v4
    v_xor_b32 v138, v169, v4
    v_xor_b32 v139, v170, v4
    v_xor_b32 v140, v171, v4
    v_xor_b32 v141, v172, v4
    v_xor_b32 v142, v173, v4
    v_xor_b32 v143, v174, v4
    v_xor_b32 v144, v175, v4
    v_xor_b32 v145, v176, v4
    v_xor_b32 v146, v178, v4
    v_xor_b32 v147, v179, v4
    v_xor_b32 v148, v180, v4
    v_xor_b32 v149, v181, v4
    v_xor_b32 v150, v182, v4
    v_xor_b32 v151, v183, v4
    v_xor_b32 v152, v184, v4
    v_xor_b32 v153, v185, v4
    v_xor_b32 v154, v186, v4
    v_mov_b32 v181, v167
    v_mov_b32 v182, v177
    v_mov_b32 v183, v187
    v_add_u32 v72, 2304, v72
    s_cmp_eq_u32 s42, 0
    s_cbranch_scc1 L_noearly_b
    s_waitcnt vmcnt(0)
    v_and_b32 v50, 0xffff, v22
    v_lshlrev_b32 v51, 16, v22
    v_lshrrev_b32 v52, 16, v22
    v_and_b32 v53, 0xffff0000, v22
    v_dot2_f32_bf16 v60, v76, v50, 0
    v_dot2_f32_bf16 v61, v76, v51, 0
    v_dot2_f32_bf16 v62, v77, v50, 0
    v_dot2_f32_bf16 v63, v77, v51, 0
    v_dot2_f32_bf16 v64, v78, v50, 0
    v_dot2_f32_bf16 v65, v78, v51, 0
    v_dot2_f32_bf16 v66, v79, v50, 0
    v_dot2_f32_bf16 v67, v79, v51, 0
    v_dot2c_f32_bf16 v60, v80, v52
    v_dot2c_f32_bf16 v61, v80, v53
    v_dot2c_f32_bf16 v62, v81, v52
    v_dot2c_f32_bf16 v63, v81, v53
    v_dot2c_f32_bf16 v64, v82, v52
    v_dot2c_f32_bf16 v65, v82, v53
    v_dot2c_f32_bf16 v66, v83, v52
    v_dot2c_f32_bf16 v67, v83, v53
    s_cmp_eq_u32 s52, 0
    s_cbranch_scc1 L_g4_5
    v_and_b32 v50, 0xffff, v26
    v_lshlrev_b32 v51, 16, v26
    v_lshrrev_b32 v52, 16, v26
    v_and_b32 v53, 0xffff0000, v26
    v_dot2_f32_bf16 v60, v84, v50, v60
    v_dot2_f32_bf16 v61, v84, v51, v61
    v_dot2_f32_bf16 v62, v85, v50, v62
    v_dot2_f32_bf16 v63, v85, v51, v63
    v_dot2_f32_bf16 v64, v86, v50, v64
    v_dot2_f32_bf16 v65, v86, v51, v65
    v_dot2_f32_bf16 v66, v87, v50, v66
    v_dot2_f32_bf16 v67, v87, v51, v67
    v_dot2c_f32_bf16 v60, v88, v52
    v_dot2c_f32_bf16 v61, v88, v53
    v_dot2c_f32_bf16 v62, v89, v52
    v_dot2c_f32_bf16 v63, v89, v53
    v_dot2c_f32_bf16 v64, v90, v52
    v_dot2c_f32_bf16 v65, v90, v53
    v_dot2c_f32_bf16 v66, v91, v52
    v_dot2c_f32_bf16 v67, v91, v53
L_g4_5:
    v_and_b32 v23, 0x7fffffff, v23
    v_add_u32 v23, v23, v75
    s_nop 0
    v_cvt_pk_bf16_f32 v68, v60, v61
    v_cvt_pk_bf16_f32 v69, v62, v63
    v_cvt_pk_bf16_f32 v70, v64, v65
    v_cvt_pk_bf16_f32 v71, v66, v67
    ds_write_b128 v23, v[68:71]
    s_add_u32 s32, s36, 5
    s_cmp_ge_u32 s32, s42
    s_cbranch_scc1 L_e1_c
    v_and_b32 v50, 0xffff, v38
    v_lshlrev_b32 v51, 16, v38
    v_lshrrev_b32 v52, 16, v38
    v_and_b32 v53, 0xffff0000, v38
    v_dot2_f32_bf16 v60, v92, v50, 0
    v_dot2_f32_bf16 v61, v92, v51, 0
    v_dot2_f32_bf16 v62, v93, v50, 0
    v_dot2_f32_bf16 v63, v93, v51, 0
    v_dot2_f32_bf16 v64, v94, v50, 0
    v_dot2_f32_bf16 v65, v94, v51, 0
    v_dot2_f32_bf16 v66, v95, v50, 0
    v_dot2_f32_bf16 v67, v95, v51, 0
    v_dot2c_f32_bf16 v60, v96, v52
    v_dot2c_f32_bf16 v61, v96, v53
    v_dot2c_f32_bf16 v62, v97, v52
    v_dot2c_f32_bf16 v63, v97, v53
    v_dot2c_f32_bf16 v64, v98, v52
    v_dot2c_f32_bf16 v65, v98, v53
    v_dot2c_f32_bf16 v66, v99, v52
    v_dot2c_f32_bf16 v67, v99, v53
    s_cmp_eq_u32 s53, 0
    s_cbranch_scc1 L_g4_6
    v_and_b32 v50, 0xffff, v42
    v_lshlrev_b32 v51, 16, v42
    v_lshrrev_b32 v52, 16, v42
    v_and_b32 v53, 0xffff0000, v42
    v_dot2_f32_bf16 v60, v100, v50, v60
    v_dot2_f32_bf16 v61, v100, v51, v61
    v_dot2_f32_bf16 v62, v101, v50, v62
    v_dot2_f32_bf16 v63, v101, v51, v63
    v_dot2_f32_bf16 v64, v102, v50, v64
    v_dot2_f32_bf16 v65, v102, v51, v65
    v_dot2_f32_bf16 v66, v103, v50, v66
    v_dot2_f32_bf16 v67, v103, v51, v67
    v_dot2c_f32_bf16 v60, v104, v52
    v_dot2c_f32_bf16 v61, v104, v53
    v_dot2c_f32_bf16 v62, v105, v52
    v_dot2c_f32_bf16 v63, v105, v53
    v_dot2c_f32_bf16 v64, v106, v52
    v_dot2c_f32_bf16 v65, v106, v53
    v_dot2c_f32_bf16 v66, v107, v52
    v_dot2c_f32_bf16 v67, v107, v53
L_g4_6:
    v_and_b32 v39, 0x7fffffff, v39
    v_add_u32 v39, v39, v75
    s_nop 0
    v_cvt_pk_bf16_f32 v68, v60, v61
    v_cvt_pk_bf16_f32 v69, v62, v63
    v_cvt_pk_bf16_f32 v70, v64, v65
    v_cvt_pk_bf16_f32 v71, v66, v67
    ds_write_b128 v39, v[68:71]
L_e1_c:
    s_add_u32 s36, s36, 10
L_gt_7:
    s_cmp_ge_u32 s36, s42
    s_cbranch_scc1 L_gd_8
    s_sub_u32 s33, s42, 1
    s_add_u32 s32, s36, 0
    v_add_u32 v48, s32, v74
    v_min_u32 v48, s33, v48
    v_lshlrev_b32 v48, 5, v48
    v_sub_u32 v48, s43, v48
    ds_read_b128 v[20:23], v48
    ds_read_b128 v[24:27], v48 offset:16
    s_add_u32 s32, s36, 5
    v_add_u32 v49, s32, v74
    v_min_u32 v49, s33, v49
    v_lshlrev_b32 v49, 5, v49
    v_sub_u32 v49, s43, v49
    ds_read_b128 v[36:39], v49
    ds_read_b128 v[40:43], v49 offset:16
    s_waitcnt lgkmcnt(0)
    v_cmp_gt_i32 vcc, 0, v23
    v_add_u32 v20, v20, v75
    v_add_u32 v21, v21, v75
    buffer_load_dwordx4 v[76:79], v20, s[8:11], 0 offen
    buffer_load_dwordx4 v[80:83], v21, s[8:11], 0 offen
    s_cmp_lg_u64 vcc, 0
    s_cselect_b32 s52, 1, 0
    s_cbranch_scc0 L_g2_10
    v_add_u32 v24, v24, v75
    v_add_u32 v25, v25, v75
    buffer_load_dwordx4 v[84:87], v24, s[8:11], 0 offen
    buffer_load_dwordx4 v[88:91], v25, s[8:11], 0 offen
L_g2_10:
    s_mov_b32 s53, 0
    s_add_u32 s32, s36, 5
    s_cmp_ge_u32 s32, s42
    s_cbranch_scc1 L_g_9_b
    v_cmp_gt_i32 vcc, 0, v39
    v_add_u32 v36, v36, v75
    v_add_u32 v37, v37, v75
    buffer_load_dwordx4 v[92:95], v36, s[8:11], 0 offen
    buffer_load_dwordx4 v[96:99], v37, s[8:11], 0 offen
    s_cmp_lg_u64 vcc, 0
    s_cselect_b32 s53, 1, 0
    s_cbranch_scc0 L_g2_11
    v_add_u32 v40, v40, v75
    v_add_u32 v41, v41, v75
    buffer_load_dwordx4 v[100:103], v40, s[8:11], 0 offen
    buffer_load_dwordx4 v[104:107], v41, s[8:11], 0 offen
L_g2_11:
L_g_9_b:
    s_waitcnt vmcnt(0)
    v_and_b32 v50, 0xffff, v22
    v_lshlrev_b32 v51, 16, v22
    v_lshrrev_b32 v52, 16, v22
    v_and_b32 v53, 0xffff0000, v22
    v_dot2_f32_bf16 v60, v76, v50, 0
    v_dot2_f32_bf16 v61, v76, v51, 0
    v_dot2_f32_bf16 v62, v77, v50, 0
    v_dot2_f32_bf16 v63, v77, v51, 0
    v_dot2_f32_bf16 v64, v78, v50, 0
    v_dot2_f32_bf16 v65, v78, v51, 0
    v_dot2_f32_bf16 v66, v79, v50, 0
    v_dot2_f32_bf16 v67, v79, v51, 0
    v_dot2c_f32_bf16 v60, v80, v52
    v_dot2c_f32_bf16 v61, v80, v53
    v_dot2c_f32_bf16 v62, v81, v52
    v_dot2c_f32_bf16 v63, v81, v53
    v_dot2c_f32_bf16 v64, v82, v52
    v_dot2c_f32_bf16 v65, v82, v53
    v_dot2c_f32_bf16 v66, v83, v52
    v_dot2c_f32_bf16 v67, v83, v53
    s_cmp_eq_u32 s52, 0
    s_cbranch_scc1 L_g4_12
    v_and_b32 v50, 0xffff, v26
    v_lshlrev_b32 v51, 16, v26
    v_lshrrev_b32 v52, 16, v26
    v_and_b32 v53, 0xffff0000, v26
    v_dot2_f32_bf16 v60, v84, v50, v60
    v_dot2_f32_bf16 v61, v84, v51, v61
    v_dot2_f32_bf16 v62, v85, v50, v62
    v_dot2_f32_bf16 v63, v85, v51, v63
    v_dot2_f32_bf16 v64, v86, v50, v64
    v_dot2_f32_bf16 v65, v86, v51, v65
    v_dot2_f32_bf16 v66, v87, v50, v66
    v_dot2_f32_bf16 v67, v87, v51, v67
    v_dot2c_f32_bf16 v60, v88, v52
    v_dot2c_f32_bf16 v61, v88, v53
    v_dot2c_f32_bf16 v62, v89, v52
    v_dot2c_f32_bf16 v63, v89, v53
    v_dot2c_f32_bf16 v64, v90, v52
    v_dot2c_f32_bf16 v65, v90, v53
    v_dot2c_f32_bf16 v66, v91, v52
    v_dot2c_f32_bf16 v67, v91, v53
L_g4_12:
    v_and_b32 v23, 0x7fffffff, v23
    v_add_u32 v23, v23, v75
    s_nop 0
    v_cvt_pk_bf16_f32 v68, v60, v61
    v_cvt_pk_bf16_f32 v69, v62, v63
    v_cvt_pk_bf16_f32 v70, v64, v65
    v_cvt_pk_bf16_f32 v71, v66, v67
    ds_write_b128 v23, v[68:71]
    s_add_u32 s32, s36, 5
    s_cmp_ge_u32 s32, s42
    s_cbranch_scc1 L_g_9_c
    v_and_b32 v50, 0xffff, v38
    v_lshlrev_b32 v51, 16, v38
    v_lshrrev_b32 v52, 16, v38
    v_and_b32 v53, 0xffff0000, v38
    v_dot2_f32_bf16 v60, v92, v50, 0
    v_dot2_f32_bf16 v61, v92, v51, 0
    v_dot2_f32_bf16 v62, v93, v50, 0
    v_dot2_f32_bf16 v63, v93, v51, 0
    v_dot2_f32_bf16 v64, v94, v50, 0
    v_dot2_f32_bf16 v65, v94, v51, 0
    v_dot2_f32_bf16 v66, v95, v50, 0
    v_dot2_f32_bf16 v67, v95, v51, 0
    v_dot2c_f32_bf16 v60, v96, v52
    v_dot2c_f32_bf16 v61, v96, v53
    v_dot2c_f32_bf16 v62, v97, v52
    v_dot2c_f32_bf16 v63, v97, v53
    v_dot2c_f32_bf16 v64, v98, v52
    v_dot2c_f32_bf16 v65, v98, v53
    v_dot2c_f32_bf16 v66, v99, v52
    v_dot2c_f32_bf16 v67, v99, v53
    s_cmp_eq_u32 s53, 0
    s_cbranch_scc1 L_g4_13
    v_and_b32 v50, 0xffff, v42
    v_lshlrev_b32 v51, 16, v42
    v_lshrrev_b32 v52, 16, v42
    v_and_b32 v53, 0xffff0000, v42
    v_dot2_f32_bf16 v60, v100, v50, v60
    v_dot2_f32_bf16 v61, v100, v51, v61
    v_dot2_f32_bf16 v62, v101, v50, v62
    v_dot2_f32_bf16 v63, v101, v51, v63
    v_dot2_f32_bf16 v64, v102, v50, v64
    v_dot2_f32_bf16 v65, v102, v51, v65
    v_dot2_f32_bf16 v66, v103, v50, v66
    v_dot2_f32_bf16 v67, v103, v51, v67
    v_dot2c_f32_bf16 v60, v104, v52
    v_dot2c_f32_bf16 v61, v104, v53
    v_dot2c_f32_bf16 v62, v105, v52
    v_dot2c_f32_bf16 v63, v105, v53
    v_dot2c_f32_bf16 v64, v106, v52
    v_dot2c_f32_bf16 v65, v106, v53
    v_dot2c_f32_bf16 v66, v107, v52
    v_dot2c_f32_bf16 v67, v107, v53
L_g4_13:
    v_and_b32 v39, 0x7fffffff, v39
    v_add_u32 v39, v39, v75
    s_nop 0
    v_cvt_pk_bf16_f32 v68, v60, v61
    v_cvt_pk_bf16_f32 v69, v62, v63
    v_cvt_pk_bf16_f32 v70, v64, v65
    v_cvt_pk_bf16_f32 v71, v66, v67
    ds_write_b128 v39, v[68:71]
L_g_9_c:
    s_add_u32 s36, s36, 10
    s_branch L_gt_7
L_gd_8:
L_noearly_b:
    s_cmp_eq_u32 s3, 3
    s_cbranch_scc1 L_b1b
    s_waitcnt vmcnt(6)
L_b1b:
    s_waitcnt lgkmcnt(0)
    s_barrier
    ds_read_b64_tr_b16 a[0:1], v15 offset:0
    ds_read_b64_tr_b16 a[2:3], v15 offset:768
    ds_read_b64_tr_b16 a[4:5], v16 offset:0
    ds_read_b64_tr_b16 a[6:7], v16 offset:768
    ds_read_b64_tr_b16 a[8:9], v17 offset:0
    ds_read_b64_tr_b16 a[10:11], v17 offset:768
    ds_read_b64_tr_b16 a[12:13], v15 offset:6144
    ds_read_b64_tr_b16 a[14:15], v15 offset:6912
    ds_read_b64_tr_b16 a[16:17], v16 offset:6144
    ds_read_b64_tr_b16 a[18:19], v16 offset:6912
    ds_read_b64_tr_b16 a[20:21], v17 offset:6144
    ds_read_b64_tr_b16 a[22:23], v17 offset:6912
    ds_read_b64_tr_b16 a[24:25], v15 offset:12288
    ds_read_b64_tr_b16 a[26:27], v15 offset:13056
    ds_read_b64_tr_b16 a[28:29], v16 offset:12288
    ds_read_b64_tr_b16 a[30:31], v16 offset:13056
    ds_read_b64_tr_b16 a[32:33], v17 offset:12288
    ds_read_b64_tr_b16 a[34:35], v17 offset:13056
    ds_read_b128 v[112:115], v128 offset:0
    ds_read_b128 v[116:119], v137 offset:0
    s_cmp_eq_u32 s3, 3
    s_cbranch_scc1 L_p1x
    s_add_u32 m0, s27, 0
    s_add_u32 s32, s4, 55296
    s_waitcnt lgkmcnt(1)
    s_barrier
    v_mfma_f32_16x16x32_bf16 v[76:79], a[0:3], v[112:115], 0
    ds_read_b128 v[120:123], v146 offset:0
    ds_read_b64_tr_b16 a[36:37], v15 offset:18432
    v_mfma_f32_16x16x32_bf16 v[80:83], a[4:7], v[112:115], 0
    ds_read_b64_tr_b16 a[38:39], v15 offset:19200
    v_lshlrev_b32 v22, 2, v1
    v_mfma_f32_16x16x32_bf16 v[84:87], a[8:11], v[112:115], 0
    ds_read_b64_tr_b16 a[40:41], v16 offset:18432
    s_waitcnt lgkmcnt(4)
    v_mfma_f32_16x16x32_bf16 v[88:91], a[0:3], v[116:119], 0
    ds_read_b128 v[124:127], v128 offset:64
    ds_read_b64_tr_b16 a[42:43], v16 offset:19200
    v_mfma_f32_16x16x32_bf16 v[92:95], a[4:7], v[116:119], 0
    ds_read_b64_tr_b16 a[44:45], v17 offset:18432
    buffer_load_dwordx4 v11, s[16:19], s32 offen offset:0 lds
    v_mfma_f32_16x16x32_bf16 v[96:99], a[8:11], v[116:119], 0
    ds_read_b64_tr_b16 a[46:47], v17 offset:19200
    s_waitcnt lgkmcnt(7)
    v_mfma_f32_16x16x32_bf16 v[100:103], a[0:3], v[120:123], 0
    ds_read_b128 v[112:115], v137 offset:64
    v_add_u32 v22, s3, v22
    v_mfma_f32_16x16x32_bf16 v[104:107], a[4:7], v[120:123], 0
    ds_read_b64_tr_b16 a[48:49], v15 offset:24576
    buffer_load_dwordx4 v12, s[16:19], s32 offen offset:1024 lds
    v_mfma_f32_16x16x32_bf16 v[108:111], a[8:11], v[120:123], 0
    ds_read_b64_tr_b16 a[50:51], v15 offset:25344
    s_waitcnt lgkmcnt(6)
    v_mfma_f32_16x16x32_bf16 v[76:79], a[12:15], v[124:127], v[76:79]
    ds_read_b128 v[116:119], v146 offset:64
    v_lshlrev_b32 v43, 3, v22
    v_mfma_f32_16x16x32_bf16 v[80:83], a[16:19], v[124:127], v[80:83]
    ds_read_b64_tr_b16 a[52:53], v16 offset:24576
    buffer_load_dwordx4 v13, s[16:19], s32 offen offset:2048 lds
    v_mfma_f32_16x16x32_bf16 v[84:87], a[20:23], v[124:127], v[84:87]
    ds_read_b64_tr_b16 a[54:55], v16 offset:25344
    s_waitcnt lgkmcnt(5)
    v_mfma_f32_16x16x32_bf16 v[88:91], a[12:15], v[112:115], v[88:91]
    ds_read_b128 v[120:123], v128 offset:128
    v_add_u32 v43, 129024, v43
    v_mfma_f32_16x16x32_bf16 v[92:95], a[16:19], v[112:115], v[92:95]
    ds_read_b64_tr_b16 a[56:57], v17 offset:24576
    s_add_u32 m0, s27, 3072
    s_add_u32 s32, s4, 58368
    v_mfma_f32_16x16x32_bf16 v[96:99], a[20:23], v[112:115], v[96:99]
    ds_read_b64_tr_b16 a[58:59], v17 offset:25344
    s_waitcnt lgkmcnt(5)
    v_mfma_f32_16x16x32_bf16 v[100:103], a[12:15], v[116:119], v[100:103]
    ds_read_b128 v[124:127], v137 offset:128
    ds_read_b64 v[172:173], v43
    v_mfma_f32_16x16x32_bf16 v[104:107], a[16:19], v[116:119], v[104:107]
    ds_read_b64_tr_b16 a[60:61], v15 offset:30720
    buffer_load_dwordx4 v11, s[16:19], s32 offen offset:0 lds
    v_mfma_f32_16x16x32_bf16 v[108:111], a[20:23], v[116:119], v[108:111]
    ds_read_b64_tr_b16 a[62:63], v15 offset:31488
    s_waitcnt lgkmcnt(6)
    v_mfma_f32_16x16x32_bf16 v[76:79], a[24:27], v[120:123], v[76:79]
    ds_read_b128 v[112:115], v146 offset:128
    v_mul_u32_u24 v40, 192, v22
    v_mfma_f32_16x16x32_bf16 v[80:83], a[28:31], v[120:123], v[80:83]
    ds_read_b64_tr_b16 a[64:65], v16 offset:30720
    buffer_load_dwordx4 v12, s[16:19], s32 offen offset:1024 lds
    v_mfma_f32_16x16x32_bf16 v[84:87], a[32:35], v[120:123], v[84:87]
    ds_read_b64_tr_b16 a[66:67], v16 offset:31488
    s_waitcnt lgkmcnt(6)
    v_mfma_f32_16x16x32_bf16 v[88:91], a[24:27], v[124:127], v[88:91]
    ds_read_b128 v[116:119], v129 offset:0
    v_add_u32 v40, 62208, v40
    v_mfma_f32_16x16x32_bf16 v[92:95], a[28:31], v[124:127], v[92:95]
    ds_read_b64_tr_b16 a[68:69], v17 offset:30720
    buffer_load_dwordx4 v13, s[16:19], s32 offen offset:2048 lds
    v_mfma_f32_16x16x32_bf16 v[96:99], a[32:35], v[124:127], v[96:99]
    ds_read_b64_tr_b16 a[70:71], v17 offset:31488
    s_waitcnt lgkmcnt(5)
    v_mfma_f32_16x16x32_bf16 v[100:103], a[24:27], v[112:115], v[100:103]
    ds_read_b128 v[120:123], v138 offset:0
    v_cmp_gt_u32 s[52:53], s38, v22
    v_mfma_f32_16x16x32_bf16 v[104:107], a[28:31], v[112:115], v[104:107]
    s_add_u32 m0, s27, 18432
    s_add_u32 s32, s4, 73728
    v_mfma_f32_16x16x32_bf16 v[108:111], a[32:35], v[112:115], v[108:111]
    s_mul_i32 s6, s3, 2304
    s_add_u32 s6, s6, 134400
    s_add_u32 s7, s6, 2272
    v_mov_b32 v46, 99
    s_waitcnt vmcnt(6) lgkmcnt(1)
    s_barrier
    v_mfma_f32_16x16x32_bf16 v[76:79], a[36:39], v[116:119], v[76:79]
    ds_read_b128 v[124:127], v147 offset:0
    ds_read_b64_tr_b16 a[72:73], v15 offset:36864
    v_mfma_f32_16x16x32_bf16 v[80:83], a[40:43], v[116:119], v[80:83]
    ds_read_b64_tr_b16 a[74:75], v15 offset:37632
    v_mov_b32 v163, 0
    v_mfma_f32_16x16x32_bf16 v[84:87], a[44:47], v[116:119], v[84:87]
    ds_read_b64_tr_b16 a[76:77], v16 offset:36864
    s_waitcnt lgkmcnt(4)
    v_mfma_f32_16x16x32_bf16 v[88:91], a[36:39], v[120:123], v[88:91]
    ds_read_b128 v[112:115], v129 offset:64
    ds_read_b64_tr_b16 a[78:79], v16 offset:37632
    v_mfma_f32_16x16x32_bf16 v[92:95], a[40:43], v[120:123], v[92:95]
    ds_read_b64_tr_b16 a[80:81], v17 offset:36864
    buffer_load_dwordx4 v11, s[16:19], s32 offen offset:0 lds
    v_mfma_f32_16x16x32_bf16 v[96:99], a[44:47], v[120:123], v[96:99]
    ds_read_b64_tr_b16 a[82:83], v17 offset:37632
    s_waitcnt lgkmcnt(7)
    v_mfma_f32_16x16x32_bf16 v[100:103], a[36:39], v[124:127], v[100:103]
    ds_read_b128 v[116:119], v138 offset:64
    v_mov_b32 v47, 162048
    v_mfma_f32_16x16x32_bf16 v[104:107], a[40:43], v[124:127], v[104:107]
    ds_read_b64_tr_b16 a[84:85], v15 offset:43008
    buffer_load_dwordx4 v12, s[16:19], s32 offen offset:1024 lds
    v_mfma_f32_16x16x32_bf16 v[108:111], a[44:47], v[124:127], v[108:111]
    ds_read_b64_tr_b16 a[86:87], v15 offset:43776
    s_waitcnt lgkmcnt(6)
    v_mfma_f32_16x16x32_bf16 v[76:79], a[48:51], v[112:115], v[76:79]
    ds_read_b128 v[120:123], v147 offset:64
    v_lshlrev_b32 v23, 16, v172
    v_mfma_f32_16x16x32_bf16 v[80:83], a[52:55], v[112:115], v[80:83]
    ds_read_b64_tr_b16 a[88:89], v16 offset:43008
    buffer_load_dwordx4 v13, s[16:19], s32 offen offset:2048 lds
    v_mfma_f32_16x16x32_bf16 v[84:87], a[56:59], v[112:115], v[84:87]
    ds_read_b64_tr_b16 a[90:91], v16 offset:43776
    s_waitcnt lgkmcnt(5)
    v_mfma_f32_16x16x32_bf16 v[88:91], a[48:51], v[116:119], v[88:91]
    ds_read_b128 v[124:127], v129 offset:128
    v_and_b32 v24, 0xffff0000, v172
    v_mfma_f32_16x16x32_bf16 v[92:95], a[52:55], v[116:119], v[92:95]
    ds_read_b64_tr_b16 a[92:93], v17 offset:43008
    s_add_u32 m0, s27, 21504
    s_add_u32 s32, s4, 76800
    v_mfma_f32_16x16x32_bf16 v[96:99], a[56:59], v[116:119], v[96:99]
    ds_read_b64_tr_b16 a[94:95], v17 offset:43776
    s_waitcnt lgkmcnt(5)
    v_mfma_f32_16x16x32_bf16 v[100:103], a[48:51], v[120:123], v[100:103]
    ds_read_b128 v[112:115], v138 offset:128
    v_floor_f32 v25, v23
    v_mfma_f32_16x16x32_bf16 v[104:107], a[52:55], v[120:123], v[104:107]
    ds_read_b64_tr_b16 a[96:97], v15 offset:49152
    buffer_load_dwordx4 v11, s[16:19], s32 offen offset:0 lds
    v_mfma_f32_16x16x32_bf16 v[108:111], a[56:59], v[120:123], v[108:111]
    ds_read_b64_tr_b16 a[98:99], v15 offset:49920
    s_waitcnt lgkmcnt(5)
    v_mfma_f32_16x16x32_bf16 v[76:79], a[60:63], v[124:127], v[76:79]
    ds_read_b128 v[116:119], v147 offset:128
    v_floor_f32 v26, v24
    v_mfma_f32_16x16x32_bf16 v[80:83], a[64:67], v[124:127], v[80:83]
    ds_read_b64_tr_b16 a[100:101], v16 offset:49152
    buffer_load_dwordx4 v12, s[16:19], s32 offen offset:1024 lds
    v_mfma_f32_16x16x32_bf16 v[84:87], a[68:71], v[124:127], v[84:87]
    ds_read_b64_tr_b16 a[102:103], v16 offset:49920
    s_waitcnt lgkmcnt(5)
    v_mfma_f32_16x16x32_bf16 v[88:91], a[60:63], v[112:115], v[88:91]
    ds_read_b128 v[120:123], v130 offset:0
    v_sub_f32 v27, v23, v25
    v_mfma_f32_16x16x32_bf16 v[92:95], a[64:67], v[112:115], v[92:95]
    ds_read_b64_tr_b16 a[104:105], v17 offset:49152
    buffer_load_dwordx4 v13, s[16:19], s32 offen offset:2048 lds
    v_mfma_f32_16x16x32_bf16 v[96:99], a[68:71], v[112:115], v[96:99]
    ds_read_b64_tr_b16 a[106:107], v17 offset:49920
    s_waitcnt lgkmcnt(5)
    v_mfma_f32_16x16x32_bf16 v[100:103], a[60:63], v[116:119], v[100:103]
    ds_read_b128 v[124:127], v139 offset:0
    v_sub_f32 v28, v24, v26
    v_mfma_f32_16x16x32_bf16 v[104:107], a[64:67], v[116:119], v[104:107]
    s_add_u32 m0, s27, 36864
    s_add_u32 s32, s4, 92160
    v_mfma_f32_16x16x32_bf16 v[108:111], a[68:71], v[116:119], v[108:111]
    v_cvt_u32_f32 v25, v25
    s_waitcnt vmcnt(6) lgkmcnt(1)
    s_barrier
    v_mfma_f32_16x16x32_bf16 v[76:79], a[72:75], v[120:123], v[76:79]
    ds_read_b128 v[112:115], v148 offset:0
    ds_read_b64_tr_b16 a[108:109], v15 offset:0
    v_mfma_f32_16x16x32_bf16 v[80:83], a[76:79], v[120:123], v[80:83]
    ds_read_b64_tr_b16 a[110:111], v15 offset:768
    v_cvt_u32_f32 v26, v26
    v_mfma_f32_16x16x32_bf16 v[84:87], a[80:83], v[120:123], v[84:87]
    ds_read_b64_tr_b16 a[112:113], v16 offset:0
    s_waitcnt lgkmcnt(4)
    v_mfma_f32_16x16x32_bf16 v[88:91], a[72:75], v[124:127], v[88:91]
    ds_read_b128 v[116:119], v130 offset:64
    ds_read_b64_tr_b16 a[114:115], v16 offset:768
    v_mfma_f32_16x16x32_bf16 v[92:95], a[76:79], v[124:127], v[92:95]
    ds_read_b64_tr_b16 a[116:117], v17 offset:0
    buffer_load_dwordx4 v11, s[16:19], s32 offen offset:0 lds
    v_mfma_f32_16x16x32_bf16 v[96:99], a[80:83], v[124:127], v[96:99]
    ds_read_b64_tr_b16 a[118:119], v17 offset:768
    s_waitcnt lgkmcnt(7)
    v_mfma_f32_16x16x32_bf16 v[100:103], a[72:75], v[112:115], v[100:103]
    ds_read_b128 v[120:123], v139 offset:64
    v_cmp_eq_f32 s[44:45], 0, v28
    v_mfma_f32_16x16x32_bf16 v[104:107], a[76:79], v[112:115], v[104:107]
    ds_read_b64_tr_b16 a[120:121], v15 offset:6144
    buffer_load_dwordx4 v12, s[16:19], s32 offen offset:1024 lds
    v_mfma_f32_16x16x32_bf16 v[108:111], a[80:83], v[112:115], v[108:111]
    ds_read_b64_tr_b16 a[122:123], v15 offset:6912
    s_waitcnt lgkmcnt(6)
    v_mfma_f32_16x16x32_bf16 v[76:79], a[84:87], v[116:119], v[76:79]
    ds_read_b128 v[124:127], v148 offset:64
    v_cmp_neq_f32 s[46:47], 0, v27
    v_mfma_f32_16x16x32_bf16 v[80:83], a[88:91], v[116:119], v[80:83]
    ds_read_b64_tr_b16 a[124:125], v16 offset:6144
    buffer_load_dwordx4 v13, s[16:19], s32 offen offset:2048 lds
    v_mfma_f32_16x16x32_bf16 v[84:87], a[92:95], v[116:119], v[84:87]
    ds_read_b64_tr_b16 a[126:127], v16 offset:6912
    s_waitcnt lgkmcnt(5)
    v_mfma_f32_16x16x32_bf16 v[88:91], a[84:87], v[120:123], v[88:91]
    ds_read_b128 v[112:115], v130 offset:128
    v_sub_f32 v23, 1.0, v27
    v_mfma_f32_16x16x32_bf16 v[92:95], a[88:91], v[120:123], v[92:95]
    ds_read_b64_tr_b16 a[128:129], v17 offset:6144
    s_add_u32 m0, s27, 39936
    s_add_u32 s32, s4, 95232
    v_mfma_f32_16x16x32_bf16 v[96:99], a[92:95], v[120:123], v[96:99]
    ds_read_b64_tr_b16 a[130:131], v17 offset:6912
    s_waitcnt lgkmcnt(5)
    v_mfma_f32_16x16x32_bf16 v[100:103], a[84:87], v[124:127], v[100:103]
    ds_read_b128 v[116:119], v139 offset:128
    v_sub_f32 v24, 1.0, v28
    v_mfma_f32_16x16x32_bf16 v[104:107], a[88:91], v[124:127], v[104:107]
    ds_read_b64_tr_b16 a[132:133], v15 offset:12288
    buffer_load_dwordx4 v11, s[16:19], s32 offen offset:0 lds
    v_mfma_f32_16x16x32_bf16 v[108:111], a[92:95], v[124:127], v[108:111]
    ds_read_b64_tr_b16 a[134:135], v15 offset:13056
    s_waitcnt lgkmcnt(5)
    v_mfma_f32_16x16x32_bf16 v[76:79], a[96:99], v[112:115], v[76:79]
    ds_read_b128 v[120:123], v148 offset:128
    v_cvt_pk_bf16_f32 v43, v23, v24
    v_mfma_f32_16x16x32_bf16 v[80:83], a[100:103], v[112:115], v[80:83]
    ds_read_b64_tr_b16 a[136:137], v16 offset:12288
    buffer_load_dwordx4 v12, s[16:19], s32 offen offset:1024 lds
    v_mfma_f32_16x16x32_bf16 v[84:87], a[104:107], v[112:115], v[84:87]
    ds_read_b64_tr_b16 a[138:139], v16 offset:13056
    s_waitcnt lgkmcnt(5)
    v_mfma_f32_16x16x32_bf16 v[88:91], a[96:99], v[116:119], v[88:91]
    ds_read_b128 v[124:127], v131 offset:0
    v_sub_u32 v31, 223, v26
    v_mfma_f32_16x16x32_bf16 v[92:95], a[100:103], v[116:119], v[92:95]
    ds_read_b64_tr_b16 a[140:141], v17 offset:12288
    buffer_load_dwordx4 v13, s[16:19], s32 offen offset:2048 lds
    v_mfma_f32_16x16x32_bf16 v[96:99], a[104:107], v[116:119], v[96:99]
    ds_read_b64_tr_b16 a[142:143], v17 offset:13056
    s_waitcnt lgkmcnt(5)
    v_mfma_f32_16x16x32_bf16 v[100:103], a[96:99], v[120:123], v[100:103]
    ds_read_b128 v[112:115], v140 offset:0
    v_sub_u32 v32, 223, v25
    v_mfma_f32_16x16x32_bf16 v[104:107], a[100:103], v[120:123], v[104:107]
    s_add_u32 m0, s27, 0
    s_add_u32 s32, s4, 110592
    v_mfma_f32_16x16x32_bf16 v[108:111], a[104:107], v[120:123], v[108:111]
    v_lshlrev_b32 v23, 16, v43
    s_waitcnt vmcnt(6) lgkmcnt(1)
    s_barrier
    v_mfma_f32_16x16x32_bf16 v[76:79], a[108:111], v[124:127], v[76:79]
    ds_read_b128 v[116:119], v149 offset:0
    ds_read_b64_tr_b16 a[144:145], v15 offset:18432
    v_mfma_f32_16x16x32_bf16 v[80:83], a[112:115], v[124:127], v[80:83]
    ds_read_b64_tr_b16 a[146:147], v15 offset:19200
    v_and_b32 v24, 0xffff0000, v43
    v_mfma_f32_16x16x32_bf16 v[84:87], a[116:119], v[124:127], v[84:87]
    ds_read_b64_tr_b16 a[148:149], v16 offset:18432
    s_waitcnt lgkmcnt(4)
    v_mfma_f32_16x16x32_bf16 v[88:91], a[108:111], v[112:115], v[88:91]
    ds_read_b128 v[120:123], v131 offset:64
    ds_read_b64_tr_b16 a[150:151], v16 offset:19200
    v_mfma_f32_16x16x32_bf16 v[92:95], a[112:115], v[112:115], v[92:95]
    ds_read_b64_tr_b16 a[152:153], v17 offset:18432
    buffer_load_dwordx4 v11, s[16:19], s32 offen offset:0 lds
    v_mfma_f32_16x16x32_bf16 v[96:99], a[116:119], v[112:115], v[96:99]
    ds_read_b64_tr_b16 a[154:155], v17 offset:19200
    s_waitcnt lgkmcnt(7)
    v_mfma_f32_16x16x32_bf16 v[100:103], a[108:111], v[116:119], v[100:103]
    ds_read_b128 v[124:127], v140 offset:64
    v_min_u32 v31, 1, v31
    v_mfma_f32_16x16x32_bf16 v[104:107], a[112:115], v[116:119], v[104:107]
    ds_read_b64_tr_b16 a[156:157], v15 offset:24576
    buffer_load_dwordx4 v12, s[16:19], s32 offen offset:1024 lds
    v_mfma_f32_16x16x32_bf16 v[108:111], a[116:119], v[116:119], v[108:111]
    ds_read_b64_tr_b16 a[158:159], v15 offset:25344
    s_waitcnt lgkmcnt(6)
    v_mfma_f32_16x16x32_bf16 v[76:79], a[120:123], v[120:123], v[76:79]
    ds_read_b128 v[112:115], v149 offset:64
    v_min_u32 v32, 1, v32
    v_mfma_f32_16x16x32_bf16 v[80:83], a[124:127], v[120:123], v[80:83]
    ds_read_b64_tr_b16 a[160:161], v16 offset:24576
    buffer_load_dwordx4 v13, s[16:19], s32 offen offset:2048 lds
    v_mfma_f32_16x16x32_bf16 v[84:87], a[128:131], v[120:123], v[84:87]
    ds_read_b64_tr_b16 a[162:163], v16 offset:25344
    s_waitcnt lgkmcnt(5)
    v_mfma_f32_16x16x32_bf16 v[88:91], a[120:123], v[124:127], v[88:91]
    ds_read_b128 v[116:119], v131 offset:128
    v_mul_f32 v33, v23, v24
    v_mfma_f32_16x16x32_bf16 v[92:95], a[124:127], v[124:127], v[92:95]
    ds_read_b64_tr_b16 a[164:165], v17 offset:24576
    s_add_u32 m0, s27, 3072
    s_add_u32 s32, s4, 113664
    v_mfma_f32_16x16x32_bf16 v[96:99], a[128:131], v[124:127], v[96:99]
    ds_read_b64_tr_b16 a[166:167], v17 offset:25344
    s_waitcnt lgkmcnt(5)
    v_mfma_f32_16x16x32_bf16 v[100:103], a[120:123], v[112:115], v[100:103]
    ds_read_b128 v[120:123], v140 offset:128
    v_mul_f32 v34, v23, v28
    v_mfma_f32_16x16x32_bf16 v[104:107], a[124:127], v[112:115], v[104:107]
    ds_read_b64_tr_b16 a[168:169], v15 offset:30720
    buffer_load_dwordx4 v11, s[16:19], s32 offen offset:0 lds
    v_mfma_f32_16x16x32_bf16 v[108:111], a[128:131], v[112:115], v[108:111]
    ds_read_b64_tr_b16 a[170:171], v15 offset:31488
    s_waitcnt lgkmcnt(5)
    v_mfma_f32_16x16x32_bf16 v[76:79], a[132:135], v[116:119], v[76:79]
    ds_read_b128 v[124:127], v149 offset:128
    v_mul_f32 v35, v27, v24
    v_mfma_f32_16x16x32_bf16 v[80:83], a[136:139], v[116:119], v[80:83]
    ds_read_b64_tr_b16 a[172:173], v16 offset:30720
    buffer_load_dwordx4 v12, s[16:19], s32 offen offset:1024 lds
    v_mfma_f32_16x16x32_bf16 v[84:87], a[140:143], v[116:119], v[84:87]
    ds_read_b64_tr_b16 a[174:175], v16 offset:31488
    s_waitcnt lgkmcnt(5)
    v_mfma_f32_16x16x32_bf16 v[88:91], a[132:135], v[120:123], v[88:91]
    ds_read_b128 v[112:115], v132 offset:0
    v_mul_f32 v36, v27, v28
    v_mfma_f32_16x16x32_bf16 v[92:95], a[136:139], v[120:123], v[92:95]
    ds_read_b64_tr_b16 a[176:177], v17 offset:30720
    buffer_load_dwordx4 v13, s[16:19], s32 offen offset:2048 lds
    v_mfma_f32_16x16x32_bf16 v[96:99], a[140:143], v[120:123], v[96:99]
    ds_read_b64_tr_b16 a[178:179], v17 offset:31488
    s_waitcnt lgkmcnt(5)
    v_mfma_f32_16x16x32_bf16 v[100:103], a[132:135], v[124:127], v[100:103]
    ds_read_b128 v[116:119], v141 offset:0
    v_cndmask_b32 v41, 0, 1, s[46:47]
    v_mfma_f32_16x16x32_bf16 v[104:107], a[136:139], v[124:127], v[104:107]
    s_add_u32 m0, s27, 18432
    s_add_u32 s32, s4, 129024
    v_mfma_f32_16x16x32_bf16 v[108:111], a[140:143], v[124:127], v[108:111]
    v_cvt_pk_bf16_f32 v37, v33, v34
    s_waitcnt vmcnt(6) lgkmcnt(1)
    s_barrier
    v_mfma_f32_16x16x32_bf16 v[76:79], a[144:147], v[112:115], v[76:79]
    ds_read_b128 v[120:123], v150 offset:0
    ds_read_b64_tr_b16 a[180:181], v15 offset:36864
    v_mfma_f32_16x16x32_bf16 v[80:83], a[148:151], v[112:115], v[80:83]
    ds_read_b64_tr_b16 a[182:183], v15 offset:37632
    v_cvt_pk_bf16_f32 v38, v33, v35
    v_mfma_f32_16x16x32_bf16 v[84:87], a[152:155], v[112:115], v[84:87]
    ds_read_b64_tr_b16 a[184:185], v16 offset:36864
    s_waitcnt lgkmcnt(4)
    v_mfma_f32_16x16x32_bf16 v[88:91], a[144:147], v[116:119], v[88:91]
    ds_read_b128 v[124:127], v132 offset:64
    ds_read_b64_tr_b16 a[186:187], v16 offset:37632
    v_mfma_f32_16x16x32_bf16 v[92:95], a[148:151], v[116:119], v[92:95]
    ds_read_b64_tr_b16 a[188:189], v17 offset:36864
    buffer_load_dwordx4 v11, s[16:19], s32 offen offset:0 lds
    v_mfma_f32_16x16x32_bf16 v[96:99], a[152:155], v[116:119], v[96:99]
    ds_read_b64_tr_b16 a[190:191], v17 offset:37632
    s_waitcnt lgkmcnt(7)
    v_mfma_f32_16x16x32_bf16 v[100:103], a[144:147], v[120:123], v[100:103]
    ds_read_b128 v[112:115], v141 offset:64
    v_cvt_pk_bf16_f32 v39, v35, v36
    v_mfma_f32_16x16x32_bf16 v[104:107], a[148:151], v[120:123], v[104:107]
    ds_read_b64_tr_b16 a[192:193], v15 offset:43008
    buffer_load_dwordx4 v12, s[16:19], s32 offen offset:1024 lds
    v_mfma_f32_16x16x32_bf16 v[108:111], a[152:155], v[120:123], v[108:111]
    ds_read_b64_tr_b16 a[194:195], v15 offset:43776
    s_waitcnt lgkmcnt(6)
    v_mfma_f32_16x16x32_bf16 v[76:79], a[156:159], v[124:127], v[76:79]
    ds_read_b128 v[116:119], v150 offset:64
    v_cndmask_b32 v41, v41, 0, s[44:45]
    v_mfma_f32_16x16x32_bf16 v[80:83], a[160:163], v[124:127], v[80:83]
    ds_read_b64_tr_b16 a[196:197], v16 offset:43008
    buffer_load_dwordx4 v13, s[16:19], s32 offen offset:2048 lds
    v_mfma_f32_16x16x32_bf16 v[84:87], a[164:167], v[124:127], v[84:87]
    ds_read_b64_tr_b16 a[198:199], v16 offset:43776
    s_waitcnt lgkmcnt(5)
    v_mfma_f32_16x16x32_bf16 v[88:91], a[156:159], v[112:115], v[88:91]
    ds_read_b128 v[120:123], v132 offset:128
    v_cndmask_b32 v42, v37, v38, s[44:45]
    v_mfma_f32_16x16x32_bf16 v[92:95], a[160:163], v[112:115], v[92:95]
    ds_read_b64_tr_b16 a[200:201], v17 offset:43008
    s_add_u32 m0, s27, 21504
    s_add_u32 s32, s4, 132096
    v_mfma_f32_16x16x32_bf16 v[96:99], a[164:167], v[112:115], v[96:99]
    ds_read_b64_tr_b16 a[202:203], v17 offset:43776
    s_waitcnt lgkmcnt(5)
    v_mfma_f32_16x16x32_bf16 v[100:103], a[156:159], v[116:119], v[100:103]
    ds_read_b128 v[124:127], v141 offset:128
    v_mul_u32_u24 v30, 43008, v25
    v_mfma_f32_16x16x32_bf16 v[104:107], a[160:163], v[116:119], v[104:107]
    ds_read_b64_tr_b16 a[204:205], v15 offset:49152
    buffer_load_dwordx4 v11, s[16:19], s32 offen offset:0 lds
    v_mfma_f32_16x16x32_bf16 v[108:111], a[164:167], v[116:119], v[108:111]
    ds_read_b64_tr_b16 a[206:207], v15 offset:49920
    s_waitcnt lgkmcnt(5)
    v_mfma_f32_16x16x32_bf16 v[76:79], a[168:171], v[120:123], v[76:79]
    ds_read_b128 v[112:115], v150 offset:128
    v_mul_u32_u24 v48, 192, v31
    v_mfma_f32_16x16x32_bf16 v[80:83], a[172:175], v[120:123], v[80:83]
    ds_read_b64_tr_b16 a[208:209], v16 offset:49152
    buffer_load_dwordx4 v12, s[16:19], s32 offen offset:1024 lds
    v_mfma_f32_16x16x32_bf16 v[84:87], a[176:179], v[120:123], v[84:87]
    ds_read_b64_tr_b16 a[210:211], v16 offset:49920
    s_waitcnt lgkmcnt(5)
    v_mfma_f32_16x16x32_bf16 v[88:91], a[168:171], v[124:127], v[88:91]
    ds_read_b128 v[116:119], v133 offset:0
    v_mul_u32_u24 v49, 43008, v32
    v_mfma_f32_16x16x32_bf16 v[92:95], a[172:175], v[124:127], v[92:95]
    ds_read_b64_tr_b16 a[212:213], v17 offset:49152
    buffer_load_dwordx4 v13, s[16:19], s32 offen offset:2048 lds
    v_mfma_f32_16x16x32_bf16 v[96:99], a[176:179], v[124:127], v[96:99]
    ds_read_b64_tr_b16 a[214:215], v17 offset:49920
    s_waitcnt lgkmcnt(5)
    v_mfma_f32_16x16x32_bf16 v[100:103], a[168:171], v[112:115], v[100:103]
    ds_read_b128 v[120:123], v142 offset:0
    v_mad_u32_u24 v156, v26, s5, v30
    v_mfma_f32_16x16x32_bf16 v[104:107], a[172:175], v[112:115], v[104:107]
    s_add_u32 m0, s27, 36864
    s_add_u32 s32, s4, 147456
    v_mfma_f32_16x16x32_bf16 v[108:111], a[176:179], v[112:115], v[108:111]
    v_cndmask_b32 v43, v48, v49, s[44:45]
    s_waitcnt vmcnt(6) lgkmcnt(1)
    s_barrier
    v_mfma_f32_16x16x32_bf16 v[76:79], a[180:183], v[116:119], v[76:79]
    ds_read_b128 v[124:127], v151 offset:0
    ds_read_b64_tr_b16 a[216:217], v15 offset:0
    v_mfma_f32_16x16x32_bf16 v[80:83], a[184:187], v[116:119], v[80:83]
    ds_read_b64_tr_b16 a[218:219], v15 offset:768
    v_add_u32 v160, v156, v49
    v_mfma_f32_16x16x32_bf16 v[84:87], a[188:191], v[116:119], v[84:87]
    ds_read_b64_tr_b16 a[220:221], v16 offset:0
    s_waitcnt lgkmcnt(4)
    v_mfma_f32_16x16x32_bf16 v[88:91], a[180:183], v[120:123], v[88:91]
    ds_read_b128 v[112:115], v133 offset:64
    ds_read_b64_tr_b16 a[222:223], v16 offset:768
    v_mfma_f32_16x16x32_bf16 v[92:95], a[184:187], v[120:123], v[92:95]
    ds_read_b64_tr_b16 a[224:225], v17 offset:0
    buffer_load_dwordx4 v11, s[16:19], s32 offen offset:0 lds
    v_mfma_f32_16x16x32_bf16 v[96:99], a[188:191], v[120:123], v[96:99]
    ds_read_b64_tr_b16 a[226:227], v17 offset:768
    s_waitcnt lgkmcnt(7)
    v_mfma_f32_16x16x32_bf16 v[100:103], a[180:183], v[124:127], v[100:103]
    ds_read_b128 v[116:119], v142 offset:64
    v_add_u32 v157, v156, v43
    v_mfma_f32_16x16x32_bf16 v[104:107], a[184:187], v[124:127], v[104:107]
    ds_read_b64_tr_b16 a[228:229], v15 offset:6144
    buffer_load_dwordx4 v12, s[16:19], s32 offen offset:1024 lds
    v_mfma_f32_16x16x32_bf16 v[108:111], a[188:191], v[124:127], v[108:111]
    ds_read_b64_tr_b16 a[230:231], v15 offset:6912
    s_waitcnt lgkmcnt(6)
    v_mfma_f32_16x16x32_bf16 v[76:79], a[192:195], v[112:115], v[76:79]
    ds_read_b128 v[120:123], v151 offset:64
    v_add_u32 v161, v160, v48
    v_mfma_f32_16x16x32_bf16 v[80:83], a[196:199], v[112:115], v[80:83]
    ds_read_b64_tr_b16 a[232:233], v16 offset:6144
    buffer_load_dwordx4 v13, s[16:19], s32 offen offset:2048 lds
    v_mfma_f32_16x16x32_bf16 v[84:87], a[200:203], v[112:115], v[84:87]
    ds_read_b64_tr_b16 a[234:235], v16 offset:6912
    s_waitcnt lgkmcnt(5)
    v_mfma_f32_16x16x32_bf16 v[88:91], a[192:195], v[116:119], v[88:91]
    ds_read_b128 v[124:127], v133 offset:128
    v_lshl_or_b32 v159, v41, 31, v40
    v_mfma_f32_16x16x32_bf16 v[92:95], a[196:199], v[116:119], v[92:95]
    ds_read_b64_tr_b16 a[236:237], v17 offset:6144
    s_add_u32 m0, s27, 39936
    s_add_u32 s32, s4, 150528
    v_mfma_f32_16x16x32_bf16 v[96:99], a[200:203], v[116:119], v[96:99]
    ds_read_b64_tr_b16 a[238:239], v17 offset:6912
    s_waitcnt lgkmcnt(5)
    v_mfma_f32_16x16x32_bf16 v[100:103], a[192:195], v[120:123], v[100:103]
    ds_read_b128 v[112:115], v142 offset:128
    v_mul_lo_u32 v162, v39, v41
    v_mfma_f32_16x16x32_bf16 v[104:107], a[196:199], v[120:123], v[104:107]
    ds_read_b64_tr_b16 a[240:241], v15 offset:12288
    buffer_load_dwordx4 v11, s[16:19], s32 offen offset:0 lds
    v_mfma_f32_16x16x32_bf16 v[108:111], a[200:203], v[120:123], v[108:111]
    ds_read_b64_tr_b16 a[242:243], v15 offset:13056
    s_waitcnt lgkmcnt(5)
    v_mfma_f32_16x16x32_bf16 v[76:79], a[204:207], v[124:127], v[76:79]
    ds_read_b128 v[116:119], v151 offset:128
    v_and_b32 v33, 0xff, v173
    v_mfma_f32_16x16x32_bf16 v[80:83], a[208:211], v[124:127], v[80:83]
    ds_read_b64_tr_b16 a[244:245], v16 offset:12288
    buffer_load_dwordx4 v12, s[16:19], s32 offen offset:1024 lds
    v_mfma_f32_16x16x32_bf16 v[84:87], a[212:215], v[124:127], v[84:87]
    ds_read_b64_tr_b16 a[246:247], v16 offset:13056
    s_waitcnt lgkmcnt(5)
    v_mfma_f32_16x16x32_bf16 v[88:91], a[204:207], v[112:115], v[88:91]
    ds_read_b128 v[120:123], v134 offset:0
    v_lshrrev_b32 v36, 18, v173
    v_mfma_f32_16x16x32_bf16 v[92:95], a[208:211], v[112:115], v[92:95]
    ds_read_b64_tr_b16 a[248:249], v17 offset:12288
    buffer_load_dwordx4 v13, s[16:19], s32 offen offset:2048 lds
    v_mfma_f32_16x16x32_bf16 v[96:99], a[212:215], v[112:115], v[96:99]
    ds_read_b64_tr_b16 a[250:251], v17 offset:13056
    s_waitcnt lgkmcnt(5)
    v_mfma_f32_16x16x32_bf16 v[100:103], a[204:207], v[116:119], v[100:103]
    ds_read_b128 v[124:127], v143 offset:0
    v_bfe_u32 v34, v173, 8, 5
    v_mfma_f32_16x16x32_bf16 v[104:107], a[208:211], v[116:119], v[104:107]
    v_mfma_f32_16x16x32_bf16 v[108:111], a[212:215], v[116:119], v[108:111]
    v_bfe_u32 v35, v173, 13, 5
    s_waitcnt vmcnt(6) lgkmcnt(1)
    s_barrier
    v_mfma_f32_16x16x32_bf16 v[76:79], a[216:219], v[120:123], v[76:79]
    ds_read_b128 v[112:115], v152 offset:0
    ds_read_b64_tr_b16 a[252:253], v15 offset:18432
    v_mfma_f32_16x16x32_bf16 v[80:83], a[220:223], v[120:123], v[80:83]
    ds_read_b64_tr_b16 a[254:255], v15 offset:19200
    v_sub_u32 v23, v25, v33
    v_mfma_f32_16x16x32_bf16 v[84:87], a[224:227], v[120:123], v[84:87]
    ds_read_b64_tr_b16 v[188:189], v16 offset:18432
    s_waitcnt lgkmcnt(4)
    v_mfma_f32_16x16x32_bf16 v[88:91], a[216:219], v[124:127], v[88:91]
    ds_read_b128 v[116:119], v134 offset:64
    ds_read_b64_tr_b16 v[190:191], v16 offset:19200
    v_mfma_f32_16x16x32_bf16 v[92:95], a[220:223], v[124:127], v[92:95]
    ds_read_b64_tr_b16 v[192:193], v17 offset:18432
    v_sub_u32 v24, v26, v36
    v_mfma_f32_16x16x32_bf16 v[96:99], a[224:227], v[124:127], v[96:99]
    ds_read_b64_tr_b16 v[194:195], v17 offset:19200
    s_waitcnt lgkmcnt(7)
    v_mfma_f32_16x16x32_bf16 v[100:103], a[216:219], v[112:115], v[100:103]
    ds_read_b128 v[120:123], v143 offset:64
    v_add_u32 v23, 1, v23
    v_mfma_f32_16x16x32_bf16 v[104:107], a[220:223], v[112:115], v[104:107]
    ds_read_b64_tr_b16 v[196:197], v15 offset:24576
    v_add_u32 v24, 1, v24
    v_mfma_f32_16x16x32_bf16 v[108:111], a[224:227], v[112:115], v[108:111]
    ds_read_b64_tr_b16 v[198:199], v15 offset:25344
    s_waitcnt lgkmcnt(6)
    v_mfma_f32_16x16x32_bf16 v[76:79], a[228:231], v[116:119], v[76:79]
    ds_read_b128 v[124:127], v152 offset:64
    v_cndmask_b32 v27, 0, v32, s[44:45]
    v_mfma_f32_16x16x32_bf16 v[80:83], a[232:235], v[116:119], v[80:83]
    ds_read_b64_tr_b16 v[200:201], v16 offset:24576
    v_cndmask_b32 v28, v31, 0, s[44:45]
    v_mfma_f32_16x16x32_bf16 v[84:87], a[236:239], v[116:119], v[84:87]
    ds_read_b64_tr_b16 v[202:203], v16 offset:25344
    s_waitcnt lgkmcnt(5)
    v_mfma_f32_16x16x32_bf16 v[88:91], a[228:231], v[120:123], v[88:91]
    ds_read_b128 v[112:115], v134 offset:128
    v_add_u32 v27, v23, v27
    v_mfma_f32_16x16x32_bf16 v[92:95], a[232:235], v[120:123], v[92:95]
    ds_read_b64_tr_b16 v[204:205], v17 offset:24576
    v_add_u32 v28, v24, v28
    v_mfma_f32_16x16x32_bf16 v[96:99], a[236:239], v[120:123], v[96:99]
    ds_read_b64_tr_b16 v[206:207], v17 offset:25344
    s_waitcnt lgkmcnt(5)
    v_mfma_f32_16x16x32_bf16 v[100:103], a[228:231], v[124:127], v[100:103]
    ds_read_b128 v[116:119], v143 offset:128
    v_max_u32 v43, v23, v27
    v_mfma_f32_16x16x32_bf16 v[104:107], a[232:235], v[124:127], v[104:107]
    ds_read_b64_tr_b16 v[208:209], v15 offset:30720
    v_max_u32 v45, v24, v28
    v_mfma_f32_16x16x32_bf16 v[108:111], a[236:239], v[124:127], v[108:111]
    ds_read_b64_tr_b16 v[210:211], v15 offset:31488
    s_waitcnt lgkmcnt(5)
    v_mfma_f32_16x16x32_bf16 v[76:79], a[240:243], v[112:115], v[76:79]
    ds_read_b128 v[120:123], v152 offset:128
    v_cmp_lt_u32 vcc, v43, v35
    v_mfma_f32_16x16x32_bf16 v[80:83], a[244:247], v[112:115], v[80:83]
    ds_read_b64_tr_b16 v[212:213], v16 offset:30720
    v_add_u32 v23, v34, v23
    v_mfma_f32_16x16x32_bf16 v[84:87], a[248:251], v[112:115], v[84:87]
    ds_read_b64_tr_b16 v[214:215], v16 offset:31488
    s_waitcnt lgkmcnt(5)
    v_mfma_f32_16x16x32_bf16 v[88:91], a[240:243], v[116:119], v[88:91]
    ds_read_b128 v[124:127], v135 offset:0
    v_add_u32 v27, v34, v27
    v_mfma_f32_16x16x32_bf16 v[92:95], a[244:247], v[116:119], v[92:95]
    ds_read_b64_tr_b16 v[216:217], v17 offset:30720
    v_cndmask_b32 v45, v46, v45, vcc
    v_mfma_f32_16x16x32_bf16 v[96:99], a[248:251], v[116:119], v[96:99]
    ds_read_b64_tr_b16 v[218:219], v17 offset:31488
    s_waitcnt lgkmcnt(5)
    v_mfma_f32_16x16x32_bf16 v[100:103], a[240:243], v[120:123], v[100:103]
    ds_read_b128 v[112:115], v144 offset:0
    v_mul_u32_u24 v23, 3456, v23
    v_mfma_f32_16x16x32_bf16 v[104:107], a[244:247], v[120:123], v[104:107]
    v_lshl_add_u32 v45, v41, 5, v45
    v_mfma_f32_16x16x32_bf16 v[108:111], a[248:251], v[120:123], v[108:111]
    v_mul_u32_u24 v27, 3456, v27
    s_waitcnt vmcnt(0) lgkmcnt(1)
    s_barrier
    v_mfma_f32_16x16x32_bf16 v[76:79], a[252:255], v[124:127], v[76:79]
    ds_read_b128 v[116:119], v153 offset:0
    ds_read_b64_tr_b16 v[220:221], v15 offset:36864
    v_mfma_f32_16x16x32_bf16 v[80:83], v[188:191], v[124:127], v[80:83]
    ds_read_b64_tr_b16 v[222:223], v15 offset:37632
    v_cndmask_b32 v45, v46, v45, s[52:53]
    v_mfma_f32_16x16x32_bf16 v[84:87], v[192:195], v[124:127], v[84:87]
    ds_read_b64_tr_b16 v[224:225], v16 offset:36864
    s_waitcnt lgkmcnt(4)
    v_mfma_f32_16x16x32_bf16 v[88:91], a[252:255], v[112:115], v[88:91]
    ds_read_b128 v[120:123], v135 offset:64
    ds_read_b64_tr_b16 v[226:227], v16 offset:37632
    v_mfma_f32_16x16x32_bf16 v[92:95], v[188:191], v[112:115], v[92:95]
    ds_read_b64_tr_b16 v[228:229], v17 offset:36864
    v_mad_u32_u24 v23, v24, s5, v23
    v_mfma_f32_16x16x32_bf16 v[96:99], v[192:195], v[112:115], v[96:99]
    ds_read_b64_tr_b16 v[230:231], v17 offset:37632
    s_waitcnt lgkmcnt(7)
    v_mfma_f32_16x16x32_bf16 v[100:103], a[252:255], v[116:119], v[100:103]
    ds_read_b128 v[124:127], v144 offset:64
    v_cmp_gt_u32 s[48:49], 18, v45
    v_mfma_f32_16x16x32_bf16 v[104:107], v[188:191], v[116:119], v[104:107]
    ds_read_b64_tr_b16 v[232:233], v15 offset:43008
    v_mad_u32_u24 v27, v28, s5, v27
    v_mfma_f32_16x16x32_bf16 v[108:111], v[192:195], v[116:119], v[108:111]
    ds_read_b64_tr_b16 v[234:235], v15 offset:43776
    s_waitcnt lgkmcnt(6)
    v_mfma_f32_16x16x32_bf16 v[76:79], v[196:199], v[120:123], v[76:79]
    ds_read_b128 v[112:115], v153 offset:64
    v_and_b32 v24, 4, v24
    v_mfma_f32_16x16x32_bf16 v[80:83], v[200:203], v[120:123], v[80:83]
    ds_read_b64_tr_b16 v[236:237], v16 offset:43008
    v_and_b32 v28, 4, v28
    v_mfma_f32_16x16x32_bf16 v[84:87], v[204:207], v[120:123], v[84:87]
    ds_read_b64_tr_b16 v[238:239], v16 offset:43776
    s_waitcnt lgkmcnt(5)
    v_mfma_f32_16x16x32_bf16 v[88:91], v[196:199], v[124:127], v[88:91]
    ds_read_b128 v[116:119], v135 offset:128
    s_andn2_b64 s[50:51], s[52:53], s[48:49]
    v_lshl_add_u32 v164, v24, 3, v23
    v_mfma_f32_16x16x32_bf16 v[92:95], v[200:203], v[124:127], v[92:95]
    ds_read_b64_tr_b16 v[240:241], v17 offset:43008
    v_lshl_add_u32 v165, v28, 3, v27
    v_mfma_f32_16x16x32_bf16 v[96:99], v[204:207], v[124:127], v[96:99]
    ds_read_b64_tr_b16 v[242:243], v17 offset:43776
    s_waitcnt lgkmcnt(5)
    v_mfma_f32_16x16x32_bf16 v[100:103], v[196:199], v[112:115], v[100:103]
    ds_read_b128 v[120:123], v144 offset:128
    v_and_b32 v168, 0xffff, v42
    v_mfma_f32_16x16x32_bf16 v[104:107], v[200:203], v[112:115], v[104:107]
    ds_read_b64_tr_b16 v[244:245], v15 offset:49152
    v_lshlrev_b32 v169, 16, v42
    v_mfma_f32_16x16x32_bf16 v[108:111], v[204:207], v[112:115], v[108:111]
    ds_read_b64_tr_b16 v[246:247], v15 offset:49920
    s_waitcnt lgkmcnt(5)
    v_mfma_f32_16x16x32_bf16 v[76:79], v[208:211], v[116:119], v[76:79]
    ds_read_b128 v[124:127], v153 offset:128
    v_lshrrev_b32 v170, 16, v42
    v_mfma_f32_16x16x32_bf16 v[80:83], v[212:215], v[116:119], v[80:83]
    ds_read_b64_tr_b16 v[248:249], v16 offset:49152
    v_and_b32 v171, 0xffff0000, v42
    v_mfma_f32_16x16x32_bf16 v[84:87], v[216:219], v[116:119], v[84:87]
    ds_read_b64_tr_b16 v[250:251], v16 offset:49920
    s_waitcnt lgkmcnt(5)
    v_mfma_f32_16x16x32_bf16 v[88:91], v[208:211], v[120:123], v[88:91]
    ds_read_b128 v[112:115], v136 offset:0
    v_mbcnt_lo_u32_b32 v43, s48, 0
    v_mfma_f32_16x16x32_bf16 v[92:95], v[212:215], v[120:123], v[92:95]
    ds_read_b64_tr_b16 v[252:253], v17 offset:49152
    v_mbcnt_lo_u32_b32 v45, s50, 0
    v_mfma_f32_16x16x32_bf16 v[96:99], v[216:219], v[120:123], v[96:99]
    ds_read_b64_tr_b16 v[254:255], v17 offset:49920
    s_waitcnt lgkmcnt(5)
    v_mfma_f32_16x16x32_bf16 v[100:103], v[208:211], v[124:127], v[100:103]
    ds_read_b128 v[116:119], v145 offset:0
    v_mbcnt_hi_u32_b32 v43, s49, v43
    v_mfma_f32_16x16x32_bf16 v[104:107], v[212:215], v[124:127], v[104:107]
    v_mbcnt_hi_u32_b32 v45, s51, v45
    v_mfma_f32_16x16x32_bf16 v[108:111], v[216:219], v[124:127], v[108:111]
    s_bcnt1_i32_b64 s40, s[48:49]
    s_bcnt1_i32_b64 s41, s[50:51]
    v_lshl_add_u32 v43, v43, 5, s6
    s_waitcnt lgkmcnt(1)
    s_barrier
    v_mfma_f32_16x16x32_bf16 v[76:79], v[220:223], v[112:115], v[76:79]
    ds_read_b128 v[120:123], v154 offset:0
    v_lshlrev_b32 v45, 5, v45
    v_mfma_f32_16x16x32_bf16 v[80:83], v[224:227], v[112:115], v[80:83]
    v_sub_u32 v45, s7, v45
    v_mfma_f32_16x16x32_bf16 v[84:87], v[228:231], v[112:115], v[84:87]
    v_cndmask_b32 v156, v156, v164, s[48:49]
    s_waitcnt lgkmcnt(1)
    v_mfma_f32_16x16x32_bf16 v[88:91], v[220:223], v[116:119], v[88:91]
    ds_read_b128 v[124:127], v136 offset:64
    v_cndmask_b32 v45, v45, v43, s[48:49]
    v_mfma_f32_16x16x32_bf16 v[92:95], v[224:227], v[116:119], v[92:95]
    v_cndmask_b32 v157, v157, v165, s[48:49]
    v_mfma_f32_16x16x32_bf16 v[96:99], v[228:231], v[116:119], v[96:99]
    v_cndmask_b32 v158, v42, v40, s[48:49]
    s_waitcnt lgkmcnt(1)
    v_mfma_f32_16x16x32_bf16 v[100:103], v[220:223], v[120:123], v[100:103]
    ds_read_b128 v[112:115], v145 offset:64
    v_cndmask_b32 v45, v47, v45, s[52:53]
    v_mfma_f32_16x16x32_bf16 v[104:107], v[224:227], v[120:123], v[104:107]
    v_cndmask_b32 v160, v160, v168, s[48:49]
    v_mfma_f32_16x16x32_bf16 v[108:111], v[228:231], v[120:123], v[108:111]
    v_cndmask_b32 v161, v161, v169, s[48:49]
    s_waitcnt lgkmcnt(1)
    v_mfma_f32_16x16x32_bf16 v[76:79], v[232:235], v[124:127], v[76:79]
    ds_read_b128 v[116:119], v154 offset:64
    v_cndmask_b32 v162, v162, v170, s[48:49]
    v_mfma_f32_16x16x32_bf16 v[80:83], v[236:239], v[124:127], v[80:83]
    v_cndmask_b32 v163, v163, v171, s[48:49]
    v_mfma_f32_16x16x32_bf16 v[84:87], v[240:243], v[124:127], v[84:87]
    ds_write_b128 v45, v[156:159]
    s_waitcnt lgkmcnt(2)
    v_mfma_f32_16x16x32_bf16 v[88:91], v[232:235], v[112:115], v[88:91]
    ds_read_b128 v[120:123], v136 offset:128
    ds_write_b128 v45, v[160:163] offset:16
    v_mfma_f32_16x16x32_bf16 v[92:95], v[236:239], v[112:115], v[92:95]
    v_mfma_f32_16x16x32_bf16 v[96:99], v[240:243], v[112:115], v[96:99]
    s_waitcnt lgkmcnt(3)
    v_mfma_f32_16x16x32_bf16 v[100:103], v[232:235], v[116:119], v[100:103]
    ds_read_b128 v[124:127], v145 offset:128
    v_mfma_f32_16x16x32_bf16 v[104:107], v[236:239], v[116:119], v[104:107]
    v_mfma_f32_16x16x32_bf16 v[108:111], v[240:243], v[116:119], v[108:111]
    s_waitcnt lgkmcnt(2)
    v_mfma_f32_16x16x32_bf16 v[76:79], v[244:247], v[120:123], v[76:79]
    ds_read_b128 v[112:115], v154 offset:128
    v_mfma_f32_16x16x32_bf16 v[80:83], v[248:251], v[120:123], v[80:83]
    v_mfma_f32_16x16x32_bf16 v[84:87], v[252:255], v[120:123], v[84:87]
    s_waitcnt lgkmcnt(1)
    v_mfma_f32_16x16x32_bf16 v[88:91], v[244:247], v[124:127], v[88:91]
    v_mfma_f32_16x16x32_bf16 v[92:95], v[248:251], v[124:127], v[92:95]
    v_mfma_f32_16x16x32_bf16 v[96:99], v[252:255], v[124:127], v[96:99]
    s_waitcnt lgkmcnt(0)
    v_mfma_f32_16x16x32_bf16 v[100:103], v[244:247], v[112:115], v[100:103]
    v_mfma_f32_16x16x32_bf16 v[104:107], v[248:251], v[112:115], v[104:107]
    v_mfma_f32_16x16x32_bf16 v[108:111], v[252:255], v[112:115], v[108:111]
L_p1end:
    s_waitcnt vmcnt(0) lgkmcnt(0)
    s_barrier
    v_cvt_pk_bf16_f32 v160, v76, v77
    v_cvt_pk_bf16_f32 v161, v78, v79
    v_cvt_pk_bf16_f32 v162, v80, v81
    v_cvt_pk_bf16_f32 v163, v82, v83
    v_cvt_pk_bf16_f32 v164, v84, v85
    v_cvt_pk_bf16_f32 v165, v86, v87
    v_cvt_pk_bf16_f32 v166, v88, v89
    v_cvt_pk_bf16_f32 v167, v90, v91
    v_cvt_pk_bf16_f32 v168, v92, v93
    v_cvt_pk_bf16_f32 v169, v94, v95
    v_cvt_pk_bf16_f32 v170, v96, v97
    v_cvt_pk_bf16_f32 v171, v98, v99
    v_cvt_pk_bf16_f32 v172, v100, v101
    v_cvt_pk_bf16_f32 v173, v102, v103
    v_cvt_pk_bf16_f32 v174, v104, v105
    v_cvt_pk_bf16_f32 v175, v106, v107
    v_cvt_pk_bf16_f32 v176, v108, v109
    v_cvt_pk_bf16_f32 v177, v110, v111
    v_permlane16_swap_b32 v160, v162
    v_permlane16_swap_b32 v161, v163
    v_permlane16_swap_b32 v166, v168
    v_permlane16_swap_b32 v167, v169
    v_permlane16_swap_b32 v172, v174
    v_permlane16_swap_b32 v173, v175
    s_cmp_eq_u32 s38, 0
    s_cbranch_scc1 L_main
    s_cmp_le_u32 s38, 256
    s_cbranch_scc1 L_nolate2
    v_mul_u32_u24 v112, 4, v1
    v_add_u32 v112, s3, v112
    v_add_u32 v112, 256, v112
    s_mov_b32 s35, 0
L_dt_14:
    v_cmp_gt_u32 vcc, s38, v112
    s_and_saveexec_b64 s[58:59], vcc
    s_cbranch_execz L_dd_15
    v_lshlrev_b32 v135, 3, v112
    v_add_u32 v135, 129024, v135
    ds_read_b64 v[114:115], v135
    v_mul_u32_u24 v132, 192, v112
    v_add_u32 v132, 62208, v132
    s_waitcnt lgkmcnt(0)
    v_lshlrev_b32 v116, 16, v114
    v_and_b32 v117, 0xffff0000, v114
    v_floor_f32 v118, v116
    v_floor_f32 v119, v117
    v_sub_f32 v120, v116, v118
    v_sub_f32 v121, v117, v119
    v_cvt_u32_f32 v118, v118
    v_cvt_u32_f32 v119, v119
    v_cmp_eq_f32 s[44:45], 0, v121
    v_cmp_neq_f32 s[46:47], 0, v120
    v_sub_f32 v116, 1.0, v120
    v_sub_f32 v117, 1.0, v121
    v_cvt_pk_bf16_f32 v135, v116, v117
    v_sub_u32 v123, 223, v119
    v_sub_u32 v124, 223, v118
    v_lshlrev_b32 v116, 16, v135
    v_and_b32 v117, 0xffff0000, v135
    v_min_u32 v123, 1, v123
    v_min_u32 v124, 1, v124
    v_mul_f32 v125, v116, v117
    v_mul_f32 v126, v116, v121
    v_mul_f32 v127, v120, v117
    v_mul_f32 v128, v120, v121
    v_cndmask_b32 v133, 0, 1, s[46:47]
    v_cvt_pk_bf16_f32 v129, v125, v126
    v_cvt_pk_bf16_f32 v130, v125, v127
    v_cvt_pk_bf16_f32 v131, v127, v128
    v_cndmask_b32 v133, v133, 0, s[44:45]
    v_cndmask_b32 v134, v129, v130, s[44:45]
    v_mul_u32_u24 v122, 43008, v118
    v_mul_u32_u24 v139, 192, v123
    v_mul_u32_u24 v140, 43008, v124
    v_mad_u32_u24 v144, v119, s5, v122
    v_cndmask_b32 v135, v139, v140, s[44:45]
    v_add_u32 v148, v144, v140
    v_add_u32 v145, v144, v135
    v_add_u32 v149, v148, v139
    v_mov_b32 v146, v134
    v_lshl_or_b32 v147, v133, 31, v132
    v_mul_lo_u32 v150, v131, v133
    v_mov_b32 v151, 0
    v_and_b32 v125, 0xff, v115
    v_lshrrev_b32 v128, 18, v115
    v_bfe_u32 v126, v115, 8, 5
    v_bfe_u32 v127, v115, 13, 5
    v_sub_u32 v116, v118, v125
    v_sub_u32 v117, v119, v128
    v_add_u32 v116, 1, v116
    v_add_u32 v117, 1, v117
    v_cndmask_b32 v120, 0, v124, s[44:45]
    v_cndmask_b32 v121, v123, 0, s[44:45]
    v_add_u32 v120, v116, v120
    v_add_u32 v121, v117, v121
    v_max_u32 v135, v116, v120
    v_max_u32 v136, v117, v121
    v_cmp_lt_u32 vcc, v135, v127
    v_mov_b32 v137, 99
    v_add_u32 v116, v126, v116
    v_cndmask_b32 v136, v137, v136, vcc
    v_add_u32 v120, v126, v120
    v_lshl_add_u32 v136, v133, 5, v136
    v_mul_u32_u24 v116, 3456, v116
    v_cmp_gt_u32 s[48:49], 18, v136
    v_mul_u32_u24 v120, 3456, v120
    v_mad_u32_u24 v116, v117, s5, v116
    v_mad_u32_u24 v120, v121, s5, v120
    v_and_b32 v117, 4, v117
    v_and_b32 v121, 4, v121
    s_andn2_b64 s[50:51], exec, s[48:49]
    v_lshl_add_u32 v152, v117, 3, v116
    v_lshl_add_u32 v153, v121, 3, v120
    v_and_b32 v156, 0xffff, v134
    v_lshlrev_b32 v157, 16, v134
    v_lshrrev_b32 v158, 16, v134
    v_and_b32 v159, 0xffff0000, v134
    v_mbcnt_lo_u32_b32 v135, s48, 0
    v_mbcnt_lo_u32_b32 v136, s50, 0
    v_mbcnt_hi_u32_b32 v135, s49, v135
    v_mbcnt_hi_u32_b32 v136, s51, v136
    s_mul_i32 s32, s3, 2304
    s_add_u32 s32, s32, 134400
    v_add_u32 v135, s40, v135
    v_add_u32 v136, s41, v136
    s_add_u32 s33, s32, 2272
    v_lshlrev_b32 v135, 5, v135
    v_lshlrev_b32 v136, 5, v136
    v_add_u32 v135, s32, v135
    v_sub_u32 v136, s33, v136
    s_bcnt1_i32_b64 s32, s[48:49]
    s_bcnt1_i32_b64 s33, s[50:51]
    v_cndmask_b32 v136, v136, v135, s[48:49]
    v_cndmask_b32 v144, v144, v152, s[48:49]
    v_cndmask_b32 v145, v145, v153, s[48:49]
    v_cndmask_b32 v146, v146, v132, s[48:49]
    v_cndmask_b32 v148, v148, v156, s[48:49]
    v_cndmask_b32 v149, v149, v157, s[48:49]
    v_cndmask_b32 v150, v150, v158, s[48:49]
    v_cndmask_b32 v151, v151, v159, s[48:49]
    s_add_u32 s40, s40, s32
    s_add_u32 s41, s41, s33
    ds_write_b128 v136, v[144:147]
    ds_write_b128 v136, v[148:151] offset:16
    s_mov_b64 exec, s[58:59]
L_dd_15:
    s_mov_b64 exec, s[58:59]
    s_waitcnt lgkmcnt(0)
L_nolate2:
    s_mov_b32 s42, s41
    s_mul_i32 s43, s3, 2304
    s_add_u32 s62, s43, 134400
    s_add_u32 s43, s62, 2272
    s_mov_b32 s36, 0
    s_cmp_eq_u32 s42, 0
    s_cbranch_scc1 L_noout_a
    s_sub_u32 s33, s42, 1
    s_add_u32 s32, s36, 0
    v_add_u32 v48, s32, v74
    v_min_u32 v48, s33, v48
    v_lshlrev_b32 v48, 5, v48
    v_sub_u32 v48, s43, v48
    ds_read_b128 v[20:23], v48
    ds_read_b128 v[24:27], v48 offset:16
    s_add_u32 s32, s36, 5
    v_add_u32 v49, s32, v74
    v_min_u32 v49, s33, v49
    v_lshlrev_b32 v49, 5, v49
    v_sub_u32 v49, s43, v49
    ds_read_b128 v[36:39], v49
    ds_read_b128 v[40:43], v49 offset:16
    s_waitcnt lgkmcnt(0)
    v_cmp_gt_i32 vcc, 0, v23
    v_add_u32 v20, v20, v75
    v_add_u32 v21, v21, v75
    buffer_load_dwordx4 v[76:79], v20, s[8:11], 0 offen
    buffer_load_dwordx4 v[80:83], v21, s[8:11], 0 offen
    s_cmp_lg_u64 vcc, 0
    s_cselect_b32 s52, 1, 0
    s_cbranch_scc0 L_g2_16
    v_add_u32 v24, v24, v75
    v_add_u32 v25, v25, v75
    buffer_load_dwordx4 v[84:87], v24, s[8:11], 0 offen
    buffer_load_dwordx4 v[88:91], v25, s[8:11], 0 offen
L_g2_16:
    s_mov_b32 s53, 0
    s_add_u32 s32, s36, 5
    s_cmp_ge_u32 s32, s42
    s_cbranch_scc1 L_o1_b
    v_cmp_gt_i32 vcc, 0, v39
    v_add_u32 v36, v36, v75
    v_add_u32 v37, v37, v75
    buffer_load_dwordx4 v[92:95], v36, s[8:11], 0 offen
    buffer_load_dwordx4 v[96:99], v37, s[8:11], 0 offen
    s_cmp_lg_u64 vcc, 0
    s_cselect_b32 s53, 1, 0
    s_cbranch_scc0 L_g2_17
    v_add_u32 v40, v40, v75
    v_add_u32 v41, v41, v75
    buffer_load_dwordx4 v[100:103], v40, s[8:11], 0 offen
    buffer_load_dwordx4 v[104:107], v41, s[8:11], 0 offen
L_g2_17:
L_o1_b:
L_noout_a:
    s_cmp_eq_u32 s40, 0
    s_cbranch_scc1 L_in_done
    s_sub_u32 s63, s40, 1
    s_mov_b32 s39, 0
    v_add_u32 v54, s39, v74
    s_add_u32 s39, s39, 5
    v_min_u32 v54, s63, v54
    v_lshl_add_u32 v54, v54, 5, s62
    ds_read_b128 v[108:111], v54
    ds_read_b128 v[112:115], v54 offset:16
    v_add_u32 v54, s39, v74
    s_add_u32 s39, s39, 5
    v_min_u32 v54, s63, v54
    v_lshl_add_u32 v54, v54, 5, s62
    ds_read_b128 v[116:119], v54
    ds_read_b128 v[120:123], v54 offset:16
    s_waitcnt lgkmcnt(2)
    v_xad_u32 v108, v108, v14, v29
    v_xad_u32 v109, v109, v14, v29
    ds_read_b128 v[132:135], v108
    ds_read_b128 v[136:139], v109
    s_mov_b32 s35, 5
L_in_top:
    v_add_u32 v54, s39, v74
    s_add_u32 s39, s39, 5
    v_min_u32 v54, s63, v54
    v_lshl_add_u32 v54, v54, 5, s62
    ds_read_b128 v[124:127], v54
    ds_read_b128 v[128:131], v54 offset:16
    s_waitcnt lgkmcnt(4)
    v_xad_u32 v116, v116, v14, v29
    v_xad_u32 v117, v117, v14, v29
    ds_read_b128 v[140:143], v116
    ds_read_b128 v[144:147], v117
    s_waitcnt lgkmcnt(4)
    v_dot2_f32_bf16 v60, v132, v112, 0
    v_dot2_f32_bf16 v61, v132, v113, 0
    v_dot2_f32_bf16 v62, v133, v112, 0
    v_dot2_f32_bf16 v63, v133, v113, 0
    v_dot2_f32_bf16 v64, v134, v112, 0
    v_dot2_f32_bf16 v65, v134, v113, 0
    v_dot2_f32_bf16 v66, v135, v112, 0
    v_dot2_f32_bf16 v67, v135, v113, 0
    v_dot2c_f32_bf16 v60, v136, v114
    v_dot2c_f32_bf16 v61, v136, v115
    v_dot2c_f32_bf16 v62, v137, v114
    v_dot2c_f32_bf16 v63, v137, v115
    v_dot2c_f32_bf16 v64, v138, v114
    v_dot2c_f32_bf16 v65, v138, v115
    v_dot2c_f32_bf16 v66, v139, v114
    v_dot2c_f32_bf16 v67, v139, v115
    s_nop 0
    v_add_u32 v110, v110, v75
    s_nop 0
    v_cvt_pk_bf16_f32 v68, v60, v61
    v_cvt_pk_bf16_f32 v69, v62, v63
    v_cvt_pk_bf16_f32 v70, v64, v65
    v_cvt_pk_bf16_f32 v71, v66, v67
    ds_write_b128 v110, v[68:71]
    s_cmp_ge_u32 s35, s40
    s_cbranch_scc1 L_in_done
    s_add_u32 s35, s35, 5
    v_add_u32 v54, s39, v74
    s_add_u32 s39, s39, 5
    v_min_u32 v54, s63, v54
    v_lshl_add_u32 v54, v54, 5, s62
    ds_read_b128 v[108:111], v54
    ds_read_b128 v[112:115], v54 offset:16
    s_waitcnt lgkmcnt(5)
    v_xad_u32 v124, v124, v14, v29
    v_xad_u32 v125, v125, v14, v29
    ds_read_b128 v[132:135], v124
    ds_read_b128 v[136:139], v125
    s_waitcnt lgkmcnt(5)
    v_dot2_f32_bf16 v60, v140, v120, 0
    v_dot2_f32_bf16 v61, v140, v121, 0
    v_dot2_f32_bf16 v62, v141, v120, 0
    v_dot2_f32_bf16 v63, v141, v121, 0
    v_dot2_f32_bf16 v64, v142, v120, 0
    v_dot2_f32_bf16 v65, v142, v121, 0
    v_dot2_f32_bf16 v66, v143, v120, 0
    v_dot2_f32_bf16 v67, v143, v121, 0
    v_dot2c_f32_bf16 v60, v144, v122
    v_dot2c_f32_bf16 v61, v144, v123
    v_dot2c_f32_bf16 v62, v145, v122
    v_dot2c_f32_bf16 v63, v145, v123
    v_dot2c_f32_bf16 v64, v146, v122
    v_dot2c_f32_bf16 v65, v146, v123
    v_dot2c_f32_bf16 v66, v147, v122
    v_dot2c_f32_bf16 v67, v147, v123
    s_nop 0
    v_add_u32 v118, v118, v75
    s_nop 0
    v_cvt_pk_bf16_f32 v68, v60, v61
    v_cvt_pk_bf16_f32 v69, v62, v63
    v_cvt_pk_bf16_f32 v70, v64, v65
    v_cvt_pk_bf16_f32 v71, v66, v67
    ds_write_b128 v118, v[68:71]
    s_cmp_ge_u32 s35, s40
    s_cbranch_scc1 L_in_done
    s_add_u32 s35, s35, 5
    v_add_u32 v54, s39, v74
    s_add_u32 s39, s39, 5
    v_min_u32 v54, s63, v54
    v_lshl_add_u32 v54, v54, 5, s62
    ds_read_b128 v[116:119], v54
    ds_read_b128 v[120:123], v54 offset:16
    s_waitcnt lgkmcnt(5)
    v_xad_u32 v108, v108, v14, v29
    v_xad_u32 v109, v109, v14, v29
    ds_read_b128 v[140:143], v108
    ds_read_b128 v[144:147], v109
    s_waitcnt lgkmcnt(5)
    v_dot2_f32_bf16 v60, v132, v128, 0
    v_dot2_f32_bf16 v61, v132, v129, 0
    v_dot2_f32_bf16 v62, v133, v128, 0
    v_dot2_f32_bf16 v63, v133, v129, 0
    v_dot2_f32_bf16 v64, v134, v128, 0
    v_dot2_f32_bf16 v65, v134, v129, 0
    v_dot2_f32_bf16 v66, v135, v128, 0
    v_dot2_f32_bf16 v67, v135, v129, 0
    v_dot2c_f32_bf16 v60, v136, v130
    v_dot2c_f32_bf16 v61, v136, v131
    v_dot2c_f32_bf16 v62, v137, v130
    v_dot2c_f32_bf16 v63, v137, v131
    v_dot2c_f32_bf16 v64, v138, v130
    v_dot2c_f32_bf16 v65, v138, v131
    v_dot2c_f32_bf16 v66, v139, v130
    v_dot2c_f32_bf16 v67, v139, v131
    s_nop 0
    v_add_u32 v126, v126, v75
    s_nop 0
    v_cvt_pk_bf16_f32 v68, v60, v61
    v_cvt_pk_bf16_f32 v69, v62, v63
    v_cvt_pk_bf16_f32 v70, v64, v65
    v_cvt_pk_bf16_f32 v71, v66, v67
    ds_write_b128 v126, v[68:71]
    s_cmp_ge_u32 s35, s40
    s_cbranch_scc1 L_in_done
    s_add_u32 s35, s35, 5
    v_add_u32 v54, s39, v74
    s_add_u32 s39, s39, 5
    v_min_u32 v54, s63, v54
    v_lshl_add_u32 v54, v54, 5, s62
    ds_read_b128 v[124:127], v54
    ds_read_b128 v[128:131], v54 offset:16
    s_waitcnt lgkmcnt(5)
    v_xad_u32 v116, v116, v14, v29
    v_xad_u32 v117, v117, v14, v29
    ds_read_b128 v[132:135], v116
    ds_read_b128 v[136:139], v117
    s_waitcnt lgkmcnt(5)
    v_dot2_f32_bf16 v60, v140, v112, 0
    v_dot2_f32_bf16 v61, v140, v113, 0
    v_dot2_f32_bf16 v62, v141, v112, 0
    v_dot2_f32_bf16 v63, v141, v113, 0
    v_dot2_f32_bf16 v64, v142, v112, 0
    v_dot2_f32_bf16 v65, v142, v113, 0
    v_dot2_f32_bf16 v66, v143, v112, 0
    v_dot2_f32_bf16 v67, v143, v113, 0
    v_dot2c_f32_bf16 v60, v144, v114
    v_dot2c_f32_bf16 v61, v144, v115
    v_dot2c_f32_bf16 v62, v145, v114
    v_dot2c_f32_bf16 v63, v145, v115
    v_dot2c_f32_bf16 v64, v146, v114
    v_dot2c_f32_bf16 v65, v146, v115
    v_dot2c_f32_bf16 v66, v147, v114
    v_dot2c_f32_bf16 v67, v147, v115
    s_nop 0
    v_add_u32 v110, v110, v75
    s_nop 0
    v_cvt_pk_bf16_f32 v68, v60, v61
    v_cvt_pk_bf16_f32 v69, v62, v63
    v_cvt_pk_bf16_f32 v70, v64, v65
    v_cvt_pk_bf16_f32 v71, v66, v67
    ds_write_b128 v110, v[68:71]
    s_cmp_ge_u32 s35, s40
    s_cbranch_scc1 L_in_done
    s_add_u32 s35, s35, 5
    v_add_u32 v54, s39, v74
    s_add_u32 s39, s39, 5
    v_min_u32 v54, s63, v54
    v_lshl_add_u32 v54, v54, 5, s62
    ds_read_b128 v[108:111], v54
    ds_read_b128 v[112:115], v54 offset:16
    s_waitcnt lgkmcnt(5)
    v_xad_u32 v124, v124, v14, v29
    v_xad_u32 v125, v125, v14, v29
    ds_read_b128 v[140:143], v124
    ds_read_b128 v[144:147], v125
    s_waitcnt lgkmcnt(5)
    v_dot2_f32_bf16 v60, v132, v120, 0
    v_dot2_f32_bf16 v61, v132, v121, 0
    v_dot2_f32_bf16 v62, v133, v120, 0
    v_dot2_f32_bf16 v63, v133, v121, 0
    v_dot2_f32_bf16 v64, v134, v120, 0
    v_dot2_f32_bf16 v65, v134, v121, 0
    v_dot2_f32_bf16 v66, v135, v120, 0
    v_dot2_f32_bf16 v67, v135, v121, 0
    v_dot2c_f32_bf16 v60, v136, v122
    v_dot2c_f32_bf16 v61, v136, v123
    v_dot2c_f32_bf16 v62, v137, v122
    v_dot2c_f32_bf16 v63, v137, v123
    v_dot2c_f32_bf16 v64, v138, v122
    v_dot2c_f32_bf16 v65, v138, v123
    v_dot2c_f32_bf16 v66, v139, v122
    v_dot2c_f32_bf16 v67, v139, v123
    s_nop 0
    v_add_u32 v118, v118, v75
    s_nop 0
    v_cvt_pk_bf16_f32 v68, v60, v61
    v_cvt_pk_bf16_f32 v69, v62, v63
    v_cvt_pk_bf16_f32 v70, v64, v65
    v_cvt_pk_bf16_f32 v71, v66, v67
    ds_write_b128 v118, v[68:71]
    s_cmp_ge_u32 s35, s40
    s_cbranch_scc1 L_in_done
    s_add_u32 s35, s35, 5
    v_add_u32 v54, s39, v74
    s_add_u32 s39, s39, 5
    v_min_u32 v54, s63, v54
    v_lshl_add_u32 v54, v54, 5, s62
    ds_read_b128 v[116:119], v54
    ds_read_b128 v[120:123], v54 offset:16
    s_waitcnt lgkmcnt(5)
    v_xad_u32 v108, v108, v14, v29
    v_xad_u32 v109, v109, v14, v29
    ds_read_b128 v[132:135], v108
    ds_read_b128 v[136:139], v109
    s_waitcnt lgkmcnt(5)
    v_dot2_f32_bf16 v60, v140, v128, 0
    v_dot2_f32_bf16 v61, v140, v129, 0
    v_dot2_f32_bf16 v62, v141, v128, 0
    v_dot2_f32_bf16 v63, v141, v129, 0
    v_dot2_f32_bf16 v64, v142, v128, 0
    v_dot2_f32_bf16 v65, v142, v129, 0
    v_dot2_f32_bf16 v66, v143, v128, 0
    v_dot2_f32_bf16 v67, v143, v129, 0
    v_dot2c_f32_bf16 v60, v144, v130
    v_dot2c_f32_bf16 v61, v144, v131
    v_dot2c_f32_bf16 v62, v145, v130
    v_dot2c_f32_bf16 v63, v145, v131
    v_dot2c_f32_bf16 v64, v146, v130
    v_dot2c_f32_bf16 v65, v146, v131
    v_dot2c_f32_bf16 v66, v147, v130
    v_dot2c_f32_bf16 v67, v147, v131
    s_nop 0
    v_add_u32 v126, v126, v75
    s_nop 0
    v_cvt_pk_bf16_f32 v68, v60, v61
    v_cvt_pk_bf16_f32 v69, v62, v63
    v_cvt_pk_bf16_f32 v70, v64, v65
    v_cvt_pk_bf16_f32 v71, v66, v67
    ds_write_b128 v126, v[68:71]
    s_cmp_ge_u32 s35, s40
    s_cbranch_scc1 L_in_done
    s_add_u32 s35, s35, 5
    s_branch L_in_top
L_in_done:
    s_cmp_eq_u32 s42, 0
    s_cbranch_scc1 L_out_done
    s_waitcnt vmcnt(0)
    v_and_b32 v50, 0xffff, v22
    v_lshlrev_b32 v51, 16, v22
    v_lshrrev_b32 v52, 16, v22
    v_and_b32 v53, 0xffff0000, v22
    v_dot2_f32_bf16 v60, v76, v50, 0
    v_dot2_f32_bf16 v61, v76, v51, 0
    v_dot2_f32_bf16 v62, v77, v50, 0
    v_dot2_f32_bf16 v63, v77, v51, 0
    v_dot2_f32_bf16 v64, v78, v50, 0
    v_dot2_f32_bf16 v65, v78, v51, 0
    v_dot2_f32_bf16 v66, v79, v50, 0
    v_dot2_f32_bf16 v67, v79, v51, 0
    v_dot2c_f32_bf16 v60, v80, v52
    v_dot2c_f32_bf16 v61, v80, v53
    v_dot2c_f32_bf16 v62, v81, v52
    v_dot2c_f32_bf16 v63, v81, v53
    v_dot2c_f32_bf16 v64, v82, v52
    v_dot2c_f32_bf16 v65, v82, v53
    v_dot2c_f32_bf16 v66, v83, v52
    v_dot2c_f32_bf16 v67, v83, v53
    s_cmp_eq_u32 s52, 0
    s_cbranch_scc1 L_g4_18
    v_and_b32 v50, 0xffff, v26
    v_lshlrev_b32 v51, 16, v26
    v_lshrrev_b32 v52, 16, v26
    v_and_b32 v53, 0xffff0000, v26
    v_dot2_f32_bf16 v60, v84, v50, v60
    v_dot2_f32_bf16 v61, v84, v51, v61
    v_dot2_f32_bf16 v62, v85, v50, v62
    v_dot2_f32_bf16 v63, v85, v51, v63
    v_dot2_f32_bf16 v64, v86, v50, v64
    v_dot2_f32_bf16 v65, v86, v51, v65
    v_dot2_f32_bf16 v66, v87, v50, v66
    v_dot2_f32_bf16 v67, v87, v51, v67
    v_dot2c_f32_bf16 v60, v88, v52
    v_dot2c_f32_bf16 v61, v88, v53
    v_dot2c_f32_bf16 v62, v89, v52
    v_dot2c_f32_bf16 v63, v89, v53
    v_dot2c_f32_bf16 v64, v90, v52
    v_dot2c_f32_bf16 v65, v90, v53
    v_dot2c_f32_bf16 v66, v91, v52
    v_dot2c_f32_bf16 v67, v91, v53
L_g4_18:
    v_and_b32 v23, 0x7fffffff, v23
    v_add_u32 v23, v23, v75
    s_nop 0
    v_cvt_pk_bf16_f32 v68, v60, v61
    v_cvt_pk_bf16_f32 v69, v62, v63
    v_cvt_pk_bf16_f32 v70, v64, v65
    v_cvt_pk_bf16_f32 v71, v66, v67
    ds_write_b128 v23, v[68:71]
    s_add_u32 s32, s36, 5
    s_cmp_ge_u32 s32, s42
    s_cbranch_scc1 L_o1_c
    v_and_b32 v50, 0xffff, v38
    v_lshlrev_b32 v51, 16, v38
    v_lshrrev_b32 v52, 16, v38
    v_and_b32 v53, 0xffff0000, v38
    v_dot2_f32_bf16 v60, v92, v50, 0
    v_dot2_f32_bf16 v61, v92, v51, 0
    v_dot2_f32_bf16 v62, v93, v50, 0
    v_dot2_f32_bf16 v63, v93, v51, 0
    v_dot2_f32_bf16 v64, v94, v50, 0
    v_dot2_f32_bf16 v65, v94, v51, 0
    v_dot2_f32_bf16 v66, v95, v50, 0
    v_dot2_f32_bf16 v67, v95, v51, 0
    v_dot2c_f32_bf16 v60, v96, v52
    v_dot2c_f32_bf16 v61, v96, v53
    v_dot2c_f32_bf16 v62, v97, v52
    v_dot2c_f32_bf16 v63, v97, v53
    v_dot2c_f32_bf16 v64, v98, v52
    v_dot2c_f32_bf16 v65, v98, v53
    v_dot2c_f32_bf16 v66, v99, v52
    v_dot2c_f32_bf16 v67, v99, v53
    s_cmp_eq_u32 s53, 0
    s_cbranch_scc1 L_g4_19
    v_and_b32 v50, 0xffff, v42
    v_lshlrev_b32 v51, 16, v42
    v_lshrrev_b32 v52, 16, v42
    v_and_b32 v53, 0xffff0000, v42
    v_dot2_f32_bf16 v60, v100, v50, v60
    v_dot2_f32_bf16 v61, v100, v51, v61
    v_dot2_f32_bf16 v62, v101, v50, v62
    v_dot2_f32_bf16 v63, v101, v51, v63
    v_dot2_f32_bf16 v64, v102, v50, v64
    v_dot2_f32_bf16 v65, v102, v51, v65
    v_dot2_f32_bf16 v66, v103, v50, v66
    v_dot2_f32_bf16 v67, v103, v51, v67
    v_dot2c_f32_bf16 v60, v104, v52
    v_dot2c_f32_bf16 v61, v104, v53
    v_dot2c_f32_bf16 v62, v105, v52
    v_dot2c_f32_bf16 v63, v105, v53
    v_dot2c_f32_bf16 v64, v106, v52
    v_dot2c_f32_bf16 v65, v106, v53
    v_dot2c_f32_bf16 v66, v107, v52
    v_dot2c_f32_bf16 v67, v107, v53
L_g4_19:
    v_and_b32 v39, 0x7fffffff, v39
    v_add_u32 v39, v39, v75
    s_nop 0
    v_cvt_pk_bf16_f32 v68, v60, v61
    v_cvt_pk_bf16_f32 v69, v62, v63
    v_cvt_pk_bf16_f32 v70, v64, v65
    v_cvt_pk_bf16_f32 v71, v66, v67
    ds_write_b128 v39, v[68:71]
L_o1_c:
    s_add_u32 s36, s36, 10
L_gt_20:
    s_cmp_ge_u32 s36, s42
    s_cbranch_scc1 L_gd_21
    s_sub_u32 s33, s42, 1
    s_add_u32 s32, s36, 0
    v_add_u32 v48, s32, v74
    v_min_u32 v48, s33, v48
    v_lshlrev_b32 v48, 5, v48
    v_sub_u32 v48, s43, v48
    ds_read_b128 v[20:23], v48
    ds_read_b128 v[24:27], v48 offset:16
    s_add_u32 s32, s36, 5
    v_add_u32 v49, s32, v74
    v_min_u32 v49, s33, v49
    v_lshlrev_b32 v49, 5, v49
    v_sub_u32 v49, s43, v49
    ds_read_b128 v[36:39], v49
    ds_read_b128 v[40:43], v49 offset:16
    s_waitcnt lgkmcnt(0)
    v_cmp_gt_i32 vcc, 0, v23
    v_add_u32 v20, v20, v75
    v_add_u32 v21, v21, v75
    buffer_load_dwordx4 v[76:79], v20, s[8:11], 0 offen
    buffer_load_dwordx4 v[80:83], v21, s[8:11], 0 offen
    s_cmp_lg_u64 vcc, 0
    s_cselect_b32 s52, 1, 0
    s_cbranch_scc0 L_g2_23
    v_add_u32 v24, v24, v75
    v_add_u32 v25, v25, v75
    buffer_load_dwordx4 v[84:87], v24, s[8:11], 0 offen
    buffer_load_dwordx4 v[88:91], v25, s[8:11], 0 offen
L_g2_23:
    s_mov_b32 s53, 0
    s_add_u32 s32, s36, 5
    s_cmp_ge_u32 s32, s42
    s_cbranch_scc1 L_g_22_b
    v_cmp_gt_i32 vcc, 0, v39
    v_add_u32 v36, v36, v75
    v_add_u32 v37, v37, v75
    buffer_load_dwordx4 v[92:95], v36, s[8:11], 0 offen
    buffer_load_dwordx4 v[96:99], v37, s[8:11], 0 offen
    s_cmp_lg_u64 vcc, 0
    s_cselect_b32 s53, 1, 0
    s_cbranch_scc0 L_g2_24
    v_add_u32 v40, v40, v75
    v_add_u32 v41, v41, v75
    buffer_load_dwordx4 v[100:103], v40, s[8:11], 0 offen
    buffer_load_dwordx4 v[104:107], v41, s[8:11], 0 offen
L_g2_24:
L_g_22_b:
    s_waitcnt vmcnt(0)
    v_and_b32 v50, 0xffff, v22
    v_lshlrev_b32 v51, 16, v22
    v_lshrrev_b32 v52, 16, v22
    v_and_b32 v53, 0xffff0000, v22
    v_dot2_f32_bf16 v60, v76, v50, 0
    v_dot2_f32_bf16 v61, v76, v51, 0
    v_dot2_f32_bf16 v62, v77, v50, 0
    v_dot2_f32_bf16 v63, v77, v51, 0
    v_dot2_f32_bf16 v64, v78, v50, 0
    v_dot2_f32_bf16 v65, v78, v51, 0
    v_dot2_f32_bf16 v66, v79, v50, 0
    v_dot2_f32_bf16 v67, v79, v51, 0
    v_dot2c_f32_bf16 v60, v80, v52
    v_dot2c_f32_bf16 v61, v80, v53
    v_dot2c_f32_bf16 v62, v81, v52
    v_dot2c_f32_bf16 v63, v81, v53
    v_dot2c_f32_bf16 v64, v82, v52
    v_dot2c_f32_bf16 v65, v82, v53
    v_dot2c_f32_bf16 v66, v83, v52
    v_dot2c_f32_bf16 v67, v83, v53
    s_cmp_eq_u32 s52, 0
    s_cbranch_scc1 L_g4_25
    v_and_b32 v50, 0xffff, v26
    v_lshlrev_b32 v51, 16, v26
    v_lshrrev_b32 v52, 16, v26
    v_and_b32 v53, 0xffff0000, v26
    v_dot2_f32_bf16 v60, v84, v50, v60
    v_dot2_f32_bf16 v61, v84, v51, v61
    v_dot2_f32_bf16 v62, v85, v50, v62
    v_dot2_f32_bf16 v63, v85, v51, v63
    v_dot2_f32_bf16 v64, v86, v50, v64
    v_dot2_f32_bf16 v65, v86, v51, v65
    v_dot2_f32_bf16 v66, v87, v50, v66
    v_dot2_f32_bf16 v67, v87, v51, v67
    v_dot2c_f32_bf16 v60, v88, v52
    v_dot2c_f32_bf16 v61, v88, v53
    v_dot2c_f32_bf16 v62, v89, v52
    v_dot2c_f32_bf16 v63, v89, v53
    v_dot2c_f32_bf16 v64, v90, v52
    v_dot2c_f32_bf16 v65, v90, v53
    v_dot2c_f32_bf16 v66, v91, v52
    v_dot2c_f32_bf16 v67, v91, v53
L_g4_25:
    v_and_b32 v23, 0x7fffffff, v23
    v_add_u32 v23, v23, v75
    s_nop 0
    v_cvt_pk_bf16_f32 v68, v60, v61
    v_cvt_pk_bf16_f32 v69, v62, v63
    v_cvt_pk_bf16_f32 v70, v64, v65
    v_cvt_pk_bf16_f32 v71, v66, v67
    ds_write_b128 v23, v[68:71]
    s_add_u32 s32, s36, 5
    s_cmp_ge_u32 s32, s42
    s_cbranch_scc1 L_g_22_c
    v_and_b32 v50, 0xffff, v38
    v_lshlrev_b32 v51, 16, v38
    v_lshrrev_b32 v52, 16, v38
    v_and_b32 v53, 0xffff0000, v38
    v_dot2_f32_bf16 v60, v92, v50, 0
    v_dot2_f32_bf16 v61, v92, v51, 0
    v_dot2_f32_bf16 v62, v93, v50, 0
    v_dot2_f32_bf16 v63, v93, v51, 0
    v_dot2_f32_bf16 v64, v94, v50, 0
    v_dot2_f32_bf16 v65, v94, v51, 0
    v_dot2_f32_bf16 v66, v95, v50, 0
    v_dot2_f32_bf16 v67, v95, v51, 0
    v_dot2c_f32_bf16 v60, v96, v52
    v_dot2c_f32_bf16 v61, v96, v53
    v_dot2c_f32_bf16 v62, v97, v52
    v_dot2c_f32_bf16 v63, v97, v53
    v_dot2c_f32_bf16 v64, v98, v52
    v_dot2c_f32_bf16 v65, v98, v53
    v_dot2c_f32_bf16 v66, v99, v52
    v_dot2c_f32_bf16 v67, v99, v53
    s_cmp_eq_u32 s53, 0
    s_cbranch_scc1 L_g4_26
    v_and_b32 v50, 0xffff, v42
    v_lshlrev_b32 v51, 16, v42
    v_lshrrev_b32 v52, 16, v42
    v_and_b32 v53, 0xffff0000, v42
    v_dot2_f32_bf16 v60, v100, v50, v60
    v_dot2_f32_bf16 v61, v100, v51, v61
    v_dot2_f32_bf16 v62, v101, v50, v62
    v_dot2_f32_bf16 v63, v101, v51, v63
    v_dot2_f32_bf16 v64, v102, v50, v64
    v_dot2_f32_bf16 v65, v102, v51, v65
    v_dot2_f32_bf16 v66, v103, v50, v66
    v_dot2_f32_bf16 v67, v103, v51, v67
    v_dot2c_f32_bf16 v60, v104, v52
    v_dot2c_f32_bf16 v61, v104, v53
    v_dot2c_f32_bf16 v62, v105, v52
    v_dot2c_f32_bf16 v63, v105, v53
    v_dot2c_f32_bf16 v64, v106, v52
    v_dot2c_f32_bf16 v65, v106, v53
    v_dot2c_f32_bf16 v66, v107, v52
    v_dot2c_f32_bf16 v67, v107, v53
L_g4_26:
    v_and_b32 v39, 0x7fffffff, v39
    v_add_u32 v39, v39, v75
    s_nop 0
    v_cvt_pk_bf16_f32 v68, v60, v61
    v_cvt_pk_bf16_f32 v69, v62, v63
    v_cvt_pk_bf16_f32 v70, v64, v65
    v_cvt_pk_bf16_f32 v71, v66, v67
    ds_write_b128 v39, v[68:71]
L_g_22_c:
    s_add_u32 s36, s36, 10
    s_branch L_gt_20
L_gd_21:
L_out_done:
    s_waitcnt lgkmcnt(0)
    s_barrier
L_main:
    ds_read_b128 v[140:143], v72
    ds_read_b128 v[144:147], v72 offset:16
    ds_read_b64 v[148:149], v72 offset:32
    s_sub_u32 s39, s83, 3
    s_waitcnt lgkmcnt(0)
    v_xor_b32 v128, v140, v4
    v_xor_b32 v129, v141, v4
    v_xor_b32 v130, v142, v4
    v_xor_b32 v131, v143, v4
    v_xor_b32 v132, v144, v4
    v_xor_b32 v133, v145, v4
    v_xor_b32 v134, v146, v4
    v_xor_b32 v135, v147, v4
    v_xor_b32 v136, v148, v4
    v_mov_b32 v150, v149
    ds_read_b128 v[112:115], v128
    ds_read_b128 v[116:119], v128 offset:64
    s_waitcnt lgkmcnt(1)
    v_mfma_f32_16x16x32_bf16 v[76:79], a[0:3], v[112:115], 0
    ds_read_b128 v[120:123], v128 offset:128
    v_mfma_f32_16x16x32_bf16 v[80:83], a[4:7], v[112:115], 0
    ds_read_b128 v[140:143], v72 offset:768
    v_mfma_f32_16x16x32_bf16 v[84:87], a[8:11], v[112:115], 0
    s_waitcnt lgkmcnt(2)
    v_mfma_f32_16x16x32_bf16 v[76:79], a[12:15], v[116:119], v[76:79]
    ds_read_b128 v[124:127], v129 offset:0
    v_mfma_f32_16x16x32_bf16 v[80:83], a[16:19], v[116:119], v[80:83]
    ds_read_b128 v[144:147], v72 offset:784
    v_mfma_f32_16x16x32_bf16 v[84:87], a[20:23], v[116:119], v[84:87]
    s_waitcnt lgkmcnt(3)
    v_mfma_f32_16x16x32_bf16 v[76:79], a[24:27], v[120:123], v[76:79]
    ds_read_b128 v[112:115], v129 offset:64
    v_mfma_f32_16x16x32_bf16 v[80:83], a[28:31], v[120:123], v[80:83]
    ds_read_b64 v[148:149], v72 offset:800
    v_mfma_f32_16x16x32_bf16 v[84:87], a[32:35], v[120:123], v[84:87]
    s_waitcnt lgkmcnt(3)
    v_mfma_f32_16x16x32_bf16 v[76:79], a[36:39], v[124:127], v[76:79]
    ds_read_b128 v[116:119], v129 offset:128
    v_mfma_f32_16x16x32_bf16 v[80:83], a[40:43], v[124:127], v[80:83]
    v_add_u32 v72, 768, v72
    v_mfma_f32_16x16x32_bf16 v[84:87], a[44:47], v[124:127], v[84:87]
    s_waitcnt lgkmcnt(2)
    v_mfma_f32_16x16x32_bf16 v[76:79], a[48:51], v[112:115], v[76:79]
    ds_read_b128 v[120:123], v130 offset:0
    v_add_u32 v178, v181, v58
    v_mfma_f32_16x16x32_bf16 v[80:83], a[52:55], v[112:115], v[80:83]
    v_xor_b32 v128, v140, v4
    v_mfma_f32_16x16x32_bf16 v[84:87], a[56:59], v[112:115], v[84:87]
    v_add_u32 v179, v181, v59
    s_waitcnt lgkmcnt(1)
    v_mfma_f32_16x16x32_bf16 v[76:79], a[60:63], v[116:119], v[76:79]
    ds_read_b128 v[124:127], v130 offset:64
    v_mfma_f32_16x16x32_bf16 v[80:83], a[64:67], v[116:119], v[80:83]
    buffer_store_dwordx2 v[164:165], v179, s[20:23], 0 offen sc1
    v_mfma_f32_16x16x32_bf16 v[84:87], a[68:71], v[116:119], v[84:87]
    s_waitcnt lgkmcnt(1)
    v_mfma_f32_16x16x32_bf16 v[76:79], a[72:75], v[120:123], v[76:79]
    ds_read_b128 v[112:115], v130 offset:128
    v_mfma_f32_16x16x32_bf16 v[80:83], a[76:79], v[120:123], v[80:83]
    v_mfma_f32_16x16x32_bf16 v[84:87], a[80:83], v[120:123], v[84:87]
    s_waitcnt lgkmcnt(1)
    v_mfma_f32_16x16x32_bf16 v[76:79], a[84:87], v[124:127], v[76:79]
    ds_read_b128 v[116:119], v131 offset:0
    v_mfma_f32_16x16x32_bf16 v[80:83], a[88:91], v[124:127], v[80:83]
    v_xor_b32 v129, v141, v4
    v_mfma_f32_16x16x32_bf16 v[84:87], a[92:95], v[124:127], v[84:87]
    s_waitcnt lgkmcnt(1)
    v_mfma_f32_16x16x32_bf16 v[76:79], a[96:99], v[112:115], v[76:79]
    ds_read_b128 v[120:123], v131 offset:64
    v_mov_b32 v180, v150
    v_mfma_f32_16x16x32_bf16 v[80:83], a[100:103], v[112:115], v[80:83]
    buffer_store_dwordx4 v[160:163], v178, s[20:23], 0 offen sc1
    v_mov_b32 v150, v149
    v_mfma_f32_16x16x32_bf16 v[84:87], a[104:107], v[112:115], v[84:87]
    s_waitcnt lgkmcnt(1)
    v_mfma_f32_16x16x32_bf16 v[76:79], a[108:111], v[116:119], v[76:79]
    ds_read_b128 v[124:127], v131 offset:128
    v_mfma_f32_16x16x32_bf16 v[80:83], a[112:115], v[116:119], v[80:83]
    v_mfma_f32_16x16x32_bf16 v[84:87], a[116:119], v[116:119], v[84:87]
    s_waitcnt lgkmcnt(1)
    v_mfma_f32_16x16x32_bf16 v[76:79], a[120:123], v[120:123], v[76:79]
    ds_read_b128 v[112:115], v132 offset:0
    v_mfma_f32_16x16x32_bf16 v[80:83], a[124:127], v[120:123], v[80:83]
    v_xor_b32 v130, v142, v4
    v_mfma_f32_16x16x32_bf16 v[84:87], a[128:131], v[120:123], v[84:87]
    s_waitcnt lgkmcnt(1)
    v_mfma_f32_16x16x32_bf16 v[76:79], a[132:135], v[124:127], v[76:79]
    ds_read_b128 v[116:119], v132 offset:64
    v_add_u32 v178, v182, v58
    v_mfma_f32_16x16x32_bf16 v[80:83], a[136:139], v[124:127], v[80:83]
    v_mfma_f32_16x16x32_bf16 v[84:87], a[140:143], v[124:127], v[84:87]
    v_add_u32 v179, v182, v59
    s_waitcnt lgkmcnt(1)
    v_mfma_f32_16x16x32_bf16 v[76:79], a[144:147], v[112:115], v[76:79]
    ds_read_b128 v[120:123], v132 offset:128
    v_mfma_f32_16x16x32_bf16 v[80:83], a[148:151], v[112:115], v[80:83]
    buffer_store_dwordx2 v[170:171], v179, s[20:23], 0 offen sc1
    v_mfma_f32_16x16x32_bf16 v[84:87], a[152:155], v[112:115], v[84:87]
    s_waitcnt lgkmcnt(1)
    v_mfma_f32_16x16x32_bf16 v[76:79], a[156:159], v[116:119], v[76:79]
    ds_read_b128 v[124:127], v133 offset:0
    v_mfma_f32_16x16x32_bf16 v[80:83], a[160:163], v[116:119], v[80:83]
    v_xor_b32 v131, v143, v4
    v_mfma_f32_16x16x32_bf16 v[84:87], a[164:167], v[116:119], v[84:87]
    s_waitcnt lgkmcnt(1)
    v_mfma_f32_16x16x32_bf16 v[76:79], a[168:171], v[120:123], v[76:79]
    ds_read_b128 v[112:115], v133 offset:64
    v_mfma_f32_16x16x32_bf16 v[80:83], a[172:175], v[120:123], v[80:83]
    v_mfma_f32_16x16x32_bf16 v[84:87], a[176:179], v[120:123], v[84:87]
    s_waitcnt lgkmcnt(1)
    v_mfma_f32_16x16x32_bf16 v[76:79], a[180:183], v[124:127], v[76:79]
    ds_read_b128 v[116:119], v133 offset:128
    v_mfma_f32_16x16x32_bf16 v[80:83], a[184:187], v[124:127], v[80:83]
    buffer_store_dwordx4 v[166:169], v178, s[20:23], 0 offen sc1
    v_mfma_f32_16x16x32_bf16 v[84:87], a[188:191], v[124:127], v[84:87]
    s_waitcnt lgkmcnt(1)
    v_mfma_f32_16x16x32_bf16 v[76:79], a[192:195], v[112:115], v[76:79]
    ds_read_b128 v[120:123], v134 offset:0
    v_mfma_f32_16x16x32_bf16 v[80:83], a[196:199], v[112:115], v[80:83]
    v_xor_b32 v132, v144, v4
    v_mfma_f32_16x16x32_bf16 v[84:87], a[200:203], v[112:115], v[84:87]
    s_waitcnt lgkmcnt(1)
    v_mfma_f32_16x16x32_bf16 v[76:79], a[204:207], v[116:119], v[76:79]
    ds_read_b128 v[124:127], v134 offset:64
    v_mfma_f32_16x16x32_bf16 v[80:83], a[208:211], v[116:119], v[80:83]
    v_mfma_f32_16x16x32_bf16 v[84:87], a[212:215], v[116:119], v[84:87]
    s_waitcnt lgkmcnt(1)
    v_mfma_f32_16x16x32_bf16 v[76:79], a[216:219], v[120:123], v[76:79]
    ds_read_b128 v[112:115], v134 offset:128
    v_add_u32 v178, v183, v58
    v_mfma_f32_16x16x32_bf16 v[80:83], a[220:223], v[120:123], v[80:83]
    v_mfma_f32_16x16x32_bf16 v[84:87], a[224:227], v[120:123], v[84:87]
    v_add_u32 v179, v183, v59
    s_waitcnt lgkmcnt(1)
    v_mfma_f32_16x16x32_bf16 v[76:79], a[228:231], v[124:127], v[76:79]
    ds_read_b128 v[116:119], v135 offset:0
    v_mfma_f32_16x16x32_bf16 v[80:83], a[232:235], v[124:127], v[80:83]
    buffer_store_dwordx2 v[176:177], v179, s[20:23], 0 offen sc1
    v_xor_b32 v133, v145, v4
    v_mfma_f32_16x16x32_bf16 v[84:87], a[236:239], v[124:127], v[84:87]
    s_waitcnt lgkmcnt(1)
    v_mfma_f32_16x16x32_bf16 v[76:79], a[240:243], v[112:115], v[76:79]
    ds_read_b128 v[120:123], v135 offset:64
    v_mfma_f32_16x16x32_bf16 v[80:83], a[244:247], v[112:115], v[80:83]
    v_mfma_f32_16x16x32_bf16 v[84:87], a[248:251], v[112:115], v[84:87]
    s_waitcnt lgkmcnt(1)
    v_mfma_f32_16x16x32_bf16 v[76:79], a[252:255], v[116:119], v[76:79]
    ds_read_b128 v[124:127], v135 offset:128
    v_mfma_f32_16x16x32_bf16 v[80:83], v[188:191], v[116:119], v[80:83]
    v_mfma_f32_16x16x32_bf16 v[84:87], v[192:195], v[116:119], v[84:87]
    s_waitcnt lgkmcnt(1)
    v_mfma_f32_16x16x32_bf16 v[76:79], v[196:199], v[120:123], v[76:79]
    ds_read_b128 v[112:115], v136 offset:0
    v_mfma_f32_16x16x32_bf16 v[80:83], v[200:203], v[120:123], v[80:83]
    buffer_store_dwordx4 v[172:175], v178, s[20:23], 0 offen sc1
    v_xor_b32 v134, v146, v4
    v_mfma_f32_16x16x32_bf16 v[84:87], v[204:207], v[120:123], v[84:87]
    s_waitcnt lgkmcnt(1)
    v_mfma_f32_16x16x32_bf16 v[76:79], v[208:211], v[124:127], v[76:79]
    ds_read_b128 v[116:119], v136 offset:64
    v_mfma_f32_16x16x32_bf16 v[80:83], v[212:215], v[124:127], v[80:83]
    v_mfma_f32_16x16x32_bf16 v[84:87], v[216:219], v[124:127], v[84:87]
    s_waitcnt lgkmcnt(1)
    v_mfma_f32_16x16x32_bf16 v[76:79], v[220:223], v[112:115], v[76:79]
    ds_read_b128 v[120:123], v136 offset:128
    v_mfma_f32_16x16x32_bf16 v[80:83], v[224:227], v[112:115], v[80:83]
    v_mfma_f32_16x16x32_bf16 v[84:87], v[228:231], v[112:115], v[84:87]
    s_waitcnt lgkmcnt(1)
    v_mfma_f32_16x16x32_bf16 v[76:79], v[232:235], v[116:119], v[76:79]
    ds_read_b128 v[124:127], v128 offset:0
    v_mfma_f32_16x16x32_bf16 v[80:83], v[236:239], v[116:119], v[80:83]
    v_xor_b32 v135, v147, v4
    v_mfma_f32_16x16x32_bf16 v[84:87], v[240:243], v[116:119], v[84:87]
    s_waitcnt lgkmcnt(1)
    v_mfma_f32_16x16x32_bf16 v[76:79], v[244:247], v[120:123], v[76:79]
    ds_read_b128 v[112:115], v128 offset:64
    v_mfma_f32_16x16x32_bf16 v[80:83], v[248:251], v[120:123], v[80:83]
    v_xor_b32 v136, v148, v4
    v_mfma_f32_16x16x32_bf16 v[84:87], v[252:255], v[120:123], v[84:87]
    s_waitcnt lgkmcnt(1)
    s_sub_u32 s39, s39, 1
    s_cmp_eq_u32 s39, 0
    s_cbranch_scc1 L_fin0
    v_mfma_f32_16x16x32_bf16 v[88:91], a[0:3], v[124:127], 0
    ds_read_b128 v[116:119], v128 offset:128
    v_mfma_f32_16x16x32_bf16 v[92:95], a[4:7], v[124:127], 0
    ds_read_b128 v[140:143], v72 offset:768
    v_mfma_f32_16x16x32_bf16 v[96:99], a[8:11], v[124:127], 0
    s_waitcnt lgkmcnt(2)
    v_mfma_f32_16x16x32_bf16 v[88:91], a[12:15], v[112:115], v[88:91]
    ds_read_b128 v[120:123], v129 offset:0
    v_cvt_pk_bf16_f32 v172, v76, v77
    v_mfma_f32_16x16x32_bf16 v[92:95], a[16:19], v[112:115], v[92:95]
    ds_read_b128 v[144:147], v72 offset:784
    v_mfma_f32_16x16x32_bf16 v[96:99], a[20:23], v[112:115], v[96:99]
    v_cvt_pk_bf16_f32 v173, v78, v79
    s_waitcnt lgkmcnt(3)
    v_mfma_f32_16x16x32_bf16 v[88:91], a[24:27], v[116:119], v[88:91]
    ds_read_b128 v[124:127], v129 offset:64
    v_cvt_pk_bf16_f32 v174, v80, v81
    v_mfma_f32_16x16x32_bf16 v[92:95], a[28:31], v[116:119], v[92:95]
    ds_read_b64 v[148:149], v72 offset:800
    v_mfma_f32_16x16x32_bf16 v[96:99], a[32:35], v[116:119], v[96:99]
    v_cvt_pk_bf16_f32 v175, v82, v83
    s_waitcnt lgkmcnt(3)
    v_mfma_f32_16x16x32_bf16 v[88:91], a[36:39], v[120:123], v[88:91]
    ds_read_b128 v[112:115], v129 offset:128
    v_cvt_pk_bf16_f32 v176, v84, v85
    v_mfma_f32_16x16x32_bf16 v[92:95], a[40:43], v[120:123], v[92:95]
    v_add_u32 v72, 768, v72
    v_mfma_f32_16x16x32_bf16 v[96:99], a[44:47], v[120:123], v[96:99]
    v_cvt_pk_bf16_f32 v177, v86, v87
    s_waitcnt lgkmcnt(2)
    v_mfma_f32_16x16x32_bf16 v[88:91], a[48:51], v[124:127], v[88:91]
    ds_read_b128 v[116:119], v130 offset:0
    v_add_u32 v178, v180, v58
    v_mfma_f32_16x16x32_bf16 v[92:95], a[52:55], v[124:127], v[92:95]
    v_add_u32 v179, v180, v59
    v_xor_b32 v128, v140, v4
    v_mfma_f32_16x16x32_bf16 v[96:99], a[56:59], v[124:127], v[96:99]
    s_waitcnt lgkmcnt(1)
    v_mfma_f32_16x16x32_bf16 v[88:91], a[60:63], v[112:115], v[88:91]
    ds_read_b128 v[120:123], v130 offset:64
    v_permlane16_swap_b32 v172, v174
    v_mfma_f32_16x16x32_bf16 v[92:95], a[64:67], v[112:115], v[92:95]
    v_permlane16_swap_b32 v173, v175
    v_mfma_f32_16x16x32_bf16 v[96:99], a[68:71], v[112:115], v[96:99]
    s_waitcnt lgkmcnt(1)
    v_mfma_f32_16x16x32_bf16 v[88:91], a[72:75], v[116:119], v[88:91]
    ds_read_b128 v[124:127], v130 offset:128
    v_mfma_f32_16x16x32_bf16 v[92:95], a[76:79], v[116:119], v[92:95]
    buffer_store_dwordx2 v[176:177], v179, s[20:23], 0 offen sc1
    v_mfma_f32_16x16x32_bf16 v[96:99], a[80:83], v[116:119], v[96:99]
    s_waitcnt lgkmcnt(1)
    v_mfma_f32_16x16x32_bf16 v[88:91], a[84:87], v[120:123], v[88:91]
    ds_read_b128 v[112:115], v131 offset:0
    v_mfma_f32_16x16x32_bf16 v[92:95], a[88:91], v[120:123], v[92:95]
    buffer_store_dwordx4 v[172:175], v178, s[20:23], 0 offen sc1
    v_xor_b32 v129, v141, v4
    v_mfma_f32_16x16x32_bf16 v[96:99], a[92:95], v[120:123], v[96:99]
    s_waitcnt lgkmcnt(1)
    v_mfma_f32_16x16x32_bf16 v[88:91], a[96:99], v[124:127], v[88:91]
    ds_read_b128 v[116:119], v131 offset:64
    v_mov_b32 v180, v150
    v_mfma_f32_16x16x32_bf16 v[92:95], a[100:103], v[124:127], v[92:95]
    v_mov_b32 v150, v149
    v_mfma_f32_16x16x32_bf16 v[96:99], a[104:107], v[124:127], v[96:99]
    s_waitcnt lgkmcnt(1)
    v_mfma_f32_16x16x32_bf16 v[88:91], a[108:111], v[112:115], v[88:91]
    ds_read_b128 v[120:123], v131 offset:128
    v_mfma_f32_16x16x32_bf16 v[92:95], a[112:115], v[112:115], v[92:95]
    v_mfma_f32_16x16x32_bf16 v[96:99], a[116:119], v[112:115], v[96:99]
    s_waitcnt lgkmcnt(1)
    v_mfma_f32_16x16x32_bf16 v[88:91], a[120:123], v[116:119], v[88:91]
    ds_read_b128 v[124:127], v132 offset:0
    v_mfma_f32_16x16x32_bf16 v[92:95], a[124:127], v[116:119], v[92:95]
    v_xor_b32 v130, v142, v4
    v_mfma_f32_16x16x32_bf16 v[96:99], a[128:131], v[116:119], v[96:99]
    s_waitcnt lgkmcnt(1)
    v_mfma_f32_16x16x32_bf16 v[88:91], a[132:135], v[120:123], v[88:91]
    ds_read_b128 v[112:115], v132 offset:64
    v_mfma_f32_16x16x32_bf16 v[92:95], a[136:139], v[120:123], v[92:95]
    v_mfma_f32_16x16x32_bf16 v[96:99], a[140:143], v[120:123], v[96:99]
    s_waitcnt lgkmcnt(1)
    v_mfma_f32_16x16x32_bf16 v[88:91], a[144:147], v[124:127], v[88:91]
    ds_read_b128 v[116:119], v132 offset:128
    v_mfma_f32_16x16x32_bf16 v[92:95], a[148:151], v[124:127], v[92:95]
    v_mfma_f32_16x16x32_bf16 v[96:99], a[152:155], v[124:127], v[96:99]
    s_waitcnt lgkmcnt(1)
    v_mfma_f32_16x16x32_bf16 v[88:91], a[156:159], v[112:115], v[88:91]
    ds_read_b128 v[120:123], v133 offset:0
    v_mfma_f32_16x16x32_bf16 v[92:95], a[160:163], v[112:115], v[92:95]
    v_xor_b32 v131, v143, v4
    v_mfma_f32_16x16x32_bf16 v[96:99], a[164:167], v[112:115], v[96:99]
    s_waitcnt lgkmcnt(1)
    v_mfma_f32_16x16x32_bf16 v[88:91], a[168:171], v[116:119], v[88:91]
    ds_read_b128 v[124:127], v133 offset:64
    v_mfma_f32_16x16x32_bf16 v[92:95], a[172:175], v[116:119], v[92:95]
    v_mfma_f32_16x16x32_bf16 v[96:99], a[176:179], v[116:119], v[96:99]
    s_waitcnt lgkmcnt(1)
    v_mfma_f32_16x16x32_bf16 v[88:91], a[180:183], v[120:123], v[88:91]
    ds_read_b128 v[112:115], v133 offset:128
    v_mfma_f32_16x16x32_bf16 v[92:95], a[184:187], v[120:123], v[92:95]
    v_mfma_f32_16x16x32_bf16 v[96:99], a[188:191], v[120:123], v[96:99]
    s_waitcnt lgkmcnt(1)
    v_mfma_f32_16x16x32_bf16 v[88:91], a[192:195], v[124:127], v[88:91]
    ds_read_b128 v[116:119], v134 offset:0
    v_mfma_f32_16x16x32_bf16 v[92:95], a[196:199], v[124:127], v[92:95]
    v_xor_b32 v132, v144, v4
    v_mfma_f32_16x16x32_bf16 v[96:99], a[200:203], v[124:127], v[96:99]
    s_waitcnt lgkmcnt(1)
    v_mfma_f32_16x16x32_bf16 v[88:91], a[204:207], v[112:115], v[88:91]
    ds_read_b128 v[120:123], v134 offset:64
    v_mfma_f32_16x16x32_bf16 v[92:95], a[208:211], v[112:115], v[92:95]
    v_mfma_f32_16x16x32_bf16 v[96:99], a[212:215], v[112:115], v[96:99]
    s_waitcnt lgkmcnt(1)
    v_mfma_f32_16x16x32_bf16 v[88:91], a[216:219], v[116:119], v[88:91]
    ds_read_b128 v[124:127], v134 offset:128
    v_mfma_f32_16x16x32_bf16 v[92:95], a[220:223], v[116:119], v[92:95]
    v_mfma_f32_16x16x32_bf16 v[96:99], a[224:227], v[116:119], v[96:99]
    s_waitcnt lgkmcnt(1)
    v_mfma_f32_16x16x32_bf16 v[88:91], a[228:231], v[120:123], v[88:91]
    ds_read_b128 v[112:115], v135 offset:0
    v_mfma_f32_16x16x32_bf16 v[92:95], a[232:235], v[120:123], v[92:95]
    v_xor_b32 v133, v145, v4
    v_mfma_f32_16x16x32_bf16 v[96:99], a[236:239], v[120:123], v[96:99]
    s_waitcnt lgkmcnt(1)
    v_mfma_f32_16x16x32_bf16 v[88:91], a[240:243], v[124:127], v[88:91]
    ds_read_b128 v[116:119], v135 offset:64
    v_mfma_f32_16x16x32_bf16 v[92:95], a[244:247], v[124:127], v[92:95]
    v_mfma_f32_16x16x32_bf16 v[96:99], a[248:251], v[124:127], v[96:99]
    s_waitcnt lgkmcnt(1)
    v_mfma_f32_16x16x32_bf16 v[88:91], a[252:255], v[112:115], v[88:91]
    ds_read_b128 v[120:123], v135 offset:128
    v_mfma_f32_16x16x32_bf16 v[92:95], v[188:191], v[112:115], v[92:95]
    v_mfma_f32_16x16x32_bf16 v[96:99], v[192:195], v[112:115], v[96:99]
    s_waitcnt lgkmcnt(1)
    v_mfma_f32_16x16x32_bf16 v[88:91], v[196:199], v[116:119], v[88:91]
    ds_read_b128 v[124:127], v136 offset:0
    v_mfma_f32_16x16x32_bf16 v[92:95], v[200:203], v[116:119], v[92:95]
    v_xor_b32 v134, v146, v4
    v_mfma_f32_16x16x32_bf16 v[96:99], v[204:207], v[116:119], v[96:99]
    s_waitcnt lgkmcnt(1)
    v_mfma_f32_16x16x32_bf16 v[88:91], v[208:211], v[120:123], v[88:91]
    ds_read_b128 v[112:115], v136 offset:64
    v_mfma_f32_16x16x32_bf16 v[92:95], v[212:215], v[120:123], v[92:95]
    v_mfma_f32_16x16x32_bf16 v[96:99], v[216:219], v[120:123], v[96:99]
    s_waitcnt lgkmcnt(1)
    v_mfma_f32_16x16x32_bf16 v[88:91], v[220:223], v[124:127], v[88:91]
    ds_read_b128 v[116:119], v136 offset:128
    v_mfma_f32_16x16x32_bf16 v[92:95], v[224:227], v[124:127], v[92:95]
    v_mfma_f32_16x16x32_bf16 v[96:99], v[228:231], v[124:127], v[96:99]
    s_waitcnt lgkmcnt(1)
    v_mfma_f32_16x16x32_bf16 v[88:91], v[232:235], v[112:115], v[88:91]
    ds_read_b128 v[120:123], v128 offset:0
    v_mfma_f32_16x16x32_bf16 v[92:95], v[236:239], v[112:115], v[92:95]
    v_xor_b32 v135, v147, v4
    v_mfma_f32_16x16x32_bf16 v[96:99], v[240:243], v[112:115], v[96:99]
    s_waitcnt lgkmcnt(1)
    v_mfma_f32_16x16x32_bf16 v[88:91], v[244:247], v[116:119], v[88:91]
    ds_read_b128 v[124:127], v128 offset:64
    v_mfma_f32_16x16x32_bf16 v[92:95], v[248:251], v[116:119], v[92:95]
    v_xor_b32 v136, v148, v4
    v_mfma_f32_16x16x32_bf16 v[96:99], v[252:255], v[116:119], v[96:99]
    s_waitcnt lgkmcnt(1)
    s_sub_u32 s39, s39, 1
    s_cmp_eq_u32 s39, 0
    s_cbranch_scc1 L_fin1
    v_mfma_f32_16x16x32_bf16 v[76:79], a[0:3], v[120:123], 0
    ds_read_b128 v[112:115], v128 offset:128
    v_mfma_f32_16x16x32_bf16 v[80:83], a[4:7], v[120:123], 0
    ds_read_b128 v[140:143], v72 offset:768
    v_mfma_f32_16x16x32_bf16 v[84:87], a[8:11], v[120:123], 0
    s_waitcnt lgkmcnt(2)
    v_mfma_f32_16x16x32_bf16 v[76:79], a[12:15], v[124:127], v[76:79]
    ds_read_b128 v[116:119], v129 offset:0
    v_cvt_pk_bf16_f32 v172, v88, v89
    v_mfma_f32_16x16x32_bf16 v[80:83], a[16:19], v[124:127], v[80:83]
    ds_read_b128 v[144:147], v72 offset:784
    v_mfma_f32_16x16x32_bf16 v[84:87], a[20:23], v[124:127], v[84:87]
    v_cvt_pk_bf16_f32 v173, v90, v91
    s_waitcnt lgkmcnt(3)
    v_mfma_f32_16x16x32_bf16 v[76:79], a[24:27], v[112:115], v[76:79]
    ds_read_b128 v[120:123], v129 offset:64
    v_cvt_pk_bf16_f32 v174, v92, v93
    v_mfma_f32_16x16x32_bf16 v[80:83], a[28:31], v[112:115], v[80:83]
    ds_read_b64 v[148:149], v72 offset:800
    v_mfma_f32_16x16x32_bf16 v[84:87], a[32:35], v[112:115], v[84:87]
    v_cvt_pk_bf16_f32 v175, v94, v95
    s_waitcnt lgkmcnt(3)
    v_mfma_f32_16x16x32_bf16 v[76:79], a[36:39], v[116:119], v[76:79]
    ds_read_b128 v[124:127], v129 offset:128
    v_cvt_pk_bf16_f32 v176, v96, v97
    v_mfma_f32_16x16x32_bf16 v[80:83], a[40:43], v[116:119], v[80:83]
    v_add_u32 v72, 768, v72
    v_mfma_f32_16x16x32_bf16 v[84:87], a[44:47], v[116:119], v[84:87]
    v_cvt_pk_bf16_f32 v177, v98, v99
    s_waitcnt lgkmcnt(2)
    v_mfma_f32_16x16x32_bf16 v[76:79], a[48:51], v[120:123], v[76:79]
    ds_read_b128 v[112:115], v130 offset:0
    v_add_u32 v178, v180, v58
    v_mfma_f32_16x16x32_bf16 v[80:83], a[52:55], v[120:123], v[80:83]
    v_add_u32 v179, v180, v59
    v_xor_b32 v128, v140, v4
    v_mfma_f32_16x16x32_bf16 v[84:87], a[56:59], v[120:123], v[84:87]
    s_waitcnt lgkmcnt(1)
    v_mfma_f32_16x16x32_bf16 v[76:79], a[60:63], v[124:127], v[76:79]
    ds_read_b128 v[116:119], v130 offset:64
    v_permlane16_swap_b32 v172, v174
    v_mfma_f32_16x16x32_bf16 v[80:83], a[64:67], v[124:127], v[80:83]
    v_permlane16_swap_b32 v173, v175
    v_mfma_f32_16x16x32_bf16 v[84:87], a[68:71], v[124:127], v[84:87]
    s_waitcnt lgkmcnt(1)
    v_mfma_f32_16x16x32_bf16 v[76:79], a[72:75], v[112:115], v[76:79]
    ds_read_b128 v[120:123], v130 offset:128
    v_mfma_f32_16x16x32_bf16 v[80:83], a[76:79], v[112:115], v[80:83]
    buffer_store_dwordx2 v[176:177], v179, s[20:23], 0 offen sc1
    v_mfma_f32_16x16x32_bf16 v[84:87], a[80:83], v[112:115], v[84:87]
    s_waitcnt lgkmcnt(1)
    v_mfma_f32_16x16x32_bf16 v[76:79], a[84:87], v[116:119], v[76:79]
    ds_read_b128 v[124:127], v131 offset:0
    v_mfma_f32_16x16x32_bf16 v[80:83], a[88:91], v[116:119], v[80:83]
    buffer_store_dwordx4 v[172:175], v178, s[20:23], 0 offen sc1
    v_xor_b32 v129, v141, v4
    v_mfma_f32_16x16x32_bf16 v[84:87], a[92:95], v[116:119], v[84:87]
    s_waitcnt lgkmcnt(1)
    v_mfma_f32_16x16x32_bf16 v[76:79], a[96:99], v[120:123], v[76:79]
    ds_read_b128 v[112:115], v131 offset:64
    v_mov_b32 v180, v150
    v_mfma_f32_16x16x32_bf16 v[80:83], a[100:103], v[120:123], v[80:83]
    v_mov_b32 v150, v149
    v_mfma_f32_16x16x32_bf16 v[84:87], a[104:107], v[120:123], v[84:87]
    s_waitcnt lgkmcnt(1)
    v_mfma_f32_16x16x32_bf16 v[76:79], a[108:111], v[124:127], v[76:79]
    ds_read_b128 v[116:119], v131 offset:128
    v_mfma_f32_16x16x32_bf16 v[80:83], a[112:115], v[124:127], v[80:83]
    v_mfma_f32_16x16x32_bf16 v[84:87], a[116:119], v[124:127], v[84:87]
    s_waitcnt lgkmcnt(1)
    v_mfma_f32_16x16x32_bf16 v[76:79], a[120:123], v[112:115], v[76:79]
    ds_read_b128 v[120:123], v132 offset:0
    v_mfma_f32_16x16x32_bf16 v[80:83], a[124:127], v[112:115], v[80:83]
    v_xor_b32 v130, v142, v4
    v_mfma_f32_16x16x32_bf16 v[84:87], a[128:131], v[112:115], v[84:87]
    s_waitcnt lgkmcnt(1)
    v_mfma_f32_16x16x32_bf16 v[76:79], a[132:135], v[116:119], v[76:79]
    ds_read_b128 v[124:127], v132 offset:64
    v_mfma_f32_16x16x32_bf16 v[80:83], a[136:139], v[116:119], v[80:83]
    v_mfma_f32_16x16x32_bf16 v[84:87], a[140:143], v[116:119], v[84:87]
    s_waitcnt lgkmcnt(1)
    v_mfma_f32_16x16x32_bf16 v[76:79], a[144:147], v[120:123], v[76:79]
    ds_read_b128 v[112:115], v132 offset:128
    v_mfma_f32_16x16x32_bf16 v[80:83], a[148:151], v[120:123], v[80:83]
    v_mfma_f32_16x16x32_bf16 v[84:87], a[152:155], v[120:123], v[84:87]
    s_waitcnt lgkmcnt(1)
    v_mfma_f32_16x16x32_bf16 v[76:79], a[156:159], v[124:127], v[76:79]
    ds_read_b128 v[116:119], v133 offset:0
    v_mfma_f32_16x16x32_bf16 v[80:83], a[160:163], v[124:127], v[80:83]
    v_xor_b32 v131, v143, v4
    v_mfma_f32_16x16x32_bf16 v[84:87], a[164:167], v[124:127], v[84:87]
    s_waitcnt lgkmcnt(1)
    v_mfma_f32_16x16x32_bf16 v[76:79], a[168:171], v[112:115], v[76:79]
    ds_read_b128 v[120:123], v133 offset:64
    v_mfma_f32_16x16x32_bf16 v[80:83], a[172:175], v[112:115], v[80:83]
    v_mfma_f32_16x16x32_bf16 v[84:87], a[176:179], v[112:115], v[84:87]
    s_waitcnt lgkmcnt(1)
    v_mfma_f32_16x16x32_bf16 v[76:79], a[180:183], v[116:119], v[76:79]
    ds_read_b128 v[124:127], v133 offset:128
    v_mfma_f32_16x16x32_bf16 v[80:83], a[184:187], v[116:119], v[80:83]
    v_mfma_f32_16x16x32_bf16 v[84:87], a[188:191], v[116:119], v[84:87]
    s_waitcnt lgkmcnt(1)
    v_mfma_f32_16x16x32_bf16 v[76:79], a[192:195], v[120:123], v[76:79]
    ds_read_b128 v[112:115], v134 offset:0
    v_mfma_f32_16x16x32_bf16 v[80:83], a[196:199], v[120:123], v[80:83]
    v_xor_b32 v132, v144, v4
    v_mfma_f32_16x16x32_bf16 v[84:87], a[200:203], v[120:123], v[84:87]
    s_waitcnt lgkmcnt(1)
    v_mfma_f32_16x16x32_bf16 v[76:79], a[204:207], v[124:127], v[76:79]
    ds_read_b128 v[116:119], v134 offset:64
    v_mfma_f32_16x16x32_bf16 v[80:83], a[208:211], v[124:127], v[80:83]
    v_mfma_f32_16x16x32_bf16 v[84:87], a[212:215], v[124:127], v[84:87]
    s_waitcnt lgkmcnt(1)
    v_mfma_f32_16x16x32_bf16 v[76:79], a[216:219], v[112:115], v[76:79]
    ds_read_b128 v[120:123], v134 offset:128
    v_mfma_f32_16x16x32_bf16 v[80:83], a[220:223], v[112:115], v[80:83]
    v_mfma_f32_16x16x32_bf16 v[84:87], a[224:227], v[112:115], v[84:87]
    s_waitcnt lgkmcnt(1)
    v_mfma_f32_16x16x32_bf16 v[76:79], a[228:231], v[116:119], v[76:79]
    ds_read_b128 v[124:127], v135 offset:0
    v_mfma_f32_16x16x32_bf16 v[80:83], a[232:235], v[116:119], v[80:83]
    v_xor_b32 v133, v145, v4
    v_mfma_f32_16x16x32_bf16 v[84:87], a[236:239], v[116:119], v[84:87]
    s_waitcnt lgkmcnt(1)
    v_mfma_f32_16x16x32_bf16 v[76:79], a[240:243], v[120:123], v[76:79]
    ds_read_b128 v[112:115], v135 offset:64
    v_mfma_f32_16x16x32_bf16 v[80:83], a[244:247], v[120:123], v[80:83]
    v_mfma_f32_16x16x32_bf16 v[84:87], a[248:251], v[120:123], v[84:87]
    s_waitcnt lgkmcnt(1)
    v_mfma_f32_16x16x32_bf16 v[76:79], a[252:255], v[124:127], v[76:79]
    ds_read_b128 v[116:119], v135 offset:128
    v_mfma_f32_16x16x32_bf16 v[80:83], v[188:191], v[124:127], v[80:83]
    v_mfma_f32_16x16x32_bf16 v[84:87], v[192:195], v[124:127], v[84:87]
    s_waitcnt lgkmcnt(1)
    v_mfma_f32_16x16x32_bf16 v[76:79], v[196:199], v[112:115], v[76:79]
    ds_read_b128 v[120:123], v136 offset:0
    v_mfma_f32_16x16x32_bf16 v[80:83], v[200:203], v[112:115], v[80:83]
    v_xor_b32 v134, v146, v4
    v_mfma_f32_16x16x32_bf16 v[84:87], v[204:207], v[112:115], v[84:87]
    s_waitcnt lgkmcnt(1)
    v_mfma_f32_16x16x32_bf16 v[76:79], v[208:211], v[116:119], v[76:79]
    ds_read_b128 v[124:127], v136 offset:64
    v_mfma_f32_16x16x32_bf16 v[80:83], v[212:215], v[116:119], v[80:83]
    v_mfma_f32_16x16x32_bf16 v[84:87], v[216:219], v[116:119], v[84:87]
    s_waitcnt lgkmcnt(1)
    v_mfma_f32_16x16x32_bf16 v[76:79], v[220:223], v[120:123], v[76:79]
    ds_read_b128 v[112:115], v136 offset:128
    v_mfma_f32_16x16x32_bf16 v[80:83], v[224:227], v[120:123], v[80:83]
    v_mfma_f32_16x16x32_bf16 v[84:87], v[228:231], v[120:123], v[84:87]
    s_waitcnt lgkmcnt(1)
    v_mfma_f32_16x16x32_bf16 v[76:79], v[232:235], v[124:127], v[76:79]
    ds_read_b128 v[116:119], v128 offset:0
    v_mfma_f32_16x16x32_bf16 v[80:83], v[236:239], v[124:127], v[80:83]
    v_xor_b32 v135, v147, v4
    v_mfma_f32_16x16x32_bf16 v[84:87], v[240:243], v[124:127], v[84:87]
    s_waitcnt lgkmcnt(1)
    v_mfma_f32_16x16x32_bf16 v[76:79], v[244:247], v[112:115], v[76:79]
    ds_read_b128 v[120:123], v128 offset:64
    v_mfma_f32_16x16x32_bf16 v[80:83], v[248:251], v[112:115], v[80:83]
    v_xor_b32 v136, v148, v4
    v_mfma_f32_16x16x32_bf16 v[84:87], v[252:255], v[112:115], v[84:87]
    s_waitcnt lgkmcnt(1)
    s_sub_u32 s39, s39, 1
    s_cmp_eq_u32 s39, 0
    s_cbranch_scc1 L_fin0
    v_mfma_f32_16x16x32_bf16 v[88:91], a[0:3], v[116:119], 0
    ds_read_b128 v[124:127], v128 offset:128
    v_mfma_f32_16x16x32_bf16 v[92:95], a[4:7], v[116:119], 0
    ds_read_b128 v[140:143], v72 offset:768
    v_mfma_f32_16x16x32_bf16 v[96:99], a[8:11], v[116:119], 0
    s_waitcnt lgkmcnt(2)
    v_mfma_f32_16x16x32_bf16 v[88:91], a[12:15], v[120:123], v[88:91]
    ds_read_b128 v[112:115], v129 offset:0
    v_cvt_pk_bf16_f32 v172, v76, v77
    v_mfma_f32_16x16x32_bf16 v[92:95], a[16:19], v[120:123], v[92:95]
    ds_read_b128 v[144:147], v72 offset:784
    v_mfma_f32_16x16x32_bf16 v[96:99], a[20:23], v[120:123], v[96:99]
    v_cvt_pk_bf16_f32 v173, v78, v79
    s_waitcnt lgkmcnt(3)
    v_mfma_f32_16x16x32_bf16 v[88:91], a[24:27], v[124:127], v[88:91]
    ds_read_b128 v[116:119], v129 offset:64
    v_cvt_pk_bf16_f32 v174, v80, v81
    v_mfma_f32_16x16x32_bf16 v[92:95], a[28:31], v[124:127], v[92:95]
    ds_read_b64 v[148:149], v72 offset:800
    v_mfma_f32_16x16x32_bf16 v[96:99], a[32:35], v[124:127], v[96:99]
    v_cvt_pk_bf16_f32 v175, v82, v83
    s_waitcnt lgkmcnt(3)
    v_mfma_f32_16x16x32_bf16 v[88:91], a[36:39], v[112:115], v[88:91]
    ds_read_b128 v[120:123], v129 offset:128
    v_cvt_pk_bf16_f32 v176, v84, v85
    v_mfma_f32_16x16x32_bf16 v[92:95], a[40:43], v[112:115], v[92:95]
    v_add_u32 v72, 768, v72
    v_mfma_f32_16x16x32_bf16 v[96:99], a[44:47], v[112:115], v[96:99]
    v_cvt_pk_bf16_f32 v177, v86, v87
    s_waitcnt lgkmcnt(2)
    v_mfma_f32_16x16x32_bf16 v[88:91], a[48:51], v[116:119], v[88:91]
    ds_read_b128 v[124:127], v130 offset:0
    v_add_u32 v178, v180, v58
    v_mfma_f32_16x16x32_bf16 v[92:95], a[52:55], v[116:119], v[92:95]
    v_add_u32 v179, v180, v59
    v_xor_b32 v128, v140, v4
    v_mfma_f32_16x16x32_bf16 v[96:99], a[56:59], v[116:119], v[96:99]
    s_waitcnt lgkmcnt(1)
    v_mfma_f32_16x16x32_bf16 v[88:91], a[60:63], v[120:123], v[88:91]
    ds_read_b128 v[112:115], v130 offset:64
    v_permlane16_swap_b32 v172, v174
    v_mfma_f32_16x16x32_bf16 v[92:95], a[64:67], v[120:123], v[92:95]
    v_permlane16_swap_b32 v173, v175
    v_mfma_f32_16x16x32_bf16 v[96:99], a[68:71], v[120:123], v[96:99]
    s_waitcnt lgkmcnt(1)
    v_mfma_f32_16x16x32_bf16 v[88:91], a[72:75], v[124:127], v[88:91]
    ds_read_b128 v[116:119], v130 offset:128
    v_mfma_f32_16x16x32_bf16 v[92:95], a[76:79], v[124:127], v[92:95]
    buffer_store_dwordx2 v[176:177], v179, s[20:23], 0 offen sc1
    v_mfma_f32_16x16x32_bf16 v[96:99], a[80:83], v[124:127], v[96:99]
    s_waitcnt lgkmcnt(1)
    v_mfma_f32_16x16x32_bf16 v[88:91], a[84:87], v[112:115], v[88:91]
    ds_read_b128 v[120:123], v131 offset:0
    v_mfma_f32_16x16x32_bf16 v[92:95], a[88:91], v[112:115], v[92:95]
    buffer_store_dwordx4 v[172:175], v178, s[20:23], 0 offen sc1
    v_xor_b32 v129, v141, v4
    v_mfma_f32_16x16x32_bf16 v[96:99], a[92:95], v[112:115], v[96:99]
    s_waitcnt lgkmcnt(1)
    v_mfma_f32_16x16x32_bf16 v[88:91], a[96:99], v[116:119], v[88:91]
    ds_read_b128 v[124:127], v131 offset:64
    v_mov_b32 v180, v150
    v_mfma_f32_16x16x32_bf16 v[92:95], a[100:103], v[116:119], v[92:95]
    v_mov_b32 v150, v149
    v_mfma_f32_16x16x32_bf16 v[96:99], a[104:107], v[116:119], v[96:99]
    s_waitcnt lgkmcnt(1)
    v_mfma_f32_16x16x32_bf16 v[88:91], a[108:111], v[120:123], v[88:91]
    ds_read_b128 v[112:115], v131 offset:128
    v_mfma_f32_16x16x32_bf16 v[92:95], a[112:115], v[120:123], v[92:95]
    v_mfma_f32_16x16x32_bf16 v[96:99], a[116:119], v[120:123], v[96:99]
    s_waitcnt lgkmcnt(1)
    v_mfma_f32_16x16x32_bf16 v[88:91], a[120:123], v[124:127], v[88:91]
    ds_read_b128 v[116:119], v132 offset:0
    v_mfma_f32_16x16x32_bf16 v[92:95], a[124:127], v[124:127], v[92:95]
    v_xor_b32 v130, v142, v4
    v_mfma_f32_16x16x32_bf16 v[96:99], a[128:131], v[124:127], v[96:99]
    s_waitcnt lgkmcnt(1)
    v_mfma_f32_16x16x32_bf16 v[88:91], a[132:135], v[112:115], v[88:91]
    ds_read_b128 v[120:123], v132 offset:64
    v_mfma_f32_16x16x32_bf16 v[92:95], a[136:139], v[112:115], v[92:95]
    v_mfma_f32_16x16x32_bf16 v[96:99], a[140:143], v[112:115], v[96:99]
    s_waitcnt lgkmcnt(1)
    v_mfma_f32_16x16x32_bf16 v[88:91], a[144:147], v[116:119], v[88:91]
    ds_read_b128 v[124:127], v132 offset:128
    v_mfma_f32_16x16x32_bf16 v[92:95], a[148:151], v[116:119], v[92:95]
    v_mfma_f32_16x16x32_bf16 v[96:99], a[152:155], v[116:119], v[96:99]
    s_waitcnt lgkmcnt(1)
    v_mfma_f32_16x16x32_bf16 v[88:91], a[156:159], v[120:123], v[88:91]
    ds_read_b128 v[112:115], v133 offset:0
    v_mfma_f32_16x16x32_bf16 v[92:95], a[160:163], v[120:123], v[92:95]
    v_xor_b32 v131, v143, v4
    v_mfma_f32_16x16x32_bf16 v[96:99], a[164:167], v[120:123], v[96:99]
    s_waitcnt lgkmcnt(1)
    v_mfma_f32_16x16x32_bf16 v[88:91], a[168:171], v[124:127], v[88:91]
    ds_read_b128 v[116:119], v133 offset:64
    v_mfma_f32_16x16x32_bf16 v[92:95], a[172:175], v[124:127], v[92:95]
    v_mfma_f32_16x16x32_bf16 v[96:99], a[176:179], v[124:127], v[96:99]
    s_waitcnt lgkmcnt(1)
    v_mfma_f32_16x16x32_bf16 v[88:91], a[180:183], v[112:115], v[88:91]
    ds_read_b128 v[120:123], v133 offset:128
    v_mfma_f32_16x16x32_bf16 v[92:95], a[184:187], v[112:115], v[92:95]
    v_mfma_f32_16x16x32_bf16 v[96:99], a[188:191], v[112:115], v[96:99]
    s_waitcnt lgkmcnt(1)
    v_mfma_f32_16x16x32_bf16 v[88:91], a[192:195], v[116:119], v[88:91]
    ds_read_b128 v[124:127], v134 offset:0
    v_mfma_f32_16x16x32_bf16 v[92:95], a[196:199], v[116:119], v[92:95]
    v_xor_b32 v132, v144, v4
    v_mfma_f32_16x16x32_bf16 v[96:99], a[200:203], v[116:119], v[96:99]
    s_waitcnt lgkmcnt(1)
    v_mfma_f32_16x16x32_bf16 v[88:91], a[204:207], v[120:123], v[88:91]
    ds_read_b128 v[112:115], v134 offset:64
    v_mfma_f32_16x16x32_bf16 v[92:95], a[208:211], v[120:123], v[92:95]
    v_mfma_f32_16x16x32_bf16 v[96:99], a[212:215], v[120:123], v[96:99]
    s_waitcnt lgkmcnt(1)
    v_mfma_f32_16x16x32_bf16 v[88:91], a[216:219], v[124:127], v[88:91]
    ds_read_b128 v[116:119], v134 offset:128
    v_mfma_f32_16x16x32_bf16 v[92:95], a[220:223], v[124:127], v[92:95]
    v_mfma_f32_16x16x32_bf16 v[96:99], a[224:227], v[124:127], v[96:99]
    s_waitcnt lgkmcnt(1)
    v_mfma_f32_16x16x32_bf16 v[88:91], a[228:231], v[112:115], v[88:91]
    ds_read_b128 v[120:123], v135 offset:0
    v_mfma_f32_16x16x32_bf16 v[92:95], a[232:235], v[112:115], v[92:95]
    v_xor_b32 v133, v145, v4
    v_mfma_f32_16x16x32_bf16 v[96:99], a[236:239], v[112:115], v[96:99]
    s_waitcnt lgkmcnt(1)
    v_mfma_f32_16x16x32_bf16 v[88:91], a[240:243], v[116:119], v[88:91]
    ds_read_b128 v[124:127], v135 offset:64
    v_mfma_f32_16x16x32_bf16 v[92:95], a[244:247], v[116:119], v[92:95]
    v_mfma_f32_16x16x32_bf16 v[96:99], a[248:251], v[116:119], v[96:99]
    s_waitcnt lgkmcnt(1)
    v_mfma_f32_16x16x32_bf16 v[88:91], a[252:255], v[120:123], v[88:91]
    ds_read_b128 v[112:115], v135 offset:128
    v_mfma_f32_16x16x32_bf16 v[92:95], v[188:191], v[120:123], v[92:95]
    v_mfma_f32_16x16x32_bf16 v[96:99], v[192:195], v[120:123], v[96:99]
    s_waitcnt lgkmcnt(1)
    v_mfma_f32_16x16x32_bf16 v[88:91], v[196:199], v[124:127], v[88:91]
    ds_read_b128 v[116:119], v136 offset:0
    v_mfma_f32_16x16x32_bf16 v[92:95], v[200:203], v[124:127], v[92:95]
    v_xor_b32 v134, v146, v4
    v_mfma_f32_16x16x32_bf16 v[96:99], v[204:207], v[124:127], v[96:99]
    s_waitcnt lgkmcnt(1)
    v_mfma_f32_16x16x32_bf16 v[88:91], v[208:211], v[112:115], v[88:91]
    ds_read_b128 v[120:123], v136 offset:64
    v_mfma_f32_16x16x32_bf16 v[92:95], v[212:215], v[112:115], v[92:95]
    v_mfma_f32_16x16x32_bf16 v[96:99], v[216:219], v[112:115], v[96:99]
    s_waitcnt lgkmcnt(1)
    v_mfma_f32_16x16x32_bf16 v[88:91], v[220:223], v[116:119], v[88:91]
    ds_read_b128 v[124:127], v136 offset:128
    v_mfma_f32_16x16x32_bf16 v[92:95], v[224:227], v[116:119], v[92:95]
    v_mfma_f32_16x16x32_bf16 v[96:99], v[228:231], v[116:119], v[96:99]
    s_waitcnt lgkmcnt(1)
    v_mfma_f32_16x16x32_bf16 v[88:91], v[232:235], v[120:123], v[88:91]
    ds_read_b128 v[112:115], v128 offset:0
    v_mfma_f32_16x16x32_bf16 v[92:95], v[236:239], v[120:123], v[92:95]
    v_xor_b32 v135, v147, v4
    v_mfma_f32_16x16x32_bf16 v[96:99], v[240:243], v[120:123], v[96:99]
    s_waitcnt lgkmcnt(1)
    v_mfma_f32_16x16x32_bf16 v[88:91], v[244:247], v[124:127], v[88:91]
    ds_read_b128 v[116:119], v128 offset:64
    v_mfma_f32_16x16x32_bf16 v[92:95], v[248:251], v[124:127], v[92:95]
    v_xor_b32 v136, v148, v4
    v_mfma_f32_16x16x32_bf16 v[96:99], v[252:255], v[124:127], v[96:99]
    s_waitcnt lgkmcnt(1)
    s_branch L_fin1
L_fin0:
    s_nop 7
    v_cvt_pk_bf16_f32 v172, v76, v77
    v_cvt_pk_bf16_f32 v173, v78, v79
    v_cvt_pk_bf16_f32 v174, v80, v81
    v_cvt_pk_bf16_f32 v175, v82, v83
    v_cvt_pk_bf16_f32 v176, v84, v85
    v_cvt_pk_bf16_f32 v177, v86, v87
    s_nop 0
    v_permlane16_swap_b32 v172, v174
    v_permlane16_swap_b32 v173, v175
    v_add_u32 v178, v180, v58
    v_add_u32 v179, v180, v59
    buffer_store_dwordx2 v[176:177], v179, s[20:23], 0 offen sc1
    buffer_store_dwordx4 v[172:175], v178, s[20:23], 0 offen sc1
    s_nop 1
    s_branch L_done
L_fin1:
    s_nop 7
    v_cvt_pk_bf16_f32 v172, v88, v89
    v_cvt_pk_bf16_f32 v173, v90, v91
    v_cvt_pk_bf16_f32 v174, v92, v93
    v_cvt_pk_bf16_f32 v175, v94, v95
    v_cvt_pk_bf16_f32 v176, v96, v97
    v_cvt_pk_bf16_f32 v177, v98, v99
    s_nop 0
    v_permlane16_swap_b32 v172, v174
    v_permlane16_swap_b32 v173, v175
    v_add_u32 v178, v180, v58
    v_add_u32 v179, v180, v59
    buffer_store_dwordx2 v[176:177], v179, s[20:23], 0 offen sc1
    buffer_store_dwordx4 v[172:175], v178, s[20:23], 0 offen sc1
    s_nop 1
    s_branch L_done
L_p1x:
    s_waitcnt lgkmcnt(1)
    s_barrier
    v_mfma_f32_16x16x32_bf16 v[76:79], a[0:3], v[112:115], 0
    ds_read_b128 v[120:123], v146 offset:0
    ds_read_b64_tr_b16 a[36:37], v15 offset:18432
    v_mfma_f32_16x16x32_bf16 v[80:83], a[4:7], v[112:115], 0
    ds_read_b64_tr_b16 a[38:39], v15 offset:19200
    s_bitcmp1_b64 s[56:57], 4
    s_cselect_b32 s33, 192, 0
    v_mad_u32_u24 v20, v9, s33, v5
    v_mfma_f32_16x16x32_bf16 v[84:87], a[8:11], v[112:115], 0
    ds_read_b64_tr_b16 a[40:41], v16 offset:18432
    s_waitcnt lgkmcnt(4)
    v_mfma_f32_16x16x32_bf16 v[88:91], a[0:3], v[116:119], 0
    ds_read_b128 v[124:127], v128 offset:64
    ds_read_b64_tr_b16 a[42:43], v16 offset:19200
    v_mfma_f32_16x16x32_bf16 v[92:95], a[4:7], v[116:119], 0
    ds_read_b64_tr_b16 a[44:45], v17 offset:18432
    s_bitcmp1_b64 s[100:101], 4
    s_cselect_b32 s33, 192, 0
    v_mul_u32_u24 v21, s33, v10
    v_mfma_f32_16x16x32_bf16 v[96:99], a[8:11], v[116:119], 0
    ds_read_b64_tr_b16 a[46:47], v17 offset:19200
    s_waitcnt lgkmcnt(7)
    v_mfma_f32_16x16x32_bf16 v[100:103], a[0:3], v[120:123], 0
    ds_read_b128 v[112:115], v137 offset:64
    s_mov_b32 m0, 41472
    v_sub_u32 v21, v8, v21
    v_mfma_f32_16x16x32_bf16 v[104:107], a[4:7], v[120:123], 0
    ds_read_b64_tr_b16 a[48:49], v15 offset:24576
    buffer_load_dwordx4 v20, s[64:67], s76 offen  lds
    v_mfma_f32_16x16x32_bf16 v[108:111], a[8:11], v[120:123], 0
    ds_read_b64_tr_b16 a[50:51], v15 offset:25344
    s_waitcnt lgkmcnt(6)
    v_mfma_f32_16x16x32_bf16 v[76:79], a[12:15], v[124:127], v[76:79]
    ds_read_b128 v[116:119], v146 offset:64
    buffer_load_dwordx4 v6, s[64:67], s76 offen offset:1024  lds
    v_mfma_f32_16x16x32_bf16 v[80:83], a[16:19], v[124:127], v[80:83]
    ds_read_b64_tr_b16 a[52:53], v16 offset:24576
    buffer_load_dwordx4 v7, s[64:67], s76 offen offset:2048  lds
    v_mfma_f32_16x16x32_bf16 v[84:87], a[20:23], v[124:127], v[84:87]
    ds_read_b64_tr_b16 a[54:55], v16 offset:25344
    s_waitcnt lgkmcnt(5)
    v_mfma_f32_16x16x32_bf16 v[88:91], a[12:15], v[112:115], v[88:91]
    ds_read_b128 v[120:123], v128 offset:128
    s_mov_b64 exec, 0xffffff
    buffer_load_dwordx4 v21, s[64:67], s76 offen offset:3072  lds
    s_mov_b64 exec, -1
    v_mfma_f32_16x16x32_bf16 v[92:95], a[16:19], v[112:115], v[92:95]
    ds_read_b64_tr_b16 a[56:57], v17 offset:24576
    s_bitcmp1_b64 s[56:57], 5
    s_cselect_b32 s33, 192, 0
    v_mad_u32_u24 v20, v9, s33, v5
    v_mfma_f32_16x16x32_bf16 v[96:99], a[20:23], v[112:115], v[96:99]
    ds_read_b64_tr_b16 a[58:59], v17 offset:25344
    s_waitcnt lgkmcnt(5)
    v_mfma_f32_16x16x32_bf16 v[100:103], a[12:15], v[116:119], v[100:103]
    ds_read_b128 v[124:127], v137 offset:128
    s_bitcmp1_b64 s[100:101], 5
    s_cselect_b32 s33, 192, 0
    v_mul_u32_u24 v21, s33, v10
    v_mfma_f32_16x16x32_bf16 v[104:107], a[16:19], v[116:119], v[104:107]
    ds_read_b64_tr_b16 a[60:61], v15 offset:30720
    s_mov_b32 m0, 44928
    v_sub_u32 v21, v8, v21
    v_mfma_f32_16x16x32_bf16 v[108:111], a[20:23], v[116:119], v[108:111]
    ds_read_b64_tr_b16 a[62:63], v15 offset:31488
    s_waitcnt lgkmcnt(5)
    v_mfma_f32_16x16x32_bf16 v[76:79], a[24:27], v[120:123], v[76:79]
    ds_read_b128 v[112:115], v146 offset:128
    buffer_load_dwordx4 v20, s[64:67], s77 offen  lds
    v_mfma_f32_16x16x32_bf16 v[80:83], a[28:31], v[120:123], v[80:83]
    ds_read_b64_tr_b16 a[64:65], v16 offset:30720
    buffer_load_dwordx4 v6, s[64:67], s77 offen offset:1024  lds
    v_mfma_f32_16x16x32_bf16 v[84:87], a[32:35], v[120:123], v[84:87]
    ds_read_b64_tr_b16 a[66:67], v16 offset:31488
    s_waitcnt lgkmcnt(5)
    v_mfma_f32_16x16x32_bf16 v[88:91], a[24:27], v[124:127], v[88:91]
    ds_read_b128 v[116:119], v129 offset:0
    v_mfma_f32_16x16x32_bf16 v[92:95], a[28:31], v[124:127], v[92:95]
    ds_read_b64_tr_b16 a[68:69], v17 offset:30720
    buffer_load_dwordx4 v7, s[64:67], s77 offen offset:2048  lds
    v_mfma_f32_16x16x32_bf16 v[96:99], a[32:35], v[124:127], v[96:99]
    ds_read_b64_tr_b16 a[70:71], v17 offset:31488
    s_waitcnt lgkmcnt(5)
    v_mfma_f32_16x16x32_bf16 v[100:103], a[24:27], v[112:115], v[100:103]
    ds_read_b128 v[120:123], v138 offset:0
    v_mfma_f32_16x16x32_bf16 v[104:107], a[28:31], v[112:115], v[104:107]
    s_mov_b64 exec, 0xffffff
    buffer_load_dwordx4 v21, s[64:67], s77 offen offset:3072  lds
    s_mov_b64 exec, -1
    v_mfma_f32_16x16x32_bf16 v[108:111], a[32:35], v[112:115], v[108:111]
    s_waitcnt lgkmcnt(1)
    s_barrier
    v_mfma_f32_16x16x32_bf16 v[76:79], a[36:39], v[116:119], v[76:79]
    ds_read_b128 v[124:127], v147 offset:0
    ds_read_b64_tr_b16 a[72:73], v15 offset:36864
    v_mfma_f32_16x16x32_bf16 v[80:83], a[40:43], v[116:119], v[80:83]
    ds_read_b64_tr_b16 a[74:75], v15 offset:37632
    s_bitcmp1_b64 s[56:57], 6
    s_cselect_b32 s33, 192, 0
    v_mad_u32_u24 v20, v9, s33, v5
    v_mfma_f32_16x16x32_bf16 v[84:87], a[44:47], v[116:119], v[84:87]
    ds_read_b64_tr_b16 a[76:77], v16 offset:36864
    s_waitcnt lgkmcnt(4)
    v_mfma_f32_16x16x32_bf16 v[88:91], a[36:39], v[120:123], v[88:91]
    ds_read_b128 v[112:115], v129 offset:64
    ds_read_b64_tr_b16 a[78:79], v16 offset:37632
    v_mfma_f32_16x16x32_bf16 v[92:95], a[40:43], v[120:123], v[92:95]
    ds_read_b64_tr_b16 a[80:81], v17 offset:36864
    s_bitcmp1_b64 s[100:101], 6
    s_cselect_b32 s33, 192, 0
    v_mul_u32_u24 v21, s33, v10
    v_mfma_f32_16x16x32_bf16 v[96:99], a[44:47], v[120:123], v[96:99]
    ds_read_b64_tr_b16 a[82:83], v17 offset:37632
    s_waitcnt lgkmcnt(7)
    v_mfma_f32_16x16x32_bf16 v[100:103], a[36:39], v[124:127], v[100:103]
    ds_read_b128 v[116:119], v138 offset:64
    s_mov_b32 m0, 48384
    v_sub_u32 v21, v8, v21
    v_mfma_f32_16x16x32_bf16 v[104:107], a[40:43], v[124:127], v[104:107]
    ds_read_b64_tr_b16 a[84:85], v15 offset:43008
    buffer_load_dwordx4 v20, s[64:67], s78 offen  lds
    v_mfma_f32_16x16x32_bf16 v[108:111], a[44:47], v[124:127], v[108:111]
    ds_read_b64_tr_b16 a[86:87], v15 offset:43776
    s_waitcnt lgkmcnt(6)
    v_mfma_f32_16x16x32_bf16 v[76:79], a[48:51], v[112:115], v[76:79]
    ds_read_b128 v[120:123], v147 offset:64
    buffer_load_dwordx4 v6, s[64:67], s78 offen offset:1024  lds
    v_mfma_f32_16x16x32_bf16 v[80:83], a[52:55], v[112:115], v[80:83]
    ds_read_b64_tr_b16 a[88:89], v16 offset:43008
    buffer_load_dwordx4 v7, s[64:67], s78 offen offset:2048  lds
    v_mfma_f32_16x16x32_bf16 v[84:87], a[56:59], v[112:115], v[84:87]
    ds_read_b64_tr_b16 a[90:91], v16 offset:43776
    s_waitcnt lgkmcnt(5)
    v_mfma_f32_16x16x32_bf16 v[88:91], a[48:51], v[116:119], v[88:91]
    ds_read_b128 v[124:127], v129 offset:128
    s_mov_b64 exec, 0xffffff
    buffer_load_dwordx4 v21, s[64:67], s78 offen offset:3072  lds
    s_mov_b64 exec, -1
    v_mfma_f32_16x16x32_bf16 v[92:95], a[52:55], v[116:119], v[92:95]
    ds_read_b64_tr_b16 a[92:93], v17 offset:43008
    s_bitcmp1_b64 s[56:57], 7
    s_cselect_b32 s33, 192, 0
    v_mad_u32_u24 v20, v9, s33, v5
    v_mfma_f32_16x16x32_bf16 v[96:99], a[56:59], v[116:119], v[96:99]
    ds_read_b64_tr_b16 a[94:95], v17 offset:43776
    s_waitcnt lgkmcnt(5)
    v_mfma_f32_16x16x32_bf16 v[100:103], a[48:51], v[120:123], v[100:103]
    ds_read_b128 v[112:115], v138 offset:128
    s_bitcmp1_b64 s[100:101], 7
    s_cselect_b32 s33, 192, 0
    v_mul_u32_u24 v21, s33, v10
    v_mfma_f32_16x16x32_bf16 v[104:107], a[52:55], v[120:123], v[104:107]
    ds_read_b64_tr_b16 a[96:97], v15 offset:49152
    s_mov_b32 m0, 51840
    v_sub_u32 v21, v8, v21
    v_mfma_f32_16x16x32_bf16 v[108:111], a[56:59], v[120:123], v[108:111]
    ds_read_b64_tr_b16 a[98:99], v15 offset:49920
    s_waitcnt lgkmcnt(5)
    v_mfma_f32_16x16x32_bf16 v[76:79], a[60:63], v[124:127], v[76:79]
    ds_read_b128 v[116:119], v147 offset:128
    buffer_load_dwordx4 v20, s[64:67], s79 offen  lds
    v_mfma_f32_16x16x32_bf16 v[80:83], a[64:67], v[124:127], v[80:83]
    ds_read_b64_tr_b16 a[100:101], v16 offset:49152
    buffer_load_dwordx4 v6, s[64:67], s79 offen offset:1024  lds
    v_mfma_f32_16x16x32_bf16 v[84:87], a[68:71], v[124:127], v[84:87]
    ds_read_b64_tr_b16 a[102:103], v16 offset:49920
    s_waitcnt lgkmcnt(5)
    v_mfma_f32_16x16x32_bf16 v[88:91], a[60:63], v[112:115], v[88:91]
    ds_read_b128 v[120:123], v130 offset:0
    v_mfma_f32_16x16x32_bf16 v[92:95], a[64:67], v[112:115], v[92:95]
    ds_read_b64_tr_b16 a[104:105], v17 offset:49152
    buffer_load_dwordx4 v7, s[64:67], s79 offen offset:2048  lds
    v_mfma_f32_16x16x32_bf16 v[96:99], a[68:71], v[112:115], v[96:99]
    ds_read_b64_tr_b16 a[106:107], v17 offset:49920
    s_waitcnt lgkmcnt(5)
    v_mfma_f32_16x16x32_bf16 v[100:103], a[60:63], v[116:119], v[100:103]
    ds_read_b128 v[124:127], v139 offset:0
    v_mfma_f32_16x16x32_bf16 v[104:107], a[64:67], v[116:119], v[104:107]
    s_mov_b64 exec, 0xffffff
    buffer_load_dwordx4 v21, s[64:67], s79 offen offset:3072  lds
    s_mov_b64 exec, -1
    v_mfma_f32_16x16x32_bf16 v[108:111], a[68:71], v[116:119], v[108:111]
    s_waitcnt lgkmcnt(1)
    s_barrier
    v_mfma_f32_16x16x32_bf16 v[76:79], a[72:75], v[120:123], v[76:79]
    ds_read_b128 v[112:115], v148 offset:0
    ds_read_b64_tr_b16 a[108:109], v15 offset:0
    v_mfma_f32_16x16x32_bf16 v[80:83], a[76:79], v[120:123], v[80:83]
    ds_read_b64_tr_b16 a[110:111], v15 offset:768
    s_bitcmp1_b64 s[56:57], 8
    s_cselect_b32 s33, 192, 0
    v_mad_u32_u24 v20, v9, s33, v5
    v_mfma_f32_16x16x32_bf16 v[84:87], a[80:83], v[120:123], v[84:87]
    ds_read_b64_tr_b16 a[112:113], v16 offset:0
    s_waitcnt lgkmcnt(4)
    v_mfma_f32_16x16x32_bf16 v[88:91], a[72:75], v[124:127], v[88:91]
    ds_read_b128 v[116:119], v130 offset:64
    ds_read_b64_tr_b16 a[114:115], v16 offset:768
    v_mfma_f32_16x16x32_bf16 v[92:95], a[76:79], v[124:127], v[92:95]
    ds_read_b64_tr_b16 a[116:117], v17 offset:0
    s_bitcmp1_b64 s[100:101], 8
    s_cselect_b32 s33, 192, 0
    v_mul_u32_u24 v21, s33, v10
    v_mfma_f32_16x16x32_bf16 v[96:99], a[80:83], v[124:127], v[96:99]
    ds_read_b64_tr_b16 a[118:119], v17 offset:768
    s_waitcnt lgkmcnt(7)
    v_mfma_f32_16x16x32_bf16 v[100:103], a[72:75], v[112:115], v[100:103]
    ds_read_b128 v[120:123], v139 offset:64
    s_mov_b32 m0, 55296
    v_sub_u32 v21, v8, v21
    v_mfma_f32_16x16x32_bf16 v[104:107], a[76:79], v[112:115], v[104:107]
    ds_read_b64_tr_b16 a[120:121], v15 offset:6144
    buffer_load_dwordx4 v20, s[64:67], s54 offen  lds
    v_mfma_f32_16x16x32_bf16 v[108:111], a[80:83], v[112:115], v[108:111]
    ds_read_b64_tr_b16 a[122:123], v15 offset:6912
    s_waitcnt lgkmcnt(6)
    v_mfma_f32_16x16x32_bf16 v[76:79], a[84:87], v[116:119], v[76:79]
    ds_read_b128 v[124:127], v148 offset:64
    buffer_load_dwordx4 v6, s[64:67], s54 offen offset:1024  lds
    v_mfma_f32_16x16x32_bf16 v[80:83], a[88:91], v[116:119], v[80:83]
    ds_read_b64_tr_b16 a[124:125], v16 offset:6144
    buffer_load_dwordx4 v7, s[64:67], s54 offen offset:2048  lds
    v_mfma_f32_16x16x32_bf16 v[84:87], a[92:95], v[116:119], v[84:87]
    ds_read_b64_tr_b16 a[126:127], v16 offset:6912
    s_waitcnt lgkmcnt(5)
    v_mfma_f32_16x16x32_bf16 v[88:91], a[84:87], v[120:123], v[88:91]
    ds_read_b128 v[112:115], v130 offset:128
    s_mov_b64 exec, 0xffffff
    buffer_load_dwordx4 v21, s[64:67], s54 offen offset:3072  lds
    s_mov_b64 exec, -1
    v_mfma_f32_16x16x32_bf16 v[92:95], a[88:91], v[120:123], v[92:95]
    ds_read_b64_tr_b16 a[128:129], v17 offset:6144
    s_bitcmp1_b64 s[56:57], 9
    s_cselect_b32 s33, 192, 0
    v_mad_u32_u24 v20, v9, s33, v5
    v_mfma_f32_16x16x32_bf16 v[96:99], a[92:95], v[120:123], v[96:99]
    ds_read_b64_tr_b16 a[130:131], v17 offset:6912
    s_waitcnt lgkmcnt(5)
    v_mfma_f32_16x16x32_bf16 v[100:103], a[84:87], v[124:127], v[100:103]
    ds_read_b128 v[116:119], v139 offset:128
    s_bitcmp1_b64 s[100:101], 9
    s_cselect_b32 s33, 192, 0
    v_mul_u32_u24 v21, s33, v10
    v_mfma_f32_16x16x32_bf16 v[104:107], a[88:91], v[124:127], v[104:107]
    ds_read_b64_tr_b16 a[132:133], v15 offset:12288
    s_mov_b32 m0, 58752
    v_sub_u32 v21, v8, v21
    v_mfma_f32_16x16x32_bf16 v[108:111], a[92:95], v[124:127], v[108:111]
    ds_read_b64_tr_b16 a[134:135], v15 offset:13056
    s_waitcnt lgkmcnt(5)
    v_mfma_f32_16x16x32_bf16 v[76:79], a[96:99], v[112:115], v[76:79]
    ds_read_b128 v[120:123], v148 offset:128
    buffer_load_dwordx4 v20, s[64:67], s55 offen  lds
    v_mfma_f32_16x16x32_bf16 v[80:83], a[100:103], v[112:115], v[80:83]
    ds_read_b64_tr_b16 a[136:137], v16 offset:12288
    buffer_load_dwordx4 v6, s[64:67], s55 offen offset:1024  lds
    v_mfma_f32_16x16x32_bf16 v[84:87], a[104:107], v[112:115], v[84:87]
    ds_read_b64_tr_b16 a[138:139], v16 offset:13056
    s_waitcnt lgkmcnt(5)
    v_mfma_f32_16x16x32_bf16 v[88:91], a[96:99], v[116:119], v[88:91]
    ds_read_b128 v[124:127], v131 offset:0
    v_mfma_f32_16x16x32_bf16 v[92:95], a[100:103], v[116:119], v[92:95]
    ds_read_b64_tr_b16 a[140:141], v17 offset:12288
    buffer_load_dwordx4 v7, s[64:67], s55 offen offset:2048  lds
    v_mfma_f32_16x16x32_bf16 v[96:99], a[104:107], v[116:119], v[96:99]
    ds_read_b64_tr_b16 a[142:143], v17 offset:13056
    s_waitcnt lgkmcnt(5)
    v_mfma_f32_16x16x32_bf16 v[100:103], a[96:99], v[120:123], v[100:103]
    ds_read_b128 v[112:115], v140 offset:0
    v_mfma_f32_16x16x32_bf16 v[104:107], a[100:103], v[120:123], v[104:107]
    s_mov_b64 exec, 0xffffff
    buffer_load_dwordx4 v21, s[64:67], s55 offen offset:3072  lds
    s_mov_b64 exec, -1
    v_mfma_f32_16x16x32_bf16 v[108:111], a[104:107], v[120:123], v[108:111]
    s_waitcnt vmcnt(48) lgkmcnt(1)
    s_barrier
    v_mfma_f32_16x16x32_bf16 v[76:79], a[108:111], v[124:127], v[76:79]
    ds_read_b128 v[116:119], v149 offset:0
    ds_read_b64_tr_b16 a[144:145], v15 offset:18432
    v_mfma_f32_16x16x32_bf16 v[80:83], a[112:115], v[124:127], v[80:83]
    ds_read_b64_tr_b16 a[146:147], v15 offset:19200
    v_lshlrev_b32 v22, 2, v1
    v_mfma_f32_16x16x32_bf16 v[84:87], a[116:119], v[124:127], v[84:87]
    ds_read_b64_tr_b16 a[148:149], v16 offset:18432
    s_waitcnt lgkmcnt(4)
    v_mfma_f32_16x16x32_bf16 v[88:91], a[108:111], v[112:115], v[88:91]
    ds_read_b128 v[120:123], v131 offset:64
    ds_read_b64_tr_b16 a[150:151], v16 offset:19200
    v_mfma_f32_16x16x32_bf16 v[92:95], a[112:115], v[112:115], v[92:95]
    ds_read_b64_tr_b16 a[152:153], v17 offset:18432
    v_add_u32 v22, s3, v22
    v_mfma_f32_16x16x32_bf16 v[96:99], a[116:119], v[112:115], v[96:99]
    ds_read_b64_tr_b16 a[154:155], v17 offset:19200
    s_waitcnt lgkmcnt(7)
    v_mfma_f32_16x16x32_bf16 v[100:103], a[108:111], v[116:119], v[100:103]
    ds_read_b128 v[124:127], v140 offset:64
    v_lshlrev_b32 v43, 3, v22
    v_mfma_f32_16x16x32_bf16 v[104:107], a[112:115], v[116:119], v[104:107]
    ds_read_b64_tr_b16 a[156:157], v15 offset:24576
    v_add_u32 v43, 129024, v43
    v_mfma_f32_16x16x32_bf16 v[108:111], a[116:119], v[116:119], v[108:111]
    ds_read_b64_tr_b16 a[158:159], v15 offset:25344
    s_waitcnt lgkmcnt(6)
    v_mfma_f32_16x16x32_bf16 v[76:79], a[120:123], v[120:123], v[76:79]
    ds_read_b128 v[112:115], v149 offset:64
    ds_read_b64 v[172:173], v43
    v_mfma_f32_16x16x32_bf16 v[80:83], a[124:127], v[120:123], v[80:83]
    ds_read_b64_tr_b16 a[160:161], v16 offset:24576
    v_mul_u32_u24 v40, 192, v22
    v_mfma_f32_16x16x32_bf16 v[84:87], a[128:131], v[120:123], v[84:87]
    ds_read_b64_tr_b16 a[162:163], v16 offset:25344
    s_waitcnt lgkmcnt(6)
    v_mfma_f32_16x16x32_bf16 v[88:91], a[120:123], v[124:127], v[88:91]
    ds_read_b128 v[116:119], v131 offset:128
    v_add_u32 v40, 62208, v40
    v_mfma_f32_16x16x32_bf16 v[92:95], a[124:127], v[124:127], v[92:95]
    ds_read_b64_tr_b16 a[164:165], v17 offset:24576
    v_cmp_gt_u32 s[52:53], s38, v22
    v_mfma_f32_16x16x32_bf16 v[96:99], a[128:131], v[124:127], v[96:99]
    ds_read_b64_tr_b16 a[166:167], v17 offset:25344
    s_waitcnt lgkmcnt(6)
    v_mfma_f32_16x16x32_bf16 v[100:103], a[120:123], v[112:115], v[100:103]
    ds_read_b128 v[120:123], v140 offset:128
    s_mul_i32 s6, s3, 2304
    s_add_u32 s6, s6, 134400
    s_add_u32 s7, s6, 2272
    v_mov_b32 v46, 99
    v_mfma_f32_16x16x32_bf16 v[104:107], a[124:127], v[112:115], v[104:107]
    ds_read_b64_tr_b16 a[168:169], v15 offset:30720
    v_mov_b32 v163, 0
    v_mfma_f32_16x16x32_bf16 v[108:111], a[128:131], v[112:115], v[108:111]
    ds_read_b64_tr_b16 a[170:171], v15 offset:31488
    s_waitcnt lgkmcnt(5)
    v_mfma_f32_16x16x32_bf16 v[76:79], a[132:135], v[116:119], v[76:79]
    ds_read_b128 v[124:127], v149 offset:128
    v_mov_b32 v47, 162048
    v_mfma_f32_16x16x32_bf16 v[80:83], a[136:139], v[116:119], v[80:83]
    ds_read_b64_tr_b16 a[172:173], v16 offset:30720
    v_lshlrev_b32 v23, 16, v172
    v_mfma_f32_16x16x32_bf16 v[84:87], a[140:143], v[116:119], v[84:87]
    ds_read_b64_tr_b16 a[174:175], v16 offset:31488
    s_waitcnt lgkmcnt(5)
    v_mfma_f32_16x16x32_bf16 v[88:91], a[132:135], v[120:123], v[88:91]
    ds_read_b128 v[112:115], v132 offset:0
    v_and_b32 v24, 0xffff0000, v172
    v_mfma_f32_16x16x32_bf16 v[92:95], a[136:139], v[120:123], v[92:95]
    ds_read_b64_tr_b16 a[176:177], v17 offset:30720
    v_floor_f32 v25, v23
    v_mfma_f32_16x16x32_bf16 v[96:99], a[140:143], v[120:123], v[96:99]
    ds_read_b64_tr_b16 a[178:179], v17 offset:31488
    s_waitcnt lgkmcnt(5)
    v_mfma_f32_16x16x32_bf16 v[100:103], a[132:135], v[124:127], v[100:103]
    ds_read_b128 v[116:119], v141 offset:0
    v_floor_f32 v26, v24
    v_mfma_f32_16x16x32_bf16 v[104:107], a[136:139], v[124:127], v[104:107]
    v_sub_f32 v27, v23, v25
    v_mfma_f32_16x16x32_bf16 v[108:111], a[140:143], v[124:127], v[108:111]
    v_sub_f32 v28, v24, v26
    s_waitcnt lgkmcnt(1)
    s_barrier
    v_mfma_f32_16x16x32_bf16 v[76:79], a[144:147], v[112:115], v[76:79]
    ds_read_b128 v[120:123], v150 offset:0
    ds_read_b64_tr_b16 a[180:181], v15 offset:36864
    v_mfma_f32_16x16x32_bf16 v[80:83], a[148:151], v[112:115], v[80:83]
    ds_read_b64_tr_b16 a[182:183], v15 offset:37632
    v_cvt_u32_f32 v25, v25
    v_mfma_f32_16x16x32_bf16 v[84:87], a[152:155], v[112:115], v[84:87]
    ds_read_b64_tr_b16 a[184:185], v16 offset:36864
    s_waitcnt lgkmcnt(4)
    v_mfma_f32_16x16x32_bf16 v[88:91], a[144:147], v[116:119], v[88:91]
    ds_read_b128 v[124:127], v132 offset:64
    ds_read_b64_tr_b16 a[186:187], v16 offset:37632
    v_mfma_f32_16x16x32_bf16 v[92:95], a[148:151], v[116:119], v[92:95]
    ds_read_b64_tr_b16 a[188:189], v17 offset:36864
    v_cvt_u32_f32 v26, v26
    v_mfma_f32_16x16x32_bf16 v[96:99], a[152:155], v[116:119], v[96:99]
    ds_read_b64_tr_b16 a[190:191], v17 offset:37632
    s_waitcnt lgkmcnt(7)
    v_mfma_f32_16x16x32_bf16 v[100:103], a[144:147], v[120:123], v[100:103]
    ds_read_b128 v[112:115], v141 offset:64
    v_cmp_eq_f32 s[44:45], 0, v28
    v_mfma_f32_16x16x32_bf16 v[104:107], a[148:151], v[120:123], v[104:107]
    ds_read_b64_tr_b16 a[192:193], v15 offset:43008
    v_cmp_neq_f32 s[46:47], 0, v27
    v_mfma_f32_16x16x32_bf16 v[108:111], a[152:155], v[120:123], v[108:111]
    ds_read_b64_tr_b16 a[194:195], v15 offset:43776
    s_waitcnt lgkmcnt(6)
    v_mfma_f32_16x16x32_bf16 v[76:79], a[156:159], v[124:127], v[76:79]
    ds_read_b128 v[116:119], v150 offset:64
    v_sub_f32 v23, 1.0, v27
    v_mfma_f32_16x16x32_bf16 v[80:83], a[160:163], v[124:127], v[80:83]
    ds_read_b64_tr_b16 a[196:197], v16 offset:43008
    v_sub_f32 v24, 1.0, v28
    v_mfma_f32_16x16x32_bf16 v[84:87], a[164:167], v[124:127], v[84:87]
    ds_read_b64_tr_b16 a[198:199], v16 offset:43776
    s_waitcnt lgkmcnt(5)
    v_mfma_f32_16x16x32_bf16 v[88:91], a[156:159], v[112:115], v[88:91]
    ds_read_b128 v[120:123], v132 offset:128
    v_cvt_pk_bf16_f32 v43, v23, v24
    v_mfma_f32_16x16x32_bf16 v[92:95], a[160:163], v[112:115], v[92:95]
    ds_read_b64_tr_b16 a[200:201], v17 offset:43008
    v_sub_u32 v31, 223, v26
    v_mfma_f32_16x16x32_bf16 v[96:99], a[164:167], v[112:115], v[96:99]
    ds_read_b64_tr_b16 a[202:203], v17 offset:43776
    s_waitcnt lgkmcnt(5)
    v_mfma_f32_16x16x32_bf16 v[100:103], a[156:159], v[116:119], v[100:103]
    ds_read_b128 v[124:127], v141 offset:128
    v_sub_u32 v32, 223, v25
    v_mfma_f32_16x16x32_bf16 v[104:107], a[160:163], v[116:119], v[104:107]
    ds_read_b64_tr_b16 a[204:205], v15 offset:49152
    v_lshlrev_b32 v23, 16, v43
    v_mfma_f32_16x16x32_bf16 v[108:111], a[164:167], v[116:119], v[108:111]
    ds_read_b64_tr_b16 a[206:207], v15 offset:49920
    s_waitcnt lgkmcnt(5)
    v_mfma_f32_16x16x32_bf16 v[76:79], a[168:171], v[120:123], v[76:79]
    ds_read_b128 v[112:115], v150 offset:128
    v_and_b32 v24, 0xffff0000, v43
    v_mfma_f32_16x16x32_bf16 v[80:83], a[172:175], v[120:123], v[80:83]
    ds_read_b64_tr_b16 a[208:209], v16 offset:49152
    v_min_u32 v31, 1, v31
    v_mfma_f32_16x16x32_bf16 v[84:87], a[176:179], v[120:123], v[84:87]
    ds_read_b64_tr_b16 a[210:211], v16 offset:49920
    s_waitcnt lgkmcnt(5)
    v_mfma_f32_16x16x32_bf16 v[88:91], a[168:171], v[124:127], v[88:91]
    ds_read_b128 v[116:119], v133 offset:0
    v_min_u32 v32, 1, v32
    v_mfma_f32_16x16x32_bf16 v[92:95], a[172:175], v[124:127], v[92:95]
    ds_read_b64_tr_b16 a[212:213], v17 offset:49152
    v_mul_f32 v33, v23, v24
    v_mfma_f32_16x16x32_bf16 v[96:99], a[176:179], v[124:127], v[96:99]
    ds_read_b64_tr_b16 a[214:215], v17 offset:49920
    s_waitcnt lgkmcnt(5)
    v_mfma_f32_16x16x32_bf16 v[100:103], a[168:171], v[112:115], v[100:103]
    ds_read_b128 v[120:123], v142 offset:0
    v_mul_f32 v34, v23, v28
    v_mfma_f32_16x16x32_bf16 v[104:107], a[172:175], v[112:115], v[104:107]
    v_mul_f32 v35, v27, v24
    v_mfma_f32_16x16x32_bf16 v[108:111], a[176:179], v[112:115], v[108:111]
    v_mul_f32 v36, v27, v28
    s_waitcnt lgkmcnt(1)
    s_barrier
    v_mfma_f32_16x16x32_bf16 v[76:79], a[180:183], v[116:119], v[76:79]
    ds_read_b128 v[124:127], v151 offset:0
    ds_read_b64_tr_b16 a[216:217], v15 offset:0
    v_mfma_f32_16x16x32_bf16 v[80:83], a[184:187], v[116:119], v[80:83]
    ds_read_b64_tr_b16 a[218:219], v15 offset:768
    v_cndmask_b32 v41, 0, 1, s[46:47]
    v_mfma_f32_16x16x32_bf16 v[84:87], a[188:191], v[116:119], v[84:87]
    ds_read_b64_tr_b16 a[220:221], v16 offset:0
    s_waitcnt lgkmcnt(4)
    v_mfma_f32_16x16x32_bf16 v[88:91], a[180:183], v[120:123], v[88:91]
    ds_read_b128 v[112:115], v133 offset:64
    ds_read_b64_tr_b16 a[222:223], v16 offset:768
    v_mfma_f32_16x16x32_bf16 v[92:95], a[184:187], v[120:123], v[92:95]
    ds_read_b64_tr_b16 a[224:225], v17 offset:0
    v_cvt_pk_bf16_f32 v37, v33, v34
    v_mfma_f32_16x16x32_bf16 v[96:99], a[188:191], v[120:123], v[96:99]
    ds_read_b64_tr_b16 a[226:227], v17 offset:768
    s_waitcnt lgkmcnt(7)
    v_mfma_f32_16x16x32_bf16 v[100:103], a[180:183], v[124:127], v[100:103]
    ds_read_b128 v[116:119], v142 offset:64
    v_cvt_pk_bf16_f32 v38, v33, v35
    v_mfma_f32_16x16x32_bf16 v[104:107], a[184:187], v[124:127], v[104:107]
    ds_read_b64_tr_b16 a[228:229], v15 offset:6144
    v_cvt_pk_bf16_f32 v39, v35, v36
    v_mfma_f32_16x16x32_bf16 v[108:111], a[188:191], v[124:127], v[108:111]
    ds_read_b64_tr_b16 a[230:231], v15 offset:6912
    s_waitcnt lgkmcnt(6)
    v_mfma_f32_16x16x32_bf16 v[76:79], a[192:195], v[112:115], v[76:79]
    ds_read_b128 v[120:123], v151 offset:64
    v_cndmask_b32 v41, v41, 0, s[44:45]
    v_mfma_f32_16x16x32_bf16 v[80:83], a[196:199], v[112:115], v[80:83]
    ds_read_b64_tr_b16 a[232:233], v16 offset:6144
    v_cndmask_b32 v42, v37, v38, s[44:45]
    v_mfma_f32_16x16x32_bf16 v[84:87], a[200:203], v[112:115], v[84:87]
    ds_read_b64_tr_b16 a[234:235], v16 offset:6912
    s_waitcnt lgkmcnt(5)
    v_mfma_f32_16x16x32_bf16 v[88:91], a[192:195], v[116:119], v[88:91]
    ds_read_b128 v[124:127], v133 offset:128
    v_mul_u32_u24 v30, 43008, v25
    v_mfma_f32_16x16x32_bf16 v[92:95], a[196:199], v[116:119], v[92:95]
    ds_read_b64_tr_b16 a[236:237], v17 offset:6144
    v_mul_u32_u24 v48, 192, v31
    v_mfma_f32_16x16x32_bf16 v[96:99], a[200:203], v[116:119], v[96:99]
    ds_read_b64_tr_b16 a[238:239], v17 offset:6912
    s_waitcnt lgkmcnt(5)
    v_mfma_f32_16x16x32_bf16 v[100:103], a[192:195], v[120:123], v[100:103]
    ds_read_b128 v[112:115], v142 offset:128
    v_mul_u32_u24 v49, 43008, v32
    v_mfma_f32_16x16x32_bf16 v[104:107], a[196:199], v[120:123], v[104:107]
    ds_read_b64_tr_b16 a[240:241], v15 offset:12288
    v_mad_u32_u24 v156, v26, s5, v30
    v_mfma_f32_16x16x32_bf16 v[108:111], a[200:203], v[120:123], v[108:111]
    ds_read_b64_tr_b16 a[242:243], v15 offset:13056
    s_waitcnt lgkmcnt(5)
    v_mfma_f32_16x16x32_bf16 v[76:79], a[204:207], v[124:127], v[76:79]
    ds_read_b128 v[116:119], v151 offset:128
    v_cndmask_b32 v43, v48, v49, s[44:45]
    v_mfma_f32_16x16x32_bf16 v[80:83], a[208:211], v[124:127], v[80:83]
    ds_read_b64_tr_b16 a[244:245], v16 offset:12288
    v_add_u32 v160, v156, v49
    v_mfma_f32_16x16x32_bf16 v[84:87], a[212:215], v[124:127], v[84:87]
    ds_read_b64_tr_b16 a[246:247], v16 offset:13056
    s_waitcnt lgkmcnt(5)
    v_mfma_f32_16x16x32_bf16 v[88:91], a[204:207], v[112:115], v[88:91]
    ds_read_b128 v[120:123], v134 offset:0
    v_add_u32 v157, v156, v43
    v_mfma_f32_16x16x32_bf16 v[92:95], a[208:211], v[112:115], v[92:95]
    ds_read_b64_tr_b16 a[248:249], v17 offset:12288
    v_add_u32 v161, v160, v48
    v_mfma_f32_16x16x32_bf16 v[96:99], a[212:215], v[112:115], v[96:99]
    ds_read_b64_tr_b16 a[250:251], v17 offset:13056
    s_waitcnt lgkmcnt(5)
    v_mfma_f32_16x16x32_bf16 v[100:103], a[204:207], v[116:119], v[100:103]
    ds_read_b128 v[124:127], v143 offset:0
    v_lshl_or_b32 v159, v41, 31, v40
    v_mfma_f32_16x16x32_bf16 v[104:107], a[208:211], v[116:119], v[104:107]
    v_mul_lo_u32 v162, v39, v41
    v_mfma_f32_16x16x32_bf16 v[108:111], a[212:215], v[116:119], v[108:111]
    v_and_b32 v33, 0xff, v173
    s_waitcnt vmcnt(44) lgkmcnt(1)
    s_barrier
    v_mfma_f32_16x16x32_bf16 v[76:79], a[216:219], v[120:123], v[76:79]
    ds_read_b128 v[112:115], v152 offset:0
    ds_read_b64_tr_b16 a[252:253], v15 offset:18432
    v_mfma_f32_16x16x32_bf16 v[80:83], a[220:223], v[120:123], v[80:83]
    ds_read_b64_tr_b16 a[254:255], v15 offset:19200
    v_lshrrev_b32 v36, 18, v173
    v_mfma_f32_16x16x32_bf16 v[84:87], a[224:227], v[120:123], v[84:87]
    ds_read_b64_tr_b16 v[188:189], v16 offset:18432
    s_waitcnt lgkmcnt(4)
    v_mfma_f32_16x16x32_bf16 v[88:91], a[216:219], v[124:127], v[88:91]
    ds_read_b128 v[116:119], v134 offset:64
    ds_read_b64_tr_b16 v[190:191], v16 offset:19200
    v_mfma_f32_16x16x32_bf16 v[92:95], a[220:223], v[124:127], v[92:95]
    ds_read_b64_tr_b16 v[192:193], v17 offset:18432
    v_bfe_u32 v34, v173, 8, 5
    v_mfma_f32_16x16x32_bf16 v[96:99], a[224:227], v[124:127], v[96:99]
    ds_read_b64_tr_b16 v[194:195], v17 offset:19200
    s_waitcnt lgkmcnt(7)
    v_mfma_f32_16x16x32_bf16 v[100:103], a[216:219], v[112:115], v[100:103]
    ds_read_b128 v[120:123], v143 offset:64
    v_bfe_u32 v35, v173, 13, 5
    v_mfma_f32_16x16x32_bf16 v[104:107], a[220:223], v[112:115], v[104:107]
    ds_read_b64_tr_b16 v[196:197], v15 offset:24576
    v_sub_u32 v23, v25, v33
    v_mfma_f32_16x16x32_bf16 v[108:111], a[224:227], v[112:115], v[108:111]
    ds_read_b64_tr_b16 v[198:199], v15 offset:25344
    s_waitcnt lgkmcnt(6)
    v_mfma_f32_16x16x32_bf16 v[76:79], a[228:231], v[116:119], v[76:79]
    ds_read_b128 v[124:127], v152 offset:64
    v_sub_u32 v24, v26, v36
    v_mfma_f32_16x16x32_bf16 v[80:83], a[232:235], v[116:119], v[80:83]
    ds_read_b64_tr_b16 v[200:201], v16 offset:24576
    v_add_u32 v23, 1, v23
    v_mfma_f32_16x16x32_bf16 v[84:87], a[236:239], v[116:119], v[84:87]
    ds_read_b64_tr_b16 v[202:203], v16 offset:25344
    s_waitcnt lgkmcnt(5)
    v_mfma_f32_16x16x32_bf16 v[88:91], a[228:231], v[120:123], v[88:91]
    ds_read_b128 v[112:115], v134 offset:128
    v_add_u32 v24, 1, v24
    v_mfma_f32_16x16x32_bf16 v[92:95], a[232:235], v[120:123], v[92:95]
    ds_read_b64_tr_b16 v[204:205], v17 offset:24576
    v_cndmask_b32 v27, 0, v32, s[44:45]
    v_mfma_f32_16x16x32_bf16 v[96:99], a[236:239], v[120:123], v[96:99]
    ds_read_b64_tr_b16 v[206:207], v17 offset:25344
    s_waitcnt lgkmcnt(5)
    v_mfma_f32_16x16x32_bf16 v[100:103], a[228:231], v[124:127], v[100:103]
    ds_read_b128 v[116:119], v143 offset:128
    v_cndmask_b32 v28, v31, 0, s[44:45]
    v_mfma_f32_16x16x32_bf16 v[104:107], a[232:235], v[124:127], v[104:107]
    ds_read_b64_tr_b16 v[208:209], v15 offset:30720
    v_add_u32 v27, v23, v27
    v_mfma_f32_16x16x32_bf16 v[108:111], a[236:239], v[124:127], v[108:111]
    ds_read_b64_tr_b16 v[210:211], v15 offset:31488
    s_waitcnt lgkmcnt(5)
    v_mfma_f32_16x16x32_bf16 v[76:79], a[240:243], v[112:115], v[76:79]
    ds_read_b128 v[120:123], v152 offset:128
    v_add_u32 v28, v24, v28
    v_mfma_f32_16x16x32_bf16 v[80:83], a[244:247], v[112:115], v[80:83]
    ds_read_b64_tr_b16 v[212:213], v16 offset:30720
    v_max_u32 v43, v23, v27
    v_mfma_f32_16x16x32_bf16 v[84:87], a[248:251], v[112:115], v[84:87]
    ds_read_b64_tr_b16 v[214:215], v16 offset:31488
    s_waitcnt lgkmcnt(5)
    v_mfma_f32_16x16x32_bf16 v[88:91], a[240:243], v[116:119], v[88:91]
    ds_read_b128 v[124:127], v135 offset:0
    v_max_u32 v45, v24, v28
    v_mfma_f32_16x16x32_bf16 v[92:95], a[244:247], v[116:119], v[92:95]
    ds_read_b64_tr_b16 v[216:217], v17 offset:30720
    v_cmp_lt_u32 vcc, v43, v35
    v_mfma_f32_16x16x32_bf16 v[96:99], a[248:251], v[116:119], v[96:99]
    ds_read_b64_tr_b16 v[218:219], v17 offset:31488
    s_waitcnt lgkmcnt(5)
    v_mfma_f32_16x16x32_bf16 v[100:103], a[240:243], v[120:123], v[100:103]
    ds_read_b128 v[112:115], v144 offset:0
    v_add_u32 v23, v34, v23
    v_mfma_f32_16x16x32_bf16 v[104:107], a[244:247], v[120:123], v[104:107]
    v_add_u32 v27, v34, v27
    v_mfma_f32_16x16x32_bf16 v[108:111], a[248:251], v[120:123], v[108:111]
    v_cndmask_b32 v45, v46, v45, vcc
    s_waitcnt lgkmcnt(1)
    s_barrier
    v_mfma_f32_16x16x32_bf16 v[76:79], a[252:255], v[124:127], v[76:79]
    ds_read_b128 v[116:119], v153 offset:0
    ds_read_b64_tr_b16 v[220:221], v15 offset:36864
    v_mfma_f32_16x16x32_bf16 v[80:83], v[188:191], v[124:127], v[80:83]
    ds_read_b64_tr_b16 v[222:223], v15 offset:37632
    v_mul_u32_u24 v23, 3456, v23
    v_mfma_f32_16x16x32_bf16 v[84:87], v[192:195], v[124:127], v[84:87]
    ds_read_b64_tr_b16 v[224:225], v16 offset:36864
    s_waitcnt lgkmcnt(4)
    v_mfma_f32_16x16x32_bf16 v[88:91], a[252:255], v[112:115], v[88:91]
    ds_read_b128 v[120:123], v135 offset:64
    ds_read_b64_tr_b16 v[226:227], v16 offset:37632
    v_mfma_f32_16x16x32_bf16 v[92:95], v[188:191], v[112:115], v[92:95]
    ds_read_b64_tr_b16 v[228:229], v17 offset:36864
    v_lshl_add_u32 v45, v41, 5, v45
    v_mfma_f32_16x16x32_bf16 v[96:99], v[192:195], v[112:115], v[96:99]
    ds_read_b64_tr_b16 v[230:231], v17 offset:37632
    s_waitcnt lgkmcnt(7)
    v_mfma_f32_16x16x32_bf16 v[100:103], a[252:255], v[116:119], v[100:103]
    ds_read_b128 v[124:127], v144 offset:64
    v_mul_u32_u24 v27, 3456, v27
    v_mfma_f32_16x16x32_bf16 v[104:107], v[188:191], v[116:119], v[104:107]
    ds_read_b64_tr_b16 v[232:233], v15 offset:43008
    v_cndmask_b32 v45, v46, v45, s[52:53]
    v_mfma_f32_16x16x32_bf16 v[108:111], v[192:195], v[116:119], v[108:111]
    ds_read_b64_tr_b16 v[234:235], v15 offset:43776
    s_waitcnt lgkmcnt(6)
    v_mfma_f32_16x16x32_bf16 v[76:79], v[196:199], v[120:123], v[76:79]
    ds_read_b128 v[112:115], v153 offset:64
    v_mad_u32_u24 v23, v24, s5, v23
    v_mfma_f32_16x16x32_bf16 v[80:83], v[200:203], v[120:123], v[80:83]
    ds_read_b64_tr_b16 v[236:237], v16 offset:43008
    v_cmp_gt_u32 s[48:49], 18, v45
    v_mfma_f32_16x16x32_bf16 v[84:87], v[204:207], v[120:123], v[84:87]
    ds_read_b64_tr_b16 v[238:239], v16 offset:43776
    s_waitcnt lgkmcnt(5)
    v_mfma_f32_16x16x32_bf16 v[88:91], v[196:199], v[124:127], v[88:91]
    ds_read_b128 v[116:119], v135 offset:128
    v_mad_u32_u24 v27, v28, s5, v27
    v_mfma_f32_16x16x32_bf16 v[92:95], v[200:203], v[124:127], v[92:95]
    ds_read_b64_tr_b16 v[240:241], v17 offset:43008
    v_and_b32 v24, 4, v24
    v_mfma_f32_16x16x32_bf16 v[96:99], v[204:207], v[124:127], v[96:99]
    ds_read_b64_tr_b16 v[242:243], v17 offset:43776
    s_waitcnt lgkmcnt(5)
    v_mfma_f32_16x16x32_bf16 v[100:103], v[196:199], v[112:115], v[100:103]
    ds_read_b128 v[120:123], v144 offset:128
    v_and_b32 v28, 4, v28
    v_mfma_f32_16x16x32_bf16 v[104:107], v[200:203], v[112:115], v[104:107]
    ds_read_b64_tr_b16 v[244:245], v15 offset:49152
    s_andn2_b64 s[50:51], s[52:53], s[48:49]
    v_lshl_add_u32 v164, v24, 3, v23
    v_mfma_f32_16x16x32_bf16 v[108:111], v[204:207], v[112:115], v[108:111]
    ds_read_b64_tr_b16 v[246:247], v15 offset:49920
    s_waitcnt lgkmcnt(5)
    v_mfma_f32_16x16x32_bf16 v[76:79], v[208:211], v[116:119], v[76:79]
    ds_read_b128 v[124:127], v153 offset:128
    v_lshl_add_u32 v165, v28, 3, v27
    v_mfma_f32_16x16x32_bf16 v[80:83], v[212:215], v[116:119], v[80:83]
    ds_read_b64_tr_b16 v[248:249], v16 offset:49152
    v_and_b32 v168, 0xffff, v42
    v_mfma_f32_16x16x32_bf16 v[84:87], v[216:219], v[116:119], v[84:87]
    ds_read_b64_tr_b16 v[250:251], v16 offset:49920
    s_waitcnt lgkmcnt(5)
    v_mfma_f32_16x16x32_bf16 v[88:91], v[208:211], v[120:123], v[88:91]
    ds_read_b128 v[112:115], v136 offset:0
    v_lshlrev_b32 v169, 16, v42
    v_mfma_f32_16x16x32_bf16 v[92:95], v[212:215], v[120:123], v[92:95]
    ds_read_b64_tr_b16 v[252:253], v17 offset:49152
    v_lshrrev_b32 v170, 16, v42
    v_mfma_f32_16x16x32_bf16 v[96:99], v[216:219], v[120:123], v[96:99]
    ds_read_b64_tr_b16 v[254:255], v17 offset:49920
    s_waitcnt lgkmcnt(5)
    v_mfma_f32_16x16x32_bf16 v[100:103], v[208:211], v[124:127], v[100:103]
    ds_read_b128 v[116:119], v145 offset:0
    v_and_b32 v171, 0xffff0000, v42
    v_mfma_f32_16x16x32_bf16 v[104:107], v[212:215], v[124:127], v[104:107]
    v_mbcnt_lo_u32_b32 v43, s48, 0
    v_mfma_f32_16x16x32_bf16 v[108:111], v[216:219], v[124:127], v[108:111]
    v_mbcnt_lo_u32_b32 v45, s50, 0
    s_waitcnt lgkmcnt(1)
    s_barrier
    v_mfma_f32_16x16x32_bf16 v[76:79], v[220:223], v[112:115], v[76:79]
    ds_read_b128 v[120:123], v154 offset:0
    v_mbcnt_hi_u32_b32 v43, s49, v43
    v_mfma_f32_16x16x32_bf16 v[80:83], v[224:227], v[112:115], v[80:83]
    v_mbcnt_hi_u32_b32 v45, s51, v45
    v_mfma_f32_16x16x32_bf16 v[84:87], v[228:231], v[112:115], v[84:87]
    s_bcnt1_i32_b64 s40, s[48:49]
    s_bcnt1_i32_b64 s41, s[50:51]
    v_lshl_add_u32 v43, v43, 5, s6
    s_waitcnt lgkmcnt(1)
    v_mfma_f32_16x16x32_bf16 v[88:91], v[220:223], v[116:119], v[88:91]
    ds_read_b128 v[124:127], v136 offset:64
    v_lshlrev_b32 v45, 5, v45
    v_mfma_f32_16x16x32_bf16 v[92:95], v[224:227], v[116:119], v[92:95]
    v_sub_u32 v45, s7, v45
    v_mfma_f32_16x16x32_bf16 v[96:99], v[228:231], v[116:119], v[96:99]
    v_cndmask_b32 v156, v156, v164, s[48:49]
    s_waitcnt lgkmcnt(1)
    v_mfma_f32_16x16x32_bf16 v[100:103], v[220:223], v[120:123], v[100:103]
    ds_read_b128 v[112:115], v145 offset:64
    v_cndmask_b32 v45, v45, v43, s[48:49]
    v_mfma_f32_16x16x32_bf16 v[104:107], v[224:227], v[120:123], v[104:107]
    v_cndmask_b32 v157, v157, v165, s[48:49]
    v_mfma_f32_16x16x32_bf16 v[108:111], v[228:231], v[120:123], v[108:111]
    v_cndmask_b32 v158, v42, v40, s[48:49]
    s_waitcnt lgkmcnt(1)
    v_mfma_f32_16x16x32_bf16 v[76:79], v[232:235], v[124:127], v[76:79]
    ds_read_b128 v[116:119], v154 offset:64
    v_cndmask_b32 v45, v47, v45, s[52:53]
    v_mfma_f32_16x16x32_bf16 v[80:83], v[236:239], v[124:127], v[80:83]
    v_cndmask_b32 v160, v160, v168, s[48:49]
    v_mfma_f32_16x16x32_bf16 v[84:87], v[240:243], v[124:127], v[84:87]
    v_cndmask_b32 v161, v161, v169, s[48:49]
    s_waitcnt lgkmcnt(1)
    v_mfma_f32_16x16x32_bf16 v[88:91], v[232:235], v[112:115], v[88:91]
    ds_read_b128 v[120:123], v136 offset:128
    v_cndmask_b32 v162, v162, v170, s[48:49]
    v_mfma_f32_16x16x32_bf16 v[92:95], v[236:239], v[112:115], v[92:95]
    v_cndmask_b32 v163, v163, v171, s[48:49]
    v_mfma_f32_16x16x32_bf16 v[96:99], v[240:243], v[112:115], v[96:99]
    ds_write_b128 v45, v[156:159]
    s_waitcnt lgkmcnt(2)
    v_mfma_f32_16x16x32_bf16 v[100:103], v[232:235], v[116:119], v[100:103]
    ds_read_b128 v[124:127], v145 offset:128
    ds_write_b128 v45, v[160:163] offset:16
    v_mfma_f32_16x16x32_bf16 v[104:107], v[236:239], v[116:119], v[104:107]
    v_mfma_f32_16x16x32_bf16 v[108:111], v[240:243], v[116:119], v[108:111]
    s_waitcnt lgkmcnt(3)
    v_mfma_f32_16x16x32_bf16 v[76:79], v[244:247], v[120:123], v[76:79]
    ds_read_b128 v[112:115], v154 offset:128
    v_mfma_f32_16x16x32_bf16 v[80:83], v[248:251], v[120:123], v[80:83]
    v_mfma_f32_16x16x32_bf16 v[84:87], v[252:255], v[120:123], v[84:87]
    s_waitcnt lgkmcnt(2)
    v_mfma_f32_16x16x32_bf16 v[88:91], v[244:247], v[124:127], v[88:91]
    v_mfma_f32_16x16x32_bf16 v[92:95], v[248:251], v[124:127], v[92:95]
    v_mfma_f32_16x16x32_bf16 v[96:99], v[252:255], v[124:127], v[96:99]
    s_waitcnt lgkmcnt(0)
    v_mfma_f32_16x16x32_bf16 v[100:103], v[244:247], v[112:115], v[100:103]
    v_mfma_f32_16x16x32_bf16 v[104:107], v[248:251], v[112:115], v[104:107]
    v_mfma_f32_16x16x32_bf16 v[108:111], v[252:255], v[112:115], v[108:111]
    s_branch L_p1end
L_slow:
    v_cmp_ne_u32 vcc, 0, v19
    s_and_saveexec_b64 s[58:59], vcc
    s_cbranch_execz L_slow0
    ds_write_b128 v57, v[48:51]
    ds_write_b128 v57, v[52:55] offset:16
    ds_write_b32 v57, v56 offset:32
L_slow0:
    s_mov_b64 exec, s[58:59]
    s_cmp_eq_u32 s3, 3
    s_cbranch_scc1 L_slow1
    s_add_u32 m0, s27, 36864
    s_add_u32 s32, s4, 36864
    buffer_load_dwordx4 v11, s[16:19], s32 offen offset:0 lds
    buffer_load_dwordx4 v12, s[16:19], s32 offen offset:1024 lds
    buffer_load_dwordx4 v13, s[16:19], s32 offen offset:2048 lds
    s_add_u32 m0, s27, 39936
    s_add_u32 s32, s4, 39936
    buffer_load_dwordx4 v11, s[16:19], s32 offen offset:0 lds
    buffer_load_dwordx4 v12, s[16:19], s32 offen offset:1024 lds
    buffer_load_dwordx4 v13, s[16:19], s32 offen offset:2048 lds
    s_branch L_slow2
L_slow1:
    s_bitcmp1_b64 s[56:57], 4
    s_cselect_b32 s33, 192, 0
    v_mad_u32_u24 v20, v9, s33, v5
    s_bitcmp1_b64 s[100:101], 4
    s_cselect_b32 s33, 192, 0
    v_mul_u32_u24 v21, s33, v10
    s_mov_b32 m0, 41472
    v_sub_u32 v21, v8, v21
    buffer_load_dwordx4 v20, s[64:67], s76 offen  lds
    buffer_load_dwordx4 v6, s[64:67], s76 offen offset:1024  lds
    buffer_load_dwordx4 v7, s[64:67], s76 offen offset:2048  lds
    s_mov_b64 exec, 0xffffff
    buffer_load_dwordx4 v21, s[64:67], s76 offen offset:3072  lds
    s_mov_b64 exec, -1
    s_bitcmp1_b64 s[56:57], 5
    s_cselect_b32 s33, 192, 0
    v_mad_u32_u24 v20, v9, s33, v5
    s_bitcmp1_b64 s[100:101], 5
    s_cselect_b32 s33, 192, 0
    v_mul_u32_u24 v21, s33, v10
    s_mov_b32 m0, 44928
    v_sub_u32 v21, v8, v21
    buffer_load_dwordx4 v20, s[64:67], s77 offen  lds
    buffer_load_dwordx4 v6, s[64:67], s77 offen offset:1024  lds
    buffer_load_dwordx4 v7, s[64:67], s77 offen offset:2048  lds
    s_mov_b64 exec, 0xffffff
    buffer_load_dwordx4 v21, s[64:67], s77 offen offset:3072  lds
    s_mov_b64 exec, -1
    s_bitcmp1_b64 s[56:57], 6
    s_cselect_b32 s33, 192, 0
    v_mad_u32_u24 v20, v9, s33, v5
    s_bitcmp1_b64 s[100:101], 6
    s_cselect_b32 s33, 192, 0
    v_mul_u32_u24 v21, s33, v10
    s_mov_b32 m0, 48384
    v_sub_u32 v21, v8, v21
    buffer_load_dwordx4 v20, s[64:67], s78 offen  lds
    buffer_load_dwordx4 v6, s[64:67], s78 offen offset:1024  lds
    buffer_load_dwordx4 v7, s[64:67], s78 offen offset:2048  lds
    s_mov_b64 exec, 0xffffff
    buffer_load_dwordx4 v21, s[64:67], s78 offen offset:3072  lds
    s_mov_b64 exec, -1
    s_bitcmp1_b64 s[56:57], 7
    s_cselect_b32 s33, 192, 0
    v_mad_u32_u24 v20, v9, s33, v5
    s_bitcmp1_b64 s[100:101], 7
    s_cselect_b32 s33, 192, 0
    v_mul_u32_u24 v21, s33, v10
    s_mov_b32 m0, 51840
    v_sub_u32 v21, v8, v21
    buffer_load_dwordx4 v20, s[64:67], s79 offen  lds
    buffer_load_dwordx4 v6, s[64:67], s79 offen offset:1024  lds
    buffer_load_dwordx4 v7, s[64:67], s79 offen offset:2048  lds
    s_mov_b64 exec, 0xffffff
    buffer_load_dwordx4 v21, s[64:67], s79 offen offset:3072  lds
    s_mov_b64 exec, -1
    s_bitcmp1_b64 s[56:57], 8
    s_cselect_b32 s33, 192, 0
    v_mad_u32_u24 v20, v9, s33, v5
    s_bitcmp1_b64 s[100:101], 8
    s_cselect_b32 s33, 192, 0
    v_mul_u32_u24 v21, s33, v10
    s_mov_b32 m0, 55296
    v_sub_u32 v21, v8, v21
    buffer_load_dwordx4 v20, s[64:67], s54 offen  lds
    buffer_load_dwordx4 v6, s[64:67], s54 offen offset:1024  lds
    buffer_load_dwordx4 v7, s[64:67], s54 offen offset:2048  lds
    s_mov_b64 exec, 0xffffff
    buffer_load_dwordx4 v21, s[64:67], s54 offen offset:3072  lds
    s_mov_b64 exec, -1
    s_bitcmp1_b64 s[56:57], 9
    s_cselect_b32 s33, 192, 0
    v_mad_u32_u24 v20, v9, s33, v5
    s_bitcmp1_b64 s[100:101], 9
    s_cselect_b32 s33, 192, 0
    v_mul_u32_u24 v21, s33, v10
    s_mov_b32 m0, 58752
    v_sub_u32 v21, v8, v21
    buffer_load_dwordx4 v20, s[64:67], s55 offen  lds
    buffer_load_dwordx4 v6, s[64:67], s55 offen offset:1024  lds
    buffer_load_dwordx4 v7, s[64:67], s55 offen offset:2048  lds
    s_mov_b64 exec, 0xffffff
    buffer_load_dwordx4 v21, s[64:67], s55 offen offset:3072  lds
    s_mov_b64 exec, -1
L_slow2:
    s_waitcnt vmcnt(0) lgkmcnt(0)
    s_barrier
    ds_read_b64_tr_b16 a[0:1], v15 offset:0
    ds_read_b64_tr_b16 a[2:3], v15 offset:768
    ds_read_b64_tr_b16 a[4:5], v16 offset:0
    ds_read_b64_tr_b16 a[6:7], v16 offset:768
    ds_read_b64_tr_b16 a[8:9], v17 offset:0
    ds_read_b64_tr_b16 a[10:11], v17 offset:768
    ds_read_b64_tr_b16 a[12:13], v15 offset:6144
    ds_read_b64_tr_b16 a[14:15], v15 offset:6912
    ds_read_b64_tr_b16 a[16:17], v16 offset:6144
    ds_read_b64_tr_b16 a[18:19], v16 offset:6912
    ds_read_b64_tr_b16 a[20:21], v17 offset:6144
    ds_read_b64_tr_b16 a[22:23], v17 offset:6912
    ds_read_b64_tr_b16 a[24:25], v15 offset:12288
    ds_read_b64_tr_b16 a[26:27], v15 offset:13056
    ds_read_b64_tr_b16 a[28:29], v16 offset:12288
    ds_read_b64_tr_b16 a[30:31], v16 offset:13056
    ds_read_b64_tr_b16 a[32:33], v17 offset:12288
    ds_read_b64_tr_b16 a[34:35], v17 offset:13056
    s_waitcnt vmcnt(0) lgkmcnt(0)
    s_barrier
    s_cmp_eq_u32 s3, 3
    s_cbranch_scc1 L_wd_27
    s_add_u32 m0, s27, 0
    s_add_u32 s32, s4, 55296
    buffer_load_dwordx4 v11, s[16:19], s32 offen offset:0 lds
    buffer_load_dwordx4 v12, s[16:19], s32 offen offset:1024 lds
    buffer_load_dwordx4 v13, s[16:19], s32 offen offset:2048 lds
    s_add_u32 m0, s27, 3072
    s_add_u32 s32, s4, 58368
    buffer_load_dwordx4 v11, s[16:19], s32 offen offset:0 lds
    buffer_load_dwordx4 v12, s[16:19], s32 offen offset:1024 lds
    buffer_load_dwordx4 v13, s[16:19], s32 offen offset:2048 lds
L_wd_27:
    ds_read_b64_tr_b16 a[36:37], v15 offset:18432
    ds_read_b64_tr_b16 a[38:39], v15 offset:19200
    ds_read_b64_tr_b16 a[40:41], v16 offset:18432
    ds_read_b64_tr_b16 a[42:43], v16 offset:19200
    ds_read_b64_tr_b16 a[44:45], v17 offset:18432
    ds_read_b64_tr_b16 a[46:47], v17 offset:19200
    ds_read_b64_tr_b16 a[48:49], v15 offset:24576
    ds_read_b64_tr_b16 a[50:51], v15 offset:25344
    ds_read_b64_tr_b16 a[52:53], v16 offset:24576
    ds_read_b64_tr_b16 a[54:55], v16 offset:25344
    ds_read_b64_tr_b16 a[56:57], v17 offset:24576
    ds_read_b64_tr_b16 a[58:59], v17 offset:25344
    ds_read_b64_tr_b16 a[60:61], v15 offset:30720
    ds_read_b64_tr_b16 a[62:63], v15 offset:31488
    ds_read_b64_tr_b16 a[64:65], v16 offset:30720
    ds_read_b64_tr_b16 a[66:67], v16 offset:31488
    ds_read_b64_tr_b16 a[68:69], v17 offset:30720
    ds_read_b64_tr_b16 a[70:71], v17 offset:31488
    s_waitcnt vmcnt(0) lgkmcnt(0)
    s_barrier
    s_cmp_eq_u32 s3, 3
    s_cbranch_scc1 L_wd_28
    s_add_u32 m0, s27, 18432
    s_add_u32 s32, s4, 73728
    buffer_load_dwordx4 v11, s[16:19], s32 offen offset:0 lds
    buffer_load_dwordx4 v12, s[16:19], s32 offen offset:1024 lds
    buffer_load_dwordx4 v13, s[16:19], s32 offen offset:2048 lds
    s_add_u32 m0, s27, 21504
    s_add_u32 s32, s4, 76800
    buffer_load_dwordx4 v11, s[16:19], s32 offen offset:0 lds
    buffer_load_dwordx4 v12, s[16:19], s32 offen offset:1024 lds
    buffer_load_dwordx4 v13, s[16:19], s32 offen offset:2048 lds
L_wd_28:
    ds_read_b64_tr_b16 a[72:73], v15 offset:36864
    ds_read_b64_tr_b16 a[74:75], v15 offset:37632
    ds_read_b64_tr_b16 a[76:77], v16 offset:36864
    ds_read_b64_tr_b16 a[78:79], v16 offset:37632
    ds_read_b64_tr_b16 a[80:81], v17 offset:36864
    ds_read_b64_tr_b16 a[82:83], v17 offset:37632
    ds_read_b64_tr_b16 a[84:85], v15 offset:43008
    ds_read_b64_tr_b16 a[86:87], v15 offset:43776
    ds_read_b64_tr_b16 a[88:89], v16 offset:43008
    ds_read_b64_tr_b16 a[90:91], v16 offset:43776
    ds_read_b64_tr_b16 a[92:93], v17 offset:43008
    ds_read_b64_tr_b16 a[94:95], v17 offset:43776
    ds_read_b64_tr_b16 a[96:97], v15 offset:49152
    ds_read_b64_tr_b16 a[98:99], v15 offset:49920
    ds_read_b64_tr_b16 a[100:101], v16 offset:49152
    ds_read_b64_tr_b16 a[102:103], v16 offset:49920
    ds_read_b64_tr_b16 a[104:105], v17 offset:49152
    ds_read_b64_tr_b16 a[106:107], v17 offset:49920
    s_waitcnt vmcnt(0) lgkmcnt(0)
    s_barrier
    s_cmp_eq_u32 s3, 3
    s_cbranch_scc1 L_wd_29
    s_add_u32 m0, s27, 36864
    s_add_u32 s32, s4, 92160
    buffer_load_dwordx4 v11, s[16:19], s32 offen offset:0 lds
    buffer_load_dwordx4 v12, s[16:19], s32 offen offset:1024 lds
    buffer_load_dwordx4 v13, s[16:19], s32 offen offset:2048 lds
    s_add_u32 m0, s27, 39936
    s_add_u32 s32, s4, 95232
    buffer_load_dwordx4 v11, s[16:19], s32 offen offset:0 lds
    buffer_load_dwordx4 v12, s[16:19], s32 offen offset:1024 lds
    buffer_load_dwordx4 v13, s[16:19], s32 offen offset:2048 lds
L_wd_29:
    ds_read_b64_tr_b16 a[108:109], v15 offset:0
    ds_read_b64_tr_b16 a[110:111], v15 offset:768
    ds_read_b64_tr_b16 a[112:113], v16 offset:0
    ds_read_b64_tr_b16 a[114:115], v16 offset:768
    ds_read_b64_tr_b16 a[116:117], v17 offset:0
    ds_read_b64_tr_b16 a[118:119], v17 offset:768
    ds_read_b64_tr_b16 a[120:121], v15 offset:6144
    ds_read_b64_tr_b16 a[122:123], v15 offset:6912
    ds_read_b64_tr_b16 a[124:125], v16 offset:6144
    ds_read_b64_tr_b16 a[126:127], v16 offset:6912
    ds_read_b64_tr_b16 a[128:129], v17 offset:6144
    ds_read_b64_tr_b16 a[130:131], v17 offset:6912
    ds_read_b64_tr_b16 a[132:133], v15 offset:12288
    ds_read_b64_tr_b16 a[134:135], v15 offset:13056
    ds_read_b64_tr_b16 a[136:137], v16 offset:12288
    ds_read_b64_tr_b16 a[138:139], v16 offset:13056
    ds_read_b64_tr_b16 a[140:141], v17 offset:12288
    ds_read_b64_tr_b16 a[142:143], v17 offset:13056
    s_waitcnt vmcnt(0) lgkmcnt(0)
    s_barrier
    s_cmp_eq_u32 s3, 3
    s_cbranch_scc1 L_wd_30
    s_add_u32 m0, s27, 0
    s_add_u32 s32, s4, 110592
    buffer_load_dwordx4 v11, s[16:19], s32 offen offset:0 lds
    buffer_load_dwordx4 v12, s[16:19], s32 offen offset:1024 lds
    buffer_load_dwordx4 v13, s[16:19], s32 offen offset:2048 lds
    s_add_u32 m0, s27, 3072
    s_add_u32 s32, s4, 113664
    buffer_load_dwordx4 v11, s[16:19], s32 offen offset:0 lds
    buffer_load_dwordx4 v12, s[16:19], s32 offen offset:1024 lds
    buffer_load_dwordx4 v13, s[16:19], s32 offen offset:2048 lds
L_wd_30:
    ds_read_b64_tr_b16 a[144:145], v15 offset:18432
    ds_read_b64_tr_b16 a[146:147], v15 offset:19200
    ds_read_b64_tr_b16 a[148:149], v16 offset:18432
    ds_read_b64_tr_b16 a[150:151], v16 offset:19200
    ds_read_b64_tr_b16 a[152:153], v17 offset:18432
    ds_read_b64_tr_b16 a[154:155], v17 offset:19200
    ds_read_b64_tr_b16 a[156:157], v15 offset:24576
    ds_read_b64_tr_b16 a[158:159], v15 offset:25344
    ds_read_b64_tr_b16 a[160:161], v16 offset:24576
    ds_read_b64_tr_b16 a[162:163], v16 offset:25344
    ds_read_b64_tr_b16 a[164:165], v17 offset:24576
    ds_read_b64_tr_b16 a[166:167], v17 offset:25344
    ds_read_b64_tr_b16 a[168:169], v15 offset:30720
    ds_read_b64_tr_b16 a[170:171], v15 offset:31488
    ds_read_b64_tr_b16 a[172:173], v16 offset:30720
    ds_read_b64_tr_b16 a[174:175], v16 offset:31488
    ds_read_b64_tr_b16 a[176:177], v17 offset:30720
    ds_read_b64_tr_b16 a[178:179], v17 offset:31488
    s_waitcnt vmcnt(0) lgkmcnt(0)
    s_barrier
    s_cmp_eq_u32 s3, 3
    s_cbranch_scc1 L_wd_31
    s_add_u32 m0, s27, 18432
    s_add_u32 s32, s4, 129024
    buffer_load_dwordx4 v11, s[16:19], s32 offen offset:0 lds
    buffer_load_dwordx4 v12, s[16:19], s32 offen offset:1024 lds
    buffer_load_dwordx4 v13, s[16:19], s32 offen offset:2048 lds
    s_add_u32 m0, s27, 21504
    s_add_u32 s32, s4, 132096
    buffer_load_dwordx4 v11, s[16:19], s32 offen offset:0 lds
    buffer_load_dwordx4 v12, s[16:19], s32 offen offset:1024 lds
    buffer_load_dwordx4 v13, s[16:19], s32 offen offset:2048 lds
L_wd_31:
    ds_read_b64_tr_b16 a[180:181], v15 offset:36864
    ds_read_b64_tr_b16 a[182:183], v15 offset:37632
    ds_read_b64_tr_b16 a[184:185], v16 offset:36864
    ds_read_b64_tr_b16 a[186:187], v16 offset:37632
    ds_read_b64_tr_b16 a[188:189], v17 offset:36864
    ds_read_b64_tr_b16 a[190:191], v17 offset:37632
    ds_read_b64_tr_b16 a[192:193], v15 offset:43008
    ds_read_b64_tr_b16 a[194:195], v15 offset:43776
    ds_read_b64_tr_b16 a[196:197], v16 offset:43008
    ds_read_b64_tr_b16 a[198:199], v16 offset:43776
    ds_read_b64_tr_b16 a[200:201], v17 offset:43008
    ds_read_b64_tr_b16 a[202:203], v17 offset:43776
    ds_read_b64_tr_b16 a[204:205], v15 offset:49152
    ds_read_b64_tr_b16 a[206:207], v15 offset:49920
    ds_read_b64_tr_b16 a[208:209], v16 offset:49152
    ds_read_b64_tr_b16 a[210:211], v16 offset:49920
    ds_read_b64_tr_b16 a[212:213], v17 offset:49152
    ds_read_b64_tr_b16 a[214:215], v17 offset:49920
    s_waitcnt vmcnt(0) lgkmcnt(0)
    s_barrier
    s_cmp_eq_u32 s3, 3
    s_cbranch_scc1 L_wd_32
    s_add_u32 m0, s27, 36864
    s_add_u32 s32, s4, 147456
    buffer_load_dwordx4 v11, s[16:19], s32 offen offset:0 lds
    buffer_load_dwordx4 v12, s[16:19], s32 offen offset:1024 lds
    buffer_load_dwordx4 v13, s[16:19], s32 offen offset:2048 lds
    s_add_u32 m0, s27, 39936
    s_add_u32 s32, s4, 150528
    buffer_load_dwordx4 v11, s[16:19], s32 offen offset:0 lds
    buffer_load_dwordx4 v12, s[16:19], s32 offen offset:1024 lds
    buffer_load_dwordx4 v13, s[16:19], s32 offen offset:2048 lds
L_wd_32:
    ds_read_b64_tr_b16 a[216:217], v15 offset:0
    ds_read_b64_tr_b16 a[218:219], v15 offset:768
    ds_read_b64_tr_b16 a[220:221], v16 offset:0
    ds_read_b64_tr_b16 a[222:223], v16 offset:768
    ds_read_b64_tr_b16 a[224:225], v17 offset:0
    ds_read_b64_tr_b16 a[226:227], v17 offset:768
    ds_read_b64_tr_b16 a[228:229], v15 offset:6144
    ds_read_b64_tr_b16 a[230:231], v15 offset:6912
    ds_read_b64_tr_b16 a[232:233], v16 offset:6144
    ds_read_b64_tr_b16 a[234:235], v16 offset:6912
    ds_read_b64_tr_b16 a[236:237], v17 offset:6144
    ds_read_b64_tr_b16 a[238:239], v17 offset:6912
    ds_read_b64_tr_b16 a[240:241], v15 offset:12288
    ds_read_b64_tr_b16 a[242:243], v15 offset:13056
    ds_read_b64_tr_b16 a[244:245], v16 offset:12288
    ds_read_b64_tr_b16 a[246:247], v16 offset:13056
    ds_read_b64_tr_b16 a[248:249], v17 offset:12288
    ds_read_b64_tr_b16 a[250:251], v17 offset:13056
    s_waitcnt vmcnt(0) lgkmcnt(0)
    s_barrier
    ds_read_b64_tr_b16 a[252:253], v15 offset:18432
    ds_read_b64_tr_b16 a[254:255], v15 offset:19200
    ds_read_b64_tr_b16 v[188:189], v16 offset:18432
    ds_read_b64_tr_b16 v[190:191], v16 offset:19200
    ds_read_b64_tr_b16 v[192:193], v17 offset:18432
    ds_read_b64_tr_b16 v[194:195], v17 offset:19200
    ds_read_b64_tr_b16 v[196:197], v15 offset:24576
    ds_read_b64_tr_b16 v[198:199], v15 offset:25344
    ds_read_b64_tr_b16 v[200:201], v16 offset:24576
    ds_read_b64_tr_b16 v[202:203], v16 offset:25344
    ds_read_b64_tr_b16 v[204:205], v17 offset:24576
    ds_read_b64_tr_b16 v[206:207], v17 offset:25344
    ds_read_b64_tr_b16 v[208:209], v15 offset:30720
    ds_read_b64_tr_b16 v[210:211], v15 offset:31488
    ds_read_b64_tr_b16 v[212:213], v16 offset:30720
    ds_read_b64_tr_b16 v[214:215], v16 offset:31488
    ds_read_b64_tr_b16 v[216:217], v17 offset:30720
    ds_read_b64_tr_b16 v[218:219], v17 offset:31488
    s_waitcnt vmcnt(0) lgkmcnt(0)
    s_barrier
    ds_read_b64_tr_b16 v[220:221], v15 offset:36864
    ds_read_b64_tr_b16 v[222:223], v15 offset:37632
    ds_read_b64_tr_b16 v[224:225], v16 offset:36864
    ds_read_b64_tr_b16 v[226:227], v16 offset:37632
    ds_read_b64_tr_b16 v[228:229], v17 offset:36864
    ds_read_b64_tr_b16 v[230:231], v17 offset:37632
    ds_read_b64_tr_b16 v[232:233], v15 offset:43008
    ds_read_b64_tr_b16 v[234:235], v15 offset:43776
    ds_read_b64_tr_b16 v[236:237], v16 offset:43008
    ds_read_b64_tr_b16 v[238:239], v16 offset:43776
    ds_read_b64_tr_b16 v[240:241], v17 offset:43008
    ds_read_b64_tr_b16 v[242:243], v17 offset:43776
    ds_read_b64_tr_b16 v[244:245], v15 offset:49152
    ds_read_b64_tr_b16 v[246:247], v15 offset:49920
    ds_read_b64_tr_b16 v[248:249], v16 offset:49152
    ds_read_b64_tr_b16 v[250:251], v16 offset:49920
    ds_read_b64_tr_b16 v[252:253], v17 offset:49152
    ds_read_b64_tr_b16 v[254:255], v17 offset:49920
    s_mov_b32 s39, 0
L_slow_round:
    s_waitcnt vmcnt(0) lgkmcnt(0)
    s_barrier
    s_add_u32 s33, s71, s72
    s_cmp_ge_u32 s39, s33
    s_cbranch_scc1 L_sk_33
    v_cmp_gt_u32 vcc, 144, v0
    s_and_saveexec_b64 s[58:59], vcc
    s_cbranch_execz L_sk_34
    v_and_b32 v160, 15, v0
    v_lshrrev_b32 v161, 4, v0
    v_mul_u32_u24 v160, 48, v160
    v_lshl_add_u32 v160, v161, 2, v160
    s_add_u32 s32, s39, 0
    s_mul_i32 s32, s32, 768
    s_add_u32 s32, s32, 117504
    v_add_u32 v160, s32, v160
    ds_read_b32 v162, v160
    v_lshlrev_b32 v164, 3, v0
    v_add_u32 v164, 129024, v164
    s_waitcnt lgkmcnt(0)
    ds_write_b32 v164, v162
L_sk_34:
    s_mov_b64 exec, s[58:59]
    s_mov_b32 s38, 144
    s_mov_b32 s41, 0
    s_waitcnt lgkmcnt(0)
    s_barrier
    v_mul_u32_u24 v112, 4, v1
    v_add_u32 v112, s3, v112
    s_mov_b32 s35, 0
L_dt_35:
    v_cmp_gt_u32 vcc, s38, v112
    s_and_saveexec_b64 s[58:59], vcc
    s_cbranch_execz L_dd_36
    v_lshlrev_b32 v135, 3, v112
    v_add_u32 v135, 129024, v135
    ds_read_b64 v[114:115], v135
    v_mul_u32_u24 v132, 192, v112
    v_add_u32 v132, 62208, v132
    s_waitcnt lgkmcnt(0)
    v_lshlrev_b32 v116, 16, v114
    v_and_b32 v117, 0xffff0000, v114
    v_floor_f32 v118, v116
    v_floor_f32 v119, v117
    v_sub_f32 v120, v116, v118
    v_sub_f32 v121, v117, v119
    v_cvt_u32_f32 v118, v118
    v_cvt_u32_f32 v119, v119
    v_cmp_eq_f32 s[44:45], 0, v121
    v_cmp_neq_f32 s[46:47], 0, v120
    v_sub_f32 v116, 1.0, v120
    v_sub_f32 v117, 1.0, v121
    v_cvt_pk_bf16_f32 v135, v116, v117
    v_sub_u32 v123, 223, v119
    v_sub_u32 v124, 223, v118
    v_lshlrev_b32 v116, 16, v135
    v_and_b32 v117, 0xffff0000, v135
    v_min_u32 v123, 1, v123
    v_min_u32 v124, 1, v124
    v_mul_f32 v125, v116, v117
    v_mul_f32 v126, v116, v121
    v_mul_f32 v127, v120, v117
    v_mul_f32 v128, v120, v121
    v_cndmask_b32 v133, 0, 1, s[46:47]
    v_cvt_pk_bf16_f32 v129, v125, v126
    v_cvt_pk_bf16_f32 v130, v125, v127
    v_cvt_pk_bf16_f32 v131, v127, v128
    v_cndmask_b32 v133, v133, 0, s[44:45]
    v_cndmask_b32 v134, v129, v130, s[44:45]
    v_mul_u32_u24 v122, 43008, v118
    v_mul_u32_u24 v139, 192, v123
    v_mul_u32_u24 v140, 43008, v124
    v_mad_u32_u24 v144, v119, s5, v122
    v_cndmask_b32 v135, v139, v140, s[44:45]
    v_add_u32 v148, v144, v140
    v_add_u32 v145, v144, v135
    v_add_u32 v149, v148, v139
    v_mov_b32 v146, v134
    v_lshl_or_b32 v147, v133, 31, v132
    v_mul_lo_u32 v150, v131, v133
    v_mov_b32 v151, 0
    v_mbcnt_lo_u32_b32 v136, exec_lo, 0
    v_mbcnt_hi_u32_b32 v136, exec_hi, v136
    s_mul_i32 s32, s3, 2304
    s_add_u32 s33, s32, 136672
    v_add_u32 v136, s41, v136
    v_lshlrev_b32 v136, 5, v136
    v_sub_u32 v136, s33, v136
    s_bcnt1_i32_b64 s32, exec
    s_add_u32 s41, s41, s32
    ds_write_b128 v136, v[144:147]
    ds_write_b128 v136, v[148:151] offset:16
    s_mov_b64 exec, s[58:59]
L_dd_36:
    s_mov_b64 exec, s[58:59]
    s_mov_b32 s42, s41
    s_mul_i32 s43, s3, 2304
    s_add_u32 s43, s43, 136672
    s_mov_b32 s36, 0
    s_waitcnt lgkmcnt(0)
L_gt_37:
    s_cmp_ge_u32 s36, s42
    s_cbranch_scc1 L_gd_38
    s_sub_u32 s33, s42, 1
    s_add_u32 s32, s36, 0
    v_add_u32 v48, s32, v74
    v_min_u32 v48, s33, v48
    v_lshlrev_b32 v48, 5, v48
    v_sub_u32 v48, s43, v48
    ds_read_b128 v[20:23], v48
    ds_read_b128 v[24:27], v48 offset:16
    s_add_u32 s32, s36, 5
    v_add_u32 v49, s32, v74
    v_min_u32 v49, s33, v49
    v_lshlrev_b32 v49, 5, v49
    v_sub_u32 v49, s43, v49
    ds_read_b128 v[36:39], v49
    ds_read_b128 v[40:43], v49 offset:16
    s_waitcnt lgkmcnt(0)
    v_cmp_gt_i32 vcc, 0, v23
    v_add_u32 v20, v20, v75
    v_add_u32 v21, v21, v75
    buffer_load_dwordx4 v[76:79], v20, s[8:11], 0 offen
    buffer_load_dwordx4 v[80:83], v21, s[8:11], 0 offen
    s_cmp_lg_u64 vcc, 0
    s_cselect_b32 s52, 1, 0
    s_cbranch_scc0 L_g2_40
    v_add_u32 v24, v24, v75
    v_add_u32 v25, v25, v75
    buffer_load_dwordx4 v[84:87], v24, s[8:11], 0 offen
    buffer_load_dwordx4 v[88:91], v25, s[8:11], 0 offen
L_g2_40:
    s_mov_b32 s53, 0
    s_add_u32 s32, s36, 5
    s_cmp_ge_u32 s32, s42
    s_cbranch_scc1 L_g_39_b
    v_cmp_gt_i32 vcc, 0, v39
    v_add_u32 v36, v36, v75
    v_add_u32 v37, v37, v75
    buffer_load_dwordx4 v[92:95], v36, s[8:11], 0 offen
    buffer_load_dwordx4 v[96:99], v37, s[8:11], 0 offen
    s_cmp_lg_u64 vcc, 0
    s_cselect_b32 s53, 1, 0
    s_cbranch_scc0 L_g2_41
    v_add_u32 v40, v40, v75
    v_add_u32 v41, v41, v75
    buffer_load_dwordx4 v[100:103], v40, s[8:11], 0 offen
    buffer_load_dwordx4 v[104:107], v41, s[8:11], 0 offen
L_g2_41:
L_g_39_b:
    s_waitcnt vmcnt(0)
    v_and_b32 v50, 0xffff, v22
    v_lshlrev_b32 v51, 16, v22
    v_lshrrev_b32 v52, 16, v22
    v_and_b32 v53, 0xffff0000, v22
    v_dot2_f32_bf16 v60, v76, v50, 0
    v_dot2_f32_bf16 v61, v76, v51, 0
    v_dot2_f32_bf16 v62, v77, v50, 0
    v_dot2_f32_bf16 v63, v77, v51, 0
    v_dot2_f32_bf16 v64, v78, v50, 0
    v_dot2_f32_bf16 v65, v78, v51, 0
    v_dot2_f32_bf16 v66, v79, v50, 0
    v_dot2_f32_bf16 v67, v79, v51, 0
    v_dot2c_f32_bf16 v60, v80, v52
    v_dot2c_f32_bf16 v61, v80, v53
    v_dot2c_f32_bf16 v62, v81, v52
    v_dot2c_f32_bf16 v63, v81, v53
    v_dot2c_f32_bf16 v64, v82, v52
    v_dot2c_f32_bf16 v65, v82, v53
    v_dot2c_f32_bf16 v66, v83, v52
    v_dot2c_f32_bf16 v67, v83, v53
    s_cmp_eq_u32 s52, 0
    s_cbranch_scc1 L_g4_42
    v_and_b32 v50, 0xffff, v26
    v_lshlrev_b32 v51, 16, v26
    v_lshrrev_b32 v52, 16, v26
    v_and_b32 v53, 0xffff0000, v26
    v_dot2_f32_bf16 v60, v84, v50, v60
    v_dot2_f32_bf16 v61, v84, v51, v61
    v_dot2_f32_bf16 v62, v85, v50, v62
    v_dot2_f32_bf16 v63, v85, v51, v63
    v_dot2_f32_bf16 v64, v86, v50, v64
    v_dot2_f32_bf16 v65, v86, v51, v65
    v_dot2_f32_bf16 v66, v87, v50, v66
    v_dot2_f32_bf16 v67, v87, v51, v67
    v_dot2c_f32_bf16 v60, v88, v52
    v_dot2c_f32_bf16 v61, v88, v53
    v_dot2c_f32_bf16 v62, v89, v52
    v_dot2c_f32_bf16 v63, v89, v53
    v_dot2c_f32_bf16 v64, v90, v52
    v_dot2c_f32_bf16 v65, v90, v53
    v_dot2c_f32_bf16 v66, v91, v52
    v_dot2c_f32_bf16 v67, v91, v53
L_g4_42:
    v_and_b32 v23, 0x7fffffff, v23
    v_add_u32 v23, v23, v75
    s_nop 0
    v_cvt_pk_bf16_f32 v68, v60, v61
    v_cvt_pk_bf16_f32 v69, v62, v63
    v_cvt_pk_bf16_f32 v70, v64, v65
    v_cvt_pk_bf16_f32 v71, v66, v67
    ds_write_b128 v23, v[68:71]
    s_add_u32 s32, s36, 5
    s_cmp_ge_u32 s32, s42
    s_cbranch_scc1 L_g_39_c
    v_and_b32 v50, 0xffff, v38
    v_lshlrev_b32 v51, 16, v38
    v_lshrrev_b32 v52, 16, v38
    v_and_b32 v53, 0xffff0000, v38
    v_dot2_f32_bf16 v60, v92, v50, 0
    v_dot2_f32_bf16 v61, v92, v51, 0
    v_dot2_f32_bf16 v62, v93, v50, 0
    v_dot2_f32_bf16 v63, v93, v51, 0
    v_dot2_f32_bf16 v64, v94, v50, 0
    v_dot2_f32_bf16 v65, v94, v51, 0
    v_dot2_f32_bf16 v66, v95, v50, 0
    v_dot2_f32_bf16 v67, v95, v51, 0
    v_dot2c_f32_bf16 v60, v96, v52
    v_dot2c_f32_bf16 v61, v96, v53
    v_dot2c_f32_bf16 v62, v97, v52
    v_dot2c_f32_bf16 v63, v97, v53
    v_dot2c_f32_bf16 v64, v98, v52
    v_dot2c_f32_bf16 v65, v98, v53
    v_dot2c_f32_bf16 v66, v99, v52
    v_dot2c_f32_bf16 v67, v99, v53
    s_cmp_eq_u32 s53, 0
    s_cbranch_scc1 L_g4_43
    v_and_b32 v50, 0xffff, v42
    v_lshlrev_b32 v51, 16, v42
    v_lshrrev_b32 v52, 16, v42
    v_and_b32 v53, 0xffff0000, v42
    v_dot2_f32_bf16 v60, v100, v50, v60
    v_dot2_f32_bf16 v61, v100, v51, v61
    v_dot2_f32_bf16 v62, v101, v50, v62
    v_dot2_f32_bf16 v63, v101, v51, v63
    v_dot2_f32_bf16 v64, v102, v50, v64
    v_dot2_f32_bf16 v65, v102, v51, v65
    v_dot2_f32_bf16 v66, v103, v50, v66
    v_dot2_f32_bf16 v67, v103, v51, v67
    v_dot2c_f32_bf16 v60, v104, v52
    v_dot2c_f32_bf16 v61, v104, v53
    v_dot2c_f32_bf16 v62, v105, v52
    v_dot2c_f32_bf16 v63, v105, v53
    v_dot2c_f32_bf16 v64, v106, v52
    v_dot2c_f32_bf16 v65, v106, v53
    v_dot2c_f32_bf16 v66, v107, v52
    v_dot2c_f32_bf16 v67, v107, v53
L_g4_43:
    v_and_b32 v39, 0x7fffffff, v39
    v_add_u32 v39, v39, v75
    s_nop 0
    v_cvt_pk_bf16_f32 v68, v60, v61
    v_cvt_pk_bf16_f32 v69, v62, v63
    v_cvt_pk_bf16_f32 v70, v64, v65
    v_cvt_pk_bf16_f32 v71, v66, v67
    ds_write_b128 v39, v[68:71]
L_g_39_c:
    s_add_u32 s36, s36, 10
    s_branch L_gt_37
L_gd_38:
    s_waitcnt lgkmcnt(0)
    s_barrier
    s_cmp_lg_u32 s82, 0
    s_cbranch_scc1 L_sk_44
    v_mul_u32_u24 v160, 192, v2
    v_add_u32 v160, 62208, v160
    v_add_u32 v160, v160, v4
    v_add_u32 v128, 0, v160
    v_add_u32 v129, 3072, v160
    v_add_u32 v130, 6144, v160
    v_add_u32 v131, 9216, v160
    v_add_u32 v132, 12288, v160
    v_add_u32 v133, 15360, v160
    v_add_u32 v134, 18432, v160
    v_add_u32 v135, 21504, v160
    v_add_u32 v136, 24576, v160
    s_add_u32 s32, s39, 0
    s_mul_i32 s32, s32, 768
    s_add_u32 s32, s32, 117540
    v_mul_u32_u24 v160, 48, v2
    v_add_u32 v160, s32, v160
    ds_read_b32 v180, v160
    ds_read_b128 v[112:115], v128 offset:0
    s_waitcnt lgkmcnt(0)
    v_mfma_f32_16x16x32_bf16 v[76:79], a[0:3], v[112:115], 0
    v_mfma_f32_16x16x32_bf16 v[80:83], a[4:7], v[112:115], 0
    v_mfma_f32_16x16x32_bf16 v[84:87], a[8:11], v[112:115], 0
    ds_read_b128 v[112:115], v128 offset:64
    s_waitcnt lgkmcnt(0)
    v_mfma_f32_16x16x32_bf16 v[76:79], a[12:15], v[112:115], v[76:79]
    v_mfma_f32_16x16x32_bf16 v[80:83], a[16:19], v[112:115], v[80:83]
    v_mfma_f32_16x16x32_bf16 v[84:87], a[20:23], v[112:115], v[84:87]
    ds_read_b128 v[112:115], v128 offset:128
    s_waitcnt lgkmcnt(0)
    v_mfma_f32_16x16x32_bf16 v[76:79], a[24:27], v[112:115], v[76:79]
    v_mfma_f32_16x16x32_bf16 v[80:83], a[28:31], v[112:115], v[80:83]
    v_mfma_f32_16x16x32_bf16 v[84:87], a[32:35], v[112:115], v[84:87]
    ds_read_b128 v[112:115], v129 offset:0
    s_waitcnt lgkmcnt(0)
    v_mfma_f32_16x16x32_bf16 v[76:79], a[36:39], v[112:115], v[76:79]
    v_mfma_f32_16x16x32_bf16 v[80:83], a[40:43], v[112:115], v[80:83]
    v_mfma_f32_16x16x32_bf16 v[84:87], a[44:47], v[112:115], v[84:87]
    ds_read_b128 v[112:115], v129 offset:64
    s_waitcnt lgkmcnt(0)
    v_mfma_f32_16x16x32_bf16 v[76:79], a[48:51], v[112:115], v[76:79]
    v_mfma_f32_16x16x32_bf16 v[80:83], a[52:55], v[112:115], v[80:83]
    v_mfma_f32_16x16x32_bf16 v[84:87], a[56:59], v[112:115], v[84:87]
    ds_read_b128 v[112:115], v129 offset:128
    s_waitcnt lgkmcnt(0)
    v_mfma_f32_16x16x32_bf16 v[76:79], a[60:63], v[112:115], v[76:79]
    v_mfma_f32_16x16x32_bf16 v[80:83], a[64:67], v[112:115], v[80:83]
    v_mfma_f32_16x16x32_bf16 v[84:87], a[68:71], v[112:115], v[84:87]
    ds_read_b128 v[112:115], v130 offset:0
    s_waitcnt lgkmcnt(0)
    v_mfma_f32_16x16x32_bf16 v[76:79], a[72:75], v[112:115], v[76:79]
    v_mfma_f32_16x16x32_bf16 v[80:83], a[76:79], v[112:115], v[80:83]
    v_mfma_f32_16x16x32_bf16 v[84:87], a[80:83], v[112:115], v[84:87]
    ds_read_b128 v[112:115], v130 offset:64
    s_waitcnt lgkmcnt(0)
    v_mfma_f32_16x16x32_bf16 v[76:79], a[84:87], v[112:115], v[76:79]
    v_mfma_f32_16x16x32_bf16 v[80:83], a[88:91], v[112:115], v[80:83]
    v_mfma_f32_16x16x32_bf16 v[84:87], a[92:95], v[112:115], v[84:87]
    ds_read_b128 v[112:115], v130 offset:128
    s_waitcnt lgkmcnt(0)
    v_mfma_f32_16x16x32_bf16 v[76:79], a[96:99], v[112:115], v[76:79]
    v_mfma_f32_16x16x32_bf16 v[80:83], a[100:103], v[112:115], v[80:83]
    v_mfma_f32_16x16x32_bf16 v[84:87], a[104:107], v[112:115], v[84:87]
    ds_read_b128 v[112:115], v131 offset:0
    s_waitcnt lgkmcnt(0)
    v_mfma_f32_16x16x32_bf16 v[76:79], a[108:111], v[112:115], v[76:79]
    v_mfma_f32_16x16x32_bf16 v[80:83], a[112:115], v[112:115], v[80:83]
    v_mfma_f32_16x16x32_bf16 v[84:87], a[116:119], v[112:115], v[84:87]
    ds_read_b128 v[112:115], v131 offset:64
    s_waitcnt lgkmcnt(0)
    v_mfma_f32_16x16x32_bf16 v[76:79], a[120:123], v[112:115], v[76:79]
    v_mfma_f32_16x16x32_bf16 v[80:83], a[124:127], v[112:115], v[80:83]
    v_mfma_f32_16x16x32_bf16 v[84:87], a[128:131], v[112:115], v[84:87]
    ds_read_b128 v[112:115], v131 offset:128
    s_waitcnt lgkmcnt(0)
    v_mfma_f32_16x16x32_bf16 v[76:79], a[132:135], v[112:115], v[76:79]
    v_mfma_f32_16x16x32_bf16 v[80:83], a[136:139], v[112:115], v[80:83]
    v_mfma_f32_16x16x32_bf16 v[84:87], a[140:143], v[112:115], v[84:87]
    ds_read_b128 v[112:115], v132 offset:0
    s_waitcnt lgkmcnt(0)
    v_mfma_f32_16x16x32_bf16 v[76:79], a[144:147], v[112:115], v[76:79]
    v_mfma_f32_16x16x32_bf16 v[80:83], a[148:151], v[112:115], v[80:83]
    v_mfma_f32_16x16x32_bf16 v[84:87], a[152:155], v[112:115], v[84:87]
    ds_read_b128 v[112:115], v132 offset:64
    s_waitcnt lgkmcnt(0)
    v_mfma_f32_16x16x32_bf16 v[76:79], a[156:159], v[112:115], v[76:79]
    v_mfma_f32_16x16x32_bf16 v[80:83], a[160:163], v[112:115], v[80:83]
    v_mfma_f32_16x16x32_bf16 v[84:87], a[164:167], v[112:115], v[84:87]
    ds_read_b128 v[112:115], v132 offset:128
    s_waitcnt lgkmcnt(0)
    v_mfma_f32_16x16x32_bf16 v[76:79], a[168:171], v[112:115], v[76:79]
    v_mfma_f32_16x16x32_bf16 v[80:83], a[172:175], v[112:115], v[80:83]
    v_mfma_f32_16x16x32_bf16 v[84:87], a[176:179], v[112:115], v[84:87]
    ds_read_b128 v[112:115], v133 offset:0
    s_waitcnt lgkmcnt(0)
    v_mfma_f32_16x16x32_bf16 v[76:79], a[180:183], v[112:115], v[76:79]
    v_mfma_f32_16x16x32_bf16 v[80:83], a[184:187], v[112:115], v[80:83]
    v_mfma_f32_16x16x32_bf16 v[84:87], a[188:191], v[112:115], v[84:87]
    ds_read_b128 v[112:115], v133 offset:64
    s_waitcnt lgkmcnt(0)
    v_mfma_f32_16x16x32_bf16 v[76:79], a[192:195], v[112:115], v[76:79]
    v_mfma_f32_16x16x32_bf16 v[80:83], a[196:199], v[112:115], v[80:83]
    v_mfma_f32_16x16x32_bf16 v[84:87], a[200:203], v[112:115], v[84:87]
    ds_read_b128 v[112:115], v133 offset:128
    s_waitcnt lgkmcnt(0)
    v_mfma_f32_16x16x32_bf16 v[76:79], a[204:207], v[112:115], v[76:79]
    v_mfma_f32_16x16x32_bf16 v[80:83], a[208:211], v[112:115], v[80:83]
    v_mfma_f32_16x16x32_bf16 v[84:87], a[212:215], v[112:115], v[84:87]
    ds_read_b128 v[112:115], v134 offset:0
    s_waitcnt lgkmcnt(0)
    v_mfma_f32_16x16x32_bf16 v[76:79], a[216:219], v[112:115], v[76:79]
    v_mfma_f32_16x16x32_bf16 v[80:83], a[220:223], v[112:115], v[80:83]
    v_mfma_f32_16x16x32_bf16 v[84:87], a[224:227], v[112:115], v[84:87]
    ds_read_b128 v[112:115], v134 offset:64
    s_waitcnt lgkmcnt(0)
    v_mfma_f32_16x16x32_bf16 v[76:79], a[228:231], v[112:115], v[76:79]
    v_mfma_f32_16x16x32_bf16 v[80:83], a[232:235], v[112:115], v[80:83]
    v_mfma_f32_16x16x32_bf16 v[84:87], a[236:239], v[112:115], v[84:87]
    ds_read_b128 v[112:115], v134 offset:128
    s_waitcnt lgkmcnt(0)
    v_mfma_f32_16x16x32_bf16 v[76:79], a[240:243], v[112:115], v[76:79]
    v_mfma_f32_16x16x32_bf16 v[80:83], a[244:247], v[112:115], v[80:83]
    v_mfma_f32_16x16x32_bf16 v[84:87], a[248:251], v[112:115], v[84:87]
    ds_read_b128 v[112:115], v135 offset:0
    s_waitcnt lgkmcnt(0)
    v_mfma_f32_16x16x32_bf16 v[76:79], a[252:255], v[112:115], v[76:79]
    v_mfma_f32_16x16x32_bf16 v[80:83], v[188:191], v[112:115], v[80:83]
    v_mfma_f32_16x16x32_bf16 v[84:87], v[192:195], v[112:115], v[84:87]
    ds_read_b128 v[112:115], v135 offset:64
    s_waitcnt lgkmcnt(0)
    v_mfma_f32_16x16x32_bf16 v[76:79], v[196:199], v[112:115], v[76:79]
    v_mfma_f32_16x16x32_bf16 v[80:83], v[200:203], v[112:115], v[80:83]
    v_mfma_f32_16x16x32_bf16 v[84:87], v[204:207], v[112:115], v[84:87]
    ds_read_b128 v[112:115], v135 offset:128
    s_waitcnt lgkmcnt(0)
    v_mfma_f32_16x16x32_bf16 v[76:79], v[208:211], v[112:115], v[76:79]
    v_mfma_f32_16x16x32_bf16 v[80:83], v[212:215], v[112:115], v[80:83]
    v_mfma_f32_16x16x32_bf16 v[84:87], v[216:219], v[112:115], v[84:87]
    ds_read_b128 v[112:115], v136 offset:0
    s_waitcnt lgkmcnt(0)
    v_mfma_f32_16x16x32_bf16 v[76:79], v[220:223], v[112:115], v[76:79]
    v_mfma_f32_16x16x32_bf16 v[80:83], v[224:227], v[112:115], v[80:83]
    v_mfma_f32_16x16x32_bf16 v[84:87], v[228:231], v[112:115], v[84:87]
    ds_read_b128 v[112:115], v136 offset:64
    s_waitcnt lgkmcnt(0)
    v_mfma_f32_16x16x32_bf16 v[76:79], v[232:235], v[112:115], v[76:79]
    v_mfma_f32_16x16x32_bf16 v[80:83], v[236:239], v[112:115], v[80:83]
    v_mfma_f32_16x16x32_bf16 v[84:87], v[240:243], v[112:115], v[84:87]
    ds_read_b128 v[112:115], v136 offset:128
    s_waitcnt lgkmcnt(0)
    v_mfma_f32_16x16x32_bf16 v[76:79], v[244:247], v[112:115], v[76:79]
    v_mfma_f32_16x16x32_bf16 v[80:83], v[248:251], v[112:115], v[80:83]
    v_mfma_f32_16x16x32_bf16 v[84:87], v[252:255], v[112:115], v[84:87]
    s_nop 7
    v_cvt_pk_bf16_f32 v172, v76, v77
    v_cvt_pk_bf16_f32 v173, v78, v79
    v_cvt_pk_bf16_f32 v174, v80, v81
    v_cvt_pk_bf16_f32 v175, v82, v83
    v_cvt_pk_bf16_f32 v176, v84, v85
    v_cvt_pk_bf16_f32 v177, v86, v87
    s_nop 0
    v_permlane16_swap_b32 v172, v174
    v_permlane16_swap_b32 v173, v175
    v_add_u32 v178, v180, v58
    v_add_u32 v179, v180, v59
    buffer_store_dwordx2 v[176:177], v179, s[20:23], 0 offen sc1
    buffer_store_dwordx4 v[172:175], v178, s[20:23], 0 offen sc1
    s_nop 1
L_sk_44:
    s_waitcnt lgkmcnt(0)
    s_barrier
L_sk_33:
    s_sub_u32 s33, s70, s71
    s_add_u32 s33, s33, s75
    s_cmp_ge_u32 s39, s33
    s_cbranch_scc1 L_sk_45
    v_cmp_gt_u32 vcc, 144, v0
    s_and_saveexec_b64 s[58:59], vcc
    s_cbranch_execz L_sk_46
    v_and_b32 v160, 15, v0
    v_lshrrev_b32 v161, 4, v0
    v_mul_u32_u24 v160, 48, v160
    v_lshl_add_u32 v160, v161, 2, v160
    s_add_u32 s32, s39, 7
    s_mul_i32 s32, s32, 768
    s_add_u32 s32, s32, 117504
    v_add_u32 v160, s32, v160
    ds_read_b32 v162, v160
    v_lshlrev_b32 v164, 3, v0
    v_add_u32 v164, 129024, v164
    s_waitcnt lgkmcnt(0)
    ds_write_b32 v164, v162
L_sk_46:
    s_mov_b64 exec, s[58:59]
    s_mov_b32 s38, 144
    s_mov_b32 s41, 0
    s_waitcnt lgkmcnt(0)
    s_barrier
    v_mul_u32_u24 v112, 4, v1
    v_add_u32 v112, s3, v112
    s_mov_b32 s35, 0
L_dt_47:
    v_cmp_gt_u32 vcc, s38, v112
    s_and_saveexec_b64 s[58:59], vcc
    s_cbranch_execz L_dd_48
    v_lshlrev_b32 v135, 3, v112
    v_add_u32 v135, 129024, v135
    ds_read_b64 v[114:115], v135
    v_mul_u32_u24 v132, 192, v112
    v_add_u32 v132, 62208, v132
    s_waitcnt lgkmcnt(0)
    v_lshlrev_b32 v116, 16, v114
    v_and_b32 v117, 0xffff0000, v114
    v_floor_f32 v118, v116
    v_floor_f32 v119, v117
    v_sub_f32 v120, v116, v118
    v_sub_f32 v121, v117, v119
    v_cvt_u32_f32 v118, v118
    v_cvt_u32_f32 v119, v119
    v_cmp_eq_f32 s[44:45], 0, v121
    v_cmp_neq_f32 s[46:47], 0, v120
    v_sub_f32 v116, 1.0, v120
    v_sub_f32 v117, 1.0, v121
    v_cvt_pk_bf16_f32 v135, v116, v117
    v_sub_u32 v123, 223, v119
    v_sub_u32 v124, 223, v118
    v_lshlrev_b32 v116, 16, v135
    v_and_b32 v117, 0xffff0000, v135
    v_min_u32 v123, 1, v123
    v_min_u32 v124, 1, v124
    v_mul_f32 v125, v116, v117
    v_mul_f32 v126, v116, v121
    v_mul_f32 v127, v120, v117
    v_mul_f32 v128, v120, v121
    v_cndmask_b32 v133, 0, 1, s[46:47]
    v_cvt_pk_bf16_f32 v129, v125, v126
    v_cvt_pk_bf16_f32 v130, v125, v127
    v_cvt_pk_bf16_f32 v131, v127, v128
    v_cndmask_b32 v133, v133, 0, s[44:45]
    v_cndmask_b32 v134, v129, v130, s[44:45]
    v_mul_u32_u24 v122, 43008, v118
    v_mul_u32_u24 v139, 192, v123
    v_mul_u32_u24 v140, 43008, v124
    v_mad_u32_u24 v144, v119, s5, v122
    v_cndmask_b32 v135, v139, v140, s[44:45]
    v_add_u32 v148, v144, v140
    v_add_u32 v145, v144, v135
    v_add_u32 v149, v148, v139
    v_mov_b32 v146, v134
    v_lshl_or_b32 v147, v133, 31, v132
    v_mul_lo_u32 v150, v131, v133
    v_mov_b32 v151, 0
    v_mbcnt_lo_u32_b32 v136, exec_lo, 0
    v_mbcnt_hi_u32_b32 v136, exec_hi, v136
    s_mul_i32 s32, s3, 2304
    s_add_u32 s33, s32, 136672
    v_add_u32 v136, s41, v136
    v_lshlrev_b32 v136, 5, v136
    v_sub_u32 v136, s33, v136
    s_bcnt1_i32_b64 s32, exec
    s_add_u32 s41, s41, s32
    ds_write_b128 v136, v[144:147]
    ds_write_b128 v136, v[148:151] offset:16
    s_mov_b64 exec, s[58:59]
L_dd_48:
    s_mov_b64 exec, s[58:59]
    s_mov_b32 s42, s41
    s_mul_i32 s43, s3, 2304
    s_add_u32 s43, s43, 136672
    s_mov_b32 s36, 0
    s_waitcnt lgkmcnt(0)
L_gt_49:
    s_cmp_ge_u32 s36, s42
    s_cbranch_scc1 L_gd_50
    s_sub_u32 s33, s42, 1
    s_add_u32 s32, s36, 0
    v_add_u32 v48, s32, v74
    v_min_u32 v48, s33, v48
    v_lshlrev_b32 v48, 5, v48
    v_sub_u32 v48, s43, v48
    ds_read_b128 v[20:23], v48
    ds_read_b128 v[24:27], v48 offset:16
    s_add_u32 s32, s36, 5
    v_add_u32 v49, s32, v74
    v_min_u32 v49, s33, v49
    v_lshlrev_b32 v49, 5, v49
    v_sub_u32 v49, s43, v49
    ds_read_b128 v[36:39], v49
    ds_read_b128 v[40:43], v49 offset:16
    s_waitcnt lgkmcnt(0)
    v_cmp_gt_i32 vcc, 0, v23
    v_add_u32 v20, v20, v75
    v_add_u32 v21, v21, v75
    buffer_load_dwordx4 v[76:79], v20, s[8:11], 0 offen
    buffer_load_dwordx4 v[80:83], v21, s[8:11], 0 offen
    s_cmp_lg_u64 vcc, 0
    s_cselect_b32 s52, 1, 0
    s_cbranch_scc0 L_g2_52
    v_add_u32 v24, v24, v75
    v_add_u32 v25, v25, v75
    buffer_load_dwordx4 v[84:87], v24, s[8:11], 0 offen
    buffer_load_dwordx4 v[88:91], v25, s[8:11], 0 offen
L_g2_52:
    s_mov_b32 s53, 0
    s_add_u32 s32, s36, 5
    s_cmp_ge_u32 s32, s42
    s_cbranch_scc1 L_g_51_b
    v_cmp_gt_i32 vcc, 0, v39
    v_add_u32 v36, v36, v75
    v_add_u32 v37, v37, v75
    buffer_load_dwordx4 v[92:95], v36, s[8:11], 0 offen
    buffer_load_dwordx4 v[96:99], v37, s[8:11], 0 offen
    s_cmp_lg_u64 vcc, 0
    s_cselect_b32 s53, 1, 0
    s_cbranch_scc0 L_g2_53
    v_add_u32 v40, v40, v75
    v_add_u32 v41, v41, v75
    buffer_load_dwordx4 v[100:103], v40, s[8:11], 0 offen
    buffer_load_dwordx4 v[104:107], v41, s[8:11], 0 offen
L_g2_53:
L_g_51_b:
    s_waitcnt vmcnt(0)
    v_and_b32 v50, 0xffff, v22
    v_lshlrev_b32 v51, 16, v22
    v_lshrrev_b32 v52, 16, v22
    v_and_b32 v53, 0xffff0000, v22
    v_dot2_f32_bf16 v60, v76, v50, 0
    v_dot2_f32_bf16 v61, v76, v51, 0
    v_dot2_f32_bf16 v62, v77, v50, 0
    v_dot2_f32_bf16 v63, v77, v51, 0
    v_dot2_f32_bf16 v64, v78, v50, 0
    v_dot2_f32_bf16 v65, v78, v51, 0
    v_dot2_f32_bf16 v66, v79, v50, 0
    v_dot2_f32_bf16 v67, v79, v51, 0
    v_dot2c_f32_bf16 v60, v80, v52
    v_dot2c_f32_bf16 v61, v80, v53
    v_dot2c_f32_bf16 v62, v81, v52
    v_dot2c_f32_bf16 v63, v81, v53
    v_dot2c_f32_bf16 v64, v82, v52
    v_dot2c_f32_bf16 v65, v82, v53
    v_dot2c_f32_bf16 v66, v83, v52
    v_dot2c_f32_bf16 v67, v83, v53
    s_cmp_eq_u32 s52, 0
    s_cbranch_scc1 L_g4_54
    v_and_b32 v50, 0xffff, v26
    v_lshlrev_b32 v51, 16, v26
    v_lshrrev_b32 v52, 16, v26
    v_and_b32 v53, 0xffff0000, v26
    v_dot2_f32_bf16 v60, v84, v50, v60
    v_dot2_f32_bf16 v61, v84, v51, v61
    v_dot2_f32_bf16 v62, v85, v50, v62
    v_dot2_f32_bf16 v63, v85, v51, v63
    v_dot2_f32_bf16 v64, v86, v50, v64
    v_dot2_f32_bf16 v65, v86, v51, v65
    v_dot2_f32_bf16 v66, v87, v50, v66
    v_dot2_f32_bf16 v67, v87, v51, v67
    v_dot2c_f32_bf16 v60, v88, v52
    v_dot2c_f32_bf16 v61, v88, v53
    v_dot2c_f32_bf16 v62, v89, v52
    v_dot2c_f32_bf16 v63, v89, v53
    v_dot2c_f32_bf16 v64, v90, v52
    v_dot2c_f32_bf16 v65, v90, v53
    v_dot2c_f32_bf16 v66, v91, v52
    v_dot2c_f32_bf16 v67, v91, v53
L_g4_54:
    v_and_b32 v23, 0x7fffffff, v23
    v_add_u32 v23, v23, v75
    s_nop 0
    v_cvt_pk_bf16_f32 v68, v60, v61
    v_cvt_pk_bf16_f32 v69, v62, v63
    v_cvt_pk_bf16_f32 v70, v64, v65
    v_cvt_pk_bf16_f32 v71, v66, v67
    ds_write_b128 v23, v[68:71]
    s_add_u32 s32, s36, 5
    s_cmp_ge_u32 s32, s42
    s_cbranch_scc1 L_g_51_c
    v_and_b32 v50, 0xffff, v38
    v_lshlrev_b32 v51, 16, v38
    v_lshrrev_b32 v52, 16, v38
    v_and_b32 v53, 0xffff0000, v38
    v_dot2_f32_bf16 v60, v92, v50, 0
    v_dot2_f32_bf16 v61, v92, v51, 0
    v_dot2_f32_bf16 v62, v93, v50, 0
    v_dot2_f32_bf16 v63, v93, v51, 0
    v_dot2_f32_bf16 v64, v94, v50, 0
    v_dot2_f32_bf16 v65, v94, v51, 0
    v_dot2_f32_bf16 v66, v95, v50, 0
    v_dot2_f32_bf16 v67, v95, v51, 0
    v_dot2c_f32_bf16 v60, v96, v52
    v_dot2c_f32_bf16 v61, v96, v53
    v_dot2c_f32_bf16 v62, v97, v52
    v_dot2c_f32_bf16 v63, v97, v53
    v_dot2c_f32_bf16 v64, v98, v52
    v_dot2c_f32_bf16 v65, v98, v53
    v_dot2c_f32_bf16 v66, v99, v52
    v_dot2c_f32_bf16 v67, v99, v53
    s_cmp_eq_u32 s53, 0
    s_cbranch_scc1 L_g4_55
    v_and_b32 v50, 0xffff, v42
    v_lshlrev_b32 v51, 16, v42
    v_lshrrev_b32 v52, 16, v42
    v_and_b32 v53, 0xffff0000, v42
    v_dot2_f32_bf16 v60, v100, v50, v60
    v_dot2_f32_bf16 v61, v100, v51, v61
    v_dot2_f32_bf16 v62, v101, v50, v62
    v_dot2_f32_bf16 v63, v101, v51, v63
    v_dot2_f32_bf16 v64, v102, v50, v64
    v_dot2_f32_bf16 v65, v102, v51, v65
    v_dot2_f32_bf16 v66, v103, v50, v66
    v_dot2_f32_bf16 v67, v103, v51, v67
    v_dot2c_f32_bf16 v60, v104, v52
    v_dot2c_f32_bf16 v61, v104, v53
    v_dot2c_f32_bf16 v62, v105, v52
    v_dot2c_f32_bf16 v63, v105, v53
    v_dot2c_f32_bf16 v64, v106, v52
    v_dot2c_f32_bf16 v65, v106, v53
    v_dot2c_f32_bf16 v66, v107, v52
    v_dot2c_f32_bf16 v67, v107, v53
L_g4_55:
    v_and_b32 v39, 0x7fffffff, v39
    v_add_u32 v39, v39, v75
    s_nop 0
    v_cvt_pk_bf16_f32 v68, v60, v61
    v_cvt_pk_bf16_f32 v69, v62, v63
    v_cvt_pk_bf16_f32 v70, v64, v65
    v_cvt_pk_bf16_f32 v71, v66, v67
    ds_write_b128 v39, v[68:71]
L_g_51_c:
    s_add_u32 s36, s36, 10
    s_branch L_gt_49
L_gd_50:
    s_waitcnt lgkmcnt(0)
    s_barrier
    s_cmp_lg_u32 s82, 1
    s_cbranch_scc1 L_sk_56
    v_mul_u32_u24 v160, 192, v2
    v_add_u32 v160, 62208, v160
    v_add_u32 v160, v160, v4
    v_add_u32 v128, 0, v160
    v_add_u32 v129, 3072, v160
    v_add_u32 v130, 6144, v160
    v_add_u32 v131, 9216, v160
    v_add_u32 v132, 12288, v160
    v_add_u32 v133, 15360, v160
    v_add_u32 v134, 18432, v160
    v_add_u32 v135, 21504, v160
    v_add_u32 v136, 24576, v160
    s_add_u32 s32, s39, 7
    s_mul_i32 s32, s32, 768
    s_add_u32 s32, s32, 117540
    v_mul_u32_u24 v160, 48, v2
    v_add_u32 v160, s32, v160
    ds_read_b32 v180, v160
    ds_read_b128 v[112:115], v128 offset:0
    s_waitcnt lgkmcnt(0)
    v_mfma_f32_16x16x32_bf16 v[76:79], a[0:3], v[112:115], 0
    v_mfma_f32_16x16x32_bf16 v[80:83], a[4:7], v[112:115], 0
    v_mfma_f32_16x16x32_bf16 v[84:87], a[8:11], v[112:115], 0
    ds_read_b128 v[112:115], v128 offset:64
    s_waitcnt lgkmcnt(0)
    v_mfma_f32_16x16x32_bf16 v[76:79], a[12:15], v[112:115], v[76:79]
    v_mfma_f32_16x16x32_bf16 v[80:83], a[16:19], v[112:115], v[80:83]
    v_mfma_f32_16x16x32_bf16 v[84:87], a[20:23], v[112:115], v[84:87]
    ds_read_b128 v[112:115], v128 offset:128
    s_waitcnt lgkmcnt(0)
    v_mfma_f32_16x16x32_bf16 v[76:79], a[24:27], v[112:115], v[76:79]
    v_mfma_f32_16x16x32_bf16 v[80:83], a[28:31], v[112:115], v[80:83]
    v_mfma_f32_16x16x32_bf16 v[84:87], a[32:35], v[112:115], v[84:87]
    ds_read_b128 v[112:115], v129 offset:0
    s_waitcnt lgkmcnt(0)
    v_mfma_f32_16x16x32_bf16 v[76:79], a[36:39], v[112:115], v[76:79]
    v_mfma_f32_16x16x32_bf16 v[80:83], a[40:43], v[112:115], v[80:83]
    v_mfma_f32_16x16x32_bf16 v[84:87], a[44:47], v[112:115], v[84:87]
    ds_read_b128 v[112:115], v129 offset:64
    s_waitcnt lgkmcnt(0)
    v_mfma_f32_16x16x32_bf16 v[76:79], a[48:51], v[112:115], v[76:79]
    v_mfma_f32_16x16x32_bf16 v[80:83], a[52:55], v[112:115], v[80:83]
    v_mfma_f32_16x16x32_bf16 v[84:87], a[56:59], v[112:115], v[84:87]
    ds_read_b128 v[112:115], v129 offset:128
    s_waitcnt lgkmcnt(0)
    v_mfma_f32_16x16x32_bf16 v[76:79], a[60:63], v[112:115], v[76:79]
    v_mfma_f32_16x16x32_bf16 v[80:83], a[64:67], v[112:115], v[80:83]
    v_mfma_f32_16x16x32_bf16 v[84:87], a[68:71], v[112:115], v[84:87]
    ds_read_b128 v[112:115], v130 offset:0
    s_waitcnt lgkmcnt(0)
    v_mfma_f32_16x16x32_bf16 v[76:79], a[72:75], v[112:115], v[76:79]
    v_mfma_f32_16x16x32_bf16 v[80:83], a[76:79], v[112:115], v[80:83]
    v_mfma_f32_16x16x32_bf16 v[84:87], a[80:83], v[112:115], v[84:87]
    ds_read_b128 v[112:115], v130 offset:64
    s_waitcnt lgkmcnt(0)
    v_mfma_f32_16x16x32_bf16 v[76:79], a[84:87], v[112:115], v[76:79]
    v_mfma_f32_16x16x32_bf16 v[80:83], a[88:91], v[112:115], v[80:83]
    v_mfma_f32_16x16x32_bf16 v[84:87], a[92:95], v[112:115], v[84:87]
    ds_read_b128 v[112:115], v130 offset:128
    s_waitcnt lgkmcnt(0)
    v_mfma_f32_16x16x32_bf16 v[76:79], a[96:99], v[112:115], v[76:79]
    v_mfma_f32_16x16x32_bf16 v[80:83], a[100:103], v[112:115], v[80:83]
    v_mfma_f32_16x16x32_bf16 v[84:87], a[104:107], v[112:115], v[84:87]
    ds_read_b128 v[112:115], v131 offset:0
    s_waitcnt lgkmcnt(0)
    v_mfma_f32_16x16x32_bf16 v[76:79], a[108:111], v[112:115], v[76:79]
    v_mfma_f32_16x16x32_bf16 v[80:83], a[112:115], v[112:115], v[80:83]
    v_mfma_f32_16x16x32_bf16 v[84:87], a[116:119], v[112:115], v[84:87]
    ds_read_b128 v[112:115], v131 offset:64
    s_waitcnt lgkmcnt(0)
    v_mfma_f32_16x16x32_bf16 v[76:79], a[120:123], v[112:115], v[76:79]
    v_mfma_f32_16x16x32_bf16 v[80:83], a[124:127], v[112:115], v[80:83]
    v_mfma_f32_16x16x32_bf16 v[84:87], a[128:131], v[112:115], v[84:87]
    ds_read_b128 v[112:115], v131 offset:128
    s_waitcnt lgkmcnt(0)
    v_mfma_f32_16x16x32_bf16 v[76:79], a[132:135], v[112:115], v[76:79]
    v_mfma_f32_16x16x32_bf16 v[80:83], a[136:139], v[112:115], v[80:83]
    v_mfma_f32_16x16x32_bf16 v[84:87], a[140:143], v[112:115], v[84:87]
    ds_read_b128 v[112:115], v132 offset:0
    s_waitcnt lgkmcnt(0)
    v_mfma_f32_16x16x32_bf16 v[76:79], a[144:147], v[112:115], v[76:79]
    v_mfma_f32_16x16x32_bf16 v[80:83], a[148:151], v[112:115], v[80:83]
    v_mfma_f32_16x16x32_bf16 v[84:87], a[152:155], v[112:115], v[84:87]
    ds_read_b128 v[112:115], v132 offset:64
    s_waitcnt lgkmcnt(0)
    v_mfma_f32_16x16x32_bf16 v[76:79], a[156:159], v[112:115], v[76:79]
    v_mfma_f32_16x16x32_bf16 v[80:83], a[160:163], v[112:115], v[80:83]
    v_mfma_f32_16x16x32_bf16 v[84:87], a[164:167], v[112:115], v[84:87]
    ds_read_b128 v[112:115], v132 offset:128
    s_waitcnt lgkmcnt(0)
    v_mfma_f32_16x16x32_bf16 v[76:79], a[168:171], v[112:115], v[76:79]
    v_mfma_f32_16x16x32_bf16 v[80:83], a[172:175], v[112:115], v[80:83]
    v_mfma_f32_16x16x32_bf16 v[84:87], a[176:179], v[112:115], v[84:87]
    ds_read_b128 v[112:115], v133 offset:0
    s_waitcnt lgkmcnt(0)
    v_mfma_f32_16x16x32_bf16 v[76:79], a[180:183], v[112:115], v[76:79]
    v_mfma_f32_16x16x32_bf16 v[80:83], a[184:187], v[112:115], v[80:83]
    v_mfma_f32_16x16x32_bf16 v[84:87], a[188:191], v[112:115], v[84:87]
    ds_read_b128 v[112:115], v133 offset:64
    s_waitcnt lgkmcnt(0)
    v_mfma_f32_16x16x32_bf16 v[76:79], a[192:195], v[112:115], v[76:79]
    v_mfma_f32_16x16x32_bf16 v[80:83], a[196:199], v[112:115], v[80:83]
    v_mfma_f32_16x16x32_bf16 v[84:87], a[200:203], v[112:115], v[84:87]
    ds_read_b128 v[112:115], v133 offset:128
    s_waitcnt lgkmcnt(0)
    v_mfma_f32_16x16x32_bf16 v[76:79], a[204:207], v[112:115], v[76:79]
    v_mfma_f32_16x16x32_bf16 v[80:83], a[208:211], v[112:115], v[80:83]
    v_mfma_f32_16x16x32_bf16 v[84:87], a[212:215], v[112:115], v[84:87]
    ds_read_b128 v[112:115], v134 offset:0
    s_waitcnt lgkmcnt(0)
    v_mfma_f32_16x16x32_bf16 v[76:79], a[216:219], v[112:115], v[76:79]
    v_mfma_f32_16x16x32_bf16 v[80:83], a[220:223], v[112:115], v[80:83]
    v_mfma_f32_16x16x32_bf16 v[84:87], a[224:227], v[112:115], v[84:87]
    ds_read_b128 v[112:115], v134 offset:64
    s_waitcnt lgkmcnt(0)
    v_mfma_f32_16x16x32_bf16 v[76:79], a[228:231], v[112:115], v[76:79]
    v_mfma_f32_16x16x32_bf16 v[80:83], a[232:235], v[112:115], v[80:83]
    v_mfma_f32_16x16x32_bf16 v[84:87], a[236:239], v[112:115], v[84:87]
    ds_read_b128 v[112:115], v134 offset:128
    s_waitcnt lgkmcnt(0)
    v_mfma_f32_16x16x32_bf16 v[76:79], a[240:243], v[112:115], v[76:79]
    v_mfma_f32_16x16x32_bf16 v[80:83], a[244:247], v[112:115], v[80:83]
    v_mfma_f32_16x16x32_bf16 v[84:87], a[248:251], v[112:115], v[84:87]
    ds_read_b128 v[112:115], v135 offset:0
    s_waitcnt lgkmcnt(0)
    v_mfma_f32_16x16x32_bf16 v[76:79], a[252:255], v[112:115], v[76:79]
    v_mfma_f32_16x16x32_bf16 v[80:83], v[188:191], v[112:115], v[80:83]
    v_mfma_f32_16x16x32_bf16 v[84:87], v[192:195], v[112:115], v[84:87]
    ds_read_b128 v[112:115], v135 offset:64
    s_waitcnt lgkmcnt(0)
    v_mfma_f32_16x16x32_bf16 v[76:79], v[196:199], v[112:115], v[76:79]
    v_mfma_f32_16x16x32_bf16 v[80:83], v[200:203], v[112:115], v[80:83]
    v_mfma_f32_16x16x32_bf16 v[84:87], v[204:207], v[112:115], v[84:87]
    ds_read_b128 v[112:115], v135 offset:128
    s_waitcnt lgkmcnt(0)
    v_mfma_f32_16x16x32_bf16 v[76:79], v[208:211], v[112:115], v[76:79]
    v_mfma_f32_16x16x32_bf16 v[80:83], v[212:215], v[112:115], v[80:83]
    v_mfma_f32_16x16x32_bf16 v[84:87], v[216:219], v[112:115], v[84:87]
    ds_read_b128 v[112:115], v136 offset:0
    s_waitcnt lgkmcnt(0)
    v_mfma_f32_16x16x32_bf16 v[76:79], v[220:223], v[112:115], v[76:79]
    v_mfma_f32_16x16x32_bf16 v[80:83], v[224:227], v[112:115], v[80:83]
    v_mfma_f32_16x16x32_bf16 v[84:87], v[228:231], v[112:115], v[84:87]
    ds_read_b128 v[112:115], v136 offset:64
    s_waitcnt lgkmcnt(0)
    v_mfma_f32_16x16x32_bf16 v[76:79], v[232:235], v[112:115], v[76:79]
    v_mfma_f32_16x16x32_bf16 v[80:83], v[236:239], v[112:115], v[80:83]
    v_mfma_f32_16x16x32_bf16 v[84:87], v[240:243], v[112:115], v[84:87]
    ds_read_b128 v[112:115], v136 offset:128
    s_waitcnt lgkmcnt(0)
    v_mfma_f32_16x16x32_bf16 v[76:79], v[244:247], v[112:115], v[76:79]
    v_mfma_f32_16x16x32_bf16 v[80:83], v[248:251], v[112:115], v[80:83]
    v_mfma_f32_16x16x32_bf16 v[84:87], v[252:255], v[112:115], v[84:87]
    s_nop 7
    v_cvt_pk_bf16_f32 v172, v76, v77
    v_cvt_pk_bf16_f32 v173, v78, v79
    v_cvt_pk_bf16_f32 v174, v80, v81
    v_cvt_pk_bf16_f32 v175, v82, v83
    v_cvt_pk_bf16_f32 v176, v84, v85
    v_cvt_pk_bf16_f32 v177, v86, v87
    s_nop 0
    v_permlane16_swap_b32 v172, v174
    v_permlane16_swap_b32 v173, v175
    v_add_u32 v178, v180, v58
    v_add_u32 v179, v180, v59
    buffer_store_dwordx2 v[176:177], v179, s[20:23], 0 offen sc1
    buffer_store_dwordx4 v[172:175], v178, s[20:23], 0 offen sc1
    s_nop 1
L_sk_56:
    s_waitcnt lgkmcnt(0)
    s_barrier
L_sk_45:
    s_add_u32 s39, s39, 1
    s_cmp_lt_u32 s39, 7
    s_cbranch_scc1 L_slow_round
L_done:
L_end:
    s_endpgm
.p2align 3
.type L_table,@object
L_table:
    .long 0x1006a101, 0x10f6
    .long 0xb882, 0x1000
    .long 0x12d0a384, 0x1950
    .long 0x1490ab05, 0x1b10
    .long 0x1610a607, 0x1c90
    .long 0x100ca109, 0x10fc
    .long 0x1036a88a, 0x10c6
    .long 0x107aa38c, 0x108a
    .long 0x1005a1a1, 0x10f5
    .long 0xb932, 0x1010
    .long 0x12e0a424, 0x1960
    .long 0x14a0aba5, 0x1b20
    .long 0x1620a6a7, 0x1ca0
    .long 0x1051a1a9, 0x10a1
    .long 0x1046a92a, 0x10b6
    .long 0x101ba42c, 0x10eb
    .long 0x1067a241, 0x1097
    .long 0xb9e2, 0x1070
    .long 0x12f0a4c4, 0x1970
    .long 0xec45, 0x0
    .long 0x1630a747, 0x1cb0
    .long 0x1041a249, 0x10b1
    .long 0x1066a9ca, 0x1096
    .long 0x102ba4cc, 0x10db
    .long 0x1058a2e1, 0x10a8
    .long 0xba92, 0x1030
    .long 0x1300a564, 0x1980
    .long 0xed25, 0x0
    .long 0x1640a7e7, 0x1cc0
    .long 0x1061a2e9, 0x1091
    .long 0x1076aa6a, 0x1086
    .long 0x103ba56c, 0x10cb
    .long 0x1057a381, 0x10a7
    .long 0xbb42, 0x1040
    .long 0x1310a604, 0x1990
    .long 0x1004a106, 0x10f4
    .long 0x1650a887, 0x1cd0
    .long 0x1071a389, 0x1081
    .long 0x1017ab0a, 0x10e7
    .long 0x104ba60c, 0x10bb
    .long 0x105aa421, 0x10aa
    .long 0xbbf2, 0x1060
    .long 0x1320a6a4, 0x19a0
    .long 0x1063a1a6, 0x1093
    .long 0x1660a927, 0x1ce0
    .long 0x1012a429, 0x10e2
    .long 0x1027abaa, 0x10d7
    .long 0x107ba6ac, 0x108b
    .long 0x1065a4c1, 0x1095
    .long 0xbca2, 0x1050
    .long 0x1330a744, 0x19b0
    .long 0x14b0a246, 0x1b30
    .long 0x1670a9c7, 0x1cf0
    .long 0x1022a4c9, 0x10d2
    .long 0xec4a, 0x0
    .long 0x101ca74c, 0x10ec
    .long 0x1055a561, 0x10a5
    .long 0xbd52, 0x1020
    .long 0x1340a7e4, 0x19c0
    .long 0x14c0a2e6, 0x1b40
    .long 0x1680aa67, 0x1d00
    .long 0x1032a569, 0x10c2
    .long 0xed2a, 0x0
    .long 0xe7ec, 0x0
    .long 0x1069a601, 0x1099
    .long 0x1001a103, 0x10f1
    .long 0x1350a884, 0x19d0
    .long 0x14d0a386, 0x1b50
    .long 0x1690ab07, 0x1d10
    .long 0x1042a609, 0x10b2
    .long 0x1008a10b, 0x10f8
    .long 0xe8cc, 0x0
    .long 0x106aa6a1, 0x109a
    .long 0x1052a1a3, 0x10a2
    .long 0x1360a924, 0x19e0
    .long 0x14e0a426, 0x1b60
    .long 0x16a0aba7, 0x1d20
    .long 0x1072a6a9, 0x1082
    .long 0x1049a1ab, 0x10b9
    .long 0xe9ac, 0x0
    .long 0x1062a741, 0x1092
    .long 0x11b0a243, 0x1830
    .long 0x1370a9c4, 0x19f0
    .long 0x14f0a4c6, 0x1b70
    .long 0xec47, 0x0
    .long 0x1013a749, 0x10e3
    .long 0x1037a24b, 0x10c7
    .long 0xea8c, 0x0
    .long 0x105ba7e1, 0x10ab
    .long 0x11c0a2e3, 0x1840
    .long 0x1380aa64, 0x1a00
    .long 0x1500a566, 0x1b80
    .long 0xed27, 0x0
    .long 0x1023a7e9, 0x10d3
    .long 0x1047a2eb, 0x10b7
    .long 0xeb6c, 0x0
    .long 0xb881, 0x10e0
    .long 0x11d0a383, 0x1850
    .long 0x1390ab04, 0x1a10
    .long 0x1510a606, 0x1b90
    .long 0x100aa108, 0x10fa
    .long 0x1033a889, 0x10c3
    .long 0x1077a38b, 0x1087
    .long 0xec4c, 0x0
    .long 0xb931, 0x10d0
    .long 0x11e0a423, 0x1860
    .long 0x13a0aba4, 0x1a20
    .long 0x1520a6a6, 0x1ba0
    .long 0x105da1a8, 0x10ad
    .long 0x1043a929, 0x10b3
    .long 0x1018a42b, 0x10e8
    .long 0xed2c, 0x0
    .long 0xb9e1, 0x10a0
    .long 0x11f0a4c3, 0x1870
    .long 0xec44, 0x0
    .long 0x1530a746, 0x1bb0
    .long 0x16b0a248, 0x1d30
    .long 0x1073a9c9, 0x1083
    .long 0x1028a4cb, 0x10d8
    .long 0x1002a10d, 0x10f2
    .long 0xba91, 0x10f0
    .long 0x1200a563, 0x1880
    .long 0xed24, 0x0
    .long 0x1540a7e6, 0x1bc0
    .long 0x16c0a2e8, 0x1d40
    .long 0x1014aa69, 0x10e4
    .long 0x1038a56b, 0x10c8
    .long 0x106da1ad, 0x109d
    .long 0xbb41, 0x10b0
    .long 0x1210a603, 0x1890
    .long 0x1007a105, 0x10f7
    .long 0x1550a886, 0x1bd0
    .long 0x16d0a388, 0x1d50
    .long 0x1024ab09, 0x10d4
    .long 0x1048a60b, 0x10b8
    .long 0x102ca24d, 0x10dc
    .long 0xbbf1, 0x1080
    .long 0x1220a6a3, 0x18a0
    .long 0x1053a1a5, 0x10a3
    .long 0x1560a926, 0x1be0
    .long 0x16e0a428, 0x1d60
    .long 0x1034aba9, 0x10c4
    .long 0x1068a6ab, 0x1098
    .long 0x103ca2ed, 0x10cc
    .long 0xbca1, 0x1090
    .long 0x1230a743, 0x18b0
    .long 0x13b0a245, 0x1a30
    .long 0x1570a9c6, 0x1bf0
    .long 0x16f0a4c8, 0x1d70
    .long 0xec49, 0x0
    .long 0x1078a74b, 0x1088
    .long 0x104ca38d, 0x10bc
    .long 0xbd51, 0x10c0
    .long 0x1240a7e3, 0x18c0
    .long 0x13c0a2e5, 0x1a40
    .long 0x1580aa66, 0x1c00
    .long 0x1700a568, 0x1d80
    .long 0xed29, 0x0
    .long 0x1019a7eb, 0x10e9
    .long 0x107ca42d, 0x108c
    .long 0x100ba102, 0x10fb
    .long 0x1250a883, 0x18d0
    .long 0x13d0a385, 0x1a50
    .long 0x1590ab06, 0x1c10
    .long 0x1710a608, 0x1d90
    .long 0x1009a10a, 0x10f9
    .long 0x1029a88b, 0x10d9
    .long 0x101da4cd, 0x10ed
    .long 0x1180a1a2, 0x1800
    .long 0x1260a923, 0x18e0
    .long 0x13e0a425, 0x1a60
    .long 0x15a0aba6, 0x1c20
    .long 0x1720a6a8, 0x1da0
    .long 0x1054a1aa, 0x10a4
    .long 0x1039a92b, 0x10c9
    .long 0x102da56d, 0x10dd
    .long 0x1100a242, 0x1780
    .long 0x1270a9c3, 0x18f0
    .long 0x13f0a4c5, 0x1a70
    .long 0xec46, 0x0
    .long 0x1730a748, 0x1db0
    .long 0x1044a24a, 0x10b4
    .long 0x1059a9cb, 0x10a9
    .long 0x103da60d, 0x10cd
    .long 0x1110a2e2, 0x1790
    .long 0x1280aa63, 0x1900
    .long 0x1400a565, 0x1a80
    .long 0xed26, 0x0
    .long 0x1740a7e8, 0x1dc0
    .long 0x1064a2ea, 0x1094
    .long 0x1079aa6b, 0x1089
    .long 0x104da6ad, 0x10bd
    .long 0x1120a382, 0x17a0
    .long 0x1290ab03, 0x1910
    .long 0x1410a605, 0x1a90
    .long 0x1056a107, 0x10a6
    .long 0x1750a888, 0x1dd0
    .long 0x1074a38a, 0x1084
    .long 0x101aab0b, 0x10ea
    .long 0x107da74d, 0x108d
    .long 0x1130a422, 0x17b0
    .long 0x12a0aba3, 0x1920
    .long 0x1420a6a5, 0x1aa0
    .long 0x105ca1a7, 0x10ac
    .long 0x1760a928, 0x1de0
    .long 0x1015a42a, 0x10e5
    .long 0x102aabab, 0x10da
    .long 0xe7ed, 0x0
    .long 0x1140a4c2, 0x17c0
    .long 0xec43, 0x0
    .long 0x1430a745, 0x1ab0
    .long 0x15b0a247, 0x1c30
    .long 0x1770a9c8, 0x1df0
    .long 0x1025a4ca, 0x10d5
    .long 0xec4b, 0x0
    .long 0xe8cd, 0x0
    .long 0x1150a562, 0x17d0
    .long 0xed23, 0x0
    .long 0x1440a7e5, 0x1ac0
    .long 0x15c0a2e7, 0x1c40
    .long 0x1011aa68, 0x10e1
    .long 0x1035a56a, 0x10c5
    .long 0xed2b, 0x0
    .long 0xe9ad, 0x0
    .long 0x1160a602, 0x17e0
    .long 0x100da104, 0x10fd
    .long 0x1450a885, 0x1ad0
    .long 0x15d0a387, 0x1c50
    .long 0x1021ab08, 0x10d1
    .long 0x1045a60a, 0x10b5
    .long 0x1003a10c, 0x10f3
    .long 0xea8d, 0x0
    .long 0x1170a6a2, 0x17f0
    .long 0x106ca1a4, 0x109c
    .long 0x1460a925, 0x1ae0
    .long 0x15e0a427, 0x1c60
    .long 0x1031aba8, 0x10c1
    .long 0x1075a6aa, 0x1085
    .long 0x106ba1ac, 0x109b
    .long 0xeb6d, 0x0
    .long 0x1190a742, 0x1810
    .long 0x12b0a244, 0x1930
    .long 0x1470a9c5, 0x1af0
    .long 0x15f0a4c7, 0x1c70
    .long 0xec48, 0x0
    .long 0x1016a74a, 0x10e6
    .long 0x103aa24c, 0x10ca
    .long 0xec4d, 0x0
    .long 0x11a0a7e2, 0x1820
    .long 0x12c0a2e4, 0x1940
    .long 0x1480aa65, 0x1b00
    .long 0x1600a567, 0x1c80
    .long 0xed28, 0x0
    .long 0x1026a7ea, 0x10d6
    .long 0x104aa2ec, 0x10ba
    .long 0xed2d, 0x0
.size L_table, .-L_table
.section .rodata,"a"
.p2align 6
.amdhsa_kernel standalone__deformable_dcnv1__vision_kernel
  .amdhsa_next_free_vgpr 512
  .amdhsa_next_free_sgpr 102
  .amdhsa_accum_offset 256
  .amdhsa_group_segment_fixed_size 0
  .amdhsa_kernarg_size 48
  .amdhsa_user_sgpr_count 2
  .amdhsa_user_sgpr_kernarg_segment_ptr 1
  .amdhsa_system_sgpr_workgroup_id_x 1
  .amdhsa_float_denorm_mode_32 3
.end_amdhsa_kernel
```

```asm
; @launch grid=(256,1,1) block=(256,1,1) lds=158016

.amdgcn_target "amdgcn-amd-amdhsa--gfx950"
.text
.globl standalone__deformable_dcnv1__vision_kernel
.p2align 8
.type standalone__deformable_dcnv1__vision_kernel,@function
standalone__deformable_dcnv1__vision_kernel:
    s_cmp_ge_u32 s2, 256
    s_cbranch_scc1 L_end
    s_load_dwordx2 s[8:9], s[0:1], 0
    s_load_dwordx2 s[12:13], s[0:1], 8
    s_load_dwordx2 s[16:17], s[0:1], 16
    s_load_dwordx2 s[20:21], s[0:1], 24
    s_getpc_b64 s[4:5]
L_pc:
    s_lshl_b32 s24, s2, 9
    s_add_u32 s24, s24, L_table-L_pc
    s_add_u32 s6, s4, s24
    s_addc_u32 s7, s5, 0
    s_load_dwordx16 s[32:47], s[6:7], 0
    s_load_dwordx16 s[48:63], s[6:7], 64
    v_lshrrev_b32 v160, 6, v0
    v_lshlrev_b32 v161, 6, v0
    v_readfirstlane_b32 s3, v160
    global_load_dword v37, v161, s[4:5]
    v_and_b32 v1, 63, v0
    s_lshl_b32 s24, s3, 6
    s_add_u32 s24, s24, 128
    s_load_dwordx16 s[64:79], s[6:7], s24
    v_and_b32 v4, 48, v0
    v_lshrrev_b32 v160, 7, v0
    v_lshl_add_u32 v160, v160, 6, v4
    global_load_dwordx3 v[84:86], v160, s[6:7] offset:384
    v_lshlrev_b32 v5, 4, v1
    v_and_b32 v160, 32, v1
    v_xor_b32 v7, 32, v5
    v_xor_b32 v6, v160, v5
    s_lshr_b32 s30, s2, 3
    s_lshl2_add_u32 s30, s30, s3
    s_mul_i32 s30, s30, 1296
    v_min_u32 v106, 10, v1
    v_lshl_add_u32 v106, v106, 7, s30
    s_lshl_b32 s30, s3, 6
    s_min_u32 s30, s30, 152
    v_add_u32 v160, s30, v1
    v_mul_u32_u24 v100, 5462, v160
    s_lshl4_add_u32 s25, s30, 61440
    v_lshrrev_b32 v100, 16, v100
    v_lshlrev_b32 v160, 4, v160
    v_and_b32 v161, 4, v100
    v_lshlrev_b32 v161, 3, v161
    v_xor_b32 v8, v160, v161
    v_mul_u32_u24 v101, 7282, v1
    v_lshrrev_b32 v101, 16, v101
    v_mad_i32_i24 v102, v101, -9, v1
    v_lshl_add_u32 v103, v101, 2, s3
    v_lshlrev_b32 v81, 2, v102
    v_mov_b32 v162, 0x7f000000
    s_mul_i32 s24, s3, 3072
    s_and_b32 s2, s3, 1
    s_lshr_b32 s31, s3, 1
    s_mul_i32 s30, s2, 3072
    s_mul_i32 s26, s31, 55296
    s_add_u32 s26, s26, s30
    s_mul_i32 s27, s31, -104448
    s_add_u32 s27, s27, s30
    s_mul_i32 s28, s31, -49152
    s_add_u32 s28, s28, s30
    s_mul_i32 s29, s31, 43008
    s_add_u32 s29, s29, s30
    s_mul_i32 s80, s31, 6144
    s_add_u32 s80, s80, s30
    s_mov_b32 s10, 9633792
    s_mov_b32 s11, 0x20000
    s_mov_b32 s14, 1806336
    s_mov_b32 s15, 0x20000
    s_mov_b32 s18, 165888
    s_mov_b32 s19, 0x20000
    s_mov_b32 s22, 9633792
    s_mov_b32 s23, 0x20000
    s_waitcnt lgkmcnt(0)
    v_cmp_gt_u32 vcc, s39, v1
    v_mad_u32_u24 v81, v103, s38, v81
    v_min_u32 v160, s33, v100
    v_cndmask_b32 v81, v162, v81, vcc
    v_sub_u32 v160, v100, v160
    v_mul_u32_u24 v160, 192, v160
    v_sub_u32 v8, v8, v160
    buffer_load_dword v37, v106, s[16:19], 0 offen
    buffer_load_dword v64, v81, s[12:15], s34 offen
    buffer_load_dword v65, v81, s[12:15], s35 offen
    buffer_load_dword v66, v81, s[12:15], s36 offen
    buffer_load_dword v67, v81, s[12:15], s37 offen
    s_add_u32 m0, s24, 0
    s_add_u32 s30, s80, 0
    buffer_load_dwordx4 v5, s[16:19], s30 offen lds
    buffer_load_dwordx4 v6, s[16:19], s30 offen offset:1024 lds
    buffer_load_dwordx4 v7, s[16:19], s30 offen offset:2048 lds
    s_add_u32 m0, s25, 0
    s_add_u32 s30, s32, 0
    buffer_load_dwordx4 v8, s[8:11], s30 offen  lds
    s_add_u32 m0, s25, 10368
    s_add_u32 s30, s32, 129024
    buffer_load_dwordx4 v8, s[8:11], s30 offen  lds
    s_add_u32 m0, s25, 3456
    s_add_u32 s30, s32, 43008
    buffer_load_dwordx4 v8, s[8:11], s30 offen  lds
    s_add_u32 m0, s25, 13824
    s_add_u32 s30, s32, 172032
    buffer_load_dwordx4 v8, s[8:11], s30 offen  lds
    s_add_u32 m0, s25, 6912
    s_add_u32 s30, s32, 86016
    buffer_load_dwordx4 v8, s[8:11], s30 offen  lds
    s_add_u32 m0, s25, 17280
    s_add_u32 s30, s32, 215040
    buffer_load_dwordx4 v8, s[8:11], s30 offen  lds
    s_add_u32 m0, s24, 12288
    s_add_u32 s30, s29, 12288
    buffer_load_dwordx4 v5, s[16:19], s30 offen lds
    buffer_load_dwordx4 v6, s[16:19], s30 offen offset:1024 lds
    buffer_load_dwordx4 v7, s[16:19], s30 offen offset:2048 lds
    v_and_b32 v2, 15, v0
    v_lshrrev_b32 v3, 4, v1
    v_mul_u32_u24 v104, 11, v102
    v_lshrrev_b32 v104, 5, v104
    v_mad_i32_i24 v105, v104, -3, v102
    s_mul_i32 s30, s31, 3072
    s_add_u32 s30, s30, 146688
    v_mad_u32_u24 v23, v2, 48, s30
    v_mov_b32 v34, 157952
    v_mov_b32 v160, 0
    ds_write_b32 v34, v160
    s_movk_i32 s59, 192
    s_waitcnt vmcnt(17)
    v_add_u32 v167, v86, v2
    v_and_b32 v163, 0xffff, v85
    v_lshrrev_b32 v165, 16, v85
    v_add_u32 v166, -1, v167
    v_add_u32 v168, 1, v167
    v_max_i32 v166, 0, v166
    v_sub_u32 v163, v84, v163
    v_mov_b32 v164, v84
    v_add_u32 v165, v84, v165
    v_and_b32 v160, 4, v166
    v_lshlrev_b32 v160, 3, v160
    v_mad_u32_u24 v160, v166, s59, v160
    v_and_b32 v161, 4, v167
    v_lshlrev_b32 v161, 3, v161
    v_mad_u32_u24 v161, v167, s59, v161
    v_and_b32 v162, 4, v168
    v_lshlrev_b32 v162, 3, v162
    v_mad_u32_u24 v162, v168, s59, v162
    s_mov_b32 s61, 0x01000c0c
    s_mov_b32 s62, 0x03020c0c
    s_cmp_eq_u32 s41, 0
    s_cbranch_scc1 L_notr
    v_swap_b32 v160, v163
    v_swap_b32 v161, v164
    v_swap_b32 v162, v165
    v_swap_b32 v104, v105
    s_mov_b32 s62, 0x01000c0c
    s_mov_b32 s61, 0x03020c0c
L_notr:
    v_add_u32 v88, v163, v160
    v_add_u32 v89, v163, v161
    v_add_u32 v90, v163, v162
    v_add_u32 v91, v164, v160
    v_add_u32 v92, v164, v161
    v_add_u32 v93, v164, v162
    v_add_u32 v94, v165, v160
    v_add_u32 v95, v165, v161
    v_add_u32 v96, v165, v162
    v_mul_u32_u24 v160, 768, v3
    v_add_u32 v160, v160, v23
    ds_write_b128 v160, v[88:91]
    ds_write_b128 v160, v[92:95] offset:16
    ds_write_b32 v160, v96 offset:32
    s_mov_b32 s63, 0x435f435f
    v_add_u32 v160, s40, v104
    v_add3_u32 v161, v103, v105, -1
    v_cvt_f32_i32 v68, v160
    v_cvt_f32_i32 v70, v161
    v_add_f32 v69, 1.0, v68
    v_add_f32 v71, 0x41c00000, v70
    v_cvt_pk_bf16_f32 v72, v68, v70
    v_cvt_pk_bf16_f32 v73, v69, v70
    v_cvt_pk_bf16_f32 v74, v68, v71
    v_cvt_pk_bf16_f32 v75, v69, v71
    v_pk_max_i16 v72, v72, 0
    v_pk_max_i16 v73, v73, 0
    v_pk_max_i16 v74, v74, 0
    v_pk_max_i16 v75, v75, 0
    v_pk_min_i16 v72, v72, s63
    v_pk_min_i16 v73, v73, s63
    v_pk_min_i16 v74, v74, s63
    v_pk_min_i16 v75, v75, s63
    v_mad_u32_u24 v80, v103, 48, s48
    v_lshl_add_u32 v80, v102, 2, v80
    s_waitcnt lgkmcnt(0)
    s_barrier
    s_sub_u32 s30, s49, 192
    v_add_u32 v160, 0, v1
    v_mul_u32_u24 v160, 5462, v160
    v_lshrrev_b32 v160, 16, v160
    v_and_b32 v161, 4, v160
    v_lshlrev_b32 v161, 3, v161
    v_xor_b32 v161, v161, v5
    v_mad_u32_u24 v9, v160, s30, v161
    v_add_u32 v160, 64, v1
    v_mul_u32_u24 v160, 5462, v160
    v_lshrrev_b32 v160, 16, v160
    v_and_b32 v161, 4, v160
    v_lshlrev_b32 v161, 3, v161
    v_xor_b32 v161, v161, v5
    v_mad_u32_u24 v10, v160, s30, v161
    v_add_u32 v160, 128, v1
    v_mul_u32_u24 v160, 5462, v160
    v_lshrrev_b32 v160, 16, v160
    v_and_b32 v161, 4, v160
    v_lshlrev_b32 v161, 3, v161
    v_xor_b32 v161, v161, v5
    v_mad_u32_u24 v11, v160, s30, v161
    v_add_u32 v160, 152, v1
    v_mul_u32_u24 v160, 5462, v160
    v_lshrrev_b32 v160, 16, v160
    v_and_b32 v161, 4, v160
    v_lshlrev_b32 v161, 3, v161
    v_xor_b32 v161, v161, v5
    v_mad_u32_u24 v12, v160, s30, v161
    v_min_u32 v161, s50, v160
    v_sub_u32 v161, v160, v161
    v_mul_u32_u24 v161, 192, v161
    v_sub_u32 v12, v12, v161
    v_bfe_u32 v160, v1, 2, 2
    v_lshl_add_u32 v160, v3, 3, v160
    v_and_b32 v161, 3, v1
    v_mul_u32_u24 v160, 192, v160
    v_and_b32 v162, 1, v3
    v_lshl_add_u32 v160, v161, 3, v160
    s_lshl2_add_u32 s30, s2, 0
    v_xor_b32 v163, s30, v162
    v_lshl_add_u32 v13, v163, 5, v160
    s_lshl2_add_u32 s30, s2, 1
    v_xor_b32 v163, s30, v162
    v_lshl_add_u32 v14, v163, 5, v160
    s_add_u32 s30, s2, 2
    v_xor_b32 v163, s30, v162
    v_lshl_add_u32 v15, v163, 5, v160
    v_lshlrev_b32 v26, 4, v161
    v_lshl_add_u32 v26, v162, 3, v26
    v_xor_b32 v27, 8, v26
    v_lshrrev_b32 v163, 1, v3
    v_lshlrev_b32 v163, 4, v163
    v_lshl_add_u32 v163, v162, 5, v163
    v_lshl_add_u32 v163, s2, 7, v163
    v_lshl_add_u32 v164, v3, 3, 64
    v_lshl_add_u32 v164, s2, 5, v164
    v_mad_u32_u24 v19, v2, s59, v163
    v_mad_u32_u24 v20, v2, s59, v164
    v_mad_u32_u24 v21, v2, s49, v163
    v_mad_u32_u24 v22, v2, s49, v164
    s_add_u32 s4, s78, 43008
    s_add_u32 s5, s78, 86016
    s_mul_i32 s30, s31, 10368
    s_add_u32 s30, s30, 61440
    v_add_u32 v160, 0, v2
    v_and_b32 v161, 4, v160
    v_lshl_add_u32 v161, v161, 3, s30
    v_mad_u32_u24 v161, v160, s59, v161
    v_xor_b32 v16, v161, v4
    v_add_u32 v160, 1, v2
    v_and_b32 v161, 4, v160
    v_lshl_add_u32 v161, v161, 3, s30
    v_mad_u32_u24 v161, v160, s59, v161
    v_xor_b32 v17, v161, v4
    v_add_u32 v160, 2, v2
    v_and_b32 v161, 4, v160
    v_lshl_add_u32 v161, v161, 3, s30
    v_mad_u32_u24 v161, v160, s59, v161
    v_xor_b32 v18, v161, v4
    s_lshl_b32 s30, s3, 10
    s_add_u32 s30, s30, 152832
    v_lshrrev_b32 v160, 3, v1
    v_lshl_add_u32 v160, v160, 4, s30
    v_and_or_b32 v24, v1, 4, v160
    v_lshl_add_u32 v25, v2, 4, s30
    v_and_b32 v160, 14, v2
    v_lshlrev_b32 v160, 2, v160
    v_xor_b32 v160, v160, v4
    v_mad_u32_u24 v160, v2, s59, v160
    v_lshl_add_u32 v28, s24, 2, v160
    v_xor_b32 v29, 8, v28
    s_movk_i32 s30, 7488
    v_mov_b32 v162, 0x7f000000
    v_cmp_gt_u32 vcc, s52, v0
    v_mul_u32_u24 v160, 1821, v0
    v_lshrrev_b32 v160, 16, v160
    v_lshlrev_b32 v161, 4, v0
    v_mad_u32_u24 v161, v160, s30, v161
    v_lshlrev_b32 v32, v160, 1
    v_cndmask_b32 v30, v162, v161, vcc
    v_add_u32 v163, 256, v0
    v_cmp_gt_u32 vcc, s52, v163
    v_mul_u32_u24 v160, 1821, v163
    v_lshrrev_b32 v160, 16, v160
    v_lshlrev_b32 v161, 4, v163
    v_mad_u32_u24 v161, v160, s30, v161
    v_lshlrev_b32 v33, v160, 1
    v_cndmask_b32 v31, v162, v161, vcc
    s_mov_b32 s79, 0xffff
    s_mov_b32 s99, 0xff8d1000
    s_mov_b32 s96, 0
    s_add_u32 m0, s25, 20736
    s_add_u32 s30, s32, 258048
    buffer_load_dwordx4 v8, s[8:11], s30 offen  lds
    s_add_u32 m0, s25, 24192
    s_mov_b32 s30, s57
    buffer_load_dwordx4 v8, s[8:11], s30 offen  lds
    s_cmp_eq_u32 s54, 0
    s_cbranch_scc1 L_nob
    s_waitcnt vmcnt(14)
    v_perm_b32 v160, v64, v64, s61
    v_perm_b32 v161, v64, v64, s62
    v_perm_b32 v162, v65, v65, s61
    v_perm_b32 v163, v65, v65, s62
    v_perm_b32 v164, v66, v66, s61
    v_perm_b32 v165, v66, v66, s62
    v_perm_b32 v166, v67, v67, s61
    v_perm_b32 v167, v67, v67, s62
    v_add_f32 v160, v68, v160
    v_add_f32 v161, v70, v161
    v_add_f32 v162, v69, v162
    v_add_f32 v163, v70, v163
    v_add_f32 v164, v68, v164
    v_add_f32 v165, v71, v165
    v_add_f32 v166, v69, v166
    v_add_f32 v167, v71, v167
    v_cvt_pk_bf16_f32 v76, v160, v161
    v_cvt_pk_bf16_f32 v77, v162, v163
    v_cvt_pk_bf16_f32 v78, v164, v165
    v_cvt_pk_bf16_f32 v79, v166, v167
    v_pk_max_i16 v76, v76, 0
    v_pk_max_i16 v77, v77, 0
    v_pk_max_i16 v78, v78, 0
    v_pk_max_i16 v79, v79, 0
    v_pk_min_i16 v76, v76, s63
    v_pk_min_i16 v77, v77, s63
    v_pk_min_i16 v78, v78, s63
    v_pk_min_i16 v79, v79, s63
    v_xor_b32 v160, v76, v72
    v_xor_b32 v161, v77, v73
    v_xor_b32 v162, v78, v74
    v_xor_b32 v163, v79, v75
    v_cmp_ne_u16 s[80:81], 0, v160
    v_cmp_lt_u32 s[82:83], s79, v160
    v_cmp_ne_u16 s[84:85], 0, v161
    v_cmp_lt_u32 s[86:87], s79, v161
    v_cmp_ne_u16 s[88:89], 0, v162
    v_cmp_lt_u32 s[90:91], s79, v162
    v_cmp_ne_u16 s[92:93], 0, v163
    v_cmp_lt_u32 s[94:95], s79, v163
    s_xor_b64 s[80:81], s[80:81], s[82:83]
    s_andn2_b64 s[82:83], s[82:83], s[80:81]
    s_bcnt1_i32_b64 s34, s[80:81]
    s_bcnt1_i32_b64 s97, s[82:83]
    s_xor_b64 s[84:85], s[84:85], s[86:87]
    s_andn2_b64 s[86:87], s[86:87], s[84:85]
    s_bcnt1_i32_b64 s35, s[84:85]
    s_bcnt1_i32_b64 s30, s[86:87]
    s_add_u32 s97, s97, s30
    s_xor_b64 s[88:89], s[88:89], s[90:91]
    s_andn2_b64 s[90:91], s[90:91], s[88:89]
    s_bcnt1_i32_b64 s36, s[88:89]
    s_bcnt1_i32_b64 s30, s[90:91]
    s_add_u32 s97, s97, s30
    s_xor_b64 s[92:93], s[92:93], s[94:95]
    s_andn2_b64 s[94:95], s[94:95], s[92:93]
    s_bcnt1_i32_b64 s37, s[92:93]
    s_bcnt1_i32_b64 s30, s[94:95]
    s_add_u32 s97, s97, s30
    s_lshl_b32 s97, s97, 1
    s_add_u32 s30, s34, s35
    s_add_u32 s31, s36, s37
    s_add_u32 s30, s30, s97
    s_add_u32 s30, s30, s31
    s_cmp_gt_u32 s30, 64
    s_cbranch_scc1 L_bfail
    s_mov_b32 s96, s30
    s_lshl_b32 s98, s3, 6
    s_add_u32 s98, s98, 39232
    s_cmp_lg_u32 s97, 0
    s_cbranch_scc1 L_doubles
L_singles:
    s_add_u32 s98, s98, s97
    s_mov_b64 exec, s[80:81]
    v_mbcnt_lo_u32_b32 v160, s80, 0
    v_mbcnt_hi_u32_b32 v160, s81, v160
    v_add_lshl_u32 v160, v160, s98, 2
    v_mad_u32_u24 v161, v160, 48, s99
    ds_write_b32 v160, v76
    v_and_or_b32 v161, v160, 48, v161
    ds_write_b32 v80, v161 offset:0
    s_add_u32 s98, s98, s34
    s_mov_b64 exec, s[84:85]
    v_mbcnt_lo_u32_b32 v162, s84, 0
    v_mbcnt_hi_u32_b32 v162, s85, v162
    v_add_lshl_u32 v162, v162, s98, 2
    v_mad_u32_u24 v163, v162, 48, s99
    ds_write_b32 v162, v77
    v_and_or_b32 v163, v162, 48, v163
    ds_write_b32 v80, v163 offset:3072
    s_add_u32 s98, s98, s35
    s_mov_b64 exec, s[88:89]
    v_mbcnt_lo_u32_b32 v160, s88, 0
    v_mbcnt_hi_u32_b32 v160, s89, v160
    v_add_lshl_u32 v160, v160, s98, 2
    v_mad_u32_u24 v161, v160, 48, s99
    ds_write_b32 v160, v78
    v_and_or_b32 v161, v160, 48, v161
    ds_write_b32 v80, v161 offset:1152
    s_add_u32 s98, s98, s36
    s_mov_b64 exec, s[92:93]
    v_mbcnt_lo_u32_b32 v162, s92, 0
    v_mbcnt_hi_u32_b32 v162, s93, v162
    v_add_lshl_u32 v162, v162, s98, 2
    v_mad_u32_u24 v163, v162, 48, s99
    ds_write_b32 v162, v79
    v_and_or_b32 v163, v162, 48, v163
    ds_write_b32 v80, v163 offset:4224
    s_mov_b64 exec, -1
    v_lshlrev_b32 v127, 2, v0
    v_add_u32 v127, 156928, v127
    ds_read_b32 v112, v127
    v_cmp_gt_u32 s[80:81], s97, v1
    v_cmp_gt_u32 vcc, s96, v1
    v_mov_b32 v128, s47
    v_lshlrev_b32 v127, 4, v0
    v_add_u32 v127, 152832, v127
    s_and_b32 s84, s80, 0x55555555
    s_and_b32 s85, s81, 0x55555555
    s_andn2_b64 s[82:83], s[80:81], s[84:85]
    s_waitcnt lgkmcnt(0)
    v_cndmask_b32 v112, v128, v112, vcc
    v_lshlrev_b32 v113, 16, v112
    v_and_b32 v114, 0xffff0000, v112
    v_fract_f32 v119, v113
    v_fract_f32 v120, v114
    v_ceil_f32 v116, v113
    v_ceil_f32 v118, v114
    v_sub_f32 v121, 1.0, v119
    v_sub_f32 v122, 1.0, v120
    v_cvt_u32_f32 v115, v113
    v_cvt_u32_f32 v117, v114
    v_cvt_pk_bf16_f32 v122, v121, v122
    v_cvt_u32_f32 v116, v116
    v_cvt_u32_f32 v118, v118
    v_lshlrev_b32 v121, 16, v122
    v_and_b32 v122, 0xffff0000, v122
    v_mul_f32 v126, v119, v120
    v_mul_f32 v124, v121, v120
    v_mul_f32 v125, v119, v122
    v_mul_f32 v123, v121, v122
    v_subrev_u32 v115, s42, v115
    v_subrev_u32 v116, s42, v116
    v_add_f32 v128, v124, v125
    v_cvt_pk_bf16_f32 v135, v125, v126
    v_max_u32 v113, v115, v116
    v_cndmask_b32 v124, v128, v124, s[80:81]
    v_cndmask_b32 v135, 0, v135, s[80:81]
    v_cmp_le_u32 vcc, s43, v113
    v_cmp_le_u32 s[80:81], s46, v118
    v_cvt_pk_bf16_f32 v134, v123, v124
    v_cndmask_b32 v113, v115, v116, s[82:83]
    v_cndmask_b32 v114, v116, v115, s[84:85]
    v_and_b32 v128, 4, v117
    v_lshl_add_u32 v128, v128, 3, s45
    v_mad_u32_u24 v128, v117, s59, v128
    v_mad_u32_u24 v132, v113, s44, v128
    v_and_b32 v128, 4, v118
    v_lshl_add_u32 v128, v128, 3, s45
    v_mad_u32_u24 v128, v118, s59, v128
    v_mad_u32_u24 v133, v114, s44, v128
    ds_write_b128 v127, v[132:135]
    s_or_b64 vcc, vcc, s[80:81]
    s_cbranch_scc1 L_bfail
L_nob:
    s_add_u32 m0, s24, 24576
    s_add_u32 s30, s28, 110592
    buffer_load_dwordx4 v5, s[16:19], s30 offen lds
    buffer_load_dwordx4 v6, s[16:19], s30 offen offset:1024 lds
    buffer_load_dwordx4 v7, s[16:19], s30 offen offset:2048 lds
    s_add_u32 m0, s24, 36864
    s_add_u32 s30, s28, 116736
    buffer_load_dwordx4 v5, s[16:19], s30 offen lds
    buffer_load_dwordx4 v6, s[16:19], s30 offen offset:1024 lds
    buffer_load_dwordx4 v7, s[16:19], s30 offen offset:2048 lds
    s_mov_b32 s80, 0x00040001
    s_mov_b32 s81, 0x00400010
    s_lshl_b64 s[82:83], s[80:81], 1
    s_lshl_b64 s[84:85], s[80:81], 8
    s_lshl_b64 s[86:87], s[80:81], 9
    s_mov_b32 s97, 0x7fff7fff
    s_waitcnt vmcnt(17) lgkmcnt(0)
    s_barrier
    ds_read_b64_tr_b16 a[0:1], v13 offset:0
    ds_read_b64_tr_b16 a[2:3], v13 offset:768
    ds_read_b64_tr_b16 a[4:5], v14 offset:0
    ds_read_b64_tr_b16 a[6:7], v14 offset:768
    ds_read_b64_tr_b16 a[8:9], v15 offset:0
    ds_read_b64_tr_b16 a[10:11], v15 offset:768
    ds_read_b64_tr_b16 a[12:13], v13 offset:6144
    ds_read_b64_tr_b16 a[14:15], v13 offset:6912
    ds_read_b64_tr_b16 a[16:17], v14 offset:6144
    ds_read_b64_tr_b16 a[18:19], v14 offset:6912
    ds_read_b64_tr_b16 a[20:21], v15 offset:6144
    ds_read_b64_tr_b16 a[22:23], v15 offset:6912
    s_waitcnt vmcnt(8) lgkmcnt(0)
    s_barrier
    ds_read_b128 v[112:115], v16 offset:0
    ds_read_b128 v[116:119], v16 offset:3456
    ds_read_b128 v[120:123], v16 offset:6912
    ds_read_b128 v[124:127], v16 offset:64
    s_waitcnt lgkmcnt(3)
    v_mfma_f32_16x16x32_bf16 v[64:67], a[0:3], v[112:115], 0
    ds_read_b128 v[128:131], v16 offset:3520
    ds_read_b64_tr_b16 a[24:25], v13 offset:12288
    v_mfma_f32_16x16x32_bf16 v[68:71], a[4:7], v[112:115], 0
    ds_read_b64_tr_b16 a[26:27], v13 offset:13056
    s_add_u32 m0, s24, 49152
    v_mfma_f32_16x16x32_bf16 v[72:75], a[8:11], v[112:115], 0
    s_waitcnt lgkmcnt(5)
    v_mfma_f32_16x16x32_bf16 v[76:79], a[0:3], v[116:119], 0
    ds_read_b128 v[132:135], v16 offset:6976
    ds_read_b64_tr_b16 a[28:29], v14 offset:12288
    v_mfma_f32_16x16x32_bf16 v[80:83], a[4:7], v[116:119], 0
    ds_read_b64_tr_b16 a[30:31], v14 offset:13056
    s_add_u32 s30, s27, 122880
    v_mfma_f32_16x16x32_bf16 v[84:87], a[8:11], v[116:119], 0
    s_waitcnt lgkmcnt(6)
    v_mfma_f32_16x16x32_bf16 v[88:91], a[0:3], v[120:123], 0
    ds_read_b64_tr_b16 a[32:33], v15 offset:12288
    ds_read_b128 v[136:139], v16 offset:128
    v_mfma_f32_16x16x32_bf16 v[92:95], a[4:7], v[120:123], 0
    ds_read_b64_tr_b16 a[34:35], v15 offset:13056
    buffer_load_dwordx4 v5, s[16:19], s30 offen lds
    v_mfma_f32_16x16x32_bf16 v[96:99], a[8:11], v[120:123], 0
    v_mfma_f32_16x16x32_bf16 v[64:67], a[12:15], v[124:127], v[64:67]
    ds_read_b128 v[140:143], v16 offset:3584
    ds_read_b64_tr_b16 a[108:109], v13 offset:18432
    v_mfma_f32_16x16x32_bf16 v[68:71], a[16:19], v[124:127], v[68:71]
    ds_read_b64_tr_b16 a[110:111], v13 offset:19200
    buffer_load_dwordx4 v6, s[16:19], s30 offen offset:1024 lds
    v_mfma_f32_16x16x32_bf16 v[72:75], a[20:23], v[124:127], v[72:75]
    s_waitcnt lgkmcnt(6)
    v_mfma_f32_16x16x32_bf16 v[76:79], a[12:15], v[128:131], v[76:79]
    ds_read_b128 v[112:115], v16 offset:7040
    ds_read_b64_tr_b16 a[112:113], v14 offset:18432
    v_mfma_f32_16x16x32_bf16 v[80:83], a[16:19], v[128:131], v[80:83]
    ds_read_b64_tr_b16 a[114:115], v14 offset:19200
    buffer_load_dwordx4 v7, s[16:19], s30 offen offset:2048 lds
    v_mfma_f32_16x16x32_bf16 v[84:87], a[20:23], v[128:131], v[84:87]
    v_mfma_f32_16x16x32_bf16 v[88:91], a[12:15], v[132:135], v[88:91]
    ds_read_b64_tr_b16 a[116:117], v15 offset:18432
    ds_read_b128 v[116:119], v16 offset:3456
    v_mfma_f32_16x16x32_bf16 v[92:95], a[16:19], v[132:135], v[92:95]
    ds_read_b64_tr_b16 a[118:119], v15 offset:19200
    v_mfma_f32_16x16x32_bf16 v[96:99], a[20:23], v[132:135], v[96:99]
    s_waitcnt vmcnt(6) lgkmcnt(6)
    s_barrier
    v_mfma_f32_16x16x32_bf16 v[64:67], a[24:27], v[136:139], v[64:67]
    ds_read_b128 v[120:123], v16 offset:6912
    ds_read_b64_tr_b16 a[216:217], v13 offset:24576
    v_mfma_f32_16x16x32_bf16 v[68:71], a[28:31], v[136:139], v[68:71]
    ds_read_b64_tr_b16 a[218:219], v13 offset:25344
    s_add_u32 m0, s24, 0
    v_mfma_f32_16x16x32_bf16 v[72:75], a[32:35], v[136:139], v[72:75]
    s_add_u32 s30, s26, 73728
    v_mfma_f32_16x16x32_bf16 v[76:79], a[24:27], v[140:143], v[76:79]
    ds_read_b128 v[124:127], v16 offset:10368
    ds_read_b64_tr_b16 a[220:221], v14 offset:24576
    v_mfma_f32_16x16x32_bf16 v[80:83], a[28:31], v[140:143], v[80:83]
    ds_read_b64_tr_b16 a[222:223], v14 offset:25344
    buffer_load_dwordx4 v5, s[16:19], s30 offen lds
    v_mfma_f32_16x16x32_bf16 v[84:87], a[32:35], v[140:143], v[84:87]
    buffer_load_dwordx4 v6, s[16:19], s30 offen offset:1024 lds
    s_waitcnt lgkmcnt(6)
    v_mfma_f32_16x16x32_bf16 v[88:91], a[24:27], v[112:115], v[88:91]
    ds_read_b64_tr_b16 a[224:225], v15 offset:24576
    buffer_load_dwordx4 v7, s[16:19], s30 offen offset:2048 lds
    v_mfma_f32_16x16x32_bf16 v[92:95], a[28:31], v[112:115], v[92:95]
    ds_read_b64_tr_b16 a[226:227], v15 offset:25344
    v_mfma_f32_16x16x32_bf16 v[96:99], a[32:35], v[112:115], v[96:99]
    s_mov_b32 m0, s64
    v_mfma_f32_16x16x32_bf16 v[64:67], a[108:111], v[116:119], v[64:67]
    ds_read_b64_tr_b16 a[120:121], v13 offset:30720
    v_mfma_f32_16x16x32_bf16 v[68:71], a[112:115], v[116:119], v[68:71]
    ds_read_b64_tr_b16 a[122:123], v13 offset:31488
    buffer_load_dwordx4 v9, s[8:11], s65 offen  lds
    v_mfma_f32_16x16x32_bf16 v[72:75], a[116:119], v[116:119], v[72:75]
    buffer_load_dwordx4 v10, s[8:11], s65 offen offset:1024  lds
    s_waitcnt lgkmcnt(4)
    v_mfma_f32_16x16x32_bf16 v[76:79], a[108:111], v[120:123], v[76:79]
    ds_read_b64_tr_b16 a[124:125], v14 offset:30720
    v_mfma_f32_16x16x32_bf16 v[80:83], a[112:115], v[120:123], v[80:83]
    ds_read_b64_tr_b16 a[126:127], v14 offset:31488
    buffer_load_dwordx4 v11, s[8:11], s65 offen offset:2048  lds
    v_mfma_f32_16x16x32_bf16 v[84:87], a[116:119], v[120:123], v[84:87]
    v_mfma_f32_16x16x32_bf16 v[88:91], a[108:111], v[124:127], v[88:91]
    ds_read_b64_tr_b16 a[128:129], v15 offset:30720
    buffer_load_dwordx4 v12, s[8:11], s65 offen offset:2432  lds
    v_mfma_f32_16x16x32_bf16 v[92:95], a[112:115], v[124:127], v[92:95]
    ds_read_b64_tr_b16 a[130:131], v15 offset:31488
    v_mfma_f32_16x16x32_bf16 v[96:99], a[116:119], v[124:127], v[96:99]
    s_waitcnt vmcnt(10) lgkmcnt(4)
    s_barrier
    v_mfma_f32_16x16x32_bf16 v[64:67], a[216:219], v[120:123], v[64:67]
    ds_read_b128 v[128:131], v16 offset:13824
    ds_read_b128 v[132:135], v16 offset:3520
    v_mfma_f32_16x16x32_bf16 v[68:71], a[220:223], v[120:123], v[68:71]
    ds_read_b128 v[136:139], v16 offset:6976
    ds_read_b64_tr_b16 a[228:229], v13 offset:36864
    v_mfma_f32_16x16x32_bf16 v[72:75], a[224:227], v[120:123], v[72:75]
    ds_read_b64_tr_b16 a[230:231], v13 offset:37632
    s_add_u32 m0, s24, 12288
    v_mfma_f32_16x16x32_bf16 v[76:79], a[216:219], v[124:127], v[76:79]
    ds_read_b128 v[140:143], v16 offset:10432
    ds_read_b64_tr_b16 a[232:233], v14 offset:36864
    v_mfma_f32_16x16x32_bf16 v[80:83], a[220:223], v[124:127], v[80:83]
    ds_read_b64_tr_b16 a[234:235], v14 offset:37632
    s_add_u32 s30, s26, 24576
    v_mfma_f32_16x16x32_bf16 v[84:87], a[224:227], v[124:127], v[84:87]
    s_waitcnt lgkmcnt(7)
    v_mfma_f32_16x16x32_bf16 v[88:91], a[216:219], v[128:131], v[88:91]
    ds_read_b64_tr_b16 a[236:237], v15 offset:36864
    buffer_load_dwordx4 v5, s[16:19], s30 offen lds
    v_mfma_f32_16x16x32_bf16 v[92:95], a[220:223], v[128:131], v[92:95]
    ds_read_b64_tr_b16 a[238:239], v15 offset:37632
    v_mfma_f32_16x16x32_bf16 v[96:99], a[224:227], v[128:131], v[96:99]
    s_waitcnt lgkmcnt(5)
    v_mfma_f32_16x16x32_bf16 v[64:67], a[120:123], v[132:135], v[64:67]
    ds_read_b64_tr_b16 a[132:133], v13 offset:43008
    v_mfma_f32_16x16x32_bf16 v[68:71], a[124:127], v[132:135], v[68:71]
    ds_read_b64_tr_b16 a[134:135], v13 offset:43776
    buffer_load_dwordx4 v6, s[16:19], s30 offen offset:1024 lds
    v_mfma_f32_16x16x32_bf16 v[72:75], a[128:131], v[132:135], v[72:75]
    v_mfma_f32_16x16x32_bf16 v[76:79], a[120:123], v[136:139], v[76:79]
    ds_read_b128 v[112:115], v16 offset:13888
    ds_read_b64_tr_b16 a[136:137], v14 offset:43008
    v_mfma_f32_16x16x32_bf16 v[80:83], a[124:127], v[136:139], v[80:83]
    ds_read_b64_tr_b16 a[138:139], v14 offset:43776
    buffer_load_dwordx4 v7, s[16:19], s30 offen offset:2048 lds
    v_mfma_f32_16x16x32_bf16 v[84:87], a[128:131], v[136:139], v[84:87]
    s_waitcnt lgkmcnt(5)
    v_mfma_f32_16x16x32_bf16 v[88:91], a[120:123], v[140:143], v[88:91]
    ds_read_b64_tr_b16 a[140:141], v15 offset:43008
    ds_read_b128 v[116:119], v16 offset:3584
    v_mfma_f32_16x16x32_bf16 v[92:95], a[124:127], v[140:143], v[92:95]
    ds_read_b64_tr_b16 a[142:143], v15 offset:43776
    v_mfma_f32_16x16x32_bf16 v[96:99], a[128:131], v[140:143], v[96:99]
    s_waitcnt vmcnt(10) lgkmcnt(6)
    s_barrier
    v_mfma_f32_16x16x32_bf16 v[64:67], a[228:231], v[136:139], v[64:67]
    ds_read_b128 v[120:123], v16 offset:7040
    ds_read_b64_tr_b16 a[240:241], v13 offset:49152
    v_mfma_f32_16x16x32_bf16 v[68:71], a[232:235], v[136:139], v[68:71]
    ds_read_b64_tr_b16 a[242:243], v13 offset:49920
    s_add_u32 m0, s24, 24576
    v_mfma_f32_16x16x32_bf16 v[72:75], a[236:239], v[136:139], v[72:75]
    v_mfma_f32_16x16x32_bf16 v[76:79], a[228:231], v[140:143], v[76:79]
    ds_read_b128 v[124:127], v16 offset:10496
    ds_read_b64_tr_b16 a[244:245], v14 offset:49152
    v_mfma_f32_16x16x32_bf16 v[80:83], a[232:235], v[140:143], v[80:83]
    ds_read_b64_tr_b16 a[246:247], v14 offset:49920
    s_add_u32 s30, s27, 135168
    v_mfma_f32_16x16x32_bf16 v[84:87], a[236:239], v[140:143], v[84:87]
    s_waitcnt lgkmcnt(6)
    v_mfma_f32_16x16x32_bf16 v[88:91], a[228:231], v[112:115], v[88:91]
    ds_read_b64_tr_b16 a[248:249], v15 offset:49152
    buffer_load_dwordx4 v5, s[16:19], s30 offen lds
    v_mfma_f32_16x16x32_bf16 v[92:95], a[232:235], v[112:115], v[92:95]
    ds_read_b64_tr_b16 a[250:251], v15 offset:49920
    v_mfma_f32_16x16x32_bf16 v[96:99], a[236:239], v[112:115], v[96:99]
    v_mfma_f32_16x16x32_bf16 v[64:67], a[132:135], v[116:119], v[64:67]
    ds_read_b64_tr_b16 a[36:37], v13 offset:55296
    v_mfma_f32_16x16x32_bf16 v[68:71], a[136:139], v[116:119], v[68:71]
    ds_read_b64_tr_b16 a[38:39], v13 offset:56064
    buffer_load_dwordx4 v6, s[16:19], s30 offen offset:1024 lds
    v_mfma_f32_16x16x32_bf16 v[72:75], a[140:143], v[116:119], v[72:75]
    s_waitcnt lgkmcnt(4)
    v_mfma_f32_16x16x32_bf16 v[76:79], a[132:135], v[120:123], v[76:79]
    ds_read_b128 v[128:131], v16 offset:13952
    ds_read_b64_tr_b16 a[40:41], v14 offset:55296
    v_mfma_f32_16x16x32_bf16 v[80:83], a[136:139], v[120:123], v[80:83]
    ds_read_b64_tr_b16 a[42:43], v14 offset:56064
    buffer_load_dwordx4 v7, s[16:19], s30 offen offset:2048 lds
    v_mfma_f32_16x16x32_bf16 v[84:87], a[140:143], v[120:123], v[84:87]
    v_mfma_f32_16x16x32_bf16 v[88:91], a[132:135], v[124:127], v[88:91]
    ds_read_b64_tr_b16 a[44:45], v15 offset:55296
    ds_read_b128 v[132:135], v17 offset:0
    v_mfma_f32_16x16x32_bf16 v[92:95], a[136:139], v[124:127], v[92:95]
    ds_read_b64_tr_b16 a[46:47], v15 offset:56064
    v_mfma_f32_16x16x32_bf16 v[96:99], a[140:143], v[124:127], v[96:99]
    s_waitcnt vmcnt(10) lgkmcnt(6)
    s_barrier
    v_mfma_f32_16x16x32_bf16 v[64:67], a[240:243], v[120:123], v[64:67]
    ds_read_b128 v[136:139], v17 offset:3456
    ds_read_b64_tr_b16 a[144:145], v13 offset:0
    v_mfma_f32_16x16x32_bf16 v[68:71], a[244:247], v[120:123], v[68:71]
    ds_read_b64_tr_b16 a[146:147], v13 offset:768
    s_add_u32 m0, s24, 36864
    v_mfma_f32_16x16x32_bf16 v[72:75], a[248:251], v[120:123], v[72:75]
    s_add_u32 s30, s26, 86016
    v_mfma_f32_16x16x32_bf16 v[76:79], a[240:243], v[124:127], v[76:79]
    ds_read_b128 v[140:143], v17 offset:6912
    ds_read_b64_tr_b16 a[148:149], v14 offset:0
    v_mfma_f32_16x16x32_bf16 v[80:83], a[244:247], v[124:127], v[80:83]
    ds_read_b64_tr_b16 a[150:151], v14 offset:768
    buffer_load_dwordx4 v5, s[16:19], s30 offen lds
    v_mfma_f32_16x16x32_bf16 v[84:87], a[248:251], v[124:127], v[84:87]
    buffer_load_dwordx4 v6, s[16:19], s30 offen offset:1024 lds
    s_waitcnt lgkmcnt(6)
    v_mfma_f32_16x16x32_bf16 v[88:91], a[240:243], v[128:131], v[88:91]
    ds_read_b64_tr_b16 a[152:153], v15 offset:0
    buffer_load_dwordx4 v7, s[16:19], s30 offen offset:2048 lds
    v_mfma_f32_16x16x32_bf16 v[92:95], a[244:247], v[128:131], v[92:95]
    ds_read_b64_tr_b16 a[154:155], v15 offset:768
    v_mfma_f32_16x16x32_bf16 v[96:99], a[248:251], v[128:131], v[96:99]
    s_mov_b32 m0, s66
    v_mfma_f32_16x16x32_bf16 v[64:67], a[36:39], v[132:135], v[64:67]
    ds_read_b64_tr_b16 a[252:253], v13 offset:6144
    v_mfma_f32_16x16x32_bf16 v[68:71], a[40:43], v[132:135], v[68:71]
    ds_read_b64_tr_b16 a[254:255], v13 offset:6912
    buffer_load_dwordx4 v9, s[8:11], s67 offen  lds
    v_mfma_f32_16x16x32_bf16 v[72:75], a[44:47], v[132:135], v[72:75]
    buffer_load_dwordx4 v10, s[8:11], s67 offen offset:1024  lds
    s_waitcnt lgkmcnt(4)
    v_mfma_f32_16x16x32_bf16 v[76:79], a[36:39], v[136:139], v[76:79]
    ds_read_b128 v[112:115], v17 offset:10368
    ds_read_b64_tr_b16 v[188:189], v14 offset:6144
    v_mfma_f32_16x16x32_bf16 v[80:83], a[40:43], v[136:139], v[80:83]
    ds_read_b64_tr_b16 v[190:191], v14 offset:6912
    buffer_load_dwordx4 v11, s[8:11], s67 offen offset:2048  lds
    v_mfma_f32_16x16x32_bf16 v[84:87], a[44:47], v[136:139], v[84:87]
    v_mfma_f32_16x16x32_bf16 v[88:91], a[36:39], v[140:143], v[88:91]
    ds_read_b64_tr_b16 v[192:193], v15 offset:6144
    buffer_load_dwordx4 v12, s[8:11], s67 offen offset:2432  lds
    v_mfma_f32_16x16x32_bf16 v[92:95], a[40:43], v[140:143], v[92:95]
    ds_read_b64_tr_b16 v[194:195], v15 offset:6912
    v_mfma_f32_16x16x32_bf16 v[96:99], a[44:47], v[140:143], v[96:99]
    s_waitcnt vmcnt(10) lgkmcnt(5)
    s_barrier
    v_mfma_f32_16x16x32_bf16 v[64:67], a[144:147], v[136:139], v[64:67]
    ds_read_b64_tr_b16 a[48:49], v13 offset:12288
    s_add_u32 m0, s24, 49152
    v_mfma_f32_16x16x32_bf16 v[68:71], a[148:151], v[136:139], v[68:71]
    ds_read_b64_tr_b16 a[50:51], v13 offset:13056
    v_mfma_f32_16x16x32_bf16 v[72:75], a[152:155], v[136:139], v[72:75]
    v_mfma_f32_16x16x32_bf16 v[76:79], a[144:147], v[140:143], v[76:79]
    ds_read_b128 v[116:119], v17 offset:13824
    ds_read_b64_tr_b16 a[52:53], v14 offset:12288
    v_mfma_f32_16x16x32_bf16 v[80:83], a[148:151], v[140:143], v[80:83]
    ds_read_b64_tr_b16 a[54:55], v14 offset:13056
    s_add_u32 s30, s26, 36864
    v_mfma_f32_16x16x32_bf16 v[84:87], a[152:155], v[140:143], v[84:87]
    s_waitcnt lgkmcnt(5)
    v_mfma_f32_16x16x32_bf16 v[88:91], a[144:147], v[112:115], v[88:91]
    ds_read_b64_tr_b16 a[56:57], v15 offset:12288
    ds_read_b128 v[120:123], v17 offset:64
    v_mfma_f32_16x16x32_bf16 v[92:95], a[148:151], v[112:115], v[92:95]
    ds_read_b64_tr_b16 a[58:59], v15 offset:13056
    buffer_load_dwordx4 v5, s[16:19], s30 offen lds
    v_mfma_f32_16x16x32_bf16 v[96:99], a[152:155], v[112:115], v[96:99]
    v_mfma_f32_16x16x32_bf16 v[64:67], a[252:255], v[140:143], v[64:67]
    ds_read_b128 v[124:127], v17 offset:3520
    ds_read_b64_tr_b16 a[156:157], v13 offset:18432
    v_mfma_f32_16x16x32_bf16 v[68:71], v[188:191], v[140:143], v[68:71]
    ds_read_b64_tr_b16 a[158:159], v13 offset:19200
    buffer_load_dwordx4 v6, s[16:19], s30 offen offset:1024 lds
    v_mfma_f32_16x16x32_bf16 v[72:75], v[192:195], v[140:143], v[72:75]
    v_mfma_f32_16x16x32_bf16 v[76:79], a[252:255], v[112:115], v[76:79]
    ds_read_b128 v[128:131], v17 offset:6976
    ds_read_b64_tr_b16 a[160:161], v14 offset:18432
    v_mfma_f32_16x16x32_bf16 v[80:83], v[188:191], v[112:115], v[80:83]
    ds_read_b64_tr_b16 a[162:163], v14 offset:19200
    buffer_load_dwordx4 v7, s[16:19], s30 offen offset:2048 lds
    v_mfma_f32_16x16x32_bf16 v[84:87], v[192:195], v[112:115], v[84:87]
    s_waitcnt lgkmcnt(6)
    v_mfma_f32_16x16x32_bf16 v[88:91], a[252:255], v[116:119], v[88:91]
    ds_read_b64_tr_b16 a[164:165], v15 offset:18432
    v_mfma_f32_16x16x32_bf16 v[92:95], v[188:191], v[116:119], v[92:95]
    ds_read_b64_tr_b16 a[166:167], v15 offset:19200
    v_mfma_f32_16x16x32_bf16 v[96:99], v[192:195], v[116:119], v[96:99]
    s_waitcnt vmcnt(10) lgkmcnt(5)
    s_barrier
    v_mfma_f32_16x16x32_bf16 v[64:67], a[48:51], v[120:123], v[64:67]
    ds_read_b64_tr_b16 v[196:197], v13 offset:24576
    s_add_u32 m0, s24, 0
    v_mfma_f32_16x16x32_bf16 v[68:71], a[52:55], v[120:123], v[68:71]
    ds_read_b64_tr_b16 v[198:199], v13 offset:25344
    v_mfma_f32_16x16x32_bf16 v[72:75], a[56:59], v[120:123], v[72:75]
    v_mfma_f32_16x16x32_bf16 v[76:79], a[48:51], v[124:127], v[76:79]
    ds_read_b128 v[132:135], v17 offset:10432
    ds_read_b64_tr_b16 v[200:201], v14 offset:24576
    v_mfma_f32_16x16x32_bf16 v[80:83], a[52:55], v[124:127], v[80:83]
    ds_read_b64_tr_b16 v[202:203], v14 offset:25344
    s_add_u32 s30, s27, 147456
    v_mfma_f32_16x16x32_bf16 v[84:87], a[56:59], v[124:127], v[84:87]
    s_waitcnt lgkmcnt(5)
    v_mfma_f32_16x16x32_bf16 v[88:91], a[48:51], v[128:131], v[88:91]
    ds_read_b64_tr_b16 v[204:205], v15 offset:24576
    buffer_load_dwordx4 v5, s[16:19], s30 offen lds
    v_mfma_f32_16x16x32_bf16 v[92:95], a[52:55], v[128:131], v[92:95]
    ds_read_b64_tr_b16 v[206:207], v15 offset:25344
    v_mfma_f32_16x16x32_bf16 v[96:99], a[56:59], v[128:131], v[96:99]
    v_mfma_f32_16x16x32_bf16 v[64:67], a[156:159], v[124:127], v[64:67]
    ds_read_b64_tr_b16 a[60:61], v13 offset:30720
    v_mfma_f32_16x16x32_bf16 v[68:71], a[160:163], v[124:127], v[68:71]
    ds_read_b64_tr_b16 a[62:63], v13 offset:31488
    buffer_load_dwordx4 v6, s[16:19], s30 offen offset:1024 lds
    v_mfma_f32_16x16x32_bf16 v[72:75], a[164:167], v[124:127], v[72:75]
    v_mfma_f32_16x16x32_bf16 v[76:79], a[156:159], v[128:131], v[76:79]
    ds_read_b128 v[136:139], v17 offset:13888
    ds_read_b64_tr_b16 a[64:65], v14 offset:30720
    v_mfma_f32_16x16x32_bf16 v[80:83], a[160:163], v[128:131], v[80:83]
    ds_read_b64_tr_b16 a[66:67], v14 offset:31488
    buffer_load_dwordx4 v7, s[16:19], s30 offen offset:2048 lds
    v_mfma_f32_16x16x32_bf16 v[84:87], a[164:167], v[128:131], v[84:87]
    s_waitcnt lgkmcnt(5)
    v_mfma_f32_16x16x32_bf16 v[88:91], a[156:159], v[132:135], v[88:91]
    ds_read_b64_tr_b16 a[68:69], v15 offset:30720
    ds_read_b128 v[140:143], v17 offset:128
    v_mfma_f32_16x16x32_bf16 v[92:95], a[160:163], v[132:135], v[92:95]
    ds_read_b64_tr_b16 a[70:71], v15 offset:31488
    v_mfma_f32_16x16x32_bf16 v[96:99], a[164:167], v[132:135], v[96:99]
    s_waitcnt vmcnt(10) lgkmcnt(6)
    s_barrier
    v_mfma_f32_16x16x32_bf16 v[64:67], v[196:199], v[128:131], v[64:67]
    ds_read_b128 v[112:115], v17 offset:3584
    ds_read_b64_tr_b16 a[168:169], v13 offset:36864
    v_mfma_f32_16x16x32_bf16 v[68:71], v[200:203], v[128:131], v[68:71]
    ds_read_b64_tr_b16 a[170:171], v13 offset:37632
    s_add_u32 m0, s24, 12288
    v_mfma_f32_16x16x32_bf16 v[72:75], v[204:207], v[128:131], v[72:75]
    s_add_u32 s30, s26, 98304
    v_mfma_f32_16x16x32_bf16 v[76:79], v[196:199], v[132:135], v[76:79]
    ds_read_b128 v[116:119], v17 offset:7040
    ds_read_b64_tr_b16 a[172:173], v14 offset:36864
    v_mfma_f32_16x16x32_bf16 v[80:83], v[200:203], v[132:135], v[80:83]
    ds_read_b64_tr_b16 a[174:175], v14 offset:37632
    buffer_load_dwordx4 v5, s[16:19], s30 offen lds
    v_mfma_f32_16x16x32_bf16 v[84:87], v[204:207], v[132:135], v[84:87]
    buffer_load_dwordx4 v6, s[16:19], s30 offen offset:1024 lds
    s_waitcnt lgkmcnt(6)
    v_mfma_f32_16x16x32_bf16 v[88:91], v[196:199], v[136:139], v[88:91]
    ds_read_b64_tr_b16 a[176:177], v15 offset:36864
    buffer_load_dwordx4 v7, s[16:19], s30 offen offset:2048 lds
    v_mfma_f32_16x16x32_bf16 v[92:95], v[200:203], v[136:139], v[92:95]
    ds_read_b64_tr_b16 a[178:179], v15 offset:37632
    v_mfma_f32_16x16x32_bf16 v[96:99], v[204:207], v[136:139], v[96:99]
    s_mov_b32 m0, s68
    v_mfma_f32_16x16x32_bf16 v[64:67], a[60:63], v[140:143], v[64:67]
    ds_read_b64_tr_b16 v[208:209], v13 offset:43008
    v_mfma_f32_16x16x32_bf16 v[68:71], a[64:67], v[140:143], v[68:71]
    ds_read_b64_tr_b16 v[210:211], v13 offset:43776
    buffer_load_dwordx4 v9, s[8:11], s69 offen  lds
    v_mfma_f32_16x16x32_bf16 v[72:75], a[68:71], v[140:143], v[72:75]
    buffer_load_dwordx4 v10, s[8:11], s69 offen offset:1024  lds
    s_waitcnt lgkmcnt(4)
    v_mfma_f32_16x16x32_bf16 v[76:79], a[60:63], v[112:115], v[76:79]
    ds_read_b128 v[120:123], v17 offset:10496
    ds_read_b64_tr_b16 v[212:213], v14 offset:43008
    v_mfma_f32_16x16x32_bf16 v[80:83], a[64:67], v[112:115], v[80:83]
    ds_read_b64_tr_b16 v[214:215], v14 offset:43776
    buffer_load_dwordx4 v11, s[8:11], s69 offen offset:2048  lds
    v_mfma_f32_16x16x32_bf16 v[84:87], a[68:71], v[112:115], v[84:87]
    v_mfma_f32_16x16x32_bf16 v[88:91], a[60:63], v[116:119], v[88:91]
    ds_read_b64_tr_b16 v[216:217], v15 offset:43008
    buffer_load_dwordx4 v12, s[8:11], s69 offen offset:2432  lds
    v_mfma_f32_16x16x32_bf16 v[92:95], a[64:67], v[116:119], v[92:95]
    ds_read_b64_tr_b16 v[218:219], v15 offset:43776
    v_mfma_f32_16x16x32_bf16 v[96:99], a[68:71], v[116:119], v[96:99]
    s_waitcnt vmcnt(10) lgkmcnt(5)
    s_barrier
    v_mfma_f32_16x16x32_bf16 v[64:67], a[168:171], v[112:115], v[64:67]
    ds_read_b64_tr_b16 a[72:73], v13 offset:49152
    s_add_u32 m0, s24, 24576
    v_mfma_f32_16x16x32_bf16 v[68:71], a[172:175], v[112:115], v[68:71]
    ds_read_b64_tr_b16 a[74:75], v13 offset:49920
    v_mfma_f32_16x16x32_bf16 v[72:75], a[176:179], v[112:115], v[72:75]
    s_add_u32 s30, s26, 49152
    v_mfma_f32_16x16x32_bf16 v[76:79], a[168:171], v[116:119], v[76:79]
    ds_read_b128 v[124:127], v17 offset:13952
    ds_read_b64_tr_b16 a[76:77], v14 offset:49152
    v_mfma_f32_16x16x32_bf16 v[80:83], a[172:175], v[116:119], v[80:83]
    ds_read_b64_tr_b16 a[78:79], v14 offset:49920
    v_mfma_f32_16x16x32_bf16 v[84:87], a[176:179], v[116:119], v[84:87]
    buffer_load_dwordx4 v5, s[16:19], s30 offen lds
    s_waitcnt lgkmcnt(5)
    v_mfma_f32_16x16x32_bf16 v[88:91], a[168:171], v[120:123], v[88:91]
    ds_read_b64_tr_b16 a[80:81], v15 offset:49152
    ds_read_b128 v[128:131], v18 offset:0
    v_mfma_f32_16x16x32_bf16 v[92:95], a[172:175], v[120:123], v[92:95]
    ds_read_b64_tr_b16 a[82:83], v15 offset:49920
    v_mfma_f32_16x16x32_bf16 v[96:99], a[176:179], v[120:123], v[96:99]
    buffer_load_dwordx4 v6, s[16:19], s30 offen offset:1024 lds
    v_mfma_f32_16x16x32_bf16 v[64:67], v[208:211], v[116:119], v[64:67]
    ds_read_b128 v[132:135], v18 offset:3456
    ds_read_b64_tr_b16 a[180:181], v13 offset:55296
    v_mfma_f32_16x16x32_bf16 v[68:71], v[212:215], v[116:119], v[68:71]
    ds_read_b64_tr_b16 a[182:183], v13 offset:56064
    v_mfma_f32_16x16x32_bf16 v[72:75], v[216:219], v[116:119], v[72:75]
    buffer_load_dwordx4 v7, s[16:19], s30 offen offset:2048 lds
    v_mfma_f32_16x16x32_bf16 v[76:79], v[208:211], v[120:123], v[76:79]
    ds_read_b128 v[136:139], v18 offset:6912
    ds_read_b64_tr_b16 a[184:185], v14 offset:55296
    v_mfma_f32_16x16x32_bf16 v[80:83], v[212:215], v[120:123], v[80:83]
    ds_read_b64_tr_b16 a[186:187], v14 offset:56064
    v_mfma_f32_16x16x32_bf16 v[84:87], v[216:219], v[120:123], v[84:87]
    s_waitcnt lgkmcnt(6)
    v_mfma_f32_16x16x32_bf16 v[88:91], v[208:211], v[124:127], v[88:91]
    ds_read_b64_tr_b16 a[188:189], v15 offset:55296
    v_mfma_f32_16x16x32_bf16 v[92:95], v[212:215], v[124:127], v[92:95]
    ds_read_b64_tr_b16 a[190:191], v15 offset:56064
    v_mfma_f32_16x16x32_bf16 v[96:99], v[216:219], v[124:127], v[96:99]
    s_waitcnt vmcnt(10) lgkmcnt(5)
    s_barrier
    v_mfma_f32_16x16x32_bf16 v[64:67], a[72:75], v[128:131], v[64:67]
    ds_read_b64_tr_b16 v[220:221], v13 offset:0
    v_mfma_f32_16x16x32_bf16 v[68:71], a[76:79], v[128:131], v[68:71]
    ds_read_b64_tr_b16 v[222:223], v13 offset:768
    v_mfma_f32_16x16x32_bf16 v[72:75], a[80:83], v[128:131], v[72:75]
    s_cmp_lg_u32 s58, 0
    s_cbranch_scc1 L_extra
L_extra_back:
    v_mfma_f32_16x16x32_bf16 v[76:79], a[72:75], v[132:135], v[76:79]
    ds_read_b128 v[140:143], v18 offset:10368
    ds_read_b64_tr_b16 v[224:225], v14 offset:0
    v_mfma_f32_16x16x32_bf16 v[80:83], a[76:79], v[132:135], v[80:83]
    ds_read_b64_tr_b16 v[226:227], v14 offset:768
    buffer_load_dwordx4 v[156:159], v30, s[12:15], s51 offen
    v_mfma_f32_16x16x32_bf16 v[84:87], a[80:83], v[132:135], v[84:87]
    buffer_load_dwordx4 v[160:163], v31, s[12:15], s51 offen
    s_waitcnt lgkmcnt(5)
    v_mfma_f32_16x16x32_bf16 v[88:91], a[72:75], v[136:139], v[88:91]
    ds_read_b64_tr_b16 v[228:229], v15 offset:0
    s_add_u32 m0, s24, 36864
    v_mfma_f32_16x16x32_bf16 v[92:95], a[76:79], v[136:139], v[92:95]
    ds_read_b64_tr_b16 v[230:231], v15 offset:768
    s_add_u32 s30, s26, 159744
    v_mfma_f32_16x16x32_bf16 v[96:99], a[80:83], v[136:139], v[96:99]
    v_mfma_f32_16x16x32_bf16 v[64:67], a[180:183], v[132:135], v[64:67]
    ds_read_b64_tr_b16 a[84:85], v13 offset:6144
    buffer_load_dwordx4 v5, s[16:19], s30 offen lds
    v_mfma_f32_16x16x32_bf16 v[68:71], a[184:187], v[132:135], v[68:71]
    ds_read_b64_tr_b16 a[86:87], v13 offset:6912
    v_mfma_f32_16x16x32_bf16 v[72:75], a[188:191], v[132:135], v[72:75]
    v_mfma_f32_16x16x32_bf16 v[76:79], a[180:183], v[136:139], v[76:79]
    ds_read_b128 v[112:115], v18 offset:13824
    ds_read_b64_tr_b16 a[88:89], v14 offset:6144
    v_mfma_f32_16x16x32_bf16 v[80:83], a[184:187], v[136:139], v[80:83]
    ds_read_b64_tr_b16 a[90:91], v14 offset:6912
    buffer_load_dwordx4 v6, s[16:19], s30 offen offset:1024 lds
    v_mfma_f32_16x16x32_bf16 v[84:87], a[188:191], v[136:139], v[84:87]
    buffer_load_dwordx4 v7, s[16:19], s30 offen offset:2048 lds
    s_waitcnt lgkmcnt(5)
    v_mfma_f32_16x16x32_bf16 v[88:91], a[180:183], v[140:143], v[88:91]
    ds_read_b64_tr_b16 a[92:93], v15 offset:6144
    ds_read_b128 v[116:119], v18 offset:64
    v_mfma_f32_16x16x32_bf16 v[92:95], a[184:187], v[140:143], v[92:95]
    ds_read_b64_tr_b16 a[94:95], v15 offset:6912
    v_mfma_f32_16x16x32_bf16 v[96:99], a[188:191], v[140:143], v[96:99]
    s_waitcnt vmcnt(12) lgkmcnt(6)
    s_barrier
    v_mfma_f32_16x16x32_bf16 v[64:67], v[220:223], v[136:139], v[64:67]
    ds_read_b128 v[120:123], v18 offset:3520
    ds_read_b64_tr_b16 a[192:193], v13 offset:12288
    v_mfma_f32_16x16x32_bf16 v[68:71], v[224:227], v[136:139], v[68:71]
    ds_read_b64_tr_b16 a[194:195], v13 offset:13056
    v_mfma_f32_16x16x32_bf16 v[72:75], v[228:231], v[136:139], v[72:75]
    v_mfma_f32_16x16x32_bf16 v[76:79], v[220:223], v[140:143], v[76:79]
    ds_read_b128 v[124:127], v18 offset:6976
    ds_read_b64_tr_b16 a[196:197], v14 offset:12288
    v_mfma_f32_16x16x32_bf16 v[80:83], v[224:227], v[140:143], v[80:83]
    ds_read_b64_tr_b16 a[198:199], v14 offset:13056
    v_mfma_f32_16x16x32_bf16 v[84:87], v[228:231], v[140:143], v[84:87]
    s_waitcnt lgkmcnt(6)
    v_mfma_f32_16x16x32_bf16 v[88:91], v[220:223], v[112:115], v[88:91]
    ds_read_b64_tr_b16 a[200:201], v15 offset:12288
    v_mfma_f32_16x16x32_bf16 v[92:95], v[224:227], v[112:115], v[92:95]
    ds_read_b64_tr_b16 a[202:203], v15 offset:13056
    v_mfma_f32_16x16x32_bf16 v[96:99], v[228:231], v[112:115], v[96:99]
    v_mfma_f32_16x16x32_bf16 v[64:67], a[84:87], v[116:119], v[64:67]
    ds_read_b64_tr_b16 v[232:233], v13 offset:18432
    v_mfma_f32_16x16x32_bf16 v[68:71], a[88:91], v[116:119], v[68:71]
    ds_read_b64_tr_b16 v[234:235], v13 offset:19200
    v_mfma_f32_16x16x32_bf16 v[72:75], a[92:95], v[116:119], v[72:75]
    s_waitcnt lgkmcnt(4)
    v_mfma_f32_16x16x32_bf16 v[76:79], a[84:87], v[120:123], v[76:79]
    ds_read_b128 v[128:131], v18 offset:10432
    ds_read_b64_tr_b16 v[236:237], v14 offset:18432
    v_mfma_f32_16x16x32_bf16 v[80:83], a[88:91], v[120:123], v[80:83]
    ds_read_b64_tr_b16 v[238:239], v14 offset:19200
    v_mfma_f32_16x16x32_bf16 v[84:87], a[92:95], v[120:123], v[84:87]
    v_mfma_f32_16x16x32_bf16 v[88:91], a[84:87], v[124:127], v[88:91]
    ds_read_b64_tr_b16 v[240:241], v15 offset:18432
    v_mfma_f32_16x16x32_bf16 v[92:95], a[88:91], v[124:127], v[92:95]
    ds_read_b64_tr_b16 v[242:243], v15 offset:19200
    v_mfma_f32_16x16x32_bf16 v[96:99], a[92:95], v[124:127], v[96:99]
    s_waitcnt vmcnt(5) lgkmcnt(5)
    s_barrier
    v_mfma_f32_16x16x32_bf16 v[64:67], a[192:195], v[120:123], v[64:67]
    ds_read_b64_tr_b16 a[96:97], v13 offset:24576
    v_mfma_f32_16x16x32_bf16 v[68:71], a[196:199], v[120:123], v[68:71]
    ds_read_b64_tr_b16 a[98:99], v13 offset:25344
    v_mfma_f32_16x16x32_bf16 v[72:75], a[200:203], v[120:123], v[72:75]
    v_mfma_f32_16x16x32_bf16 v[76:79], a[192:195], v[124:127], v[76:79]
    ds_read_b128 v[132:135], v18 offset:13888
    ds_read_b64_tr_b16 a[100:101], v14 offset:24576
    v_mfma_f32_16x16x32_bf16 v[80:83], a[196:199], v[124:127], v[80:83]
    ds_read_b64_tr_b16 a[102:103], v14 offset:25344
    v_mfma_f32_16x16x32_bf16 v[84:87], a[200:203], v[124:127], v[84:87]
    s_waitcnt lgkmcnt(5)
    v_mfma_f32_16x16x32_bf16 v[88:91], a[192:195], v[128:131], v[88:91]
    ds_read_b64_tr_b16 a[104:105], v15 offset:24576
    ds_read_b128 v[136:139], v18 offset:128
    v_mfma_f32_16x16x32_bf16 v[92:95], a[196:199], v[128:131], v[92:95]
    ds_read_b128 v[52:55], v23 offset:0
    ds_read_b64_tr_b16 a[106:107], v15 offset:25344
    v_mfma_f32_16x16x32_bf16 v[96:99], a[200:203], v[128:131], v[96:99]
    v_mfma_f32_16x16x32_bf16 v[64:67], v[232:235], v[124:127], v[64:67]
    ds_read_b128 v[140:143], v18 offset:3584
    ds_read_b64_tr_b16 a[204:205], v13 offset:30720
    v_mfma_f32_16x16x32_bf16 v[68:71], v[236:239], v[124:127], v[68:71]
    ds_read_b128 v[56:59], v23 offset:16
    ds_read_b64_tr_b16 a[206:207], v13 offset:31488
    v_mfma_f32_16x16x32_bf16 v[72:75], v[240:243], v[124:127], v[72:75]
    v_mfma_f32_16x16x32_bf16 v[76:79], v[232:235], v[128:131], v[76:79]
    ds_read_b128 v[112:115], v18 offset:7040
    ds_read_b64_tr_b16 a[208:209], v14 offset:30720
    v_mfma_f32_16x16x32_bf16 v[80:83], v[236:239], v[128:131], v[80:83]
    ds_read_b32 v60, v23 offset:32
    ds_read_b64_tr_b16 a[210:211], v14 offset:31488
    v_mfma_f32_16x16x32_bf16 v[84:87], v[240:243], v[128:131], v[84:87]
    s_waitcnt lgkmcnt(8)
    v_mfma_f32_16x16x32_bf16 v[88:91], v[232:235], v[132:135], v[88:91]
    ds_read_b64_tr_b16 a[212:213], v15 offset:30720
    v_mfma_f32_16x16x32_bf16 v[92:95], v[236:239], v[132:135], v[92:95]
    ds_read_b64_tr_b16 a[214:215], v15 offset:31488
    v_mfma_f32_16x16x32_bf16 v[96:99], v[240:243], v[132:135], v[96:99]
    s_waitcnt vmcnt(0) lgkmcnt(6)
    s_barrier
    v_mfma_f32_16x16x32_bf16 v[64:67], a[96:99], v[136:139], v[64:67]
    ds_read_b64_tr_b16 v[244:245], v13 offset:36864
    v_xor_b32 v40, v52, v4
    v_mfma_f32_16x16x32_bf16 v[68:71], a[100:103], v[136:139], v[68:71]
    ds_read_b64_tr_b16 v[246:247], v13 offset:37632
    v_and_b32 v156, s97, v156
    v_mfma_f32_16x16x32_bf16 v[72:75], a[104:107], v[136:139], v[72:75]
    v_and_b32 v157, s97, v157
    v_and_b32 v158, s97, v158
    v_mfma_f32_16x16x32_bf16 v[76:79], a[96:99], v[140:143], v[76:79]
    ds_read_b128 v[116:119], v18 offset:10496
    ds_read_b64_tr_b16 v[248:249], v14 offset:36864
    v_mfma_f32_16x16x32_bf16 v[80:83], a[100:103], v[140:143], v[80:83]
    ds_read_b64_tr_b16 v[250:251], v14 offset:37632
    v_and_b32 v159, s97, v159
    v_mfma_f32_16x16x32_bf16 v[84:87], a[104:107], v[140:143], v[84:87]
    v_pk_max_u16 v156, v156, v157
    s_waitcnt lgkmcnt(5)
    v_mfma_f32_16x16x32_bf16 v[88:91], a[96:99], v[112:115], v[88:91]
    ds_read_b64_tr_b16 v[252:253], v15 offset:36864
    v_pk_max_u16 v158, v158, v159
    v_mfma_f32_16x16x32_bf16 v[92:95], a[100:103], v[112:115], v[92:95]
    ds_read_b64_tr_b16 v[254:255], v15 offset:37632
    v_pk_max_u16 v156, v156, s53
    v_mfma_f32_16x16x32_bf16 v[96:99], a[104:107], v[112:115], v[96:99]
    v_pk_max_u16 v156, v156, v158
    v_cmp_ne_u32 s[88:89], s53, v156
    v_mfma_f32_16x16x32_bf16 v[64:67], a[204:207], v[140:143], v[64:67]
    v_and_b32 v160, s97, v160
    v_and_b32 v161, s97, v161
    v_mfma_f32_16x16x32_bf16 v[68:71], a[208:211], v[140:143], v[68:71]
    v_and_b32 v162, s97, v162
    v_and_b32 v163, s97, v163
    v_mfma_f32_16x16x32_bf16 v[72:75], a[212:215], v[140:143], v[72:75]
    v_pk_max_u16 v160, v160, v161
    v_pk_max_u16 v162, v162, v163
    v_mfma_f32_16x16x32_bf16 v[76:79], a[204:207], v[112:115], v[76:79]
    v_pk_max_u16 v160, v160, s53
    v_pk_max_u16 v160, v160, v162
    v_mfma_f32_16x16x32_bf16 v[80:83], a[208:211], v[112:115], v[80:83]
    v_cmp_ne_u32 s[90:91], s53, v160
    ds_read_b128 v[120:123], v18 offset:13952
    v_mfma_f32_16x16x32_bf16 v[84:87], a[212:215], v[112:115], v[84:87]
    v_xor_b32 v41, v53, v4
    s_waitcnt lgkmcnt(1)
    v_mfma_f32_16x16x32_bf16 v[88:91], a[204:207], v[116:119], v[88:91]
    v_xor_b32 v42, v54, v4
    v_xor_b32 v43, v55, v4
    v_mfma_f32_16x16x32_bf16 v[92:95], a[208:211], v[116:119], v[92:95]
    v_xor_b32 v44, v56, v4
    v_xor_b32 v45, v57, v4
    v_mfma_f32_16x16x32_bf16 v[96:99], a[212:215], v[116:119], v[96:99]
    s_or_b64 vcc, s[88:89], s[90:91]
    s_cbranch_scc1 L_afail
L_afail_back:
    s_waitcnt vmcnt(0)
    s_barrier
    v_mfma_f32_16x16x32_bf16 v[64:67], v[244:247], v[112:115], v[64:67]
    ds_read_b128 v[124:127], v40 offset:0
    ds_read_b128 v[128:131], v40 offset:64
    v_mfma_f32_16x16x32_bf16 v[68:71], v[248:251], v[112:115], v[68:71]
    v_xor_b32 v46, v58, v4
    v_xor_b32 v47, v59, v4
    v_mfma_f32_16x16x32_bf16 v[72:75], v[252:255], v[112:115], v[72:75]
    v_xor_b32 v48, v60, v4
    v_mfma_f32_16x16x32_bf16 v[76:79], v[244:247], v[116:119], v[76:79]
    ds_read_b128 v[132:135], v40 offset:128
    v_mfma_f32_16x16x32_bf16 v[80:83], v[248:251], v[116:119], v[80:83]
    v_mfma_f32_16x16x32_bf16 v[84:87], v[252:255], v[116:119], v[84:87]
    s_waitcnt lgkmcnt(3)
    v_mfma_f32_16x16x32_bf16 v[88:91], v[244:247], v[120:123], v[88:91]
    ds_read_b128 v[136:139], v41 offset:0
    v_mfma_f32_16x16x32_bf16 v[92:95], v[248:251], v[120:123], v[92:95]
    v_mfma_f32_16x16x32_bf16 v[96:99], v[252:255], v[120:123], v[96:99]
    s_cmp_lg_u32 s54, 0
    s_cbranch_scc1 L_patch
L_patch_back:
    s_waitcnt lgkmcnt(2)
    v_mfma_f32_16x16x32_bf16 v[100:103], a[0:3], v[124:127], 0
    ds_read_b128 v[140:143], v41 offset:64
    v_mfma_f32_16x16x32_bf16 v[104:107], a[4:7], v[124:127], 0
    ds_read_b128 v[52:55], v23 offset:768
    v_mfma_f32_16x16x32_bf16 v[108:111], a[8:11], v[124:127], 0
    v_cvt_pk_bf16_f32 v144, v64, v65
    v_mfma_f32_16x16x32_bf16 v[100:103], a[12:15], v[128:131], v[100:103]
    ds_read_b128 v[112:115], v41 offset:128
    v_cvt_pk_bf16_f32 v145, v66, v67
    v_mfma_f32_16x16x32_bf16 v[104:107], a[16:19], v[128:131], v[104:107]
    ds_read_b128 v[56:59], v23 offset:784
    v_cvt_pk_bf16_f32 v146, v68, v69
    v_mfma_f32_16x16x32_bf16 v[108:111], a[20:23], v[128:131], v[108:111]
    v_cvt_pk_bf16_f32 v147, v70, v71
    s_waitcnt lgkmcnt(4)
    v_mfma_f32_16x16x32_bf16 v[100:103], a[24:27], v[132:135], v[100:103]
    ds_read_b128 v[116:119], v42 offset:0
    v_cvt_pk_bf16_f32 v148, v72, v73
    v_mfma_f32_16x16x32_bf16 v[104:107], a[28:31], v[132:135], v[104:107]
    ds_read_b32 v60, v23 offset:800
    v_cvt_pk_bf16_f32 v149, v74, v75
    v_mfma_f32_16x16x32_bf16 v[108:111], a[32:35], v[132:135], v[108:111]
    v_permlane16_swap_b32 v144, v146
    v_mfma_f32_16x16x32_bf16 v[100:103], a[36:39], v[136:139], v[100:103]
    ds_read_b128 v[120:123], v42 offset:64
    v_permlane16_swap_b32 v145, v147
    v_mfma_f32_16x16x32_bf16 v[104:107], a[40:43], v[136:139], v[104:107]
    v_mfma_f32_16x16x32_bf16 v[108:111], a[44:47], v[136:139], v[108:111]
    buffer_store_dwordx4 v[144:147], v19, s[20:23], s78 offen sc1
    s_waitcnt lgkmcnt(3)
    v_mfma_f32_16x16x32_bf16 v[100:103], a[48:51], v[140:143], v[100:103]
    ds_read_b128 v[124:127], v42 offset:128
    v_mfma_f32_16x16x32_bf16 v[104:107], a[52:55], v[140:143], v[104:107]
    v_xor_b32 v40, v52, v4
    v_xor_b32 v41, v53, v4
    v_mfma_f32_16x16x32_bf16 v[108:111], a[56:59], v[140:143], v[108:111]
    v_xor_b32 v42, v54, v4
    v_mfma_f32_16x16x32_bf16 v[100:103], a[60:63], v[112:115], v[100:103]
    ds_read_b128 v[128:131], v43 offset:0
    buffer_store_dwordx2 v[148:149], v20, s[20:23], s78 offen sc1
    v_mfma_f32_16x16x32_bf16 v[104:107], a[64:67], v[112:115], v[104:107]
    v_mfma_f32_16x16x32_bf16 v[108:111], a[68:71], v[112:115], v[108:111]
    s_waitcnt lgkmcnt(2)
    v_mfma_f32_16x16x32_bf16 v[100:103], a[72:75], v[116:119], v[100:103]
    ds_read_b128 v[132:135], v43 offset:64
    v_mfma_f32_16x16x32_bf16 v[104:107], a[76:79], v[116:119], v[104:107]
    v_mfma_f32_16x16x32_bf16 v[108:111], a[80:83], v[116:119], v[108:111]
    ds_read_b32 v35, v34
    v_mfma_f32_16x16x32_bf16 v[100:103], a[84:87], v[120:123], v[100:103]
    ds_read_b128 v[136:139], v43 offset:128
    v_xor_b32 v43, v55, v4
    v_mfma_f32_16x16x32_bf16 v[104:107], a[88:91], v[120:123], v[104:107]
    v_mfma_f32_16x16x32_bf16 v[108:111], a[92:95], v[120:123], v[108:111]
    s_waitcnt lgkmcnt(3)
    v_mfma_f32_16x16x32_bf16 v[100:103], a[96:99], v[124:127], v[100:103]
    ds_read_b128 v[140:143], v44 offset:0
    v_mfma_f32_16x16x32_bf16 v[104:107], a[100:103], v[124:127], v[104:107]
    v_mfma_f32_16x16x32_bf16 v[108:111], a[104:107], v[124:127], v[108:111]
    v_cvt_pk_bf16_f32 v150, v76, v77
    v_mfma_f32_16x16x32_bf16 v[100:103], a[108:111], v[128:131], v[100:103]
    ds_read_b128 v[112:115], v44 offset:64
    v_cvt_pk_bf16_f32 v151, v78, v79
    v_mfma_f32_16x16x32_bf16 v[104:107], a[112:115], v[128:131], v[104:107]
    v_cvt_pk_bf16_f32 v152, v80, v81
    v_mfma_f32_16x16x32_bf16 v[108:111], a[116:119], v[128:131], v[108:111]
    v_cvt_pk_bf16_f32 v153, v82, v83
    s_waitcnt lgkmcnt(2)
    v_mfma_f32_16x16x32_bf16 v[100:103], a[120:123], v[132:135], v[100:103]
    ds_read_b128 v[116:119], v44 offset:128
    v_cvt_pk_bf16_f32 v154, v84, v85
    v_mfma_f32_16x16x32_bf16 v[104:107], a[124:127], v[132:135], v[104:107]
    v_cvt_pk_bf16_f32 v155, v86, v87
    v_xor_b32 v44, v56, v4
    v_mfma_f32_16x16x32_bf16 v[108:111], a[128:131], v[132:135], v[108:111]
    v_permlane16_swap_b32 v150, v152
    v_mfma_f32_16x16x32_bf16 v[100:103], a[132:135], v[136:139], v[100:103]
    ds_read_b128 v[120:123], v45 offset:0
    v_permlane16_swap_b32 v151, v153
    v_mfma_f32_16x16x32_bf16 v[104:107], a[136:139], v[136:139], v[104:107]
    v_mfma_f32_16x16x32_bf16 v[108:111], a[140:143], v[136:139], v[108:111]
    buffer_store_dwordx4 v[150:153], v19, s[20:23], s4 offen sc1
    s_waitcnt lgkmcnt(2)
    v_mfma_f32_16x16x32_bf16 v[100:103], a[144:147], v[140:143], v[100:103]
    ds_read_b128 v[124:127], v45 offset:64
    v_mfma_f32_16x16x32_bf16 v[104:107], a[148:151], v[140:143], v[104:107]
    v_mfma_f32_16x16x32_bf16 v[108:111], a[152:155], v[140:143], v[108:111]
    v_mfma_f32_16x16x32_bf16 v[100:103], a[156:159], v[112:115], v[100:103]
    ds_read_b128 v[128:131], v45 offset:128
    buffer_store_dwordx2 v[154:155], v20, s[20:23], s4 offen sc1
    v_mfma_f32_16x16x32_bf16 v[104:107], a[160:163], v[112:115], v[104:107]
    v_xor_b32 v45, v57, v4
    v_mfma_f32_16x16x32_bf16 v[108:111], a[164:167], v[112:115], v[108:111]
    s_waitcnt lgkmcnt(2)
    v_mfma_f32_16x16x32_bf16 v[100:103], a[168:171], v[116:119], v[100:103]
    ds_read_b128 v[132:135], v46 offset:0
    v_mfma_f32_16x16x32_bf16 v[104:107], a[172:175], v[116:119], v[104:107]
    v_mfma_f32_16x16x32_bf16 v[108:111], a[176:179], v[116:119], v[108:111]
    v_mfma_f32_16x16x32_bf16 v[100:103], a[180:183], v[120:123], v[100:103]
    ds_read_b128 v[136:139], v46 offset:64
    v_mfma_f32_16x16x32_bf16 v[104:107], a[184:187], v[120:123], v[104:107]
    v_mfma_f32_16x16x32_bf16 v[108:111], a[188:191], v[120:123], v[108:111]
    s_waitcnt lgkmcnt(2)
    v_mfma_f32_16x16x32_bf16 v[100:103], a[192:195], v[124:127], v[100:103]
    ds_read_b128 v[140:143], v46 offset:128
    v_xor_b32 v46, v58, v4
    v_mfma_f32_16x16x32_bf16 v[104:107], a[196:199], v[124:127], v[104:107]
    v_mfma_f32_16x16x32_bf16 v[108:111], a[200:203], v[124:127], v[108:111]
    v_cvt_pk_bf16_f32 v144, v88, v89
    v_mfma_f32_16x16x32_bf16 v[100:103], a[204:207], v[128:131], v[100:103]
    ds_read_b128 v[112:115], v47 offset:0
    v_cvt_pk_bf16_f32 v145, v90, v91
    v_mfma_f32_16x16x32_bf16 v[104:107], a[208:211], v[128:131], v[104:107]
    v_cvt_pk_bf16_f32 v146, v92, v93
    v_mfma_f32_16x16x32_bf16 v[108:111], a[212:215], v[128:131], v[108:111]
    v_cvt_pk_bf16_f32 v147, v94, v95
    s_waitcnt lgkmcnt(2)
    v_mfma_f32_16x16x32_bf16 v[100:103], a[216:219], v[132:135], v[100:103]
    ds_read_b128 v[116:119], v47 offset:64
    v_cvt_pk_bf16_f32 v148, v96, v97
    v_mfma_f32_16x16x32_bf16 v[104:107], a[220:223], v[132:135], v[104:107]
    v_cvt_pk_bf16_f32 v149, v98, v99
    v_mfma_f32_16x16x32_bf16 v[108:111], a[224:227], v[132:135], v[108:111]
    v_permlane16_swap_b32 v144, v146
    v_mfma_f32_16x16x32_bf16 v[100:103], a[228:231], v[136:139], v[100:103]
    ds_read_b128 v[120:123], v47 offset:128
    v_permlane16_swap_b32 v145, v147
    v_mfma_f32_16x16x32_bf16 v[104:107], a[232:235], v[136:139], v[104:107]
    v_xor_b32 v47, v59, v4
    v_mfma_f32_16x16x32_bf16 v[108:111], a[236:239], v[136:139], v[108:111]
    buffer_store_dwordx4 v[144:147], v19, s[20:23], s5 offen sc1
    s_waitcnt lgkmcnt(2)
    v_mfma_f32_16x16x32_bf16 v[100:103], a[240:243], v[140:143], v[100:103]
    ds_read_b128 v[124:127], v48 offset:0
    v_mfma_f32_16x16x32_bf16 v[104:107], a[244:247], v[140:143], v[104:107]
    v_mfma_f32_16x16x32_bf16 v[108:111], a[248:251], v[140:143], v[108:111]
    v_mfma_f32_16x16x32_bf16 v[100:103], a[252:255], v[112:115], v[100:103]
    ds_read_b128 v[128:131], v48 offset:64
    buffer_store_dwordx2 v[148:149], v20, s[20:23], s5 offen sc1
    v_mfma_f32_16x16x32_bf16 v[104:107], v[188:191], v[112:115], v[104:107]
    v_mfma_f32_16x16x32_bf16 v[108:111], v[192:195], v[112:115], v[108:111]
    s_waitcnt lgkmcnt(2)
    v_mfma_f32_16x16x32_bf16 v[100:103], v[196:199], v[116:119], v[100:103]
    ds_read_b128 v[132:135], v48 offset:128
    v_xor_b32 v48, v60, v4
    v_mfma_f32_16x16x32_bf16 v[104:107], v[200:203], v[116:119], v[104:107]
    v_mfma_f32_16x16x32_bf16 v[108:111], v[204:207], v[116:119], v[108:111]
    v_mfma_f32_16x16x32_bf16 v[100:103], v[208:211], v[120:123], v[100:103]
    ds_read_b128 v[136:139], v40 offset:0
    v_mfma_f32_16x16x32_bf16 v[104:107], v[212:215], v[120:123], v[104:107]
    v_mfma_f32_16x16x32_bf16 v[108:111], v[216:219], v[120:123], v[108:111]
    s_waitcnt lgkmcnt(2)
    v_mfma_f32_16x16x32_bf16 v[100:103], v[220:223], v[124:127], v[100:103]
    ds_read_b128 v[140:143], v40 offset:64
    v_mfma_f32_16x16x32_bf16 v[104:107], v[224:227], v[124:127], v[104:107]
    v_mfma_f32_16x16x32_bf16 v[108:111], v[228:231], v[124:127], v[108:111]
    v_mfma_f32_16x16x32_bf16 v[100:103], v[232:235], v[128:131], v[100:103]
    ds_read_b128 v[112:115], v40 offset:128
    v_mfma_f32_16x16x32_bf16 v[104:107], v[236:239], v[128:131], v[104:107]
    v_readfirstlane_b32 s98, v35
    v_mfma_f32_16x16x32_bf16 v[108:111], v[240:243], v[128:131], v[108:111]
    s_waitcnt lgkmcnt(2)
    v_mfma_f32_16x16x32_bf16 v[100:103], v[244:247], v[132:135], v[100:103]
    ds_read_b128 v[116:119], v41 offset:0
    v_mfma_f32_16x16x32_bf16 v[104:107], v[248:251], v[132:135], v[104:107]
    v_mfma_f32_16x16x32_bf16 v[108:111], v[252:255], v[132:135], v[108:111]
    v_mfma_f32_16x16x32_bf16 v[64:67], a[0:3], v[136:139], 0
    ds_read_b128 v[120:123], v41 offset:64
    v_mfma_f32_16x16x32_bf16 v[68:71], a[4:7], v[136:139], 0
    ds_read_b128 v[52:55], v23 offset:1536
    v_mfma_f32_16x16x32_bf16 v[72:75], a[8:11], v[136:139], 0
    s_waitcnt lgkmcnt(3)
    v_mfma_f32_16x16x32_bf16 v[64:67], a[12:15], v[140:143], v[64:67]
    ds_read_b128 v[124:127], v41 offset:128
    v_cvt_pk_bf16_f32 v150, v100, v101
    v_mfma_f32_16x16x32_bf16 v[68:71], a[16:19], v[140:143], v[68:71]
    ds_read_b128 v[56:59], v23 offset:1552
    v_cvt_pk_bf16_f32 v151, v102, v103
    v_mfma_f32_16x16x32_bf16 v[72:75], a[20:23], v[140:143], v[72:75]
    v_cvt_pk_bf16_f32 v152, v104, v105
    v_mfma_f32_16x16x32_bf16 v[64:67], a[24:27], v[112:115], v[64:67]
    ds_read_b128 v[128:131], v42 offset:0
    v_cvt_pk_bf16_f32 v153, v106, v107
    v_mfma_f32_16x16x32_bf16 v[68:71], a[28:31], v[112:115], v[68:71]
    ds_read_b32 v60, v23 offset:1568
    v_cvt_pk_bf16_f32 v154, v108, v109
    v_mfma_f32_16x16x32_bf16 v[72:75], a[32:35], v[112:115], v[72:75]
    v_cvt_pk_bf16_f32 v155, v110, v111
    s_waitcnt lgkmcnt(4)
    v_mfma_f32_16x16x32_bf16 v[64:67], a[36:39], v[116:119], v[64:67]
    ds_read_b128 v[132:135], v42 offset:64
    v_permlane16_swap_b32 v150, v152
    v_mfma_f32_16x16x32_bf16 v[68:71], a[40:43], v[116:119], v[68:71]
    v_permlane16_swap_b32 v151, v153
    v_mfma_f32_16x16x32_bf16 v[72:75], a[44:47], v[116:119], v[72:75]
    v_mfma_f32_16x16x32_bf16 v[64:67], a[48:51], v[120:123], v[64:67]
    ds_read_b128 v[136:139], v42 offset:128
    buffer_store_dwordx4 v[150:153], v21, s[20:23], s74 offen sc1
    v_mfma_f32_16x16x32_bf16 v[68:71], a[52:55], v[120:123], v[68:71]
    v_xor_b32 v40, v52, v4
    v_xor_b32 v41, v53, v4
    v_mfma_f32_16x16x32_bf16 v[72:75], a[56:59], v[120:123], v[72:75]
    v_xor_b32 v42, v54, v4
    s_waitcnt lgkmcnt(2)
    v_mfma_f32_16x16x32_bf16 v[64:67], a[60:63], v[124:127], v[64:67]
    ds_read_b128 v[140:143], v43 offset:0
    v_mfma_f32_16x16x32_bf16 v[68:71], a[64:67], v[124:127], v[68:71]
    buffer_store_dwordx2 v[154:155], v22, s[20:23], s74 offen sc1
    v_mfma_f32_16x16x32_bf16 v[72:75], a[68:71], v[124:127], v[72:75]
    v_mfma_f32_16x16x32_bf16 v[64:67], a[72:75], v[128:131], v[64:67]
    ds_read_b128 v[112:115], v43 offset:64
    v_mfma_f32_16x16x32_bf16 v[68:71], a[76:79], v[128:131], v[68:71]
    v_mfma_f32_16x16x32_bf16 v[72:75], a[80:83], v[128:131], v[72:75]
    s_waitcnt lgkmcnt(2)
    v_mfma_f32_16x16x32_bf16 v[64:67], a[84:87], v[132:135], v[64:67]
    ds_read_b128 v[116:119], v43 offset:128
    v_xor_b32 v43, v55, v4
    v_mfma_f32_16x16x32_bf16 v[68:71], a[88:91], v[132:135], v[68:71]
    v_mfma_f32_16x16x32_bf16 v[72:75], a[92:95], v[132:135], v[72:75]
    v_mfma_f32_16x16x32_bf16 v[64:67], a[96:99], v[136:139], v[64:67]
    ds_read_b128 v[120:123], v44 offset:0
    v_mfma_f32_16x16x32_bf16 v[68:71], a[100:103], v[136:139], v[68:71]
    v_mfma_f32_16x16x32_bf16 v[72:75], a[104:107], v[136:139], v[72:75]
    s_waitcnt lgkmcnt(2)
    v_mfma_f32_16x16x32_bf16 v[64:67], a[108:111], v[140:143], v[64:67]
    ds_read_b128 v[124:127], v44 offset:64
    v_mfma_f32_16x16x32_bf16 v[68:71], a[112:115], v[140:143], v[68:71]
    v_mfma_f32_16x16x32_bf16 v[72:75], a[116:119], v[140:143], v[72:75]
    v_mfma_f32_16x16x32_bf16 v[64:67], a[120:123], v[112:115], v[64:67]
    ds_read_b128 v[128:131], v44 offset:128
    v_xor_b32 v44, v56, v4
    v_mfma_f32_16x16x32_bf16 v[68:71], a[124:127], v[112:115], v[68:71]
    v_mfma_f32_16x16x32_bf16 v[72:75], a[128:131], v[112:115], v[72:75]
    s_waitcnt lgkmcnt(2)
    v_mfma_f32_16x16x32_bf16 v[64:67], a[132:135], v[116:119], v[64:67]
    ds_read_b128 v[132:135], v45 offset:0
    v_mfma_f32_16x16x32_bf16 v[68:71], a[136:139], v[116:119], v[68:71]
    v_mfma_f32_16x16x32_bf16 v[72:75], a[140:143], v[116:119], v[72:75]
    v_mfma_f32_16x16x32_bf16 v[64:67], a[144:147], v[120:123], v[64:67]
    ds_read_b128 v[136:139], v45 offset:64
    v_mfma_f32_16x16x32_bf16 v[68:71], a[148:151], v[120:123], v[68:71]
    v_mfma_f32_16x16x32_bf16 v[72:75], a[152:155], v[120:123], v[72:75]
    s_waitcnt lgkmcnt(2)
    v_mfma_f32_16x16x32_bf16 v[64:67], a[156:159], v[124:127], v[64:67]
    ds_read_b128 v[140:143], v45 offset:128
    v_xor_b32 v45, v57, v4
    v_mfma_f32_16x16x32_bf16 v[68:71], a[160:163], v[124:127], v[68:71]
    v_mfma_f32_16x16x32_bf16 v[72:75], a[164:167], v[124:127], v[72:75]
    v_mfma_f32_16x16x32_bf16 v[64:67], a[168:171], v[128:131], v[64:67]
    ds_read_b128 v[112:115], v46 offset:0
    v_mfma_f32_16x16x32_bf16 v[68:71], a[172:175], v[128:131], v[68:71]
    v_mfma_f32_16x16x32_bf16 v[72:75], a[176:179], v[128:131], v[72:75]
    s_waitcnt lgkmcnt(2)
    v_mfma_f32_16x16x32_bf16 v[64:67], a[180:183], v[132:135], v[64:67]
    ds_read_b128 v[116:119], v46 offset:64
    v_mfma_f32_16x16x32_bf16 v[68:71], a[184:187], v[132:135], v[68:71]
    v_mfma_f32_16x16x32_bf16 v[72:75], a[188:191], v[132:135], v[72:75]
    v_mfma_f32_16x16x32_bf16 v[64:67], a[192:195], v[136:139], v[64:67]
    ds_read_b128 v[120:123], v46 offset:128
    v_xor_b32 v46, v58, v4
    v_mfma_f32_16x16x32_bf16 v[68:71], a[196:199], v[136:139], v[68:71]
    v_mfma_f32_16x16x32_bf16 v[72:75], a[200:203], v[136:139], v[72:75]
    s_waitcnt lgkmcnt(2)
    v_mfma_f32_16x16x32_bf16 v[64:67], a[204:207], v[140:143], v[64:67]
    ds_read_b128 v[124:127], v47 offset:0
    v_mfma_f32_16x16x32_bf16 v[68:71], a[208:211], v[140:143], v[68:71]
    v_mfma_f32_16x16x32_bf16 v[72:75], a[212:215], v[140:143], v[72:75]
    v_mfma_f32_16x16x32_bf16 v[64:67], a[216:219], v[112:115], v[64:67]
    ds_read_b128 v[128:131], v47 offset:64
    v_mfma_f32_16x16x32_bf16 v[68:71], a[220:223], v[112:115], v[68:71]
    v_mfma_f32_16x16x32_bf16 v[72:75], a[224:227], v[112:115], v[72:75]
    s_waitcnt lgkmcnt(2)
    v_mfma_f32_16x16x32_bf16 v[64:67], a[228:231], v[116:119], v[64:67]
    ds_read_b128 v[132:135], v47 offset:128
    v_xor_b32 v47, v59, v4
    v_mfma_f32_16x16x32_bf16 v[68:71], a[232:235], v[116:119], v[68:71]
    v_mfma_f32_16x16x32_bf16 v[72:75], a[236:239], v[116:119], v[72:75]
    v_mfma_f32_16x16x32_bf16 v[64:67], a[240:243], v[120:123], v[64:67]
    ds_read_b128 v[136:139], v48 offset:0
    v_mfma_f32_16x16x32_bf16 v[68:71], a[244:247], v[120:123], v[68:71]
    v_mfma_f32_16x16x32_bf16 v[72:75], a[248:251], v[120:123], v[72:75]
    s_waitcnt lgkmcnt(2)
    v_mfma_f32_16x16x32_bf16 v[64:67], a[252:255], v[124:127], v[64:67]
    ds_read_b128 v[140:143], v48 offset:64
    v_mfma_f32_16x16x32_bf16 v[68:71], v[188:191], v[124:127], v[68:71]
    v_mfma_f32_16x16x32_bf16 v[72:75], v[192:195], v[124:127], v[72:75]
    v_mfma_f32_16x16x32_bf16 v[64:67], v[196:199], v[128:131], v[64:67]
    ds_read_b128 v[112:115], v48 offset:128
    v_xor_b32 v48, v60, v4
    v_mfma_f32_16x16x32_bf16 v[68:71], v[200:203], v[128:131], v[68:71]
    v_mfma_f32_16x16x32_bf16 v[72:75], v[204:207], v[128:131], v[72:75]
    s_waitcnt lgkmcnt(2)
    v_mfma_f32_16x16x32_bf16 v[64:67], v[208:211], v[132:135], v[64:67]
    ds_read_b128 v[116:119], v40 offset:0
    v_mfma_f32_16x16x32_bf16 v[68:71], v[212:215], v[132:135], v[68:71]
    v_mfma_f32_16x16x32_bf16 v[72:75], v[216:219], v[132:135], v[72:75]
    v_mfma_f32_16x16x32_bf16 v[64:67], v[220:223], v[136:139], v[64:67]
    ds_read_b128 v[120:123], v40 offset:64
    v_mfma_f32_16x16x32_bf16 v[68:71], v[224:227], v[136:139], v[68:71]
    v_mfma_f32_16x16x32_bf16 v[72:75], v[228:231], v[136:139], v[72:75]
    s_waitcnt lgkmcnt(2)
    v_mfma_f32_16x16x32_bf16 v[64:67], v[232:235], v[140:143], v[64:67]
    ds_read_b128 v[124:127], v40 offset:128
    v_mfma_f32_16x16x32_bf16 v[68:71], v[236:239], v[140:143], v[68:71]
    v_mfma_f32_16x16x32_bf16 v[72:75], v[240:243], v[140:143], v[72:75]
    v_mfma_f32_16x16x32_bf16 v[64:67], v[244:247], v[112:115], v[64:67]
    ds_read_b128 v[128:131], v41 offset:0
    v_mfma_f32_16x16x32_bf16 v[68:71], v[248:251], v[112:115], v[68:71]
    v_mfma_f32_16x16x32_bf16 v[72:75], v[252:255], v[112:115], v[72:75]
    s_waitcnt lgkmcnt(2)
    v_mfma_f32_16x16x32_bf16 v[76:79], a[0:3], v[116:119], 0
    ds_read_b128 v[132:135], v41 offset:64
    v_mfma_f32_16x16x32_bf16 v[80:83], a[4:7], v[116:119], 0
    ds_read_b128 v[52:55], v23 offset:2304
    v_mfma_f32_16x16x32_bf16 v[84:87], a[8:11], v[116:119], 0
    v_mfma_f32_16x16x32_bf16 v[76:79], a[12:15], v[120:123], v[76:79]
    ds_read_b128 v[136:139], v41 offset:128
    v_cvt_pk_bf16_f32 v144, v64, v65
    v_mfma_f32_16x16x32_bf16 v[80:83], a[16:19], v[120:123], v[80:83]
    ds_read_b128 v[56:59], v23 offset:2320
    v_cvt_pk_bf16_f32 v145, v66, v67
    v_mfma_f32_16x16x32_bf16 v[84:87], a[20:23], v[120:123], v[84:87]
    v_cvt_pk_bf16_f32 v146, v68, v69
    s_waitcnt lgkmcnt(4)
    v_mfma_f32_16x16x32_bf16 v[76:79], a[24:27], v[124:127], v[76:79]
    ds_read_b128 v[140:143], v42 offset:0
    v_cvt_pk_bf16_f32 v147, v70, v71
    v_mfma_f32_16x16x32_bf16 v[80:83], a[28:31], v[124:127], v[80:83]
    ds_read_b32 v60, v23 offset:2336
    v_cvt_pk_bf16_f32 v148, v72, v73
    v_mfma_f32_16x16x32_bf16 v[84:87], a[32:35], v[124:127], v[84:87]
    v_cvt_pk_bf16_f32 v149, v74, v75
    v_mfma_f32_16x16x32_bf16 v[76:79], a[36:39], v[128:131], v[76:79]
    ds_read_b128 v[112:115], v42 offset:64
    v_permlane16_swap_b32 v144, v146
    v_mfma_f32_16x16x32_bf16 v[80:83], a[40:43], v[128:131], v[80:83]
    v_permlane16_swap_b32 v145, v147
    v_mfma_f32_16x16x32_bf16 v[84:87], a[44:47], v[128:131], v[84:87]
    s_waitcnt lgkmcnt(3)
    v_mfma_f32_16x16x32_bf16 v[76:79], a[48:51], v[132:135], v[76:79]
    ds_read_b128 v[116:119], v42 offset:128
    buffer_store_dwordx4 v[144:147], v21, s[20:23], s75 offen sc1
    v_mfma_f32_16x16x32_bf16 v[80:83], a[52:55], v[132:135], v[80:83]
    v_xor_b32 v40, v52, v4
    v_xor_b32 v41, v53, v4
    v_mfma_f32_16x16x32_bf16 v[84:87], a[56:59], v[132:135], v[84:87]
    v_xor_b32 v42, v54, v4
    v_mfma_f32_16x16x32_bf16 v[76:79], a[60:63], v[136:139], v[76:79]
    ds_read_b128 v[120:123], v43 offset:0
    v_mfma_f32_16x16x32_bf16 v[80:83], a[64:67], v[136:139], v[80:83]
    buffer_store_dwordx2 v[148:149], v22, s[20:23], s75 offen sc1
    v_mfma_f32_16x16x32_bf16 v[84:87], a[68:71], v[136:139], v[84:87]
    s_waitcnt lgkmcnt(2)
    v_mfma_f32_16x16x32_bf16 v[76:79], a[72:75], v[140:143], v[76:79]
    ds_read_b128 v[124:127], v43 offset:64
    v_mfma_f32_16x16x32_bf16 v[80:83], a[76:79], v[140:143], v[80:83]
    v_mfma_f32_16x16x32_bf16 v[84:87], a[80:83], v[140:143], v[84:87]
    v_mfma_f32_16x16x32_bf16 v[76:79], a[84:87], v[112:115], v[76:79]
    ds_read_b128 v[128:131], v43 offset:128
    v_xor_b32 v43, v55, v4
    v_mfma_f32_16x16x32_bf16 v[80:83], a[88:91], v[112:115], v[80:83]
    v_mfma_f32_16x16x32_bf16 v[84:87], a[92:95], v[112:115], v[84:87]
    s_waitcnt lgkmcnt(2)
    v_mfma_f32_16x16x32_bf16 v[76:79], a[96:99], v[116:119], v[76:79]
    ds_read_b128 v[132:135], v44 offset:0
    v_mfma_f32_16x16x32_bf16 v[80:83], a[100:103], v[116:119], v[80:83]
    v_mfma_f32_16x16x32_bf16 v[84:87], a[104:107], v[116:119], v[84:87]
    v_mfma_f32_16x16x32_bf16 v[76:79], a[108:111], v[120:123], v[76:79]
    ds_read_b128 v[136:139], v44 offset:64
    v_mfma_f32_16x16x32_bf16 v[80:83], a[112:115], v[120:123], v[80:83]
    v_mfma_f32_16x16x32_bf16 v[84:87], a[116:119], v[120:123], v[84:87]
    s_waitcnt lgkmcnt(2)
    v_mfma_f32_16x16x32_bf16 v[76:79], a[120:123], v[124:127], v[76:79]
    ds_read_b128 v[140:143], v44 offset:128
    v_xor_b32 v44, v56, v4
    v_mfma_f32_16x16x32_bf16 v[80:83], a[124:127], v[124:127], v[80:83]
    v_mfma_f32_16x16x32_bf16 v[84:87], a[128:131], v[124:127], v[84:87]
    v_mfma_f32_16x16x32_bf16 v[76:79], a[132:135], v[128:131], v[76:79]
    ds_read_b128 v[112:115], v45 offset:0
    v_mfma_f32_16x16x32_bf16 v[80:83], a[136:139], v[128:131], v[80:83]
    v_mfma_f32_16x16x32_bf16 v[84:87], a[140:143], v[128:131], v[84:87]
    s_waitcnt lgkmcnt(2)
    v_mfma_f32_16x16x32_bf16 v[76:79], a[144:147], v[132:135], v[76:79]
    ds_read_b128 v[116:119], v45 offset:64
    v_mfma_f32_16x16x32_bf16 v[80:83], a[148:151], v[132:135], v[80:83]
    v_mfma_f32_16x16x32_bf16 v[84:87], a[152:155], v[132:135], v[84:87]
    v_mfma_f32_16x16x32_bf16 v[76:79], a[156:159], v[136:139], v[76:79]
    ds_read_b128 v[120:123], v45 offset:128
    v_xor_b32 v45, v57, v4
    v_mfma_f32_16x16x32_bf16 v[80:83], a[160:163], v[136:139], v[80:83]
    v_mfma_f32_16x16x32_bf16 v[84:87], a[164:167], v[136:139], v[84:87]
    s_waitcnt lgkmcnt(2)
    v_mfma_f32_16x16x32_bf16 v[76:79], a[168:171], v[140:143], v[76:79]
    ds_read_b128 v[124:127], v46 offset:0
    v_mfma_f32_16x16x32_bf16 v[80:83], a[172:175], v[140:143], v[80:83]
    v_mfma_f32_16x16x32_bf16 v[84:87], a[176:179], v[140:143], v[84:87]
    v_mfma_f32_16x16x32_bf16 v[76:79], a[180:183], v[112:115], v[76:79]
    ds_read_b128 v[128:131], v46 offset:64
    v_mfma_f32_16x16x32_bf16 v[80:83], a[184:187], v[112:115], v[80:83]
    v_mfma_f32_16x16x32_bf16 v[84:87], a[188:191], v[112:115], v[84:87]
    s_waitcnt lgkmcnt(2)
    v_mfma_f32_16x16x32_bf16 v[76:79], a[192:195], v[116:119], v[76:79]
    ds_read_b128 v[132:135], v46 offset:128
    v_xor_b32 v46, v58, v4
    v_mfma_f32_16x16x32_bf16 v[80:83], a[196:199], v[116:119], v[80:83]
    v_mfma_f32_16x16x32_bf16 v[84:87], a[200:203], v[116:119], v[84:87]
    v_mfma_f32_16x16x32_bf16 v[76:79], a[204:207], v[120:123], v[76:79]
    ds_read_b128 v[136:139], v47 offset:0
    v_mfma_f32_16x16x32_bf16 v[80:83], a[208:211], v[120:123], v[80:83]
    v_mfma_f32_16x16x32_bf16 v[84:87], a[212:215], v[120:123], v[84:87]
    s_waitcnt lgkmcnt(2)
    v_mfma_f32_16x16x32_bf16 v[76:79], a[216:219], v[124:127], v[76:79]
    ds_read_b128 v[140:143], v47 offset:64
    v_mfma_f32_16x16x32_bf16 v[80:83], a[220:223], v[124:127], v[80:83]
    v_mfma_f32_16x16x32_bf16 v[84:87], a[224:227], v[124:127], v[84:87]
    v_mfma_f32_16x16x32_bf16 v[76:79], a[228:231], v[128:131], v[76:79]
    ds_read_b128 v[112:115], v47 offset:128
    v_xor_b32 v47, v59, v4
    v_mfma_f32_16x16x32_bf16 v[80:83], a[232:235], v[128:131], v[80:83]
    v_mfma_f32_16x16x32_bf16 v[84:87], a[236:239], v[128:131], v[84:87]
    s_waitcnt lgkmcnt(2)
    v_mfma_f32_16x16x32_bf16 v[76:79], a[240:243], v[132:135], v[76:79]
    ds_read_b128 v[116:119], v48 offset:0
    v_mfma_f32_16x16x32_bf16 v[80:83], a[244:247], v[132:135], v[80:83]
    v_mfma_f32_16x16x32_bf16 v[84:87], a[248:251], v[132:135], v[84:87]
    v_mfma_f32_16x16x32_bf16 v[76:79], a[252:255], v[136:139], v[76:79]
    ds_read_b128 v[120:123], v48 offset:64
    v_mfma_f32_16x16x32_bf16 v[80:83], v[188:191], v[136:139], v[80:83]
    v_mfma_f32_16x16x32_bf16 v[84:87], v[192:195], v[136:139], v[84:87]
    s_waitcnt lgkmcnt(2)
    v_mfma_f32_16x16x32_bf16 v[76:79], v[196:199], v[140:143], v[76:79]
    ds_read_b128 v[124:127], v48 offset:128
    v_xor_b32 v48, v60, v4
    v_mfma_f32_16x16x32_bf16 v[80:83], v[200:203], v[140:143], v[80:83]
    v_mfma_f32_16x16x32_bf16 v[84:87], v[204:207], v[140:143], v[84:87]
    v_mfma_f32_16x16x32_bf16 v[76:79], v[208:211], v[112:115], v[76:79]
    ds_read_b128 v[128:131], v40 offset:0
    v_mfma_f32_16x16x32_bf16 v[80:83], v[212:215], v[112:115], v[80:83]
    v_mfma_f32_16x16x32_bf16 v[84:87], v[216:219], v[112:115], v[84:87]
    s_waitcnt lgkmcnt(2)
    v_mfma_f32_16x16x32_bf16 v[76:79], v[220:223], v[116:119], v[76:79]
    ds_read_b128 v[132:135], v40 offset:64
    v_mfma_f32_16x16x32_bf16 v[80:83], v[224:227], v[116:119], v[80:83]
    v_mfma_f32_16x16x32_bf16 v[84:87], v[228:231], v[116:119], v[84:87]
    v_mfma_f32_16x16x32_bf16 v[76:79], v[232:235], v[120:123], v[76:79]
    ds_read_b128 v[136:139], v40 offset:128
    v_mfma_f32_16x16x32_bf16 v[80:83], v[236:239], v[120:123], v[80:83]
    v_mfma_f32_16x16x32_bf16 v[84:87], v[240:243], v[120:123], v[84:87]
    s_waitcnt lgkmcnt(2)
    v_mfma_f32_16x16x32_bf16 v[76:79], v[244:247], v[124:127], v[76:79]
    ds_read_b128 v[140:143], v41 offset:0
    v_mfma_f32_16x16x32_bf16 v[80:83], v[248:251], v[124:127], v[80:83]
    v_mfma_f32_16x16x32_bf16 v[84:87], v[252:255], v[124:127], v[84:87]
    s_cmp_eq_u32 s55, 3
    s_cbranch_scc1 L_fin2
    v_mfma_f32_16x16x32_bf16 v[88:91], a[0:3], v[128:131], 0
    ds_read_b128 v[112:115], v41 offset:64
    v_mfma_f32_16x16x32_bf16 v[92:95], a[4:7], v[128:131], 0
    v_mfma_f32_16x16x32_bf16 v[96:99], a[8:11], v[128:131], 0
    s_waitcnt lgkmcnt(2)
    v_mfma_f32_16x16x32_bf16 v[88:91], a[12:15], v[132:135], v[88:91]
    ds_read_b128 v[116:119], v41 offset:128
    v_cvt_pk_bf16_f32 v150, v76, v77
    v_mfma_f32_16x16x32_bf16 v[92:95], a[16:19], v[132:135], v[92:95]
    v_cvt_pk_bf16_f32 v151, v78, v79
    v_mfma_f32_16x16x32_bf16 v[96:99], a[20:23], v[132:135], v[96:99]
    v_cvt_pk_bf16_f32 v152, v80, v81
    v_mfma_f32_16x16x32_bf16 v[88:91], a[24:27], v[136:139], v[88:91]
    ds_read_b128 v[120:123], v42 offset:0
    v_cvt_pk_bf16_f32 v153, v82, v83
    v_mfma_f32_16x16x32_bf16 v[92:95], a[28:31], v[136:139], v[92:95]
    v_cvt_pk_bf16_f32 v154, v84, v85
    v_mfma_f32_16x16x32_bf16 v[96:99], a[32:35], v[136:139], v[96:99]
    v_cvt_pk_bf16_f32 v155, v86, v87
    s_waitcnt lgkmcnt(2)
    v_mfma_f32_16x16x32_bf16 v[88:91], a[36:39], v[140:143], v[88:91]
    ds_read_b128 v[124:127], v42 offset:64
    v_permlane16_swap_b32 v150, v152
    v_mfma_f32_16x16x32_bf16 v[92:95], a[40:43], v[140:143], v[92:95]
    v_permlane16_swap_b32 v151, v153
    v_mfma_f32_16x16x32_bf16 v[96:99], a[44:47], v[140:143], v[96:99]
    v_mfma_f32_16x16x32_bf16 v[88:91], a[48:51], v[112:115], v[88:91]
    ds_read_b128 v[128:131], v42 offset:128
    buffer_store_dwordx4 v[150:153], v21, s[20:23], s76 offen sc1
    v_mfma_f32_16x16x32_bf16 v[92:95], a[52:55], v[112:115], v[92:95]
    v_mfma_f32_16x16x32_bf16 v[96:99], a[56:59], v[112:115], v[96:99]
    s_waitcnt lgkmcnt(2)
    v_mfma_f32_16x16x32_bf16 v[88:91], a[60:63], v[116:119], v[88:91]
    ds_read_b128 v[132:135], v43 offset:0
    v_mfma_f32_16x16x32_bf16 v[92:95], a[64:67], v[116:119], v[92:95]
    buffer_store_dwordx2 v[154:155], v22, s[20:23], s76 offen sc1
    v_mfma_f32_16x16x32_bf16 v[96:99], a[68:71], v[116:119], v[96:99]
    v_mfma_f32_16x16x32_bf16 v[88:91], a[72:75], v[120:123], v[88:91]
    ds_read_b128 v[136:139], v43 offset:64
    v_mfma_f32_16x16x32_bf16 v[92:95], a[76:79], v[120:123], v[92:95]
    v_mfma_f32_16x16x32_bf16 v[96:99], a[80:83], v[120:123], v[96:99]
    s_waitcnt lgkmcnt(2)
    v_mfma_f32_16x16x32_bf16 v[88:91], a[84:87], v[124:127], v[88:91]
    ds_read_b128 v[140:143], v43 offset:128
    v_mfma_f32_16x16x32_bf16 v[92:95], a[88:91], v[124:127], v[92:95]
    v_mfma_f32_16x16x32_bf16 v[96:99], a[92:95], v[124:127], v[96:99]
    v_mfma_f32_16x16x32_bf16 v[88:91], a[96:99], v[128:131], v[88:91]
    ds_read_b128 v[112:115], v44 offset:0
    v_mfma_f32_16x16x32_bf16 v[92:95], a[100:103], v[128:131], v[92:95]
    v_mfma_f32_16x16x32_bf16 v[96:99], a[104:107], v[128:131], v[96:99]
    s_waitcnt lgkmcnt(2)
    v_mfma_f32_16x16x32_bf16 v[88:91], a[108:111], v[132:135], v[88:91]
    ds_read_b128 v[116:119], v44 offset:64
    v_mfma_f32_16x16x32_bf16 v[92:95], a[112:115], v[132:135], v[92:95]
    v_mfma_f32_16x16x32_bf16 v[96:99], a[116:119], v[132:135], v[96:99]
    v_mfma_f32_16x16x32_bf16 v[88:91], a[120:123], v[136:139], v[88:91]
    ds_read_b128 v[120:123], v44 offset:128
    v_mfma_f32_16x16x32_bf16 v[92:95], a[124:127], v[136:139], v[92:95]
    v_mfma_f32_16x16x32_bf16 v[96:99], a[128:131], v[136:139], v[96:99]
    s_waitcnt lgkmcnt(2)
    v_mfma_f32_16x16x32_bf16 v[88:91], a[132:135], v[140:143], v[88:91]
    ds_read_b128 v[124:127], v45 offset:0
    v_mfma_f32_16x16x32_bf16 v[92:95], a[136:139], v[140:143], v[92:95]
    v_mfma_f32_16x16x32_bf16 v[96:99], a[140:143], v[140:143], v[96:99]
    v_mfma_f32_16x16x32_bf16 v[88:91], a[144:147], v[112:115], v[88:91]
    ds_read_b128 v[128:131], v45 offset:64
    v_mfma_f32_16x16x32_bf16 v[92:95], a[148:151], v[112:115], v[92:95]
    v_mfma_f32_16x16x32_bf16 v[96:99], a[152:155], v[112:115], v[96:99]
    s_waitcnt lgkmcnt(2)
    v_mfma_f32_16x16x32_bf16 v[88:91], a[156:159], v[116:119], v[88:91]
    ds_read_b128 v[132:135], v45 offset:128
    v_mfma_f32_16x16x32_bf16 v[92:95], a[160:163], v[116:119], v[92:95]
    v_mfma_f32_16x16x32_bf16 v[96:99], a[164:167], v[116:119], v[96:99]
    v_mfma_f32_16x16x32_bf16 v[88:91], a[168:171], v[120:123], v[88:91]
    ds_read_b128 v[136:139], v46 offset:0
    v_mfma_f32_16x16x32_bf16 v[92:95], a[172:175], v[120:123], v[92:95]
    v_mfma_f32_16x16x32_bf16 v[96:99], a[176:179], v[120:123], v[96:99]
    s_waitcnt lgkmcnt(2)
    v_mfma_f32_16x16x32_bf16 v[88:91], a[180:183], v[124:127], v[88:91]
    ds_read_b128 v[140:143], v46 offset:64
    v_mfma_f32_16x16x32_bf16 v[92:95], a[184:187], v[124:127], v[92:95]
    v_mfma_f32_16x16x32_bf16 v[96:99], a[188:191], v[124:127], v[96:99]
    v_mfma_f32_16x16x32_bf16 v[88:91], a[192:195], v[128:131], v[88:91]
    ds_read_b128 v[112:115], v46 offset:128
    v_mfma_f32_16x16x32_bf16 v[92:95], a[196:199], v[128:131], v[92:95]
    v_mfma_f32_16x16x32_bf16 v[96:99], a[200:203], v[128:131], v[96:99]
    s_waitcnt lgkmcnt(2)
    v_mfma_f32_16x16x32_bf16 v[88:91], a[204:207], v[132:135], v[88:91]
    ds_read_b128 v[116:119], v47 offset:0
    v_mfma_f32_16x16x32_bf16 v[92:95], a[208:211], v[132:135], v[92:95]
    v_mfma_f32_16x16x32_bf16 v[96:99], a[212:215], v[132:135], v[96:99]
    v_mfma_f32_16x16x32_bf16 v[88:91], a[216:219], v[136:139], v[88:91]
    ds_read_b128 v[120:123], v47 offset:64
    v_mfma_f32_16x16x32_bf16 v[92:95], a[220:223], v[136:139], v[92:95]
    v_mfma_f32_16x16x32_bf16 v[96:99], a[224:227], v[136:139], v[96:99]
    s_waitcnt lgkmcnt(2)
    v_mfma_f32_16x16x32_bf16 v[88:91], a[228:231], v[140:143], v[88:91]
    ds_read_b128 v[124:127], v47 offset:128
    v_mfma_f32_16x16x32_bf16 v[92:95], a[232:235], v[140:143], v[92:95]
    v_mfma_f32_16x16x32_bf16 v[96:99], a[236:239], v[140:143], v[96:99]
    v_mfma_f32_16x16x32_bf16 v[88:91], a[240:243], v[112:115], v[88:91]
    ds_read_b128 v[128:131], v48 offset:0
    v_mfma_f32_16x16x32_bf16 v[92:95], a[244:247], v[112:115], v[92:95]
    v_mfma_f32_16x16x32_bf16 v[96:99], a[248:251], v[112:115], v[96:99]
    s_waitcnt lgkmcnt(2)
    v_mfma_f32_16x16x32_bf16 v[88:91], a[252:255], v[116:119], v[88:91]
    ds_read_b128 v[132:135], v48 offset:64
    v_mfma_f32_16x16x32_bf16 v[92:95], v[188:191], v[116:119], v[92:95]
    v_mfma_f32_16x16x32_bf16 v[96:99], v[192:195], v[116:119], v[96:99]
    v_mfma_f32_16x16x32_bf16 v[88:91], v[196:199], v[120:123], v[88:91]
    ds_read_b128 v[136:139], v48 offset:128
    v_mfma_f32_16x16x32_bf16 v[92:95], v[200:203], v[120:123], v[92:95]
    v_mfma_f32_16x16x32_bf16 v[96:99], v[204:207], v[120:123], v[96:99]
    s_waitcnt lgkmcnt(2)
    v_mfma_f32_16x16x32_bf16 v[88:91], v[208:211], v[124:127], v[88:91]
    v_mfma_f32_16x16x32_bf16 v[92:95], v[212:215], v[124:127], v[92:95]
    v_mfma_f32_16x16x32_bf16 v[96:99], v[216:219], v[124:127], v[96:99]
    v_mfma_f32_16x16x32_bf16 v[88:91], v[220:223], v[128:131], v[88:91]
    v_mfma_f32_16x16x32_bf16 v[92:95], v[224:227], v[128:131], v[92:95]
    v_mfma_f32_16x16x32_bf16 v[96:99], v[228:231], v[128:131], v[96:99]
    s_waitcnt lgkmcnt(0)
    v_mfma_f32_16x16x32_bf16 v[88:91], v[232:235], v[132:135], v[88:91]
    v_mfma_f32_16x16x32_bf16 v[92:95], v[236:239], v[132:135], v[92:95]
    v_mfma_f32_16x16x32_bf16 v[96:99], v[240:243], v[132:135], v[96:99]
    v_mfma_f32_16x16x32_bf16 v[88:91], v[244:247], v[136:139], v[88:91]
    v_mfma_f32_16x16x32_bf16 v[92:95], v[248:251], v[136:139], v[92:95]
    v_mfma_f32_16x16x32_bf16 v[96:99], v[252:255], v[136:139], v[96:99]
    s_nop 5
    v_cvt_pk_bf16_f32 v144, v88, v89
    v_cvt_pk_bf16_f32 v145, v90, v91
    v_cvt_pk_bf16_f32 v146, v92, v93
    v_cvt_pk_bf16_f32 v147, v94, v95
    v_cvt_pk_bf16_f32 v148, v96, v97
    v_cvt_pk_bf16_f32 v149, v98, v99
    v_permlane16_swap_b32 v144, v146
    v_permlane16_swap_b32 v145, v147
    buffer_store_dwordx4 v[144:147], v21, s[20:23], s77 offen sc1
    buffer_store_dwordx2 v[148:149], v22, s[20:23], s77 offen sc1
L_check:
    s_cmp_lg_u32 s98, 0
    s_cbranch_scc1 L_slow
L_done:
L_end:
    s_endpgm
L_fin2:
    s_nop 5
    v_cvt_pk_bf16_f32 v144, v76, v77
    v_cvt_pk_bf16_f32 v145, v78, v79
    v_cvt_pk_bf16_f32 v146, v80, v81
    v_cvt_pk_bf16_f32 v147, v82, v83
    v_cvt_pk_bf16_f32 v148, v84, v85
    v_cvt_pk_bf16_f32 v149, v86, v87
    v_permlane16_swap_b32 v144, v146
    v_permlane16_swap_b32 v145, v147
    buffer_store_dwordx4 v[144:147], v21, s[20:23], s76 offen sc1
    buffer_store_dwordx2 v[148:149], v22, s[20:23], s76 offen sc1
    s_branch L_check
L_patch:
    s_cmp_eq_u32 s96, 0
    s_cbranch_scc1 L_patch_end
    ds_read2_b32 v[52:53], v24 offset0:0 offset1:32
    ds_read_b64 v[54:55], v25 offset:8
    ds_read2_b32 v[56:57], v24 offset0:64 offset1:96
    ds_read_b64 v[58:59], v25 offset:264
    ds_read2_b32 v[60:61], v24 offset0:128 offset1:160
    ds_read_b64 v[62:63], v25 offset:520
    ds_read2_b32 v[184:185], v24 offset0:192 offset1:224
    ds_read_b64 v[186:187], v25 offset:776
    s_waitcnt lgkmcnt(7)
    v_xor_b32 v176, v52, v26
    v_xor_b32 v177, v52, v27
    v_xor_b32 v178, v53, v26
    v_xor_b32 v179, v53, v27
    ds_read_b64_tr_b16 v[100:101], v176 offset:0
    ds_read_b64_tr_b16 v[102:103], v178 offset:0
    ds_read_b64_tr_b16 v[104:105], v177 offset:0
    ds_read_b64_tr_b16 v[106:107], v179 offset:0
    ds_read_b64_tr_b16 v[108:109], v176 offset:64
    ds_read_b64_tr_b16 v[110:111], v178 offset:64
    ds_read_b64_tr_b16 v[112:113], v177 offset:64
    ds_read_b64_tr_b16 v[114:115], v179 offset:64
    ds_read_b64_tr_b16 v[116:117], v176 offset:128
    ds_read_b64_tr_b16 v[118:119], v178 offset:128
    ds_read_b64_tr_b16 v[120:121], v177 offset:128
    ds_read_b64_tr_b16 v[122:123], v179 offset:128
    s_waitcnt lgkmcnt(12)
    v_cndmask_b32 v173, 0, v55, s[80:81]
    v_cndmask_b32 v175, 0, v55, s[84:85]
    v_cndmask_b32 v172, 0, v54, s[80:81]
    v_cndmask_b32 v174, 0, v54, s[84:85]
    v_cndmask_b32 v173, v173, v54, s[82:83]
    v_cndmask_b32 v175, v175, v54, s[86:87]
    v_xor_b32 v176, v56, v26
    v_xor_b32 v177, v56, v27
    v_xor_b32 v178, v57, v26
    v_xor_b32 v179, v57, v27
    s_waitcnt lgkmcnt(0)
    v_mfma_f32_16x16x32_bf16 v[148:151], v[100:103], v[172:175], 0
    ds_read_b64_tr_b16 v[124:125], v176 offset:0
    ds_read_b64_tr_b16 v[126:127], v178 offset:0
    v_mfma_f32_16x16x32_bf16 v[152:155], v[104:107], v[172:175], 0
    ds_read_b64_tr_b16 v[128:129], v177 offset:0
    ds_read_b64_tr_b16 v[130:131], v179 offset:0
    v_mfma_f32_16x16x32_bf16 v[156:159], v[108:111], v[172:175], 0
    ds_read_b64_tr_b16 v[132:133], v176 offset:64
    ds_read_b64_tr_b16 v[134:135], v178 offset:64
    v_mfma_f32_16x16x32_bf16 v[160:163], v[112:115], v[172:175], 0
    ds_read_b64_tr_b16 v[136:137], v177 offset:64
    ds_read_b64_tr_b16 v[138:139], v179 offset:64
    v_mfma_f32_16x16x32_bf16 v[164:167], v[116:119], v[172:175], 0
    ds_read_b64_tr_b16 v[140:141], v176 offset:128
    ds_read_b64_tr_b16 v[142:143], v178 offset:128
    v_mfma_f32_16x16x32_bf16 v[168:171], v[120:123], v[172:175], 0
    ds_read_b64_tr_b16 v[144:145], v177 offset:128
    ds_read_b64_tr_b16 v[146:147], v179 offset:128
    v_cvt_pk_bf16_f32 v148, v148, v149
    v_cvt_pk_bf16_f32 v149, v150, v151
    ds_write_b64 v28, v[148:149] offset:0
    v_cvt_pk_bf16_f32 v152, v152, v153
    v_cvt_pk_bf16_f32 v153, v154, v155
    ds_write_b64 v29, v[152:153] offset:0
    v_cvt_pk_bf16_f32 v156, v156, v157
    v_cvt_pk_bf16_f32 v157, v158, v159
    ds_write_b64 v28, v[156:157] offset:64
    v_cvt_pk_bf16_f32 v160, v160, v161
    v_cvt_pk_bf16_f32 v161, v162, v163
    ds_write_b64 v29, v[160:161] offset:64
    v_cvt_pk_bf16_f32 v164, v164, v165
    v_cvt_pk_bf16_f32 v165, v166, v167
    ds_write_b64 v28, v[164:165] offset:128
    v_cvt_pk_bf16_f32 v168, v168, v169
    v_cvt_pk_bf16_f32 v169, v170, v171
    ds_write_b64 v29, v[168:169] offset:128
    s_cmp_le_u32 s96, 16
    s_cbranch_scc1 L_patch_end
    v_cndmask_b32 v173, 0, v59, s[80:81]
    v_cndmask_b32 v175, 0, v59, s[84:85]
    v_cndmask_b32 v172, 0, v58, s[80:81]
    v_cndmask_b32 v174, 0, v58, s[84:85]
    v_cndmask_b32 v173, v173, v58, s[82:83]
    v_cndmask_b32 v175, v175, v58, s[86:87]
    v_xor_b32 v176, v60, v26
    v_xor_b32 v177, v60, v27
    v_xor_b32 v178, v61, v26
    v_xor_b32 v179, v61, v27
    s_waitcnt lgkmcnt(6)
    v_mfma_f32_16x16x32_bf16 v[148:151], v[124:127], v[172:175], 0
    ds_read_b64_tr_b16 v[100:101], v176 offset:0
    ds_read_b64_tr_b16 v[102:103], v178 offset:0
    v_mfma_f32_16x16x32_bf16 v[152:155], v[128:131], v[172:175], 0
    ds_read_b64_tr_b16 v[104:105], v177 offset:0
    ds_read_b64_tr_b16 v[106:107], v179 offset:0
    v_mfma_f32_16x16x32_bf16 v[156:159], v[132:135], v[172:175], 0
    ds_read_b64_tr_b16 v[108:109], v176 offset:64
    ds_read_b64_tr_b16 v[110:111], v178 offset:64
    v_mfma_f32_16x16x32_bf16 v[160:163], v[136:139], v[172:175], 0
    ds_read_b64_tr_b16 v[112:113], v177 offset:64
    ds_read_b64_tr_b16 v[114:115], v179 offset:64
    v_mfma_f32_16x16x32_bf16 v[164:167], v[140:143], v[172:175], 0
    ds_read_b64_tr_b16 v[116:117], v176 offset:128
    ds_read_b64_tr_b16 v[118:119], v178 offset:128
    v_mfma_f32_16x16x32_bf16 v[168:171], v[144:147], v[172:175], 0
    ds_read_b64_tr_b16 v[120:121], v177 offset:128
    ds_read_b64_tr_b16 v[122:123], v179 offset:128
    v_cvt_pk_bf16_f32 v148, v148, v149
    v_cvt_pk_bf16_f32 v149, v150, v151
    ds_write_b64 v28, v[148:149] offset:3072
    v_cvt_pk_bf16_f32 v152, v152, v153
    v_cvt_pk_bf16_f32 v153, v154, v155
    ds_write_b64 v29, v[152:153] offset:3072
    v_cvt_pk_bf16_f32 v156, v156, v157
    v_cvt_pk_bf16_f32 v157, v158, v159
    ds_write_b64 v28, v[156:157] offset:3136
    v_cvt_pk_bf16_f32 v160, v160, v161
    v_cvt_pk_bf16_f32 v161, v162, v163
    ds_write_b64 v29, v[160:161] offset:3136
    v_cvt_pk_bf16_f32 v164, v164, v165
    v_cvt_pk_bf16_f32 v165, v166, v167
    ds_write_b64 v28, v[164:165] offset:3200
    v_cvt_pk_bf16_f32 v168, v168, v169
    v_cvt_pk_bf16_f32 v169, v170, v171
    ds_write_b64 v29, v[168:169] offset:3200
    s_cmp_le_u32 s96, 32
    s_cbranch_scc1 L_patch_end
    v_cndmask_b32 v173, 0, v63, s[80:81]
    v_cndmask_b32 v175, 0, v63, s[84:85]
    v_cndmask_b32 v172, 0, v62, s[80:81]
    v_cndmask_b32 v174, 0, v62, s[84:85]
    v_cndmask_b32 v173, v173, v62, s[82:83]
    v_cndmask_b32 v175, v175, v62, s[86:87]
    v_xor_b32 v176, v184, v26
    v_xor_b32 v177, v184, v27
    v_xor_b32 v178, v185, v26
    v_xor_b32 v179, v185, v27
    s_waitcnt lgkmcnt(6)
    v_mfma_f32_16x16x32_bf16 v[148:151], v[100:103], v[172:175], 0
    ds_read_b64_tr_b16 v[124:125], v176 offset:0
    ds_read_b64_tr_b16 v[126:127], v178 offset:0
    v_mfma_f32_16x16x32_bf16 v[152:155], v[104:107], v[172:175], 0
    ds_read_b64_tr_b16 v[128:129], v177 offset:0
    ds_read_b64_tr_b16 v[130:131], v179 offset:0
    v_mfma_f32_16x16x32_bf16 v[156:159], v[108:111], v[172:175], 0
    ds_read_b64_tr_b16 v[132:133], v176 offset:64
    ds_read_b64_tr_b16 v[134:135], v178 offset:64
    v_mfma_f32_16x16x32_bf16 v[160:163], v[112:115], v[172:175], 0
    ds_read_b64_tr_b16 v[136:137], v177 offset:64
    ds_read_b64_tr_b16 v[138:139], v179 offset:64
    v_mfma_f32_16x16x32_bf16 v[164:167], v[116:119], v[172:175], 0
    ds_read_b64_tr_b16 v[140:141], v176 offset:128
    ds_read_b64_tr_b16 v[142:143], v178 offset:128
    v_mfma_f32_16x16x32_bf16 v[168:171], v[120:123], v[172:175], 0
    ds_read_b64_tr_b16 v[144:145], v177 offset:128
    ds_read_b64_tr_b16 v[146:147], v179 offset:128
    v_cvt_pk_bf16_f32 v148, v148, v149
    v_cvt_pk_bf16_f32 v149, v150, v151
    ds_write_b64 v28, v[148:149] offset:6144
    v_cvt_pk_bf16_f32 v152, v152, v153
    v_cvt_pk_bf16_f32 v153, v154, v155
    ds_write_b64 v29, v[152:153] offset:6144
    v_cvt_pk_bf16_f32 v156, v156, v157
    v_cvt_pk_bf16_f32 v157, v158, v159
    ds_write_b64 v28, v[156:157] offset:6208
    v_cvt_pk_bf16_f32 v160, v160, v161
    v_cvt_pk_bf16_f32 v161, v162, v163
    ds_write_b64 v29, v[160:161] offset:6208
    v_cvt_pk_bf16_f32 v164, v164, v165
    v_cvt_pk_bf16_f32 v165, v166, v167
    ds_write_b64 v28, v[164:165] offset:6272
    v_cvt_pk_bf16_f32 v168, v168, v169
    v_cvt_pk_bf16_f32 v169, v170, v171
    ds_write_b64 v29, v[168:169] offset:6272
    s_cmp_le_u32 s96, 48
    s_cbranch_scc1 L_patch_end
    v_cndmask_b32 v173, 0, v187, s[80:81]
    v_cndmask_b32 v175, 0, v187, s[84:85]
    v_cndmask_b32 v172, 0, v186, s[80:81]
    v_cndmask_b32 v174, 0, v186, s[84:85]
    v_cndmask_b32 v173, v173, v186, s[82:83]
    v_cndmask_b32 v175, v175, v186, s[86:87]
    s_nop 0
    s_waitcnt lgkmcnt(6)
    v_mfma_f32_16x16x32_bf16 v[148:151], v[124:127], v[172:175], 0
    v_mfma_f32_16x16x32_bf16 v[152:155], v[128:131], v[172:175], 0
    v_mfma_f32_16x16x32_bf16 v[156:159], v[132:135], v[172:175], 0
    v_mfma_f32_16x16x32_bf16 v[160:163], v[136:139], v[172:175], 0
    v_mfma_f32_16x16x32_bf16 v[164:167], v[140:143], v[172:175], 0
    v_mfma_f32_16x16x32_bf16 v[168:171], v[144:147], v[172:175], 0
    s_nop 3
    v_cvt_pk_bf16_f32 v148, v148, v149
    v_cvt_pk_bf16_f32 v149, v150, v151
    ds_write_b64 v28, v[148:149] offset:9216
    v_cvt_pk_bf16_f32 v152, v152, v153
    v_cvt_pk_bf16_f32 v153, v154, v155
    ds_write_b64 v29, v[152:153] offset:9216
    v_cvt_pk_bf16_f32 v156, v156, v157
    v_cvt_pk_bf16_f32 v157, v158, v159
    ds_write_b64 v28, v[156:157] offset:9280
    v_cvt_pk_bf16_f32 v160, v160, v161
    v_cvt_pk_bf16_f32 v161, v162, v163
    ds_write_b64 v29, v[160:161] offset:9280
    v_cvt_pk_bf16_f32 v164, v164, v165
    v_cvt_pk_bf16_f32 v165, v166, v167
    ds_write_b64 v28, v[164:165] offset:9344
    v_cvt_pk_bf16_f32 v168, v168, v169
    v_cvt_pk_bf16_f32 v169, v170, v171
    ds_write_b64 v29, v[168:169] offset:9344
L_patch_end:
    s_waitcnt lgkmcnt(0)
    s_barrier
    ds_read_b128 v[124:127], v40 offset:0
    ds_read_b128 v[128:131], v40 offset:64
    ds_read_b128 v[132:135], v40 offset:128
    ds_read_b128 v[136:139], v41 offset:0
    s_waitcnt lgkmcnt(0)
    s_branch L_patch_back
L_doubles:
    s_lshr_b32 s31, s98, 1
    s_mov_b64 exec, s[82:83]
    v_mbcnt_lo_u32_b32 v160, s82, 0
    v_mbcnt_hi_u32_b32 v160, s83, v160
    v_add_lshl_u32 v160, v160, s31, 3
    v_mad_u32_u24 v161, v160, 48, s99
    ds_write2_b32 v160, v76, v76 offset1:1
    v_and_or_b32 v161, v160, 48, v161
    ds_write_b32 v80, v161 offset:0
    s_bcnt1_i32_b64 s30, s[82:83]
    s_add_u32 s31, s31, s30
    s_mov_b64 exec, s[86:87]
    v_mbcnt_lo_u32_b32 v162, s86, 0
    v_mbcnt_hi_u32_b32 v162, s87, v162
    v_add_lshl_u32 v162, v162, s31, 3
    v_mad_u32_u24 v163, v162, 48, s99
    ds_write2_b32 v162, v77, v77 offset1:1
    v_and_or_b32 v163, v162, 48, v163
    ds_write_b32 v80, v163 offset:3072
    s_bcnt1_i32_b64 s30, s[86:87]
    s_add_u32 s31, s31, s30
    s_mov_b64 exec, s[90:91]
    v_mbcnt_lo_u32_b32 v160, s90, 0
    v_mbcnt_hi_u32_b32 v160, s91, v160
    v_add_lshl_u32 v160, v160, s31, 3
    v_mad_u32_u24 v161, v160, 48, s99
    ds_write2_b32 v160, v78, v78 offset1:1
    v_and_or_b32 v161, v160, 48, v161
    ds_write_b32 v80, v161 offset:1152
    s_bcnt1_i32_b64 s30, s[90:91]
    s_add_u32 s31, s31, s30
    s_mov_b64 exec, s[94:95]
    v_mbcnt_lo_u32_b32 v162, s94, 0
    v_mbcnt_hi_u32_b32 v162, s95, v162
    v_add_lshl_u32 v162, v162, s31, 3
    v_mad_u32_u24 v163, v162, 48, s99
    ds_write2_b32 v162, v79, v79 offset1:1
    v_and_or_b32 v163, v162, 48, v163
    ds_write_b32 v80, v163 offset:4224
    s_branch L_singles
L_extra:
    s_mov_b32 m0, s70
    s_nop 0
    buffer_load_dwordx4 v9, s[8:11], s71 offen  lds
    buffer_load_dwordx4 v10, s[8:11], s71 offen offset:1024  lds
    buffer_load_dwordx4 v11, s[8:11], s71 offen offset:2048  lds
    buffer_load_dwordx4 v12, s[8:11], s71 offen offset:2432  lds
    s_mov_b32 m0, s72
    s_nop 0
    buffer_load_dwordx4 v9, s[8:11], s73 offen  lds
    buffer_load_dwordx4 v10, s[8:11], s73 offen offset:1024  lds
    buffer_load_dwordx4 v11, s[8:11], s73 offen offset:2048  lds
    buffer_load_dwordx4 v12, s[8:11], s73 offen offset:2432  lds
    s_branch L_extra_back
L_hot_end:
L_bfail:
    v_mov_b32 v160, s54
    s_mov_b32 s96, 0
    ds_or_b32 v34, v160
    s_branch L_nob
L_afail:
    s_mov_b64 exec, s[88:89]
    ds_or_b32 v34, v32
    s_mov_b64 exec, s[90:91]
    ds_or_b32 v34, v33
    s_mov_b64 exec, -1
    s_waitcnt lgkmcnt(0)
    s_branch L_afail_back
L_slow:
    s_waitcnt vmcnt(0) lgkmcnt(0)
    s_barrier
    s_ff1_i32_b32 s80, s98
    s_bitset0_b32 s98, s80
    s_mul_i32 s81, s80, 224
    s_add_u32 s81, s81, s56
    s_mov_b32 s82, 1
    s_cmp_lt_u32 s80, 6
    s_cbranch_scc1 L_s1
    s_sub_u32 s30, s80, 6
    s_and_b32 s31, s30, 1
    s_lshr_b32 s30, s30, 1
    s_lshl2_add_u32 s30, s31, s30
    s_lshl4_add_u32 s30, s30, 396
    s_load_dword s81, s[6:7], s30
    s_cmp_eq_u32 s41, 0
    s_cselect_b32 s82, 1, 224
    s_waitcnt lgkmcnt(0)
L_s1:
    s_movk_i32 s59, 192
    s_movk_i32 s60, 224
    v_mul_u32_u24 v79, s82, v2
    v_add_u32 v79, s81, v79
    v_lshrrev_b32 v80, 4, v0
    v_min_u32 v80, 8, v80
    v_mul_u32_u24 v85, 36, v79
    v_lshl_add_u32 v85, v80, 2, v85
    buffer_load_dword v85, v85, s[12:15], 0 offen
    v_mul_u32_u24 v81, 74899, v79
    v_lshrrev_b32 v81, 24, v81
    v_mul_u32_u24 v82, 224, v81
    v_sub_u32 v82, v79, v82
    v_mul_u32_u24 v83, 11, v80
    v_lshrrev_b32 v83, 5, v83
    v_mad_i32_i24 v84, v83, -3, v80
    v_add3_u32 v81, v81, v83, -1
    v_add3_u32 v82, v82, v84, -1
    v_cvt_f32_i32 v81, v81
    v_cvt_f32_i32 v82, v82
    s_waitcnt vmcnt(0)
    v_lshlrev_b32 v65, 16, v85
    v_and_b32 v66, 0xffff0000, v85
    v_add_f32 v65, v81, v65
    v_add_f32 v66, v82, v66
    v_cvt_pk_bf16_f32 v64, v65, v66
    v_pk_max_i16 v64, v64, 0
    v_pk_min_i16 v64, v64, s63
    v_lshlrev_b32 v65, 16, v64
    v_and_b32 v66, 0xffff0000, v64
    v_fract_f32 v71, v65
    v_fract_f32 v72, v66
    v_ceil_f32 v68, v65
    v_ceil_f32 v70, v66
    v_sub_f32 v73, 1.0, v71
    v_sub_f32 v74, 1.0, v72
    v_cvt_u32_f32 v67, v65
    v_cvt_u32_f32 v69, v66
    v_cvt_pk_bf16_f32 v74, v73, v74
    v_cvt_u32_f32 v68, v68
    v_cvt_u32_f32 v70, v70
    v_lshlrev_b32 v73, 16, v74
    v_and_b32 v74, 0xffff0000, v74
    v_mul_f32 v78, v71, v72
    v_mul_f32 v76, v73, v72
    v_mul_f32 v77, v71, v74
    v_mul_f32 v75, v73, v74
    v_mad_u32_u24 v88, v67, s60, v69
    v_mul_u32_u24 v88, 192, v88
    v_mad_u32_u24 v89, v67, s60, v70
    v_mul_u32_u24 v89, 192, v89
    v_mad_u32_u24 v90, v68, s60, v69
    v_mul_u32_u24 v90, 192, v90
    v_mad_u32_u24 v91, v68, s60, v70
    v_mul_u32_u24 v91, 192, v91
    v_cvt_pk_bf16_f32 v92, v75, v76
    v_cvt_pk_bf16_f32 v93, v77, v78
    v_lshlrev_b32 v79, 5, v0
    v_add_u32 v79, 61440, v79
    ds_write_b128 v79, v[88:91]
    ds_write_b64 v79, v[92:93] offset:16
    s_mov_b32 s83, 0
    s_waitcnt lgkmcnt(0)
    s_barrier
L_s2:
    s_add_u32 s30, s83, 0
    v_add_u32 v96, s30, v0
    v_mul_u32_u24 v70, 5462, v96
    v_lshrrev_b32 v70, 16, v70
    v_mad_i32_i24 v71, v70, -12, v96
    v_lshlrev_b32 v70, 5, v70
    v_add_u32 v70, 61440, v70
    ds_read_b128 v[64:67], v70
    ds_read_b64 v[68:69], v70 offset:16
    v_lshlrev_b32 v96, 4, v96
    s_add_u32 s30, s83, 256
    v_add_u32 v97, s30, v0
    v_mul_u32_u24 v78, 5462, v97
    v_lshrrev_b32 v78, 16, v78
    v_mad_i32_i24 v79, v78, -12, v97
    v_lshlrev_b32 v78, 5, v78
    v_add_u32 v78, 61440, v78
    ds_read_b128 v[72:75], v78
    ds_read_b64 v[76:77], v78 offset:16
    v_lshlrev_b32 v97, 4, v97
    s_add_u32 s30, s83, 512
    v_add_u32 v98, s30, v0
    v_mul_u32_u24 v86, 5462, v98
    v_lshrrev_b32 v86, 16, v86
    v_mad_i32_i24 v87, v86, -12, v98
    v_lshlrev_b32 v86, 5, v86
    v_add_u32 v86, 61440, v86
    ds_read_b128 v[80:83], v86
    ds_read_b64 v[84:85], v86 offset:16
    v_lshlrev_b32 v98, 4, v98
    s_add_u32 s30, s83, 768
    v_add_u32 v99, s30, v0
    v_mul_u32_u24 v94, 5462, v99
    v_lshrrev_b32 v94, 16, v94
    v_mad_i32_i24 v95, v94, -12, v99
    v_lshlrev_b32 v94, 5, v94
    v_add_u32 v94, 61440, v94
    ds_read_b128 v[88:91], v94
    ds_read_b64 v[92:93], v94 offset:16
    v_lshlrev_b32 v99, 4, v99
    s_waitcnt lgkmcnt(0)
    v_lshl_add_u32 v64, v71, 4, v64
    buffer_load_dwordx4 v[100:103], v64, s[8:11], 0 offen
    v_lshl_add_u32 v65, v71, 4, v65
    buffer_load_dwordx4 v[104:107], v65, s[8:11], 0 offen
    v_lshl_add_u32 v66, v71, 4, v66
    buffer_load_dwordx4 v[108:111], v66, s[8:11], 0 offen
    v_lshl_add_u32 v67, v71, 4, v67
    buffer_load_dwordx4 v[112:115], v67, s[8:11], 0 offen
    v_lshl_add_u32 v72, v79, 4, v72
    buffer_load_dwordx4 v[116:119], v72, s[8:11], 0 offen
    v_lshl_add_u32 v73, v79, 4, v73
    buffer_load_dwordx4 v[120:123], v73, s[8:11], 0 offen
    v_lshl_add_u32 v74, v79, 4, v74
    buffer_load_dwordx4 v[124:127], v74, s[8:11], 0 offen
    v_lshl_add_u32 v75, v79, 4, v75
    buffer_load_dwordx4 v[128:131], v75, s[8:11], 0 offen
    v_lshl_add_u32 v80, v87, 4, v80
    buffer_load_dwordx4 v[132:135], v80, s[8:11], 0 offen
    v_lshl_add_u32 v81, v87, 4, v81
    buffer_load_dwordx4 v[136:139], v81, s[8:11], 0 offen
    v_lshl_add_u32 v82, v87, 4, v82
    buffer_load_dwordx4 v[140:143], v82, s[8:11], 0 offen
    v_lshl_add_u32 v83, v87, 4, v83
    buffer_load_dwordx4 v[144:147], v83, s[8:11], 0 offen
    v_lshl_add_u32 v88, v95, 4, v88
    buffer_load_dwordx4 v[148:151], v88, s[8:11], 0 offen
    v_lshl_add_u32 v89, v95, 4, v89
    buffer_load_dwordx4 v[152:155], v89, s[8:11], 0 offen
    v_lshl_add_u32 v90, v95, 4, v90
    buffer_load_dwordx4 v[156:159], v90, s[8:11], 0 offen
    v_lshl_add_u32 v91, v95, 4, v91
    buffer_load_dwordx4 v[160:163], v91, s[8:11], 0 offen
    s_waitcnt vmcnt(12)
    v_lshlrev_b32 v172, 16, v68
    v_lshlrev_b32 v173, 16, v100
    v_and_b32 v174, 0xffff0000, v100
    v_mul_f32 v164, v172, v173
    v_mul_f32 v165, v172, v174
    v_lshlrev_b32 v173, 16, v101
    v_and_b32 v174, 0xffff0000, v101
    v_mul_f32 v166, v172, v173
    v_mul_f32 v167, v172, v174
    v_lshlrev_b32 v173, 16, v102
    v_and_b32 v174, 0xffff0000, v102
    v_mul_f32 v168, v172, v173
    v_mul_f32 v169, v172, v174
    v_lshlrev_b32 v173, 16, v103
    v_and_b32 v174, 0xffff0000, v103
    v_mul_f32 v170, v172, v173
    v_mul_f32 v171, v172, v174
    v_and_b32 v172, 0xffff0000, v68
    v_lshlrev_b32 v173, 16, v104
    v_and_b32 v174, 0xffff0000, v104
    v_fmac_f32 v164, v172, v173
    v_fmac_f32 v165, v172, v174
    v_lshlrev_b32 v173, 16, v105
    v_and_b32 v174, 0xffff0000, v105
    v_fmac_f32 v166, v172, v173
    v_fmac_f32 v167, v172, v174
    v_lshlrev_b32 v173, 16, v106
    v_and_b32 v174, 0xffff0000, v106
    v_fmac_f32 v168, v172, v173
    v_fmac_f32 v169, v172, v174
    v_lshlrev_b32 v173, 16, v107
    v_and_b32 v174, 0xffff0000, v107
    v_fmac_f32 v170, v172, v173
    v_fmac_f32 v171, v172, v174
    v_lshlrev_b32 v172, 16, v69
    v_lshlrev_b32 v173, 16, v108
    v_and_b32 v174, 0xffff0000, v108
    v_fmac_f32 v164, v172, v173
    v_fmac_f32 v165, v172, v174
    v_lshlrev_b32 v173, 16, v109
    v_and_b32 v174, 0xffff0000, v109
    v_fmac_f32 v166, v172, v173
    v_fmac_f32 v167, v172, v174
    v_lshlrev_b32 v173, 16, v110
    v_and_b32 v174, 0xffff0000, v110
    v_fmac_f32 v168, v172, v173
    v_fmac_f32 v169, v172, v174
    v_lshlrev_b32 v173, 16, v111
    v_and_b32 v174, 0xffff0000, v111
    v_fmac_f32 v170, v172, v173
    v_fmac_f32 v171, v172, v174
    v_and_b32 v172, 0xffff0000, v69
    v_lshlrev_b32 v173, 16, v112
    v_and_b32 v174, 0xffff0000, v112
    v_fmac_f32 v164, v172, v173
    v_fmac_f32 v165, v172, v174
    v_lshlrev_b32 v173, 16, v113
    v_and_b32 v174, 0xffff0000, v113
    v_fmac_f32 v166, v172, v173
    v_fmac_f32 v167, v172, v174
    v_lshlrev_b32 v173, 16, v114
    v_and_b32 v174, 0xffff0000, v114
    v_fmac_f32 v168, v172, v173
    v_fmac_f32 v169, v172, v174
    v_lshlrev_b32 v173, 16, v115
    v_and_b32 v174, 0xffff0000, v115
    v_fmac_f32 v170, v172, v173
    v_fmac_f32 v171, v172, v174
    v_cvt_pk_bf16_f32 v176, v164, v165
    v_cvt_pk_bf16_f32 v177, v166, v167
    v_cvt_pk_bf16_f32 v178, v168, v169
    v_cvt_pk_bf16_f32 v179, v170, v171
    ds_write_b128 v96, v[176:179]
    s_waitcnt vmcnt(8)
    v_lshlrev_b32 v172, 16, v76
    v_lshlrev_b32 v173, 16, v116
    v_and_b32 v174, 0xffff0000, v116
    v_mul_f32 v164, v172, v173
    v_mul_f32 v165, v172, v174
    v_lshlrev_b32 v173, 16, v117
    v_and_b32 v174, 0xffff0000, v117
    v_mul_f32 v166, v172, v173
    v_mul_f32 v167, v172, v174
    v_lshlrev_b32 v173, 16, v118
    v_and_b32 v174, 0xffff0000, v118
    v_mul_f32 v168, v172, v173
    v_mul_f32 v169, v172, v174
    v_lshlrev_b32 v173, 16, v119
    v_and_b32 v174, 0xffff0000, v119
    v_mul_f32 v170, v172, v173
    v_mul_f32 v171, v172, v174
    v_and_b32 v172, 0xffff0000, v76
    v_lshlrev_b32 v173, 16, v120
    v_and_b32 v174, 0xffff0000, v120
    v_fmac_f32 v164, v172, v173
    v_fmac_f32 v165, v172, v174
    v_lshlrev_b32 v173, 16, v121
    v_and_b32 v174, 0xffff0000, v121
    v_fmac_f32 v166, v172, v173
    v_fmac_f32 v167, v172, v174
    v_lshlrev_b32 v173, 16, v122
    v_and_b32 v174, 0xffff0000, v122
    v_fmac_f32 v168, v172, v173
    v_fmac_f32 v169, v172, v174
    v_lshlrev_b32 v173, 16, v123
    v_and_b32 v174, 0xffff0000, v123
    v_fmac_f32 v170, v172, v173
    v_fmac_f32 v171, v172, v174
    v_lshlrev_b32 v172, 16, v77
    v_lshlrev_b32 v173, 16, v124
    v_and_b32 v174, 0xffff0000, v124
    v_fmac_f32 v164, v172, v173
    v_fmac_f32 v165, v172, v174
    v_lshlrev_b32 v173, 16, v125
    v_and_b32 v174, 0xffff0000, v125
    v_fmac_f32 v166, v172, v173
    v_fmac_f32 v167, v172, v174
    v_lshlrev_b32 v173, 16, v126
    v_and_b32 v174, 0xffff0000, v126
    v_fmac_f32 v168, v172, v173
    v_fmac_f32 v169, v172, v174
    v_lshlrev_b32 v173, 16, v127
    v_and_b32 v174, 0xffff0000, v127
    v_fmac_f32 v170, v172, v173
    v_fmac_f32 v171, v172, v174
    v_and_b32 v172, 0xffff0000, v77
    v_lshlrev_b32 v173, 16, v128
    v_and_b32 v174, 0xffff0000, v128
    v_fmac_f32 v164, v172, v173
    v_fmac_f32 v165, v172, v174
    v_lshlrev_b32 v173, 16, v129
    v_and_b32 v174, 0xffff0000, v129
    v_fmac_f32 v166, v172, v173
    v_fmac_f32 v167, v172, v174
    v_lshlrev_b32 v173, 16, v130
    v_and_b32 v174, 0xffff0000, v130
    v_fmac_f32 v168, v172, v173
    v_fmac_f32 v169, v172, v174
    v_lshlrev_b32 v173, 16, v131
    v_and_b32 v174, 0xffff0000, v131
    v_fmac_f32 v170, v172, v173
    v_fmac_f32 v171, v172, v174
    v_cvt_pk_bf16_f32 v176, v164, v165
    v_cvt_pk_bf16_f32 v177, v166, v167
    v_cvt_pk_bf16_f32 v178, v168, v169
    v_cvt_pk_bf16_f32 v179, v170, v171
    ds_write_b128 v97, v[176:179]
    s_waitcnt vmcnt(4)
    v_lshlrev_b32 v172, 16, v84
    v_lshlrev_b32 v173, 16, v132
    v_and_b32 v174, 0xffff0000, v132
    v_mul_f32 v164, v172, v173
    v_mul_f32 v165, v172, v174
    v_lshlrev_b32 v173, 16, v133
    v_and_b32 v174, 0xffff0000, v133
    v_mul_f32 v166, v172, v173
    v_mul_f32 v167, v172, v174
    v_lshlrev_b32 v173, 16, v134
    v_and_b32 v174, 0xffff0000, v134
    v_mul_f32 v168, v172, v173
    v_mul_f32 v169, v172, v174
    v_lshlrev_b32 v173, 16, v135
    v_and_b32 v174, 0xffff0000, v135
    v_mul_f32 v170, v172, v173
    v_mul_f32 v171, v172, v174
    v_and_b32 v172, 0xffff0000, v84
    v_lshlrev_b32 v173, 16, v136
    v_and_b32 v174, 0xffff0000, v136
    v_fmac_f32 v164, v172, v173
    v_fmac_f32 v165, v172, v174
    v_lshlrev_b32 v173, 16, v137
    v_and_b32 v174, 0xffff0000, v137
    v_fmac_f32 v166, v172, v173
    v_fmac_f32 v167, v172, v174
    v_lshlrev_b32 v173, 16, v138
    v_and_b32 v174, 0xffff0000, v138
    v_fmac_f32 v168, v172, v173
    v_fmac_f32 v169, v172, v174
    v_lshlrev_b32 v173, 16, v139
    v_and_b32 v174, 0xffff0000, v139
    v_fmac_f32 v170, v172, v173
    v_fmac_f32 v171, v172, v174
    v_lshlrev_b32 v172, 16, v85
    v_lshlrev_b32 v173, 16, v140
    v_and_b32 v174, 0xffff0000, v140
    v_fmac_f32 v164, v172, v173
    v_fmac_f32 v165, v172, v174
    v_lshlrev_b32 v173, 16, v141
    v_and_b32 v174, 0xffff0000, v141
    v_fmac_f32 v166, v172, v173
    v_fmac_f32 v167, v172, v174
    v_lshlrev_b32 v173, 16, v142
    v_and_b32 v174, 0xffff0000, v142
    v_fmac_f32 v168, v172, v173
    v_fmac_f32 v169, v172, v174
    v_lshlrev_b32 v173, 16, v143
    v_and_b32 v174, 0xffff0000, v143
    v_fmac_f32 v170, v172, v173
    v_fmac_f32 v171, v172, v174
    v_and_b32 v172, 0xffff0000, v85
    v_lshlrev_b32 v173, 16, v144
    v_and_b32 v174, 0xffff0000, v144
    v_fmac_f32 v164, v172, v173
    v_fmac_f32 v165, v172, v174
    v_lshlrev_b32 v173, 16, v145
    v_and_b32 v174, 0xffff0000, v145
    v_fmac_f32 v166, v172, v173
    v_fmac_f32 v167, v172, v174
    v_lshlrev_b32 v173, 16, v146
    v_and_b32 v174, 0xffff0000, v146
    v_fmac_f32 v168, v172, v173
    v_fmac_f32 v169, v172, v174
    v_lshlrev_b32 v173, 16, v147
    v_and_b32 v174, 0xffff0000, v147
    v_fmac_f32 v170, v172, v173
    v_fmac_f32 v171, v172, v174
    v_cvt_pk_bf16_f32 v176, v164, v165
    v_cvt_pk_bf16_f32 v177, v166, v167
    v_cvt_pk_bf16_f32 v178, v168, v169
    v_cvt_pk_bf16_f32 v179, v170, v171
    ds_write_b128 v98, v[176:179]
    s_waitcnt vmcnt(0)
    v_lshlrev_b32 v172, 16, v92
    v_lshlrev_b32 v173, 16, v148
    v_and_b32 v174, 0xffff0000, v148
    v_mul_f32 v164, v172, v173
    v_mul_f32 v165, v172, v174
    v_lshlrev_b32 v173, 16, v149
    v_and_b32 v174, 0xffff0000, v149
    v_mul_f32 v166, v172, v173
    v_mul_f32 v167, v172, v174
    v_lshlrev_b32 v173, 16, v150
    v_and_b32 v174, 0xffff0000, v150
    v_mul_f32 v168, v172, v173
    v_mul_f32 v169, v172, v174
    v_lshlrev_b32 v173, 16, v151
    v_and_b32 v174, 0xffff0000, v151
    v_mul_f32 v170, v172, v173
    v_mul_f32 v171, v172, v174
    v_and_b32 v172, 0xffff0000, v92
    v_lshlrev_b32 v173, 16, v152
    v_and_b32 v174, 0xffff0000, v152
    v_fmac_f32 v164, v172, v173
    v_fmac_f32 v165, v172, v174
    v_lshlrev_b32 v173, 16, v153
    v_and_b32 v174, 0xffff0000, v153
    v_fmac_f32 v166, v172, v173
    v_fmac_f32 v167, v172, v174
    v_lshlrev_b32 v173, 16, v154
    v_and_b32 v174, 0xffff0000, v154
    v_fmac_f32 v168, v172, v173
    v_fmac_f32 v169, v172, v174
    v_lshlrev_b32 v173, 16, v155
    v_and_b32 v174, 0xffff0000, v155
    v_fmac_f32 v170, v172, v173
    v_fmac_f32 v171, v172, v174
    v_lshlrev_b32 v172, 16, v93
    v_lshlrev_b32 v173, 16, v156
    v_and_b32 v174, 0xffff0000, v156
    v_fmac_f32 v164, v172, v173
    v_fmac_f32 v165, v172, v174
    v_lshlrev_b32 v173, 16, v157
    v_and_b32 v174, 0xffff0000, v157
    v_fmac_f32 v166, v172, v173
    v_fmac_f32 v167, v172, v174
    v_lshlrev_b32 v173, 16, v158
    v_and_b32 v174, 0xffff0000, v158
    v_fmac_f32 v168, v172, v173
    v_fmac_f32 v169, v172, v174
    v_lshlrev_b32 v173, 16, v159
    v_and_b32 v174, 0xffff0000, v159
    v_fmac_f32 v170, v172, v173
    v_fmac_f32 v171, v172, v174
    v_and_b32 v172, 0xffff0000, v93
    v_lshlrev_b32 v173, 16, v160
    v_and_b32 v174, 0xffff0000, v160
    v_fmac_f32 v164, v172, v173
    v_fmac_f32 v165, v172, v174
    v_lshlrev_b32 v173, 16, v161
    v_and_b32 v174, 0xffff0000, v161
    v_fmac_f32 v166, v172, v173
    v_fmac_f32 v167, v172, v174
    v_lshlrev_b32 v173, 16, v162
    v_and_b32 v174, 0xffff0000, v162
    v_fmac_f32 v168, v172, v173
    v_fmac_f32 v169, v172, v174
    v_lshlrev_b32 v173, 16, v163
    v_and_b32 v174, 0xffff0000, v163
    v_fmac_f32 v170, v172, v173
    v_fmac_f32 v171, v172, v174
    v_cvt_pk_bf16_f32 v176, v164, v165
    v_cvt_pk_bf16_f32 v177, v166, v167
    v_cvt_pk_bf16_f32 v178, v168, v169
    v_cvt_pk_bf16_f32 v179, v170, v171
    ds_write_b128 v99, v[176:179]
    s_add_u32 s83, s83, 1024
    s_cmp_lt_u32 s83, 1728
    s_cbranch_scc1 L_s2
    s_waitcnt lgkmcnt(0)
    s_barrier
    s_cmp_ge_u32 s3, 2
    s_cbranch_scc1 L_s3
    v_mad_u32_u24 v40, v2, s59, v4
    ds_read_b128 v[112:115], v40 offset:0
    ds_read_b128 v[116:119], v40 offset:64
    ds_read_b128 v[120:123], v40 offset:128
    s_waitcnt lgkmcnt(0)
    v_mfma_f32_16x16x32_bf16 v[64:67], a[0:3], v[112:115], 0
    v_mfma_f32_16x16x32_bf16 v[68:71], a[4:7], v[112:115], 0
    v_mfma_f32_16x16x32_bf16 v[72:75], a[8:11], v[112:115], 0
    v_mfma_f32_16x16x32_bf16 v[64:67], a[12:15], v[116:119], v[64:67]
    v_mfma_f32_16x16x32_bf16 v[68:71], a[16:19], v[116:119], v[68:71]
    v_mfma_f32_16x16x32_bf16 v[72:75], a[20:23], v[116:119], v[72:75]
    v_mfma_f32_16x16x32_bf16 v[64:67], a[24:27], v[120:123], v[64:67]
    v_mfma_f32_16x16x32_bf16 v[68:71], a[28:31], v[120:123], v[68:71]
    v_mfma_f32_16x16x32_bf16 v[72:75], a[32:35], v[120:123], v[72:75]
    s_nop 1
    ds_read_b128 v[112:115], v40 offset:3072
    ds_read_b128 v[116:119], v40 offset:3136
    ds_read_b128 v[120:123], v40 offset:3200
    s_waitcnt lgkmcnt(0)
    v_mfma_f32_16x16x32_bf16 v[64:67], a[36:39], v[112:115], v[64:67]
    v_mfma_f32_16x16x32_bf16 v[68:71], a[40:43], v[112:115], v[68:71]
    v_mfma_f32_16x16x32_bf16 v[72:75], a[44:47], v[112:115], v[72:75]
    v_mfma_f32_16x16x32_bf16 v[64:67], a[48:51], v[116:119], v[64:67]
    v_mfma_f32_16x16x32_bf16 v[68:71], a[52:55], v[116:119], v[68:71]
    v_mfma_f32_16x16x32_bf16 v[72:75], a[56:59], v[116:119], v[72:75]
    v_mfma_f32_16x16x32_bf16 v[64:67], a[60:63], v[120:123], v[64:67]
    v_mfma_f32_16x16x32_bf16 v[68:71], a[64:67], v[120:123], v[68:71]
    v_mfma_f32_16x16x32_bf16 v[72:75], a[68:71], v[120:123], v[72:75]
    s_nop 1
    ds_read_b128 v[112:115], v40 offset:6144
    ds_read_b128 v[116:119], v40 offset:6208
    ds_read_b128 v[120:123], v40 offset:6272
    s_waitcnt lgkmcnt(0)
    v_mfma_f32_16x16x32_bf16 v[64:67], a[72:75], v[112:115], v[64:67]
    v_mfma_f32_16x16x32_bf16 v[68:71], a[76:79], v[112:115], v[68:71]
    v_mfma_f32_16x16x32_bf16 v[72:75], a[80:83], v[112:115], v[72:75]
    v_mfma_f32_16x16x32_bf16 v[64:67], a[84:87], v[116:119], v[64:67]
    v_mfma_f32_16x16x32_bf16 v[68:71], a[88:91], v[116:119], v[68:71]
    v_mfma_f32_16x16x32_bf16 v[72:75], a[92:95], v[116:119], v[72:75]
    v_mfma_f32_16x16x32_bf16 v[64:67], a[96:99], v[120:123], v[64:67]
    v_mfma_f32_16x16x32_bf16 v[68:71], a[100:103], v[120:123], v[68:71]
    v_mfma_f32_16x16x32_bf16 v[72:75], a[104:107], v[120:123], v[72:75]
    s_nop 1
    ds_read_b128 v[112:115], v40 offset:9216
    ds_read_b128 v[116:119], v40 offset:9280
    ds_read_b128 v[120:123], v40 offset:9344
    s_waitcnt lgkmcnt(0)
    v_mfma_f32_16x16x32_bf16 v[64:67], a[108:111], v[112:115], v[64:67]
    v_mfma_f32_16x16x32_bf16 v[68:71], a[112:115], v[112:115], v[68:71]
    v_mfma_f32_16x16x32_bf16 v[72:75], a[116:119], v[112:115], v[72:75]
    v_mfma_f32_16x16x32_bf16 v[64:67], a[120:123], v[116:119], v[64:67]
    v_mfma_f32_16x16x32_bf16 v[68:71], a[124:127], v[116:119], v[68:71]
    v_mfma_f32_16x16x32_bf16 v[72:75], a[128:131], v[116:119], v[72:75]
    v_mfma_f32_16x16x32_bf16 v[64:67], a[132:135], v[120:123], v[64:67]
    v_mfma_f32_16x16x32_bf16 v[68:71], a[136:139], v[120:123], v[68:71]
    v_mfma_f32_16x16x32_bf16 v[72:75], a[140:143], v[120:123], v[72:75]
    s_nop 1
    ds_read_b128 v[112:115], v40 offset:12288
    ds_read_b128 v[116:119], v40 offset:12352
    ds_read_b128 v[120:123], v40 offset:12416
    s_waitcnt lgkmcnt(0)
    v_mfma_f32_16x16x32_bf16 v[64:67], a[144:147], v[112:115], v[64:67]
    v_mfma_f32_16x16x32_bf16 v[68:71], a[148:151], v[112:115], v[68:71]
    v_mfma_f32_16x16x32_bf16 v[72:75], a[152:155], v[112:115], v[72:75]
    v_mfma_f32_16x16x32_bf16 v[64:67], a[156:159], v[116:119], v[64:67]
    v_mfma_f32_16x16x32_bf16 v[68:71], a[160:163], v[116:119], v[68:71]
    v_mfma_f32_16x16x32_bf16 v[72:75], a[164:167], v[116:119], v[72:75]
    v_mfma_f32_16x16x32_bf16 v[64:67], a[168:171], v[120:123], v[64:67]
    v_mfma_f32_16x16x32_bf16 v[68:71], a[172:175], v[120:123], v[68:71]
    v_mfma_f32_16x16x32_bf16 v[72:75], a[176:179], v[120:123], v[72:75]
    s_nop 1
    ds_read_b128 v[112:115], v40 offset:15360
    ds_read_b128 v[116:119], v40 offset:15424
    ds_read_b128 v[120:123], v40 offset:15488
    s_waitcnt lgkmcnt(0)
    v_mfma_f32_16x16x32_bf16 v[64:67], a[180:183], v[112:115], v[64:67]
    v_mfma_f32_16x16x32_bf16 v[68:71], a[184:187], v[112:115], v[68:71]
    v_mfma_f32_16x16x32_bf16 v[72:75], a[188:191], v[112:115], v[72:75]
    v_mfma_f32_16x16x32_bf16 v[64:67], a[192:195], v[116:119], v[64:67]
    v_mfma_f32_16x16x32_bf16 v[68:71], a[196:199], v[116:119], v[68:71]
    v_mfma_f32_16x16x32_bf16 v[72:75], a[200:203], v[116:119], v[72:75]
    v_mfma_f32_16x16x32_bf16 v[64:67], a[204:207], v[120:123], v[64:67]
    v_mfma_f32_16x16x32_bf16 v[68:71], a[208:211], v[120:123], v[68:71]
    v_mfma_f32_16x16x32_bf16 v[72:75], a[212:215], v[120:123], v[72:75]
    s_nop 1
    ds_read_b128 v[112:115], v40 offset:18432
    ds_read_b128 v[116:119], v40 offset:18496
    ds_read_b128 v[120:123], v40 offset:18560
    s_waitcnt lgkmcnt(0)
    v_mfma_f32_16x16x32_bf16 v[64:67], a[216:219], v[112:115], v[64:67]
    v_mfma_f32_16x16x32_bf16 v[68:71], a[220:223], v[112:115], v[68:71]
    v_mfma_f32_16x16x32_bf16 v[72:75], a[224:227], v[112:115], v[72:75]
    v_mfma_f32_16x16x32_bf16 v[64:67], a[228:231], v[116:119], v[64:67]
    v_mfma_f32_16x16x32_bf16 v[68:71], a[232:235], v[116:119], v[68:71]
    v_mfma_f32_16x16x32_bf16 v[72:75], a[236:239], v[116:119], v[72:75]
    v_mfma_f32_16x16x32_bf16 v[64:67], a[240:243], v[120:123], v[64:67]
    v_mfma_f32_16x16x32_bf16 v[68:71], a[244:247], v[120:123], v[68:71]
    v_mfma_f32_16x16x32_bf16 v[72:75], a[248:251], v[120:123], v[72:75]
    s_nop 1
    ds_read_b128 v[112:115], v40 offset:21504
    ds_read_b128 v[116:119], v40 offset:21568
    ds_read_b128 v[120:123], v40 offset:21632
    s_waitcnt lgkmcnt(0)
    v_mfma_f32_16x16x32_bf16 v[64:67], a[252:255], v[112:115], v[64:67]
    v_mfma_f32_16x16x32_bf16 v[68:71], v[188:191], v[112:115], v[68:71]
    v_mfma_f32_16x16x32_bf16 v[72:75], v[192:195], v[112:115], v[72:75]
    v_mfma_f32_16x16x32_bf16 v[64:67], v[196:199], v[116:119], v[64:67]
    v_mfma_f32_16x16x32_bf16 v[68:71], v[200:203], v[116:119], v[68:71]
    v_mfma_f32_16x16x32_bf16 v[72:75], v[204:207], v[116:119], v[72:75]
    v_mfma_f32_16x16x32_bf16 v[64:67], v[208:211], v[120:123], v[64:67]
    v_mfma_f32_16x16x32_bf16 v[68:71], v[212:215], v[120:123], v[68:71]
    v_mfma_f32_16x16x32_bf16 v[72:75], v[216:219], v[120:123], v[72:75]
    s_nop 1
    ds_read_b128 v[112:115], v40 offset:24576
    ds_read_b128 v[116:119], v40 offset:24640
    ds_read_b128 v[120:123], v40 offset:24704
    s_waitcnt lgkmcnt(0)
    v_mfma_f32_16x16x32_bf16 v[64:67], v[220:223], v[112:115], v[64:67]
    v_mfma_f32_16x16x32_bf16 v[68:71], v[224:227], v[112:115], v[68:71]
    v_mfma_f32_16x16x32_bf16 v[72:75], v[228:231], v[112:115], v[72:75]
    v_mfma_f32_16x16x32_bf16 v[64:67], v[232:235], v[116:119], v[64:67]
    v_mfma_f32_16x16x32_bf16 v[68:71], v[236:239], v[116:119], v[68:71]
    v_mfma_f32_16x16x32_bf16 v[72:75], v[240:243], v[116:119], v[72:75]
    v_mfma_f32_16x16x32_bf16 v[64:67], v[244:247], v[120:123], v[64:67]
    v_mfma_f32_16x16x32_bf16 v[68:71], v[248:251], v[120:123], v[68:71]
    v_mfma_f32_16x16x32_bf16 v[72:75], v[252:255], v[120:123], v[72:75]
    s_nop 1
    s_mul_i32 s81, s81, 192
    s_cmp_lt_u32 s80, 6
    s_cselect_b64 vcc, -1, 0
    v_cndmask_b32 v40, v21, v19, vcc
    v_cndmask_b32 v41, v22, v20, vcc
    s_nop 5
    v_cvt_pk_bf16_f32 v144, v64, v65
    v_cvt_pk_bf16_f32 v145, v66, v67
    v_cvt_pk_bf16_f32 v146, v68, v69
    v_cvt_pk_bf16_f32 v147, v70, v71
    v_cvt_pk_bf16_f32 v148, v72, v73
    v_cvt_pk_bf16_f32 v149, v74, v75
    v_permlane16_swap_b32 v144, v146
    v_permlane16_swap_b32 v145, v147
    buffer_store_dwordx4 v[144:147], v40, s[20:23], s81 offen sc1
    buffer_store_dwordx2 v[148:149], v41, s[20:23], s81 offen sc1
L_s3:
    s_branch L_check
.p2align 8
.type L_table,@object
L_table:
    .long 2030400,17,2130706432,0,2130706432,2130706432,36,36,4294967294,0,0,5,3456,106368,18,1065353216
    .long 148224,192,17,388800,396,1040203264,2048,3,10800,2331456,0,0,0,0,0,0
    .long 89088,2374464,102912,2546496,116736,129024,143232,2130706432,143232,2130706432,2331648,2417664,2503680,2503680,2073600,0
    .long 92544,2417472,106368,0,120192,172032,143232,2130706432,143232,2130706432,2331648,2417664,2503680,2503680,2073600,0
    .long 96000,2460480,109824,43008,143232,2130706432,143232,2130706432,143232,2130706432,2374656,2460672,0,0,2202624,0
    .long 99456,2503488,113280,86016,143232,2130706432,143232,2130706432,143232,2130706432,2374656,2460672,0,0,2202624,0
    .long 85632,226495872,1,12144,92544,226495872,1,12592,99456,226495872,1,13040,99456,226495872,1,13040
    .long 89088,226495872,1,12368,96000,226495872,1,12816,106368,226492416,0,0,106368,226492416,0,0
    .long 6162240,17,129024,137088,2130706432,2130706432,36,36,15,0,14,6,3456,102912,18,1065369984
    .long 148224,192,17,1163520,360,1040203392,3072,3,32320,6463296,0,0,0,0,0,0
    .long 89088,6506304,102912,602112,116736,774144,143232,2130706432,143232,2130706432,6463488,6549504,688128,688128,6205440,0
    .long 92544,6549312,106368,645120,120192,817152,143232,2130706432,143232,2130706432,6463488,6549504,688128,688128,6205440,0
    .long 96000,6592320,109824,688128,143232,2130706432,143232,2130706432,143232,2130706432,6506496,6592512,731136,731136,6334464,0
    .long 99456,6635328,113280,731136,143232,2130706432,143232,2130706432,143232,2130706432,6506496,6592512,731136,731136,6334464,0
    .long 85632,226495872,1,33664,92544,226495872,1,34112,109824,226495872,0,3584,109824,226495872,0,3584
    .long 89088,226495872,1,33888,96000,226495872,1,34336,113280,226495872,0,3808,113280,226495872,0,3808
    .long 2039616,17,903168,911232,904032,912096,36,54,111,0,111,4,9600,89088,50,1065370336
    .long 146688,192,17,390528,216,1048591872,4032,3,10848,2340672,0,0,0,0,0,0
    .long 89088,4773888,92160,4776960,95232,4780032,143232,2130706432,143232,2130706432,4816896,4819968,4823040,4823040,2082816,0
    .long 98688,4816896,101760,4819968,104832,4823040,143232,2130706432,143232,2130706432,4816896,4819968,4823040,4823040,2082816,0
    .long 108288,4859904,111360,4862976,114432,4866048,143232,2130706432,143232,2130706432,4859904,4862976,4866048,4866048,2211840,0
    .long 117888,4902912,120960,4905984,124032,4909056,143232,2130706432,143232,2130706432,4859904,4862976,4866048,4866048,2211840,0
    .long 98688,629155200,0,25088,98688,629155200,16,25104,98688,629155200,32,25120,98688,629155200,32,25120
    .long 108288,629155200,0,25312,108288,629155200,16,25328,108288,629155200,32,25344,108288,629155200,32,25344
    .long 4107072,17,1354752,1362816,1355616,1363680,36,54,167,0,167,4,9600,89088,50,1065370408
    .long 146688,192,17,778176,216,1048592000,4032,3,21616,4408128,0,0,0,0,0,0
    .long 89088,7182336,92160,7185408,95232,7188480,143232,2130706432,143232,2130706432,7225344,7228416,7231488,7231488,4150272,0
    .long 98688,7225344,101760,7228416,104832,7231488,143232,2130706432,143232,2130706432,7225344,7228416,7231488,7231488,4150272,0
    .long 108288,7268352,111360,7271424,114432,7274496,143232,2130706432,143232,2130706432,7268352,7271424,7274496,7274496,4279296,0
    .long 117888,7311360,120960,7314432,124032,7317504,143232,2130706432,143232,2130706432,7268352,7271424,7274496,7274496,4279296,0
    .long 98688,629155200,0,37632,98688,629155200,16,37648,98688,629155200,32,37664,98688,629155200,32,37664
    .long 108288,629155200,0,37856,108288,629155200,16,37872,108288,629155200,32,37888,108288,629155200,32,37888
    .long 6174528,17,576,612,194112,194148,8064,54,15,1,14,6,9600,89088,50,1065369984
    .long 146688,43008,17,1165824,216,1048592000,4032,3,32384,6475584,1,0,0,0,0,0
    .long 89088,2688,127488,3456,111360,691200,95232,1378944,133632,1379712,3072,691200,1379328,1379328,6217728,0
    .long 98688,2880,137088,3648,120960,691392,104832,1379136,143232,1379904,3072,691200,1379328,1379328,6217728,0
    .long 108288,3072,92160,690816,130560,691584,114432,1379328,143232,1379904,3264,691392,1379520,1379520,6346752,0
    .long 117888,3264,101760,691008,140160,691776,124032,1379520,143232,1379904,3264,691392,1379520,1379520,6346752,0
    .long 108288,629155200,0,16,108288,629155200,16,3600,108288,629155200,32,7184,108288,629155200,32,7184
    .long 117888,629155200,0,17,117888,629155200,16,3601,117888,629155200,32,7185,117888,629155200,32,7185
    .long 2051904,17,2304,2340,195840,195876,8064,54,63,1,63,4,9600,89088,50,1065370240
    .long 146688,43008,17,392832,216,1048591872,4032,3,10912,2352960,0,0,0,0,0,0
    .long 89088,12096,92160,700224,95232,1388352,143232,2130706432,143232,2130706432,12288,700416,1388544,1388544,2095104,0
    .long 98688,12288,101760,700416,104832,1388544,143232,2130706432,143232,2130706432,12288,700416,1388544,1388544,2095104,0
    .long 108288,12480,111360,700608,114432,1388736,143232,2130706432,143232,2130706432,12480,700608,1388736,1388736,2224128,0
    .long 117888,12672,120960,700800,124032,1388928,143232,2130706432,143232,2130706432,12480,700608,1388736,1388736,2224128,0
    .long 98688,629155200,0,64,98688,629155200,16,3648,98688,629155200,32,7232,98688,629155200,32,7232
    .long 108288,629155200,0,65,108288,629155200,16,3649,108288,629155200,32,7233,108288,629155200,32,7233
    .long 4119360,17,4320,4356,197856,197892,8064,54,119,1,119,4,9600,89088,50,1065370352
    .long 146688,43008,17,780480,216,1048592000,4032,3,21680,4420416,0,0,0,0,0,0
    .long 89088,22848,92160,710976,95232,1399104,143232,2130706432,143232,2130706432,23040,711168,1399296,1399296,4162560,0
    .long 98688,23040,101760,711168,104832,1399296,143232,2130706432,143232,2130706432,23040,711168,1399296,1399296,4162560,0
    .long 108288,23232,111360,711360,114432,1399488,143232,2130706432,143232,2130706432,23232,711360,1399488,1399488,4291584,0
    .long 117888,23424,120960,711552,124032,1399680,143232,2130706432,143232,2130706432,23232,711360,1399488,1399488,4291584,0
    .long 98688,629155200,0,120,98688,629155200,16,3704,98688,629155200,32,7288,98688,629155200,32,7288
    .long 108288,629155200,0,121,108288,629155200,16,3705,108288,629155200,32,7289,108288,629155200,32,7289
    .long 6186816,17,6336,6372,199872,199908,8064,54,175,1,175,4,9600,89088,50,1065370416
    .long 146688,43008,17,1168128,216,1048592000,4032,3,32448,6487872,0,0,0,0,0,0
    .long 89088,33600,92160,721728,95232,1409856,143232,2130706432,143232,2130706432,33792,721920,1410048,1410048,6230016,0
    .long 98688,33792,101760,721920,104832,1410048,143232,2130706432,143232,2130706432,33792,721920,1410048,1410048,6230016,0
    .long 108288,33984,111360,722112,114432,1410240,143232,2130706432,143232,2130706432,33984,722112,1410240,1410240,6359040,0
    .long 117888,34176,120960,722304,124032,1410432,143232,2130706432,143232,2130706432,33984,722112,1410240,1410240,6359040,0
    .long 98688,629155200,0,176,98688,629155200,16,3760,98688,629155200,32,7344,98688,629155200,32,7344
    .long 108288,629155200,0,177,108288,629155200,16,3761,108288,629155200,32,7345,108288,629155200,32,7345
    .long 2503488,17,2130706432,8064,2130706432,2130706432,36,36,4294967295,0,0,5,3456,106368,18,1065369472
    .long 148224,192,17,477504,396,1040203264,2048,3,13264,2804544,0,0,0,0,0,0
    .long 89088,2847552,102912,3019584,116736,129024,143232,2130706432,143232,2130706432,2804736,2890752,2976768,2976768,2546688,0
    .long 92544,2890560,106368,0,120192,172032,143232,2130706432,143232,2130706432,2804736,2890752,2976768,2976768,2546688,0
    .long 96000,2933568,109824,43008,143232,2130706432,143232,2130706432,143232,2130706432,2847744,2933760,43008,43008,2675712,0
    .long 99456,2976576,113280,86016,143232,2130706432,143232,2130706432,143232,2130706432,2847744,2933760,43008,43008,2675712,0
    .long 85632,226495872,1,14608,92544,226495872,1,15056,99456,226495872,1,15504,99456,226495872,1,15504
    .long 89088,226495872,1,14832,96000,226495872,1,15280,109824,226495872,0,224,109824,226495872,0,224
    .long 6592320,17,145152,153216,2130706432,2130706432,36,36,17,0,16,6,3456,102912,18,1065370000
    .long 148224,192,17,1244160,360,1040203392,3072,3,34560,6893376,0,0,0,0,0,0
    .long 89088,6936384,102912,688128,116736,860160,143232,2130706432,143232,2130706432,6893568,6979584,774144,774144,6635520,0
    .long 92544,6979392,106368,731136,120192,903168,143232,2130706432,143232,2130706432,6893568,6979584,774144,774144,6635520,0
    .long 96000,7022400,109824,774144,143232,2130706432,143232,2130706432,143232,2130706432,6936576,7022592,817152,817152,6764544,0
    .long 99456,7065408,113280,817152,143232,2130706432,143232,2130706432,143232,2130706432,6936576,7022592,817152,817152,6764544,0
    .long 85632,226495872,1,35904,92544,226495872,1,36352,109824,226495872,0,4032,109824,226495872,0,4032
    .long 89088,226495872,1,36128,96000,226495872,1,36576,113280,226495872,0,4256,113280,226495872,0,4256
    .long 2297664,17,919296,927360,920160,928224,36,54,113,0,113,4,9600,89088,50,1065370340
    .long 146688,192,17,438912,216,1048591872,4032,3,12192,2598720,0,0,0,0,0,0
    .long 89088,4859904,92160,4862976,95232,4866048,143232,2130706432,143232,2130706432,4902912,4905984,4909056,4909056,2340864,0
    .long 98688,4902912,101760,4905984,104832,4909056,143232,2130706432,143232,2130706432,4902912,4905984,4909056,4909056,2340864,0
    .long 108288,4945920,111360,4948992,114432,4952064,143232,2130706432,143232,2130706432,4945920,4948992,4952064,4952064,2469888,0
    .long 117888,4988928,120960,4992000,124032,4995072,143232,2130706432,143232,2130706432,4945920,4948992,4952064,4952064,2469888,0
    .long 98688,629155200,0,25536,98688,629155200,16,25552,98688,629155200,32,25568,98688,629155200,32,25568
    .long 108288,629155200,0,25760,108288,629155200,16,25776,108288,629155200,32,25792,108288,629155200,32,25792
    .long 4365120,17,1370880,1378944,1371744,1379808,36,54,169,0,169,4,9600,89088,50,1065370410
    .long 146688,192,17,826560,216,1048592000,4032,3,22960,4666176,0,0,0,0,0,0
    .long 89088,7268352,92160,7271424,95232,7274496,143232,2130706432,143232,2130706432,7311360,7314432,7317504,7317504,4408320,0
    .long 98688,7311360,101760,7314432,104832,7317504,143232,2130706432,143232,2130706432,7311360,7314432,7317504,7317504,4408320,0
    .long 108288,7354368,111360,7357440,114432,7360512,143232,2130706432,143232,2130706432,7354368,7357440,7360512,7360512,4537344,0
    .long 117888,7397376,120960,7400448,124032,7403520,143232,2130706432,143232,2130706432,7354368,7357440,7360512,7360512,4537344,0
    .long 98688,629155200,0,38080,98688,629155200,16,38096,98688,629155200,32,38112,98688,629155200,32,38112
    .long 108288,629155200,0,38304,108288,629155200,16,38320,108288,629155200,32,38336,108288,629155200,32,38336
    .long 6432576,17,648,684,194184,194220,8064,54,17,1,16,6,9600,89088,50,1065370000
    .long 146688,43008,17,1214208,216,1048592000,4032,3,33728,6733632,1,0,0,0,0,0
    .long 89088,3072,127488,3840,111360,691584,95232,1379328,133632,1380096,3456,691584,1379712,1379712,6475776,0
    .long 98688,3264,137088,4032,120960,691776,104832,1379520,143232,1380288,3456,691584,1379712,1379712,6475776,0
    .long 108288,3456,92160,691200,130560,691968,114432,1379712,143232,1380288,3648,691776,1379904,1379904,6604800,0
    .long 117888,3648,101760,691392,140160,692160,124032,1379904,143232,1380288,3648,691776,1379904,1379904,6604800,0
    .long 108288,629155200,0,18,108288,629155200,16,3602,108288,629155200,32,7186,108288,629155200,32,7186
    .long 117888,629155200,0,19,117888,629155200,16,3603,117888,629155200,32,7187,117888,629155200,32,7187
    .long 2309952,17,2376,2412,195912,195948,8064,54,65,1,65,4,9600,89088,50,1065370244
    .long 146688,43008,17,441216,216,1048591872,4032,3,12256,2611008,0,0,0,0,0,0
    .long 89088,12480,92160,700608,95232,1388736,143232,2130706432,143232,2130706432,12672,700800,1388928,1388928,2353152,0
    .long 98688,12672,101760,700800,104832,1388928,143232,2130706432,143232,2130706432,12672,700800,1388928,1388928,2353152,0
    .long 108288,12864,111360,700992,114432,1389120,143232,2130706432,143232,2130706432,12864,700992,1389120,1389120,2482176,0
    .long 117888,13056,120960,701184,124032,1389312,143232,2130706432,143232,2130706432,12864,700992,1389120,1389120,2482176,0
    .long 98688,629155200,0,66,98688,629155200,16,3650,98688,629155200,32,7234,98688,629155200,32,7234
    .long 108288,629155200,0,67,108288,629155200,16,3651,108288,629155200,32,7235,108288,629155200,32,7235
    .long 4377408,17,4392,4428,197928,197964,8064,54,121,1,121,4,9600,89088,50,1065370356
    .long 146688,43008,17,828864,216,1048592000,4032,3,23024,4678464,0,0,0,0,0,0
    .long 89088,23232,92160,711360,95232,1399488,143232,2130706432,143232,2130706432,23424,711552,1399680,1399680,4420608,0
    .long 98688,23424,101760,711552,104832,1399680,143232,2130706432,143232,2130706432,23424,711552,1399680,1399680,4420608,0
    .long 108288,23616,111360,711744,114432,1399872,143232,2130706432,143232,2130706432,23616,711744,1399872,1399872,4549632,0
    .long 117888,23808,120960,711936,124032,1400064,143232,2130706432,143232,2130706432,23616,711744,1399872,1399872,4549632,0
    .long 98688,629155200,0,122,98688,629155200,16,3706,98688,629155200,32,7290,98688,629155200,32,7290
    .long 108288,629155200,0,123,108288,629155200,16,3707,108288,629155200,32,7291,108288,629155200,32,7291
    .long 6444864,17,6408,6444,199944,199980,8064,54,177,1,177,4,9600,89088,50,1065370418
    .long 146688,43008,17,1216512,216,1048592000,4032,3,33792,6745920,0,0,0,0,0,0
    .long 89088,33984,92160,722112,95232,1410240,143232,2130706432,143232,2130706432,34176,722304,1410432,1410432,6488064,0
    .long 98688,34176,101760,722304,104832,1410432,143232,2130706432,143232,2130706432,34176,722304,1410432,1410432,6488064,0
    .long 108288,34368,111360,722496,114432,1410624,143232,2130706432,143232,2130706432,34368,722496,1410624,1410624,6617088,0
    .long 117888,34560,120960,722688,124032,1410816,143232,2130706432,143232,2130706432,34368,722496,1410624,1410624,6617088,0
    .long 98688,629155200,0,178,98688,629155200,16,3762,98688,629155200,32,7346,98688,629155200,32,7346
    .long 108288,629155200,0,179,108288,629155200,16,3763,108288,629155200,32,7347,108288,629155200,32,7347
    .long 2976576,17,2130706432,16128,2130706432,2130706432,36,36,0,0,0,5,3456,106368,18,1065369600
    .long 148224,192,17,566208,396,1040203392,2048,3,15728,3277632,0,0,0,0,0,0
    .long 89088,3320640,102912,3492672,116736,129024,143232,2130706432,143232,2130706432,3277824,3363840,3449856,3449856,3019776,0
    .long 92544,3363648,106368,0,120192,172032,143232,2130706432,143232,2130706432,3277824,3363840,3449856,3449856,3019776,0
    .long 96000,3406656,109824,43008,143232,2130706432,143232,2130706432,143232,2130706432,3320832,3406848,86016,86016,3148800,0
    .long 99456,3449664,113280,86016,143232,2130706432,143232,2130706432,143232,2130706432,3320832,3406848,86016,86016,3148800,0
    .long 85632,226495872,1,17072,92544,226495872,1,17520,99456,226495872,1,17968,99456,226495872,1,17968
    .long 89088,226495872,1,17296,96000,226495872,1,17744,113280,226495872,0,448,113280,226495872,0,448
    .long 7022400,17,161280,169344,2130706432,2130706432,36,36,19,0,18,6,3456,102912,18,1065370016
    .long 148224,192,17,1324800,360,1040203392,3072,3,36800,7323456,0,0,0,0,0,0
    .long 89088,7366464,102912,774144,116736,946176,143232,2130706432,143232,2130706432,7323648,7409664,860160,860160,7065600,0
    .long 92544,7409472,106368,817152,120192,989184,143232,2130706432,143232,2130706432,7323648,7409664,860160,860160,7065600,0
    .long 96000,7452480,109824,860160,143232,2130706432,143232,2130706432,143232,2130706432,7366656,7452672,903168,903168,7194624,0
    .long 99456,7495488,113280,903168,143232,2130706432,143232,2130706432,143232,2130706432,7366656,7452672,903168,903168,7194624,0
    .long 85632,226495872,1,38144,92544,226495872,1,38592,109824,226495872,0,4480,109824,226495872,0,4480
    .long 89088,226495872,1,38368,96000,226495872,1,38816,113280,226495872,0,4704,113280,226495872,0,4704
    .long 2555712,17,935424,943488,936288,944352,36,54,115,0,115,4,9600,89088,50,1065370344
    .long 146688,192,17,487296,216,1048591872,4032,3,13536,2856768,0,0,0,0,0,0
    .long 89088,4945920,92160,4948992,95232,4952064,143232,2130706432,143232,2130706432,4988928,4992000,4995072,4995072,2598912,0
    .long 98688,4988928,101760,4992000,104832,4995072,143232,2130706432,143232,2130706432,4988928,4992000,4995072,4995072,2598912,0
    .long 108288,5031936,111360,5035008,114432,5038080,143232,2130706432,143232,2130706432,5031936,5035008,5038080,5038080,2727936,0
    .long 117888,5074944,120960,5078016,124032,5081088,143232,2130706432,143232,2130706432,5031936,5035008,5038080,5038080,2727936,0
    .long 98688,629155200,0,25984,98688,629155200,16,26000,98688,629155200,32,26016,98688,629155200,32,26016
    .long 108288,629155200,0,26208,108288,629155200,16,26224,108288,629155200,32,26240,108288,629155200,32,26240
    .long 4623168,17,1387008,1395072,1387872,1395936,36,54,171,0,171,4,9600,89088,50,1065370412
    .long 146688,192,17,874944,216,1048592000,4032,3,24304,4924224,0,0,0,0,0,0
    .long 89088,7354368,92160,7357440,95232,7360512,143232,2130706432,143232,2130706432,7397376,7400448,7403520,7403520,4666368,0
    .long 98688,7397376,101760,7400448,104832,7403520,143232,2130706432,143232,2130706432,7397376,7400448,7403520,7403520,4666368,0
    .long 108288,7440384,111360,7443456,114432,7446528,143232,2130706432,143232,2130706432,7440384,7443456,7446528,7446528,4795392,0
    .long 117888,7483392,120960,7486464,124032,7489536,143232,2130706432,143232,2130706432,7440384,7443456,7446528,7446528,4795392,0
    .long 98688,629155200,0,38528,98688,629155200,16,38544,98688,629155200,32,38560,98688,629155200,32,38560
    .long 108288,629155200,0,38752,108288,629155200,16,38768,108288,629155200,32,38784,108288,629155200,32,38784
    .long 6690624,17,720,756,194256,194292,8064,54,19,1,18,6,9600,89088,50,1065370016
    .long 146688,43008,17,1262592,216,1048592000,4032,3,35072,6991680,1,0,0,0,0,0
    .long 89088,3456,127488,4224,111360,691968,95232,1379712,133632,1380480,3840,691968,1380096,1380096,6733824,0
    .long 98688,3648,137088,4416,120960,692160,104832,1379904,143232,1380672,3840,691968,1380096,1380096,6733824,0
    .long 108288,3840,92160,691584,130560,692352,114432,1380096,143232,1380672,4032,692160,1380288,1380288,6862848,0
    .long 117888,4032,101760,691776,140160,692544,124032,1380288,143232,1380672,4032,692160,1380288,1380288,6862848,0
    .long 108288,629155200,0,20,108288,629155200,16,3604,108288,629155200,32,7188,108288,629155200,32,7188
    .long 117888,629155200,0,21,117888,629155200,16,3605,117888,629155200,32,7189,117888,629155200,32,7189
    .long 2568000,17,2448,2484,195984,196020,8064,54,67,1,67,4,9600,89088,50,1065370248
    .long 146688,43008,17,489600,216,1048591872,4032,3,13600,2869056,0,0,0,0,0,0
    .long 89088,12864,92160,700992,95232,1389120,143232,2130706432,143232,2130706432,13056,701184,1389312,1389312,2611200,0
    .long 98688,13056,101760,701184,104832,1389312,143232,2130706432,143232,2130706432,13056,701184,1389312,1389312,2611200,0
    .long 108288,13248,111360,701376,114432,1389504,143232,2130706432,143232,2130706432,13248,701376,1389504,1389504,2740224,0
    .long 117888,13440,120960,701568,124032,1389696,143232,2130706432,143232,2130706432,13248,701376,1389504,1389504,2740224,0
    .long 98688,629155200,0,68,98688,629155200,16,3652,98688,629155200,32,7236,98688,629155200,32,7236
    .long 108288,629155200,0,69,108288,629155200,16,3653,108288,629155200,32,7237,108288,629155200,32,7237
    .long 4635456,17,4464,4500,198000,198036,8064,54,123,1,123,4,9600,89088,50,1065370360
    .long 146688,43008,17,877248,216,1048592000,4032,3,24368,4936512,0,0,0,0,0,0
    .long 89088,23616,92160,711744,95232,1399872,143232,2130706432,143232,2130706432,23808,711936,1400064,1400064,4678656,0
    .long 98688,23808,101760,711936,104832,1400064,143232,2130706432,143232,2130706432,23808,711936,1400064,1400064,4678656,0
    .long 108288,24000,111360,712128,114432,1400256,143232,2130706432,143232,2130706432,24000,712128,1400256,1400256,4807680,0
    .long 117888,24192,120960,712320,124032,1400448,143232,2130706432,143232,2130706432,24000,712128,1400256,1400256,4807680,0
    .long 98688,629155200,0,124,98688,629155200,16,3708,98688,629155200,32,7292,98688,629155200,32,7292
    .long 108288,629155200,0,125,108288,629155200,16,3709,108288,629155200,32,7293,108288,629155200,32,7293
    .long 6702912,17,6480,6516,200016,200052,8064,54,179,1,179,4,9600,89088,50,1065370420
    .long 146688,43008,17,1264896,216,1048592000,4032,3,35136,7003968,0,0,0,0,0,0
    .long 89088,34368,92160,722496,95232,1410624,143232,2130706432,143232,2130706432,34560,722688,1410816,1410816,6746112,0
    .long 98688,34560,101760,722688,104832,1410816,143232,2130706432,143232,2130706432,34560,722688,1410816,1410816,6746112,0
    .long 108288,34752,111360,722880,114432,1411008,143232,2130706432,143232,2130706432,34752,722880,1411008,1411008,6875136,0
    .long 117888,34944,120960,723072,124032,1411200,143232,2130706432,143232,2130706432,34752,722880,1411008,1411008,6875136,0
    .long 98688,629155200,0,180,98688,629155200,16,3764,98688,629155200,32,7348,98688,629155200,32,7348
    .long 108288,629155200,0,181,108288,629155200,16,3765,108288,629155200,32,7349,108288,629155200,32,7349
    .long 3449664,17,2130706432,24192,2130706432,2130706432,36,36,1,0,1,5,3456,106368,18,1065369664
    .long 148224,192,17,654912,396,1040203392,2048,3,18192,3750720,0,0,0,0,0,0
    .long 89088,3793728,102912,3965760,116736,172032,143232,2130706432,143232,2130706432,3750912,3836928,3922944,3922944,3492864,0
    .long 92544,3836736,106368,43008,120192,215040,143232,2130706432,143232,2130706432,3750912,3836928,3922944,3922944,3492864,0
    .long 96000,3879744,109824,86016,143232,2130706432,143232,2130706432,143232,2130706432,3793920,3879936,129024,129024,3621888,0
    .long 99456,3922752,113280,129024,143232,2130706432,143232,2130706432,143232,2130706432,3793920,3879936,129024,129024,3621888,0
    .long 85632,226495872,1,19536,92544,226495872,1,19984,99456,226495872,1,20432,99456,226495872,1,20432
    .long 89088,226495872,1,19760,96000,226495872,1,20208,113280,226495872,0,672,113280,226495872,0,672
    .long 7452480,17,177408,185472,2130706432,2130706432,36,36,21,0,20,6,3456,102912,18,1065370032
    .long 148224,192,17,1405440,360,1040203392,3072,3,39040,7753536,0,0,0,0,0,0
    .long 89088,7796544,102912,860160,116736,1032192,143232,2130706432,143232,2130706432,7753728,7839744,946176,946176,7495680,0
    .long 92544,7839552,106368,903168,120192,1075200,143232,2130706432,143232,2130706432,7753728,7839744,946176,946176,7495680,0
    .long 96000,7882560,109824,946176,143232,2130706432,143232,2130706432,143232,2130706432,7796736,7882752,989184,989184,7624704,0
    .long 99456,7925568,113280,989184,143232,2130706432,143232,2130706432,143232,2130706432,7796736,7882752,989184,989184,7624704,0
    .long 85632,226495872,1,40384,92544,226495872,1,40832,109824,226495872,0,4928,109824,226495872,0,4928
    .long 89088,226495872,1,40608,96000,226495872,1,41056,113280,226495872,0,5152,113280,226495872,0,5152
    .long 2813760,17,951552,959616,952416,960480,36,54,117,0,117,4,9600,89088,50,1065370348
    .long 146688,192,17,535680,216,1048592000,4032,3,14880,3114816,0,0,0,0,0,0
    .long 89088,5031936,92160,5035008,95232,5038080,143232,2130706432,143232,2130706432,5074944,5078016,5081088,5081088,2856960,0
    .long 98688,5074944,101760,5078016,104832,5081088,143232,2130706432,143232,2130706432,5074944,5078016,5081088,5081088,2856960,0
    .long 108288,5117952,111360,5121024,114432,5124096,143232,2130706432,143232,2130706432,5117952,5121024,5124096,5124096,2985984,0
    .long 117888,5160960,120960,5164032,124032,5167104,143232,2130706432,143232,2130706432,5117952,5121024,5124096,5124096,2985984,0
    .long 98688,629155200,0,26432,98688,629155200,16,26448,98688,629155200,32,26464,98688,629155200,32,26464
    .long 108288,629155200,0,26656,108288,629155200,16,26672,108288,629155200,32,26688,108288,629155200,32,26688
    .long 4881216,17,1403136,1411200,1404000,1412064,36,54,173,0,173,4,9600,89088,50,1065370414
    .long 146688,192,17,923328,216,1048592000,4032,3,25648,5182272,0,0,0,0,0,0
    .long 89088,7440384,92160,7443456,95232,7446528,143232,2130706432,143232,2130706432,7483392,7486464,7489536,7489536,4924416,0
    .long 98688,7483392,101760,7486464,104832,7489536,143232,2130706432,143232,2130706432,7483392,7486464,7489536,7489536,4924416,0
    .long 108288,7526400,111360,7529472,114432,7532544,143232,2130706432,143232,2130706432,7526400,7529472,7532544,7532544,5053440,0
    .long 117888,7569408,120960,7572480,124032,7575552,143232,2130706432,143232,2130706432,7526400,7529472,7532544,7532544,5053440,0
    .long 98688,629155200,0,38976,98688,629155200,16,38992,98688,629155200,32,39008,98688,629155200,32,39008
    .long 108288,629155200,0,39200,108288,629155200,16,39216,108288,629155200,32,39232,108288,629155200,32,39232
    .long 6948672,17,792,828,194328,194364,8064,54,21,1,20,6,9600,89088,50,1065370032
    .long 146688,43008,17,1310976,216,1048592000,4032,3,36416,7249728,1,0,0,0,0,0
    .long 89088,3840,127488,4608,111360,692352,95232,1380096,133632,1380864,4224,692352,1380480,1380480,6991872,0
    .long 98688,4032,137088,4800,120960,692544,104832,1380288,143232,1381056,4224,692352,1380480,1380480,6991872,0
    .long 108288,4224,92160,691968,130560,692736,114432,1380480,143232,1381056,4416,692544,1380672,1380672,7120896,0
    .long 117888,4416,101760,692160,140160,692928,124032,1380672,143232,1381056,4416,692544,1380672,1380672,7120896,0
    .long 108288,629155200,0,22,108288,629155200,16,3606,108288,629155200,32,7190,108288,629155200,32,7190
    .long 117888,629155200,0,23,117888,629155200,16,3607,117888,629155200,32,7191,117888,629155200,32,7191
    .long 2826048,17,2520,2556,196056,196092,8064,54,69,1,69,4,9600,89088,50,1065370252
    .long 146688,43008,17,537984,216,1048592000,4032,3,14944,3127104,0,0,0,0,0,0
    .long 89088,13248,92160,701376,95232,1389504,143232,2130706432,143232,2130706432,13440,701568,1389696,1389696,2869248,0
    .long 98688,13440,101760,701568,104832,1389696,143232,2130706432,143232,2130706432,13440,701568,1389696,1389696,2869248,0
    .long 108288,13632,111360,701760,114432,1389888,143232,2130706432,143232,2130706432,13632,701760,1389888,1389888,2998272,0
    .long 117888,13824,120960,701952,124032,1390080,143232,2130706432,143232,2130706432,13632,701760,1389888,1389888,2998272,0
    .long 98688,629155200,0,70,98688,629155200,16,3654,98688,629155200,32,7238,98688,629155200,32,7238
    .long 108288,629155200,0,71,108288,629155200,16,3655,108288,629155200,32,7239,108288,629155200,32,7239
    .long 4893504,17,4536,4572,198072,198108,8064,54,125,1,125,4,9600,89088,50,1065370364
    .long 146688,43008,17,925632,216,1048592000,4032,3,25712,5194560,0,0,0,0,0,0
    .long 89088,24000,92160,712128,95232,1400256,143232,2130706432,143232,2130706432,24192,712320,1400448,1400448,4936704,0
    .long 98688,24192,101760,712320,104832,1400448,143232,2130706432,143232,2130706432,24192,712320,1400448,1400448,4936704,0
    .long 108288,24384,111360,712512,114432,1400640,143232,2130706432,143232,2130706432,24384,712512,1400640,1400640,5065728,0
    .long 117888,24576,120960,712704,124032,1400832,143232,2130706432,143232,2130706432,24384,712512,1400640,1400640,5065728,0
    .long 98688,629155200,0,126,98688,629155200,16,3710,98688,629155200,32,7294,98688,629155200,32,7294
    .long 108288,629155200,0,127,108288,629155200,16,3711,108288,629155200,32,7295,108288,629155200,32,7295
    .long 6960960,17,6552,6588,200088,200124,8064,54,181,1,181,4,9600,89088,50,1065370422
    .long 146688,43008,17,1313280,216,1048592000,4032,3,36480,7262016,0,0,0,0,0,0
    .long 89088,34752,92160,722880,95232,1411008,143232,2130706432,143232,2130706432,34944,723072,1411200,1411200,7004160,0
    .long 98688,34944,101760,723072,104832,1411200,143232,2130706432,143232,2130706432,34944,723072,1411200,1411200,7004160,0
    .long 108288,35136,111360,723264,114432,1411392,143232,2130706432,143232,2130706432,35136,723264,1411392,1411392,7133184,0
    .long 117888,35328,120960,723456,124032,1411584,143232,2130706432,143232,2130706432,35136,723264,1411392,1411392,7133184,0
    .long 98688,629155200,0,182,98688,629155200,16,3766,98688,629155200,32,7350,98688,629155200,32,7350
    .long 108288,629155200,0,183,108288,629155200,16,3767,108288,629155200,32,7351,108288,629155200,32,7351
    .long 3922752,17,2130706432,32256,2130706432,2130706432,36,36,2,0,2,5,3456,106368,18,1065369728
    .long 148224,192,17,743616,396,1040203392,2048,3,20656,4223808,0,0,0,0,0,0
    .long 89088,4266816,102912,4438848,116736,215040,143232,2130706432,143232,2130706432,4224000,4310016,4396032,4396032,3965952,0
    .long 92544,4309824,106368,86016,120192,258048,143232,2130706432,143232,2130706432,4224000,4310016,4396032,4396032,3965952,0
    .long 96000,4352832,109824,129024,143232,2130706432,143232,2130706432,143232,2130706432,4267008,4353024,172032,172032,4094976,0
    .long 99456,4395840,113280,172032,143232,2130706432,143232,2130706432,143232,2130706432,4267008,4353024,172032,172032,4094976,0
    .long 85632,226495872,1,22000,92544,226495872,1,22448,99456,226495872,1,22896,99456,226495872,1,22896
    .long 89088,226495872,1,22224,96000,226495872,1,22672,113280,226495872,0,896,113280,226495872,0,896
    .long 7882560,17,193536,201600,2130706432,2130706432,36,36,23,0,22,6,3456,102912,18,1065370048
    .long 148224,192,17,1486080,360,1040203392,3072,3,41280,8183616,0,0,0,0,0,0
    .long 89088,8226624,102912,946176,116736,1118208,143232,2130706432,143232,2130706432,8183808,8269824,1032192,1032192,7925760,0
    .long 92544,8269632,106368,989184,120192,1161216,143232,2130706432,143232,2130706432,8183808,8269824,1032192,1032192,7925760,0
    .long 96000,8312640,109824,1032192,143232,2130706432,143232,2130706432,143232,2130706432,8226816,8312832,1075200,1075200,8054784,0
    .long 99456,8355648,113280,1075200,143232,2130706432,143232,2130706432,143232,2130706432,8226816,8312832,1075200,1075200,8054784,0
    .long 85632,226495872,1,42624,92544,226495872,1,43072,109824,226495872,0,5376,109824,226495872,0,5376
    .long 89088,226495872,1,42848,96000,226495872,1,43296,113280,226495872,0,5600,113280,226495872,0,5600
    .long 3071808,17,967680,975744,968544,976608,36,54,119,0,119,4,9600,89088,50,1065370352
    .long 146688,192,17,584064,216,1048592000,4032,3,16224,3372864,0,0,0,0,0,0
    .long 89088,5117952,92160,5121024,95232,5124096,143232,2130706432,143232,2130706432,5160960,5164032,5167104,5167104,3115008,0
    .long 98688,5160960,101760,5164032,104832,5167104,143232,2130706432,143232,2130706432,5160960,5164032,5167104,5167104,3115008,0
    .long 108288,5203968,111360,5207040,114432,5210112,143232,2130706432,143232,2130706432,5203968,5207040,5210112,5210112,3244032,0
    .long 117888,5246976,120960,5250048,124032,5253120,143232,2130706432,143232,2130706432,5203968,5207040,5210112,5210112,3244032,0
    .long 98688,629155200,0,26880,98688,629155200,16,26896,98688,629155200,32,26912,98688,629155200,32,26912
    .long 108288,629155200,0,27104,108288,629155200,16,27120,108288,629155200,32,27136,108288,629155200,32,27136
    .long 5139264,17,1419264,1427328,1420128,1428192,36,54,175,0,175,4,9600,89088,50,1065370416
    .long 146688,192,17,971712,216,1048592000,4032,3,26992,5440320,0,0,0,0,0,0
    .long 89088,7526400,92160,7529472,95232,7532544,143232,2130706432,143232,2130706432,7569408,7572480,7575552,7575552,5182464,0
    .long 98688,7569408,101760,7572480,104832,7575552,143232,2130706432,143232,2130706432,7569408,7572480,7575552,7575552,5182464,0
    .long 108288,7612416,111360,7615488,114432,7618560,143232,2130706432,143232,2130706432,7612416,7615488,7618560,7618560,5311488,0
    .long 117888,7655424,120960,7658496,124032,7661568,143232,2130706432,143232,2130706432,7612416,7615488,7618560,7618560,5311488,0
    .long 98688,629155200,0,39424,98688,629155200,16,39440,98688,629155200,32,39456,98688,629155200,32,39456
    .long 108288,629155200,0,39648,108288,629155200,16,39664,108288,629155200,32,39680,108288,629155200,32,39680
    .long 7206720,17,2130706432,2130706432,2130706432,2130706432,36,0,0,0,0,0,0,116736,0,0
    .long 0,192,17,1359360,504,1048592000,0,4,37760,7507776,0,0,0,0,0,0
    .long 89088,7550784,102912,7722816,143232,2130706432,143232,2130706432,143232,2130706432,7507968,7593984,7680000,7766016,7249920,0
    .long 92544,7593792,106368,7765824,143232,2130706432,143232,2130706432,143232,2130706432,7507968,7593984,7680000,7766016,7249920,0
    .long 96000,7636800,109824,7808832,143232,2130706432,143232,2130706432,143232,2130706432,7550976,7636992,7723008,7809024,7378944,0
    .long 99456,7679808,113280,7851840,143232,2130706432,143232,2130706432,143232,2130706432,7550976,7636992,7723008,7809024,7378944,0
    .long 85632,226495872,1,39104,92544,226495872,1,39552,99456,226495872,1,40000,106368,226495872,1,40448
    .long 89088,226495872,1,39328,96000,226495872,1,39776,102912,226495872,1,40224,109824,226495872,1,40672
    .long 3084096,17,2592,2628,196128,196164,8064,54,71,1,71,4,9600,89088,50,1065370256
    .long 146688,43008,17,586368,216,1048592000,4032,3,16288,3385152,0,0,0,0,0,0
    .long 89088,13632,92160,701760,95232,1389888,143232,2130706432,143232,2130706432,13824,701952,1390080,1390080,3127296,0
    .long 98688,13824,101760,701952,104832,1390080,143232,2130706432,143232,2130706432,13824,701952,1390080,1390080,3127296,0
    .long 108288,14016,111360,702144,114432,1390272,143232,2130706432,143232,2130706432,14016,702144,1390272,1390272,3256320,0
    .long 117888,14208,120960,702336,124032,1390464,143232,2130706432,143232,2130706432,14016,702144,1390272,1390272,3256320,0
    .long 98688,629155200,0,72,98688,629155200,16,3656,98688,629155200,32,7240,98688,629155200,32,7240
    .long 108288,629155200,0,73,108288,629155200,16,3657,108288,629155200,32,7241,108288,629155200,32,7241
    .long 5151552,17,4608,4644,198144,198180,8064,54,127,1,127,4,9600,89088,50,1065370368
    .long 146688,43008,17,974016,216,1048592000,4032,3,27056,5452608,0,0,0,0,0,0
    .long 89088,24384,92160,712512,95232,1400640,143232,2130706432,143232,2130706432,24576,712704,1400832,1400832,5194752,0
    .long 98688,24576,101760,712704,104832,1400832,143232,2130706432,143232,2130706432,24576,712704,1400832,1400832,5194752,0
    .long 108288,24768,111360,712896,114432,1401024,143232,2130706432,143232,2130706432,24768,712896,1401024,1401024,5323776,0
    .long 117888,24960,120960,713088,124032,1401216,143232,2130706432,143232,2130706432,24768,712896,1401024,1401024,5323776,0
    .long 98688,629155200,0,128,98688,629155200,16,3712,98688,629155200,32,7296,98688,629155200,32,7296
    .long 108288,629155200,0,129,108288,629155200,16,3713,108288,629155200,32,7297,108288,629155200,32,7297
    .long 7219008,17,2130706432,2130706432,2130706432,2130706432,36,0,0,0,0,0,0,116736,0,0
    .long 0,192,17,1361664,504,1048592000,0,4,37824,7520064,0,0,0,0,0,0
    .long 89088,7563072,102912,7735104,143232,2130706432,143232,2130706432,143232,2130706432,7520256,7606272,7692288,7778304,7262208,0
    .long 92544,7606080,106368,7778112,143232,2130706432,143232,2130706432,143232,2130706432,7520256,7606272,7692288,7778304,7262208,0
    .long 96000,7649088,109824,7821120,143232,2130706432,143232,2130706432,143232,2130706432,7563264,7649280,7735296,7821312,7391232,0
    .long 99456,7692096,113280,7864128,143232,2130706432,143232,2130706432,143232,2130706432,7563264,7649280,7735296,7821312,7391232,0
    .long 85632,226495872,1,39168,92544,226495872,1,39616,99456,226495872,1,40064,106368,226495872,1,40512
    .long 89088,226495872,1,39392,96000,226495872,1,39840,102912,226495872,1,40288,109824,226495872,1,40736
    .long 4395840,17,2130706432,40320,2130706432,2130706432,36,36,3,0,3,5,3456,106368,18,1065369760
    .long 148224,192,17,832320,396,1040203392,2048,3,23120,4696896,0,0,0,0,0,0
    .long 89088,4739904,102912,4911936,116736,258048,143232,2130706432,143232,2130706432,4697088,4783104,4869120,4869120,4439040,0
    .long 92544,4782912,106368,129024,120192,301056,143232,2130706432,143232,2130706432,4697088,4783104,4869120,4869120,4439040,0
    .long 96000,4825920,109824,172032,143232,2130706432,143232,2130706432,143232,2130706432,4740096,4826112,215040,215040,4568064,0
    .long 99456,4868928,113280,215040,143232,2130706432,143232,2130706432,143232,2130706432,4740096,4826112,215040,215040,4568064,0
    .long 85632,226495872,1,24464,92544,226495872,1,24912,99456,226495872,1,25360,99456,226495872,1,25360
    .long 89088,226495872,1,24688,96000,226495872,1,25136,113280,226495872,0,1120,113280,226495872,0,1120
    .long 8312640,17,209664,217728,2130706432,2130706432,36,36,25,0,24,6,3456,102912,18,1065370064
    .long 148224,192,17,1566720,360,1040203392,3072,3,43520,8613696,0,0,0,0,0,0
    .long 89088,8656704,102912,1032192,116736,1204224,143232,2130706432,143232,2130706432,8613888,8699904,1118208,1118208,8355840,0
    .long 92544,8699712,106368,1075200,120192,1247232,143232,2130706432,143232,2130706432,8613888,8699904,1118208,1118208,8355840,0
    .long 96000,8742720,109824,1118208,143232,2130706432,143232,2130706432,143232,2130706432,8656896,8742912,1161216,1161216,8484864,0
    .long 99456,8785728,113280,1161216,143232,2130706432,143232,2130706432,143232,2130706432,8656896,8742912,1161216,1161216,8484864,0
    .long 85632,226495872,1,44864,92544,226495872,1,45312,109824,226495872,0,5824,109824,226495872,0,5824
    .long 89088,226495872,1,45088,96000,226495872,1,45536,113280,226495872,0,6048,113280,226495872,0,6048
    .long 3329856,17,983808,991872,984672,992736,36,54,121,0,121,4,9600,89088,50,1065370356
    .long 146688,192,17,632448,216,1048592000,4032,3,17568,3630912,0,0,0,0,0,0
    .long 89088,5203968,92160,5207040,95232,5210112,143232,2130706432,143232,2130706432,5246976,5250048,5253120,5253120,3373056,0
    .long 98688,5246976,101760,5250048,104832,5253120,143232,2130706432,143232,2130706432,5246976,5250048,5253120,5253120,3373056,0
    .long 108288,5289984,111360,5293056,114432,5296128,143232,2130706432,143232,2130706432,5289984,5293056,5296128,5296128,3502080,0
    .long 117888,5332992,120960,5336064,124032,5339136,143232,2130706432,143232,2130706432,5289984,5293056,5296128,5296128,3502080,0
    .long 98688,629155200,0,27328,98688,629155200,16,27344,98688,629155200,32,27360,98688,629155200,32,27360
    .long 108288,629155200,0,27552,108288,629155200,16,27568,108288,629155200,32,27584,108288,629155200,32,27584
    .long 5397312,17,1435392,1443456,1436256,1444320,36,54,177,0,177,4,9600,89088,50,1065370418
    .long 146688,192,17,1020096,216,1048592000,4032,3,28336,5698368,0,0,0,0,0,0
    .long 89088,7612416,92160,7615488,95232,7618560,143232,2130706432,143232,2130706432,7655424,7658496,7661568,7661568,5440512,0
    .long 98688,7655424,101760,7658496,104832,7661568,143232,2130706432,143232,2130706432,7655424,7658496,7661568,7661568,5440512,0
    .long 108288,7698432,111360,7701504,114432,7704576,143232,2130706432,143232,2130706432,7698432,7701504,7704576,7704576,5569536,0
    .long 117888,7741440,120960,7744512,124032,7747584,143232,2130706432,143232,2130706432,7698432,7701504,7704576,7704576,5569536,0
    .long 98688,629155200,0,39872,98688,629155200,16,39888,98688,629155200,32,39904,98688,629155200,32,39904
    .long 108288,629155200,0,40096,108288,629155200,16,40112,108288,629155200,32,40128,108288,629155200,32,40128
    .long 7808832,17,2130706432,2130706432,2130706432,2130706432,36,0,0,0,0,0,0,116736,0,0
    .long 0,192,17,1472256,504,1048592000,0,4,40896,8109888,0,0,0,0,0,0
    .long 89088,8152896,102912,8324928,143232,2130706432,143232,2130706432,143232,2130706432,8110080,8196096,8282112,8368128,7852032,0
    .long 92544,8195904,106368,8367936,143232,2130706432,143232,2130706432,143232,2130706432,8110080,8196096,8282112,8368128,7852032,0
    .long 96000,8238912,109824,8410944,143232,2130706432,143232,2130706432,143232,2130706432,8153088,8239104,8325120,8411136,7981056,0
    .long 99456,8281920,113280,8453952,143232,2130706432,143232,2130706432,143232,2130706432,8153088,8239104,8325120,8411136,7981056,0
    .long 85632,226495872,1,42240,92544,226495872,1,42688,99456,226495872,1,43136,106368,226495872,1,43584
    .long 89088,226495872,1,42464,96000,226495872,1,42912,102912,226495872,1,43360,109824,226495872,1,43808
    .long 3342144,17,2664,2700,196200,196236,8064,54,73,1,73,4,9600,89088,50,1065370260
    .long 146688,43008,17,634752,216,1048592000,4032,3,17632,3643200,0,0,0,0,0,0
    .long 89088,14016,92160,702144,95232,1390272,143232,2130706432,143232,2130706432,14208,702336,1390464,1390464,3385344,0
    .long 98688,14208,101760,702336,104832,1390464,143232,2130706432,143232,2130706432,14208,702336,1390464,1390464,3385344,0
    .long 108288,14400,111360,702528,114432,1390656,143232,2130706432,143232,2130706432,14400,702528,1390656,1390656,3514368,0
    .long 117888,14592,120960,702720,124032,1390848,143232,2130706432,143232,2130706432,14400,702528,1390656,1390656,3514368,0
    .long 98688,629155200,0,74,98688,629155200,16,3658,98688,629155200,32,7242,98688,629155200,32,7242
    .long 108288,629155200,0,75,108288,629155200,16,3659,108288,629155200,32,7243,108288,629155200,32,7243
    .long 5409600,17,4680,4716,198216,198252,8064,54,129,1,129,4,9600,89088,50,1065370370
    .long 146688,43008,17,1022400,216,1048592000,4032,3,28400,5710656,0,0,0,0,0,0
    .long 89088,24768,92160,712896,95232,1401024,143232,2130706432,143232,2130706432,24960,713088,1401216,1401216,5452800,0
    .long 98688,24960,101760,713088,104832,1401216,143232,2130706432,143232,2130706432,24960,713088,1401216,1401216,5452800,0
    .long 108288,25152,111360,713280,114432,1401408,143232,2130706432,143232,2130706432,25152,713280,1401408,1401408,5581824,0
    .long 117888,25344,120960,713472,124032,1401600,143232,2130706432,143232,2130706432,25152,713280,1401408,1401408,5581824,0
    .long 98688,629155200,0,130,98688,629155200,16,3714,98688,629155200,32,7298,98688,629155200,32,7298
    .long 108288,629155200,0,131,108288,629155200,16,3715,108288,629155200,32,7299,108288,629155200,32,7299
    .long 7821120,17,2130706432,2130706432,2130706432,2130706432,36,0,0,0,0,0,0,116736,0,0
    .long 0,192,17,1474560,504,1048592000,0,4,40960,8122176,0,0,0,0,0,0
    .long 89088,8165184,102912,8337216,143232,2130706432,143232,2130706432,143232,2130706432,8122368,8208384,8294400,8380416,7864320,0
    .long 92544,8208192,106368,8380224,143232,2130706432,143232,2130706432,143232,2130706432,8122368,8208384,8294400,8380416,7864320,0
    .long 96000,8251200,109824,8423232,143232,2130706432,143232,2130706432,143232,2130706432,8165376,8251392,8337408,8423424,7993344,0
    .long 99456,8294208,113280,8466240,143232,2130706432,143232,2130706432,143232,2130706432,8165376,8251392,8337408,8423424,7993344,0
    .long 85632,226495872,1,42304,92544,226495872,1,42752,99456,226495872,1,43200,106368,226495872,1,43648
    .long 89088,226495872,1,42528,96000,226495872,1,42976,102912,226495872,1,43424,109824,226495872,1,43872
    .long 4868928,17,2130706432,48384,2130706432,2130706432,36,36,4,0,4,5,3456,106368,18,1065369792
    .long 148224,192,17,921024,396,1040203392,2048,3,25584,5169984,0,0,0,0,0,0
    .long 89088,5212992,102912,5385024,116736,301056,143232,2130706432,143232,2130706432,5170176,5256192,5342208,5342208,4912128,0
    .long 92544,5256000,106368,172032,120192,344064,143232,2130706432,143232,2130706432,5170176,5256192,5342208,5342208,4912128,0
    .long 96000,5299008,109824,215040,143232,2130706432,143232,2130706432,143232,2130706432,5213184,5299200,258048,258048,5041152,0
    .long 99456,5342016,113280,258048,143232,2130706432,143232,2130706432,143232,2130706432,5213184,5299200,258048,258048,5041152,0
    .long 85632,226495872,1,26928,92544,226495872,1,27376,99456,226495872,1,27824,99456,226495872,1,27824
    .long 89088,226495872,1,27152,96000,226495872,1,27600,113280,226495872,0,1344,113280,226495872,0,1344
    .long 8742720,17,225792,233856,2130706432,2130706432,36,36,27,0,26,6,3456,102912,18,1065370080
    .long 148224,192,17,1647360,360,1040203392,3072,3,45760,9043776,0,0,0,0,0,0
    .long 89088,9086784,102912,1118208,116736,1290240,143232,2130706432,143232,2130706432,9043968,9129984,1204224,1204224,8785920,0
    .long 92544,9129792,106368,1161216,120192,1333248,143232,2130706432,143232,2130706432,9043968,9129984,1204224,1204224,8785920,0
    .long 96000,9172800,109824,1204224,143232,2130706432,143232,2130706432,143232,2130706432,9086976,9172992,1247232,1247232,8914944,0
    .long 99456,9215808,113280,1247232,143232,2130706432,143232,2130706432,143232,2130706432,9086976,9172992,1247232,1247232,8914944,0
    .long 85632,226495872,1,47104,92544,226495872,1,47552,109824,226495872,0,6272,109824,226495872,0,6272
    .long 89088,226495872,1,47328,96000,226495872,1,47776,113280,226495872,0,6496,113280,226495872,0,6496
    .long 3587904,17,999936,1008000,1000800,1008864,36,54,123,0,123,4,9600,89088,50,1065370360
    .long 146688,192,17,680832,216,1048592000,4032,3,18912,3888960,0,0,0,0,0,0
    .long 89088,5289984,92160,5293056,95232,5296128,143232,2130706432,143232,2130706432,5332992,5336064,5339136,5339136,3631104,0
    .long 98688,5332992,101760,5336064,104832,5339136,143232,2130706432,143232,2130706432,5332992,5336064,5339136,5339136,3631104,0
    .long 108288,5376000,111360,5379072,114432,5382144,143232,2130706432,143232,2130706432,5376000,5379072,5382144,5382144,3760128,0
    .long 117888,5419008,120960,5422080,124032,5425152,143232,2130706432,143232,2130706432,5376000,5379072,5382144,5382144,3760128,0
    .long 98688,629155200,0,27776,98688,629155200,16,27792,98688,629155200,32,27808,98688,629155200,32,27808
    .long 108288,629155200,0,28000,108288,629155200,16,28016,108288,629155200,32,28032,108288,629155200,32,28032
    .long 5655360,17,1451520,1459584,1452384,1460448,36,54,179,0,179,4,9600,89088,50,1065370420
    .long 146688,192,17,1068480,216,1048592000,4032,3,29680,5956416,0,0,0,0,0,0
    .long 89088,7698432,92160,7701504,95232,7704576,143232,2130706432,143232,2130706432,7741440,7744512,7747584,7747584,5698560,0
    .long 98688,7741440,101760,7744512,104832,7747584,143232,2130706432,143232,2130706432,7741440,7744512,7747584,7747584,5698560,0
    .long 108288,7784448,111360,7787520,114432,7790592,143232,2130706432,143232,2130706432,7784448,7787520,7790592,7790592,5827584,0
    .long 117888,7827456,120960,7830528,124032,7833600,143232,2130706432,143232,2130706432,7784448,7787520,7790592,7790592,5827584,0
    .long 98688,629155200,0,40320,98688,629155200,16,40336,98688,629155200,32,40352,98688,629155200,32,40352
    .long 108288,629155200,0,40544,108288,629155200,16,40560,108288,629155200,32,40576,108288,629155200,32,40576
    .long 8410944,17,2130706432,2130706432,2130706432,2130706432,36,0,0,0,0,0,0,116736,0,0
    .long 0,192,17,1585152,504,1048592000,0,4,44032,8712000,0,0,0,0,0,0
    .long 89088,8755008,102912,8927040,143232,2130706432,143232,2130706432,143232,2130706432,8712192,8798208,8884224,8970240,8454144,0
    .long 92544,8798016,106368,8970048,143232,2130706432,143232,2130706432,143232,2130706432,8712192,8798208,8884224,8970240,8454144,0
    .long 96000,8841024,109824,9013056,143232,2130706432,143232,2130706432,143232,2130706432,8755200,8841216,8927232,9013248,8583168,0
    .long 99456,8884032,113280,9056064,143232,2130706432,143232,2130706432,143232,2130706432,8755200,8841216,8927232,9013248,8583168,0
    .long 85632,226495872,1,45376,92544,226495872,1,45824,99456,226495872,1,46272,106368,226495872,1,46720
    .long 89088,226495872,1,45600,96000,226495872,1,46048,102912,226495872,1,46496,109824,226495872,1,46944
    .long 3600192,17,2736,2772,196272,196308,8064,54,75,1,75,4,9600,89088,50,1065370264
    .long 146688,43008,17,683136,216,1048592000,4032,3,18976,3901248,0,0,0,0,0,0
    .long 89088,14400,92160,702528,95232,1390656,143232,2130706432,143232,2130706432,14592,702720,1390848,1390848,3643392,0
    .long 98688,14592,101760,702720,104832,1390848,143232,2130706432,143232,2130706432,14592,702720,1390848,1390848,3643392,0
    .long 108288,14784,111360,702912,114432,1391040,143232,2130706432,143232,2130706432,14784,702912,1391040,1391040,3772416,0
    .long 117888,14976,120960,703104,124032,1391232,143232,2130706432,143232,2130706432,14784,702912,1391040,1391040,3772416,0
    .long 98688,629155200,0,76,98688,629155200,16,3660,98688,629155200,32,7244,98688,629155200,32,7244
    .long 108288,629155200,0,77,108288,629155200,16,3661,108288,629155200,32,7245,108288,629155200,32,7245
    .long 5667648,17,4752,4788,198288,198324,8064,54,131,1,131,4,9600,89088,50,1065370372
    .long 146688,43008,17,1070784,216,1048592000,4032,3,29744,5968704,0,0,0,0,0,0
    .long 89088,25152,92160,713280,95232,1401408,143232,2130706432,143232,2130706432,25344,713472,1401600,1401600,5710848,0
    .long 98688,25344,101760,713472,104832,1401600,143232,2130706432,143232,2130706432,25344,713472,1401600,1401600,5710848,0
    .long 108288,25536,111360,713664,114432,1401792,143232,2130706432,143232,2130706432,25536,713664,1401792,1401792,5839872,0
    .long 117888,25728,120960,713856,124032,1401984,143232,2130706432,143232,2130706432,25536,713664,1401792,1401792,5839872,0
    .long 98688,629155200,0,132,98688,629155200,16,3716,98688,629155200,32,7300,98688,629155200,32,7300
    .long 108288,629155200,0,133,108288,629155200,16,3717,108288,629155200,32,7301,108288,629155200,32,7301
    .long 8423232,17,2130706432,2130706432,2130706432,2130706432,36,0,0,0,0,0,0,116736,0,0
    .long 0,192,17,1587456,504,1048592000,0,4,44096,8724288,0,0,0,0,0,0
    .long 89088,8767296,102912,8939328,143232,2130706432,143232,2130706432,143232,2130706432,8724480,8810496,8896512,8982528,8466432,0
    .long 92544,8810304,106368,8982336,143232,2130706432,143232,2130706432,143232,2130706432,8724480,8810496,8896512,8982528,8466432,0
    .long 96000,8853312,109824,9025344,143232,2130706432,143232,2130706432,143232,2130706432,8767488,8853504,8939520,9025536,8595456,0
    .long 99456,8896320,113280,9068352,143232,2130706432,143232,2130706432,143232,2130706432,8767488,8853504,8939520,9025536,8595456,0
    .long 85632,226495872,1,45440,92544,226495872,1,45888,99456,226495872,1,46336,106368,226495872,1,46784
    .long 89088,226495872,1,45664,96000,226495872,1,46112,102912,226495872,1,46560,109824,226495872,1,47008
    .long 5342016,17,2130706432,56448,2130706432,2130706432,36,36,5,0,5,5,3456,106368,18,1065369824
    .long 148224,192,17,1009728,396,1040203392,2048,3,28048,5643072,0,0,0,0,0,0
    .long 89088,5686080,102912,5858112,116736,344064,143232,2130706432,143232,2130706432,5643264,5729280,5815296,5815296,5385216,0
    .long 92544,5729088,106368,215040,120192,387072,143232,2130706432,143232,2130706432,5643264,5729280,5815296,5815296,5385216,0
    .long 96000,5772096,109824,258048,143232,2130706432,143232,2130706432,143232,2130706432,5686272,5772288,301056,301056,5514240,0
    .long 99456,5815104,113280,301056,143232,2130706432,143232,2130706432,143232,2130706432,5686272,5772288,301056,301056,5514240,0
    .long 85632,226495872,1,29392,92544,226495872,1,29840,99456,226495872,1,30288,99456,226495872,1,30288
    .long 89088,226495872,1,29616,96000,226495872,1,30064,113280,226495872,0,1568,113280,226495872,0,1568
    .long 9172800,17,241920,249984,2130706432,2130706432,36,36,29,0,28,6,3456,102912,18,1065370096
    .long 148224,192,17,1728000,360,1040203392,3072,3,48000,9473856,0,0,0,0,0,0
    .long 89088,9516864,102912,1204224,116736,1376256,143232,2130706432,143232,2130706432,9474048,9560064,1290240,1290240,9216000,0
    .long 92544,9559872,106368,1247232,120192,1419264,143232,2130706432,143232,2130706432,9474048,9560064,1290240,1290240,9216000,0
    .long 96000,9602880,109824,1290240,143232,2130706432,143232,2130706432,143232,2130706432,9517056,9603072,1333248,1333248,9345024,0
    .long 99456,9602880,113280,1333248,143232,2130706432,143232,2130706432,143232,2130706432,9517056,9603072,1333248,1333248,9345024,0
    .long 85632,226495872,1,49344,92544,226495872,1,49792,109824,226495872,0,6720,109824,226495872,0,6720
    .long 89088,226495872,1,49568,96000,226495872,1,50016,113280,226495872,0,6944,113280,226495872,0,6944
    .long 3845952,17,1016064,1024128,1016928,1024992,36,54,125,0,125,4,9600,89088,50,1065370364
    .long 146688,192,17,729216,216,1048592000,4032,3,20256,4147008,0,0,0,0,0,0
    .long 89088,5376000,92160,5379072,95232,5382144,143232,2130706432,143232,2130706432,5419008,5422080,5425152,5425152,3889152,0
    .long 98688,5419008,101760,5422080,104832,5425152,143232,2130706432,143232,2130706432,5419008,5422080,5425152,5425152,3889152,0
    .long 108288,5462016,111360,5465088,114432,5468160,143232,2130706432,143232,2130706432,5462016,5465088,5468160,5468160,4018176,0
    .long 117888,5505024,120960,5508096,124032,5511168,143232,2130706432,143232,2130706432,5462016,5465088,5468160,5468160,4018176,0
    .long 98688,629155200,0,28224,98688,629155200,16,28240,98688,629155200,32,28256,98688,629155200,32,28256
    .long 108288,629155200,0,28448,108288,629155200,16,28464,108288,629155200,32,28480,108288,629155200,32,28480
    .long 5913408,17,1467648,1475712,1468512,1476576,36,54,181,0,181,4,9600,89088,50,1065370422
    .long 146688,192,17,1116864,216,1048592000,4032,3,31024,6214464,0,0,0,0,0,0
    .long 89088,7784448,92160,7787520,95232,7790592,143232,2130706432,143232,2130706432,7827456,7830528,7833600,7833600,5956608,0
    .long 98688,7827456,101760,7830528,104832,7833600,143232,2130706432,143232,2130706432,7827456,7830528,7833600,7833600,5956608,0
    .long 108288,7870464,111360,7873536,114432,7876608,143232,2130706432,143232,2130706432,7870464,7873536,7876608,7876608,6085632,0
    .long 117888,7913472,120960,7916544,124032,7919616,143232,2130706432,143232,2130706432,7870464,7873536,7876608,7876608,6085632,0
    .long 98688,629155200,0,40768,98688,629155200,16,40784,98688,629155200,32,40800,98688,629155200,32,40800
    .long 108288,629155200,0,40992,108288,629155200,16,41008,108288,629155200,32,41024,108288,629155200,32,41024
    .long 9013056,17,2130706432,2130706432,2130706432,2130706432,36,0,0,0,0,0,0,116736,0,0
    .long 0,192,17,1698048,504,1048592000,0,4,47168,9314112,0,0,0,0,0,0
    .long 89088,9357120,102912,9529152,143232,2130706432,143232,2130706432,143232,2130706432,9314304,9400320,9486336,9572352,9056256,0
    .long 92544,9400128,106368,9572160,143232,2130706432,143232,2130706432,143232,2130706432,9314304,9400320,9486336,9572352,9056256,0
    .long 96000,9443136,109824,9615168,143232,2130706432,143232,2130706432,143232,2130706432,9357312,9443328,9529344,9615360,9185280,0
    .long 99456,9486144,113280,9615168,143232,2130706432,143232,2130706432,143232,2130706432,9357312,9443328,9529344,9615360,9185280,0
    .long 85632,226495872,1,48512,92544,226495872,1,48960,99456,226495872,1,49408,106368,226495872,1,49856
    .long 89088,226495872,1,48736,96000,226495872,1,49184,102912,226495872,1,49632,109824,226495872,1,50080
    .long 3858240,17,2808,2844,196344,196380,8064,54,77,1,77,4,9600,89088,50,1065370268
    .long 146688,43008,17,731520,216,1048592000,4032,3,20320,4159296,0,0,0,0,0,0
    .long 89088,14784,92160,702912,95232,1391040,143232,2130706432,143232,2130706432,14976,703104,1391232,1391232,3901440,0
    .long 98688,14976,101760,703104,104832,1391232,143232,2130706432,143232,2130706432,14976,703104,1391232,1391232,3901440,0
    .long 108288,15168,111360,703296,114432,1391424,143232,2130706432,143232,2130706432,15168,703296,1391424,1391424,4030464,0
    .long 117888,15360,120960,703488,124032,1391616,143232,2130706432,143232,2130706432,15168,703296,1391424,1391424,4030464,0
    .long 98688,629155200,0,78,98688,629155200,16,3662,98688,629155200,32,7246,98688,629155200,32,7246
    .long 108288,629155200,0,79,108288,629155200,16,3663,108288,629155200,32,7247,108288,629155200,32,7247
    .long 5925696,17,4824,4860,198360,198396,8064,54,133,1,133,4,9600,89088,50,1065370374
    .long 146688,43008,17,1119168,216,1048592000,4032,3,31088,6226752,0,0,0,0,0,0
    .long 89088,25536,92160,713664,95232,1401792,143232,2130706432,143232,2130706432,25728,713856,1401984,1401984,5968896,0
    .long 98688,25728,101760,713856,104832,1401984,143232,2130706432,143232,2130706432,25728,713856,1401984,1401984,5968896,0
    .long 108288,25920,111360,714048,114432,1402176,143232,2130706432,143232,2130706432,25920,714048,1402176,1402176,6097920,0
    .long 117888,26112,120960,714240,124032,1402368,143232,2130706432,143232,2130706432,25920,714048,1402176,1402176,6097920,0
    .long 98688,629155200,0,134,98688,629155200,16,3718,98688,629155200,32,7302,98688,629155200,32,7302
    .long 108288,629155200,0,135,108288,629155200,16,3719,108288,629155200,32,7303,108288,629155200,32,7303
    .long 9025344,17,2130706432,2130706432,2130706432,2130706432,36,0,0,0,0,0,0,116736,0,0
    .long 0,192,17,1700352,504,1048592000,0,4,47232,9326400,0,0,0,0,0,0
    .long 89088,9369408,102912,9541440,143232,2130706432,143232,2130706432,143232,2130706432,9326592,9412608,9498624,9584640,9068544,0
    .long 92544,9412416,106368,9584448,143232,2130706432,143232,2130706432,143232,2130706432,9326592,9412608,9498624,9584640,9068544,0
    .long 96000,9455424,109824,9627456,143232,2130706432,143232,2130706432,143232,2130706432,9369600,9455616,9541632,9627648,9197568,0
    .long 99456,9498432,113280,9627456,143232,2130706432,143232,2130706432,143232,2130706432,9369600,9455616,9541632,9627648,9197568,0
    .long 85632,226495872,1,48576,92544,226495872,1,49024,99456,226495872,1,49472,106368,226495872,1,49920
    .long 89088,226495872,1,48800,96000,226495872,1,49248,102912,226495872,1,49696,109824,226495872,1,50144
    .long 5815104,17,2130706432,64512,2130706432,2130706432,36,36,6,0,6,5,3456,106368,18,1065369856
    .long 148224,192,17,1098432,396,1040203392,2048,3,30512,6116160,0,0,0,0,0,0
    .long 89088,6159168,102912,6331200,116736,387072,143232,2130706432,143232,2130706432,6116352,6202368,6288384,6288384,5858304,0
    .long 92544,6202176,106368,258048,120192,430080,143232,2130706432,143232,2130706432,6116352,6202368,6288384,6288384,5858304,0
    .long 96000,6245184,109824,301056,143232,2130706432,143232,2130706432,143232,2130706432,6159360,6245376,344064,344064,5987328,0
    .long 99456,6288192,113280,344064,143232,2130706432,143232,2130706432,143232,2130706432,6159360,6245376,344064,344064,5987328,0
    .long 85632,226495872,1,31856,92544,226495872,1,32304,99456,226495872,1,32752,99456,226495872,1,32752
    .long 89088,226495872,1,32080,96000,226495872,1,32528,113280,226495872,0,1792,113280,226495872,0,1792
    .long 2036544,17,645120,653184,645984,654048,36,54,79,0,79,4,9600,89088,50,1065370272
    .long 146688,192,17,389952,216,1048591872,4032,3,10832,2337600,0,0,0,0,0,0
    .long 89088,3397632,92160,3400704,95232,3403776,143232,2130706432,143232,2130706432,3440640,3443712,3446784,3446784,2079744,0
    .long 98688,3440640,101760,3443712,104832,3446784,143232,2130706432,143232,2130706432,3440640,3443712,3446784,3446784,2079744,0
    .long 108288,3483648,111360,3486720,114432,3489792,143232,2130706432,143232,2130706432,3483648,3486720,3489792,3489792,2208768,0
    .long 117888,3526656,120960,3529728,124032,3532800,143232,2130706432,143232,2130706432,3483648,3486720,3489792,3489792,2208768,0
    .long 98688,629155200,0,17920,98688,629155200,16,17936,98688,629155200,32,17952,98688,629155200,32,17952
    .long 108288,629155200,0,18144,108288,629155200,16,18160,108288,629155200,32,18176,108288,629155200,32,18176
    .long 4104000,17,1032192,1040256,1033056,1041120,36,54,127,0,127,4,9600,89088,50,1065370368
    .long 146688,192,17,777600,216,1048592000,4032,3,21600,4405056,0,0,0,0,0,0
    .long 89088,5462016,92160,5465088,95232,5468160,143232,2130706432,143232,2130706432,5505024,5508096,5511168,5511168,4147200,0
    .long 98688,5505024,101760,5508096,104832,5511168,143232,2130706432,143232,2130706432,5505024,5508096,5511168,5511168,4147200,0
    .long 108288,5548032,111360,5551104,114432,5554176,143232,2130706432,143232,2130706432,5548032,5551104,5554176,5554176,4276224,0
    .long 117888,5591040,120960,5594112,124032,5597184,143232,2130706432,143232,2130706432,5548032,5551104,5554176,5554176,4276224,0
    .long 98688,629155200,0,28672,98688,629155200,16,28688,98688,629155200,32,28704,98688,629155200,32,28704
    .long 108288,629155200,0,28896,108288,629155200,16,28912,108288,629155200,32,28928,108288,629155200,32,28928
    .long 6171456,17,1483776,1491840,1484640,1492704,36,54,183,0,183,4,9600,89088,50,1065370424
    .long 146688,192,17,1165248,216,1048592000,4032,3,32368,6472512,0,0,0,0,0,0
    .long 89088,7870464,92160,7873536,95232,7876608,143232,2130706432,143232,2130706432,7913472,7916544,7919616,7919616,6214656,0
    .long 98688,7913472,101760,7916544,104832,7919616,143232,2130706432,143232,2130706432,7913472,7916544,7919616,7919616,6214656,0
    .long 108288,7956480,111360,7959552,114432,7962624,143232,2130706432,143232,2130706432,7956480,7959552,7962624,7962624,6343680,0
    .long 117888,7999488,120960,8002560,124032,8005632,143232,2130706432,143232,2130706432,7956480,7959552,7962624,7962624,6343680,0
    .long 98688,629155200,0,41216,98688,629155200,16,41232,98688,629155200,32,41248,98688,629155200,32,41248
    .long 108288,629155200,0,41440,108288,629155200,16,41456,108288,629155200,32,41472,108288,629155200,32,41472
    .long 2048832,17,864,900,194400,194436,8064,54,23,1,22,6,9600,89088,50,1065370048
    .long 146688,43008,17,392256,216,1048591872,4032,3,10896,2349888,1,0,0,0,0,0
    .long 89088,4224,127488,4992,111360,692736,95232,1380480,133632,1381248,4608,692736,1380864,1380864,2092032,0
    .long 98688,4416,137088,5184,120960,692928,104832,1380672,143232,1381440,4608,692736,1380864,1380864,2092032,0
    .long 108288,4608,92160,692352,130560,693120,114432,1380864,143232,1381440,4800,692928,1381056,1381056,2221056,0
    .long 117888,4800,101760,692544,140160,693312,124032,1381056,143232,1381440,4800,692928,1381056,1381056,2221056,0
    .long 108288,629155200,0,24,108288,629155200,16,3608,108288,629155200,32,7192,108288,629155200,32,7192
    .long 117888,629155200,0,25,117888,629155200,16,3609,117888,629155200,32,7193,117888,629155200,32,7193
    .long 4116288,17,2880,2916,196416,196452,8064,54,79,1,79,4,9600,89088,50,1065370272
    .long 146688,43008,17,779904,216,1048592000,4032,3,21664,4417344,0,0,0,0,0,0
    .long 89088,15168,92160,703296,95232,1391424,143232,2130706432,143232,2130706432,15360,703488,1391616,1391616,4159488,0
    .long 98688,15360,101760,703488,104832,1391616,143232,2130706432,143232,2130706432,15360,703488,1391616,1391616,4159488,0
    .long 108288,15552,111360,703680,114432,1391808,143232,2130706432,143232,2130706432,15552,703680,1391808,1391808,4288512,0
    .long 117888,15744,120960,703872,124032,1392000,143232,2130706432,143232,2130706432,15552,703680,1391808,1391808,4288512,0
    .long 98688,629155200,0,80,98688,629155200,16,3664,98688,629155200,32,7248,98688,629155200,32,7248
    .long 108288,629155200,0,81,108288,629155200,16,3665,108288,629155200,32,7249,108288,629155200,32,7249
    .long 6183744,17,4896,4932,198432,198468,8064,54,135,1,135,4,9600,89088,50,1065370376
    .long 146688,43008,17,1167552,216,1048592000,4032,3,32432,6484800,0,0,0,0,0,0
    .long 89088,25920,92160,714048,95232,1402176,143232,2130706432,143232,2130706432,26112,714240,1402368,1402368,6226944,0
    .long 98688,26112,101760,714240,104832,1402368,143232,2130706432,143232,2130706432,26112,714240,1402368,1402368,6226944,0
    .long 108288,26304,111360,714432,114432,1402560,143232,2130706432,143232,2130706432,26304,714432,1402560,1402560,6355968,0
    .long 117888,26496,120960,714624,124032,1402752,143232,2130706432,143232,2130706432,26304,714432,1402560,1402560,6355968,0
    .long 98688,629155200,0,136,98688,629155200,16,3720,98688,629155200,32,7304,98688,629155200,32,7304
    .long 108288,629155200,0,137,108288,629155200,16,3721,108288,629155200,32,7305,108288,629155200,32,7305
    .long 2061120,16,6624,6660,200160,200196,8064,54,183,1,183,4,9600,89088,50,1065370424
    .long 146688,43008,17,394560,216,1048591872,4032,3,10960,2362176,0,0,0,0,0,0
    .long 89088,35136,92160,723264,95232,1411392,143232,2130706432,143232,2130706432,35328,723456,1411584,1411584,2104320,0
    .long 98688,35328,101760,723456,104832,1411584,143232,2130706432,143232,2130706432,35328,723456,1411584,1411584,2104320,0
    .long 108288,35520,111360,723648,114432,1411776,143232,2130706432,143232,2130706432,35520,723648,1411776,1411776,2233344,0
    .long 117888,35712,120960,723840,124032,1411968,143232,2130706432,143232,2130706432,35520,723648,1411776,1411776,2233344,0
    .long 98688,629155200,0,184,98688,629155200,16,3768,98688,629155200,32,7352,98688,629155200,32,7352
    .long 108288,629155200,0,185,108288,629155200,16,3769,108288,629155200,32,7353,108288,629155200,32,7353
    .long 6288192,17,2130706432,72576,2130706432,2130706432,36,36,7,0,7,5,3456,106368,18,1065369872
    .long 148224,192,17,1187136,396,1040203392,2048,3,32976,6589248,0,0,0,0,0,0
    .long 89088,6632256,102912,6804288,116736,430080,143232,2130706432,143232,2130706432,6589440,6675456,6761472,6761472,6331392,0
    .long 92544,6675264,106368,301056,120192,473088,143232,2130706432,143232,2130706432,6589440,6675456,6761472,6761472,6331392,0
    .long 96000,6718272,109824,344064,143232,2130706432,143232,2130706432,143232,2130706432,6632448,6718464,387072,387072,6460416,0
    .long 99456,6761280,113280,387072,143232,2130706432,143232,2130706432,143232,2130706432,6632448,6718464,387072,387072,6460416,0
    .long 85632,226495872,1,34320,92544,226495872,1,34768,99456,226495872,1,35216,99456,226495872,1,35216
    .long 89088,226495872,1,34544,96000,226495872,1,34992,113280,226495872,0,2016,113280,226495872,0,2016
    .long 2294592,17,661248,669312,662112,670176,36,54,81,0,81,4,9600,89088,50,1065370276
    .long 146688,192,17,438336,216,1048591872,4032,3,12176,2595648,0,0,0,0,0,0
    .long 89088,3483648,92160,3486720,95232,3489792,143232,2130706432,143232,2130706432,3526656,3529728,3532800,3532800,2337792,0
    .long 98688,3526656,101760,3529728,104832,3532800,143232,2130706432,143232,2130706432,3526656,3529728,3532800,3532800,2337792,0
    .long 108288,3569664,111360,3572736,114432,3575808,143232,2130706432,143232,2130706432,3569664,3572736,3575808,3575808,2466816,0
    .long 117888,3612672,120960,3615744,124032,3618816,143232,2130706432,143232,2130706432,3569664,3572736,3575808,3575808,2466816,0
    .long 98688,629155200,0,18368,98688,629155200,16,18384,98688,629155200,32,18400,98688,629155200,32,18400
    .long 108288,629155200,0,18592,108288,629155200,16,18608,108288,629155200,32,18624,108288,629155200,32,18624
    .long 4362048,17,1048320,1056384,1049184,1057248,36,54,129,0,129,4,9600,89088,50,1065370370
    .long 146688,192,17,825984,216,1048592000,4032,3,22944,4663104,0,0,0,0,0,0
    .long 89088,5548032,92160,5551104,95232,5554176,143232,2130706432,143232,2130706432,5591040,5594112,5597184,5597184,4405248,0
    .long 98688,5591040,101760,5594112,104832,5597184,143232,2130706432,143232,2130706432,5591040,5594112,5597184,5597184,4405248,0
    .long 108288,5634048,111360,5637120,114432,5640192,143232,2130706432,143232,2130706432,5634048,5637120,5640192,5640192,4534272,0
    .long 117888,5677056,120960,5680128,124032,5683200,143232,2130706432,143232,2130706432,5634048,5637120,5640192,5640192,4534272,0
    .long 98688,629155200,0,29120,98688,629155200,16,29136,98688,629155200,32,29152,98688,629155200,32,29152
    .long 108288,629155200,0,29344,108288,629155200,16,29360,108288,629155200,32,29376,108288,629155200,32,29376
    .long 6429504,17,1499904,1507968,1500768,1508832,36,54,185,0,185,4,9600,89088,50,1065370426
    .long 146688,192,17,1213632,216,1048592000,4032,3,33712,6730560,0,0,0,0,0,0
    .long 89088,7956480,92160,7959552,95232,7962624,143232,2130706432,143232,2130706432,7999488,8002560,8005632,8005632,6472704,0
    .long 98688,7999488,101760,8002560,104832,8005632,143232,2130706432,143232,2130706432,7999488,8002560,8005632,8005632,6472704,0
    .long 108288,8042496,111360,8045568,114432,8048640,143232,2130706432,143232,2130706432,8042496,8045568,8048640,8048640,6601728,0
    .long 117888,8085504,120960,8088576,124032,8091648,143232,2130706432,143232,2130706432,8042496,8045568,8048640,8048640,6601728,0
    .long 98688,629155200,0,41664,98688,629155200,16,41680,98688,629155200,32,41696,98688,629155200,32,41696
    .long 108288,629155200,0,41888,108288,629155200,16,41904,108288,629155200,32,41920,108288,629155200,32,41920
    .long 2306880,17,936,972,194472,194508,8064,54,25,1,24,6,9600,89088,50,1065370064
    .long 146688,43008,17,440640,216,1048591872,4032,3,12240,2607936,1,0,0,0,0,0
    .long 89088,4608,127488,5376,111360,693120,95232,1380864,133632,1381632,4992,693120,1381248,1381248,2350080,0
    .long 98688,4800,137088,5568,120960,693312,104832,1381056,143232,1381824,4992,693120,1381248,1381248,2350080,0
    .long 108288,4992,92160,692736,130560,693504,114432,1381248,143232,1381824,5184,693312,1381440,1381440,2479104,0
    .long 117888,5184,101760,692928,140160,693696,124032,1381440,143232,1381824,5184,693312,1381440,1381440,2479104,0
    .long 108288,629155200,0,26,108288,629155200,16,3610,108288,629155200,32,7194,108288,629155200,32,7194
    .long 117888,629155200,0,27,117888,629155200,16,3611,117888,629155200,32,7195,117888,629155200,32,7195
    .long 4374336,17,2952,2988,196488,196524,8064,54,81,1,81,4,9600,89088,50,1065370276
    .long 146688,43008,17,828288,216,1048592000,4032,3,23008,4675392,0,0,0,0,0,0
    .long 89088,15552,92160,703680,95232,1391808,143232,2130706432,143232,2130706432,15744,703872,1392000,1392000,4417536,0
    .long 98688,15744,101760,703872,104832,1392000,143232,2130706432,143232,2130706432,15744,703872,1392000,1392000,4417536,0
    .long 108288,15936,111360,704064,114432,1392192,143232,2130706432,143232,2130706432,15936,704064,1392192,1392192,4546560,0
    .long 117888,16128,120960,704256,124032,1392384,143232,2130706432,143232,2130706432,15936,704064,1392192,1392192,4546560,0
    .long 98688,629155200,0,82,98688,629155200,16,3666,98688,629155200,32,7250,98688,629155200,32,7250
    .long 108288,629155200,0,83,108288,629155200,16,3667,108288,629155200,32,7251,108288,629155200,32,7251
    .long 6441792,17,4968,5004,198504,198540,8064,54,137,1,137,4,9600,89088,50,1065370378
    .long 146688,43008,17,1215936,216,1048592000,4032,3,33776,6742848,0,0,0,0,0,0
    .long 89088,26304,92160,714432,95232,1402560,143232,2130706432,143232,2130706432,26496,714624,1402752,1402752,6484992,0
    .long 98688,26496,101760,714624,104832,1402752,143232,2130706432,143232,2130706432,26496,714624,1402752,1402752,6484992,0
    .long 108288,26688,111360,714816,114432,1402944,143232,2130706432,143232,2130706432,26688,714816,1402944,1402944,6614016,0
    .long 117888,26880,120960,715008,124032,1403136,143232,2130706432,143232,2130706432,26688,714816,1402944,1402944,6614016,0
    .long 98688,629155200,0,138,98688,629155200,16,3722,98688,629155200,32,7306,98688,629155200,32,7306
    .long 108288,629155200,0,139,108288,629155200,16,3723,108288,629155200,32,7307,108288,629155200,32,7307
    .long 2319168,16,6696,6732,200232,200268,8064,54,185,1,185,4,9600,89088,50,1065370426
    .long 146688,43008,17,442944,216,1048591872,4032,3,12304,2620224,0,0,0,0,0,0
    .long 89088,35520,92160,723648,95232,1411776,143232,2130706432,143232,2130706432,35712,723840,1411968,1411968,2362368,0
    .long 98688,35712,101760,723840,104832,1411968,143232,2130706432,143232,2130706432,35712,723840,1411968,1411968,2362368,0
    .long 108288,35904,111360,724032,114432,1412160,143232,2130706432,143232,2130706432,35904,724032,1412160,1412160,2491392,0
    .long 117888,36096,120960,724224,124032,1412352,143232,2130706432,143232,2130706432,35904,724032,1412160,1412160,2491392,0
    .long 98688,629155200,0,186,98688,629155200,16,3770,98688,629155200,32,7354,98688,629155200,32,7354
    .long 108288,629155200,0,187,108288,629155200,16,3771,108288,629155200,32,7355,108288,629155200,32,7355
    .long 6761280,17,2130706432,80640,2130706432,2130706432,36,36,8,0,8,5,3456,106368,18,1065369888
    .long 148224,192,17,1275840,396,1040203392,2048,3,35440,7062336,0,0,0,0,0,0
    .long 89088,7105344,102912,7277376,116736,473088,143232,2130706432,143232,2130706432,7062528,7148544,7234560,7234560,6804480,0
    .long 92544,7148352,106368,344064,120192,516096,143232,2130706432,143232,2130706432,7062528,7148544,7234560,7234560,6804480,0
    .long 96000,7191360,109824,387072,143232,2130706432,143232,2130706432,143232,2130706432,7105536,7191552,430080,430080,6933504,0
    .long 99456,7234368,113280,430080,143232,2130706432,143232,2130706432,143232,2130706432,7105536,7191552,430080,430080,6933504,0
    .long 85632,226495872,1,36784,92544,226495872,1,37232,99456,226495872,1,37680,99456,226495872,1,37680
    .long 89088,226495872,1,37008,96000,226495872,1,37456,113280,226495872,0,2240,113280,226495872,0,2240
    .long 2552640,17,677376,685440,678240,686304,36,54,83,0,83,4,9600,89088,50,1065370280
    .long 146688,192,17,486720,216,1048591872,4032,3,13520,2853696,0,0,0,0,0,0
    .long 89088,3569664,92160,3572736,95232,3575808,143232,2130706432,143232,2130706432,3612672,3615744,3618816,3618816,2595840,0
    .long 98688,3612672,101760,3615744,104832,3618816,143232,2130706432,143232,2130706432,3612672,3615744,3618816,3618816,2595840,0
    .long 108288,3655680,111360,3658752,114432,3661824,143232,2130706432,143232,2130706432,3655680,3658752,3661824,3661824,2724864,0
    .long 117888,3698688,120960,3701760,124032,3704832,143232,2130706432,143232,2130706432,3655680,3658752,3661824,3661824,2724864,0
    .long 98688,629155200,0,18816,98688,629155200,16,18832,98688,629155200,32,18848,98688,629155200,32,18848
    .long 108288,629155200,0,19040,108288,629155200,16,19056,108288,629155200,32,19072,108288,629155200,32,19072
    .long 4620096,17,1064448,1072512,1065312,1073376,36,54,131,0,131,4,9600,89088,50,1065370372
    .long 146688,192,17,874368,216,1048592000,4032,3,24288,4921152,0,0,0,0,0,0
    .long 89088,5634048,92160,5637120,95232,5640192,143232,2130706432,143232,2130706432,5677056,5680128,5683200,5683200,4663296,0
    .long 98688,5677056,101760,5680128,104832,5683200,143232,2130706432,143232,2130706432,5677056,5680128,5683200,5683200,4663296,0
    .long 108288,5720064,111360,5723136,114432,5726208,143232,2130706432,143232,2130706432,5720064,5723136,5726208,5726208,4792320,0
    .long 117888,5763072,120960,5766144,124032,5769216,143232,2130706432,143232,2130706432,5720064,5723136,5726208,5726208,4792320,0
    .long 98688,629155200,0,29568,98688,629155200,16,29584,98688,629155200,32,29600,98688,629155200,32,29600
    .long 108288,629155200,0,29792,108288,629155200,16,29808,108288,629155200,32,29824,108288,629155200,32,29824
    .long 6687552,17,1516032,1524096,1516896,1524960,36,54,187,0,187,4,9600,89088,50,1065370428
    .long 146688,192,17,1262016,216,1048592000,4032,3,35056,6988608,0,0,0,0,0,0
    .long 89088,8042496,92160,8045568,95232,8048640,143232,2130706432,143232,2130706432,8085504,8088576,8091648,8091648,6730752,0
    .long 98688,8085504,101760,8088576,104832,8091648,143232,2130706432,143232,2130706432,8085504,8088576,8091648,8091648,6730752,0
    .long 108288,8128512,111360,8131584,114432,8134656,143232,2130706432,143232,2130706432,8128512,8131584,8134656,8134656,6859776,0
    .long 117888,8171520,120960,8174592,124032,8177664,143232,2130706432,143232,2130706432,8128512,8131584,8134656,8134656,6859776,0
    .long 98688,629155200,0,42112,98688,629155200,16,42128,98688,629155200,32,42144,98688,629155200,32,42144
    .long 108288,629155200,0,42336,108288,629155200,16,42352,108288,629155200,32,42368,108288,629155200,32,42368
    .long 2564928,17,1008,1044,194544,194580,8064,54,27,1,26,6,9600,89088,50,1065370080
    .long 146688,43008,17,489024,216,1048591872,4032,3,13584,2865984,1,0,0,0,0,0
    .long 89088,4992,127488,5760,111360,693504,95232,1381248,133632,1382016,5376,693504,1381632,1381632,2608128,0
    .long 98688,5184,137088,5952,120960,693696,104832,1381440,143232,1382208,5376,693504,1381632,1381632,2608128,0
    .long 108288,5376,92160,693120,130560,693888,114432,1381632,143232,1382208,5568,693696,1381824,1381824,2737152,0
    .long 117888,5568,101760,693312,140160,694080,124032,1381824,143232,1382208,5568,693696,1381824,1381824,2737152,0
    .long 108288,629155200,0,28,108288,629155200,16,3612,108288,629155200,32,7196,108288,629155200,32,7196
    .long 117888,629155200,0,29,117888,629155200,16,3613,117888,629155200,32,7197,117888,629155200,32,7197
    .long 4632384,17,3024,3060,196560,196596,8064,54,83,1,83,4,9600,89088,50,1065370280
    .long 146688,43008,17,876672,216,1048592000,4032,3,24352,4933440,0,0,0,0,0,0
    .long 89088,15936,92160,704064,95232,1392192,143232,2130706432,143232,2130706432,16128,704256,1392384,1392384,4675584,0
    .long 98688,16128,101760,704256,104832,1392384,143232,2130706432,143232,2130706432,16128,704256,1392384,1392384,4675584,0
    .long 108288,16320,111360,704448,114432,1392576,143232,2130706432,143232,2130706432,16320,704448,1392576,1392576,4804608,0
    .long 117888,16512,120960,704640,124032,1392768,143232,2130706432,143232,2130706432,16320,704448,1392576,1392576,4804608,0
    .long 98688,629155200,0,84,98688,629155200,16,3668,98688,629155200,32,7252,98688,629155200,32,7252
    .long 108288,629155200,0,85,108288,629155200,16,3669,108288,629155200,32,7253,108288,629155200,32,7253
    .long 6699840,17,5040,5076,198576,198612,8064,54,139,1,139,4,9600,89088,50,1065370380
    .long 146688,43008,17,1264320,216,1048592000,4032,3,35120,7000896,0,0,0,0,0,0
    .long 89088,26688,92160,714816,95232,1402944,143232,2130706432,143232,2130706432,26880,715008,1403136,1403136,6743040,0
    .long 98688,26880,101760,715008,104832,1403136,143232,2130706432,143232,2130706432,26880,715008,1403136,1403136,6743040,0
    .long 108288,27072,111360,715200,114432,1403328,143232,2130706432,143232,2130706432,27072,715200,1403328,1403328,6872064,0
    .long 117888,27264,120960,715392,124032,1403520,143232,2130706432,143232,2130706432,27072,715200,1403328,1403328,6872064,0
    .long 98688,629155200,0,140,98688,629155200,16,3724,98688,629155200,32,7308,98688,629155200,32,7308
    .long 108288,629155200,0,141,108288,629155200,16,3725,108288,629155200,32,7309,108288,629155200,32,7309
    .long 2577216,16,6768,6804,200304,200340,8064,54,187,1,187,4,9600,89088,50,1065370428
    .long 146688,43008,17,491328,216,1048591872,4032,3,13648,2878272,0,0,0,0,0,0
    .long 89088,35904,92160,724032,95232,1412160,143232,2130706432,143232,2130706432,36096,724224,1412352,1412352,2620416,0
    .long 98688,36096,101760,724224,104832,1412352,143232,2130706432,143232,2130706432,36096,724224,1412352,1412352,2620416,0
    .long 108288,36288,111360,724416,114432,1412544,143232,2130706432,143232,2130706432,36288,724416,1412544,1412544,2749440,0
    .long 117888,36480,120960,724608,124032,1412736,143232,2130706432,143232,2130706432,36288,724416,1412544,1412544,2749440,0
    .long 98688,629155200,0,188,98688,629155200,16,3772,98688,629155200,32,7356,98688,629155200,32,7356
    .long 108288,629155200,0,189,108288,629155200,16,3773,108288,629155200,32,7357,108288,629155200,32,7357
    .long 7234368,17,2130706432,88704,2130706432,2130706432,36,36,9,0,9,5,3456,106368,18,1065369904
    .long 148224,192,17,1364544,396,1040203392,2048,3,37904,7535424,0,0,0,0,0,0
    .long 89088,7578432,102912,7750464,116736,516096,143232,2130706432,143232,2130706432,7535616,7621632,7707648,7707648,7277568,0
    .long 92544,7621440,106368,387072,120192,559104,143232,2130706432,143232,2130706432,7535616,7621632,7707648,7707648,7277568,0
    .long 96000,7664448,109824,430080,143232,2130706432,143232,2130706432,143232,2130706432,7578624,7664640,473088,473088,7406592,0
    .long 99456,7707456,113280,473088,143232,2130706432,143232,2130706432,143232,2130706432,7578624,7664640,473088,473088,7406592,0
    .long 85632,226495872,1,39248,92544,226495872,1,39696,99456,226495872,1,40144,99456,226495872,1,40144
    .long 89088,226495872,1,39472,96000,226495872,1,39920,113280,226495872,0,2464,113280,226495872,0,2464
    .long 2810688,17,693504,701568,694368,702432,36,54,85,0,85,4,9600,89088,50,1065370284
    .long 146688,192,17,535104,216,1048592000,4032,3,14864,3111744,0,0,0,0,0,0
    .long 89088,3655680,92160,3658752,95232,3661824,143232,2130706432,143232,2130706432,3698688,3701760,3704832,3704832,2853888,0
    .long 98688,3698688,101760,3701760,104832,3704832,143232,2130706432,143232,2130706432,3698688,3701760,3704832,3704832,2853888,0
    .long 108288,3741696,111360,3744768,114432,3747840,143232,2130706432,143232,2130706432,3741696,3744768,3747840,3747840,2982912,0
    .long 117888,3784704,120960,3787776,124032,3790848,143232,2130706432,143232,2130706432,3741696,3744768,3747840,3747840,2982912,0
    .long 98688,629155200,0,19264,98688,629155200,16,19280,98688,629155200,32,19296,98688,629155200,32,19296
    .long 108288,629155200,0,19488,108288,629155200,16,19504,108288,629155200,32,19520,108288,629155200,32,19520
    .long 4878144,17,1080576,1088640,1081440,1089504,36,54,133,0,133,4,9600,89088,50,1065370374
    .long 146688,192,17,922752,216,1048592000,4032,3,25632,5179200,0,0,0,0,0,0
    .long 89088,5720064,92160,5723136,95232,5726208,143232,2130706432,143232,2130706432,5763072,5766144,5769216,5769216,4921344,0
    .long 98688,5763072,101760,5766144,104832,5769216,143232,2130706432,143232,2130706432,5763072,5766144,5769216,5769216,4921344,0
    .long 108288,5806080,111360,5809152,114432,5812224,143232,2130706432,143232,2130706432,5806080,5809152,5812224,5812224,5050368,0
    .long 117888,5849088,120960,5852160,124032,5855232,143232,2130706432,143232,2130706432,5806080,5809152,5812224,5812224,5050368,0
    .long 98688,629155200,0,30016,98688,629155200,16,30032,98688,629155200,32,30048,98688,629155200,32,30048
    .long 108288,629155200,0,30240,108288,629155200,16,30256,108288,629155200,32,30272,108288,629155200,32,30272
    .long 6945600,17,1532160,1540224,1533024,1541088,36,54,189,0,189,4,9600,89088,50,1065370430
    .long 146688,192,17,1310400,216,1048592000,4032,3,36400,7246656,0,0,0,0,0,0
    .long 89088,8128512,92160,8131584,95232,8134656,143232,2130706432,143232,2130706432,8171520,8174592,8177664,8177664,6988800,0
    .long 98688,8171520,101760,8174592,104832,8177664,143232,2130706432,143232,2130706432,8171520,8174592,8177664,8177664,6988800,0
    .long 108288,8214528,111360,8217600,114432,8220672,143232,2130706432,143232,2130706432,8214528,8217600,8220672,8220672,7117824,0
    .long 117888,8257536,120960,8260608,124032,8263680,143232,2130706432,143232,2130706432,8214528,8217600,8220672,8220672,7117824,0
    .long 98688,629155200,0,42560,98688,629155200,16,42576,98688,629155200,32,42592,98688,629155200,32,42592
    .long 108288,629155200,0,42784,108288,629155200,16,42800,108288,629155200,32,42816,108288,629155200,32,42816
    .long 2822976,17,1080,1116,194616,194652,8064,54,29,1,28,6,9600,89088,50,1065370096
    .long 146688,43008,17,537408,216,1048592000,4032,3,14928,3124032,1,0,0,0,0,0
    .long 89088,5376,127488,6144,111360,693888,95232,1381632,133632,1382400,5760,693888,1382016,1382016,2866176,0
    .long 98688,5568,137088,6336,120960,694080,104832,1381824,143232,1382592,5760,693888,1382016,1382016,2866176,0
    .long 108288,5760,92160,693504,130560,694272,114432,1382016,143232,1382592,5952,694080,1382208,1382208,2995200,0
    .long 117888,5952,101760,693696,140160,694464,124032,1382208,143232,1382592,5952,694080,1382208,1382208,2995200,0
    .long 108288,629155200,0,30,108288,629155200,16,3614,108288,629155200,32,7198,108288,629155200,32,7198
    .long 117888,629155200,0,31,117888,629155200,16,3615,117888,629155200,32,7199,117888,629155200,32,7199
    .long 4890432,17,3096,3132,196632,196668,8064,54,85,1,85,4,9600,89088,50,1065370284
    .long 146688,43008,17,925056,216,1048592000,4032,3,25696,5191488,0,0,0,0,0,0
    .long 89088,16320,92160,704448,95232,1392576,143232,2130706432,143232,2130706432,16512,704640,1392768,1392768,4933632,0
    .long 98688,16512,101760,704640,104832,1392768,143232,2130706432,143232,2130706432,16512,704640,1392768,1392768,4933632,0
    .long 108288,16704,111360,704832,114432,1392960,143232,2130706432,143232,2130706432,16704,704832,1392960,1392960,5062656,0
    .long 117888,16896,120960,705024,124032,1393152,143232,2130706432,143232,2130706432,16704,704832,1392960,1392960,5062656,0
    .long 98688,629155200,0,86,98688,629155200,16,3670,98688,629155200,32,7254,98688,629155200,32,7254
    .long 108288,629155200,0,87,108288,629155200,16,3671,108288,629155200,32,7255,108288,629155200,32,7255
    .long 6957888,17,5112,5148,198648,198684,8064,54,141,1,141,4,9600,89088,50,1065370382
    .long 146688,43008,17,1312704,216,1048592000,4032,3,36464,7258944,0,0,0,0,0,0
    .long 89088,27072,92160,715200,95232,1403328,143232,2130706432,143232,2130706432,27264,715392,1403520,1403520,7001088,0
    .long 98688,27264,101760,715392,104832,1403520,143232,2130706432,143232,2130706432,27264,715392,1403520,1403520,7001088,0
    .long 108288,27456,111360,715584,114432,1403712,143232,2130706432,143232,2130706432,27456,715584,1403712,1403712,7130112,0
    .long 117888,27648,120960,715776,124032,1403904,143232,2130706432,143232,2130706432,27456,715584,1403712,1403712,7130112,0
    .long 98688,629155200,0,142,98688,629155200,16,3726,98688,629155200,32,7310,98688,629155200,32,7310
    .long 108288,629155200,0,143,108288,629155200,16,3727,108288,629155200,32,7311,108288,629155200,32,7311
    .long 2835264,16,6840,6876,200376,200412,8064,54,189,1,189,4,9600,89088,50,1065370430
    .long 146688,43008,17,539712,216,1048592000,4032,3,14992,3136320,0,0,0,0,0,0
    .long 89088,36288,92160,724416,95232,1412544,143232,2130706432,143232,2130706432,36480,724608,1412736,1412736,2878464,0
    .long 98688,36480,101760,724608,104832,1412736,143232,2130706432,143232,2130706432,36480,724608,1412736,1412736,2878464,0
    .long 108288,36672,111360,724800,114432,1412928,143232,2130706432,143232,2130706432,36672,724800,1412928,1412928,3007488,0
    .long 117888,36864,120960,724992,124032,1413120,143232,2130706432,143232,2130706432,36672,724800,1412928,1412928,3007488,0
    .long 98688,629155200,0,190,98688,629155200,16,3774,98688,629155200,32,7358,98688,629155200,32,7358
    .long 108288,629155200,0,191,108288,629155200,16,3775,108288,629155200,32,7359,108288,629155200,32,7359
    .long 7707456,17,2130706432,96768,2130706432,2130706432,36,36,10,0,10,5,3456,106368,18,1065369920
    .long 148224,192,17,1453248,396,1040203392,2048,3,40368,8008512,0,0,0,0,0,0
    .long 89088,8051520,102912,8223552,116736,559104,143232,2130706432,143232,2130706432,8008704,8094720,8180736,8180736,7750656,0
    .long 92544,8094528,106368,430080,120192,602112,143232,2130706432,143232,2130706432,8008704,8094720,8180736,8180736,7750656,0
    .long 96000,8137536,109824,473088,143232,2130706432,143232,2130706432,143232,2130706432,8051712,8137728,516096,516096,7879680,0
    .long 99456,8180544,113280,516096,143232,2130706432,143232,2130706432,143232,2130706432,8051712,8137728,516096,516096,7879680,0
    .long 85632,226495872,1,41712,92544,226495872,1,42160,99456,226495872,1,42608,99456,226495872,1,42608
    .long 89088,226495872,1,41936,96000,226495872,1,42384,113280,226495872,0,2688,113280,226495872,0,2688
    .long 3068736,17,709632,717696,710496,718560,36,54,87,0,87,4,9600,89088,50,1065370288
    .long 146688,192,17,583488,216,1048592000,4032,3,16208,3369792,0,0,0,0,0,0
    .long 89088,3741696,92160,3744768,95232,3747840,143232,2130706432,143232,2130706432,3784704,3787776,3790848,3790848,3111936,0
    .long 98688,3784704,101760,3787776,104832,3790848,143232,2130706432,143232,2130706432,3784704,3787776,3790848,3790848,3111936,0
    .long 108288,3827712,111360,3830784,114432,3833856,143232,2130706432,143232,2130706432,3827712,3830784,3833856,3833856,3240960,0
    .long 117888,3870720,120960,3873792,124032,3876864,143232,2130706432,143232,2130706432,3827712,3830784,3833856,3833856,3240960,0
    .long 98688,629155200,0,19712,98688,629155200,16,19728,98688,629155200,32,19744,98688,629155200,32,19744
    .long 108288,629155200,0,19936,108288,629155200,16,19952,108288,629155200,32,19968,108288,629155200,32,19968
    .long 5136192,17,1096704,1104768,1097568,1105632,36,54,135,0,135,4,9600,89088,50,1065370376
    .long 146688,192,17,971136,216,1048592000,4032,3,26976,5437248,0,0,0,0,0,0
    .long 89088,5806080,92160,5809152,95232,5812224,143232,2130706432,143232,2130706432,5849088,5852160,5855232,5855232,5179392,0
    .long 98688,5849088,101760,5852160,104832,5855232,143232,2130706432,143232,2130706432,5849088,5852160,5855232,5855232,5179392,0
    .long 108288,5892096,111360,5895168,114432,5898240,143232,2130706432,143232,2130706432,5892096,5895168,5898240,5898240,5308416,0
    .long 117888,5935104,120960,5938176,124032,5941248,143232,2130706432,143232,2130706432,5892096,5895168,5898240,5898240,5308416,0
    .long 98688,629155200,0,30464,98688,629155200,16,30480,98688,629155200,32,30496,98688,629155200,32,30496
    .long 108288,629155200,0,30688,108288,629155200,16,30704,108288,629155200,32,30720,108288,629155200,32,30720
    .long 7203648,17,2130706432,2130706432,2130706432,2130706432,36,0,0,0,0,0,0,116736,0,0
    .long 0,192,17,1358784,504,1048592000,0,4,37744,7504704,0,0,0,0,0,0
    .long 89088,7547712,102912,7719744,143232,2130706432,143232,2130706432,143232,2130706432,7504896,7590912,7676928,7762944,7246848,0
    .long 92544,7590720,106368,7762752,143232,2130706432,143232,2130706432,143232,2130706432,7504896,7590912,7676928,7762944,7246848,0
    .long 96000,7633728,109824,7805760,143232,2130706432,143232,2130706432,143232,2130706432,7547904,7633920,7719936,7805952,7375872,0
    .long 99456,7676736,113280,7848768,143232,2130706432,143232,2130706432,143232,2130706432,7547904,7633920,7719936,7805952,7375872,0
    .long 85632,226495872,1,39088,92544,226495872,1,39536,99456,226495872,1,39984,106368,226495872,1,40432
    .long 89088,226495872,1,39312,96000,226495872,1,39760,102912,226495872,1,40208,109824,226495872,1,40656
    .long 3081024,17,1152,1188,194688,194724,8064,54,31,1,30,6,9600,89088,50,1065370112
    .long 146688,43008,17,585792,216,1048592000,4032,3,16272,3382080,1,0,0,0,0,0
    .long 89088,5760,127488,6528,111360,694272,95232,1382016,133632,1382784,6144,694272,1382400,1382400,3124224,0
    .long 98688,5952,137088,6720,120960,694464,104832,1382208,143232,1382976,6144,694272,1382400,1382400,3124224,0
    .long 108288,6144,92160,693888,130560,694656,114432,1382400,143232,1382976,6336,694464,1382592,1382592,3253248,0
    .long 117888,6336,101760,694080,140160,694848,124032,1382592,143232,1382976,6336,694464,1382592,1382592,3253248,0
    .long 108288,629155200,0,32,108288,629155200,16,3616,108288,629155200,32,7200,108288,629155200,32,7200
    .long 117888,629155200,0,33,117888,629155200,16,3617,117888,629155200,32,7201,117888,629155200,32,7201
    .long 5148480,17,3168,3204,196704,196740,8064,54,87,1,87,4,9600,89088,50,1065370288
    .long 146688,43008,17,973440,216,1048592000,4032,3,27040,5449536,0,0,0,0,0,0
    .long 89088,16704,92160,704832,95232,1392960,143232,2130706432,143232,2130706432,16896,705024,1393152,1393152,5191680,0
    .long 98688,16896,101760,705024,104832,1393152,143232,2130706432,143232,2130706432,16896,705024,1393152,1393152,5191680,0
    .long 108288,17088,111360,705216,114432,1393344,143232,2130706432,143232,2130706432,17088,705216,1393344,1393344,5320704,0
    .long 117888,17280,120960,705408,124032,1393536,143232,2130706432,143232,2130706432,17088,705216,1393344,1393344,5320704,0
    .long 98688,629155200,0,88,98688,629155200,16,3672,98688,629155200,32,7256,98688,629155200,32,7256
    .long 108288,629155200,0,89,108288,629155200,16,3673,108288,629155200,32,7257,108288,629155200,32,7257
    .long 7215936,17,2130706432,2130706432,2130706432,2130706432,36,0,0,0,0,0,0,116736,0,0
    .long 0,192,17,1361088,504,1048592000,0,4,37808,7516992,0,0,0,0,0,0
    .long 89088,7560000,102912,7732032,143232,2130706432,143232,2130706432,143232,2130706432,7517184,7603200,7689216,7775232,7259136,0
    .long 92544,7603008,106368,7775040,143232,2130706432,143232,2130706432,143232,2130706432,7517184,7603200,7689216,7775232,7259136,0
    .long 96000,7646016,109824,7818048,143232,2130706432,143232,2130706432,143232,2130706432,7560192,7646208,7732224,7818240,7388160,0
    .long 99456,7689024,113280,7861056,143232,2130706432,143232,2130706432,143232,2130706432,7560192,7646208,7732224,7818240,7388160,0
    .long 85632,226495872,1,39152,92544,226495872,1,39600,99456,226495872,1,40048,106368,226495872,1,40496
    .long 89088,226495872,1,39376,96000,226495872,1,39824,102912,226495872,1,40272,109824,226495872,1,40720
    .long 3093312,16,6912,6948,200448,200484,8064,54,191,1,191,4,9600,89088,50,1065370432
    .long 146688,43008,17,588096,216,1048592000,4032,3,16336,3394368,0,0,0,0,0,0
    .long 89088,36672,92160,724800,95232,1412928,143232,2130706432,143232,2130706432,36864,724992,1413120,1413120,3136512,0
    .long 98688,36864,101760,724992,104832,1413120,143232,2130706432,143232,2130706432,36864,724992,1413120,1413120,3136512,0
    .long 108288,37056,111360,725184,114432,1413312,143232,2130706432,143232,2130706432,37056,725184,1413312,1413312,3265536,0
    .long 117888,37248,120960,725376,124032,1413504,143232,2130706432,143232,2130706432,37056,725184,1413312,1413312,3265536,0
    .long 98688,629155200,0,192,98688,629155200,16,3776,98688,629155200,32,7360,98688,629155200,32,7360
    .long 108288,629155200,0,193,108288,629155200,16,3777,108288,629155200,32,7361,108288,629155200,32,7361
    .long 8180544,17,2130706432,104832,2130706432,2130706432,36,36,11,0,11,5,3456,106368,18,1065369936
    .long 148224,192,17,1541952,396,1040203392,2048,3,42832,8481600,0,0,0,0,0,0
    .long 89088,8524608,102912,8696640,116736,602112,143232,2130706432,143232,2130706432,8481792,8567808,8653824,8653824,8223744,0
    .long 92544,8567616,106368,473088,120192,645120,143232,2130706432,143232,2130706432,8481792,8567808,8653824,8653824,8223744,0
    .long 96000,8610624,109824,516096,143232,2130706432,143232,2130706432,143232,2130706432,8524800,8610816,559104,559104,8352768,0
    .long 99456,8653632,113280,559104,143232,2130706432,143232,2130706432,143232,2130706432,8524800,8610816,559104,559104,8352768,0
    .long 85632,226495872,1,44176,92544,226495872,1,44624,99456,226495872,1,45072,99456,226495872,1,45072
    .long 89088,226495872,1,44400,96000,226495872,1,44848,113280,226495872,0,2912,113280,226495872,0,2912
    .long 3326784,17,725760,733824,726624,734688,36,54,89,0,89,4,9600,89088,50,1065370292
    .long 146688,192,17,631872,216,1048592000,4032,3,17552,3627840,0,0,0,0,0,0
    .long 89088,3827712,92160,3830784,95232,3833856,143232,2130706432,143232,2130706432,3870720,3873792,3876864,3876864,3369984,0
    .long 98688,3870720,101760,3873792,104832,3876864,143232,2130706432,143232,2130706432,3870720,3873792,3876864,3876864,3369984,0
    .long 108288,3913728,111360,3916800,114432,3919872,143232,2130706432,143232,2130706432,3913728,3916800,3919872,3919872,3499008,0
    .long 117888,3956736,120960,3959808,124032,3962880,143232,2130706432,143232,2130706432,3913728,3916800,3919872,3919872,3499008,0
    .long 98688,629155200,0,20160,98688,629155200,16,20176,98688,629155200,32,20192,98688,629155200,32,20192
    .long 108288,629155200,0,20384,108288,629155200,16,20400,108288,629155200,32,20416,108288,629155200,32,20416
    .long 5394240,17,1112832,1120896,1113696,1121760,36,54,137,0,137,4,9600,89088,50,1065370378
    .long 146688,192,17,1019520,216,1048592000,4032,3,28320,5695296,0,0,0,0,0,0
    .long 89088,5892096,92160,5895168,95232,5898240,143232,2130706432,143232,2130706432,5935104,5938176,5941248,5941248,5437440,0
    .long 98688,5935104,101760,5938176,104832,5941248,143232,2130706432,143232,2130706432,5935104,5938176,5941248,5941248,5437440,0
    .long 108288,5978112,111360,5981184,114432,5984256,143232,2130706432,143232,2130706432,5978112,5981184,5984256,5984256,5566464,0
    .long 117888,6021120,120960,6024192,124032,6027264,143232,2130706432,143232,2130706432,5978112,5981184,5984256,5984256,5566464,0
    .long 98688,629155200,0,30912,98688,629155200,16,30928,98688,629155200,32,30944,98688,629155200,32,30944
    .long 108288,629155200,0,31136,108288,629155200,16,31152,108288,629155200,32,31168,108288,629155200,32,31168
    .long 7805760,17,2130706432,2130706432,2130706432,2130706432,36,0,0,0,0,0,0,116736,0,0
    .long 0,192,17,1471680,504,1048592000,0,4,40880,8106816,0,0,0,0,0,0
    .long 89088,8149824,102912,8321856,143232,2130706432,143232,2130706432,143232,2130706432,8107008,8193024,8279040,8365056,7848960,0
    .long 92544,8192832,106368,8364864,143232,2130706432,143232,2130706432,143232,2130706432,8107008,8193024,8279040,8365056,7848960,0
    .long 96000,8235840,109824,8407872,143232,2130706432,143232,2130706432,143232,2130706432,8150016,8236032,8322048,8408064,7977984,0
    .long 99456,8278848,113280,8450880,143232,2130706432,143232,2130706432,143232,2130706432,8150016,8236032,8322048,8408064,7977984,0
    .long 85632,226495872,1,42224,92544,226495872,1,42672,99456,226495872,1,43120,106368,226495872,1,43568
    .long 89088,226495872,1,42448,96000,226495872,1,42896,102912,226495872,1,43344,109824,226495872,1,43792
    .long 3339072,17,1224,1260,194760,194796,8064,54,33,1,33,4,9600,89088,50,1065370120
    .long 146688,43008,17,634176,216,1048592000,4032,3,17616,3640128,0,0,0,0,0,0
    .long 89088,6336,92160,694464,95232,1382592,143232,2130706432,143232,2130706432,6528,694656,1382784,1382784,3382272,0
    .long 98688,6528,101760,694656,104832,1382784,143232,2130706432,143232,2130706432,6528,694656,1382784,1382784,3382272,0
    .long 108288,6720,111360,694848,114432,1382976,143232,2130706432,143232,2130706432,6720,694848,1382976,1382976,3511296,0
    .long 117888,6912,120960,695040,124032,1383168,143232,2130706432,143232,2130706432,6720,694848,1382976,1382976,3511296,0
    .long 98688,629155200,0,34,98688,629155200,16,3618,98688,629155200,32,7202,98688,629155200,32,7202
    .long 108288,629155200,0,35,108288,629155200,16,3619,108288,629155200,32,7203,108288,629155200,32,7203
    .long 5406528,17,3240,3276,196776,196812,8064,54,89,1,89,4,9600,89088,50,1065370292
    .long 146688,43008,17,1021824,216,1048592000,4032,3,28384,5707584,0,0,0,0,0,0
    .long 89088,17088,92160,705216,95232,1393344,143232,2130706432,143232,2130706432,17280,705408,1393536,1393536,5449728,0
    .long 98688,17280,101760,705408,104832,1393536,143232,2130706432,143232,2130706432,17280,705408,1393536,1393536,5449728,0
    .long 108288,17472,111360,705600,114432,1393728,143232,2130706432,143232,2130706432,17472,705600,1393728,1393728,5578752,0
    .long 117888,17664,120960,705792,124032,1393920,143232,2130706432,143232,2130706432,17472,705600,1393728,1393728,5578752,0
    .long 98688,629155200,0,90,98688,629155200,16,3674,98688,629155200,32,7258,98688,629155200,32,7258
    .long 108288,629155200,0,91,108288,629155200,16,3675,108288,629155200,32,7259,108288,629155200,32,7259
    .long 7818048,17,2130706432,2130706432,2130706432,2130706432,36,0,0,0,0,0,0,116736,0,0
    .long 0,192,17,1473984,504,1048592000,0,4,40944,8119104,0,0,0,0,0,0
    .long 89088,8162112,102912,8334144,143232,2130706432,143232,2130706432,143232,2130706432,8119296,8205312,8291328,8377344,7861248,0
    .long 92544,8205120,106368,8377152,143232,2130706432,143232,2130706432,143232,2130706432,8119296,8205312,8291328,8377344,7861248,0
    .long 96000,8248128,109824,8420160,143232,2130706432,143232,2130706432,143232,2130706432,8162304,8248320,8334336,8420352,7990272,0
    .long 99456,8291136,113280,8463168,143232,2130706432,143232,2130706432,143232,2130706432,8162304,8248320,8334336,8420352,7990272,0
    .long 85632,226495872,1,42288,92544,226495872,1,42736,99456,226495872,1,43184,106368,226495872,1,43632
    .long 89088,226495872,1,42512,96000,226495872,1,42960,102912,226495872,1,43408,109824,226495872,1,43856
    .long 3351360,16,6984,7020,200520,200556,8064,54,193,1,193,4,9600,89088,50,1065370434
    .long 146688,43008,17,636480,216,1048592000,4032,3,17680,3652416,0,0,0,0,0,0
    .long 89088,37056,92160,725184,95232,1413312,143232,2130706432,143232,2130706432,37248,725376,1413504,1413504,3394560,0
    .long 98688,37248,101760,725376,104832,1413504,143232,2130706432,143232,2130706432,37248,725376,1413504,1413504,3394560,0
    .long 108288,37440,111360,725568,114432,1413696,143232,2130706432,143232,2130706432,37440,725568,1413696,1413696,3523584,0
    .long 117888,37632,120960,725760,124032,1413888,143232,2130706432,143232,2130706432,37440,725568,1413696,1413696,3523584,0
    .long 98688,629155200,0,194,98688,629155200,16,3778,98688,629155200,32,7362,98688,629155200,32,7362
    .long 108288,629155200,0,195,108288,629155200,16,3779,108288,629155200,32,7363,108288,629155200,32,7363
    .long 8653632,17,2130706432,112896,2130706432,2130706432,36,36,12,0,12,5,3456,106368,18,1065369952
    .long 148224,192,17,1630656,396,1040203392,2048,3,45296,8954688,0,0,0,0,0,0
    .long 89088,8997696,102912,9169728,116736,645120,143232,2130706432,143232,2130706432,8954880,9040896,9126912,9126912,8696832,0
    .long 92544,9040704,106368,516096,120192,688128,143232,2130706432,143232,2130706432,8954880,9040896,9126912,9126912,8696832,0
    .long 96000,9083712,109824,559104,143232,2130706432,143232,2130706432,143232,2130706432,8997888,9083904,602112,602112,8825856,0
    .long 99456,9126720,113280,602112,143232,2130706432,143232,2130706432,143232,2130706432,8997888,9083904,602112,602112,8825856,0
    .long 85632,226495872,1,46640,92544,226495872,1,47088,99456,226495872,1,47536,99456,226495872,1,47536
    .long 89088,226495872,1,46864,96000,226495872,1,47312,113280,226495872,0,3136,113280,226495872,0,3136
    .long 3584832,17,741888,749952,742752,750816,36,54,91,0,91,4,9600,89088,50,1065370296
    .long 146688,192,17,680256,216,1048592000,4032,3,18896,3885888,0,0,0,0,0,0
    .long 89088,3913728,92160,3916800,95232,3919872,143232,2130706432,143232,2130706432,3956736,3959808,3962880,3962880,3628032,0
    .long 98688,3956736,101760,3959808,104832,3962880,143232,2130706432,143232,2130706432,3956736,3959808,3962880,3962880,3628032,0
    .long 108288,3999744,111360,4002816,114432,4005888,143232,2130706432,143232,2130706432,3999744,4002816,4005888,4005888,3757056,0
    .long 117888,4042752,120960,4045824,124032,4048896,143232,2130706432,143232,2130706432,3999744,4002816,4005888,4005888,3757056,0
    .long 98688,629155200,0,20608,98688,629155200,16,20624,98688,629155200,32,20640,98688,629155200,32,20640
    .long 108288,629155200,0,20832,108288,629155200,16,20848,108288,629155200,32,20864,108288,629155200,32,20864
    .long 5652288,17,1128960,1137024,1129824,1137888,36,54,139,0,139,4,9600,89088,50,1065370380
    .long 146688,192,17,1067904,216,1048592000,4032,3,29664,5953344,0,0,0,0,0,0
    .long 89088,5978112,92160,5981184,95232,5984256,143232,2130706432,143232,2130706432,6021120,6024192,6027264,6027264,5695488,0
    .long 98688,6021120,101760,6024192,104832,6027264,143232,2130706432,143232,2130706432,6021120,6024192,6027264,6027264,5695488,0
    .long 108288,6064128,111360,6067200,114432,6070272,143232,2130706432,143232,2130706432,6064128,6067200,6070272,6070272,5824512,0
    .long 117888,6107136,120960,6110208,124032,6113280,143232,2130706432,143232,2130706432,6064128,6067200,6070272,6070272,5824512,0
    .long 98688,629155200,0,31360,98688,629155200,16,31376,98688,629155200,32,31392,98688,629155200,32,31392
    .long 108288,629155200,0,31584,108288,629155200,16,31600,108288,629155200,32,31616,108288,629155200,32,31616
    .long 8407872,17,2130706432,2130706432,2130706432,2130706432,36,0,0,0,0,0,0,116736,0,0
    .long 0,192,17,1584576,504,1048592000,0,4,44016,8708928,0,0,0,0,0,0
    .long 89088,8751936,102912,8923968,143232,2130706432,143232,2130706432,143232,2130706432,8709120,8795136,8881152,8967168,8451072,0
    .long 92544,8794944,106368,8966976,143232,2130706432,143232,2130706432,143232,2130706432,8709120,8795136,8881152,8967168,8451072,0
    .long 96000,8837952,109824,9009984,143232,2130706432,143232,2130706432,143232,2130706432,8752128,8838144,8924160,9010176,8580096,0
    .long 99456,8880960,113280,9052992,143232,2130706432,143232,2130706432,143232,2130706432,8752128,8838144,8924160,9010176,8580096,0
    .long 85632,226495872,1,45360,92544,226495872,1,45808,99456,226495872,1,46256,106368,226495872,1,46704
    .long 89088,226495872,1,45584,96000,226495872,1,46032,102912,226495872,1,46480,109824,226495872,1,46928
    .long 3597120,17,1296,1332,194832,194868,8064,54,35,1,35,4,9600,89088,50,1065370128
    .long 146688,43008,17,682560,216,1048592000,4032,3,18960,3898176,0,0,0,0,0,0
    .long 89088,6720,92160,694848,95232,1382976,143232,2130706432,143232,2130706432,6912,695040,1383168,1383168,3640320,0
    .long 98688,6912,101760,695040,104832,1383168,143232,2130706432,143232,2130706432,6912,695040,1383168,1383168,3640320,0
    .long 108288,7104,111360,695232,114432,1383360,143232,2130706432,143232,2130706432,7104,695232,1383360,1383360,3769344,0
    .long 117888,7296,120960,695424,124032,1383552,143232,2130706432,143232,2130706432,7104,695232,1383360,1383360,3769344,0
    .long 98688,629155200,0,36,98688,629155200,16,3620,98688,629155200,32,7204,98688,629155200,32,7204
    .long 108288,629155200,0,37,108288,629155200,16,3621,108288,629155200,32,7205,108288,629155200,32,7205
    .long 5664576,17,3312,3348,196848,196884,8064,54,91,1,91,4,9600,89088,50,1065370296
    .long 146688,43008,17,1070208,216,1048592000,4032,3,29728,5965632,0,0,0,0,0,0
    .long 89088,17472,92160,705600,95232,1393728,143232,2130706432,143232,2130706432,17664,705792,1393920,1393920,5707776,0
    .long 98688,17664,101760,705792,104832,1393920,143232,2130706432,143232,2130706432,17664,705792,1393920,1393920,5707776,0
    .long 108288,17856,111360,705984,114432,1394112,143232,2130706432,143232,2130706432,17856,705984,1394112,1394112,5836800,0
    .long 117888,18048,120960,706176,124032,1394304,143232,2130706432,143232,2130706432,17856,705984,1394112,1394112,5836800,0
    .long 98688,629155200,0,92,98688,629155200,16,3676,98688,629155200,32,7260,98688,629155200,32,7260
    .long 108288,629155200,0,93,108288,629155200,16,3677,108288,629155200,32,7261,108288,629155200,32,7261
    .long 8420160,17,2130706432,2130706432,2130706432,2130706432,36,0,0,0,0,0,0,116736,0,0
    .long 0,192,17,1586880,504,1048592000,0,4,44080,8721216,0,0,0,0,0,0
    .long 89088,8764224,102912,8936256,143232,2130706432,143232,2130706432,143232,2130706432,8721408,8807424,8893440,8979456,8463360,0
    .long 92544,8807232,106368,8979264,143232,2130706432,143232,2130706432,143232,2130706432,8721408,8807424,8893440,8979456,8463360,0
    .long 96000,8850240,109824,9022272,143232,2130706432,143232,2130706432,143232,2130706432,8764416,8850432,8936448,9022464,8592384,0
    .long 99456,8893248,113280,9065280,143232,2130706432,143232,2130706432,143232,2130706432,8764416,8850432,8936448,9022464,8592384,0
    .long 85632,226495872,1,45424,92544,226495872,1,45872,99456,226495872,1,46320,106368,226495872,1,46768
    .long 89088,226495872,1,45648,96000,226495872,1,46096,102912,226495872,1,46544,109824,226495872,1,46992
    .long 3609408,16,7056,7092,200592,200628,8064,54,195,1,195,4,9600,89088,50,1065370436
    .long 146688,43008,17,684864,216,1048592000,4032,3,19024,3910464,0,0,0,0,0,0
    .long 89088,37440,92160,725568,95232,1413696,143232,2130706432,143232,2130706432,37632,725760,1413888,1413888,3652608,0
    .long 98688,37632,101760,725760,104832,1413888,143232,2130706432,143232,2130706432,37632,725760,1413888,1413888,3652608,0
    .long 108288,37824,111360,725952,114432,1414080,143232,2130706432,143232,2130706432,37824,725952,1414080,1414080,3781632,0
    .long 117888,38016,120960,726144,124032,1414272,143232,2130706432,143232,2130706432,37824,725952,1414080,1414080,3781632,0
    .long 98688,629155200,0,196,98688,629155200,16,3780,98688,629155200,32,7364,98688,629155200,32,7364
    .long 108288,629155200,0,197,108288,629155200,16,3781,108288,629155200,32,7365,108288,629155200,32,7365
    .long 9126720,17,2130706432,120960,2130706432,2130706432,36,36,13,0,13,5,3456,106368,18,1065369968
    .long 148224,192,17,1719360,396,1040203392,2048,3,47760,9427776,0,0,0,0,0,0
    .long 89088,9470784,102912,9599808,116736,688128,143232,2130706432,143232,2130706432,9427968,9513984,9600000,9600000,9169920,0
    .long 92544,9513792,106368,559104,120192,731136,143232,2130706432,143232,2130706432,9427968,9513984,9600000,9600000,9169920,0
    .long 96000,9556800,109824,602112,143232,2130706432,143232,2130706432,143232,2130706432,9470976,9556992,645120,645120,9298944,0
    .long 99456,9599808,113280,645120,143232,2130706432,143232,2130706432,143232,2130706432,9470976,9556992,645120,645120,9298944,0
    .long 85632,226495872,1,49104,92544,226495872,1,49552,99456,226495872,1,50000,99456,226495872,1,50000
    .long 89088,226495872,1,49328,96000,226495872,1,49776,113280,226495872,0,3360,113280,226495872,0,3360
    .long 3842880,17,758016,766080,758880,766944,36,54,93,0,93,4,9600,89088,50,1065370300
    .long 146688,192,17,728640,216,1048592000,4032,3,20240,4143936,0,0,0,0,0,0
    .long 89088,3999744,92160,4002816,95232,4005888,143232,2130706432,143232,2130706432,4042752,4045824,4048896,4048896,3886080,0
    .long 98688,4042752,101760,4045824,104832,4048896,143232,2130706432,143232,2130706432,4042752,4045824,4048896,4048896,3886080,0
    .long 108288,4085760,111360,4088832,114432,4091904,143232,2130706432,143232,2130706432,4085760,4088832,4091904,4091904,4015104,0
    .long 117888,4128768,120960,4131840,124032,4134912,143232,2130706432,143232,2130706432,4085760,4088832,4091904,4091904,4015104,0
    .long 98688,629155200,0,21056,98688,629155200,16,21072,98688,629155200,32,21088,98688,629155200,32,21088
    .long 108288,629155200,0,21280,108288,629155200,16,21296,108288,629155200,32,21312,108288,629155200,32,21312
    .long 5910336,17,1145088,1153152,1145952,1154016,36,54,141,0,141,4,9600,89088,50,1065370382
    .long 146688,192,17,1116288,216,1048592000,4032,3,31008,6211392,0,0,0,0,0,0
    .long 89088,6064128,92160,6067200,95232,6070272,143232,2130706432,143232,2130706432,6107136,6110208,6113280,6113280,5953536,0
    .long 98688,6107136,101760,6110208,104832,6113280,143232,2130706432,143232,2130706432,6107136,6110208,6113280,6113280,5953536,0
    .long 108288,6150144,111360,6153216,114432,6156288,143232,2130706432,143232,2130706432,6150144,6153216,6156288,6156288,6082560,0
    .long 117888,6193152,120960,6196224,124032,6199296,143232,2130706432,143232,2130706432,6150144,6153216,6156288,6156288,6082560,0
    .long 98688,629155200,0,31808,98688,629155200,16,31824,98688,629155200,32,31840,98688,629155200,32,31840
    .long 108288,629155200,0,32032,108288,629155200,16,32048,108288,629155200,32,32064,108288,629155200,32,32064
    .long 9009984,17,2130706432,2130706432,2130706432,2130706432,36,0,0,0,0,0,0,116736,0,0
    .long 0,192,17,1697472,504,1048592000,0,4,47152,9311040,0,0,0,0,0,0
    .long 89088,9354048,102912,9526080,143232,2130706432,143232,2130706432,143232,2130706432,9311232,9397248,9483264,9569280,9053184,0
    .long 92544,9397056,106368,9569088,143232,2130706432,143232,2130706432,143232,2130706432,9311232,9397248,9483264,9569280,9053184,0
    .long 96000,9440064,109824,9612096,143232,2130706432,143232,2130706432,143232,2130706432,9354240,9440256,9526272,9612288,9182208,0
    .long 99456,9483072,113280,9612096,143232,2130706432,143232,2130706432,143232,2130706432,9354240,9440256,9526272,9612288,9182208,0
    .long 85632,226495872,1,48496,92544,226495872,1,48944,99456,226495872,1,49392,106368,226495872,1,49840
    .long 89088,226495872,1,48720,96000,226495872,1,49168,102912,226495872,1,49616,109824,226495872,1,50064
    .long 3855168,17,1368,1404,194904,194940,8064,54,37,1,37,4,9600,89088,50,1065370136
    .long 146688,43008,17,730944,216,1048592000,4032,3,20304,4156224,0,0,0,0,0,0
    .long 89088,7104,92160,695232,95232,1383360,143232,2130706432,143232,2130706432,7296,695424,1383552,1383552,3898368,0
    .long 98688,7296,101760,695424,104832,1383552,143232,2130706432,143232,2130706432,7296,695424,1383552,1383552,3898368,0
    .long 108288,7488,111360,695616,114432,1383744,143232,2130706432,143232,2130706432,7488,695616,1383744,1383744,4027392,0
    .long 117888,7680,120960,695808,124032,1383936,143232,2130706432,143232,2130706432,7488,695616,1383744,1383744,4027392,0
    .long 98688,629155200,0,38,98688,629155200,16,3622,98688,629155200,32,7206,98688,629155200,32,7206
    .long 108288,629155200,0,39,108288,629155200,16,3623,108288,629155200,32,7207,108288,629155200,32,7207
    .long 5922624,17,3384,3420,196920,196956,8064,54,93,1,93,4,9600,89088,50,1065370300
    .long 146688,43008,17,1118592,216,1048592000,4032,3,31072,6223680,0,0,0,0,0,0
    .long 89088,17856,92160,705984,95232,1394112,143232,2130706432,143232,2130706432,18048,706176,1394304,1394304,5965824,0
    .long 98688,18048,101760,706176,104832,1394304,143232,2130706432,143232,2130706432,18048,706176,1394304,1394304,5965824,0
    .long 108288,18240,111360,706368,114432,1394496,143232,2130706432,143232,2130706432,18240,706368,1394496,1394496,6094848,0
    .long 117888,18432,120960,706560,124032,1394688,143232,2130706432,143232,2130706432,18240,706368,1394496,1394496,6094848,0
    .long 98688,629155200,0,94,98688,629155200,16,3678,98688,629155200,32,7262,98688,629155200,32,7262
    .long 108288,629155200,0,95,108288,629155200,16,3679,108288,629155200,32,7263,108288,629155200,32,7263
    .long 9022272,17,2130706432,2130706432,2130706432,2130706432,36,0,0,0,0,0,0,116736,0,0
    .long 0,192,17,1699776,504,1048592000,0,4,47216,9323328,0,0,0,0,0,0
    .long 89088,9366336,102912,9538368,143232,2130706432,143232,2130706432,143232,2130706432,9323520,9409536,9495552,9581568,9065472,0
    .long 92544,9409344,106368,9581376,143232,2130706432,143232,2130706432,143232,2130706432,9323520,9409536,9495552,9581568,9065472,0
    .long 96000,9452352,109824,9624384,143232,2130706432,143232,2130706432,143232,2130706432,9366528,9452544,9538560,9624576,9194496,0
    .long 99456,9495360,113280,9624384,143232,2130706432,143232,2130706432,143232,2130706432,9366528,9452544,9538560,9624576,9194496,0
    .long 85632,226495872,1,48560,92544,226495872,1,49008,99456,226495872,1,49456,106368,226495872,1,49904
    .long 89088,226495872,1,48784,96000,226495872,1,49232,102912,226495872,1,49680,109824,226495872,1,50128
    .long 3867456,16,7128,7164,200664,200700,8064,54,197,1,197,4,9600,89088,50,1065370438
    .long 146688,43008,17,733248,216,1048592000,4032,3,20368,4168512,0,0,0,0,0,0
    .long 89088,37824,92160,725952,95232,1414080,143232,2130706432,143232,2130706432,38016,726144,1414272,1414272,3910656,0
    .long 98688,38016,101760,726144,104832,1414272,143232,2130706432,143232,2130706432,38016,726144,1414272,1414272,3910656,0
    .long 108288,38208,111360,726336,114432,1414464,143232,2130706432,143232,2130706432,38208,726336,1414464,1414464,4039680,0
    .long 117888,38400,120960,726528,124032,1414656,143232,2130706432,143232,2130706432,38208,726336,1414464,1414464,4039680,0
    .long 98688,629155200,0,198,98688,629155200,16,3782,98688,629155200,32,7366,98688,629155200,32,7366
    .long 108288,629155200,0,199,108288,629155200,16,3783,108288,629155200,32,7367,108288,629155200,32,7367
    .long 2033472,17,387072,395136,387936,396000,36,54,47,0,47,4,9600,89088,50,1065370176
    .long 146688,192,17,389376,216,1040203264,4032,3,10816,2334528,0,0,0,0,0,0
    .long 89088,2021376,92160,2024448,95232,2027520,143232,2130706432,143232,2130706432,2064384,2067456,2070528,2070528,2076672,0
    .long 98688,2064384,101760,2067456,104832,2070528,143232,2130706432,143232,2130706432,2064384,2067456,2070528,2070528,2076672,0
    .long 108288,2107392,111360,2110464,114432,2113536,143232,2130706432,143232,2130706432,2107392,2110464,2113536,2113536,2205696,0
    .long 117888,2150400,120960,2153472,124032,2156544,143232,2130706432,143232,2130706432,2107392,2110464,2113536,2113536,2205696,0
    .long 98688,629155200,0,10752,98688,629155200,16,10768,98688,629155200,32,10784,98688,629155200,32,10784
    .long 108288,629155200,0,10976,108288,629155200,16,10992,108288,629155200,32,11008,108288,629155200,32,11008
    .long 4100928,17,774144,782208,775008,783072,36,54,95,0,95,4,9600,89088,50,1065370304
    .long 146688,192,17,777024,216,1048592000,4032,3,21584,4401984,0,0,0,0,0,0
    .long 89088,4085760,92160,4088832,95232,4091904,143232,2130706432,143232,2130706432,4128768,4131840,4134912,4134912,4144128,0
    .long 98688,4128768,101760,4131840,104832,4134912,143232,2130706432,143232,2130706432,4128768,4131840,4134912,4134912,4144128,0
    .long 108288,4171776,111360,4174848,114432,4177920,143232,2130706432,143232,2130706432,4171776,4174848,4177920,4177920,4273152,0
    .long 117888,4214784,120960,4217856,124032,4220928,143232,2130706432,143232,2130706432,4171776,4174848,4177920,4177920,4273152,0
    .long 98688,629155200,0,21504,98688,629155200,16,21520,98688,629155200,32,21536,98688,629155200,32,21536
    .long 108288,629155200,0,21728,108288,629155200,16,21744,108288,629155200,32,21760,108288,629155200,32,21760
    .long 6168384,17,1161216,1169280,1162080,1170144,36,54,143,0,143,4,9600,89088,50,1065370384
    .long 146688,192,17,1164672,216,1048592000,4032,3,32352,6469440,0,0,0,0,0,0
    .long 89088,6150144,92160,6153216,95232,6156288,143232,2130706432,143232,2130706432,6193152,6196224,6199296,6199296,6211584,0
    .long 98688,6193152,101760,6196224,104832,6199296,143232,2130706432,143232,2130706432,6193152,6196224,6199296,6199296,6211584,0
    .long 108288,6236160,111360,6239232,114432,6242304,143232,2130706432,143232,2130706432,6236160,6239232,6242304,6242304,6340608,0
    .long 117888,6279168,120960,6282240,124032,6285312,143232,2130706432,143232,2130706432,6236160,6239232,6242304,6242304,6340608,0
    .long 98688,629155200,0,32256,98688,629155200,16,32272,98688,629155200,32,32288,98688,629155200,32,32288
    .long 108288,629155200,0,32480,108288,629155200,16,32496,108288,629155200,32,32512,108288,629155200,32,32512
    .long 2045760,17,1548288,1556352,1549152,1557216,36,54,191,0,191,4,9600,89088,50,1065370432
    .long 146688,192,17,391680,216,1048591872,4032,3,10880,2346816,0,0,0,0,0,0
    .long 89088,8214528,92160,8217600,95232,8220672,143232,2130706432,143232,2130706432,8257536,8260608,8263680,8263680,2088960,0
    .long 98688,8257536,101760,8260608,104832,8263680,143232,2130706432,143232,2130706432,8257536,8260608,8263680,8263680,2088960,0
    .long 108288,8300544,111360,8303616,114432,8306688,143232,2130706432,143232,2130706432,8300544,8303616,8306688,8306688,2217984,0
    .long 117888,8343552,120960,8346624,124032,8349696,143232,2130706432,143232,2130706432,8300544,8303616,8306688,8306688,2217984,0
    .long 98688,629155200,0,43008,98688,629155200,16,43024,98688,629155200,32,43040,98688,629155200,32,43040
    .long 108288,629155200,0,43232,108288,629155200,16,43248,108288,629155200,32,43264,108288,629155200,32,43264
    .long 4113216,17,1440,1476,194976,195012,8064,54,39,1,39,4,9600,89088,50,1065370144
    .long 146688,43008,17,779328,216,1048592000,4032,3,21648,4414272,0,0,0,0,0,0
    .long 89088,7488,92160,695616,95232,1383744,143232,2130706432,143232,2130706432,7680,695808,1383936,1383936,4156416,0
    .long 98688,7680,101760,695808,104832,1383936,143232,2130706432,143232,2130706432,7680,695808,1383936,1383936,4156416,0
    .long 108288,7872,111360,696000,114432,1384128,143232,2130706432,143232,2130706432,7872,696000,1384128,1384128,4285440,0
    .long 117888,8064,120960,696192,124032,1384320,143232,2130706432,143232,2130706432,7872,696000,1384128,1384128,4285440,0
    .long 98688,629155200,0,40,98688,629155200,16,3624,98688,629155200,32,7208,98688,629155200,32,7208
    .long 108288,629155200,0,41,108288,629155200,16,3625,108288,629155200,32,7209,108288,629155200,32,7209
    .long 6180672,17,3456,3492,196992,197028,8064,54,95,1,95,4,9600,89088,50,1065370304
    .long 146688,43008,17,1166976,216,1048592000,4032,3,32416,6481728,0,0,0,0,0,0
    .long 89088,18240,92160,706368,95232,1394496,143232,2130706432,143232,2130706432,18432,706560,1394688,1394688,6223872,0
    .long 98688,18432,101760,706560,104832,1394688,143232,2130706432,143232,2130706432,18432,706560,1394688,1394688,6223872,0
    .long 108288,18624,111360,706752,114432,1394880,143232,2130706432,143232,2130706432,18624,706752,1394880,1394880,6352896,0
    .long 117888,18816,120960,706944,124032,1395072,143232,2130706432,143232,2130706432,18624,706752,1394880,1394880,6352896,0
    .long 98688,629155200,0,96,98688,629155200,16,3680,98688,629155200,32,7264,98688,629155200,32,7264
    .long 108288,629155200,0,97,108288,629155200,16,3681,108288,629155200,32,7265,108288,629155200,32,7265
    .long 2058048,17,5184,5220,198720,198756,8064,54,143,1,143,4,9600,89088,50,1065370384
    .long 146688,43008,17,393984,216,1048591872,4032,3,10944,2359104,0,0,0,0,0,0
    .long 89088,27456,92160,715584,95232,1403712,143232,2130706432,143232,2130706432,27648,715776,1403904,1403904,2101248,0
    .long 98688,27648,101760,715776,104832,1403904,143232,2130706432,143232,2130706432,27648,715776,1403904,1403904,2101248,0
    .long 108288,27840,111360,715968,114432,1404096,143232,2130706432,143232,2130706432,27840,715968,1404096,1404096,2230272,0
    .long 117888,28032,120960,716160,124032,1404288,143232,2130706432,143232,2130706432,27840,715968,1404096,1404096,2230272,0
    .long 98688,629155200,0,144,98688,629155200,16,3728,98688,629155200,32,7312,98688,629155200,32,7312
    .long 108288,629155200,0,145,108288,629155200,16,3729,108288,629155200,32,7313,108288,629155200,32,7313
    .long 4125504,16,7200,7236,200736,200772,8064,54,199,1,199,4,9600,89088,50,1065370440
    .long 146688,43008,17,781632,216,1048592000,4032,3,21712,4426560,0,0,0,0,0,0
    .long 89088,38208,92160,726336,95232,1414464,143232,2130706432,143232,2130706432,38400,726528,1414656,1414656,4168704,0
    .long 98688,38400,101760,726528,104832,1414656,143232,2130706432,143232,2130706432,38400,726528,1414656,1414656,4168704,0
    .long 108288,38592,111360,726720,114432,1414848,143232,2130706432,143232,2130706432,38592,726720,1414848,1414848,4297728,0
    .long 117888,38784,120960,726912,124032,1415040,143232,2130706432,143232,2130706432,38592,726720,1414848,1414848,4297728,0
    .long 98688,629155200,0,200,98688,629155200,16,3784,98688,629155200,32,7368,98688,629155200,32,7368
    .long 108288,629155200,0,201,108288,629155200,16,3785,108288,629155200,32,7369,108288,629155200,32,7369
    .long 2291520,17,403200,411264,404064,412128,36,54,49,0,49,4,9600,89088,50,1065370184
    .long 146688,192,17,437760,216,1040203264,4032,3,12160,2592576,0,0,0,0,0,0
    .long 89088,2107392,92160,2110464,95232,2113536,143232,2130706432,143232,2130706432,2150400,2153472,2156544,2156544,2334720,0
    .long 98688,2150400,101760,2153472,104832,2156544,143232,2130706432,143232,2130706432,2150400,2153472,2156544,2156544,2334720,0
    .long 108288,2193408,111360,2196480,114432,2199552,143232,2130706432,143232,2130706432,2193408,2196480,2199552,2199552,2463744,0
    .long 117888,2236416,120960,2239488,124032,2242560,143232,2130706432,143232,2130706432,2193408,2196480,2199552,2199552,2463744,0
    .long 98688,629155200,0,11200,98688,629155200,16,11216,98688,629155200,32,11232,98688,629155200,32,11232
    .long 108288,629155200,0,11424,108288,629155200,16,11440,108288,629155200,32,11456,108288,629155200,32,11456
    .long 4358976,17,790272,798336,791136,799200,36,54,97,0,97,4,9600,89088,50,1065370308
    .long 146688,192,17,825408,216,1048592000,4032,3,22928,4660032,0,0,0,0,0,0
    .long 89088,4171776,92160,4174848,95232,4177920,143232,2130706432,143232,2130706432,4214784,4217856,4220928,4220928,4402176,0
    .long 98688,4214784,101760,4217856,104832,4220928,143232,2130706432,143232,2130706432,4214784,4217856,4220928,4220928,4402176,0
    .long 108288,4257792,111360,4260864,114432,4263936,143232,2130706432,143232,2130706432,4257792,4260864,4263936,4263936,4531200,0
    .long 117888,4300800,120960,4303872,124032,4306944,143232,2130706432,143232,2130706432,4257792,4260864,4263936,4263936,4531200,0
    .long 98688,629155200,0,21952,98688,629155200,16,21968,98688,629155200,32,21984,98688,629155200,32,21984
    .long 108288,629155200,0,22176,108288,629155200,16,22192,108288,629155200,32,22208,108288,629155200,32,22208
    .long 6426432,17,1177344,1185408,1178208,1186272,36,54,145,0,145,4,9600,89088,50,1065370386
    .long 146688,192,17,1213056,216,1048592000,4032,3,33696,6727488,0,0,0,0,0,0
    .long 89088,6236160,92160,6239232,95232,6242304,143232,2130706432,143232,2130706432,6279168,6282240,6285312,6285312,6469632,0
    .long 98688,6279168,101760,6282240,104832,6285312,143232,2130706432,143232,2130706432,6279168,6282240,6285312,6285312,6469632,0
    .long 108288,6322176,111360,6325248,114432,6328320,143232,2130706432,143232,2130706432,6322176,6325248,6328320,6328320,6598656,0
    .long 117888,6365184,120960,6368256,124032,6371328,143232,2130706432,143232,2130706432,6322176,6325248,6328320,6328320,6598656,0
    .long 98688,629155200,0,32704,98688,629155200,16,32720,98688,629155200,32,32736,98688,629155200,32,32736
    .long 108288,629155200,0,32928,108288,629155200,16,32944,108288,629155200,32,32960,108288,629155200,32,32960
    .long 2303808,17,1564416,1572480,1565280,1573344,36,54,193,0,193,4,9600,89088,50,1065370434
    .long 146688,192,17,440064,216,1048591872,4032,3,12224,2604864,0,0,0,0,0,0
    .long 89088,8300544,92160,8303616,95232,8306688,143232,2130706432,143232,2130706432,8343552,8346624,8349696,8349696,2347008,0
    .long 98688,8343552,101760,8346624,104832,8349696,143232,2130706432,143232,2130706432,8343552,8346624,8349696,8349696,2347008,0
    .long 108288,8386560,111360,8389632,114432,8392704,143232,2130706432,143232,2130706432,8386560,8389632,8392704,8392704,2476032,0
    .long 117888,8429568,120960,8432640,124032,8435712,143232,2130706432,143232,2130706432,8386560,8389632,8392704,8392704,2476032,0
    .long 98688,629155200,0,43456,98688,629155200,16,43472,98688,629155200,32,43488,98688,629155200,32,43488
    .long 108288,629155200,0,43680,108288,629155200,16,43696,108288,629155200,32,43712,108288,629155200,32,43712
    .long 4371264,17,1512,1548,195048,195084,8064,54,41,1,41,4,9600,89088,50,1065370152
    .long 146688,43008,17,827712,216,1048592000,4032,3,22992,4672320,0,0,0,0,0,0
    .long 89088,7872,92160,696000,95232,1384128,143232,2130706432,143232,2130706432,8064,696192,1384320,1384320,4414464,0
    .long 98688,8064,101760,696192,104832,1384320,143232,2130706432,143232,2130706432,8064,696192,1384320,1384320,4414464,0
    .long 108288,8256,111360,696384,114432,1384512,143232,2130706432,143232,2130706432,8256,696384,1384512,1384512,4543488,0
    .long 117888,8448,120960,696576,124032,1384704,143232,2130706432,143232,2130706432,8256,696384,1384512,1384512,4543488,0
    .long 98688,629155200,0,42,98688,629155200,16,3626,98688,629155200,32,7210,98688,629155200,32,7210
    .long 108288,629155200,0,43,108288,629155200,16,3627,108288,629155200,32,7211,108288,629155200,32,7211
    .long 6438720,17,3528,3564,197064,197100,8064,54,97,1,97,4,9600,89088,50,1065370308
    .long 146688,43008,17,1215360,216,1048592000,4032,3,33760,6739776,0,0,0,0,0,0
    .long 89088,18624,92160,706752,95232,1394880,143232,2130706432,143232,2130706432,18816,706944,1395072,1395072,6481920,0
    .long 98688,18816,101760,706944,104832,1395072,143232,2130706432,143232,2130706432,18816,706944,1395072,1395072,6481920,0
    .long 108288,19008,111360,707136,114432,1395264,143232,2130706432,143232,2130706432,19008,707136,1395264,1395264,6610944,0
    .long 117888,19200,120960,707328,124032,1395456,143232,2130706432,143232,2130706432,19008,707136,1395264,1395264,6610944,0
    .long 98688,629155200,0,98,98688,629155200,16,3682,98688,629155200,32,7266,98688,629155200,32,7266
    .long 108288,629155200,0,99,108288,629155200,16,3683,108288,629155200,32,7267,108288,629155200,32,7267
    .long 2316096,17,5256,5292,198792,198828,8064,54,145,1,145,4,9600,89088,50,1065370386
    .long 146688,43008,17,442368,216,1048591872,4032,3,12288,2617152,0,0,0,0,0,0
    .long 89088,27840,92160,715968,95232,1404096,143232,2130706432,143232,2130706432,28032,716160,1404288,1404288,2359296,0
    .long 98688,28032,101760,716160,104832,1404288,143232,2130706432,143232,2130706432,28032,716160,1404288,1404288,2359296,0
    .long 108288,28224,111360,716352,114432,1404480,143232,2130706432,143232,2130706432,28224,716352,1404480,1404480,2488320,0
    .long 117888,28416,120960,716544,124032,1404672,143232,2130706432,143232,2130706432,28224,716352,1404480,1404480,2488320,0
    .long 98688,629155200,0,146,98688,629155200,16,3730,98688,629155200,32,7314,98688,629155200,32,7314
    .long 108288,629155200,0,147,108288,629155200,16,3731,108288,629155200,32,7315,108288,629155200,32,7315
    .long 4383552,16,7272,7308,200808,200844,8064,54,201,1,201,4,9600,89088,50,1065370442
    .long 146688,43008,17,830016,216,1048592000,4032,3,23056,4684608,0,0,0,0,0,0
    .long 89088,38592,92160,726720,95232,1414848,143232,2130706432,143232,2130706432,38784,726912,1415040,1415040,4426752,0
    .long 98688,38784,101760,726912,104832,1415040,143232,2130706432,143232,2130706432,38784,726912,1415040,1415040,4426752,0
    .long 108288,38976,111360,727104,114432,1415232,143232,2130706432,143232,2130706432,38976,727104,1415232,1415232,4555776,0
    .long 117888,39168,120960,727296,124032,1415424,143232,2130706432,143232,2130706432,38976,727104,1415232,1415232,4555776,0
    .long 98688,629155200,0,202,98688,629155200,16,3786,98688,629155200,32,7370,98688,629155200,32,7370
    .long 108288,629155200,0,203,108288,629155200,16,3787,108288,629155200,32,7371,108288,629155200,32,7371
    .long 2549568,17,419328,427392,420192,428256,36,54,51,0,51,4,9600,89088,50,1065370192
    .long 146688,192,17,486144,216,1040203264,4032,3,13504,2850624,0,0,0,0,0,0
    .long 89088,2193408,92160,2196480,95232,2199552,143232,2130706432,143232,2130706432,2236416,2239488,2242560,2242560,2592768,0
    .long 98688,2236416,101760,2239488,104832,2242560,143232,2130706432,143232,2130706432,2236416,2239488,2242560,2242560,2592768,0
    .long 108288,2279424,111360,2282496,114432,2285568,143232,2130706432,143232,2130706432,2279424,2282496,2285568,2285568,2721792,0
    .long 117888,2322432,120960,2325504,124032,2328576,143232,2130706432,143232,2130706432,2279424,2282496,2285568,2285568,2721792,0
    .long 98688,629155200,0,11648,98688,629155200,16,11664,98688,629155200,32,11680,98688,629155200,32,11680
    .long 108288,629155200,0,11872,108288,629155200,16,11888,108288,629155200,32,11904,108288,629155200,32,11904
    .long 4617024,17,806400,814464,807264,815328,36,54,99,0,99,4,9600,89088,50,1065370312
    .long 146688,192,17,873792,216,1048592000,4032,3,24272,4918080,0,0,0,0,0,0
    .long 89088,4257792,92160,4260864,95232,4263936,143232,2130706432,143232,2130706432,4300800,4303872,4306944,4306944,4660224,0
    .long 98688,4300800,101760,4303872,104832,4306944,143232,2130706432,143232,2130706432,4300800,4303872,4306944,4306944,4660224,0
    .long 108288,4343808,111360,4346880,114432,4349952,143232,2130706432,143232,2130706432,4343808,4346880,4349952,4349952,4789248,0
    .long 117888,4386816,120960,4389888,124032,4392960,143232,2130706432,143232,2130706432,4343808,4346880,4349952,4349952,4789248,0
    .long 98688,629155200,0,22400,98688,629155200,16,22416,98688,629155200,32,22432,98688,629155200,32,22432
    .long 108288,629155200,0,22624,108288,629155200,16,22640,108288,629155200,32,22656,108288,629155200,32,22656
    .long 6684480,17,1193472,1201536,1194336,1202400,36,54,147,0,147,4,9600,89088,50,1065370388
    .long 146688,192,17,1261440,216,1048592000,4032,3,35040,6985536,0,0,0,0,0,0
    .long 89088,6322176,92160,6325248,95232,6328320,143232,2130706432,143232,2130706432,6365184,6368256,6371328,6371328,6727680,0
    .long 98688,6365184,101760,6368256,104832,6371328,143232,2130706432,143232,2130706432,6365184,6368256,6371328,6371328,6727680,0
    .long 108288,6408192,111360,6411264,114432,6414336,143232,2130706432,143232,2130706432,6408192,6411264,6414336,6414336,6856704,0
    .long 117888,6451200,120960,6454272,124032,6457344,143232,2130706432,143232,2130706432,6408192,6411264,6414336,6414336,6856704,0
    .long 98688,629155200,0,33152,98688,629155200,16,33168,98688,629155200,32,33184,98688,629155200,32,33184
    .long 108288,629155200,0,33376,108288,629155200,16,33392,108288,629155200,32,33408,108288,629155200,32,33408
    .long 2561856,17,1580544,1588608,1581408,1589472,36,54,195,0,195,4,9600,89088,50,1065370436
    .long 146688,192,17,488448,216,1048591872,4032,3,13568,2862912,0,0,0,0,0,0
    .long 89088,8386560,92160,8389632,95232,8392704,143232,2130706432,143232,2130706432,8429568,8432640,8435712,8435712,2605056,0
    .long 98688,8429568,101760,8432640,104832,8435712,143232,2130706432,143232,2130706432,8429568,8432640,8435712,8435712,2605056,0
    .long 108288,8472576,111360,8475648,114432,8478720,143232,2130706432,143232,2130706432,8472576,8475648,8478720,8478720,2734080,0
    .long 117888,8515584,120960,8518656,124032,8521728,143232,2130706432,143232,2130706432,8472576,8475648,8478720,8478720,2734080,0
    .long 98688,629155200,0,43904,98688,629155200,16,43920,98688,629155200,32,43936,98688,629155200,32,43936
    .long 108288,629155200,0,44128,108288,629155200,16,44144,108288,629155200,32,44160,108288,629155200,32,44160
    .long 4629312,17,1584,1620,195120,195156,8064,54,43,1,43,4,9600,89088,50,1065370160
    .long 146688,43008,17,876096,216,1048592000,4032,3,24336,4930368,0,0,0,0,0,0
    .long 89088,8256,92160,696384,95232,1384512,143232,2130706432,143232,2130706432,8448,696576,1384704,1384704,4672512,0
    .long 98688,8448,101760,696576,104832,1384704,143232,2130706432,143232,2130706432,8448,696576,1384704,1384704,4672512,0
    .long 108288,8640,111360,696768,114432,1384896,143232,2130706432,143232,2130706432,8640,696768,1384896,1384896,4801536,0
    .long 117888,8832,120960,696960,124032,1385088,143232,2130706432,143232,2130706432,8640,696768,1384896,1384896,4801536,0
    .long 98688,629155200,0,44,98688,629155200,16,3628,98688,629155200,32,7212,98688,629155200,32,7212
    .long 108288,629155200,0,45,108288,629155200,16,3629,108288,629155200,32,7213,108288,629155200,32,7213
    .long 6696768,17,3600,3636,197136,197172,8064,54,99,1,99,4,9600,89088,50,1065370312
    .long 146688,43008,17,1263744,216,1048592000,4032,3,35104,6997824,0,0,0,0,0,0
    .long 89088,19008,92160,707136,95232,1395264,143232,2130706432,143232,2130706432,19200,707328,1395456,1395456,6739968,0
    .long 98688,19200,101760,707328,104832,1395456,143232,2130706432,143232,2130706432,19200,707328,1395456,1395456,6739968,0
    .long 108288,19392,111360,707520,114432,1395648,143232,2130706432,143232,2130706432,19392,707520,1395648,1395648,6868992,0
    .long 117888,19584,120960,707712,124032,1395840,143232,2130706432,143232,2130706432,19392,707520,1395648,1395648,6868992,0
    .long 98688,629155200,0,100,98688,629155200,16,3684,98688,629155200,32,7268,98688,629155200,32,7268
    .long 108288,629155200,0,101,108288,629155200,16,3685,108288,629155200,32,7269,108288,629155200,32,7269
    .long 2574144,17,5328,5364,198864,198900,8064,54,147,1,147,4,9600,89088,50,1065370388
    .long 146688,43008,17,490752,216,1048591872,4032,3,13632,2875200,0,0,0,0,0,0
    .long 89088,28224,92160,716352,95232,1404480,143232,2130706432,143232,2130706432,28416,716544,1404672,1404672,2617344,0
    .long 98688,28416,101760,716544,104832,1404672,143232,2130706432,143232,2130706432,28416,716544,1404672,1404672,2617344,0
    .long 108288,28608,111360,716736,114432,1404864,143232,2130706432,143232,2130706432,28608,716736,1404864,1404864,2746368,0
    .long 117888,28800,120960,716928,124032,1405056,143232,2130706432,143232,2130706432,28608,716736,1404864,1404864,2746368,0
    .long 98688,629155200,0,148,98688,629155200,16,3732,98688,629155200,32,7316,98688,629155200,32,7316
    .long 108288,629155200,0,149,108288,629155200,16,3733,108288,629155200,32,7317,108288,629155200,32,7317
    .long 4641600,16,7344,7380,200880,200916,8064,54,203,1,203,4,9600,89088,50,1065370444
    .long 146688,43008,17,878400,216,1048592000,4032,3,24400,4942656,0,0,0,0,0,0
    .long 89088,38976,92160,727104,95232,1415232,143232,2130706432,143232,2130706432,39168,727296,1415424,1415424,4684800,0
    .long 98688,39168,101760,727296,104832,1415424,143232,2130706432,143232,2130706432,39168,727296,1415424,1415424,4684800,0
    .long 108288,39360,111360,727488,114432,1415616,143232,2130706432,143232,2130706432,39360,727488,1415616,1415616,4813824,0
    .long 117888,39552,120960,727680,124032,1415808,143232,2130706432,143232,2130706432,39360,727488,1415616,1415616,4813824,0
    .long 98688,629155200,0,204,98688,629155200,16,3788,98688,629155200,32,7372,98688,629155200,32,7372
    .long 108288,629155200,0,205,108288,629155200,16,3789,108288,629155200,32,7373,108288,629155200,32,7373
    .long 2807616,17,435456,443520,436320,444384,36,54,53,0,53,4,9600,89088,50,1065370200
    .long 146688,192,17,534528,216,1040203392,4032,3,14848,3108672,0,0,0,0,0,0
    .long 89088,2279424,92160,2282496,95232,2285568,143232,2130706432,143232,2130706432,2322432,2325504,2328576,2328576,2850816,0
    .long 98688,2322432,101760,2325504,104832,2328576,143232,2130706432,143232,2130706432,2322432,2325504,2328576,2328576,2850816,0
    .long 108288,2365440,111360,2368512,114432,2371584,143232,2130706432,143232,2130706432,2365440,2368512,2371584,2371584,2979840,0
    .long 117888,2408448,120960,2411520,124032,2414592,143232,2130706432,143232,2130706432,2365440,2368512,2371584,2371584,2979840,0
    .long 98688,629155200,0,12096,98688,629155200,16,12112,98688,629155200,32,12128,98688,629155200,32,12128
    .long 108288,629155200,0,12320,108288,629155200,16,12336,108288,629155200,32,12352,108288,629155200,32,12352
    .long 4875072,17,822528,830592,823392,831456,36,54,101,0,101,4,9600,89088,50,1065370316
    .long 146688,192,17,922176,216,1048592000,4032,3,25616,5176128,0,0,0,0,0,0
    .long 89088,4343808,92160,4346880,95232,4349952,143232,2130706432,143232,2130706432,4386816,4389888,4392960,4392960,4918272,0
    .long 98688,4386816,101760,4389888,104832,4392960,143232,2130706432,143232,2130706432,4386816,4389888,4392960,4392960,4918272,0
    .long 108288,4429824,111360,4432896,114432,4435968,143232,2130706432,143232,2130706432,4429824,4432896,4435968,4435968,5047296,0
    .long 117888,4472832,120960,4475904,124032,4478976,143232,2130706432,143232,2130706432,4429824,4432896,4435968,4435968,5047296,0
    .long 98688,629155200,0,22848,98688,629155200,16,22864,98688,629155200,32,22880,98688,629155200,32,22880
    .long 108288,629155200,0,23072,108288,629155200,16,23088,108288,629155200,32,23104,108288,629155200,32,23104
    .long 6942528,17,1209600,1217664,1210464,1218528,36,54,149,0,149,4,9600,89088,50,1065370390
    .long 146688,192,17,1309824,216,1048592000,4032,3,36384,7243584,0,0,0,0,0,0
    .long 89088,6408192,92160,6411264,95232,6414336,143232,2130706432,143232,2130706432,6451200,6454272,6457344,6457344,6985728,0
    .long 98688,6451200,101760,6454272,104832,6457344,143232,2130706432,143232,2130706432,6451200,6454272,6457344,6457344,6985728,0
    .long 108288,6494208,111360,6497280,114432,6500352,143232,2130706432,143232,2130706432,6494208,6497280,6500352,6500352,7114752,0
    .long 117888,6537216,120960,6540288,124032,6543360,143232,2130706432,143232,2130706432,6494208,6497280,6500352,6500352,7114752,0
    .long 98688,629155200,0,33600,98688,629155200,16,33616,98688,629155200,32,33632,98688,629155200,32,33632
    .long 108288,629155200,0,33824,108288,629155200,16,33840,108288,629155200,32,33856,108288,629155200,32,33856
    .long 2819904,17,1596672,1604736,1597536,1605600,36,54,197,0,197,4,9600,89088,50,1065370438
    .long 146688,192,17,536832,216,1048592000,4032,3,14912,3120960,0,0,0,0,0,0
    .long 89088,8472576,92160,8475648,95232,8478720,143232,2130706432,143232,2130706432,8515584,8518656,8521728,8521728,2863104,0
    .long 98688,8515584,101760,8518656,104832,8521728,143232,2130706432,143232,2130706432,8515584,8518656,8521728,8521728,2863104,0
    .long 108288,8558592,111360,8561664,114432,8564736,143232,2130706432,143232,2130706432,8558592,8561664,8564736,8564736,2992128,0
    .long 117888,8601600,120960,8604672,124032,8607744,143232,2130706432,143232,2130706432,8558592,8561664,8564736,8564736,2992128,0
    .long 98688,629155200,0,44352,98688,629155200,16,44368,98688,629155200,32,44384,98688,629155200,32,44384
    .long 108288,629155200,0,44576,108288,629155200,16,44592,108288,629155200,32,44608,108288,629155200,32,44608
    .long 4887360,17,1656,1692,195192,195228,8064,54,45,1,45,4,9600,89088,50,1065370168
    .long 146688,43008,17,924480,216,1048592000,4032,3,25680,5188416,0,0,0,0,0,0
    .long 89088,8640,92160,696768,95232,1384896,143232,2130706432,143232,2130706432,8832,696960,1385088,1385088,4930560,0
    .long 98688,8832,101760,696960,104832,1385088,143232,2130706432,143232,2130706432,8832,696960,1385088,1385088,4930560,0
    .long 108288,9024,111360,697152,114432,1385280,143232,2130706432,143232,2130706432,9024,697152,1385280,1385280,5059584,0
    .long 117888,9216,120960,697344,124032,1385472,143232,2130706432,143232,2130706432,9024,697152,1385280,1385280,5059584,0
    .long 98688,629155200,0,46,98688,629155200,16,3630,98688,629155200,32,7214,98688,629155200,32,7214
    .long 108288,629155200,0,47,108288,629155200,16,3631,108288,629155200,32,7215,108288,629155200,32,7215
    .long 6954816,17,3672,3708,197208,197244,8064,54,101,1,101,4,9600,89088,50,1065370316
    .long 146688,43008,17,1312128,216,1048592000,4032,3,36448,7255872,0,0,0,0,0,0
    .long 89088,19392,92160,707520,95232,1395648,143232,2130706432,143232,2130706432,19584,707712,1395840,1395840,6998016,0
    .long 98688,19584,101760,707712,104832,1395840,143232,2130706432,143232,2130706432,19584,707712,1395840,1395840,6998016,0
    .long 108288,19776,111360,707904,114432,1396032,143232,2130706432,143232,2130706432,19776,707904,1396032,1396032,7127040,0
    .long 117888,19968,120960,708096,124032,1396224,143232,2130706432,143232,2130706432,19776,707904,1396032,1396032,7127040,0
    .long 98688,629155200,0,102,98688,629155200,16,3686,98688,629155200,32,7270,98688,629155200,32,7270
    .long 108288,629155200,0,103,108288,629155200,16,3687,108288,629155200,32,7271,108288,629155200,32,7271
    .long 2832192,17,5400,5436,198936,198972,8064,54,149,1,149,4,9600,89088,50,1065370390
    .long 146688,43008,17,539136,216,1048592000,4032,3,14976,3133248,0,0,0,0,0,0
    .long 89088,28608,92160,716736,95232,1404864,143232,2130706432,143232,2130706432,28800,716928,1405056,1405056,2875392,0
    .long 98688,28800,101760,716928,104832,1405056,143232,2130706432,143232,2130706432,28800,716928,1405056,1405056,2875392,0
    .long 108288,28992,111360,717120,114432,1405248,143232,2130706432,143232,2130706432,28992,717120,1405248,1405248,3004416,0
    .long 117888,29184,120960,717312,124032,1405440,143232,2130706432,143232,2130706432,28992,717120,1405248,1405248,3004416,0
    .long 98688,629155200,0,150,98688,629155200,16,3734,98688,629155200,32,7318,98688,629155200,32,7318
    .long 108288,629155200,0,151,108288,629155200,16,3735,108288,629155200,32,7319,108288,629155200,32,7319
    .long 4899648,16,7416,7452,200952,200988,8064,54,205,1,205,4,9600,89088,50,1065370446
    .long 146688,43008,17,926784,216,1048592000,4032,3,25744,5200704,0,0,0,0,0,0
    .long 89088,39360,92160,727488,95232,1415616,143232,2130706432,143232,2130706432,39552,727680,1415808,1415808,4942848,0
    .long 98688,39552,101760,727680,104832,1415808,143232,2130706432,143232,2130706432,39552,727680,1415808,1415808,4942848,0
    .long 108288,39744,111360,727872,114432,1416000,143232,2130706432,143232,2130706432,39744,727872,1416000,1416000,5071872,0
    .long 117888,39936,120960,728064,124032,1416192,143232,2130706432,143232,2130706432,39744,727872,1416000,1416000,5071872,0
    .long 98688,629155200,0,206,98688,629155200,16,3790,98688,629155200,32,7374,98688,629155200,32,7374
    .long 108288,629155200,0,207,108288,629155200,16,3791,108288,629155200,32,7375,108288,629155200,32,7375
    .long 3065664,17,451584,459648,452448,460512,36,54,55,0,55,4,9600,89088,50,1065370208
    .long 146688,192,17,582912,216,1040203392,4032,3,16192,3366720,0,0,0,0,0,0
    .long 89088,2365440,92160,2368512,95232,2371584,143232,2130706432,143232,2130706432,2408448,2411520,2414592,2414592,3108864,0
    .long 98688,2408448,101760,2411520,104832,2414592,143232,2130706432,143232,2130706432,2408448,2411520,2414592,2414592,3108864,0
    .long 108288,2451456,111360,2454528,114432,2457600,143232,2130706432,143232,2130706432,2451456,2454528,2457600,2457600,3237888,0
    .long 117888,2494464,120960,2497536,124032,2500608,143232,2130706432,143232,2130706432,2451456,2454528,2457600,2457600,3237888,0
    .long 98688,629155200,0,12544,98688,629155200,16,12560,98688,629155200,32,12576,98688,629155200,32,12576
    .long 108288,629155200,0,12768,108288,629155200,16,12784,108288,629155200,32,12800,108288,629155200,32,12800
    .long 5133120,17,838656,846720,839520,847584,36,54,103,0,103,4,9600,89088,50,1065370320
    .long 146688,192,17,970560,216,1048592000,4032,3,26960,5434176,0,0,0,0,0,0
    .long 89088,4429824,92160,4432896,95232,4435968,143232,2130706432,143232,2130706432,4472832,4475904,4478976,4478976,5176320,0
    .long 98688,4472832,101760,4475904,104832,4478976,143232,2130706432,143232,2130706432,4472832,4475904,4478976,4478976,5176320,0
    .long 108288,4515840,111360,4518912,114432,4521984,143232,2130706432,143232,2130706432,4515840,4518912,4521984,4521984,5305344,0
    .long 117888,4558848,120960,4561920,124032,4564992,143232,2130706432,143232,2130706432,4515840,4518912,4521984,4521984,5305344,0
    .long 98688,629155200,0,23296,98688,629155200,16,23312,98688,629155200,32,23328,98688,629155200,32,23328
    .long 108288,629155200,0,23520,108288,629155200,16,23536,108288,629155200,32,23552,108288,629155200,32,23552
    .long 7200576,17,2130706432,2130706432,2130706432,2130706432,36,0,0,0,0,0,0,116736,0,0
    .long 0,192,17,1358208,504,1048592000,0,4,37728,7501632,0,0,0,0,0,0
    .long 89088,7544640,102912,7716672,143232,2130706432,143232,2130706432,143232,2130706432,7501824,7587840,7673856,7759872,7243776,0
    .long 92544,7587648,106368,7759680,143232,2130706432,143232,2130706432,143232,2130706432,7501824,7587840,7673856,7759872,7243776,0
    .long 96000,7630656,109824,7802688,143232,2130706432,143232,2130706432,143232,2130706432,7544832,7630848,7716864,7802880,7372800,0
    .long 99456,7673664,113280,7845696,143232,2130706432,143232,2130706432,143232,2130706432,7544832,7630848,7716864,7802880,7372800,0
    .long 85632,226495872,1,39072,92544,226495872,1,39520,99456,226495872,1,39968,106368,226495872,1,40416
    .long 89088,226495872,1,39296,96000,226495872,1,39744,102912,226495872,1,40192,109824,226495872,1,40640
    .long 3077952,17,1612800,1620864,1613664,1621728,36,54,199,0,199,4,9600,89088,50,1065370440
    .long 146688,192,17,585216,216,1048592000,4032,3,16256,3379008,0,0,0,0,0,0
    .long 89088,8558592,92160,8561664,95232,8564736,143232,2130706432,143232,2130706432,8601600,8604672,8607744,8607744,3121152,0
    .long 98688,8601600,101760,8604672,104832,8607744,143232,2130706432,143232,2130706432,8601600,8604672,8607744,8607744,3121152,0
    .long 108288,8644608,111360,8647680,114432,8650752,143232,2130706432,143232,2130706432,8644608,8647680,8650752,8650752,3250176,0
    .long 117888,8687616,120960,8690688,124032,8693760,143232,2130706432,143232,2130706432,8644608,8647680,8650752,8650752,3250176,0
    .long 98688,629155200,0,44800,98688,629155200,16,44816,98688,629155200,32,44832,98688,629155200,32,44832
    .long 108288,629155200,0,45024,108288,629155200,16,45040,108288,629155200,32,45056,108288,629155200,32,45056
    .long 5145408,17,1728,1764,195264,195300,8064,54,47,1,47,4,9600,89088,50,1065370176
    .long 146688,43008,17,972864,216,1048592000,4032,3,27024,5446464,0,0,0,0,0,0
    .long 89088,9024,92160,697152,95232,1385280,143232,2130706432,143232,2130706432,9216,697344,1385472,1385472,5188608,0
    .long 98688,9216,101760,697344,104832,1385472,143232,2130706432,143232,2130706432,9216,697344,1385472,1385472,5188608,0
    .long 108288,9408,111360,697536,114432,1385664,143232,2130706432,143232,2130706432,9408,697536,1385664,1385664,5317632,0
    .long 117888,9600,120960,697728,124032,1385856,143232,2130706432,143232,2130706432,9408,697536,1385664,1385664,5317632,0
    .long 98688,629155200,0,48,98688,629155200,16,3632,98688,629155200,32,7216,98688,629155200,32,7216
    .long 108288,629155200,0,49,108288,629155200,16,3633,108288,629155200,32,7217,108288,629155200,32,7217
    .long 7212864,17,2130706432,2130706432,2130706432,2130706432,36,0,0,0,0,0,0,116736,0,0
    .long 0,192,17,1360512,504,1048592000,0,4,37792,7513920,0,0,0,0,0,0
    .long 89088,7556928,102912,7728960,143232,2130706432,143232,2130706432,143232,2130706432,7514112,7600128,7686144,7772160,7256064,0
    .long 92544,7599936,106368,7771968,143232,2130706432,143232,2130706432,143232,2130706432,7514112,7600128,7686144,7772160,7256064,0
    .long 96000,7642944,109824,7814976,143232,2130706432,143232,2130706432,143232,2130706432,7557120,7643136,7729152,7815168,7385088,0
    .long 99456,7685952,113280,7857984,143232,2130706432,143232,2130706432,143232,2130706432,7557120,7643136,7729152,7815168,7385088,0
    .long 85632,226495872,1,39136,92544,226495872,1,39584,99456,226495872,1,40032,106368,226495872,1,40480
    .long 89088,226495872,1,39360,96000,226495872,1,39808,102912,226495872,1,40256,109824,226495872,1,40704
    .long 3090240,17,5472,5508,199008,199044,8064,54,151,1,151,4,9600,89088,50,1065370392
    .long 146688,43008,17,587520,216,1048592000,4032,3,16320,3391296,0,0,0,0,0,0
    .long 89088,28992,92160,717120,95232,1405248,143232,2130706432,143232,2130706432,29184,717312,1405440,1405440,3133440,0
    .long 98688,29184,101760,717312,104832,1405440,143232,2130706432,143232,2130706432,29184,717312,1405440,1405440,3133440,0
    .long 108288,29376,111360,717504,114432,1405632,143232,2130706432,143232,2130706432,29376,717504,1405632,1405632,3262464,0
    .long 117888,29568,120960,717696,124032,1405824,143232,2130706432,143232,2130706432,29376,717504,1405632,1405632,3262464,0
    .long 98688,629155200,0,152,98688,629155200,16,3736,98688,629155200,32,7320,98688,629155200,32,7320
    .long 108288,629155200,0,153,108288,629155200,16,3737,108288,629155200,32,7321,108288,629155200,32,7321
    .long 5157696,16,7488,7524,201024,201060,8064,54,207,1,207,4,9600,89088,50,1065370448
    .long 146688,43008,17,975168,216,1048592000,4032,3,27088,5458752,0,0,0,0,0,0
    .long 89088,39744,92160,727872,95232,1416000,143232,2130706432,143232,2130706432,39936,728064,1416192,1416192,5200896,0
    .long 98688,39936,101760,728064,104832,1416192,143232,2130706432,143232,2130706432,39936,728064,1416192,1416192,5200896,0
    .long 108288,40128,111360,728256,114432,1416384,143232,2130706432,143232,2130706432,40128,728256,1416384,1416384,5329920,0
    .long 117888,40320,120960,728448,124032,1416576,143232,2130706432,143232,2130706432,40128,728256,1416384,1416384,5329920,0
    .long 98688,629155200,0,208,98688,629155200,16,3792,98688,629155200,32,7376,98688,629155200,32,7376
    .long 108288,629155200,0,209,108288,629155200,16,3793,108288,629155200,32,7377,108288,629155200,32,7377
    .long 3323712,17,467712,475776,468576,476640,36,54,57,0,57,4,9600,89088,50,1065370216
    .long 146688,192,17,631296,216,1040203392,4032,3,17536,3624768,0,0,0,0,0,0
    .long 89088,2451456,92160,2454528,95232,2457600,143232,2130706432,143232,2130706432,2494464,2497536,2500608,2500608,3366912,0
    .long 98688,2494464,101760,2497536,104832,2500608,143232,2130706432,143232,2130706432,2494464,2497536,2500608,2500608,3366912,0
    .long 108288,2537472,111360,2540544,114432,2543616,143232,2130706432,143232,2130706432,2537472,2540544,2543616,2543616,3495936,0
    .long 117888,2580480,120960,2583552,124032,2586624,143232,2130706432,143232,2130706432,2537472,2540544,2543616,2543616,3495936,0
    .long 98688,629155200,0,12992,98688,629155200,16,13008,98688,629155200,32,13024,98688,629155200,32,13024
    .long 108288,629155200,0,13216,108288,629155200,16,13232,108288,629155200,32,13248,108288,629155200,32,13248
    .long 5391168,17,854784,862848,855648,863712,36,54,105,0,105,4,9600,89088,50,1065370324
    .long 146688,192,17,1018944,216,1048592000,4032,3,28304,5692224,0,0,0,0,0,0
    .long 89088,4515840,92160,4518912,95232,4521984,143232,2130706432,143232,2130706432,4558848,4561920,4564992,4564992,5434368,0
    .long 98688,4558848,101760,4561920,104832,4564992,143232,2130706432,143232,2130706432,4558848,4561920,4564992,4564992,5434368,0
    .long 108288,4601856,111360,4604928,114432,4608000,143232,2130706432,143232,2130706432,4601856,4604928,4608000,4608000,5563392,0
    .long 117888,4644864,120960,4647936,124032,4651008,143232,2130706432,143232,2130706432,4601856,4604928,4608000,4608000,5563392,0
    .long 98688,629155200,0,23744,98688,629155200,16,23760,98688,629155200,32,23776,98688,629155200,32,23776
    .long 108288,629155200,0,23968,108288,629155200,16,23984,108288,629155200,32,24000,108288,629155200,32,24000
    .long 7802688,17,2130706432,2130706432,2130706432,2130706432,36,0,0,0,0,0,0,116736,0,0
    .long 0,192,17,1471104,504,1048592000,0,4,40864,8103744,0,0,0,0,0,0
    .long 89088,8146752,102912,8318784,143232,2130706432,143232,2130706432,143232,2130706432,8103936,8189952,8275968,8361984,7845888,0
    .long 92544,8189760,106368,8361792,143232,2130706432,143232,2130706432,143232,2130706432,8103936,8189952,8275968,8361984,7845888,0
    .long 96000,8232768,109824,8404800,143232,2130706432,143232,2130706432,143232,2130706432,8146944,8232960,8318976,8404992,7974912,0
    .long 99456,8275776,113280,8447808,143232,2130706432,143232,2130706432,143232,2130706432,8146944,8232960,8318976,8404992,7974912,0
    .long 85632,226495872,1,42208,92544,226495872,1,42656,99456,226495872,1,43104,106368,226495872,1,43552
    .long 89088,226495872,1,42432,96000,226495872,1,42880,102912,226495872,1,43328,109824,226495872,1,43776
    .long 3336000,17,1628928,1636992,1629792,1637856,36,54,201,0,201,4,9600,89088,50,1065370442
    .long 146688,192,17,633600,216,1048592000,4032,3,17600,3637056,0,0,0,0,0,0
    .long 89088,8644608,92160,8647680,95232,8650752,143232,2130706432,143232,2130706432,8687616,8690688,8693760,8693760,3379200,0
    .long 98688,8687616,101760,8690688,104832,8693760,143232,2130706432,143232,2130706432,8687616,8690688,8693760,8693760,3379200,0
    .long 108288,8730624,111360,8733696,114432,8736768,143232,2130706432,143232,2130706432,8730624,8733696,8736768,8736768,3508224,0
    .long 117888,8773632,120960,8776704,124032,8779776,143232,2130706432,143232,2130706432,8730624,8733696,8736768,8736768,3508224,0
    .long 98688,629155200,0,45248,98688,629155200,16,45264,98688,629155200,32,45280,98688,629155200,32,45280
    .long 108288,629155200,0,45472,108288,629155200,16,45488,108288,629155200,32,45504,108288,629155200,32,45504
    .long 5403456,17,1800,1836,195336,195372,8064,54,49,1,49,4,9600,89088,50,1065370184
    .long 146688,43008,17,1021248,216,1048592000,4032,3,28368,5704512,0,0,0,0,0,0
    .long 89088,9408,92160,697536,95232,1385664,143232,2130706432,143232,2130706432,9600,697728,1385856,1385856,5446656,0
    .long 98688,9600,101760,697728,104832,1385856,143232,2130706432,143232,2130706432,9600,697728,1385856,1385856,5446656,0
    .long 108288,9792,111360,697920,114432,1386048,143232,2130706432,143232,2130706432,9792,697920,1386048,1386048,5575680,0
    .long 117888,9984,120960,698112,124032,1386240,143232,2130706432,143232,2130706432,9792,697920,1386048,1386048,5575680,0
    .long 98688,629155200,0,50,98688,629155200,16,3634,98688,629155200,32,7218,98688,629155200,32,7218
    .long 108288,629155200,0,51,108288,629155200,16,3635,108288,629155200,32,7219,108288,629155200,32,7219
    .long 7814976,17,2130706432,2130706432,2130706432,2130706432,36,0,0,0,0,0,0,116736,0,0
    .long 0,192,17,1473408,504,1048592000,0,4,40928,8116032,0,0,0,0,0,0
    .long 89088,8159040,102912,8331072,143232,2130706432,143232,2130706432,143232,2130706432,8116224,8202240,8288256,8374272,7858176,0
    .long 92544,8202048,106368,8374080,143232,2130706432,143232,2130706432,143232,2130706432,8116224,8202240,8288256,8374272,7858176,0
    .long 96000,8245056,109824,8417088,143232,2130706432,143232,2130706432,143232,2130706432,8159232,8245248,8331264,8417280,7987200,0
    .long 99456,8288064,113280,8460096,143232,2130706432,143232,2130706432,143232,2130706432,8159232,8245248,8331264,8417280,7987200,0
    .long 85632,226495872,1,42272,92544,226495872,1,42720,99456,226495872,1,43168,106368,226495872,1,43616
    .long 89088,226495872,1,42496,96000,226495872,1,42944,102912,226495872,1,43392,109824,226495872,1,43840
    .long 3348288,17,5544,5580,199080,199116,8064,54,153,1,153,4,9600,89088,50,1065370394
    .long 146688,43008,17,635904,216,1048592000,4032,3,17664,3649344,0,0,0,0,0,0
    .long 89088,29376,92160,717504,95232,1405632,143232,2130706432,143232,2130706432,29568,717696,1405824,1405824,3391488,0
    .long 98688,29568,101760,717696,104832,1405824,143232,2130706432,143232,2130706432,29568,717696,1405824,1405824,3391488,0
    .long 108288,29760,111360,717888,114432,1406016,143232,2130706432,143232,2130706432,29760,717888,1406016,1406016,3520512,0
    .long 117888,29952,120960,718080,124032,1406208,143232,2130706432,143232,2130706432,29760,717888,1406016,1406016,3520512,0
    .long 98688,629155200,0,154,98688,629155200,16,3738,98688,629155200,32,7322,98688,629155200,32,7322
    .long 108288,629155200,0,155,108288,629155200,16,3739,108288,629155200,32,7323,108288,629155200,32,7323
    .long 5415744,16,7560,7596,201096,201132,8064,54,209,1,209,4,9600,89088,50,1065370450
    .long 146688,43008,17,1023552,216,1048592000,4032,3,28432,5716800,0,0,0,0,0,0
    .long 89088,40128,92160,728256,95232,1416384,143232,2130706432,143232,2130706432,40320,728448,1416576,1416576,5458944,0
    .long 98688,40320,101760,728448,104832,1416576,143232,2130706432,143232,2130706432,40320,728448,1416576,1416576,5458944,0
    .long 108288,40512,111360,728640,114432,1416768,143232,2130706432,143232,2130706432,40512,728640,1416768,1416768,5587968,0
    .long 117888,40704,120960,728832,124032,1416960,143232,2130706432,143232,2130706432,40512,728640,1416768,1416768,5587968,0
    .long 98688,629155200,0,210,98688,629155200,16,3794,98688,629155200,32,7378,98688,629155200,32,7378
    .long 108288,629155200,0,211,108288,629155200,16,3795,108288,629155200,32,7379,108288,629155200,32,7379
    .long 3581760,17,483840,491904,484704,492768,36,54,59,0,59,4,9600,89088,50,1065370224
    .long 146688,192,17,679680,216,1040203392,4032,3,18880,3882816,0,0,0,0,0,0
    .long 89088,2537472,92160,2540544,95232,2543616,143232,2130706432,143232,2130706432,2580480,2583552,2586624,2586624,3624960,0
    .long 98688,2580480,101760,2583552,104832,2586624,143232,2130706432,143232,2130706432,2580480,2583552,2586624,2586624,3624960,0
    .long 108288,2623488,111360,2626560,114432,2629632,143232,2130706432,143232,2130706432,2623488,2626560,2629632,2629632,3753984,0
    .long 117888,2666496,120960,2669568,124032,2672640,143232,2130706432,143232,2130706432,2623488,2626560,2629632,2629632,3753984,0
    .long 98688,629155200,0,13440,98688,629155200,16,13456,98688,629155200,32,13472,98688,629155200,32,13472
    .long 108288,629155200,0,13664,108288,629155200,16,13680,108288,629155200,32,13696,108288,629155200,32,13696
    .long 5649216,17,870912,878976,871776,879840,36,54,107,0,107,4,9600,89088,50,1065370328
    .long 146688,192,17,1067328,216,1048592000,4032,3,29648,5950272,0,0,0,0,0,0
    .long 89088,4601856,92160,4604928,95232,4608000,143232,2130706432,143232,2130706432,4644864,4647936,4651008,4651008,5692416,0
    .long 98688,4644864,101760,4647936,104832,4651008,143232,2130706432,143232,2130706432,4644864,4647936,4651008,4651008,5692416,0
    .long 108288,4687872,111360,4690944,114432,4694016,143232,2130706432,143232,2130706432,4687872,4690944,4694016,4694016,5821440,0
    .long 117888,4730880,120960,4733952,124032,4737024,143232,2130706432,143232,2130706432,4687872,4690944,4694016,4694016,5821440,0
    .long 98688,629155200,0,24192,98688,629155200,16,24208,98688,629155200,32,24224,98688,629155200,32,24224
    .long 108288,629155200,0,24416,108288,629155200,16,24432,108288,629155200,32,24448,108288,629155200,32,24448
    .long 8404800,17,2130706432,2130706432,2130706432,2130706432,36,0,0,0,0,0,0,116736,0,0
    .long 0,192,17,1584000,504,1048592000,0,4,44000,8705856,0,0,0,0,0,0
    .long 89088,8748864,102912,8920896,143232,2130706432,143232,2130706432,143232,2130706432,8706048,8792064,8878080,8964096,8448000,0
    .long 92544,8791872,106368,8963904,143232,2130706432,143232,2130706432,143232,2130706432,8706048,8792064,8878080,8964096,8448000,0
    .long 96000,8834880,109824,9006912,143232,2130706432,143232,2130706432,143232,2130706432,8749056,8835072,8921088,9007104,8577024,0
    .long 99456,8877888,113280,9049920,143232,2130706432,143232,2130706432,143232,2130706432,8749056,8835072,8921088,9007104,8577024,0
    .long 85632,226495872,1,45344,92544,226495872,1,45792,99456,226495872,1,46240,106368,226495872,1,46688
    .long 89088,226495872,1,45568,96000,226495872,1,46016,102912,226495872,1,46464,109824,226495872,1,46912
    .long 3594048,17,1645056,1653120,1645920,1653984,36,54,203,0,203,4,9600,89088,50,1065370444
    .long 146688,192,17,681984,216,1048592000,4032,3,18944,3895104,0,0,0,0,0,0
    .long 89088,8730624,92160,8733696,95232,8736768,143232,2130706432,143232,2130706432,8773632,8776704,8779776,8779776,3637248,0
    .long 98688,8773632,101760,8776704,104832,8779776,143232,2130706432,143232,2130706432,8773632,8776704,8779776,8779776,3637248,0
    .long 108288,8816640,111360,8819712,114432,8822784,143232,2130706432,143232,2130706432,8816640,8819712,8822784,8822784,3766272,0
    .long 117888,8859648,120960,8862720,124032,8865792,143232,2130706432,143232,2130706432,8816640,8819712,8822784,8822784,3766272,0
    .long 98688,629155200,0,45696,98688,629155200,16,45712,98688,629155200,32,45728,98688,629155200,32,45728
    .long 108288,629155200,0,45920,108288,629155200,16,45936,108288,629155200,32,45952,108288,629155200,32,45952
    .long 5661504,17,1872,1908,195408,195444,8064,54,51,1,51,4,9600,89088,50,1065370192
    .long 146688,43008,17,1069632,216,1048592000,4032,3,29712,5962560,0,0,0,0,0,0
    .long 89088,9792,92160,697920,95232,1386048,143232,2130706432,143232,2130706432,9984,698112,1386240,1386240,5704704,0
    .long 98688,9984,101760,698112,104832,1386240,143232,2130706432,143232,2130706432,9984,698112,1386240,1386240,5704704,0
    .long 108288,10176,111360,698304,114432,1386432,143232,2130706432,143232,2130706432,10176,698304,1386432,1386432,5833728,0
    .long 117888,10368,120960,698496,124032,1386624,143232,2130706432,143232,2130706432,10176,698304,1386432,1386432,5833728,0
    .long 98688,629155200,0,52,98688,629155200,16,3636,98688,629155200,32,7220,98688,629155200,32,7220
    .long 108288,629155200,0,53,108288,629155200,16,3637,108288,629155200,32,7221,108288,629155200,32,7221
    .long 8417088,17,2130706432,2130706432,2130706432,2130706432,36,0,0,0,0,0,0,116736,0,0
    .long 0,192,17,1586304,504,1048592000,0,4,44064,8718144,0,0,0,0,0,0
    .long 89088,8761152,102912,8933184,143232,2130706432,143232,2130706432,143232,2130706432,8718336,8804352,8890368,8976384,8460288,0
    .long 92544,8804160,106368,8976192,143232,2130706432,143232,2130706432,143232,2130706432,8718336,8804352,8890368,8976384,8460288,0
    .long 96000,8847168,109824,9019200,143232,2130706432,143232,2130706432,143232,2130706432,8761344,8847360,8933376,9019392,8589312,0
    .long 99456,8890176,113280,9062208,143232,2130706432,143232,2130706432,143232,2130706432,8761344,8847360,8933376,9019392,8589312,0
    .long 85632,226495872,1,45408,92544,226495872,1,45856,99456,226495872,1,46304,106368,226495872,1,46752
    .long 89088,226495872,1,45632,96000,226495872,1,46080,102912,226495872,1,46528,109824,226495872,1,46976
    .long 3606336,17,5616,5652,199152,199188,8064,54,155,1,155,4,9600,89088,50,1065370396
    .long 146688,43008,17,684288,216,1048592000,4032,3,19008,3907392,0,0,0,0,0,0
    .long 89088,29760,92160,717888,95232,1406016,143232,2130706432,143232,2130706432,29952,718080,1406208,1406208,3649536,0
    .long 98688,29952,101760,718080,104832,1406208,143232,2130706432,143232,2130706432,29952,718080,1406208,1406208,3649536,0
    .long 108288,30144,111360,718272,114432,1406400,143232,2130706432,143232,2130706432,30144,718272,1406400,1406400,3778560,0
    .long 117888,30336,120960,718464,124032,1406592,143232,2130706432,143232,2130706432,30144,718272,1406400,1406400,3778560,0
    .long 98688,629155200,0,156,98688,629155200,16,3740,98688,629155200,32,7324,98688,629155200,32,7324
    .long 108288,629155200,0,157,108288,629155200,16,3741,108288,629155200,32,7325,108288,629155200,32,7325
    .long 5673792,16,7632,7668,201168,201204,8064,54,211,1,211,4,9600,89088,50,1065370452
    .long 146688,43008,17,1071936,216,1048592000,4032,3,29776,5974848,0,0,0,0,0,0
    .long 89088,40512,92160,728640,95232,1416768,143232,2130706432,143232,2130706432,40704,728832,1416960,1416960,5716992,0
    .long 98688,40704,101760,728832,104832,1416960,143232,2130706432,143232,2130706432,40704,728832,1416960,1416960,5716992,0
    .long 108288,40896,111360,729024,114432,1417152,143232,2130706432,143232,2130706432,40896,729024,1417152,1417152,5846016,0
    .long 117888,41088,120960,729216,124032,1417344,143232,2130706432,143232,2130706432,40896,729024,1417152,1417152,5846016,0
    .long 98688,629155200,0,212,98688,629155200,16,3796,98688,629155200,32,7380,98688,629155200,32,7380
    .long 108288,629155200,0,213,108288,629155200,16,3797,108288,629155200,32,7381,108288,629155200,32,7381
    .long 3839808,17,499968,508032,500832,508896,36,54,61,0,61,4,9600,89088,50,1065370232
    .long 146688,192,17,728064,216,1040203392,4032,3,20224,4140864,0,0,0,0,0,0
    .long 89088,2623488,92160,2626560,95232,2629632,143232,2130706432,143232,2130706432,2666496,2669568,2672640,2672640,3883008,0
    .long 98688,2666496,101760,2669568,104832,2672640,143232,2130706432,143232,2130706432,2666496,2669568,2672640,2672640,3883008,0
    .long 108288,2709504,111360,2712576,114432,2715648,143232,2130706432,143232,2130706432,2709504,2712576,2715648,2715648,4012032,0
    .long 117888,2752512,120960,2755584,124032,2758656,143232,2130706432,143232,2130706432,2709504,2712576,2715648,2715648,4012032,0
    .long 98688,629155200,0,13888,98688,629155200,16,13904,98688,629155200,32,13920,98688,629155200,32,13920
    .long 108288,629155200,0,14112,108288,629155200,16,14128,108288,629155200,32,14144,108288,629155200,32,14144
    .long 5907264,17,887040,895104,887904,895968,36,54,109,0,109,4,9600,89088,50,1065370332
    .long 146688,192,17,1115712,216,1048592000,4032,3,30992,6208320,0,0,0,0,0,0
    .long 89088,4687872,92160,4690944,95232,4694016,143232,2130706432,143232,2130706432,4730880,4733952,4737024,4737024,5950464,0
    .long 98688,4730880,101760,4733952,104832,4737024,143232,2130706432,143232,2130706432,4730880,4733952,4737024,4737024,5950464,0
    .long 108288,4773888,111360,4776960,114432,4780032,143232,2130706432,143232,2130706432,4773888,4776960,4780032,4780032,6079488,0
    .long 117888,4816896,120960,4819968,124032,4823040,143232,2130706432,143232,2130706432,4773888,4776960,4780032,4780032,6079488,0
    .long 98688,629155200,0,24640,98688,629155200,16,24656,98688,629155200,32,24672,98688,629155200,32,24672
    .long 108288,629155200,0,24864,108288,629155200,16,24880,108288,629155200,32,24896,108288,629155200,32,24896
    .long 9006912,17,2130706432,2130706432,2130706432,2130706432,36,0,0,0,0,0,0,116736,0,0
    .long 0,192,17,1696896,504,1048592000,0,4,47136,9307968,0,0,0,0,0,0
    .long 89088,9350976,102912,9523008,143232,2130706432,143232,2130706432,143232,2130706432,9308160,9394176,9480192,9566208,9050112,0
    .long 92544,9393984,106368,9566016,143232,2130706432,143232,2130706432,143232,2130706432,9308160,9394176,9480192,9566208,9050112,0
    .long 96000,9436992,109824,9609024,143232,2130706432,143232,2130706432,143232,2130706432,9351168,9437184,9523200,9609216,9179136,0
    .long 99456,9480000,113280,9609024,143232,2130706432,143232,2130706432,143232,2130706432,9351168,9437184,9523200,9609216,9179136,0
    .long 85632,226495872,1,48480,92544,226495872,1,48928,99456,226495872,1,49376,106368,226495872,1,49824
    .long 89088,226495872,1,48704,96000,226495872,1,49152,102912,226495872,1,49600,109824,226495872,1,50048
    .long 3852096,17,1661184,1669248,1662048,1670112,36,54,205,0,205,4,9600,89088,50,1065370446
    .long 146688,192,17,730368,216,1048592000,4032,3,20288,4153152,0,0,0,0,0,0
    .long 89088,8816640,92160,8819712,95232,8822784,143232,2130706432,143232,2130706432,8859648,8862720,8865792,8865792,3895296,0
    .long 98688,8859648,101760,8862720,104832,8865792,143232,2130706432,143232,2130706432,8859648,8862720,8865792,8865792,3895296,0
    .long 108288,8902656,111360,8905728,114432,8908800,143232,2130706432,143232,2130706432,8902656,8905728,8908800,8908800,4024320,0
    .long 117888,8945664,120960,8948736,124032,8951808,143232,2130706432,143232,2130706432,8902656,8905728,8908800,8908800,4024320,0
    .long 98688,629155200,0,46144,98688,629155200,16,46160,98688,629155200,32,46176,98688,629155200,32,46176
    .long 108288,629155200,0,46368,108288,629155200,16,46384,108288,629155200,32,46400,108288,629155200,32,46400
    .long 5919552,17,1944,1980,195480,195516,8064,54,53,1,53,4,9600,89088,50,1065370200
    .long 146688,43008,17,1118016,216,1048592000,4032,3,31056,6220608,0,0,0,0,0,0
    .long 89088,10176,92160,698304,95232,1386432,143232,2130706432,143232,2130706432,10368,698496,1386624,1386624,5962752,0
    .long 98688,10368,101760,698496,104832,1386624,143232,2130706432,143232,2130706432,10368,698496,1386624,1386624,5962752,0
    .long 108288,10560,111360,698688,114432,1386816,143232,2130706432,143232,2130706432,10560,698688,1386816,1386816,6091776,0
    .long 117888,10752,120960,698880,124032,1387008,143232,2130706432,143232,2130706432,10560,698688,1386816,1386816,6091776,0
    .long 98688,629155200,0,54,98688,629155200,16,3638,98688,629155200,32,7222,98688,629155200,32,7222
    .long 108288,629155200,0,55,108288,629155200,16,3639,108288,629155200,32,7223,108288,629155200,32,7223
    .long 9019200,17,2130706432,2130706432,2130706432,2130706432,36,0,0,0,0,0,0,116736,0,0
    .long 0,192,17,1699200,504,1048592000,0,4,47200,9320256,0,0,0,0,0,0
    .long 89088,9363264,102912,9535296,143232,2130706432,143232,2130706432,143232,2130706432,9320448,9406464,9492480,9578496,9062400,0
    .long 92544,9406272,106368,9578304,143232,2130706432,143232,2130706432,143232,2130706432,9320448,9406464,9492480,9578496,9062400,0
    .long 96000,9449280,109824,9621312,143232,2130706432,143232,2130706432,143232,2130706432,9363456,9449472,9535488,9621504,9191424,0
    .long 99456,9492288,113280,9621312,143232,2130706432,143232,2130706432,143232,2130706432,9363456,9449472,9535488,9621504,9191424,0
    .long 85632,226495872,1,48544,92544,226495872,1,48992,99456,226495872,1,49440,106368,226495872,1,49888
    .long 89088,226495872,1,48768,96000,226495872,1,49216,102912,226495872,1,49664,109824,226495872,1,50112
    .long 3864384,17,5688,5724,199224,199260,8064,54,157,1,157,4,9600,89088,50,1065370398
    .long 146688,43008,17,732672,216,1048592000,4032,3,20352,4165440,0,0,0,0,0,0
    .long 89088,30144,92160,718272,95232,1406400,143232,2130706432,143232,2130706432,30336,718464,1406592,1406592,3907584,0
    .long 98688,30336,101760,718464,104832,1406592,143232,2130706432,143232,2130706432,30336,718464,1406592,1406592,3907584,0
    .long 108288,30528,111360,718656,114432,1406784,143232,2130706432,143232,2130706432,30528,718656,1406784,1406784,4036608,0
    .long 117888,30720,120960,718848,124032,1406976,143232,2130706432,143232,2130706432,30528,718656,1406784,1406784,4036608,0
    .long 98688,629155200,0,158,98688,629155200,16,3742,98688,629155200,32,7326,98688,629155200,32,7326
    .long 108288,629155200,0,159,108288,629155200,16,3743,108288,629155200,32,7327,108288,629155200,32,7327
    .long 5931840,16,7704,7740,201240,201276,8064,54,213,1,213,4,9600,89088,50,1065370454
    .long 146688,43008,17,1120320,216,1048592000,4032,3,31120,6232896,0,0,0,0,0,0
    .long 89088,40896,92160,729024,95232,1417152,143232,2130706432,143232,2130706432,41088,729216,1417344,1417344,5975040,0
    .long 98688,41088,101760,729216,104832,1417344,143232,2130706432,143232,2130706432,41088,729216,1417344,1417344,5975040,0
    .long 108288,41280,111360,729408,114432,1417536,143232,2130706432,143232,2130706432,41280,729408,1417536,1417536,6104064,0
    .long 117888,41472,120960,729600,124032,1417728,143232,2130706432,143232,2130706432,41280,729408,1417536,1417536,6104064,0
    .long 98688,629155200,0,214,98688,629155200,16,3798,98688,629155200,32,7382,98688,629155200,32,7382
    .long 108288,629155200,0,215,108288,629155200,16,3799,108288,629155200,32,7383,108288,629155200,32,7383
    .long 4097856,17,516096,524160,516960,525024,36,54,63,0,63,4,9600,89088,50,1065370240
    .long 146688,192,17,776448,216,1040203392,4032,3,21568,4398912,0,0,0,0,0,0
    .long 89088,2709504,92160,2712576,95232,2715648,143232,2130706432,143232,2130706432,2752512,2755584,2758656,2758656,4141056,0
    .long 98688,2752512,101760,2755584,104832,2758656,143232,2130706432,143232,2130706432,2752512,2755584,2758656,2758656,4141056,0
    .long 108288,2795520,111360,2798592,114432,2801664,143232,2130706432,143232,2130706432,2795520,2798592,2801664,2801664,4270080,0
    .long 117888,2838528,120960,2841600,124032,2844672,143232,2130706432,143232,2130706432,2795520,2798592,2801664,2801664,4270080,0
    .long 98688,629155200,0,14336,98688,629155200,16,14352,98688,629155200,32,14368,98688,629155200,32,14368
    .long 108288,629155200,0,14560,108288,629155200,16,14576,108288,629155200,32,14592,108288,629155200,32,14592
    .long 6165312,17,258048,266112,2130706432,2130706432,36,36,31,0,30,6,3456,102912,18,1065370112
    .long 148224,192,17,1164096,360,1048592000,3072,3,32336,6466368,0,0,0,0,0,0
    .long 89088,6509376,102912,1290240,116736,1462272,143232,2130706432,143232,2130706432,6466560,6552576,1376256,1376256,6208512,0
    .long 92544,6552384,106368,1333248,120192,1505280,143232,2130706432,143232,2130706432,6466560,6552576,1376256,1376256,6208512,0
    .long 96000,6595392,109824,1376256,143232,2130706432,143232,2130706432,143232,2130706432,6509568,6595584,1419264,1419264,6337536,0
    .long 99456,6638400,113280,1419264,143232,2130706432,143232,2130706432,143232,2130706432,6509568,6595584,1419264,1419264,6337536,0
    .long 85632,226495872,1,33680,92544,226495872,1,34128,109824,226495872,0,7168,109824,226495872,0,7168
    .long 89088,226495872,1,33904,96000,226495872,1,34352,113280,226495872,0,7392,113280,226495872,0,7392
    .long 2042688,17,1225728,1233792,1226592,1234656,36,54,151,0,151,4,9600,89088,50,1065370392
    .long 146688,192,17,391104,216,1048591872,4032,3,10864,2343744,0,0,0,0,0,0
    .long 89088,6494208,92160,6497280,95232,6500352,143232,2130706432,143232,2130706432,6537216,6540288,6543360,6543360,2085888,0
    .long 98688,6537216,101760,6540288,104832,6543360,143232,2130706432,143232,2130706432,6537216,6540288,6543360,6543360,2085888,0
    .long 108288,6580224,111360,6583296,114432,6586368,143232,2130706432,143232,2130706432,6580224,6583296,6586368,6586368,2214912,0
    .long 117888,6623232,120960,6626304,124032,6629376,143232,2130706432,143232,2130706432,6580224,6583296,6586368,6586368,2214912,0
    .long 98688,629155200,0,34048,98688,629155200,16,34064,98688,629155200,32,34080,98688,629155200,32,34080
    .long 108288,629155200,0,34272,108288,629155200,16,34288,108288,629155200,32,34304,108288,629155200,32,34304
    .long 4110144,17,1677312,1685376,1678176,1686240,36,54,207,0,207,4,9600,89088,50,1065370448
    .long 146688,192,17,778752,216,1048592000,4032,3,21632,4411200,0,0,0,0,0,0
    .long 89088,8902656,92160,8905728,95232,8908800,143232,2130706432,143232,2130706432,8945664,8948736,8951808,8951808,4153344,0
    .long 98688,8945664,101760,8948736,104832,8951808,143232,2130706432,143232,2130706432,8945664,8948736,8951808,8951808,4153344,0
    .long 108288,8988672,111360,8991744,114432,8994816,143232,2130706432,143232,2130706432,8988672,8991744,8994816,8994816,4282368,0
    .long 117888,9031680,120960,9034752,124032,9037824,143232,2130706432,143232,2130706432,8988672,8991744,8994816,8994816,4282368,0
    .long 98688,629155200,0,46592,98688,629155200,16,46608,98688,629155200,32,46624,98688,629155200,32,46624
    .long 108288,629155200,0,46816,108288,629155200,16,46832,108288,629155200,32,46848,108288,629155200,32,46848
    .long 6177600,17,2016,2052,195552,195588,8064,54,55,1,55,4,9600,89088,50,1065370208
    .long 146688,43008,17,1166400,216,1048592000,4032,3,32400,6478656,0,0,0,0,0,0
    .long 89088,10560,92160,698688,95232,1386816,143232,2130706432,143232,2130706432,10752,698880,1387008,1387008,6220800,0
    .long 98688,10752,101760,698880,104832,1387008,143232,2130706432,143232,2130706432,10752,698880,1387008,1387008,6220800,0
    .long 108288,10944,111360,699072,114432,1387200,143232,2130706432,143232,2130706432,10944,699072,1387200,1387200,6349824,0
    .long 117888,11136,120960,699264,124032,1387392,143232,2130706432,143232,2130706432,10944,699072,1387200,1387200,6349824,0
    .long 98688,629155200,0,56,98688,629155200,16,3640,98688,629155200,32,7224,98688,629155200,32,7224
    .long 108288,629155200,0,57,108288,629155200,16,3641,108288,629155200,32,7225,108288,629155200,32,7225
    .long 2054976,17,3744,3780,197280,197316,8064,54,103,1,103,4,9600,89088,50,1065370320
    .long 146688,43008,17,393408,216,1048591872,4032,3,10928,2356032,0,0,0,0,0,0
    .long 89088,19776,92160,707904,95232,1396032,143232,2130706432,143232,2130706432,19968,708096,1396224,1396224,2098176,0
    .long 98688,19968,101760,708096,104832,1396224,143232,2130706432,143232,2130706432,19968,708096,1396224,1396224,2098176,0
    .long 108288,20160,111360,708288,114432,1396416,143232,2130706432,143232,2130706432,20160,708288,1396416,1396416,2227200,0
    .long 117888,20352,120960,708480,124032,1396608,143232,2130706432,143232,2130706432,20160,708288,1396416,1396416,2227200,0
    .long 98688,629155200,0,104,98688,629155200,16,3688,98688,629155200,32,7272,98688,629155200,32,7272
    .long 108288,629155200,0,105,108288,629155200,16,3689,108288,629155200,32,7273,108288,629155200,32,7273
    .long 4122432,17,5760,5796,199296,199332,8064,54,159,1,159,4,9600,89088,50,1065370400
    .long 146688,43008,17,781056,216,1048592000,4032,3,21696,4423488,0,0,0,0,0,0
    .long 89088,30528,92160,718656,95232,1406784,143232,2130706432,143232,2130706432,30720,718848,1406976,1406976,4165632,0
    .long 98688,30720,101760,718848,104832,1406976,143232,2130706432,143232,2130706432,30720,718848,1406976,1406976,4165632,0
    .long 108288,30912,111360,719040,114432,1407168,143232,2130706432,143232,2130706432,30912,719040,1407168,1407168,4294656,0
    .long 117888,31104,120960,719232,124032,1407360,143232,2130706432,143232,2130706432,30912,719040,1407168,1407168,4294656,0
    .long 98688,629155200,0,160,98688,629155200,16,3744,98688,629155200,32,7328,98688,629155200,32,7328
    .long 108288,629155200,0,161,108288,629155200,16,3745,108288,629155200,32,7329,108288,629155200,32,7329
    .long 6189888,16,7776,7812,201312,201348,8064,54,215,1,215,4,9600,89088,50,1065370456
    .long 146688,43008,17,1168704,216,1048592000,4032,3,32464,6490944,0,0,0,0,0,0
    .long 89088,41280,92160,729408,95232,1417536,143232,2130706432,143232,2130706432,41472,729600,1417728,1417728,6233088,0
    .long 98688,41472,101760,729600,104832,1417728,143232,2130706432,143232,2130706432,41472,729600,1417728,1417728,6233088,0
    .long 108288,41664,111360,729792,114432,1417920,143232,2130706432,143232,2130706432,41664,729792,1417920,1417920,6362112,0
    .long 117888,41856,120960,729984,124032,1418112,143232,2130706432,143232,2130706432,41664,729792,1417920,1417920,6362112,0
    .long 98688,629155200,0,216,98688,629155200,16,3800,98688,629155200,32,7384,98688,629155200,32,7384
    .long 108288,629155200,0,217,108288,629155200,16,3801,108288,629155200,32,7385,108288,629155200,32,7385
    .long 4355904,17,532224,540288,533088,541152,36,54,65,0,65,4,9600,89088,50,1065370244
    .long 146688,192,17,824832,216,1040203392,4032,3,22912,4656960,0,0,0,0,0,0
    .long 89088,2795520,92160,2798592,95232,2801664,143232,2130706432,143232,2130706432,2838528,2841600,2844672,2844672,4399104,0
    .long 98688,2838528,101760,2841600,104832,2844672,143232,2130706432,143232,2130706432,2838528,2841600,2844672,2844672,4399104,0
    .long 108288,2881536,111360,2884608,114432,2887680,143232,2130706432,143232,2130706432,2881536,2884608,2887680,2887680,4528128,0
    .long 117888,2924544,120960,2927616,124032,2930688,143232,2130706432,143232,2130706432,2881536,2884608,2887680,2887680,4528128,0
    .long 98688,629155200,0,14784,98688,629155200,16,14800,98688,629155200,32,14816,98688,629155200,32,14816
    .long 108288,629155200,0,15008,108288,629155200,16,15024,108288,629155200,32,15040,108288,629155200,32,15040
    .long 6595392,17,274176,282240,2130706432,2130706432,36,36,33,0,32,6,3456,102912,18,1065370120
    .long 148224,192,17,1244736,360,1048592000,3072,3,34576,6896448,0,0,0,0,0,0
    .long 89088,6939456,102912,1376256,116736,1548288,143232,2130706432,143232,2130706432,6896640,6982656,1462272,1462272,6638592,0
    .long 92544,6982464,106368,1419264,120192,1591296,143232,2130706432,143232,2130706432,6896640,6982656,1462272,1462272,6638592,0
    .long 96000,7025472,109824,1462272,143232,2130706432,143232,2130706432,143232,2130706432,6939648,7025664,1505280,1505280,6767616,0
    .long 99456,7068480,113280,1505280,143232,2130706432,143232,2130706432,143232,2130706432,6939648,7025664,1505280,1505280,6767616,0
    .long 85632,226495872,1,35920,92544,226495872,1,36368,109824,226495872,0,7616,109824,226495872,0,7616
    .long 89088,226495872,1,36144,96000,226495872,1,36592,113280,226495872,0,7840,113280,226495872,0,7840
    .long 2300736,17,1241856,1249920,1242720,1250784,36,54,153,0,153,4,9600,89088,50,1065370394
    .long 146688,192,17,439488,216,1048591872,4032,3,12208,2601792,0,0,0,0,0,0
    .long 89088,6580224,92160,6583296,95232,6586368,143232,2130706432,143232,2130706432,6623232,6626304,6629376,6629376,2343936,0
    .long 98688,6623232,101760,6626304,104832,6629376,143232,2130706432,143232,2130706432,6623232,6626304,6629376,6629376,2343936,0
    .long 108288,6666240,111360,6669312,114432,6672384,143232,2130706432,143232,2130706432,6666240,6669312,6672384,6672384,2472960,0
    .long 117888,6709248,120960,6712320,124032,6715392,143232,2130706432,143232,2130706432,6666240,6669312,6672384,6672384,2472960,0
    .long 98688,629155200,0,34496,98688,629155200,16,34512,98688,629155200,32,34528,98688,629155200,32,34528
    .long 108288,629155200,0,34720,108288,629155200,16,34736,108288,629155200,32,34752,108288,629155200,32,34752
    .long 4368192,17,1693440,1701504,1694304,1702368,36,54,209,0,209,4,9600,89088,50,1065370450
    .long 146688,192,17,827136,216,1048592000,4032,3,22976,4669248,0,0,0,0,0,0
    .long 89088,8988672,92160,8991744,95232,8994816,143232,2130706432,143232,2130706432,9031680,9034752,9037824,9037824,4411392,0
    .long 98688,9031680,101760,9034752,104832,9037824,143232,2130706432,143232,2130706432,9031680,9034752,9037824,9037824,4411392,0
    .long 108288,9074688,111360,9077760,114432,9080832,143232,2130706432,143232,2130706432,9074688,9077760,9080832,9080832,4540416,0
    .long 117888,9117696,120960,9120768,124032,9123840,143232,2130706432,143232,2130706432,9074688,9077760,9080832,9080832,4540416,0
    .long 98688,629155200,0,47040,98688,629155200,16,47056,98688,629155200,32,47072,98688,629155200,32,47072
    .long 108288,629155200,0,47264,108288,629155200,16,47280,108288,629155200,32,47296,108288,629155200,32,47296
    .long 6435648,17,2088,2124,195624,195660,8064,54,57,1,57,4,9600,89088,50,1065370216
    .long 146688,43008,17,1214784,216,1048592000,4032,3,33744,6736704,0,0,0,0,0,0
    .long 89088,10944,92160,699072,95232,1387200,143232,2130706432,143232,2130706432,11136,699264,1387392,1387392,6478848,0
    .long 98688,11136,101760,699264,104832,1387392,143232,2130706432,143232,2130706432,11136,699264,1387392,1387392,6478848,0
    .long 108288,11328,111360,699456,114432,1387584,143232,2130706432,143232,2130706432,11328,699456,1387584,1387584,6607872,0
    .long 117888,11520,120960,699648,124032,1387776,143232,2130706432,143232,2130706432,11328,699456,1387584,1387584,6607872,0
    .long 98688,629155200,0,58,98688,629155200,16,3642,98688,629155200,32,7226,98688,629155200,32,7226
    .long 108288,629155200,0,59,108288,629155200,16,3643,108288,629155200,32,7227,108288,629155200,32,7227
    .long 2313024,17,3816,3852,197352,197388,8064,54,105,1,105,4,9600,89088,50,1065370324
    .long 146688,43008,17,441792,216,1048591872,4032,3,12272,2614080,0,0,0,0,0,0
    .long 89088,20160,92160,708288,95232,1396416,143232,2130706432,143232,2130706432,20352,708480,1396608,1396608,2356224,0
    .long 98688,20352,101760,708480,104832,1396608,143232,2130706432,143232,2130706432,20352,708480,1396608,1396608,2356224,0
    .long 108288,20544,111360,708672,114432,1396800,143232,2130706432,143232,2130706432,20544,708672,1396800,1396800,2485248,0
    .long 117888,20736,120960,708864,124032,1396992,143232,2130706432,143232,2130706432,20544,708672,1396800,1396800,2485248,0
    .long 98688,629155200,0,106,98688,629155200,16,3690,98688,629155200,32,7274,98688,629155200,32,7274
    .long 108288,629155200,0,107,108288,629155200,16,3691,108288,629155200,32,7275,108288,629155200,32,7275
    .long 4380480,17,5832,5868,199368,199404,8064,54,161,1,161,4,9600,89088,50,1065370402
    .long 146688,43008,17,829440,216,1048592000,4032,3,23040,4681536,0,0,0,0,0,0
    .long 89088,30912,92160,719040,95232,1407168,143232,2130706432,143232,2130706432,31104,719232,1407360,1407360,4423680,0
    .long 98688,31104,101760,719232,104832,1407360,143232,2130706432,143232,2130706432,31104,719232,1407360,1407360,4423680,0
    .long 108288,31296,111360,719424,114432,1407552,143232,2130706432,143232,2130706432,31296,719424,1407552,1407552,4552704,0
    .long 117888,31488,120960,719616,124032,1407744,143232,2130706432,143232,2130706432,31296,719424,1407552,1407552,4552704,0
    .long 98688,629155200,0,162,98688,629155200,16,3746,98688,629155200,32,7330,98688,629155200,32,7330
    .long 108288,629155200,0,163,108288,629155200,16,3747,108288,629155200,32,7331,108288,629155200,32,7331
    .long 6447936,16,7848,7884,201384,201420,8064,54,217,1,217,4,9600,89088,50,1065370458
    .long 146688,43008,17,1217088,216,1048592000,4032,3,33808,6748992,0,0,0,0,0,0
    .long 89088,41664,92160,729792,95232,1417920,143232,2130706432,143232,2130706432,41856,729984,1418112,1418112,6491136,0
    .long 98688,41856,101760,729984,104832,1418112,143232,2130706432,143232,2130706432,41856,729984,1418112,1418112,6491136,0
    .long 108288,42048,111360,730176,114432,1418304,143232,2130706432,143232,2130706432,42048,730176,1418304,1418304,6620160,0
    .long 117888,42240,120960,730368,124032,1418496,143232,2130706432,143232,2130706432,42048,730176,1418304,1418304,6620160,0
    .long 98688,629155200,0,218,98688,629155200,16,3802,98688,629155200,32,7386,98688,629155200,32,7386
    .long 108288,629155200,0,219,108288,629155200,16,3803,108288,629155200,32,7387,108288,629155200,32,7387
    .long 4613952,17,548352,556416,549216,557280,36,54,67,0,67,4,9600,89088,50,1065370248
    .long 146688,192,17,873216,216,1040203392,4032,3,24256,4915008,0,0,0,0,0,0
    .long 89088,2881536,92160,2884608,95232,2887680,143232,2130706432,143232,2130706432,2924544,2927616,2930688,2930688,4657152,0
    .long 98688,2924544,101760,2927616,104832,2930688,143232,2130706432,143232,2130706432,2924544,2927616,2930688,2930688,4657152,0
    .long 108288,2967552,111360,2970624,114432,2973696,143232,2130706432,143232,2130706432,2967552,2970624,2973696,2973696,4786176,0
    .long 117888,3010560,120960,3013632,124032,3016704,143232,2130706432,143232,2130706432,2967552,2970624,2973696,2973696,4786176,0
    .long 98688,629155200,0,15232,98688,629155200,16,15248,98688,629155200,32,15264,98688,629155200,32,15264
    .long 108288,629155200,0,15456,108288,629155200,16,15472,108288,629155200,32,15488,108288,629155200,32,15488
    .long 7025472,17,290304,298368,2130706432,2130706432,36,36,35,0,34,6,3456,102912,18,1065370128
    .long 148224,192,17,1325376,360,1048592000,3072,3,36816,7326528,0,0,0,0,0,0
    .long 89088,7369536,102912,1462272,116736,1634304,143232,2130706432,143232,2130706432,7326720,7412736,1548288,1548288,7068672,0
    .long 92544,7412544,106368,1505280,120192,1677312,143232,2130706432,143232,2130706432,7326720,7412736,1548288,1548288,7068672,0
    .long 96000,7455552,109824,1548288,143232,2130706432,143232,2130706432,143232,2130706432,7369728,7455744,1591296,1591296,7197696,0
    .long 99456,7498560,113280,1591296,143232,2130706432,143232,2130706432,143232,2130706432,7369728,7455744,1591296,1591296,7197696,0
    .long 85632,226495872,1,38160,92544,226495872,1,38608,109824,226495872,0,8064,109824,226495872,0,8064
    .long 89088,226495872,1,38384,96000,226495872,1,38832,113280,226495872,0,8288,113280,226495872,0,8288
    .long 2558784,17,1257984,1266048,1258848,1266912,36,54,155,0,155,4,9600,89088,50,1065370396
    .long 146688,192,17,487872,216,1048591872,4032,3,13552,2859840,0,0,0,0,0,0
    .long 89088,6666240,92160,6669312,95232,6672384,143232,2130706432,143232,2130706432,6709248,6712320,6715392,6715392,2601984,0
    .long 98688,6709248,101760,6712320,104832,6715392,143232,2130706432,143232,2130706432,6709248,6712320,6715392,6715392,2601984,0
    .long 108288,6752256,111360,6755328,114432,6758400,143232,2130706432,143232,2130706432,6752256,6755328,6758400,6758400,2731008,0
    .long 117888,6795264,120960,6798336,124032,6801408,143232,2130706432,143232,2130706432,6752256,6755328,6758400,6758400,2731008,0
    .long 98688,629155200,0,34944,98688,629155200,16,34960,98688,629155200,32,34976,98688,629155200,32,34976
    .long 108288,629155200,0,35168,108288,629155200,16,35184,108288,629155200,32,35200,108288,629155200,32,35200
    .long 4626240,17,1709568,1717632,1710432,1718496,36,54,211,0,211,4,9600,89088,50,1065370452
    .long 146688,192,17,875520,216,1048592000,4032,3,24320,4927296,0,0,0,0,0,0
    .long 89088,9074688,92160,9077760,95232,9080832,143232,2130706432,143232,2130706432,9117696,9120768,9123840,9123840,4669440,0
    .long 98688,9117696,101760,9120768,104832,9123840,143232,2130706432,143232,2130706432,9117696,9120768,9123840,9123840,4669440,0
    .long 108288,9160704,111360,9163776,114432,9166848,143232,2130706432,143232,2130706432,9160704,9163776,9166848,9166848,4798464,0
    .long 117888,9203712,120960,9206784,124032,9209856,143232,2130706432,143232,2130706432,9160704,9163776,9166848,9166848,4798464,0
    .long 98688,629155200,0,47488,98688,629155200,16,47504,98688,629155200,32,47520,98688,629155200,32,47520
    .long 108288,629155200,0,47712,108288,629155200,16,47728,108288,629155200,32,47744,108288,629155200,32,47744
    .long 6693696,17,2160,2196,195696,195732,8064,54,59,1,59,4,9600,89088,50,1065370224
    .long 146688,43008,17,1263168,216,1048592000,4032,3,35088,6994752,0,0,0,0,0,0
    .long 89088,11328,92160,699456,95232,1387584,143232,2130706432,143232,2130706432,11520,699648,1387776,1387776,6736896,0
    .long 98688,11520,101760,699648,104832,1387776,143232,2130706432,143232,2130706432,11520,699648,1387776,1387776,6736896,0
    .long 108288,11712,111360,699840,114432,1387968,143232,2130706432,143232,2130706432,11712,699840,1387968,1387968,6865920,0
    .long 117888,11904,120960,700032,124032,1388160,143232,2130706432,143232,2130706432,11712,699840,1387968,1387968,6865920,0
    .long 98688,629155200,0,60,98688,629155200,16,3644,98688,629155200,32,7228,98688,629155200,32,7228
    .long 108288,629155200,0,61,108288,629155200,16,3645,108288,629155200,32,7229,108288,629155200,32,7229
    .long 2571072,17,3888,3924,197424,197460,8064,54,107,1,107,4,9600,89088,50,1065370328
    .long 146688,43008,17,490176,216,1048591872,4032,3,13616,2872128,0,0,0,0,0,0
    .long 89088,20544,92160,708672,95232,1396800,143232,2130706432,143232,2130706432,20736,708864,1396992,1396992,2614272,0
    .long 98688,20736,101760,708864,104832,1396992,143232,2130706432,143232,2130706432,20736,708864,1396992,1396992,2614272,0
    .long 108288,20928,111360,709056,114432,1397184,143232,2130706432,143232,2130706432,20928,709056,1397184,1397184,2743296,0
    .long 117888,21120,120960,709248,124032,1397376,143232,2130706432,143232,2130706432,20928,709056,1397184,1397184,2743296,0
    .long 98688,629155200,0,108,98688,629155200,16,3692,98688,629155200,32,7276,98688,629155200,32,7276
    .long 108288,629155200,0,109,108288,629155200,16,3693,108288,629155200,32,7277,108288,629155200,32,7277
    .long 4638528,17,5904,5940,199440,199476,8064,54,163,1,163,4,9600,89088,50,1065370404
    .long 146688,43008,17,877824,216,1048592000,4032,3,24384,4939584,0,0,0,0,0,0
    .long 89088,31296,92160,719424,95232,1407552,143232,2130706432,143232,2130706432,31488,719616,1407744,1407744,4681728,0
    .long 98688,31488,101760,719616,104832,1407744,143232,2130706432,143232,2130706432,31488,719616,1407744,1407744,4681728,0
    .long 108288,31680,111360,719808,114432,1407936,143232,2130706432,143232,2130706432,31680,719808,1407936,1407936,4810752,0
    .long 117888,31872,120960,720000,124032,1408128,143232,2130706432,143232,2130706432,31680,719808,1407936,1407936,4810752,0
    .long 98688,629155200,0,164,98688,629155200,16,3748,98688,629155200,32,7332,98688,629155200,32,7332
    .long 108288,629155200,0,165,108288,629155200,16,3749,108288,629155200,32,7333,108288,629155200,32,7333
    .long 6705984,16,7920,7956,201456,201492,8064,54,219,1,219,4,9600,89088,50,1065370460
    .long 146688,43008,17,1265472,216,1048592000,4032,3,35152,7007040,0,0,0,0,0,0
    .long 89088,42048,92160,730176,95232,1418304,143232,2130706432,143232,2130706432,42240,730368,1418496,1418496,6749184,0
    .long 98688,42240,101760,730368,104832,1418496,143232,2130706432,143232,2130706432,42240,730368,1418496,1418496,6749184,0
    .long 108288,42432,111360,730560,114432,1418688,143232,2130706432,143232,2130706432,42432,730560,1418688,1418688,6878208,0
    .long 117888,42624,120960,730752,124032,1418880,143232,2130706432,143232,2130706432,42432,730560,1418688,1418688,6878208,0
    .long 98688,629155200,0,220,98688,629155200,16,3804,98688,629155200,32,7388,98688,629155200,32,7388
    .long 108288,629155200,0,221,108288,629155200,16,3805,108288,629155200,32,7389,108288,629155200,32,7389
    .long 4872000,17,564480,572544,565344,573408,36,54,69,0,69,4,9600,89088,50,1065370252
    .long 146688,192,17,921600,216,1040203392,4032,3,25600,5173056,0,0,0,0,0,0
    .long 89088,2967552,92160,2970624,95232,2973696,143232,2130706432,143232,2130706432,3010560,3013632,3016704,3016704,4915200,0
    .long 98688,3010560,101760,3013632,104832,3016704,143232,2130706432,143232,2130706432,3010560,3013632,3016704,3016704,4915200,0
    .long 108288,3053568,111360,3056640,114432,3059712,143232,2130706432,143232,2130706432,3053568,3056640,3059712,3059712,5044224,0
    .long 117888,3096576,120960,3099648,124032,3102720,143232,2130706432,143232,2130706432,3053568,3056640,3059712,3059712,5044224,0
    .long 98688,629155200,0,15680,98688,629155200,16,15696,98688,629155200,32,15712,98688,629155200,32,15712
    .long 108288,629155200,0,15904,108288,629155200,16,15920,108288,629155200,32,15936,108288,629155200,32,15936
    .long 7455552,17,306432,314496,2130706432,2130706432,36,36,37,0,36,6,3456,102912,18,1065370136
    .long 148224,192,17,1406016,360,1048592000,3072,3,39056,7756608,0,0,0,0,0,0
    .long 89088,7799616,102912,1548288,116736,1720320,143232,2130706432,143232,2130706432,7756800,7842816,1634304,1634304,7498752,0
    .long 92544,7842624,106368,1591296,120192,1763328,143232,2130706432,143232,2130706432,7756800,7842816,1634304,1634304,7498752,0
    .long 96000,7885632,109824,1634304,143232,2130706432,143232,2130706432,143232,2130706432,7799808,7885824,1677312,1677312,7627776,0
    .long 99456,7928640,113280,1677312,143232,2130706432,143232,2130706432,143232,2130706432,7799808,7885824,1677312,1677312,7627776,0
    .long 85632,226495872,1,40400,92544,226495872,1,40848,109824,226495872,0,8512,109824,226495872,0,8512
    .long 89088,226495872,1,40624,96000,226495872,1,41072,113280,226495872,0,8736,113280,226495872,0,8736
    .long 2816832,17,1274112,1282176,1274976,1283040,36,54,157,0,157,4,9600,89088,50,1065370398
    .long 146688,192,17,536256,216,1048592000,4032,3,14896,3117888,0,0,0,0,0,0
    .long 89088,6752256,92160,6755328,95232,6758400,143232,2130706432,143232,2130706432,6795264,6798336,6801408,6801408,2860032,0
    .long 98688,6795264,101760,6798336,104832,6801408,143232,2130706432,143232,2130706432,6795264,6798336,6801408,6801408,2860032,0
    .long 108288,6838272,111360,6841344,114432,6844416,143232,2130706432,143232,2130706432,6838272,6841344,6844416,6844416,2989056,0
    .long 117888,6881280,120960,6884352,124032,6887424,143232,2130706432,143232,2130706432,6838272,6841344,6844416,6844416,2989056,0
    .long 98688,629155200,0,35392,98688,629155200,16,35408,98688,629155200,32,35424,98688,629155200,32,35424
    .long 108288,629155200,0,35616,108288,629155200,16,35632,108288,629155200,32,35648,108288,629155200,32,35648
    .long 4884288,17,1725696,1733760,1726560,1734624,36,54,213,0,213,4,9600,89088,50,1065370454
    .long 146688,192,17,923904,216,1048592000,4032,3,25664,5185344,0,0,0,0,0,0
    .long 89088,9160704,92160,9163776,95232,9166848,143232,2130706432,143232,2130706432,9203712,9206784,9209856,9209856,4927488,0
    .long 98688,9203712,101760,9206784,104832,9209856,143232,2130706432,143232,2130706432,9203712,9206784,9209856,9209856,4927488,0
    .long 108288,9246720,111360,9249792,114432,9252864,143232,2130706432,143232,2130706432,9246720,9249792,9252864,9252864,5056512,0
    .long 117888,9289728,120960,9292800,124032,9295872,143232,2130706432,143232,2130706432,9246720,9249792,9252864,9252864,5056512,0
    .long 98688,629155200,0,47936,98688,629155200,16,47952,98688,629155200,32,47968,98688,629155200,32,47968
    .long 108288,629155200,0,48160,108288,629155200,16,48176,108288,629155200,32,48192,108288,629155200,32,48192
    .long 6951744,17,2232,2268,195768,195804,8064,54,61,1,61,4,9600,89088,50,1065370232
    .long 146688,43008,17,1311552,216,1048592000,4032,3,36432,7252800,0,0,0,0,0,0
    .long 89088,11712,92160,699840,95232,1387968,143232,2130706432,143232,2130706432,11904,700032,1388160,1388160,6994944,0
    .long 98688,11904,101760,700032,104832,1388160,143232,2130706432,143232,2130706432,11904,700032,1388160,1388160,6994944,0
    .long 108288,12096,111360,700224,114432,1388352,143232,2130706432,143232,2130706432,12096,700224,1388352,1388352,7123968,0
    .long 117888,12288,120960,700416,124032,1388544,143232,2130706432,143232,2130706432,12096,700224,1388352,1388352,7123968,0
    .long 98688,629155200,0,62,98688,629155200,16,3646,98688,629155200,32,7230,98688,629155200,32,7230
    .long 108288,629155200,0,63,108288,629155200,16,3647,108288,629155200,32,7231,108288,629155200,32,7231
    .long 2829120,17,3960,3996,197496,197532,8064,54,109,1,109,4,9600,89088,50,1065370332
    .long 146688,43008,17,538560,216,1048592000,4032,3,14960,3130176,0,0,0,0,0,0
    .long 89088,20928,92160,709056,95232,1397184,143232,2130706432,143232,2130706432,21120,709248,1397376,1397376,2872320,0
    .long 98688,21120,101760,709248,104832,1397376,143232,2130706432,143232,2130706432,21120,709248,1397376,1397376,2872320,0
    .long 108288,21312,111360,709440,114432,1397568,143232,2130706432,143232,2130706432,21312,709440,1397568,1397568,3001344,0
    .long 117888,21504,120960,709632,124032,1397760,143232,2130706432,143232,2130706432,21312,709440,1397568,1397568,3001344,0
    .long 98688,629155200,0,110,98688,629155200,16,3694,98688,629155200,32,7278,98688,629155200,32,7278
    .long 108288,629155200,0,111,108288,629155200,16,3695,108288,629155200,32,7279,108288,629155200,32,7279
    .long 4896576,17,5976,6012,199512,199548,8064,54,165,1,165,4,9600,89088,50,1065370406
    .long 146688,43008,17,926208,216,1048592000,4032,3,25728,5197632,0,0,0,0,0,0
    .long 89088,31680,92160,719808,95232,1407936,143232,2130706432,143232,2130706432,31872,720000,1408128,1408128,4939776,0
    .long 98688,31872,101760,720000,104832,1408128,143232,2130706432,143232,2130706432,31872,720000,1408128,1408128,4939776,0
    .long 108288,32064,111360,720192,114432,1408320,143232,2130706432,143232,2130706432,32064,720192,1408320,1408320,5068800,0
    .long 117888,32256,120960,720384,124032,1408512,143232,2130706432,143232,2130706432,32064,720192,1408320,1408320,5068800,0
    .long 98688,629155200,0,166,98688,629155200,16,3750,98688,629155200,32,7334,98688,629155200,32,7334
    .long 108288,629155200,0,167,108288,629155200,16,3751,108288,629155200,32,7335,108288,629155200,32,7335
    .long 6964032,16,7992,8028,201528,201564,8064,54,221,1,221,4,9600,89088,50,1065370462
    .long 146688,43008,17,1313856,216,1048592000,4032,3,36496,7265088,0,0,0,0,0,0
    .long 89088,42432,92160,730560,95232,1418688,143232,2130706432,143232,2130706432,42624,730752,1418880,1418880,7007232,0
    .long 98688,42624,101760,730752,104832,1418880,143232,2130706432,143232,2130706432,42624,730752,1418880,1418880,7007232,0
    .long 108288,42816,111360,730944,114432,1419072,143232,2130706432,143232,2130706432,42816,730944,1419072,1419072,7136256,0
    .long 117888,42816,120960,730944,124032,1419072,143232,2130706432,143232,2130706432,42816,730944,1419072,1419072,7136256,0
    .long 98688,629155200,0,222,98688,629155200,16,3806,98688,629155200,32,7390,98688,629155200,32,7390
    .long 108288,629155200,0,223,108288,629155200,16,3807,108288,629155200,32,7391,108288,629155200,32,7391
    .long 5130048,17,580608,588672,581472,589536,36,54,71,0,71,4,9600,89088,50,1065370256
    .long 146688,192,17,969984,216,1040203392,4032,3,26944,5431104,0,0,0,0,0,0
    .long 89088,3053568,92160,3056640,95232,3059712,143232,2130706432,143232,2130706432,3096576,3099648,3102720,3102720,5173248,0
    .long 98688,3096576,101760,3099648,104832,3102720,143232,2130706432,143232,2130706432,3096576,3099648,3102720,3102720,5173248,0
    .long 108288,3139584,111360,3142656,114432,3145728,143232,2130706432,143232,2130706432,3139584,3142656,3145728,3145728,5302272,0
    .long 117888,3182592,120960,3185664,124032,3188736,143232,2130706432,143232,2130706432,3139584,3142656,3145728,3145728,5302272,0
    .long 98688,629155200,0,16128,98688,629155200,16,16144,98688,629155200,32,16160,98688,629155200,32,16160
    .long 108288,629155200,0,16352,108288,629155200,16,16368,108288,629155200,32,16384,108288,629155200,32,16384
    .long 7885632,17,322560,330624,2130706432,2130706432,36,36,39,0,38,6,3456,102912,18,1065370144
    .long 148224,192,17,1486656,360,1048592000,3072,3,41296,8186688,0,0,0,0,0,0
    .long 89088,8229696,102912,1634304,116736,1806336,143232,2130706432,143232,2130706432,8186880,8272896,1720320,1720320,7928832,0
    .long 92544,8272704,106368,1677312,120192,1849344,143232,2130706432,143232,2130706432,8186880,8272896,1720320,1720320,7928832,0
    .long 96000,8315712,109824,1720320,143232,2130706432,143232,2130706432,143232,2130706432,8229888,8315904,1763328,1763328,8057856,0
    .long 99456,8358720,113280,1763328,143232,2130706432,143232,2130706432,143232,2130706432,8229888,8315904,1763328,1763328,8057856,0
    .long 85632,226495872,1,42640,92544,226495872,1,43088,109824,226495872,0,8960,109824,226495872,0,8960
    .long 89088,226495872,1,42864,96000,226495872,1,43312,113280,226495872,0,9184,113280,226495872,0,9184
    .long 3074880,17,1290240,1298304,1291104,1299168,36,54,159,0,159,4,9600,89088,50,1065370400
    .long 146688,192,17,584640,216,1048592000,4032,3,16240,3375936,0,0,0,0,0,0
    .long 89088,6838272,92160,6841344,95232,6844416,143232,2130706432,143232,2130706432,6881280,6884352,6887424,6887424,3118080,0
    .long 98688,6881280,101760,6884352,104832,6887424,143232,2130706432,143232,2130706432,6881280,6884352,6887424,6887424,3118080,0
    .long 108288,6924288,111360,6927360,114432,6930432,143232,2130706432,143232,2130706432,6924288,6927360,6930432,6930432,3247104,0
    .long 117888,6967296,120960,6970368,124032,6973440,143232,2130706432,143232,2130706432,6924288,6927360,6930432,6930432,3247104,0
    .long 98688,629155200,0,35840,98688,629155200,16,35856,98688,629155200,32,35872,98688,629155200,32,35872
    .long 108288,629155200,0,36064,108288,629155200,16,36080,108288,629155200,32,36096,108288,629155200,32,36096
    .long 5142336,17,1741824,1749888,1742688,1750752,36,54,215,0,215,4,9600,89088,50,1065370456
    .long 146688,192,17,972288,216,1048592000,4032,3,27008,5443392,0,0,0,0,0,0
    .long 89088,9246720,92160,9249792,95232,9252864,143232,2130706432,143232,2130706432,9289728,9292800,9295872,9295872,5185536,0
    .long 98688,9289728,101760,9292800,104832,9295872,143232,2130706432,143232,2130706432,9289728,9292800,9295872,9295872,5185536,0
    .long 108288,9332736,111360,9335808,114432,9338880,143232,2130706432,143232,2130706432,9332736,9335808,9338880,9338880,5314560,0
    .long 117888,9375744,120960,9378816,124032,9381888,143232,2130706432,143232,2130706432,9332736,9335808,9338880,9338880,5314560,0
    .long 98688,629155200,0,48384,98688,629155200,16,48400,98688,629155200,32,48416,98688,629155200,32,48416
    .long 108288,629155200,0,48608,108288,629155200,16,48624,108288,629155200,32,48640,108288,629155200,32,48640
    .long 7209792,17,2130706432,2130706432,2130706432,2130706432,36,0,0,0,0,0,0,116736,0,0
    .long 0,192,17,1359936,504,1048592000,0,4,37776,7510848,0,0,0,0,0,0
    .long 89088,7553856,102912,7725888,143232,2130706432,143232,2130706432,143232,2130706432,7511040,7597056,7683072,7769088,7252992,0
    .long 92544,7596864,106368,7768896,143232,2130706432,143232,2130706432,143232,2130706432,7511040,7597056,7683072,7769088,7252992,0
    .long 96000,7639872,109824,7811904,143232,2130706432,143232,2130706432,143232,2130706432,7554048,7640064,7726080,7812096,7382016,0
    .long 99456,7682880,113280,7854912,143232,2130706432,143232,2130706432,143232,2130706432,7554048,7640064,7726080,7812096,7382016,0
    .long 85632,226495872,1,39120,92544,226495872,1,39568,99456,226495872,1,40016,106368,226495872,1,40464
    .long 89088,226495872,1,39344,96000,226495872,1,39792,102912,226495872,1,40240,109824,226495872,1,40688
    .long 3087168,17,4032,4068,197568,197604,8064,54,111,1,111,4,9600,89088,50,1065370336
    .long 146688,43008,17,586944,216,1048592000,4032,3,16304,3388224,0,0,0,0,0,0
    .long 89088,21312,92160,709440,95232,1397568,143232,2130706432,143232,2130706432,21504,709632,1397760,1397760,3130368,0
    .long 98688,21504,101760,709632,104832,1397760,143232,2130706432,143232,2130706432,21504,709632,1397760,1397760,3130368,0
    .long 108288,21696,111360,709824,114432,1397952,143232,2130706432,143232,2130706432,21696,709824,1397952,1397952,3259392,0
    .long 117888,21888,120960,710016,124032,1398144,143232,2130706432,143232,2130706432,21696,709824,1397952,1397952,3259392,0
    .long 98688,629155200,0,112,98688,629155200,16,3696,98688,629155200,32,7280,98688,629155200,32,7280
    .long 108288,629155200,0,113,108288,629155200,16,3697,108288,629155200,32,7281,108288,629155200,32,7281
    .long 5154624,17,6048,6084,199584,199620,8064,54,167,1,167,4,9600,89088,50,1065370408
    .long 146688,43008,17,974592,216,1048592000,4032,3,27072,5455680,0,0,0,0,0,0
    .long 89088,32064,92160,720192,95232,1408320,143232,2130706432,143232,2130706432,32256,720384,1408512,1408512,5197824,0
    .long 98688,32256,101760,720384,104832,1408512,143232,2130706432,143232,2130706432,32256,720384,1408512,1408512,5197824,0
    .long 108288,32448,111360,720576,114432,1408704,143232,2130706432,143232,2130706432,32448,720576,1408704,1408704,5326848,0
    .long 117888,32640,120960,720768,124032,1408896,143232,2130706432,143232,2130706432,32448,720576,1408704,1408704,5326848,0
    .long 98688,629155200,0,168,98688,629155200,16,3752,98688,629155200,32,7336,98688,629155200,32,7336
    .long 108288,629155200,0,169,108288,629155200,16,3753,108288,629155200,32,7337,108288,629155200,32,7337
    .long 7222080,16,2130706432,2130706432,2130706432,2130706432,36,0,0,0,0,0,0,116736,0,0
    .long 0,192,16,1362240,504,1048592000,0,4,37840,7523136,0,0,0,0,0,0
    .long 89088,7566144,102912,7738176,143232,2130706432,143232,2130706432,143232,2130706432,7523328,7609344,7695360,7781376,7265280,0
    .long 92544,7609152,106368,7781184,143232,2130706432,143232,2130706432,143232,2130706432,7523328,7609344,7695360,7781376,7265280,0
    .long 96000,7652160,109824,7824192,143232,2130706432,143232,2130706432,143232,2130706432,7566336,7652352,7738368,7824384,7394304,0
    .long 99456,7695168,113280,7867200,143232,2130706432,143232,2130706432,143232,2130706432,7566336,7652352,7738368,7824384,7394304,0
    .long 85632,226495872,1,39184,92544,226495872,1,39632,99456,226495872,1,40080,106368,226495872,1,40528
    .long 89088,226495872,1,39408,96000,226495872,1,39856,102912,226495872,1,40304,109824,226495872,1,40752
    .long 5388096,17,596736,604800,597600,605664,36,54,73,0,73,4,9600,89088,50,1065370260
    .long 146688,192,17,1018368,216,1040203392,4032,3,28288,5689152,0,0,0,0,0,0
    .long 89088,3139584,92160,3142656,95232,3145728,143232,2130706432,143232,2130706432,3182592,3185664,3188736,3188736,5431296,0
    .long 98688,3182592,101760,3185664,104832,3188736,143232,2130706432,143232,2130706432,3182592,3185664,3188736,3188736,5431296,0
    .long 108288,3225600,111360,3228672,114432,3231744,143232,2130706432,143232,2130706432,3225600,3228672,3231744,3231744,5560320,0
    .long 117888,3268608,120960,3271680,124032,3274752,143232,2130706432,143232,2130706432,3225600,3228672,3231744,3231744,5560320,0
    .long 98688,629155200,0,16576,98688,629155200,16,16592,98688,629155200,32,16608,98688,629155200,32,16608
    .long 108288,629155200,0,16800,108288,629155200,16,16816,108288,629155200,32,16832,108288,629155200,32,16832
    .long 8315712,17,338688,346752,2130706432,2130706432,36,36,41,0,40,6,3456,102912,18,1065370152
    .long 148224,192,17,1567296,360,1048592000,3072,3,43536,8616768,0,0,0,0,0,0
    .long 89088,8659776,102912,1720320,116736,1892352,143232,2130706432,143232,2130706432,8616960,8702976,1806336,1806336,8358912,0
    .long 92544,8702784,106368,1763328,120192,1935360,143232,2130706432,143232,2130706432,8616960,8702976,1806336,1806336,8358912,0
    .long 96000,8745792,109824,1806336,143232,2130706432,143232,2130706432,143232,2130706432,8659968,8745984,1849344,1849344,8487936,0
    .long 99456,8788800,113280,1849344,143232,2130706432,143232,2130706432,143232,2130706432,8659968,8745984,1849344,1849344,8487936,0
    .long 85632,226495872,1,44880,92544,226495872,1,45328,109824,226495872,0,9408,109824,226495872,0,9408
    .long 89088,226495872,1,45104,96000,226495872,1,45552,113280,226495872,0,9632,113280,226495872,0,9632
    .long 3332928,17,1306368,1314432,1307232,1315296,36,54,161,0,161,4,9600,89088,50,1065370402
    .long 146688,192,17,633024,216,1048592000,4032,3,17584,3633984,0,0,0,0,0,0
    .long 89088,6924288,92160,6927360,95232,6930432,143232,2130706432,143232,2130706432,6967296,6970368,6973440,6973440,3376128,0
    .long 98688,6967296,101760,6970368,104832,6973440,143232,2130706432,143232,2130706432,6967296,6970368,6973440,6973440,3376128,0
    .long 108288,7010304,111360,7013376,114432,7016448,143232,2130706432,143232,2130706432,7010304,7013376,7016448,7016448,3505152,0
    .long 117888,7053312,120960,7056384,124032,7059456,143232,2130706432,143232,2130706432,7010304,7013376,7016448,7016448,3505152,0
    .long 98688,629155200,0,36288,98688,629155200,16,36304,98688,629155200,32,36320,98688,629155200,32,36320
    .long 108288,629155200,0,36512,108288,629155200,16,36528,108288,629155200,32,36544,108288,629155200,32,36544
    .long 5400384,17,1757952,1766016,1758816,1766880,36,54,217,0,217,4,9600,89088,50,1065370458
    .long 146688,192,17,1020672,216,1048592000,4032,3,28352,5701440,0,0,0,0,0,0
    .long 89088,9332736,92160,9335808,95232,9338880,143232,2130706432,143232,2130706432,9375744,9378816,9381888,9381888,5443584,0
    .long 98688,9375744,101760,9378816,104832,9381888,143232,2130706432,143232,2130706432,9375744,9378816,9381888,9381888,5443584,0
    .long 108288,9418752,111360,9421824,114432,9424896,143232,2130706432,143232,2130706432,9418752,9421824,9424896,9424896,5572608,0
    .long 117888,9461760,120960,9464832,124032,9467904,143232,2130706432,143232,2130706432,9418752,9421824,9424896,9424896,5572608,0
    .long 98688,629155200,0,48832,98688,629155200,16,48848,98688,629155200,32,48864,98688,629155200,32,48864
    .long 108288,629155200,0,49056,108288,629155200,16,49072,108288,629155200,32,49088,108288,629155200,32,49088
    .long 7811904,17,2130706432,2130706432,2130706432,2130706432,36,0,0,0,0,0,0,116736,0,0
    .long 0,192,17,1472832,504,1048592000,0,4,40912,8112960,0,0,0,0,0,0
    .long 89088,8155968,102912,8328000,143232,2130706432,143232,2130706432,143232,2130706432,8113152,8199168,8285184,8371200,7855104,0
    .long 92544,8198976,106368,8371008,143232,2130706432,143232,2130706432,143232,2130706432,8113152,8199168,8285184,8371200,7855104,0
    .long 96000,8241984,109824,8414016,143232,2130706432,143232,2130706432,143232,2130706432,8156160,8242176,8328192,8414208,7984128,0
    .long 99456,8284992,113280,8457024,143232,2130706432,143232,2130706432,143232,2130706432,8156160,8242176,8328192,8414208,7984128,0
    .long 85632,226495872,1,42256,92544,226495872,1,42704,99456,226495872,1,43152,106368,226495872,1,43600
    .long 89088,226495872,1,42480,96000,226495872,1,42928,102912,226495872,1,43376,109824,226495872,1,43824
    .long 3345216,17,4104,4140,197640,197676,8064,54,113,1,113,4,9600,89088,50,1065370340
    .long 146688,43008,17,635328,216,1048592000,4032,3,17648,3646272,0,0,0,0,0,0
    .long 89088,21696,92160,709824,95232,1397952,143232,2130706432,143232,2130706432,21888,710016,1398144,1398144,3388416,0
    .long 98688,21888,101760,710016,104832,1398144,143232,2130706432,143232,2130706432,21888,710016,1398144,1398144,3388416,0
    .long 108288,22080,111360,710208,114432,1398336,143232,2130706432,143232,2130706432,22080,710208,1398336,1398336,3517440,0
    .long 117888,22272,120960,710400,124032,1398528,143232,2130706432,143232,2130706432,22080,710208,1398336,1398336,3517440,0
    .long 98688,629155200,0,114,98688,629155200,16,3698,98688,629155200,32,7282,98688,629155200,32,7282
    .long 108288,629155200,0,115,108288,629155200,16,3699,108288,629155200,32,7283,108288,629155200,32,7283
    .long 5412672,17,6120,6156,199656,199692,8064,54,169,1,169,4,9600,89088,50,1065370410
    .long 146688,43008,17,1022976,216,1048592000,4032,3,28416,5713728,0,0,0,0,0,0
    .long 89088,32448,92160,720576,95232,1408704,143232,2130706432,143232,2130706432,32640,720768,1408896,1408896,5455872,0
    .long 98688,32640,101760,720768,104832,1408896,143232,2130706432,143232,2130706432,32640,720768,1408896,1408896,5455872,0
    .long 108288,32832,111360,720960,114432,1409088,143232,2130706432,143232,2130706432,32832,720960,1409088,1409088,5584896,0
    .long 117888,33024,120960,721152,124032,1409280,143232,2130706432,143232,2130706432,32832,720960,1409088,1409088,5584896,0
    .long 98688,629155200,0,170,98688,629155200,16,3754,98688,629155200,32,7338,98688,629155200,32,7338
    .long 108288,629155200,0,171,108288,629155200,16,3755,108288,629155200,32,7339,108288,629155200,32,7339
    .long 7824192,16,2130706432,2130706432,2130706432,2130706432,36,0,0,0,0,0,0,116736,0,0
    .long 0,192,16,1475136,504,1048592000,0,4,40976,8125248,0,0,0,0,0,0
    .long 89088,8168256,102912,8340288,143232,2130706432,143232,2130706432,143232,2130706432,8125440,8211456,8297472,8383488,7867392,0
    .long 92544,8211264,106368,8383296,143232,2130706432,143232,2130706432,143232,2130706432,8125440,8211456,8297472,8383488,7867392,0
    .long 96000,8254272,109824,8426304,143232,2130706432,143232,2130706432,143232,2130706432,8168448,8254464,8340480,8426496,7996416,0
    .long 99456,8297280,113280,8469312,143232,2130706432,143232,2130706432,143232,2130706432,8168448,8254464,8340480,8426496,7996416,0
    .long 85632,226495872,1,42320,92544,226495872,1,42768,99456,226495872,1,43216,106368,226495872,1,43664
    .long 89088,226495872,1,42544,96000,226495872,1,42992,102912,226495872,1,43440,109824,226495872,1,43888
    .long 5646144,17,612864,620928,613728,621792,36,54,75,0,75,4,9600,89088,50,1065370264
    .long 146688,192,17,1066752,216,1040203392,4032,3,29632,5947200,0,0,0,0,0,0
    .long 89088,3225600,92160,3228672,95232,3231744,143232,2130706432,143232,2130706432,3268608,3271680,3274752,3274752,5689344,0
    .long 98688,3268608,101760,3271680,104832,3274752,143232,2130706432,143232,2130706432,3268608,3271680,3274752,3274752,5689344,0
    .long 108288,3311616,111360,3314688,114432,3317760,143232,2130706432,143232,2130706432,3311616,3314688,3317760,3317760,5818368,0
    .long 117888,3354624,120960,3357696,124032,3360768,143232,2130706432,143232,2130706432,3311616,3314688,3317760,3317760,5818368,0
    .long 98688,629155200,0,17024,98688,629155200,16,17040,98688,629155200,32,17056,98688,629155200,32,17056
    .long 108288,629155200,0,17248,108288,629155200,16,17264,108288,629155200,32,17280,108288,629155200,32,17280
    .long 8745792,17,354816,362880,2130706432,2130706432,36,36,43,0,42,6,3456,102912,18,1065370160
    .long 148224,192,17,1647936,360,1048592000,3072,3,45776,9046848,0,0,0,0,0,0
    .long 89088,9089856,102912,1806336,116736,1978368,143232,2130706432,143232,2130706432,9047040,9133056,1892352,1892352,8788992,0
    .long 92544,9132864,106368,1849344,120192,2021376,143232,2130706432,143232,2130706432,9047040,9133056,1892352,1892352,8788992,0
    .long 96000,9175872,109824,1892352,143232,2130706432,143232,2130706432,143232,2130706432,9090048,9176064,1935360,1935360,8918016,0
    .long 99456,9218880,113280,1935360,143232,2130706432,143232,2130706432,143232,2130706432,9090048,9176064,1935360,1935360,8918016,0
    .long 85632,226495872,1,47120,92544,226495872,1,47568,109824,226495872,0,9856,109824,226495872,0,9856
    .long 89088,226495872,1,47344,96000,226495872,1,47792,113280,226495872,0,10080,113280,226495872,0,10080
    .long 3590976,17,1322496,1330560,1323360,1331424,36,54,163,0,163,4,9600,89088,50,1065370404
    .long 146688,192,17,681408,216,1048592000,4032,3,18928,3892032,0,0,0,0,0,0
    .long 89088,7010304,92160,7013376,95232,7016448,143232,2130706432,143232,2130706432,7053312,7056384,7059456,7059456,3634176,0
    .long 98688,7053312,101760,7056384,104832,7059456,143232,2130706432,143232,2130706432,7053312,7056384,7059456,7059456,3634176,0
    .long 108288,7096320,111360,7099392,114432,7102464,143232,2130706432,143232,2130706432,7096320,7099392,7102464,7102464,3763200,0
    .long 117888,7139328,120960,7142400,124032,7145472,143232,2130706432,143232,2130706432,7096320,7099392,7102464,7102464,3763200,0
    .long 98688,629155200,0,36736,98688,629155200,16,36752,98688,629155200,32,36768,98688,629155200,32,36768
    .long 108288,629155200,0,36960,108288,629155200,16,36976,108288,629155200,32,36992,108288,629155200,32,36992
    .long 5658432,17,1774080,1782144,1774944,1783008,36,54,219,0,219,4,9600,89088,50,1065370460
    .long 146688,192,17,1069056,216,1048592000,4032,3,29696,5959488,0,0,0,0,0,0
    .long 89088,9418752,92160,9421824,95232,9424896,143232,2130706432,143232,2130706432,9461760,9464832,9467904,9467904,5701632,0
    .long 98688,9461760,101760,9464832,104832,9467904,143232,2130706432,143232,2130706432,9461760,9464832,9467904,9467904,5701632,0
    .long 108288,9504768,111360,9507840,114432,9510912,143232,2130706432,143232,2130706432,9504768,9507840,9510912,9510912,5830656,0
    .long 117888,9547776,120960,9550848,124032,9553920,143232,2130706432,143232,2130706432,9504768,9507840,9510912,9510912,5830656,0
    .long 98688,629155200,0,49280,98688,629155200,16,49296,98688,629155200,32,49312,98688,629155200,32,49312
    .long 108288,629155200,0,49504,108288,629155200,16,49520,108288,629155200,32,49536,108288,629155200,32,49536
    .long 8414016,17,2130706432,2130706432,2130706432,2130706432,36,0,0,0,0,0,0,116736,0,0
    .long 0,192,17,1585728,504,1048592000,0,4,44048,8715072,0,0,0,0,0,0
    .long 89088,8758080,102912,8930112,143232,2130706432,143232,2130706432,143232,2130706432,8715264,8801280,8887296,8973312,8457216,0
    .long 92544,8801088,106368,8973120,143232,2130706432,143232,2130706432,143232,2130706432,8715264,8801280,8887296,8973312,8457216,0
    .long 96000,8844096,109824,9016128,143232,2130706432,143232,2130706432,143232,2130706432,8758272,8844288,8930304,9016320,8586240,0
    .long 99456,8887104,113280,9059136,143232,2130706432,143232,2130706432,143232,2130706432,8758272,8844288,8930304,9016320,8586240,0
    .long 85632,226495872,1,45392,92544,226495872,1,45840,99456,226495872,1,46288,106368,226495872,1,46736
    .long 89088,226495872,1,45616,96000,226495872,1,46064,102912,226495872,1,46512,109824,226495872,1,46960
    .long 3603264,17,4176,4212,197712,197748,8064,54,115,1,115,4,9600,89088,50,1065370344
    .long 146688,43008,17,683712,216,1048592000,4032,3,18992,3904320,0,0,0,0,0,0
    .long 89088,22080,92160,710208,95232,1398336,143232,2130706432,143232,2130706432,22272,710400,1398528,1398528,3646464,0
    .long 98688,22272,101760,710400,104832,1398528,143232,2130706432,143232,2130706432,22272,710400,1398528,1398528,3646464,0
    .long 108288,22464,111360,710592,114432,1398720,143232,2130706432,143232,2130706432,22464,710592,1398720,1398720,3775488,0
    .long 117888,22656,120960,710784,124032,1398912,143232,2130706432,143232,2130706432,22464,710592,1398720,1398720,3775488,0
    .long 98688,629155200,0,116,98688,629155200,16,3700,98688,629155200,32,7284,98688,629155200,32,7284
    .long 108288,629155200,0,117,108288,629155200,16,3701,108288,629155200,32,7285,108288,629155200,32,7285
    .long 5670720,17,6192,6228,199728,199764,8064,54,171,1,171,4,9600,89088,50,1065370412
    .long 146688,43008,17,1071360,216,1048592000,4032,3,29760,5971776,0,0,0,0,0,0
    .long 89088,32832,92160,720960,95232,1409088,143232,2130706432,143232,2130706432,33024,721152,1409280,1409280,5713920,0
    .long 98688,33024,101760,721152,104832,1409280,143232,2130706432,143232,2130706432,33024,721152,1409280,1409280,5713920,0
    .long 108288,33216,111360,721344,114432,1409472,143232,2130706432,143232,2130706432,33216,721344,1409472,1409472,5842944,0
    .long 117888,33408,120960,721536,124032,1409664,143232,2130706432,143232,2130706432,33216,721344,1409472,1409472,5842944,0
    .long 98688,629155200,0,172,98688,629155200,16,3756,98688,629155200,32,7340,98688,629155200,32,7340
    .long 108288,629155200,0,173,108288,629155200,16,3757,108288,629155200,32,7341,108288,629155200,32,7341
    .long 8426304,16,2130706432,2130706432,2130706432,2130706432,36,0,0,0,0,0,0,116736,0,0
    .long 0,192,16,1588032,504,1048592000,0,4,44112,8727360,0,0,0,0,0,0
    .long 89088,8770368,102912,8942400,143232,2130706432,143232,2130706432,143232,2130706432,8727552,8813568,8899584,8985600,8469504,0
    .long 92544,8813376,106368,8985408,143232,2130706432,143232,2130706432,143232,2130706432,8727552,8813568,8899584,8985600,8469504,0
    .long 96000,8856384,109824,9028416,143232,2130706432,143232,2130706432,143232,2130706432,8770560,8856576,8942592,9028608,8598528,0
    .long 99456,8899392,113280,9071424,143232,2130706432,143232,2130706432,143232,2130706432,8770560,8856576,8942592,9028608,8598528,0
    .long 85632,226495872,1,45456,92544,226495872,1,45904,99456,226495872,1,46352,106368,226495872,1,46800
    .long 89088,226495872,1,45680,96000,226495872,1,46128,102912,226495872,1,46576,109824,226495872,1,47024
    .long 5904192,17,628992,637056,629856,637920,36,54,77,0,77,4,9600,89088,50,1065370268
    .long 146688,192,17,1115136,216,1040203392,4032,3,30976,6205248,0,0,0,0,0,0
    .long 89088,3311616,92160,3314688,95232,3317760,143232,2130706432,143232,2130706432,3354624,3357696,3360768,3360768,5947392,0
    .long 98688,3354624,101760,3357696,104832,3360768,143232,2130706432,143232,2130706432,3354624,3357696,3360768,3360768,5947392,0
    .long 108288,3397632,111360,3400704,114432,3403776,143232,2130706432,143232,2130706432,3397632,3400704,3403776,3403776,6076416,0
    .long 117888,3440640,120960,3443712,124032,3446784,143232,2130706432,143232,2130706432,3397632,3400704,3403776,3403776,6076416,0
    .long 98688,629155200,0,17472,98688,629155200,16,17488,98688,629155200,32,17504,98688,629155200,32,17504
    .long 108288,629155200,0,17696,108288,629155200,16,17712,108288,629155200,32,17728,108288,629155200,32,17728
    .long 9175872,17,370944,379008,2130706432,2130706432,36,36,45,0,44,6,3456,102912,18,1065370168
    .long 148224,192,17,1728576,360,1048592000,3072,3,48016,9476928,0,0,0,0,0,0
    .long 89088,9519936,102912,1892352,116736,2064384,143232,2130706432,143232,2130706432,9477120,9563136,1978368,1978368,9219072,0
    .long 92544,9562944,106368,1935360,120192,2107392,143232,2130706432,143232,2130706432,9477120,9563136,1978368,1978368,9219072,0
    .long 96000,9605952,109824,1978368,143232,2130706432,143232,2130706432,143232,2130706432,9520128,9606144,2021376,2021376,9348096,0
    .long 99456,9605952,113280,2021376,143232,2130706432,143232,2130706432,143232,2130706432,9520128,9606144,2021376,2021376,9348096,0
    .long 85632,226495872,1,49360,92544,226495872,1,49808,109824,226495872,0,10304,109824,226495872,0,10304
    .long 89088,226495872,1,49584,96000,226495872,1,50032,113280,226495872,0,10528,113280,226495872,0,10528
    .long 3849024,17,1338624,1346688,1339488,1347552,36,54,165,0,165,4,9600,89088,50,1065370406
    .long 146688,192,17,729792,216,1048592000,4032,3,20272,4150080,0,0,0,0,0,0
    .long 89088,7096320,92160,7099392,95232,7102464,143232,2130706432,143232,2130706432,7139328,7142400,7145472,7145472,3892224,0
    .long 98688,7139328,101760,7142400,104832,7145472,143232,2130706432,143232,2130706432,7139328,7142400,7145472,7145472,3892224,0
    .long 108288,7182336,111360,7185408,114432,7188480,143232,2130706432,143232,2130706432,7182336,7185408,7188480,7188480,4021248,0
    .long 117888,7225344,120960,7228416,124032,7231488,143232,2130706432,143232,2130706432,7182336,7185408,7188480,7188480,4021248,0
    .long 98688,629155200,0,37184,98688,629155200,16,37200,98688,629155200,32,37216,98688,629155200,32,37216
    .long 108288,629155200,0,37408,108288,629155200,16,37424,108288,629155200,32,37440,108288,629155200,32,37440
    .long 5916480,17,1790208,1798272,1791072,1799136,36,54,221,0,221,4,9600,89088,50,1065370462
    .long 146688,192,17,1117440,216,1048592000,4032,3,31040,6217536,0,0,0,0,0,0
    .long 89088,9504768,92160,9507840,95232,9510912,143232,2130706432,143232,2130706432,9547776,9550848,9553920,9553920,5959680,0
    .long 98688,9547776,101760,9550848,104832,9553920,143232,2130706432,143232,2130706432,9547776,9550848,9553920,9553920,5959680,0
    .long 108288,9590784,111360,9593856,114432,9596928,143232,2130706432,143232,2130706432,9590784,9593856,9596928,9596928,6088704,0
    .long 117888,9590784,120960,9593856,124032,9596928,143232,2130706432,143232,2130706432,9590784,9593856,9596928,9596928,6088704,0
    .long 98688,629155200,0,49728,98688,629155200,16,49744,98688,629155200,32,49760,98688,629155200,32,49760
    .long 108288,629155200,0,49952,108288,629155200,16,49968,108288,629155200,32,49984,108288,629155200,32,49984
    .long 9016128,17,2130706432,2130706432,2130706432,2130706432,36,0,0,0,0,0,0,116736,0,0
    .long 0,192,17,1698624,504,1048592000,0,4,47184,9317184,0,0,0,0,0,0
    .long 89088,9360192,102912,9532224,143232,2130706432,143232,2130706432,143232,2130706432,9317376,9403392,9489408,9575424,9059328,0
    .long 92544,9403200,106368,9575232,143232,2130706432,143232,2130706432,143232,2130706432,9317376,9403392,9489408,9575424,9059328,0
    .long 96000,9446208,109824,9618240,143232,2130706432,143232,2130706432,143232,2130706432,9360384,9446400,9532416,9618432,9188352,0
    .long 99456,9489216,113280,9618240,143232,2130706432,143232,2130706432,143232,2130706432,9360384,9446400,9532416,9618432,9188352,0
    .long 85632,226495872,1,48528,92544,226495872,1,48976,99456,226495872,1,49424,106368,226495872,1,49872
    .long 89088,226495872,1,48752,96000,226495872,1,49200,102912,226495872,1,49648,109824,226495872,1,50096
    .long 3861312,17,4248,4284,197784,197820,8064,54,117,1,117,4,9600,89088,50,1065370348
    .long 146688,43008,17,732096,216,1048592000,4032,3,20336,4162368,0,0,0,0,0,0
    .long 89088,22464,92160,710592,95232,1398720,143232,2130706432,143232,2130706432,22656,710784,1398912,1398912,3904512,0
    .long 98688,22656,101760,710784,104832,1398912,143232,2130706432,143232,2130706432,22656,710784,1398912,1398912,3904512,0
    .long 108288,22848,111360,710976,114432,1399104,143232,2130706432,143232,2130706432,22848,710976,1399104,1399104,4033536,0
    .long 117888,23040,120960,711168,124032,1399296,143232,2130706432,143232,2130706432,22848,710976,1399104,1399104,4033536,0
    .long 98688,629155200,0,118,98688,629155200,16,3702,98688,629155200,32,7286,98688,629155200,32,7286
    .long 108288,629155200,0,119,108288,629155200,16,3703,108288,629155200,32,7287,108288,629155200,32,7287
    .long 5928768,17,6264,6300,199800,199836,8064,54,173,1,173,4,9600,89088,50,1065370414
    .long 146688,43008,17,1119744,216,1048592000,4032,3,31104,6229824,0,0,0,0,0,0
    .long 89088,33216,92160,721344,95232,1409472,143232,2130706432,143232,2130706432,33408,721536,1409664,1409664,5971968,0
    .long 98688,33408,101760,721536,104832,1409664,143232,2130706432,143232,2130706432,33408,721536,1409664,1409664,5971968,0
    .long 108288,33600,111360,721728,114432,1409856,143232,2130706432,143232,2130706432,33600,721728,1409856,1409856,6100992,0
    .long 117888,33792,120960,721920,124032,1410048,143232,2130706432,143232,2130706432,33600,721728,1409856,1409856,6100992,0
    .long 98688,629155200,0,174,98688,629155200,16,3758,98688,629155200,32,7342,98688,629155200,32,7342
    .long 108288,629155200,0,175,108288,629155200,16,3759,108288,629155200,32,7343,108288,629155200,32,7343
    .long 9028416,16,2130706432,2130706432,2130706432,2130706432,36,0,0,0,0,0,0,116736,0,0
    .long 0,192,16,1700928,504,1048592000,0,4,47248,9329472,0,0,0,0,0,0
    .long 89088,9372480,102912,9544512,143232,2130706432,143232,2130706432,143232,2130706432,9329664,9415680,9501696,9587712,9071616,0
    .long 92544,9415488,106368,9587520,143232,2130706432,143232,2130706432,143232,2130706432,9329664,9415680,9501696,9587712,9071616,0
    .long 96000,9458496,109824,9630528,143232,2130706432,143232,2130706432,143232,2130706432,9372672,9458688,9544704,9630720,9200640,0
    .long 99456,9501504,113280,9630528,143232,2130706432,143232,2130706432,143232,2130706432,9372672,9458688,9544704,9630720,9200640,0
    .long 85632,226495872,1,48592,92544,226495872,1,49040,99456,226495872,1,49488,106368,226495872,1,49936
    .long 89088,226495872,1,48816,96000,226495872,1,49264,102912,226495872,1,49712,109824,226495872,1,50160
.size L_table, .-L_table
.section .rodata,"a"
.p2align 6
.amdhsa_kernel standalone__deformable_dcnv1__vision_kernel
  .amdhsa_next_free_vgpr 512
  .amdhsa_next_free_sgpr 102
  .amdhsa_accum_offset 256
  .amdhsa_group_segment_fixed_size 0
  .amdhsa_kernarg_size 48
  .amdhsa_user_sgpr_count 2
  .amdhsa_user_sgpr_kernarg_segment_ptr 1
  .amdhsa_system_sgpr_workgroup_id_x 1
  .amdhsa_float_denorm_mode_32 3
.end_amdhsa_kernel
```

```asm
; @launch grid=(256,1,1) block=(256,1,1) lds=159040

.amdgcn_target "amdgcn-amd-amdhsa--gfx950"
.text
.globl standalone__deformable_dcnv1__vision_kernel
.p2align 8
.type standalone__deformable_dcnv1__vision_kernel,@function
standalone__deformable_dcnv1__vision_kernel:
    s_cmpk_ge_u32 s2, 256
    s_cbranch_scc1 L_end
    s_load_dwordx2 s[8:9], s[0:1], 0
    s_load_dwordx2 s[16:17], s[0:1], 16
    s_load_dwordx2 s[12:13], s[0:1], 8
    s_load_dwordx2 s[20:21], s[0:1], 24
    s_getpc_b64 s[6:7]
L_pc:
    s_lshr_b32 s41, s2, 3
    v_lshrrev_b32 v144, 6, v0
    s_mul_i32 s40, s41, 768
    v_lshl_add_u32 v145, v0, 2, s40
    v_readfirstlane_b32 s3, v144
    global_load_dword v37, v145, s[6:7]
    s_and_b32 s85, s2, 7
    s_lshl_b32 s85, s85, 5
    s_add_u32 s85, s85, s41
    s_add_u32 s81, s85, 8
    s_mul_i32 s80, s81, 2731
    s_lshr_b32 s80, s80, 16
    s_mul_i32 s86, s80, 24
    s_sub_u32 s81, s81, s86
    s_cmp_lt_u32 s80, 3
    s_cselect_b32 s82, 16, 20
    s_cselect_b32 s83, 4, 8
    s_cmp_eq_u32 s80, 0
    s_cselect_b32 s82, 8, s82
    s_cselect_b32 s83, 5, s83
    s_cselect_b32 s86, -1, 47
    s_sub_u32 s84, s81, s82
    s_cselect_b32 s46, 0, s83
    s_mul_i32 s44, s81, 6
    s_mul_i32 s40, s84, s46
    s_add_u32 s86, s86, s44
    s_add_u32 s86, s86, s40
    s_mul_i32 s86, s86, 14
    s_add_u32 s44, s86, s80
    s_mulk_i32 s44, 3072
    s_addk_i32 s44, 9024
    v_and_b32 v1, 63, v0
    s_lshl2_add_u32 s41, s41, s3
    s_mulk_i32 s41, 1296
    v_min_u32 v70, 10, v1
    s_lshl_b32 s40, s3, 6
    v_lshl_add_u32 v70, v70, 7, s41
    s_min_u32 s40, s40, 152
    v_add_u32 v144, s40, v1
    s_lshl4_add_u32 s25, s40, 61440
    v_mul_u32_u24 v64, 5462, v144
    v_lshlrev_b32 v144, 4, v144
    v_lshrrev_b32 v64, 13, v64
    v_and_b32 v64, 32, v64
    v_xor_b32 v8, v144, v64
    v_lshlrev_b32 v5, 4, v1
    v_and_b32 v144, 32, v1
    v_xor_b32 v7, 32, v5
    v_xor_b32 v6, v144, v5
    s_mul_i32 s24, s3, 3072
    s_add_u32 s87, s24, 12288
    s_mov_b32 s41, 43008
    s_mov_b32 s10, 9633792
    s_mov_b32 s11, 0x20000
    s_mov_b32 s18, 165888
    s_mov_b32 s19, s11
    s_mov_b32 m0, s87
    s_waitcnt lgkmcnt(0)
    buffer_load_dword v37, v70, s[16:19], 0 offen
    buffer_load_dwordx4 v5, s[16:19], s24 offen lds
    buffer_load_dwordx4 v6, s[16:19], s24 offen offset:1024 lds
    buffer_load_dwordx4 v7, s[16:19], s24 offen offset:2048 lds
    s_mov_b32 m0, s25
    s_lshr_b32 s57, s3, 1
    buffer_load_dwordx4 v8, s[8:11], s44 offen  lds
    s_addk_i32 m0, 3456
    s_add_u32 s31, s44, s41
    buffer_load_dwordx4 v8, s[8:11], s31 offen  lds
    s_addk_i32 m0, 3456
    s_add_u32 s31, s31, s41
    buffer_load_dwordx4 v8, s[8:11], s31 offen  lds
    s_addk_i32 m0, 3456
    s_add_u32 s31, s31, s41
    buffer_load_dwordx4 v8, s[8:11], s31 offen  lds
    s_addk_i32 m0, 3456
    s_add_u32 s31, s31, s41
    buffer_load_dwordx4 v8, s[8:11], s31 offen  lds
    s_addk_i32 m0, 3456
    s_add_u32 s31, s31, s41
    buffer_load_dwordx4 v8, s[8:11], s31 offen  lds
    s_add_u32 m0, s87, 12288
    v_and_b32 v4, 48, v0
    buffer_load_dwordx4 v5, s[16:19], s87 offen lds
    buffer_load_dwordx4 v6, s[16:19], s87 offen offset:1024 lds
    buffer_load_dwordx4 v7, s[16:19], s87 offen offset:2048 lds
L_issued:
    s_add_u32 s86, s86, s80
    s_and_b32 s2, s3, 1
    s_lshl4_add_u32 s45, s86, 272
    s_mov_b32 s14, 1806336
    s_mov_b32 s15, 0x20000
    s_mov_b32 s22, 9633792
    s_mov_b32 s23, 0x20000
    s_mul_i32 s40, s2, 3072
    s_mul_i32 s26, s57, -104448
    s_add_u32 s26, s26, s40
    s_mul_i32 s27, s57, 6144
    s_add_u32 s27, s27, s40
    s_mul_i32 s28, s57, 55296
    s_add_u32 s28, s28, s40
    s_cmp_eq_u32 s46, 8
    s_cbranch_scc1 L_x
    v_mul_u32_u24 v65, 7282, v1
    s_mul_i32 s85, s82, s80
    s_mul_i32 s86, s83, 3
    v_lshrrev_b32 v65, 16, v65
    s_add_u32 s85, s85, s81
    s_sub_u32 s85, s85, s86
    v_mad_i32_i24 v66, v65, -9, v1
    s_cmp_ge_i32 s85, 92
    s_cselect_b32 s86, -168, 40
    s_cselect_b32 s47, 1, 0
    s_cselect_b32 s52, 8064, 36
    s_cselect_b32 s41, 36, 8064
    v_lshl_add_u32 v67, v65, 2, s3
    s_lshl1_add_u32 s53, s85, s86
    s_lshl3_add_u32 s86, s80, s84
    s_lshl_b32 s86, s86, 1
    v_lshlrev_b32 v71, 2, v66
    s_cmp_eq_u32 s46, 4
    s_cselect_b32 s53, s86, s53
    s_sub_u32 s86, s84, 1
    v_mad_u32_u24 v71, v67, s52, v71
    s_cmp_eq_u32 s46, 5
    s_cselect_b32 s53, s86, s53
    s_cselect_b32 s86, 0x7f000000, 0
    s_mul_i32 s40, s52, 24
    s_cmp_eq_u32 s46, 0
    s_cselect_b32 s40, s40, 0x7f000000
    s_cselect_b32 s85, 54, 36
    v_cmp_gt_u32 vcc, s85, v1
    v_mov_b32 v146, 0x7f000000
    s_mul_i32 s48, s53, s41
    s_add_u32 s49, s48, s41
    v_cndmask_b32 v71, v146, v71, vcc
    s_add_u32 s50, s48, s40
    s_add_u32 s51, s49, s40
    s_add_u32 s48, s48, s86
    v_mul_u32_u24 v68, 11, v66
    v_lshrrev_b32 v68, 5, v68
    v_mad_i32_i24 v69, v68, -3, v66
    s_mul_i32 s54, s47, 42816
    s_mov_b32 s60, 0x435f435f
    s_mov_b64 s[96:97], 0
    s_mov_b64 s[98:99], 0
    s_mov_b32 s59, 0x03020c0c
    s_cmp_eq_u32 s47, 0
    s_cselect_b32 s58, 0x01000c0c, s59
    s_cselect_b32 s59, s59, 0x01000c0c
    s_cselect_b64 vcc, -1, 0
    v_cndmask_b32 v144, v69, v68, vcc
    v_cndmask_b32 v145, v68, v69, vcc
    v_add3_u32 v144, s53, v144, -1
    v_add3_u32 v145, v67, v145, -1
    v_cvt_f32_i32 v100, v144
    v_cvt_f32_i32 v102, v145
    v_add_f32 v101, 1.0, v100
    v_add_f32 v103, 0x41c00000, v102
    v_cvt_pk_bf16_f32 v104, v100, v102
    v_cvt_pk_bf16_f32 v105, v101, v102
    v_cvt_pk_bf16_f32 v106, v100, v103
    v_cvt_pk_bf16_f32 v107, v101, v103
    v_pk_max_i16 v104, v104, 0
    v_pk_max_i16 v105, v105, 0
    v_pk_max_i16 v106, v106, 0
    v_pk_max_i16 v107, v107, 0
    v_pk_min_i16 v104, v104, s60
    v_pk_min_i16 v105, v105, s60
    v_pk_min_i16 v106, v106, s60
    v_pk_min_i16 v107, v107, s60
    v_mul_u32_u24 v144, 48, v67
    v_readfirstlane_b32 s41, v105
    v_lshl_add_u32 v144, v66, 2, v144
    v_add_u32 v168, 146688, v144
    v_add_u32 v170, 149760, v144
    v_add_u32 v172, 147840, v144
    v_add_u32 v174, 150912, v144
    v_mov_b32 v145, s41
    v_lshlrev_b32 v110, 3, v0
    v_cmp_gt_u32 vcc, 36, v1
    v_lshlrev_b32 v144, 2, v1
    v_add_u32 v110, 156928, v110
    v_add_u32 v144, 148992, v144
    v_cndmask_b32 v108, 0, 1, vcc
    ds_write_b64 v110, v[144:145]
    v_and_b32 v2, 15, v0
    v_lshrrev_b32 v3, 4, v1
    s_movk_i32 s42, 192
    v_mov_b32 v34, 158976
    v_mov_b32 v147, 0
    ds_write_b32 v34, v147
    v_bfe_u32 v144, v1, 2, 2
    v_lshl_add_u32 v144, v3, 3, v144
    v_and_b32 v145, 3, v1
    v_mul_u32_u24 v144, 192, v144
    v_and_b32 v146, 1, v3
    v_lshl_add_u32 v144, v145, 3, v144
    s_lshl2_add_u32 s40, s2, 0
    v_xor_b32 v147, s40, v146
    v_lshl_add_u32 v13, v147, 5, v144
    s_lshl2_add_u32 s40, s2, 1
    v_xor_b32 v147, s40, v146
    v_lshl_add_u32 v14, v147, 5, v144
    s_add_u32 s40, s2, 2
    v_xor_b32 v147, s40, v146
    v_lshl_add_u32 v15, v147, 5, v144
    v_lshlrev_b32 v26, 4, v145
    v_lshl_add_u32 v26, v146, 3, v26
    v_xor_b32 v27, 8, v26
    s_mul_i32 s40, s57, 10368
    s_add_u32 s40, s40, 61440
    s_cmp_eq_u32 s80, 10
    s_cselect_b32 s41, 16, 17
    v_add_u32 v144, 0, v2
    v_and_b32 v145, 4, v144
    v_lshl_add_u32 v145, v145, 3, s40
    v_mad_u32_u24 v145, v144, s42, v145
    v_xor_b32 v16, v145, v4
    v_add_u32 v144, 1, v2
    v_and_b32 v145, 4, v144
    v_lshl_add_u32 v145, v145, 3, s40
    v_mad_u32_u24 v145, v144, s42, v145
    v_xor_b32 v17, v145, v4
    v_add_u32 v144, 2, v2
    v_min_u32 v144, s41, v144
    v_and_b32 v145, 4, v144
    v_lshl_add_u32 v145, v145, 3, s40
    v_mad_u32_u24 v145, v144, s42, v145
    v_xor_b32 v18, v145, v4
    v_mul_u32_u24 v144, 5462, v1
    v_lshrrev_b32 v145, 13, v144
    v_lshrrev_b32 v144, 16, v144
    v_and_b32 v145, 32, v145
    v_xor_b32 v145, v145, v5
    v_mad_u32_u24 v9, v144, s54, v145
    v_add_u32 v144, 64, v1
    v_mul_u32_u24 v144, 5462, v144
    v_lshrrev_b32 v145, 13, v144
    v_lshrrev_b32 v144, 16, v144
    v_and_b32 v145, 32, v145
    v_xor_b32 v145, v145, v5
    v_mad_u32_u24 v10, v144, s54, v145
    v_add_u32 v144, 128, v1
    v_mul_u32_u24 v144, 5462, v144
    v_lshrrev_b32 v145, 13, v144
    v_lshrrev_b32 v144, 16, v144
    v_and_b32 v145, 32, v145
    v_xor_b32 v145, v145, v5
    v_mad_u32_u24 v11, v144, s54, v145
    v_add_u32 v144, 152, v1
    v_mul_u32_u24 v144, 5462, v144
    v_lshrrev_b32 v145, 13, v144
    v_lshrrev_b32 v144, 16, v144
    v_and_b32 v145, 32, v145
    v_xor_b32 v145, v145, v5
    v_mad_u32_u24 v12, v144, s54, v145
    s_add_u32 s54, s54, 192
    v_lshrrev_b32 v144, 5, v1
    v_and_b32 v145, 16, v1
    v_lshlrev_b32 v145, 1, v145
    v_lshl_add_u32 v145, v144, 4, v145
    v_lshl_add_u32 v145, s2, 7, v145
    v_mad_u32_u24 v19, v2, s42, v145
    v_mad_u32_u24 v21, v2, s54, v145
    v_lshl_add_u32 v146, s2, 2, v3
    v_lshrrev_b32 v145, 1, v2
    v_and_b32 v145, 6, v145
    v_xor_b32 v145, v145, v146
    v_lshl_add_u32 v145, v2, 3, v145
    s_lshl_b32 s40, s57, 10
    v_lshl_add_u32 v38, v145, 3, s40
    v_lshlrev_b32 v39, 3, v0
    v_lshl_add_u32 v144, s2, 1, v144
    v_lshlrev_b32 v144, 4, v144
    v_xor_b32 v144, v144, v39
    v_bfe_u32 v147, v0, 3, 4
    v_and_or_b32 v144, v144, 56, 64
    v_mad_u32_u24 v20, v147, s42, v144
    v_mad_u32_u24 v22, v147, s54, v144
    s_mul_i32 s40, s57, 129024
    s_add_u32 s56, s44, 43200
    s_add_u32 s56, s56, s40
    s_add_u32 s4, s56, 43008
    s_add_u32 s5, s56, 86016
    s_mul_i32 s55, s45, 36
    s_mul_i32 s41, s46, 36
    s_add_u32 s41, s41, 216
    s_movk_i32 s40, 7488
    v_mov_b32 v146, 0x7f000000
    v_cmp_gt_u32 vcc, s41, v0
    v_mul_u32_u24 v144, 1821, v0
    v_lshrrev_b32 v144, 16, v144
    v_lshlrev_b32 v145, 4, v0
    v_mad_u32_u24 v145, v144, s40, v145
    v_lshlrev_b32 v32, v144, 1
    v_cndmask_b32 v30, v146, v145, vcc
    v_add_u32 v147, 256, v0
    v_cmp_gt_u32 vcc, s41, v147
    v_mul_u32_u24 v144, 1821, v147
    v_lshrrev_b32 v144, 16, v144
    v_lshlrev_b32 v145, 4, v147
    v_mad_u32_u24 v145, v144, s40, v145
    v_lshlrev_b32 v33, v144, 1
    v_cndmask_b32 v31, v146, v145, vcc
    s_lshl_b32 s40, s3, 10
    s_add_u32 s40, s40, 152832
    v_lshrrev_b32 v144, 3, v1
    v_lshl_add_u32 v144, v144, 4, s40
    v_and_or_b32 v24, v1, 4, v144
    v_lshl_add_u32 v25, v2, 4, s40
    v_mul_u32_u24 v145, 192, v2
    v_lshlrev_b32 v144, 2, v2
    v_add_u32 v145, s24, v145
    v_and_or_b32 v109, v144, 48, v145
    v_and_or_b32 v144, v144, 56, v145
    v_mul_u32_u24 v146, 768, v4
    v_xor_b32 v28, v144, v4
    v_add_u32 v109, v109, v146
    v_xor_b32 v29, 8, v28
    s_mul_i32 s40, s57, 3072
    s_add_u32 s40, s40, 146688
    v_mad_u32_u24 v23, v2, 48, s40
    v_lshlrev_b32 v111, 4, v0
    v_add_u32 v111, 152832, v111
    s_sub_u32 s61, 43200, s54
    s_cmp_lt_u32 s45, 14784
    s_cselect_b32 s37, 0, 0x80
    s_cmp_lt_u32 s80, 2
    s_cselect_b32 s40, 0, 0x800000
    s_or_b32 s37, s37, s40
    s_or_b32 s37, s37, 0x3e003e00
    s_mul_i32 s35, s46, 3456
    s_add_u32 s35, s35, 89088
    s_add_u32 s43, s53, s57
    s_mul_i32 s76, s43, s61
    s_cmp_lg_u32 s46, 0
    s_cbranch_scc1 L_mc
    s_cmp_lt_u32 s53, 34
    s_cselect_b32 s39, 1, 0
    s_cselect_b32 s33, 6, 4
    s_subb_u32 s32, s53, 1
    s_movk_i32 s34, 9600
    s_movk_i32 s36, 50
    s_mov_b32 s38, 0x770000
    s_lshl_b32 s40, s54, 4
    s_add_u32 s75, s76, s40
    s_add_u32 s74, s75, s40
    s_add_u32 s65, s32, s3
    s_min_u32 s65, s65, 223
    s_mul_i32 s65, s65, s61
    s_add_u32 s67, s65, s40
    s_add_u32 s69, s67, s40
    s_mul_i32 s64, s3, s34
    s_add_u32 s64, s64, s35
    s_add_u32 s66, s64, 3072
    s_add_u32 s68, s64, 6144
    s_sub_u32 s43, s43, s32
    s_mul_i32 s43, s43, s34
    s_add_u32 s77, s43, 0x80015c00
    s_add_u32 s78, s77, 0x400000
    s_add_u32 s79, s77, 0x800000
L_mc_back:
    v_mov_b32 v84, s79
    s_mov_b32 exec_hi, 0
    v_mov_b32 v84, s78
    s_mov_b32 exec_lo, 0xffff
    v_mov_b32 v84, s77
    s_mov_b64 exec, -1
    v_bfe_u32 v155, v84, 18, 6
    v_and_b32 v148, 0x3ffff, v84
    v_ashrrev_i32 v147, 31, v84
    v_add_u32 v155, v155, v2
    v_add_u32 v149, s34, v148
    v_mad_i32_i24 v147, v147, s34, v148
    v_add_u32 v154, -1, v155
    v_add_u32 v156, 1, v155
    v_max_i32 v154, 0, v154
    v_and_b32 v144, 4, v154
    v_lshlrev_b32 v144, 3, v144
    v_mad_u32_u24 v144, v154, s42, v144
    v_and_b32 v145, 4, v155
    v_lshlrev_b32 v145, 3, v145
    v_mad_u32_u24 v145, v155, s42, v145
    v_and_b32 v146, 4, v156
    v_lshlrev_b32 v146, 3, v146
    v_mad_u32_u24 v146, v156, s42, v146
    s_cmp_eq_u32 s47, 0
    s_cbranch_scc1 L_notr
    v_swap_b32 v144, v147
    v_swap_b32 v145, v148
    v_swap_b32 v146, v149
L_notr:
    v_add_u32 v88, v147, v144
    v_add_u32 v89, v147, v145
    v_add_u32 v90, v147, v146
    v_add_u32 v91, v148, v144
    v_add_u32 v92, v148, v145
    v_add_u32 v93, v148, v146
    v_add_u32 v94, v149, v144
    v_add_u32 v95, v149, v145
    v_add_u32 v96, v149, v146
    v_mad_u32_u24 v144, v4, 48, v23
    ds_write_b128 v144, v[88:91]
    ds_write_b128 v144, v[92:95] offset:16
    ds_write_b32 v144, v96 offset:32
    buffer_load_dword v176, v71, s[12:15], s48 offen
    buffer_load_dword v177, v71, s[12:15], s49 offen
    buffer_load_dword v178, v71, s[12:15], s50 offen
    buffer_load_dword v179, v71, s[12:15], s51 offen
    s_add_u32 m0, s25, 20736
    s_add_u32 s31, s44, 258048
    buffer_load_dwordx4 v8, s[8:11], s31 offen  lds
    s_add_u32 m0, s25, 24192
    s_add_u32 s31, s44, 301056
    buffer_load_dwordx4 v8, s[8:11], s31 offen  lds
    s_waitcnt vmcnt(15) lgkmcnt(0)
    s_barrier
    ds_read_b64_tr_b16 a[0:1], v13 offset:12288
    ds_read_b64_tr_b16 a[2:3], v13 offset:13056
    ds_read_b64_tr_b16 a[4:5], v14 offset:12288
    ds_read_b64_tr_b16 a[6:7], v14 offset:13056
    s_add_u32 m0, s24, 36864
    s_add_u32 s31, s28, 55296
    buffer_load_dwordx4 v5, s[16:19], s31 offen lds
    ds_read_b64_tr_b16 a[8:9], v15 offset:12288
    ds_read_b64_tr_b16 a[10:11], v15 offset:13056
    buffer_load_dwordx4 v6, s[16:19], s31 offen offset:1024 lds
    ds_read_b64_tr_b16 a[12:13], v13 offset:18432
    ds_read_b64_tr_b16 a[14:15], v13 offset:19200
    buffer_load_dwordx4 v7, s[16:19], s31 offen offset:2048 lds
    ds_read_b64_tr_b16 a[16:17], v14 offset:18432
    ds_read_b64_tr_b16 a[18:19], v14 offset:19200
    s_add_u32 m0, s24, 49152
    s_add_u32 s31, s28, 61440
    buffer_load_dwordx4 v5, s[16:19], s31 offen lds
    ds_read_b64_tr_b16 a[20:21], v15 offset:18432
    ds_read_b64_tr_b16 a[22:23], v15 offset:19200
    buffer_load_dwordx4 v6, s[16:19], s31 offen offset:1024 lds
    buffer_load_dwordx4 v7, s[16:19], s31 offen offset:2048 lds
    s_waitcnt lgkmcnt(0)
    s_waitcnt vmcnt(12)
    s_barrier
    ds_read_b128 v[112:115], v16 offset:0
    ds_read_b128 v[116:119], v16 offset:3456
    ds_read_b128 v[120:123], v16 offset:6912
    ds_read_b128 v[124:127], v16 offset:64
    s_waitcnt lgkmcnt(3)
    v_mfma_f32_16x16x32_bf16 v[64:67], a[0:3], v[112:115], 0
    ds_read_b64_tr_b16 a[24:25], v13 offset:24576
    ds_read_b128 v[128:131], v16 offset:3520
    v_mfma_f32_16x16x32_bf16 v[68:71], a[4:7], v[112:115], 0
    ds_read_b64_tr_b16 a[26:27], v13 offset:25344
    s_add_u32 m0, s24, 0
    v_mfma_f32_16x16x32_bf16 v[72:75], a[8:11], v[112:115], 0
    ds_read_b64_tr_b16 a[28:29], v14 offset:24576
    s_waitcnt lgkmcnt(6)
    v_mfma_f32_16x16x32_bf16 v[76:79], a[0:3], v[116:119], 0
    ds_read_b64_tr_b16 a[30:31], v14 offset:25344
    ds_read_b128 v[132:135], v16 offset:6976
    v_mfma_f32_16x16x32_bf16 v[80:83], a[4:7], v[116:119], 0
    ds_read_b64_tr_b16 a[32:33], v15 offset:24576
    s_add_u32 s31, s28, 67584
    v_mfma_f32_16x16x32_bf16 v[84:87], a[8:11], v[116:119], 0
    ds_read_b64_tr_b16 a[34:35], v15 offset:25344
    s_waitcnt lgkmcnt(8)
    v_mfma_f32_16x16x32_bf16 v[88:91], a[0:3], v[120:123], 0
    ds_read_b64_tr_b16 a[36:37], v13 offset:30720
    ds_read_b128 v[136:139], v16 offset:128
    v_mfma_f32_16x16x32_bf16 v[92:95], a[4:7], v[120:123], 0
    ds_read_b64_tr_b16 a[38:39], v13 offset:31488
    buffer_load_dwordx4 v5, s[16:19], s31 offen lds
    v_mfma_f32_16x16x32_bf16 v[96:99], a[8:11], v[120:123], 0
    ds_read_b64_tr_b16 a[40:41], v14 offset:30720
    v_mfma_f32_16x16x32_bf16 v[64:67], a[12:15], v[124:127], v[64:67]
    ds_read_b64_tr_b16 a[42:43], v14 offset:31488
    ds_read_b128 v[140:143], v16 offset:3584
    v_mfma_f32_16x16x32_bf16 v[68:71], a[16:19], v[124:127], v[68:71]
    ds_read_b64_tr_b16 a[44:45], v15 offset:30720
    v_mfma_f32_16x16x32_bf16 v[72:75], a[20:23], v[124:127], v[72:75]
    ds_read_b64_tr_b16 a[46:47], v15 offset:31488
    s_waitcnt lgkmcnt(8)
    v_mfma_f32_16x16x32_bf16 v[76:79], a[12:15], v[128:131], v[76:79]
    ds_read_b128 v[112:115], v16 offset:7040
    buffer_load_dwordx4 v6, s[16:19], s31 offen offset:1024 lds
    v_mfma_f32_16x16x32_bf16 v[80:83], a[16:19], v[128:131], v[80:83]
    v_mfma_f32_16x16x32_bf16 v[84:87], a[20:23], v[128:131], v[84:87]
    v_mfma_f32_16x16x32_bf16 v[88:91], a[12:15], v[132:135], v[88:91]
    ds_read_b128 v[116:119], v17 offset:0
    v_mfma_f32_16x16x32_bf16 v[92:95], a[16:19], v[132:135], v[92:95]
    buffer_load_dwordx4 v7, s[16:19], s31 offen offset:2048 lds
    s_add_u32 m0, s24, 12288
    v_mfma_f32_16x16x32_bf16 v[96:99], a[20:23], v[132:135], v[96:99]
    s_waitcnt vmcnt(6) lgkmcnt(2)
    s_barrier
    v_mfma_f32_16x16x32_bf16 v[64:67], a[24:27], v[136:139], v[64:67]
    ds_read_b64_tr_b16 a[108:109], v13 offset:36864
    ds_read_b128 v[120:123], v17 offset:3456
    v_perm_b32 v144, v176, v176, s58
    v_mfma_f32_16x16x32_bf16 v[68:71], a[28:31], v[136:139], v[68:71]
    ds_read_b64_tr_b16 a[110:111], v13 offset:37632
    s_add_u32 s31, s28, 73728
    v_perm_b32 v145, v176, v176, s59
    v_mfma_f32_16x16x32_bf16 v[72:75], a[32:35], v[136:139], v[72:75]
    ds_read_b64_tr_b16 a[112:113], v14 offset:36864
    buffer_load_dwordx4 v5, s[16:19], s31 offen lds
    v_mfma_f32_16x16x32_bf16 v[76:79], a[24:27], v[140:143], v[76:79]
    ds_read_b64_tr_b16 a[114:115], v14 offset:37632
    ds_read_b128 v[124:127], v17 offset:6912
    v_perm_b32 v146, v177, v177, s58
    v_perm_b32 v147, v177, v177, s59
    v_mfma_f32_16x16x32_bf16 v[80:83], a[28:31], v[140:143], v[80:83]
    ds_read_b64_tr_b16 a[116:117], v15 offset:36864
    v_perm_b32 v148, v178, v178, s58
    v_mfma_f32_16x16x32_bf16 v[84:87], a[32:35], v[140:143], v[84:87]
    ds_read_b64_tr_b16 a[118:119], v15 offset:37632
    v_perm_b32 v149, v178, v178, s59
    s_waitcnt lgkmcnt(8)
    v_mfma_f32_16x16x32_bf16 v[88:91], a[24:27], v[112:115], v[88:91]
    ds_read_b64_tr_b16 a[216:217], v13 offset:43008
    ds_read_b128 v[128:131], v16 offset:3456
    v_perm_b32 v150, v179, v179, s58
    v_mfma_f32_16x16x32_bf16 v[92:95], a[28:31], v[112:115], v[92:95]
    ds_read_b64_tr_b16 a[218:219], v13 offset:43776
    buffer_load_dwordx4 v6, s[16:19], s31 offen offset:1024 lds
    v_mfma_f32_16x16x32_bf16 v[96:99], a[32:35], v[112:115], v[96:99]
    ds_read_b64_tr_b16 a[220:221], v14 offset:43008
    v_perm_b32 v151, v179, v179, s59
    v_add_f32 v144, v100, v144
    v_mfma_f32_16x16x32_bf16 v[64:67], a[36:39], v[116:119], v[64:67]
    ds_read_b64_tr_b16 a[222:223], v14 offset:43776
    ds_read_b128 v[132:135], v16 offset:6912
    v_add_f32 v145, v102, v145
    v_mfma_f32_16x16x32_bf16 v[68:71], a[40:43], v[116:119], v[68:71]
    ds_read_b64_tr_b16 a[224:225], v15 offset:43008
    v_add_f32 v146, v101, v146
    v_mfma_f32_16x16x32_bf16 v[72:75], a[44:47], v[116:119], v[72:75]
    ds_read_b64_tr_b16 a[226:227], v15 offset:43776
    v_add_f32 v147, v102, v147
    s_waitcnt lgkmcnt(8)
    v_mfma_f32_16x16x32_bf16 v[76:79], a[36:39], v[120:123], v[76:79]
    buffer_load_dwordx4 v7, s[16:19], s31 offen offset:2048 lds
    s_add_u32 m0, s24, 24576
    v_mfma_f32_16x16x32_bf16 v[80:83], a[40:43], v[120:123], v[80:83]
    s_add_u32 s31, s28, 24576
    v_add_f32 v148, v100, v148
    v_add_f32 v149, v103, v149
    v_mfma_f32_16x16x32_bf16 v[84:87], a[44:47], v[120:123], v[84:87]
    v_add_f32 v150, v101, v150
    v_add_f32 v151, v103, v151
    v_mfma_f32_16x16x32_bf16 v[88:91], a[36:39], v[124:127], v[88:91]
    v_cvt_pk_bf16_f32 v169, v144, v145
    v_cvt_pk_bf16_f32 v171, v146, v147
    v_mfma_f32_16x16x32_bf16 v[92:95], a[40:43], v[124:127], v[92:95]
    buffer_load_dwordx4 v5, s[16:19], s31 offen lds
    v_cvt_pk_bf16_f32 v173, v148, v149
    v_mfma_f32_16x16x32_bf16 v[96:99], a[44:47], v[124:127], v[96:99]
    s_waitcnt vmcnt(7) lgkmcnt(0)
    s_barrier
    v_mfma_f32_16x16x32_bf16 v[64:67], a[108:111], v[128:131], v[64:67]
    ds_read_b128 v[136:139], v16 offset:10368
    ds_read_b64_tr_b16 a[120:121], v13 offset:49152
    v_mfma_f32_16x16x32_bf16 v[68:71], a[112:115], v[128:131], v[68:71]
    ds_read_b64_tr_b16 a[122:123], v13 offset:49920
    v_cvt_pk_bf16_f32 v175, v150, v151
    v_mfma_f32_16x16x32_bf16 v[72:75], a[116:119], v[128:131], v[72:75]
    ds_read_b64_tr_b16 a[124:125], v14 offset:49152
    buffer_load_dwordx4 v6, s[16:19], s31 offen offset:1024 lds
    v_mfma_f32_16x16x32_bf16 v[76:79], a[108:111], v[132:135], v[76:79]
    ds_read_b64_tr_b16 a[126:127], v14 offset:49920
    ds_read_b128 v[140:143], v16 offset:13824
    v_pk_max_i16 v169, v169, 0
    v_pk_max_i16 v171, v171, 0
    v_mfma_f32_16x16x32_bf16 v[80:83], a[112:115], v[132:135], v[80:83]
    ds_read_b64_tr_b16 a[128:129], v15 offset:49152
    v_pk_max_i16 v173, v173, 0
    v_mfma_f32_16x16x32_bf16 v[84:87], a[116:119], v[132:135], v[84:87]
    ds_read_b64_tr_b16 a[130:131], v15 offset:49920
    v_pk_max_i16 v175, v175, 0
    s_waitcnt lgkmcnt(7)
    v_mfma_f32_16x16x32_bf16 v[88:91], a[108:111], v[136:139], v[88:91]
    ds_read_b64_tr_b16 a[228:229], v13 offset:55296
    ds_read_b128 v[112:115], v16 offset:3520
    v_pk_min_i16 v169, v169, s60
    v_mfma_f32_16x16x32_bf16 v[92:95], a[112:115], v[136:139], v[92:95]
    ds_read_b64_tr_b16 a[230:231], v13 offset:56064
    buffer_load_dwordx4 v7, s[16:19], s31 offen offset:2048 lds
    v_mfma_f32_16x16x32_bf16 v[96:99], a[116:119], v[136:139], v[96:99]
    ds_read_b64_tr_b16 a[232:233], v14 offset:55296
    s_mov_b32 m0, s64
    v_pk_min_i16 v171, v171, s60
    v_pk_min_i16 v173, v173, s60
    v_mfma_f32_16x16x32_bf16 v[64:67], a[216:219], v[132:135], v[64:67]
    ds_read_b64_tr_b16 a[234:235], v14 offset:56064
    ds_read_b128 v[116:119], v16 offset:6976
    v_pk_min_i16 v175, v175, s60
    v_mfma_f32_16x16x32_bf16 v[68:71], a[220:223], v[132:135], v[68:71]
    ds_read_b64_tr_b16 a[236:237], v15 offset:55296
    v_xor_b32 v144, v169, v104
    v_mfma_f32_16x16x32_bf16 v[72:75], a[224:227], v[132:135], v[72:75]
    ds_read_b64_tr_b16 a[238:239], v15 offset:56064
    buffer_load_dwordx4 v9, s[8:11], s65 offen  lds
    v_mfma_f32_16x16x32_bf16 v[76:79], a[216:219], v[136:139], v[76:79]
    ds_read_b128 v[120:123], v16 offset:10432
    v_xor_b32 v145, v171, v105
    v_xor_b32 v146, v173, v106
    v_mfma_f32_16x16x32_bf16 v[80:83], a[220:223], v[136:139], v[80:83]
    v_xor_b32 v147, v175, v107
    v_mad_u32_u16 v148, v144, v144, 0 op_sel:[0,1,0,0]
    v_mfma_f32_16x16x32_bf16 v[84:87], a[224:227], v[136:139], v[84:87]
    v_mad_u32_u16 v148, v145, v145, v148 op_sel:[0,1,0,0]
    s_waitcnt lgkmcnt(5)
    v_mfma_f32_16x16x32_bf16 v[88:91], a[216:219], v[140:143], v[88:91]
    buffer_load_dwordx4 v10, s[8:11], s65 offen offset:1024  lds
    v_mad_u32_u16 v148, v146, v146, v148 op_sel:[0,1,0,0]
    v_mfma_f32_16x16x32_bf16 v[92:95], a[220:223], v[140:143], v[92:95]
    v_mad_u32_u16 v148, v147, v147, v148 op_sel:[0,1,0,0]
    v_cmp_ne_u32 vcc, 0, v148
    v_mfma_f32_16x16x32_bf16 v[96:99], a[224:227], v[140:143], v[96:99]
    s_waitcnt vmcnt(8) lgkmcnt(1)
    s_barrier
    v_mfma_f32_16x16x32_bf16 v[64:67], a[120:123], v[112:115], v[64:67]
    ds_read_b64_tr_b16 a[132:133], v13 offset:0
    v_cmp_ne_u32 s[80:81], 0, v144
    v_mfma_f32_16x16x32_bf16 v[68:71], a[124:127], v[112:115], v[68:71]
    ds_read_b64_tr_b16 a[134:135], v13 offset:768
    buffer_load_dwordx4 v11, s[8:11], s65 offen offset:2048  lds
    v_mfma_f32_16x16x32_bf16 v[72:75], a[128:131], v[112:115], v[72:75]
    ds_read_b64_tr_b16 a[136:137], v14 offset:0
    v_cmp_ne_u32 s[82:83], 0, v145
    v_mfma_f32_16x16x32_bf16 v[76:79], a[120:123], v[116:119], v[76:79]
    ds_read_b64_tr_b16 a[138:139], v14 offset:768
    ds_read_b128 v[124:127], v16 offset:13888
    v_cmp_ne_u32 s[84:85], 0, v146
    v_mfma_f32_16x16x32_bf16 v[80:83], a[124:127], v[116:119], v[80:83]
    ds_read_b64_tr_b16 a[140:141], v15 offset:0
    v_cmp_ne_u32 s[86:87], 0, v147
    v_mfma_f32_16x16x32_bf16 v[84:87], a[128:131], v[116:119], v[84:87]
    buffer_load_dwordx4 v12, s[8:11], s65 offen offset:2432  lds
    s_waitcnt lgkmcnt(6)
    v_mfma_f32_16x16x32_bf16 v[88:91], a[120:123], v[120:123], v[88:91]
    ds_read_b64_tr_b16 a[142:143], v15 offset:768
    ds_read_b64_tr_b16 a[240:241], v13 offset:6144
    s_cbranch_vccnz L_doubles
L_singles:
    s_bcnt1_i32_b64 s48, s[80:81]
    v_mfma_f32_16x16x32_bf16 v[92:95], a[124:127], v[120:123], v[92:95]
    ds_read_b64_tr_b16 a[242:243], v13 offset:6912
    ds_read_b128 v[128:131], v16 offset:3584
    s_bcnt1_i32_b64 s49, s[82:83]
    v_mfma_f32_16x16x32_bf16 v[96:99], a[128:131], v[120:123], v[96:99]
    ds_read_b64_tr_b16 a[244:245], v14 offset:6144
    s_add_u32 m0, s24, 36864
    s_bcnt1_i32_b64 s50, s[84:85]
    v_mfma_f32_16x16x32_bf16 v[64:67], a[228:231], v[116:119], v[64:67]
    ds_read_b64_tr_b16 a[246:247], v14 offset:6912
    ds_read_b128 v[132:135], v16 offset:7040
    s_bcnt1_i32_b64 s51, s[86:87]
    v_mfma_f32_16x16x32_bf16 v[68:71], a[232:235], v[116:119], v[68:71]
    ds_read_b64_tr_b16 a[248:249], v15 offset:6144
    s_add_u32 s31, s26, 135168
    s_lshr_b32 s52, s81, 4
    v_mfma_f32_16x16x32_bf16 v[72:75], a[236:239], v[116:119], v[72:75]
    ds_read_b64_tr_b16 a[250:251], v15 offset:6912
    buffer_load_dwordx4 v5, s[16:19], s31 offen lds
    v_mfma_f32_16x16x32_bf16 v[76:79], a[228:231], v[120:123], v[76:79]
    ds_read_b128 v[136:139], v16 offset:10496
    s_lshr_b32 s61, s83, 4
    v_mfma_f32_16x16x32_bf16 v[80:83], a[232:235], v[120:123], v[80:83]
    s_bcnt1_i32_b32 s52, s52
    s_bcnt1_i32_b32 s61, s61
    v_mfma_f32_16x16x32_bf16 v[84:87], a[236:239], v[120:123], v[84:87]
    s_add_u32 s51, s51, s50
    s_waitcnt lgkmcnt(5)
    v_mfma_f32_16x16x32_bf16 v[88:91], a[228:231], v[124:127], v[88:91]
    buffer_load_dwordx4 v6, s[16:19], s31 offen offset:1024 lds
    s_add_u32 s43, s48, s49
    v_mfma_f32_16x16x32_bf16 v[92:95], a[232:235], v[124:127], v[92:95]
    s_add_u32 s43, s43, s51
    s_add_u32 s51, s51, s52
    v_mfma_f32_16x16x32_bf16 v[96:99], a[236:239], v[124:127], v[96:99]
    s_waitcnt vmcnt(9) lgkmcnt(1)
    s_barrier
    v_mfma_f32_16x16x32_bf16 v[64:67], a[132:135], v[128:131], v[64:67]
    ds_read_b64_tr_b16 a[144:145], v13 offset:12288
    s_add_u32 s51, s51, s61
    v_mfma_f32_16x16x32_bf16 v[68:71], a[136:139], v[128:131], v[68:71]
    ds_read_b64_tr_b16 a[146:147], v13 offset:13056
    buffer_load_dwordx4 v7, s[16:19], s31 offen offset:2048 lds
    v_mfma_f32_16x16x32_bf16 v[72:75], a[140:143], v[128:131], v[72:75]
    ds_read_b64_tr_b16 a[148:149], v14 offset:12288
    s_add_u32 m0, s24, 49152
    s_add_u32 s40, s96, s97
    v_mfma_f32_16x16x32_bf16 v[76:79], a[132:135], v[132:135], v[76:79]
    ds_read_b64_tr_b16 a[150:151], v14 offset:13056
    ds_read_b128 v[140:143], v16 offset:13952
    s_sub_u32 s40, 64, s40
    v_mfma_f32_16x16x32_bf16 v[80:83], a[136:139], v[132:135], v[80:83]
    ds_read_b64_tr_b16 a[152:153], v15 offset:12288
    s_add_u32 s31, s28, 86016
    s_add_u32 s62, s51, s96
    v_mfma_f32_16x16x32_bf16 v[84:87], a[140:143], v[132:135], v[84:87]
    ds_read_b64_tr_b16 a[154:155], v15 offset:13056
    s_lshl_b32 s41, s3, 6
    s_waitcnt lgkmcnt(7)
    v_mfma_f32_16x16x32_bf16 v[88:91], a[132:135], v[136:139], v[88:91]
    ds_read_b64_tr_b16 a[252:253], v13 offset:18432
    ds_read_b128 v[112:115], v17 offset:3456
    s_add_u32 s41, s41, s96
    v_mfma_f32_16x16x32_bf16 v[92:95], a[136:139], v[136:139], v[92:95]
    ds_read_b64_tr_b16 a[254:255], v13 offset:19200
    buffer_load_dwordx4 v5, s[16:19], s31 offen lds
    v_mfma_f32_16x16x32_bf16 v[96:99], a[140:143], v[136:139], v[96:99]
    ds_read_b64_tr_b16 v[188:189], v14 offset:18432
    s_add_u32 s41, s41, 19616
    v_mfma_f32_16x16x32_bf16 v[64:67], a[240:243], v[132:135], v[64:67]
    ds_read_b64_tr_b16 v[190:191], v14 offset:19200
    ds_read_b128 v[116:119], v17 offset:6912
    v_mfma_f32_16x16x32_bf16 v[68:71], a[244:247], v[132:135], v[68:71]
    ds_read_b64_tr_b16 v[192:193], v15 offset:18432
    v_mfma_f32_16x16x32_bf16 v[72:75], a[248:251], v[132:135], v[72:75]
    ds_read_b64_tr_b16 v[194:195], v15 offset:19200
    buffer_load_dwordx4 v6, s[16:19], s31 offen offset:1024 lds
    v_mfma_f32_16x16x32_bf16 v[76:79], a[240:243], v[136:139], v[76:79]
    ds_read_b128 v[120:123], v17 offset:10368
    s_cmp_gt_u32 s62, 32
    s_cselect_b32 s43, 65, s43
    s_cmp_gt_u32 s43, s40
    s_cbranch_scc1 L_bfail1
L_bfail1_back:
    v_mul_u32_u24 v144, s40, v108
    v_mfma_f32_16x16x32_bf16 v[80:83], a[244:247], v[136:139], v[80:83]
    s_sub_u32 s40, s40, s48
    s_add_u32 s41, s41, s52
    v_mfma_f32_16x16x32_bf16 v[84:87], a[248:251], v[136:139], v[84:87]
    v_mul_u32_u24 v145, s40, v108
    s_waitcnt lgkmcnt(5)
    v_mfma_f32_16x16x32_bf16 v[88:91], a[240:243], v[140:143], v[88:91]
    buffer_load_dwordx4 v7, s[16:19], s31 offen offset:2048 lds
    s_mov_b32 m0, s66
    v_mfma_f32_16x16x32_bf16 v[92:95], a[244:247], v[140:143], v[92:95]
    s_sub_u32 s48, s41, s48
    s_add_u32 s41, s41, s61
    v_mfma_f32_16x16x32_bf16 v[96:99], a[248:251], v[140:143], v[96:99]
    s_waitcnt vmcnt(10) lgkmcnt(1)
    s_barrier
    v_mfma_f32_16x16x32_bf16 v[64:67], a[144:147], v[112:115], v[64:67]
    ds_read_b64_tr_b16 a[48:49], v13 offset:24576
    s_sub_u32 s49, s41, s49
    v_mfma_f32_16x16x32_bf16 v[68:71], a[148:151], v[112:115], v[68:71]
    buffer_load_dwordx4 v9, s[8:11], s67 offen  lds
    ds_read_b64_tr_b16 a[50:51], v13 offset:25344
    v_mfma_f32_16x16x32_bf16 v[72:75], a[152:155], v[112:115], v[72:75]
    ds_read_b64_tr_b16 a[52:53], v14 offset:24576
    s_add_u32 s50, s50, s41
    v_mbcnt_lo_u32_b32 v144, s80, v144
    v_mfma_f32_16x16x32_bf16 v[76:79], a[144:147], v[116:119], v[76:79]
    ds_read_b64_tr_b16 a[54:55], v14 offset:25344
    ds_read_b128 v[124:127], v17 offset:13824
    v_mbcnt_lo_u32_b32 v145, s82, v145
    v_mfma_f32_16x16x32_bf16 v[80:83], a[148:151], v[116:119], v[80:83]
    ds_read_b64_tr_b16 a[56:57], v15 offset:24576
    v_mbcnt_lo_u32_b32 v146, s84, 0
    v_mfma_f32_16x16x32_bf16 v[84:87], a[152:155], v[116:119], v[84:87]
    buffer_load_dwordx4 v10, s[8:11], s67 offen offset:1024  lds
    s_waitcnt lgkmcnt(6)
    v_mfma_f32_16x16x32_bf16 v[88:91], a[144:147], v[120:123], v[88:91]
    ds_read_b64_tr_b16 a[58:59], v15 offset:25344
    ds_read_b64_tr_b16 a[156:157], v13 offset:30720
    v_mbcnt_lo_u32_b32 v147, s86, 0
    v_mbcnt_hi_u32_b32 v144, s81, v144
    v_mfma_f32_16x16x32_bf16 v[92:95], a[148:151], v[120:123], v[92:95]
    ds_read_b64_tr_b16 a[158:159], v13 offset:31488
    ds_read_b128 v[128:131], v17 offset:64
    v_mbcnt_hi_u32_b32 v145, s83, v145
    v_mfma_f32_16x16x32_bf16 v[96:99], a[152:155], v[120:123], v[96:99]
    buffer_load_dwordx4 v11, s[8:11], s67 offen offset:2048  lds
    buffer_load_dwordx4 v12, s[8:11], s67 offen offset:2432  lds
    v_mfma_f32_16x16x32_bf16 v[64:67], a[252:255], v[116:119], v[64:67]
    ds_read_b64_tr_b16 a[160:161], v14 offset:30720
    ds_read_b64_tr_b16 a[162:163], v14 offset:31488
    v_mbcnt_hi_u32_b32 v146, s85, v146
    v_mbcnt_hi_u32_b32 v147, s87, v147
    v_mfma_f32_16x16x32_bf16 v[68:71], v[188:191], v[116:119], v[68:71]
    ds_read_b64_tr_b16 a[164:165], v15 offset:30720
    ds_read_b128 v[132:135], v17 offset:3520
    v_add_lshl_u32 v144, v144, s48, 3
    v_mfma_f32_16x16x32_bf16 v[72:75], v[192:195], v[116:119], v[72:75]
    ds_read_b64_tr_b16 a[166:167], v15 offset:31488
    s_add_u32 m0, s24, 0
    v_add_lshl_u32 v145, v145, s49, 3
    v_mfma_f32_16x16x32_bf16 v[76:79], a[252:255], v[120:123], v[76:79]
    ds_read_b128 v[136:139], v17 offset:6976
    s_add_u32 s31, s28, 36864
    v_add_lshl_u32 v146, v146, s41, 3
    v_mfma_f32_16x16x32_bf16 v[80:83], v[188:191], v[120:123], v[80:83]
    buffer_load_dwordx4 v5, s[16:19], s31 offen lds
    v_add_lshl_u32 v147, v147, s50, 3
    v_mfma_f32_16x16x32_bf16 v[84:87], v[192:195], v[120:123], v[84:87]
    v_cndmask_b32 v144, v111, v144, s[80:81]
    s_waitcnt lgkmcnt(6)
    v_mfma_f32_16x16x32_bf16 v[88:91], a[252:255], v[124:127], v[88:91]
    v_cndmask_b32 v145, v111, v145, s[82:83]
    v_cndmask_b32 v146, v111, v146, s[84:85]
    v_mfma_f32_16x16x32_bf16 v[92:95], v[188:191], v[124:127], v[92:95]
    v_cndmask_b32 v147, v111, v147, s[86:87]
    ds_write_b64 v144, v[168:169]
    v_mfma_f32_16x16x32_bf16 v[96:99], v[192:195], v[124:127], v[96:99]
    s_waitcnt vmcnt(8) lgkmcnt(2)
    s_barrier
    v_mfma_f32_16x16x32_bf16 v[64:67], a[48:51], v[128:131], v[64:67]
    ds_read_b64_tr_b16 v[196:197], v13 offset:36864
    buffer_load_dwordx4 v6, s[16:19], s31 offen offset:1024 lds
    v_mfma_f32_16x16x32_bf16 v[68:71], a[52:55], v[128:131], v[68:71]
    ds_read_b64_tr_b16 v[198:199], v13 offset:37632
    ds_write_b64 v145, v[170:171]
    v_mfma_f32_16x16x32_bf16 v[72:75], a[56:59], v[128:131], v[72:75]
    ds_read_b64_tr_b16 v[200:201], v14 offset:36864
    ds_write_b64 v146, v[172:173]
    v_mfma_f32_16x16x32_bf16 v[76:79], a[48:51], v[132:135], v[76:79]
    ds_read_b64_tr_b16 v[202:203], v14 offset:37632
    ds_read_b128 v[140:143], v17 offset:10432
    ds_write_b64 v147, v[174:175]
    v_mfma_f32_16x16x32_bf16 v[80:83], a[52:55], v[132:135], v[80:83]
    buffer_load_dwordx4 v7, s[16:19], s31 offen offset:2048 lds
    ds_read_b64_tr_b16 v[204:205], v15 offset:36864
    v_mfma_f32_16x16x32_bf16 v[84:87], a[56:59], v[132:135], v[84:87]
    ds_read_b64_tr_b16 v[206:207], v15 offset:37632
    ds_read_b64 v[144:145], v110
    s_and_b32 s82, s98, 0x55555555
    s_waitcnt lgkmcnt(11)
    v_mfma_f32_16x16x32_bf16 v[88:91], a[48:51], v[136:139], v[88:91]
    ds_read_b64_tr_b16 a[60:61], v13 offset:43008
    s_add_u32 m0, s24, 12288
    s_and_b32 s83, s99, 0x55555555
    v_mfma_f32_16x16x32_bf16 v[92:95], a[52:55], v[136:139], v[92:95]
    ds_read_b64_tr_b16 a[62:63], v13 offset:43776
    s_add_u32 s31, s26, 147456
    s_andn2_b64 s[80:81], s[98:99], s[82:83]
    v_mfma_f32_16x16x32_bf16 v[96:99], a[56:59], v[136:139], v[96:99]
    ds_read_b64_tr_b16 a[64:65], v14 offset:43008
    buffer_load_dwordx4 v5, s[16:19], s31 offen lds
    v_mfma_f32_16x16x32_bf16 v[64:67], a[156:159], v[132:135], v[64:67]
    ds_read_b64_tr_b16 a[66:67], v14 offset:43776
    s_mov_b32 s88, 0x00040001
    v_mfma_f32_16x16x32_bf16 v[68:71], a[160:163], v[132:135], v[68:71]
    ds_read_b64_tr_b16 a[68:69], v15 offset:43008
    s_mov_b32 s89, 0x00400010
    v_mfma_f32_16x16x32_bf16 v[72:75], a[164:167], v[132:135], v[72:75]
    ds_read_b64_tr_b16 a[70:71], v15 offset:43776
    s_lshl_b64 s[90:91], s[88:89], 1
    v_mfma_f32_16x16x32_bf16 v[76:79], a[156:159], v[136:139], v[76:79]
    ds_read_b128 v[112:115], v17 offset:13888
    buffer_load_dwordx4 v6, s[16:19], s31 offen offset:1024 lds
    v_mfma_f32_16x16x32_bf16 v[80:83], a[160:163], v[136:139], v[80:83]
    s_lshl_b64 s[92:93], s[88:89], 8
    s_lshl_b64 s[94:95], s[88:89], 9
    v_mfma_f32_16x16x32_bf16 v[84:87], a[164:167], v[136:139], v[84:87]
    s_mov_b32 s96, 0x7fff7fff
    s_waitcnt lgkmcnt(4)
    v_mfma_f32_16x16x32_bf16 v[88:91], a[156:159], v[140:143], v[88:91]
    ds_read_b128 v[116:119], v17 offset:128
    ds_write_b32 v144, v109
    v_mfma_f32_16x16x32_bf16 v[92:95], a[160:163], v[140:143], v[92:95]
    buffer_load_dwordx4 v7, s[16:19], s31 offen offset:2048 lds
    s_add_u32 m0, s24, 24576
    v_mfma_f32_16x16x32_bf16 v[96:99], a[164:167], v[140:143], v[96:99]
    s_waitcnt vmcnt(10) lgkmcnt(3)
    s_barrier
    v_mfma_f32_16x16x32_bf16 v[64:67], v[196:199], v[136:139], v[64:67]
    ds_read_b64_tr_b16 a[168:169], v13 offset:49152
    ds_read_b128 v[120:123], v17 offset:3584
    v_mfma_f32_16x16x32_bf16 v[68:71], v[200:203], v[136:139], v[68:71]
    ds_read_b64_tr_b16 a[170:171], v13 offset:49920
    s_add_u32 s31, s28, 98304
    v_mfma_f32_16x16x32_bf16 v[72:75], v[204:207], v[136:139], v[72:75]
    ds_read_b64_tr_b16 a[172:173], v14 offset:49152
    buffer_load_dwordx4 v5, s[16:19], s31 offen lds
    v_mfma_f32_16x16x32_bf16 v[76:79], v[196:199], v[140:143], v[76:79]
    ds_read_b64_tr_b16 a[174:175], v14 offset:49920
    ds_read_b128 v[124:127], v17 offset:7040
    v_mfma_f32_16x16x32_bf16 v[80:83], v[200:203], v[140:143], v[80:83]
    ds_read_b64_tr_b16 a[176:177], v15 offset:49152
    v_lshlrev_b32 v146, 16, v145
    v_mfma_f32_16x16x32_bf16 v[84:87], v[204:207], v[140:143], v[84:87]
    ds_read_b64_tr_b16 a[178:179], v15 offset:49920
    s_waitcnt lgkmcnt(8)
    v_mfma_f32_16x16x32_bf16 v[88:91], v[196:199], v[112:115], v[88:91]
    ds_read_b64_tr_b16 v[208:209], v13 offset:55296
    buffer_load_dwordx4 v6, s[16:19], s31 offen offset:1024 lds
    v_mfma_f32_16x16x32_bf16 v[92:95], v[200:203], v[112:115], v[92:95]
    ds_read_b64_tr_b16 v[210:211], v13 offset:56064
    v_and_b32 v147, 0xffff0000, v145
    v_mfma_f32_16x16x32_bf16 v[96:99], v[204:207], v[112:115], v[96:99]
    ds_read_b64_tr_b16 v[212:213], v14 offset:55296
    v_fract_f32 v152, v146
    v_mfma_f32_16x16x32_bf16 v[64:67], a[60:63], v[116:119], v[64:67]
    ds_read_b64_tr_b16 v[214:215], v14 offset:56064
    v_fract_f32 v153, v147
    v_mfma_f32_16x16x32_bf16 v[68:71], a[64:67], v[116:119], v[68:71]
    ds_read_b64_tr_b16 v[216:217], v15 offset:55296
    buffer_load_dwordx4 v7, s[16:19], s31 offen offset:2048 lds
    v_mfma_f32_16x16x32_bf16 v[72:75], a[68:71], v[116:119], v[72:75]
    ds_read_b64_tr_b16 v[218:219], v15 offset:56064
    s_waitcnt lgkmcnt(6)
    v_mfma_f32_16x16x32_bf16 v[76:79], a[60:63], v[120:123], v[76:79]
    ds_read_b128 v[128:131], v17 offset:10496
    s_mov_b32 m0, s68
    v_ceil_f32 v149, v146
    v_mfma_f32_16x16x32_bf16 v[80:83], a[64:67], v[120:123], v[80:83]
    v_ceil_f32 v151, v147
    v_sub_f32 v154, 1.0, v152
    v_mfma_f32_16x16x32_bf16 v[84:87], a[68:71], v[120:123], v[84:87]
    buffer_load_dwordx4 v9, s[8:11], s69 offen  lds
    v_sub_f32 v155, 1.0, v153
    v_mfma_f32_16x16x32_bf16 v[88:91], a[60:63], v[124:127], v[88:91]
    v_cvt_u32_f32 v148, v146
    v_cvt_u32_f32 v150, v147
    v_mfma_f32_16x16x32_bf16 v[92:95], a[64:67], v[124:127], v[92:95]
    v_cvt_pk_bf16_f32 v155, v154, v155
    v_cvt_u32_f32 v149, v149
    v_mfma_f32_16x16x32_bf16 v[96:99], a[68:71], v[124:127], v[96:99]
    s_waitcnt vmcnt(7) lgkmcnt(1)
    s_barrier
    v_mfma_f32_16x16x32_bf16 v[64:67], a[168:171], v[120:123], v[64:67]
    buffer_load_dwordx4 v10, s[8:11], s69 offen offset:1024  lds
    ds_read_b64_tr_b16 a[72:73], v13 offset:0
    v_mfma_f32_16x16x32_bf16 v[68:71], a[172:175], v[120:123], v[68:71]
    ds_read_b64_tr_b16 a[74:75], v13 offset:768
    v_cvt_u32_f32 v151, v151
    v_mfma_f32_16x16x32_bf16 v[72:75], a[176:179], v[120:123], v[72:75]
    ds_read_b64_tr_b16 a[76:77], v14 offset:0
    v_lshlrev_b32 v154, 16, v155
    v_mfma_f32_16x16x32_bf16 v[76:79], a[168:171], v[124:127], v[76:79]
    ds_read_b128 v[132:135], v17 offset:13952
    ds_read_b64_tr_b16 a[78:79], v14 offset:768
    v_mfma_f32_16x16x32_bf16 v[80:83], a[172:175], v[124:127], v[80:83]
    buffer_load_dwordx4 v11, s[8:11], s69 offen offset:2048  lds
    ds_read_b64_tr_b16 a[80:81], v15 offset:0
    v_mfma_f32_16x16x32_bf16 v[84:87], a[176:179], v[124:127], v[84:87]
    ds_read_b64_tr_b16 a[82:83], v15 offset:768
    v_and_b32 v155, 0xffff0000, v155
    v_mul_f32 v159, v152, v153
    s_waitcnt lgkmcnt(7)
    v_mfma_f32_16x16x32_bf16 v[88:91], a[168:171], v[128:131], v[88:91]
    ds_read_b128 v[136:139], v18 offset:0
    ds_read_b64_tr_b16 a[180:181], v13 offset:6144
    v_mul_f32 v157, v154, v153
    v_mfma_f32_16x16x32_bf16 v[92:95], a[172:175], v[128:131], v[92:95]
    ds_read_b64_tr_b16 a[182:183], v13 offset:6912
    v_mul_f32 v158, v152, v155
    v_mfma_f32_16x16x32_bf16 v[96:99], a[176:179], v[128:131], v[96:99]
    buffer_load_dwordx4 v12, s[8:11], s69 offen offset:2432  lds
    ds_read_b64_tr_b16 a[184:185], v14 offset:6144
    v_mfma_f32_16x16x32_bf16 v[64:67], v[208:211], v[124:127], v[64:67]
    ds_read_b128 v[140:143], v18 offset:3456
    ds_read_b64_tr_b16 a[186:187], v14 offset:6912
    v_mul_f32 v156, v154, v155
    v_subrev_u32 v148, s32, v148
    v_mfma_f32_16x16x32_bf16 v[68:71], v[212:215], v[124:127], v[68:71]
    ds_read_b64_tr_b16 a[188:189], v15 offset:6144
    s_add_u32 m0, s24, 36864
    v_subrev_u32 v149, s32, v149
    v_mfma_f32_16x16x32_bf16 v[72:75], v[216:219], v[124:127], v[72:75]
    ds_read_b64_tr_b16 a[190:191], v15 offset:6912
    s_add_u32 s31, s28, 49152
    v_add_f32 v160, v157, v158
    v_mfma_f32_16x16x32_bf16 v[76:79], v[208:211], v[128:131], v[76:79]
    ds_read_b128 v[112:115], v18 offset:6912
    buffer_load_dwordx4 v5, s[16:19], s31 offen lds
    v_mfma_f32_16x16x32_bf16 v[80:83], v[212:215], v[128:131], v[80:83]
    v_cvt_pk_bf16_f32 v167, v158, v159
    v_max_u32 v146, v148, v149
    v_mfma_f32_16x16x32_bf16 v[84:87], v[216:219], v[128:131], v[84:87]
    v_cndmask_b32 v157, v160, v157, s[98:99]
    s_waitcnt lgkmcnt(5)
    v_mfma_f32_16x16x32_bf16 v[88:91], v[208:211], v[132:135], v[88:91]
    v_cndmask_b32 v167, 0, v167, s[98:99]
    v_cmp_le_u32 vcc, s33, v146
    v_mfma_f32_16x16x32_bf16 v[92:95], v[212:215], v[132:135], v[92:95]
    buffer_load_dwordx4 v6, s[16:19], s31 offen offset:1024 lds
    v_cmp_le_u32 s[84:85], s36, v151
    v_mfma_f32_16x16x32_bf16 v[96:99], v[216:219], v[132:135], v[96:99]
    s_waitcnt vmcnt(9) lgkmcnt(1)
    s_barrier
    v_mfma_f32_16x16x32_bf16 v[64:67], a[72:75], v[136:139], v[64:67]
    ds_read_b64_tr_b16 v[220:221], v13 offset:12288
    v_cvt_pk_bf16_f32 v166, v156, v157
    v_mfma_f32_16x16x32_bf16 v[68:71], a[76:79], v[136:139], v[68:71]
    ds_read_b64_tr_b16 v[222:223], v13 offset:13056
    v_cndmask_b32 v146, v148, v149, s[80:81]
    v_mfma_f32_16x16x32_bf16 v[72:75], a[80:83], v[136:139], v[72:75]
    buffer_load_dwordx4 v7, s[16:19], s31 offen offset:2048 lds
    ds_read_b64_tr_b16 v[224:225], v14 offset:12288
    v_mfma_f32_16x16x32_bf16 v[76:79], a[72:75], v[140:143], v[76:79]
    s_cmp_lg_u32 s39, 0
    s_cbranch_scc1 L_extra
L_extra_back:
    v_cndmask_b32 v147, v149, v148, s[82:83]
    v_and_b32 v160, 4, v150
    v_mfma_f32_16x16x32_bf16 v[80:83], a[76:79], v[140:143], v[80:83]
    ds_read_b128 v[116:119], v18 offset:10368
    ds_read_b64_tr_b16 v[226:227], v14 offset:13056
    v_lshl_add_u32 v160, v160, 3, s35
    v_mfma_f32_16x16x32_bf16 v[84:87], a[80:83], v[140:143], v[84:87]
    ds_read_b64_tr_b16 v[228:229], v15 offset:12288
    v_mad_u32_u24 v160, v150, s42, v160
    s_waitcnt lgkmcnt(6)
    v_mfma_f32_16x16x32_bf16 v[88:91], a[72:75], v[112:115], v[88:91]
    ds_read_b64_tr_b16 v[230:231], v15 offset:13056
    ds_read_b64_tr_b16 a[84:85], v13 offset:18432
    v_mad_u32_u24 v164, v146, s34, v160
    v_mfma_f32_16x16x32_bf16 v[92:95], a[76:79], v[112:115], v[92:95]
    ds_read_b64_tr_b16 a[86:87], v13 offset:19200
    s_add_u32 m0, s24, 49152
    v_and_b32 v160, 4, v151
    v_mfma_f32_16x16x32_bf16 v[96:99], a[80:83], v[112:115], v[96:99]
    ds_read_b64_tr_b16 a[88:89], v14 offset:18432
    s_add_u32 s31, s28, 159744
    v_lshl_add_u32 v160, v160, 3, s35
    v_mfma_f32_16x16x32_bf16 v[64:67], a[180:183], v[140:143], v[64:67]
    ds_read_b64_tr_b16 a[90:91], v14 offset:19200
    buffer_load_dwordx4 v5, s[16:19], s31 offen lds
    v_mfma_f32_16x16x32_bf16 v[68:71], a[184:187], v[140:143], v[68:71]
    ds_read_b64_tr_b16 a[92:93], v15 offset:18432
    v_mad_u32_u24 v160, v151, s42, v160
    v_mad_u32_u24 v165, v147, s34, v160
    v_mfma_f32_16x16x32_bf16 v[72:75], a[188:191], v[140:143], v[72:75]
    ds_read_b64_tr_b16 a[94:95], v15 offset:19200
    ds_write_b128 v111, v[164:167]
    v_mfma_f32_16x16x32_bf16 v[76:79], a[180:183], v[112:115], v[76:79]
    ds_read_b128 v[120:123], v18 offset:13824
    v_mfma_f32_16x16x32_bf16 v[80:83], a[184:187], v[112:115], v[80:83]
    buffer_load_dwordx4 v6, s[16:19], s31 offen offset:1024 lds
    v_mfma_f32_16x16x32_bf16 v[84:87], a[188:191], v[112:115], v[84:87]
    s_or_b64 vcc, vcc, s[84:85]
    s_cbranch_scc1 L_bfail2
L_bfail2_back:
    s_waitcnt lgkmcnt(5)
    v_mfma_f32_16x16x32_bf16 v[88:91], a[180:183], v[116:119], v[88:91]
    ds_read_b128 v[124:127], v18 offset:64
    v_mfma_f32_16x16x32_bf16 v[92:95], a[184:187], v[116:119], v[92:95]
    v_mfma_f32_16x16x32_bf16 v[96:99], a[188:191], v[116:119], v[96:99]
    s_waitcnt vmcnt(9) lgkmcnt(2)
    s_barrier
    v_mfma_f32_16x16x32_bf16 v[64:67], v[220:223], v[112:115], v[64:67]
    ds_read_b128 v[128:131], v18 offset:3520
    buffer_load_dwordx4 v7, s[16:19], s31 offen offset:2048 lds
    v_mfma_f32_16x16x32_bf16 v[68:71], v[224:227], v[112:115], v[68:71]
    ds_read_b64_tr_b16 a[192:193], v13 offset:24576
    ds_read_b128 v[52:55], v23 offset:1536
    v_mfma_f32_16x16x32_bf16 v[72:75], v[228:231], v[112:115], v[72:75]
    ds_read_b64_tr_b16 a[194:195], v13 offset:25344
    ds_read_b64_tr_b16 a[196:197], v14 offset:24576
    v_mfma_f32_16x16x32_bf16 v[76:79], v[220:223], v[116:119], v[76:79]
    ds_read_b128 v[132:135], v18 offset:6976
    ds_read_b64_tr_b16 a[198:199], v14 offset:25344
    v_mfma_f32_16x16x32_bf16 v[80:83], v[224:227], v[116:119], v[80:83]
    ds_read_b128 v[56:59], v23 offset:1552
    ds_read_b64_tr_b16 a[200:201], v15 offset:24576
    v_mfma_f32_16x16x32_bf16 v[84:87], v[228:231], v[116:119], v[84:87]
    ds_read_b64_tr_b16 a[202:203], v15 offset:25344
    s_waitcnt lgkmcnt(10)
    v_mfma_f32_16x16x32_bf16 v[88:91], v[220:223], v[120:123], v[88:91]
    ds_read_b64_tr_b16 v[232:233], v13 offset:30720
    ds_read_b32 v60, v23 offset:1568
    v_mfma_f32_16x16x32_bf16 v[92:95], v[224:227], v[120:123], v[92:95]
    ds_read_b64_tr_b16 v[234:235], v13 offset:31488
    buffer_load_dwordx4 v[180:183], v30, s[12:15], s55 offen
    v_mfma_f32_16x16x32_bf16 v[96:99], v[228:231], v[120:123], v[96:99]
    ds_read_b64_tr_b16 v[236:237], v14 offset:30720
    ds_read2_b32 v[176:177], v24 offset0:0 offset1:32
    v_mfma_f32_16x16x32_bf16 v[64:67], a[84:87], v[124:127], v[64:67]
    ds_read_b64_tr_b16 v[238:239], v14 offset:31488
    ds_read_b64 v[178:179], v25 offset:8
    v_mfma_f32_16x16x32_bf16 v[68:71], a[88:91], v[124:127], v[68:71]
    ds_read_b64_tr_b16 v[240:241], v15 offset:30720
    v_mfma_f32_16x16x32_bf16 v[72:75], a[92:95], v[124:127], v[72:75]
    ds_read_b64_tr_b16 v[242:243], v15 offset:31488
    s_waitcnt lgkmcnt(9)
    v_mfma_f32_16x16x32_bf16 v[76:79], a[84:87], v[128:131], v[76:79]
    ds_read_b128 v[136:139], v18 offset:10432
    buffer_load_dwordx4 v[184:187], v31, s[12:15], s55 offen
    v_mfma_f32_16x16x32_bf16 v[80:83], a[88:91], v[128:131], v[80:83]
    v_xor_b32 v40, v52, v4
    v_xor_b32 v41, v53, v4
    v_mfma_f32_16x16x32_bf16 v[84:87], a[92:95], v[128:131], v[84:87]
    v_xor_b32 v42, v54, v4
    v_xor_b32 v43, v55, v4
    v_mfma_f32_16x16x32_bf16 v[88:91], a[84:87], v[132:135], v[88:91]
    v_xor_b32 v44, v56, v4
    v_xor_b32 v45, v57, v4
    v_mfma_f32_16x16x32_bf16 v[92:95], a[88:91], v[132:135], v[92:95]
    v_xor_b32 v46, v58, v4
    v_xor_b32 v47, v59, v4
    v_mfma_f32_16x16x32_bf16 v[96:99], a[92:95], v[132:135], v[96:99]
    s_waitcnt vmcnt(5) lgkmcnt(1)
    s_barrier
    v_mfma_f32_16x16x32_bf16 v[64:67], a[192:195], v[128:131], v[64:67]
    ds_read_b64_tr_b16 a[96:97], v13 offset:36864
    v_xor_b32 v172, v176, v26
    v_mfma_f32_16x16x32_bf16 v[68:71], a[196:199], v[128:131], v[68:71]
    ds_read_b64_tr_b16 a[98:99], v13 offset:37632
    v_xor_b32 v174, v177, v26
    v_mfma_f32_16x16x32_bf16 v[72:75], a[200:203], v[128:131], v[72:75]
    ds_read_b64_tr_b16 a[100:101], v14 offset:36864
    v_xor_b32 v173, v176, v27
    v_mfma_f32_16x16x32_bf16 v[76:79], a[192:195], v[132:135], v[76:79]
    ds_read_b128 v[140:143], v18 offset:13888
    ds_read_b64_tr_b16 a[102:103], v14 offset:37632
    v_mfma_f32_16x16x32_bf16 v[80:83], a[196:199], v[132:135], v[80:83]
    ds_read_b64_tr_b16 a[104:105], v15 offset:36864
    v_xor_b32 v175, v177, v27
    v_mfma_f32_16x16x32_bf16 v[84:87], a[200:203], v[132:135], v[84:87]
    ds_read_b64_tr_b16 a[106:107], v15 offset:37632
    s_waitcnt lgkmcnt(7)
    v_mfma_f32_16x16x32_bf16 v[88:91], a[192:195], v[136:139], v[88:91]
    ds_read_b128 v[112:115], v18 offset:128
    v_xor_b32 v48, v60, v4
    v_mfma_f32_16x16x32_bf16 v[92:95], a[196:199], v[136:139], v[92:95]
    ds_read_b64_tr_b16 a[204:205], v13 offset:43008
    ds_read_b64_tr_b16 a[206:207], v13 offset:43776
    v_mfma_f32_16x16x32_bf16 v[96:99], a[200:203], v[136:139], v[96:99]
    ds_read_b64_tr_b16 a[208:209], v14 offset:43008
    v_cndmask_b32 v169, 0, v179, s[88:89]
    v_mfma_f32_16x16x32_bf16 v[64:67], v[232:235], v[132:135], v[64:67]
    ds_read_b128 v[116:119], v18 offset:3584
    ds_read_b64_tr_b16 a[210:211], v14 offset:43776
    v_mfma_f32_16x16x32_bf16 v[68:71], v[236:239], v[132:135], v[68:71]
    ds_read_b64_tr_b16 a[212:213], v15 offset:43008
    v_cndmask_b32 v171, 0, v179, s[92:93]
    v_mfma_f32_16x16x32_bf16 v[72:75], v[240:243], v[132:135], v[72:75]
    ds_read_b64_tr_b16 a[214:215], v15 offset:43776
    v_cndmask_b32 v168, 0, v178, s[88:89]
    v_mfma_f32_16x16x32_bf16 v[76:79], v[232:235], v[136:139], v[76:79]
    ds_read_b128 v[120:123], v18 offset:7040
    v_cndmask_b32 v170, 0, v178, s[92:93]
    v_mfma_f32_16x16x32_bf16 v[80:83], v[236:239], v[136:139], v[80:83]
    v_cndmask_b32 v169, v169, v178, s[90:91]
    v_cndmask_b32 v171, v171, v178, s[94:95]
    v_mfma_f32_16x16x32_bf16 v[84:87], v[240:243], v[136:139], v[84:87]
    s_waitcnt lgkmcnt(5)
    v_mfma_f32_16x16x32_bf16 v[88:91], v[232:235], v[140:143], v[88:91]
    v_mfma_f32_16x16x32_bf16 v[92:95], v[236:239], v[140:143], v[92:95]
    v_mfma_f32_16x16x32_bf16 v[96:99], v[240:243], v[140:143], v[96:99]
    s_waitcnt vmcnt(2) lgkmcnt(1)
    s_barrier
    v_mfma_f32_16x16x32_bf16 v[64:67], a[96:99], v[112:115], v[64:67]
    ds_read_b64_tr_b16 v[144:145], v172 offset:0
    ds_read_b64_tr_b16 v[146:147], v174 offset:0
    v_mfma_f32_16x16x32_bf16 v[68:71], a[100:103], v[112:115], v[68:71]
    ds_read_b64_tr_b16 v[148:149], v173 offset:0
    ds_read_b64_tr_b16 v[244:245], v13 offset:49152
    v_mfma_f32_16x16x32_bf16 v[72:75], a[104:107], v[112:115], v[72:75]
    ds_read_b64_tr_b16 v[150:151], v175 offset:0
    ds_read_b64_tr_b16 v[152:153], v172 offset:64
    v_mfma_f32_16x16x32_bf16 v[76:79], a[96:99], v[116:119], v[76:79]
    ds_read_b64_tr_b16 v[154:155], v174 offset:64
    ds_read_b64_tr_b16 v[246:247], v13 offset:49920
    v_mfma_f32_16x16x32_bf16 v[80:83], a[100:103], v[116:119], v[80:83]
    ds_read_b64_tr_b16 v[156:157], v173 offset:64
    ds_read_b64_tr_b16 v[158:159], v175 offset:64
    v_mfma_f32_16x16x32_bf16 v[84:87], a[104:107], v[116:119], v[84:87]
    ds_read_b64_tr_b16 v[160:161], v172 offset:128
    s_waitcnt lgkmcnt(11)
    v_mfma_f32_16x16x32_bf16 v[88:91], a[96:99], v[120:123], v[88:91]
    ds_read_b64_tr_b16 v[162:163], v174 offset:128
    ds_read_b64_tr_b16 v[164:165], v173 offset:128
    v_mfma_f32_16x16x32_bf16 v[92:95], a[100:103], v[120:123], v[92:95]
    ds_read_b64_tr_b16 v[166:167], v175 offset:128
    ds_read_b64_tr_b16 v[248:249], v14 offset:49152
    v_mfma_f32_16x16x32_bf16 v[96:99], a[104:107], v[120:123], v[96:99]
    ds_read_b64_tr_b16 v[250:251], v14 offset:49920
    ds_read_b64_tr_b16 v[252:253], v15 offset:49152
    v_mfma_f32_16x16x32_bf16 v[64:67], a[204:207], v[116:119], v[64:67]
    ds_read_b128 v[124:127], v18 offset:10496
    ds_read_b64_tr_b16 v[254:255], v15 offset:49920
    v_mfma_f32_16x16x32_bf16 v[68:71], a[208:211], v[116:119], v[68:71]
    v_mfma_f32_16x16x32_bf16 v[72:75], a[212:215], v[116:119], v[72:75]
    s_waitcnt lgkmcnt(8)
    v_mfma_f32_16x16x32_bf16 v[144:147], v[144:147], v[168:171], 0
    v_mfma_f32_16x16x32_bf16 v[148:151], v[148:151], v[168:171], 0
    v_mfma_f32_16x16x32_bf16 v[152:155], v[152:155], v[168:171], 0
    s_waitcnt lgkmcnt(2)
    v_mfma_f32_16x16x32_bf16 v[156:159], v[156:159], v[168:171], 0
    v_mfma_f32_16x16x32_bf16 v[160:163], v[160:163], v[168:171], 0
    v_mfma_f32_16x16x32_bf16 v[164:167], v[164:167], v[168:171], 0
    v_mfma_f32_16x16x32_bf16 v[76:79], a[204:207], v[120:123], v[76:79]
    ds_read_b128 v[128:131], v18 offset:13952
    v_cvt_pk_bf16_f32 v144, v144, v145
    v_mfma_f32_16x16x32_bf16 v[80:83], a[208:211], v[120:123], v[80:83]
    v_cvt_pk_bf16_f32 v145, v146, v147
    ds_write_b64 v28, v[144:145] offset:0
    v_mfma_f32_16x16x32_bf16 v[84:87], a[212:215], v[120:123], v[84:87]
    v_cvt_pk_bf16_f32 v148, v148, v149
    s_waitcnt lgkmcnt(2)
    v_mfma_f32_16x16x32_bf16 v[88:91], a[204:207], v[124:127], v[88:91]
    v_cvt_pk_bf16_f32 v149, v150, v151
    ds_write_b64 v29, v[148:149] offset:0
    v_mfma_f32_16x16x32_bf16 v[92:95], a[208:211], v[124:127], v[92:95]
    v_cvt_pk_bf16_f32 v152, v152, v153
    v_cvt_pk_bf16_f32 v153, v154, v155
    v_mfma_f32_16x16x32_bf16 v[96:99], a[212:215], v[124:127], v[96:99]
    ds_write_b64 v28, v[152:153] offset:64
    v_cvt_pk_bf16_f32 v156, v156, v157
    v_mfma_f32_16x16x32_bf16 v[64:67], v[244:247], v[120:123], v[64:67]
    v_cvt_pk_bf16_f32 v157, v158, v159
    ds_write_b64 v29, v[156:157] offset:64
    v_cvt_pk_bf16_f32 v160, v160, v161
    v_cvt_pk_bf16_f32 v161, v162, v163
    ds_write_b64 v28, v[160:161] offset:128
    v_cvt_pk_bf16_f32 v164, v164, v165
    v_cvt_pk_bf16_f32 v165, v166, v167
    ds_write_b64 v29, v[164:165] offset:128
    v_mfma_f32_16x16x32_bf16 v[68:71], v[248:251], v[120:123], v[68:71]
    v_mfma_f32_16x16x32_bf16 v[72:75], v[252:255], v[120:123], v[72:75]
    s_cmp_gt_u32 s62, 16
    s_cbranch_scc1 L_more
L_more_back:
    s_waitcnt lgkmcnt(0)
    s_barrier
    v_mfma_f32_16x16x32_bf16 v[76:79], v[244:247], v[124:127], v[76:79]
    ds_read_b128 v[132:135], v40 offset:0
    ds_read_b128 v[136:139], v40 offset:64
    v_mfma_f32_16x16x32_bf16 v[80:83], v[248:251], v[124:127], v[80:83]
    ds_read_b128 v[140:143], v40 offset:128
    v_mfma_f32_16x16x32_bf16 v[84:87], v[252:255], v[124:127], v[84:87]
    v_mfma_f32_16x16x32_bf16 v[88:91], v[244:247], v[128:131], v[88:91]
    ds_read_b128 v[112:115], v41 offset:0
    v_mfma_f32_16x16x32_bf16 v[92:95], v[248:251], v[128:131], v[92:95]
    v_mfma_f32_16x16x32_bf16 v[96:99], v[252:255], v[128:131], v[96:99]
    s_waitcnt lgkmcnt(3)
    v_mfma_f32_16x16x32_bf16 v[100:103], a[0:3], v[132:135], 0
    ds_read_b128 v[116:119], v41 offset:64
    v_mfma_f32_16x16x32_bf16 v[104:107], a[4:7], v[132:135], 0
    ds_read_b128 v[52:55], v23 offset:768
    v_mfma_f32_16x16x32_bf16 v[108:111], a[8:11], v[132:135], 0
    v_cvt_pk_bf16_f32 v72, v72, v73
    s_waitcnt lgkmcnt(3)
    v_mfma_f32_16x16x32_bf16 v[100:103], a[12:15], v[136:139], v[100:103]
    ds_read_b128 v[120:123], v41 offset:128
    v_cvt_pk_bf16_f32 v73, v74, v75
    v_mfma_f32_16x16x32_bf16 v[104:107], a[16:19], v[136:139], v[104:107]
    ds_read_b128 v[56:59], v23 offset:784
    ds_write_b64 v38, v[72:73] offset:49152
    v_mfma_f32_16x16x32_bf16 v[108:111], a[20:23], v[136:139], v[108:111]
    v_mfma_f32_16x16x32_bf16 v[100:103], a[24:27], v[140:143], v[100:103]
    ds_read_b128 v[124:127], v42 offset:0
    v_cvt_pk_bf16_f32 v84, v84, v85
    v_mfma_f32_16x16x32_bf16 v[104:107], a[28:31], v[140:143], v[104:107]
    ds_read_b32 v60, v23 offset:800
    v_cvt_pk_bf16_f32 v85, v86, v87
    v_mfma_f32_16x16x32_bf16 v[108:111], a[32:35], v[140:143], v[108:111]
    ds_write_b64 v38, v[84:85] offset:51200
    s_waitcnt lgkmcnt(6)
    v_mfma_f32_16x16x32_bf16 v[100:103], a[36:39], v[112:115], v[100:103]
    ds_read_b128 v[128:131], v42 offset:64
    v_mfma_f32_16x16x32_bf16 v[104:107], a[40:43], v[112:115], v[104:107]
    v_cvt_pk_bf16_f32 v96, v96, v97
    v_cvt_pk_bf16_f32 v97, v98, v99
    v_mfma_f32_16x16x32_bf16 v[108:111], a[44:47], v[112:115], v[108:111]
    ds_write_b64 v38, v[96:97] offset:53248
    ds_read2_b32 v[176:177], v24 offset0:64 offset1:96
    v_mfma_f32_16x16x32_bf16 v[100:103], a[48:51], v[116:119], v[100:103]
    ds_read_b128 v[132:135], v42 offset:128
    ds_read_b64 v[178:179], v25 offset:264
    v_mfma_f32_16x16x32_bf16 v[104:107], a[52:55], v[116:119], v[104:107]
    v_xor_b32 v40, v52, v4
    v_cvt_pk_bf16_f32 v64, v64, v65
    v_mfma_f32_16x16x32_bf16 v[108:111], a[56:59], v[116:119], v[108:111]
    v_cvt_pk_bf16_f32 v65, v66, v67
    s_waitcnt lgkmcnt(5)
    v_mfma_f32_16x16x32_bf16 v[100:103], a[60:63], v[120:123], v[100:103]
    ds_read_b128 v[136:139], v43 offset:0
    v_cvt_pk_bf16_f32 v66, v68, v69
    v_mfma_f32_16x16x32_bf16 v[104:107], a[64:67], v[120:123], v[104:107]
    v_xor_b32 v41, v53, v4
    v_cvt_pk_bf16_f32 v67, v70, v71
    v_mfma_f32_16x16x32_bf16 v[108:111], a[68:71], v[120:123], v[108:111]
    v_permlane16_swap_b32 v64, v66
    v_xor_b32 v42, v54, v4
    v_mfma_f32_16x16x32_bf16 v[100:103], a[72:75], v[124:127], v[100:103]
    ds_read_b128 v[140:143], v43 offset:64
    v_permlane16_swap_b32 v65, v67
    v_mfma_f32_16x16x32_bf16 v[104:107], a[76:79], v[124:127], v[104:107]
    buffer_store_dwordx4 v[64:67], v19, s[20:23], s56 offen sc1
    v_mfma_f32_16x16x32_bf16 v[108:111], a[80:83], v[124:127], v[108:111]
    s_waitcnt lgkmcnt(2)
    v_mfma_f32_16x16x32_bf16 v[100:103], a[84:87], v[128:131], v[100:103]
    ds_read_b128 v[112:115], v43 offset:128
    v_xor_b32 v172, v176, v26
    v_mfma_f32_16x16x32_bf16 v[104:107], a[88:91], v[128:131], v[104:107]
    v_xor_b32 v174, v177, v26
    v_xor_b32 v173, v176, v27
    v_mfma_f32_16x16x32_bf16 v[108:111], a[92:95], v[128:131], v[108:111]
    v_xor_b32 v175, v177, v27
    v_cndmask_b32 v169, 0, v179, s[88:89]
    v_mfma_f32_16x16x32_bf16 v[100:103], a[96:99], v[132:135], v[100:103]
    ds_read_b128 v[116:119], v44 offset:0
    v_cndmask_b32 v171, 0, v179, s[92:93]
    v_mfma_f32_16x16x32_bf16 v[104:107], a[100:103], v[132:135], v[104:107]
    v_cndmask_b32 v168, 0, v178, s[88:89]
    v_cndmask_b32 v170, 0, v178, s[92:93]
    v_mfma_f32_16x16x32_bf16 v[108:111], a[104:107], v[132:135], v[108:111]
    v_cndmask_b32 v169, v169, v178, s[90:91]
    s_waitcnt lgkmcnt(2)
    v_mfma_f32_16x16x32_bf16 v[100:103], a[108:111], v[136:139], v[100:103]
    ds_read_b128 v[120:123], v44 offset:64
    v_cndmask_b32 v171, v171, v178, s[94:95]
    v_mfma_f32_16x16x32_bf16 v[104:107], a[112:115], v[136:139], v[104:107]
    v_xor_b32 v43, v55, v4
    v_mfma_f32_16x16x32_bf16 v[108:111], a[116:119], v[136:139], v[108:111]
    s_barrier
    v_mfma_f32_16x16x32_bf16 v[100:103], a[120:123], v[140:143], v[100:103]
    ds_read_b128 v[124:127], v44 offset:128
    ds_read_b64 v[74:75], v39 offset:49152
    v_mfma_f32_16x16x32_bf16 v[104:107], a[124:127], v[140:143], v[104:107]
    ds_read_b64_tr_b16 v[144:145], v172 offset:0
    ds_read_b64_tr_b16 v[146:147], v174 offset:0
    v_mfma_f32_16x16x32_bf16 v[108:111], a[128:131], v[140:143], v[108:111]
    ds_read_b64_tr_b16 v[148:149], v173 offset:0
    s_waitcnt lgkmcnt(6)
    v_mfma_f32_16x16x32_bf16 v[100:103], a[132:135], v[112:115], v[100:103]
    ds_read_b128 v[128:131], v45 offset:0
    ds_read_b64_tr_b16 v[150:151], v175 offset:0
    v_mfma_f32_16x16x32_bf16 v[104:107], a[136:139], v[112:115], v[104:107]
    ds_read_b64_tr_b16 v[152:153], v172 offset:64
    ds_read_b64_tr_b16 v[154:155], v174 offset:64
    v_mfma_f32_16x16x32_bf16 v[108:111], a[140:143], v[112:115], v[108:111]
    ds_read_b64_tr_b16 v[156:157], v173 offset:64
    ds_read_b64_tr_b16 v[158:159], v175 offset:64
    v_mfma_f32_16x16x32_bf16 v[100:103], a[144:147], v[116:119], v[100:103]
    ds_read_b128 v[132:135], v45 offset:64
    ds_read_b64_tr_b16 v[160:161], v172 offset:128
    v_mfma_f32_16x16x32_bf16 v[104:107], a[148:151], v[116:119], v[104:107]
    ds_read_b64_tr_b16 v[162:163], v174 offset:128
    ds_read_b64_tr_b16 v[164:165], v173 offset:128
    v_mfma_f32_16x16x32_bf16 v[108:111], a[152:155], v[116:119], v[108:111]
    ds_read_b64_tr_b16 v[166:167], v175 offset:128
    s_waitcnt lgkmcnt(11)
    v_mfma_f32_16x16x32_bf16 v[100:103], a[156:159], v[120:123], v[100:103]
    buffer_store_dwordx2 v[74:75], v20, s[20:23], s56 offen sc1
    v_xor_b32 v44, v56, v4
    v_mfma_f32_16x16x32_bf16 v[104:107], a[160:163], v[120:123], v[104:107]
    v_cvt_pk_bf16_f32 v76, v76, v77
    v_cvt_pk_bf16_f32 v77, v78, v79
    v_mfma_f32_16x16x32_bf16 v[108:111], a[164:167], v[120:123], v[108:111]
    v_cvt_pk_bf16_f32 v78, v80, v81
    v_cvt_pk_bf16_f32 v79, v82, v83
    v_mfma_f32_16x16x32_bf16 v[100:103], a[168:171], v[124:127], v[100:103]
    v_permlane16_swap_b32 v76, v78
    v_permlane16_swap_b32 v77, v79
    v_mfma_f32_16x16x32_bf16 v[104:107], a[172:175], v[124:127], v[104:107]
    buffer_store_dwordx4 v[76:79], v19, s[20:23], s4 offen sc1
    v_mfma_f32_16x16x32_bf16 v[108:111], a[176:179], v[124:127], v[108:111]
    s_waitcnt lgkmcnt(0)
    v_mfma_f32_16x16x32_bf16 v[100:103], a[180:183], v[128:131], v[100:103]
    ds_read_b128 v[136:139], v45 offset:128
    v_xor_b32 v45, v57, v4
    v_mfma_f32_16x16x32_bf16 v[104:107], a[184:187], v[128:131], v[104:107]
    v_mfma_f32_16x16x32_bf16 v[108:111], a[188:191], v[128:131], v[108:111]
    v_mfma_f32_16x16x32_bf16 v[100:103], a[192:195], v[132:135], v[100:103]
    ds_read_b128 v[140:143], v46 offset:0
    ds_read_b64 v[86:87], v39 offset:51200
    v_mfma_f32_16x16x32_bf16 v[104:107], a[196:199], v[132:135], v[104:107]
    v_mfma_f32_16x16x32_bf16 v[108:111], a[200:203], v[132:135], v[108:111]
    v_mfma_f32_16x16x32_bf16 v[144:147], v[144:147], v[168:171], 0
    ds_read_b128 v[112:115], v46 offset:64
    v_mfma_f32_16x16x32_bf16 v[148:151], v[148:151], v[168:171], 0
    v_mfma_f32_16x16x32_bf16 v[152:155], v[152:155], v[168:171], 0
    v_mfma_f32_16x16x32_bf16 v[156:159], v[156:159], v[168:171], 0
    ds_read_b128 v[116:119], v46 offset:128
    v_xor_b32 v46, v58, v4
    v_mfma_f32_16x16x32_bf16 v[160:163], v[160:163], v[168:171], 0
    v_mfma_f32_16x16x32_bf16 v[164:167], v[164:167], v[168:171], 0
    v_cvt_pk_bf16_f32 v144, v144, v145
    s_waitcnt lgkmcnt(2)
    v_mfma_f32_16x16x32_bf16 v[100:103], a[204:207], v[136:139], v[100:103]
    ds_read_b128 v[120:123], v47 offset:0
    v_cvt_pk_bf16_f32 v145, v146, v147
    v_mfma_f32_16x16x32_bf16 v[104:107], a[208:211], v[136:139], v[104:107]
    ds_write_b64 v28, v[144:145] offset:12288
    v_cvt_pk_bf16_f32 v148, v148, v149
    v_mfma_f32_16x16x32_bf16 v[108:111], a[212:215], v[136:139], v[108:111]
    v_cvt_pk_bf16_f32 v149, v150, v151
    ds_write_b64 v29, v[148:149] offset:12288
    v_mfma_f32_16x16x32_bf16 v[100:103], a[216:219], v[140:143], v[100:103]
    ds_read_b128 v[124:127], v47 offset:64
    v_cvt_pk_bf16_f32 v152, v152, v153
    v_mfma_f32_16x16x32_bf16 v[104:107], a[220:223], v[140:143], v[104:107]
    v_cvt_pk_bf16_f32 v153, v154, v155
    ds_write_b64 v28, v[152:153] offset:12352
    v_mfma_f32_16x16x32_bf16 v[108:111], a[224:227], v[140:143], v[108:111]
    v_cvt_pk_bf16_f32 v156, v156, v157
    s_waitcnt lgkmcnt(5)
    v_mfma_f32_16x16x32_bf16 v[100:103], a[228:231], v[112:115], v[100:103]
    ds_read_b128 v[128:131], v47 offset:128
    v_cvt_pk_bf16_f32 v157, v158, v159
    v_mfma_f32_16x16x32_bf16 v[104:107], a[232:235], v[112:115], v[104:107]
    ds_write_b64 v29, v[156:157] offset:12352
    v_cvt_pk_bf16_f32 v160, v160, v161
    v_mfma_f32_16x16x32_bf16 v[108:111], a[236:239], v[112:115], v[108:111]
    v_cvt_pk_bf16_f32 v161, v162, v163
    ds_write_b64 v28, v[160:161] offset:12416
    v_mfma_f32_16x16x32_bf16 v[100:103], a[240:243], v[116:119], v[100:103]
    ds_read_b128 v[132:135], v48 offset:0
    v_cvt_pk_bf16_f32 v164, v164, v165
    v_mfma_f32_16x16x32_bf16 v[104:107], a[244:247], v[116:119], v[104:107]
    v_cvt_pk_bf16_f32 v165, v166, v167
    ds_write_b64 v29, v[164:165] offset:12416
    v_mfma_f32_16x16x32_bf16 v[108:111], a[248:251], v[116:119], v[108:111]
    ds_read2_b32 v[176:177], v24 offset0:128 offset1:160
    s_waitcnt lgkmcnt(6)
    v_mfma_f32_16x16x32_bf16 v[100:103], a[252:255], v[120:123], v[100:103]
    ds_read_b128 v[136:139], v48 offset:64
    ds_read_b64 v[178:179], v25 offset:520
    v_mfma_f32_16x16x32_bf16 v[104:107], v[188:191], v[120:123], v[104:107]
    v_xor_b32 v47, v59, v4
    v_cvt_pk_bf16_f32 v88, v88, v89
    v_mfma_f32_16x16x32_bf16 v[108:111], v[192:195], v[120:123], v[108:111]
    v_cvt_pk_bf16_f32 v89, v90, v91
    v_cvt_pk_bf16_f32 v90, v92, v93
    v_mfma_f32_16x16x32_bf16 v[100:103], v[196:199], v[124:127], v[100:103]
    ds_read_b128 v[140:143], v48 offset:128
    v_xor_b32 v48, v60, v4
    v_mfma_f32_16x16x32_bf16 v[104:107], v[200:203], v[124:127], v[104:107]
    v_cvt_pk_bf16_f32 v91, v94, v95
    v_permlane16_swap_b32 v88, v90
    v_mfma_f32_16x16x32_bf16 v[108:111], v[204:207], v[124:127], v[108:111]
    v_permlane16_swap_b32 v89, v91
    s_waitcnt lgkmcnt(3)
    v_mfma_f32_16x16x32_bf16 v[100:103], v[208:211], v[128:131], v[100:103]
    ds_read_b128 v[112:115], v40 offset:0
    v_xor_b32 v172, v176, v26
    v_mfma_f32_16x16x32_bf16 v[104:107], v[212:215], v[128:131], v[104:107]
    v_xor_b32 v174, v177, v26
    v_xor_b32 v173, v176, v27
    v_mfma_f32_16x16x32_bf16 v[108:111], v[216:219], v[128:131], v[108:111]
    v_xor_b32 v175, v177, v27
    buffer_store_dwordx4 v[88:91], v19, s[20:23], s5 offen sc1
    v_mfma_f32_16x16x32_bf16 v[100:103], v[220:223], v[132:135], v[100:103]
    ds_read_b128 v[116:119], v40 offset:64
    v_mfma_f32_16x16x32_bf16 v[104:107], v[224:227], v[132:135], v[104:107]
    v_mfma_f32_16x16x32_bf16 v[108:111], v[228:231], v[132:135], v[108:111]
    s_waitcnt lgkmcnt(2)
    v_mfma_f32_16x16x32_bf16 v[100:103], v[232:235], v[136:139], v[100:103]
    ds_read_b128 v[120:123], v40 offset:128
    v_cndmask_b32 v169, 0, v179, s[88:89]
    v_mfma_f32_16x16x32_bf16 v[104:107], v[236:239], v[136:139], v[104:107]
    ds_read_b64_tr_b16 v[144:145], v172 offset:0
    ds_read_b64_tr_b16 v[146:147], v174 offset:0
    v_mfma_f32_16x16x32_bf16 v[108:111], v[240:243], v[136:139], v[108:111]
    ds_read_b64_tr_b16 v[148:149], v173 offset:0
    v_cndmask_b32 v171, 0, v179, s[92:93]
    v_mfma_f32_16x16x32_bf16 v[100:103], v[244:247], v[140:143], v[100:103]
    ds_read_b128 v[124:127], v41 offset:0
    ds_read_b64_tr_b16 v[150:151], v175 offset:0
    v_mfma_f32_16x16x32_bf16 v[104:107], v[248:251], v[140:143], v[104:107]
    ds_read_b64_tr_b16 v[152:153], v172 offset:64
    ds_read_b64_tr_b16 v[154:155], v174 offset:64
    v_mfma_f32_16x16x32_bf16 v[108:111], v[252:255], v[140:143], v[108:111]
    ds_read_b64_tr_b16 v[156:157], v173 offset:64
    s_waitcnt lgkmcnt(9)
    v_mfma_f32_16x16x32_bf16 v[64:67], a[0:3], v[112:115], 0
    ds_read_b128 v[128:131], v41 offset:64
    ds_read_b64_tr_b16 v[158:159], v175 offset:64
    v_mfma_f32_16x16x32_bf16 v[68:71], a[4:7], v[112:115], 0
    ds_read_b64_tr_b16 v[160:161], v172 offset:128
    v_cndmask_b32 v168, 0, v178, s[88:89]
    v_mfma_f32_16x16x32_bf16 v[72:75], a[8:11], v[112:115], 0
    ds_read_b64_tr_b16 v[162:163], v174 offset:128
    v_cndmask_b32 v170, 0, v178, s[92:93]
    v_mfma_f32_16x16x32_bf16 v[64:67], a[12:15], v[116:119], v[64:67]
    ds_read_b64_tr_b16 v[164:165], v173 offset:128
    v_cndmask_b32 v169, v169, v178, s[90:91]
    v_mfma_f32_16x16x32_bf16 v[68:71], a[16:19], v[116:119], v[68:71]
    ds_read_b64_tr_b16 v[166:167], v175 offset:128
    v_cndmask_b32 v171, v171, v178, s[94:95]
    v_mfma_f32_16x16x32_bf16 v[72:75], a[20:23], v[116:119], v[72:75]
    ds_read_b128 v[52:55], v23 offset:0
    s_waitcnt lgkmcnt(7)
    v_mfma_f32_16x16x32_bf16 v[64:67], a[24:27], v[120:123], v[64:67]
    ds_read_b128 v[56:59], v23 offset:16
    v_cvt_pk_bf16_f32 v108, v108, v109
    v_mfma_f32_16x16x32_bf16 v[68:71], a[28:31], v[120:123], v[68:71]
    ds_read_b32 v60, v23 offset:32
    v_cvt_pk_bf16_f32 v109, v110, v111
    v_mfma_f32_16x16x32_bf16 v[72:75], a[32:35], v[120:123], v[72:75]
    ds_write_b64 v38, v[108:109] offset:55296
    buffer_store_dwordx2 v[86:87], v20, s[20:23], s4 offen sc1
    v_mfma_f32_16x16x32_bf16 v[64:67], a[36:39], v[124:127], v[64:67]
    ds_read_b128 v[132:135], v41 offset:128
    v_cvt_pk_bf16_f32 v100, v100, v101
    v_mfma_f32_16x16x32_bf16 v[68:71], a[40:43], v[124:127], v[68:71]
    v_cvt_pk_bf16_f32 v101, v102, v103
    v_cvt_pk_bf16_f32 v102, v104, v105
    v_mfma_f32_16x16x32_bf16 v[72:75], a[44:47], v[124:127], v[72:75]
    ds_read2_b32 v[176:177], v24 offset0:192 offset1:224
    s_waitcnt lgkmcnt(5)
    v_mfma_f32_16x16x32_bf16 v[64:67], a[48:51], v[128:131], v[64:67]
    ds_read_b128 v[136:139], v42 offset:0
    ds_read_b64 v[178:179], v25 offset:776
    v_mfma_f32_16x16x32_bf16 v[68:71], a[52:55], v[128:131], v[68:71]
    v_xor_b32 v40, v52, v4
    v_xor_b32 v41, v53, v4
    v_mfma_f32_16x16x32_bf16 v[72:75], a[56:59], v[128:131], v[72:75]
    v_cvt_pk_bf16_f32 v103, v106, v107
    v_permlane16_swap_b32 v100, v102
    v_mfma_f32_16x16x32_bf16 v[144:147], v[144:147], v[168:171], 0
    ds_read_b128 v[140:143], v42 offset:64
    v_permlane16_swap_b32 v101, v103
    v_mfma_f32_16x16x32_bf16 v[148:151], v[148:151], v[168:171], 0
    buffer_store_dwordx4 v[100:103], v21, s[20:23], s74 offen sc1
    ds_read_b64 v[98:99], v39 offset:53248
    v_mfma_f32_16x16x32_bf16 v[152:155], v[152:155], v[168:171], 0
    v_mfma_f32_16x16x32_bf16 v[156:159], v[156:159], v[168:171], 0
    ds_read_b128 v[112:115], v42 offset:128
    v_cvt_pk_bf16_f32 v144, v144, v145
    v_mfma_f32_16x16x32_bf16 v[160:163], v[160:163], v[168:171], 0
    v_cvt_pk_bf16_f32 v145, v146, v147
    ds_write_b64 v28, v[144:145] offset:24576
    v_mfma_f32_16x16x32_bf16 v[164:167], v[164:167], v[168:171], 0
    v_cvt_pk_bf16_f32 v148, v148, v149
    s_waitcnt lgkmcnt(4)
    v_mfma_f32_16x16x32_bf16 v[64:67], a[60:63], v[132:135], v[64:67]
    ds_read_b128 v[116:119], v43 offset:0
    v_cvt_pk_bf16_f32 v149, v150, v151
    v_mfma_f32_16x16x32_bf16 v[68:71], a[64:67], v[132:135], v[68:71]
    ds_write_b64 v29, v[148:149] offset:24576
    v_cvt_pk_bf16_f32 v152, v152, v153
    v_mfma_f32_16x16x32_bf16 v[72:75], a[68:71], v[132:135], v[72:75]
    v_cvt_pk_bf16_f32 v153, v154, v155
    ds_write_b64 v28, v[152:153] offset:24640
    v_mfma_f32_16x16x32_bf16 v[64:67], a[72:75], v[136:139], v[64:67]
    ds_read_b128 v[120:123], v43 offset:64
    v_cvt_pk_bf16_f32 v156, v156, v157
    v_mfma_f32_16x16x32_bf16 v[68:71], a[76:79], v[136:139], v[68:71]
    v_cvt_pk_bf16_f32 v157, v158, v159
    ds_write_b64 v29, v[156:157] offset:24640
    v_mfma_f32_16x16x32_bf16 v[72:75], a[80:83], v[136:139], v[72:75]
    v_xor_b32 v172, v176, v26
    s_waitcnt lgkmcnt(5)
    v_mfma_f32_16x16x32_bf16 v[64:67], a[84:87], v[140:143], v[64:67]
    ds_read_b128 v[124:127], v43 offset:128
    v_cvt_pk_bf16_f32 v160, v160, v161
    v_mfma_f32_16x16x32_bf16 v[68:71], a[88:91], v[140:143], v[68:71]
    v_xor_b32 v174, v177, v26
    v_cvt_pk_bf16_f32 v161, v162, v163
    v_mfma_f32_16x16x32_bf16 v[72:75], a[92:95], v[140:143], v[72:75]
    v_xor_b32 v173, v176, v27
    ds_write_b64 v28, v[160:161] offset:24704
    v_mfma_f32_16x16x32_bf16 v[64:67], a[96:99], v[112:115], v[64:67]
    ds_read_b128 v[128:131], v44 offset:0
    v_xor_b32 v175, v177, v27
    v_mfma_f32_16x16x32_bf16 v[68:71], a[100:103], v[112:115], v[68:71]
    v_cvt_pk_bf16_f32 v164, v164, v165
    v_cvt_pk_bf16_f32 v165, v166, v167
    v_mfma_f32_16x16x32_bf16 v[72:75], a[104:107], v[112:115], v[72:75]
    ds_write_b64 v29, v[164:165] offset:24704
    s_waitcnt lgkmcnt(4)
    v_mfma_f32_16x16x32_bf16 v[64:67], a[108:111], v[116:119], v[64:67]
    ds_read_b128 v[132:135], v44 offset:64
    ds_read_b64_tr_b16 v[144:145], v172 offset:0
    v_mfma_f32_16x16x32_bf16 v[68:71], a[112:115], v[116:119], v[68:71]
    ds_read_b64_tr_b16 v[146:147], v174 offset:0
    ds_read_b64_tr_b16 v[148:149], v173 offset:0
    v_mfma_f32_16x16x32_bf16 v[72:75], a[116:119], v[116:119], v[72:75]
    ds_read_b64_tr_b16 v[150:151], v175 offset:0
    ds_read_b64_tr_b16 v[152:153], v172 offset:64
    v_mfma_f32_16x16x32_bf16 v[64:67], a[120:123], v[120:123], v[64:67]
    ds_read_b128 v[136:139], v44 offset:128
    ds_read_b64_tr_b16 v[154:155], v174 offset:64
    v_mfma_f32_16x16x32_bf16 v[68:71], a[124:127], v[120:123], v[68:71]
    ds_read_b64_tr_b16 v[156:157], v173 offset:64
    v_cndmask_b32 v169, 0, v179, s[88:89]
    v_mfma_f32_16x16x32_bf16 v[72:75], a[128:131], v[120:123], v[72:75]
    ds_read_b64_tr_b16 v[158:159], v175 offset:64
    s_waitcnt lgkmcnt(10)
    v_mfma_f32_16x16x32_bf16 v[64:67], a[132:135], v[124:127], v[64:67]
    v_cndmask_b32 v171, 0, v179, s[92:93]
    ds_read_b64_tr_b16 v[160:161], v172 offset:128
    v_mfma_f32_16x16x32_bf16 v[68:71], a[136:139], v[124:127], v[68:71]
    v_cndmask_b32 v168, 0, v178, s[88:89]
    ds_read_b64_tr_b16 v[162:163], v174 offset:128
    v_mfma_f32_16x16x32_bf16 v[72:75], a[140:143], v[124:127], v[72:75]
    v_cndmask_b32 v170, 0, v178, s[92:93]
    ds_read_b64_tr_b16 v[164:165], v173 offset:128
    v_mfma_f32_16x16x32_bf16 v[64:67], a[144:147], v[128:131], v[64:67]
    v_cndmask_b32 v169, v169, v178, s[90:91]
    ds_read_b64_tr_b16 v[166:167], v175 offset:128
    v_mfma_f32_16x16x32_bf16 v[68:71], a[148:151], v[128:131], v[68:71]
    v_cndmask_b32 v171, v171, v178, s[94:95]
    v_xor_b32 v42, v54, v4
    v_mfma_f32_16x16x32_bf16 v[72:75], a[152:155], v[128:131], v[72:75]
    v_xor_b32 v43, v55, v4
    s_waitcnt lgkmcnt(4)
    v_mfma_f32_16x16x32_bf16 v[64:67], a[156:159], v[132:135], v[64:67]
    ds_read_b128 v[140:143], v45 offset:0
    v_xor_b32 v44, v56, v4
    v_mfma_f32_16x16x32_bf16 v[68:71], a[160:163], v[132:135], v[68:71]
    buffer_store_dwordx2 v[98:99], v20, s[20:23], s5 offen sc1
    v_mfma_f32_16x16x32_bf16 v[72:75], a[164:167], v[132:135], v[72:75]
    v_mfma_f32_16x16x32_bf16 v[64:67], a[168:171], v[136:139], v[64:67]
    ds_read_b128 v[112:115], v45 offset:64
    v_mfma_f32_16x16x32_bf16 v[68:71], a[172:175], v[136:139], v[68:71]
    v_mfma_f32_16x16x32_bf16 v[72:75], a[176:179], v[136:139], v[72:75]
    v_mfma_f32_16x16x32_bf16 v[144:147], v[144:147], v[168:171], 0
    ds_read_b128 v[116:119], v45 offset:128
    v_xor_b32 v45, v57, v4
    v_mfma_f32_16x16x32_bf16 v[148:151], v[148:151], v[168:171], 0
    v_mfma_f32_16x16x32_bf16 v[152:155], v[152:155], v[168:171], 0
    s_waitcnt lgkmcnt(2)
    v_mfma_f32_16x16x32_bf16 v[156:159], v[156:159], v[168:171], 0
    ds_read_b128 v[120:123], v46 offset:0
    v_mfma_f32_16x16x32_bf16 v[160:163], v[160:163], v[168:171], 0
    v_cvt_pk_bf16_f32 v144, v144, v145
    v_cvt_pk_bf16_f32 v145, v146, v147
    v_mfma_f32_16x16x32_bf16 v[164:167], v[164:167], v[168:171], 0
    ds_write_b64 v28, v[144:145] offset:36864
    v_cvt_pk_bf16_f32 v148, v148, v149
    v_mfma_f32_16x16x32_bf16 v[64:67], a[180:183], v[140:143], v[64:67]
    ds_read_b128 v[124:127], v46 offset:64
    v_cvt_pk_bf16_f32 v149, v150, v151
    v_mfma_f32_16x16x32_bf16 v[68:71], a[184:187], v[140:143], v[68:71]
    ds_write_b64 v29, v[148:149] offset:36864
    v_cvt_pk_bf16_f32 v152, v152, v153
    v_mfma_f32_16x16x32_bf16 v[72:75], a[188:191], v[140:143], v[72:75]
    v_cvt_pk_bf16_f32 v153, v154, v155
    s_waitcnt lgkmcnt(4)
    v_mfma_f32_16x16x32_bf16 v[64:67], a[192:195], v[112:115], v[64:67]
    ds_read_b128 v[128:131], v46 offset:128
    ds_write_b64 v28, v[152:153] offset:36928
    v_mfma_f32_16x16x32_bf16 v[68:71], a[196:199], v[112:115], v[68:71]
    v_cvt_pk_bf16_f32 v156, v156, v157
    v_cvt_pk_bf16_f32 v157, v158, v159
    v_mfma_f32_16x16x32_bf16 v[72:75], a[200:203], v[112:115], v[72:75]
    ds_write_b64 v29, v[156:157] offset:36928
    v_cvt_pk_bf16_f32 v160, v160, v161
    v_mfma_f32_16x16x32_bf16 v[64:67], a[204:207], v[116:119], v[64:67]
    ds_read_b128 v[132:135], v47 offset:0
    v_cvt_pk_bf16_f32 v161, v162, v163
    v_mfma_f32_16x16x32_bf16 v[68:71], a[208:211], v[116:119], v[68:71]
    ds_write_b64 v28, v[160:161] offset:36992
    v_cvt_pk_bf16_f32 v164, v164, v165
    v_mfma_f32_16x16x32_bf16 v[72:75], a[212:215], v[116:119], v[72:75]
    v_cvt_pk_bf16_f32 v165, v166, v167
    s_waitcnt lgkmcnt(5)
    v_mfma_f32_16x16x32_bf16 v[64:67], a[216:219], v[120:123], v[64:67]
    ds_read_b128 v[136:139], v47 offset:64
    ds_write_b64 v29, v[164:165] offset:36992
    v_mfma_f32_16x16x32_bf16 v[68:71], a[220:223], v[120:123], v[68:71]
    v_xor_b32 v46, v58, v4
    v_mfma_f32_16x16x32_bf16 v[72:75], a[224:227], v[120:123], v[72:75]
    v_mfma_f32_16x16x32_bf16 v[64:67], a[228:231], v[124:127], v[64:67]
    ds_read_b128 v[140:143], v47 offset:128
    v_xor_b32 v47, v59, v4
    v_mfma_f32_16x16x32_bf16 v[68:71], a[232:235], v[124:127], v[68:71]
    v_mfma_f32_16x16x32_bf16 v[72:75], a[236:239], v[124:127], v[72:75]
    s_waitcnt lgkmcnt(3)
    v_mfma_f32_16x16x32_bf16 v[64:67], a[240:243], v[128:131], v[64:67]
    ds_read_b128 v[112:115], v48 offset:0
    v_mfma_f32_16x16x32_bf16 v[68:71], a[244:247], v[128:131], v[68:71]
    v_mfma_f32_16x16x32_bf16 v[72:75], a[248:251], v[128:131], v[72:75]
    v_mfma_f32_16x16x32_bf16 v[64:67], a[252:255], v[132:135], v[64:67]
    ds_read_b128 v[116:119], v48 offset:64
    v_mfma_f32_16x16x32_bf16 v[68:71], v[188:191], v[132:135], v[68:71]
    v_mfma_f32_16x16x32_bf16 v[72:75], v[192:195], v[132:135], v[72:75]
    s_waitcnt lgkmcnt(2)
    v_mfma_f32_16x16x32_bf16 v[64:67], v[196:199], v[136:139], v[64:67]
    ds_read_b128 v[120:123], v48 offset:128
    v_xor_b32 v48, v60, v4
    v_mfma_f32_16x16x32_bf16 v[68:71], v[200:203], v[136:139], v[68:71]
    v_mfma_f32_16x16x32_bf16 v[72:75], v[204:207], v[136:139], v[72:75]
    s_waitcnt vmcnt(7) lgkmcnt(2)
    s_barrier
    v_mfma_f32_16x16x32_bf16 v[64:67], v[208:211], v[140:143], v[64:67]
    ds_read_b128 v[124:127], v40 offset:0
    ds_read_b64 v[110:111], v39 offset:55296
    v_mfma_f32_16x16x32_bf16 v[68:71], v[212:215], v[140:143], v[68:71]
    v_mfma_f32_16x16x32_bf16 v[72:75], v[216:219], v[140:143], v[72:75]
    v_mfma_f32_16x16x32_bf16 v[64:67], v[220:223], v[112:115], v[64:67]
    ds_read_b128 v[128:131], v40 offset:64
    v_mfma_f32_16x16x32_bf16 v[68:71], v[224:227], v[112:115], v[68:71]
    v_mfma_f32_16x16x32_bf16 v[72:75], v[228:231], v[112:115], v[72:75]
    s_waitcnt lgkmcnt(3)
    v_mfma_f32_16x16x32_bf16 v[64:67], v[232:235], v[116:119], v[64:67]
    ds_read_b128 v[132:135], v40 offset:128
    v_and_b32 v180, s96, v180
    v_mfma_f32_16x16x32_bf16 v[68:71], v[236:239], v[116:119], v[68:71]
    v_and_b32 v181, s96, v181
    v_and_b32 v182, s96, v182
    v_mfma_f32_16x16x32_bf16 v[72:75], v[240:243], v[116:119], v[72:75]
    v_and_b32 v183, s96, v183
    v_pk_max_u16 v180, v180, v181
    v_mfma_f32_16x16x32_bf16 v[64:67], v[244:247], v[120:123], v[64:67]
    ds_read_b128 v[136:139], v41 offset:0
    v_pk_max_u16 v182, v182, v183
    v_mfma_f32_16x16x32_bf16 v[68:71], v[248:251], v[120:123], v[68:71]
    v_pk_max_u16 v180, v180, s37
    v_pk_max_u16 v180, v180, v182
    v_mfma_f32_16x16x32_bf16 v[72:75], v[252:255], v[120:123], v[72:75]
    v_cmp_ne_u32 s[80:81], s37, v180
    s_waitcnt lgkmcnt(2)
    v_mfma_f32_16x16x32_bf16 v[76:79], a[0:3], v[124:127], 0
    ds_read_b128 v[140:143], v41 offset:64
    v_and_b32 v184, s96, v184
    v_mfma_f32_16x16x32_bf16 v[80:83], a[4:7], v[124:127], 0
    v_and_b32 v185, s96, v185
    v_and_b32 v186, s96, v186
    v_mfma_f32_16x16x32_bf16 v[84:87], a[8:11], v[124:127], 0
    v_and_b32 v187, s96, v187
    v_pk_max_u16 v184, v184, v185
    v_mfma_f32_16x16x32_bf16 v[76:79], a[12:15], v[128:131], v[76:79]
    ds_read_b128 v[112:115], v41 offset:128
    v_cvt_pk_bf16_f32 v72, v72, v73
    v_mfma_f32_16x16x32_bf16 v[80:83], a[16:19], v[128:131], v[80:83]
    v_cvt_pk_bf16_f32 v73, v74, v75
    ds_write_b64 v38, v[72:73] offset:57344
    v_mfma_f32_16x16x32_bf16 v[84:87], a[20:23], v[128:131], v[84:87]
    v_pk_max_u16 v186, v186, v187
    s_waitcnt lgkmcnt(3)
    v_mfma_f32_16x16x32_bf16 v[76:79], a[24:27], v[132:135], v[76:79]
    ds_read_b128 v[116:119], v42 offset:0
    v_pk_max_u16 v184, v184, s37
    v_mfma_f32_16x16x32_bf16 v[80:83], a[28:31], v[132:135], v[80:83]
    v_pk_max_u16 v184, v184, v186
    v_cmp_ne_u32 s[82:83], s37, v184
    v_mfma_f32_16x16x32_bf16 v[84:87], a[32:35], v[132:135], v[84:87]
    s_or_b64 vcc, s[80:81], s[82:83]
    s_cbranch_scc1 L_afailY
L_afailY_back:
    v_mfma_f32_16x16x32_bf16 v[76:79], a[36:39], v[136:139], v[76:79]
    ds_read_b128 v[120:123], v42 offset:64
    buffer_store_dwordx2 v[110:111], v22, s[20:23], s74 offen sc1
    v_mfma_f32_16x16x32_bf16 v[80:83], a[40:43], v[136:139], v[80:83]
    v_cvt_pk_bf16_f32 v64, v64, v65
    v_cvt_pk_bf16_f32 v65, v66, v67
    v_mfma_f32_16x16x32_bf16 v[84:87], a[44:47], v[136:139], v[84:87]
    v_cvt_pk_bf16_f32 v66, v68, v69
    s_waitcnt lgkmcnt(2)
    v_mfma_f32_16x16x32_bf16 v[76:79], a[48:51], v[140:143], v[76:79]
    ds_read_b128 v[124:127], v42 offset:128
    v_cvt_pk_bf16_f32 v67, v70, v71
    v_mfma_f32_16x16x32_bf16 v[80:83], a[52:55], v[140:143], v[80:83]
    v_permlane16_swap_b32 v64, v66
    v_permlane16_swap_b32 v65, v67
    v_mfma_f32_16x16x32_bf16 v[84:87], a[56:59], v[140:143], v[84:87]
    buffer_store_dwordx4 v[64:67], v21, s[20:23], s75 offen sc1
    v_mfma_f32_16x16x32_bf16 v[76:79], a[60:63], v[112:115], v[76:79]
    ds_read_b128 v[128:131], v43 offset:0
    v_mfma_f32_16x16x32_bf16 v[80:83], a[64:67], v[112:115], v[80:83]
    v_mfma_f32_16x16x32_bf16 v[84:87], a[68:71], v[112:115], v[84:87]
    s_waitcnt lgkmcnt(2)
    v_mfma_f32_16x16x32_bf16 v[76:79], a[72:75], v[116:119], v[76:79]
    ds_read_b128 v[132:135], v43 offset:64
    v_mfma_f32_16x16x32_bf16 v[80:83], a[76:79], v[116:119], v[80:83]
    v_mfma_f32_16x16x32_bf16 v[84:87], a[80:83], v[116:119], v[84:87]
    v_mfma_f32_16x16x32_bf16 v[76:79], a[84:87], v[120:123], v[76:79]
    ds_read_b128 v[136:139], v43 offset:128
    v_mfma_f32_16x16x32_bf16 v[80:83], a[88:91], v[120:123], v[80:83]
    v_mfma_f32_16x16x32_bf16 v[84:87], a[92:95], v[120:123], v[84:87]
    s_waitcnt lgkmcnt(2)
    v_mfma_f32_16x16x32_bf16 v[76:79], a[96:99], v[124:127], v[76:79]
    ds_read_b128 v[140:143], v44 offset:0
    v_mfma_f32_16x16x32_bf16 v[80:83], a[100:103], v[124:127], v[80:83]
    v_mfma_f32_16x16x32_bf16 v[84:87], a[104:107], v[124:127], v[84:87]
    v_mfma_f32_16x16x32_bf16 v[76:79], a[108:111], v[128:131], v[76:79]
    ds_read_b128 v[112:115], v44 offset:64
    v_mfma_f32_16x16x32_bf16 v[80:83], a[112:115], v[128:131], v[80:83]
    v_mfma_f32_16x16x32_bf16 v[84:87], a[116:119], v[128:131], v[84:87]
    s_waitcnt lgkmcnt(2)
    s_barrier
    v_mfma_f32_16x16x32_bf16 v[76:79], a[120:123], v[132:135], v[76:79]
    ds_read_b128 v[116:119], v44 offset:128
    ds_read_b32 v35, v34
    v_mfma_f32_16x16x32_bf16 v[80:83], a[124:127], v[132:135], v[80:83]
    ds_read_b64 v[74:75], v39 offset:57344
    v_mfma_f32_16x16x32_bf16 v[84:87], a[128:131], v[132:135], v[84:87]
    v_mfma_f32_16x16x32_bf16 v[76:79], a[132:135], v[136:139], v[76:79]
    ds_read_b128 v[120:123], v45 offset:0
    v_mfma_f32_16x16x32_bf16 v[80:83], a[136:139], v[136:139], v[80:83]
    v_mfma_f32_16x16x32_bf16 v[84:87], a[140:143], v[136:139], v[84:87]
    s_waitcnt lgkmcnt(4)
    v_mfma_f32_16x16x32_bf16 v[76:79], a[144:147], v[140:143], v[76:79]
    ds_read_b128 v[124:127], v45 offset:64
    v_mfma_f32_16x16x32_bf16 v[80:83], a[148:151], v[140:143], v[80:83]
    v_mfma_f32_16x16x32_bf16 v[84:87], a[152:155], v[140:143], v[84:87]
    v_mfma_f32_16x16x32_bf16 v[76:79], a[156:159], v[112:115], v[76:79]
    ds_read_b128 v[128:131], v45 offset:128
    v_mfma_f32_16x16x32_bf16 v[80:83], a[160:163], v[112:115], v[80:83]
    v_mfma_f32_16x16x32_bf16 v[84:87], a[164:167], v[112:115], v[84:87]
    s_waitcnt lgkmcnt(2)
    v_mfma_f32_16x16x32_bf16 v[76:79], a[168:171], v[116:119], v[76:79]
    ds_read_b128 v[132:135], v46 offset:0
    v_readfirstlane_b32 s63, v35
    v_mfma_f32_16x16x32_bf16 v[80:83], a[172:175], v[116:119], v[80:83]
    buffer_store_dwordx2 v[74:75], v22, s[20:23], s75 offen sc1
    v_mfma_f32_16x16x32_bf16 v[84:87], a[176:179], v[116:119], v[84:87]
    v_mfma_f32_16x16x32_bf16 v[76:79], a[180:183], v[120:123], v[76:79]
    ds_read_b128 v[136:139], v46 offset:64
    v_mfma_f32_16x16x32_bf16 v[80:83], a[184:187], v[120:123], v[80:83]
    v_mfma_f32_16x16x32_bf16 v[84:87], a[188:191], v[120:123], v[84:87]
    s_waitcnt lgkmcnt(2)
    v_mfma_f32_16x16x32_bf16 v[76:79], a[192:195], v[124:127], v[76:79]
    ds_read_b128 v[140:143], v46 offset:128
    v_mfma_f32_16x16x32_bf16 v[80:83], a[196:199], v[124:127], v[80:83]
    v_mfma_f32_16x16x32_bf16 v[84:87], a[200:203], v[124:127], v[84:87]
    v_mfma_f32_16x16x32_bf16 v[76:79], a[204:207], v[128:131], v[76:79]
    ds_read_b128 v[112:115], v47 offset:0
    v_mfma_f32_16x16x32_bf16 v[80:83], a[208:211], v[128:131], v[80:83]
    v_mfma_f32_16x16x32_bf16 v[84:87], a[212:215], v[128:131], v[84:87]
    s_waitcnt lgkmcnt(2)
    v_mfma_f32_16x16x32_bf16 v[76:79], a[216:219], v[132:135], v[76:79]
    ds_read_b128 v[116:119], v47 offset:64
    v_mfma_f32_16x16x32_bf16 v[80:83], a[220:223], v[132:135], v[80:83]
    v_mfma_f32_16x16x32_bf16 v[84:87], a[224:227], v[132:135], v[84:87]
    v_mfma_f32_16x16x32_bf16 v[76:79], a[228:231], v[136:139], v[76:79]
    ds_read_b128 v[120:123], v47 offset:128
    v_mfma_f32_16x16x32_bf16 v[80:83], a[232:235], v[136:139], v[80:83]
    v_mfma_f32_16x16x32_bf16 v[84:87], a[236:239], v[136:139], v[84:87]
    s_waitcnt lgkmcnt(2)
    v_mfma_f32_16x16x32_bf16 v[76:79], a[240:243], v[140:143], v[76:79]
    ds_read_b128 v[124:127], v48 offset:0
    v_mfma_f32_16x16x32_bf16 v[80:83], a[244:247], v[140:143], v[80:83]
    v_mfma_f32_16x16x32_bf16 v[84:87], a[248:251], v[140:143], v[84:87]
    v_mfma_f32_16x16x32_bf16 v[76:79], a[252:255], v[112:115], v[76:79]
    ds_read_b128 v[128:131], v48 offset:64
    v_mfma_f32_16x16x32_bf16 v[80:83], v[188:191], v[112:115], v[80:83]
    v_mfma_f32_16x16x32_bf16 v[84:87], v[192:195], v[112:115], v[84:87]
    s_waitcnt lgkmcnt(2)
    v_mfma_f32_16x16x32_bf16 v[76:79], v[196:199], v[116:119], v[76:79]
    ds_read_b128 v[132:135], v48 offset:128
    v_mfma_f32_16x16x32_bf16 v[80:83], v[200:203], v[116:119], v[80:83]
    v_mfma_f32_16x16x32_bf16 v[84:87], v[204:207], v[116:119], v[84:87]
    v_mfma_f32_16x16x32_bf16 v[76:79], v[208:211], v[120:123], v[76:79]
    v_mfma_f32_16x16x32_bf16 v[80:83], v[212:215], v[120:123], v[80:83]
    v_mfma_f32_16x16x32_bf16 v[84:87], v[216:219], v[120:123], v[84:87]
    s_waitcnt lgkmcnt(1)
    v_mfma_f32_16x16x32_bf16 v[76:79], v[220:223], v[124:127], v[76:79]
    v_mfma_f32_16x16x32_bf16 v[80:83], v[224:227], v[124:127], v[80:83]
    v_mfma_f32_16x16x32_bf16 v[84:87], v[228:231], v[124:127], v[84:87]
    v_mfma_f32_16x16x32_bf16 v[76:79], v[232:235], v[128:131], v[76:79]
    v_mfma_f32_16x16x32_bf16 v[80:83], v[236:239], v[128:131], v[80:83]
    v_mfma_f32_16x16x32_bf16 v[84:87], v[240:243], v[128:131], v[84:87]
    s_waitcnt lgkmcnt(0)
    v_mfma_f32_16x16x32_bf16 v[84:87], v[252:255], v[132:135], v[84:87]
    v_mfma_f32_16x16x32_bf16 v[76:79], v[244:247], v[132:135], v[76:79]
    v_mfma_f32_16x16x32_bf16 v[80:83], v[248:251], v[132:135], v[80:83]
    s_nop 5
    v_cvt_pk_bf16_f32 v84, v84, v85
    v_cvt_pk_bf16_f32 v85, v86, v87
    ds_write_b64 v38, v[84:85] offset:59392
    v_cvt_pk_bf16_f32 v76, v76, v77
    v_cvt_pk_bf16_f32 v77, v78, v79
    v_cvt_pk_bf16_f32 v78, v80, v81
    v_cvt_pk_bf16_f32 v79, v82, v83
    s_waitcnt lgkmcnt(0)
    s_barrier
    ds_read_b64 v[86:87], v39 offset:59392
    v_permlane16_swap_b32 v76, v78
    v_permlane16_swap_b32 v77, v79
    buffer_store_dwordx4 v[76:79], v21, s[20:23], s76 offen sc1
    s_waitcnt lgkmcnt(0)
    buffer_store_dwordx2 v[86:87], v22, s[20:23], s76 offen sc1
L_check:
    s_cmp_lg_u32 s63, 0
    s_cbranch_scc1 L_slow
L_end:
    s_endpgm
L_doubles:
    v_mad_u32_u16 v144, v144, v144, 0 op_sel:[0,1,0,0]
    v_mad_u32_u16 v145, v145, v145, 0 op_sel:[0,1,0,0]
    v_mad_u32_u16 v146, v146, v146, 0 op_sel:[0,1,0,0]
    v_mad_u32_u16 v147, v147, v147, 0 op_sel:[0,1,0,0]
    v_cmp_ne_u32 s[88:89], 0, v144
    v_cmp_ne_u32 s[90:91], 0, v145
    v_cmp_ne_u32 s[92:93], 0, v146
    v_cmp_ne_u32 s[94:95], 0, v147
    s_andn2_b64 s[80:81], s[80:81], s[88:89]
    s_andn2_b64 s[82:83], s[82:83], s[90:91]
    s_andn2_b64 s[84:85], s[84:85], s[92:93]
    s_andn2_b64 s[86:87], s[86:87], s[94:95]
    s_bcnt1_i32_b64 s48, s[88:89]
    s_bcnt1_i32_b64 s49, s[90:91]
    s_bcnt1_i32_b64 s50, s[92:93]
    s_bcnt1_i32_b64 s51, s[94:95]
    s_lshr_b32 s52, s89, 4
    s_lshr_b32 s61, s91, 4
    s_bcnt1_i32_b32 s52, s52
    s_bcnt1_i32_b32 s61, s61
    s_add_u32 s51, s51, s50
    s_add_u32 s43, s48, s49
    s_add_u32 s43, s43, s51
    s_add_u32 s51, s51, s52
    s_add_u32 s51, s51, s61
    s_cmp_gt_u32 s43, 31
    s_cbranch_scc1 L_bfail0
    s_lshl_b32 s96, s51, 1
    s_sub_u32 s43, s43, s51
    s_lshl_b32 s97, s43, 1
    s_sub_u32 s43, 64, s97
    s_bfm_b64 s[98:99], s96, 0
    s_bfm_b64 vcc, s97, s43
    s_or_b64 s[98:99], s[98:99], vcc
    s_mov_b32 s40, 32
    s_lshl_b32 s41, s3, 5
    s_add_u32 s41, s41, 9808
    v_mul_u32_u24 v144, s40, v108
    s_sub_u32 s40, s40, s48
    s_add_u32 s41, s41, s52
    v_mul_u32_u24 v145, s40, v108
    s_sub_u32 s48, s41, s48
    s_add_u32 s41, s41, s61
    s_sub_u32 s49, s41, s49
    s_add_u32 s50, s50, s41
    v_mbcnt_lo_u32_b32 v144, s88, v144
    v_mbcnt_lo_u32_b32 v145, s90, v145
    v_mbcnt_lo_u32_b32 v146, s92, 0
    v_mbcnt_lo_u32_b32 v147, s94, 0
    v_mbcnt_hi_u32_b32 v144, s89, v144
    v_mbcnt_hi_u32_b32 v145, s91, v145
    v_mbcnt_hi_u32_b32 v146, s93, v146
    v_mbcnt_hi_u32_b32 v147, s95, v147
    v_add_lshl_u32 v144, v144, s48, 4
    v_add_lshl_u32 v145, v145, s49, 4
    v_add_lshl_u32 v146, v146, s41, 4
    v_add_lshl_u32 v147, v147, s50, 4
    v_cndmask_b32 v144, v111, v144, s[88:89]
    v_cndmask_b32 v145, v111, v145, s[90:91]
    v_cndmask_b32 v146, v111, v146, s[92:93]
    v_cndmask_b32 v147, v111, v147, s[94:95]
    ds_write_b64 v144, v[168:169]
    ds_write_b32 v144, v169 offset:12
    ds_write_b64 v145, v[170:171]
    ds_write_b32 v145, v171 offset:12
    ds_write_b64 v146, v[172:173]
    ds_write_b32 v146, v173 offset:12
    ds_write_b64 v147, v[174:175]
    ds_write_b32 v147, v175 offset:12
    s_branch L_singles
L_mc:
    s_mov_b32 s39, 0
    s_sub_u32 s33, 10, s46
    s_add_u32 s32, s53, s46
    s_sub_u32 s32, s32, 6
    s_max_i32 s32, s32, 0
    s_movk_i32 s34, 3456
    s_movk_i32 s36, 18
    s_mul_i32 s64, s3, 3456
    s_add_u32 s64, s64, 89088
    s_add_u32 s66, s64, 13824
    s_add_u32 s68, s64, 27648
    s_mul_i32 s40, s80, 3072
    s_add_u32 s40, s40, 9599808
    s_add_u32 s69, s3, 8
    s_mul_i32 s65, s69, s61
    s_add_u32 s65, s65, s44
    s_min_u32 s65, s65, s40
    s_add_u32 s41, s44, 516096
    s_min_u32 s41, s41, s40
    s_sub_u32 s40, s69, s46
    s_add_u32 s69, s40, s32
    s_mul_i32 s69, s69, s61
    s_sub_u32 s67, s69, 172032
    s_cmp_lt_u32 s40, 4
    s_cselect_b32 s67, s41, s67
    s_mul_i32 s40, s57, 86016
    s_sub_u32 s40, s56, s40
    s_add_u32 s74, s40, 258048
    s_add_u32 s75, s40, 344064
    s_add_u32 s40, s40, 430080
    s_mul_i32 s79, s57, 3456
    s_add_u32 s79, s79, 0x80054e80
    s_add_u32 s78, s79, 6912
    s_add_u32 s41, s79, 13824
    s_sub_u32 s77, s43, s32
    s_mul_i32 s77, s77, 3456
    s_add_u32 s77, s77, s35
    s_cmp_eq_u32 s43, 0
    s_cselect_b32 s43, 0, 0x80000000
    s_or_b32 s77, s77, s43
    s_sub_u32 s38, 21, s46
    s_lshl_b32 s38, s38, 16
    s_sub_u32 s43, s46, s57
    s_cmp_eq_u32 s43, 5
    s_cselect_b32 s76, s40, s76
    s_cselect_b32 s77, s41, s77
    s_branch L_mc_back
L_extra:
    s_mul_i32 s72, s2, 9600
    s_add_u32 s72, s72, 127488
    s_mul_i32 s70, s57, 3072
    s_add_u32 s70, s70, s72
    s_addk_i32 s72, 6144
    s_add_u32 s73, s32, s2
    s_mulk_i32 s73, 192
    s_addk_i32 s73, 768
    s_mul_i32 s71, s57, 688128
    s_add_u32 s71, s71, s73
    s_add_u32 s73, s73, 1376256
    s_mov_b32 m0, s70
    s_nop 0
    buffer_load_dwordx4 v9, s[8:11], s71 offen  lds
    buffer_load_dwordx4 v10, s[8:11], s71 offen offset:1024  lds
    buffer_load_dwordx4 v11, s[8:11], s71 offen offset:2048  lds
    buffer_load_dwordx4 v12, s[8:11], s71 offen offset:2432  lds
    s_mov_b32 m0, s72
    s_nop 0
    buffer_load_dwordx4 v9, s[8:11], s73 offen  lds
    buffer_load_dwordx4 v10, s[8:11], s73 offen offset:1024  lds
    buffer_load_dwordx4 v11, s[8:11], s73 offen offset:2048  lds
    buffer_load_dwordx4 v12, s[8:11], s73 offen offset:2432  lds
    s_branch L_extra_back
L_more:
    ds_read2_b32 v[176:177], v24 offset0:64 offset1:96
    ds_read_b64 v[178:179], v25 offset:264
    s_waitcnt lgkmcnt(0)
    v_xor_b32 v172, v176, v26
    v_xor_b32 v174, v177, v26
    v_xor_b32 v173, v176, v27
    v_xor_b32 v175, v177, v27
    ds_read_b64_tr_b16 v[144:145], v172 offset:0
    ds_read_b64_tr_b16 v[146:147], v174 offset:0
    ds_read_b64_tr_b16 v[148:149], v173 offset:0
    ds_read_b64_tr_b16 v[150:151], v175 offset:0
    ds_read_b64_tr_b16 v[152:153], v172 offset:64
    ds_read_b64_tr_b16 v[154:155], v174 offset:64
    v_cndmask_b32 v169, 0, v179, s[88:89]
    v_cndmask_b32 v171, 0, v179, s[92:93]
    v_cndmask_b32 v168, 0, v178, s[88:89]
    v_cndmask_b32 v170, 0, v178, s[92:93]
    v_cndmask_b32 v169, v169, v178, s[90:91]
    v_cndmask_b32 v171, v171, v178, s[94:95]
    ds_read_b64_tr_b16 v[156:157], v173 offset:64
    ds_read_b64_tr_b16 v[158:159], v175 offset:64
    ds_read_b64_tr_b16 v[160:161], v172 offset:128
    ds_read_b64_tr_b16 v[162:163], v174 offset:128
    ds_read_b64_tr_b16 v[164:165], v173 offset:128
    ds_read_b64_tr_b16 v[166:167], v175 offset:128
    s_waitcnt lgkmcnt(0)
    v_mfma_f32_16x16x32_bf16 v[144:147], v[144:147], v[168:171], 0
    v_mfma_f32_16x16x32_bf16 v[148:151], v[148:151], v[168:171], 0
    v_mfma_f32_16x16x32_bf16 v[152:155], v[152:155], v[168:171], 0
    v_mfma_f32_16x16x32_bf16 v[156:159], v[156:159], v[168:171], 0
    v_mfma_f32_16x16x32_bf16 v[160:163], v[160:163], v[168:171], 0
    v_mfma_f32_16x16x32_bf16 v[164:167], v[164:167], v[168:171], 0
    s_nop 3
    v_cvt_pk_bf16_f32 v144, v144, v145
    v_cvt_pk_bf16_f32 v145, v146, v147
    ds_write_b64 v28, v[144:145] offset:12288
    v_cvt_pk_bf16_f32 v148, v148, v149
    v_cvt_pk_bf16_f32 v149, v150, v151
    ds_write_b64 v29, v[148:149] offset:12288
    v_cvt_pk_bf16_f32 v152, v152, v153
    v_cvt_pk_bf16_f32 v153, v154, v155
    ds_write_b64 v28, v[152:153] offset:12352
    v_cvt_pk_bf16_f32 v156, v156, v157
    v_cvt_pk_bf16_f32 v157, v158, v159
    ds_write_b64 v29, v[156:157] offset:12352
    v_cvt_pk_bf16_f32 v160, v160, v161
    v_cvt_pk_bf16_f32 v161, v162, v163
    ds_write_b64 v28, v[160:161] offset:12416
    v_cvt_pk_bf16_f32 v164, v164, v165
    v_cvt_pk_bf16_f32 v165, v166, v167
    ds_write_b64 v29, v[164:165] offset:12416
    s_waitcnt lgkmcnt(0)
    s_branch L_more_back
.p2align 6
L_x:
    v_and_b32 v2, 15, v0
    v_lshrrev_b32 v3, 4, v1
    s_movk_i32 s42, 192
    v_mov_b32 v34, 158976
    v_mov_b32 v147, 0
    ds_write_b32 v34, v147
    v_bfe_u32 v144, v1, 2, 2
    v_lshl_add_u32 v144, v3, 3, v144
    v_and_b32 v145, 3, v1
    v_mul_u32_u24 v144, 192, v144
    v_and_b32 v146, 1, v3
    v_lshl_add_u32 v144, v145, 3, v144
    s_lshl2_add_u32 s40, s2, 0
    v_xor_b32 v147, s40, v146
    v_lshl_add_u32 v13, v147, 5, v144
    s_lshl2_add_u32 s40, s2, 1
    v_xor_b32 v147, s40, v146
    v_lshl_add_u32 v14, v147, 5, v144
    s_add_u32 s40, s2, 2
    v_xor_b32 v147, s40, v146
    v_lshl_add_u32 v15, v147, 5, v144
    v_lshlrev_b32 v26, 4, v145
    v_lshl_add_u32 v26, v146, 3, v26
    v_xor_b32 v27, 8, v26
    s_mul_i32 s40, s57, 10368
    s_add_u32 s40, s40, 61440
    s_cmp_eq_u32 s80, 10
    s_cselect_b32 s41, 16, 17
    v_add_u32 v144, 0, v2
    v_and_b32 v145, 4, v144
    v_lshl_add_u32 v145, v145, 3, s40
    v_mad_u32_u24 v145, v144, s42, v145
    v_xor_b32 v16, v145, v4
    v_add_u32 v144, 1, v2
    v_and_b32 v145, 4, v144
    v_lshl_add_u32 v145, v145, 3, s40
    v_mad_u32_u24 v145, v144, s42, v145
    v_xor_b32 v17, v145, v4
    v_add_u32 v144, 2, v2
    v_min_u32 v144, s41, v144
    v_and_b32 v145, 4, v144
    v_lshl_add_u32 v145, v145, 3, s40
    v_mad_u32_u24 v145, v144, s42, v145
    v_xor_b32 v18, v145, v4
    s_mul_i32 s40, s57, 6912
    v_subrev_u32 v40, s40, v16
    v_subrev_u32 v41, s40, v17
    v_subrev_u32 v42, s40, v18
    v_lshrrev_b32 v144, 5, v1
    v_and_b32 v145, 16, v1
    v_lshlrev_b32 v145, 1, v145
    v_lshl_add_u32 v145, v144, 4, v145
    v_lshl_add_u32 v145, s2, 7, v145
    v_mad_u32_u24 v19, v2, s42, v145
    v_mad_u32_u24 v21, v2, s42, v145
    v_lshl_add_u32 v146, s2, 2, v3
    v_lshrrev_b32 v145, 1, v2
    v_and_b32 v145, 6, v145
    v_xor_b32 v145, v145, v146
    v_lshl_add_u32 v145, v2, 3, v145
    s_lshl_b32 s40, s57, 10
    v_lshl_add_u32 v38, v145, 3, s40
    v_lshlrev_b32 v39, 3, v0
    v_lshl_add_u32 v144, s2, 1, v144
    v_lshlrev_b32 v144, 4, v144
    v_xor_b32 v144, v144, v39
    v_bfe_u32 v147, v0, 3, 4
    v_and_or_b32 v144, v144, 56, 64
    v_mad_u32_u24 v20, v147, s42, v144
    v_mad_u32_u24 v22, v147, s42, v144
    s_mul_i32 s40, s57, 129024
    s_add_u32 s56, s44, 43200
    s_add_u32 s56, s56, s40
    s_add_u32 s4, s56, 43008
    s_add_u32 s5, s56, 86016
    s_mul_i32 s55, s45, 36
    s_mul_i32 s41, s46, 36
    s_add_u32 s41, s41, 216
    s_movk_i32 s40, 7488
    v_mov_b32 v146, 0x7f000000
    v_cmp_gt_u32 vcc, s41, v0
    v_mul_u32_u24 v144, 1821, v0
    v_lshrrev_b32 v144, 16, v144
    v_lshlrev_b32 v145, 4, v0
    v_mad_u32_u24 v145, v144, s40, v145
    v_lshlrev_b32 v32, v144, 1
    v_cndmask_b32 v30, v146, v145, vcc
    v_add_u32 v147, 256, v0
    v_cmp_gt_u32 vcc, s41, v147
    v_mul_u32_u24 v144, 1821, v147
    v_lshrrev_b32 v144, 16, v144
    v_lshlrev_b32 v145, 4, v147
    v_mad_u32_u24 v145, v144, s40, v145
    v_lshlrev_b32 v33, v144, 1
    v_cndmask_b32 v31, v146, v145, vcc
    s_mul_i32 s40, s57, 86016
    s_sub_u32 s40, s56, s40
    s_add_u32 s74, s40, 258048
    s_add_u32 s75, s40, 344064
    s_add_u32 s76, s40, 430080
    s_add_u32 s77, s40, 516096
    s_cmp_ge_u32 s45, 47040
    s_cselect_b32 s40, 43008, 0
    s_sub_u32 s53, s44, s40
    s_mov_b32 s37, 0x3e803e80
    s_mov_b32 s96, 0x7fff7fff
    s_mov_b32 s60, 0x435f435f
    s_add_u32 m0, s25, 20736
    s_add_u32 s31, s44, 258048
    buffer_load_dwordx4 v8, s[8:11], s31 offen  lds
    s_add_u32 m0, s25, 24192
    s_add_u32 s31, s44, 301056
    buffer_load_dwordx4 v8, s[8:11], s31 offen  lds
    s_waitcnt vmcnt(11) lgkmcnt(0)
    s_barrier
    ds_read_b64_tr_b16 a[0:1], v13 offset:12288
    ds_read_b64_tr_b16 a[2:3], v13 offset:13056
    ds_read_b64_tr_b16 a[4:5], v14 offset:12288
    ds_read_b64_tr_b16 a[6:7], v14 offset:13056
    s_add_u32 m0, s24, 36864
    s_add_u32 s31, s28, 55296
    buffer_load_dwordx4 v5, s[16:19], s31 offen lds
    ds_read_b64_tr_b16 a[8:9], v15 offset:12288
    ds_read_b64_tr_b16 a[10:11], v15 offset:13056
    buffer_load_dwordx4 v6, s[16:19], s31 offen offset:1024 lds
    ds_read_b64_tr_b16 a[12:13], v13 offset:18432
    ds_read_b64_tr_b16 a[14:15], v13 offset:19200
    buffer_load_dwordx4 v7, s[16:19], s31 offen offset:2048 lds
    ds_read_b64_tr_b16 a[16:17], v14 offset:18432
    ds_read_b64_tr_b16 a[18:19], v14 offset:19200
    s_add_u32 m0, s24, 49152
    s_add_u32 s31, s28, 61440
    buffer_load_dwordx4 v5, s[16:19], s31 offen lds
    ds_read_b64_tr_b16 a[20:21], v15 offset:18432
    ds_read_b64_tr_b16 a[22:23], v15 offset:19200
    buffer_load_dwordx4 v6, s[16:19], s31 offen offset:1024 lds
    buffer_load_dwordx4 v7, s[16:19], s31 offen offset:2048 lds
    s_waitcnt lgkmcnt(0)
    s_waitcnt vmcnt(8)
    s_barrier
    ds_read_b128 v[112:115], v16 offset:0
    ds_read_b128 v[116:119], v16 offset:3456
    ds_read_b128 v[120:123], v16 offset:6912
    ds_read_b128 v[124:127], v16 offset:64
    s_waitcnt lgkmcnt(3)
    v_mfma_f32_16x16x32_bf16 v[64:67], a[0:3], v[112:115], 0
    ds_read_b64_tr_b16 a[24:25], v13 offset:24576
    ds_read_b128 v[128:131], v16 offset:3520
    v_mfma_f32_16x16x32_bf16 v[68:71], a[4:7], v[112:115], 0
    ds_read_b64_tr_b16 a[26:27], v13 offset:25344
    s_add_u32 m0, s24, 0
    v_mfma_f32_16x16x32_bf16 v[72:75], a[8:11], v[112:115], 0
    ds_read_b64_tr_b16 a[28:29], v14 offset:24576
    s_waitcnt lgkmcnt(6)
    v_mfma_f32_16x16x32_bf16 v[76:79], a[0:3], v[116:119], 0
    ds_read_b64_tr_b16 a[30:31], v14 offset:25344
    ds_read_b128 v[132:135], v16 offset:6976
    v_mfma_f32_16x16x32_bf16 v[80:83], a[4:7], v[116:119], 0
    ds_read_b64_tr_b16 a[32:33], v15 offset:24576
    s_add_u32 s31, s28, 67584
    v_mfma_f32_16x16x32_bf16 v[84:87], a[8:11], v[116:119], 0
    ds_read_b64_tr_b16 a[34:35], v15 offset:25344
    s_waitcnt lgkmcnt(8)
    v_mfma_f32_16x16x32_bf16 v[88:91], a[0:3], v[120:123], 0
    ds_read_b64_tr_b16 a[36:37], v13 offset:30720
    ds_read_b128 v[136:139], v16 offset:128
    v_mfma_f32_16x16x32_bf16 v[92:95], a[4:7], v[120:123], 0
    ds_read_b64_tr_b16 a[38:39], v13 offset:31488
    buffer_load_dwordx4 v5, s[16:19], s31 offen lds
    v_mfma_f32_16x16x32_bf16 v[96:99], a[8:11], v[120:123], 0
    ds_read_b64_tr_b16 a[40:41], v14 offset:30720
    v_mfma_f32_16x16x32_bf16 v[64:67], a[12:15], v[124:127], v[64:67]
    ds_read_b64_tr_b16 a[42:43], v14 offset:31488
    ds_read_b128 v[140:143], v16 offset:3584
    v_mfma_f32_16x16x32_bf16 v[68:71], a[16:19], v[124:127], v[68:71]
    ds_read_b64_tr_b16 a[44:45], v15 offset:30720
    v_mfma_f32_16x16x32_bf16 v[72:75], a[20:23], v[124:127], v[72:75]
    ds_read_b64_tr_b16 a[46:47], v15 offset:31488
    s_waitcnt lgkmcnt(8)
    v_mfma_f32_16x16x32_bf16 v[76:79], a[12:15], v[128:131], v[76:79]
    ds_read_b128 v[112:115], v16 offset:7040
    buffer_load_dwordx4 v6, s[16:19], s31 offen offset:1024 lds
    v_mfma_f32_16x16x32_bf16 v[80:83], a[16:19], v[128:131], v[80:83]
    v_mfma_f32_16x16x32_bf16 v[84:87], a[20:23], v[128:131], v[84:87]
    v_mfma_f32_16x16x32_bf16 v[88:91], a[12:15], v[132:135], v[88:91]
    ds_read_b128 v[116:119], v17 offset:0
    v_mfma_f32_16x16x32_bf16 v[92:95], a[16:19], v[132:135], v[92:95]
    buffer_load_dwordx4 v7, s[16:19], s31 offen offset:2048 lds
    s_add_u32 m0, s24, 12288
    v_mfma_f32_16x16x32_bf16 v[96:99], a[20:23], v[132:135], v[96:99]
    s_waitcnt vmcnt(6) lgkmcnt(2)
    s_barrier
    v_mfma_f32_16x16x32_bf16 v[64:67], a[24:27], v[136:139], v[64:67]
    ds_read_b64_tr_b16 a[108:109], v13 offset:36864
    ds_read_b128 v[120:123], v17 offset:3456
    v_mfma_f32_16x16x32_bf16 v[68:71], a[28:31], v[136:139], v[68:71]
    ds_read_b64_tr_b16 a[110:111], v13 offset:37632
    s_add_u32 s31, s28, 73728
    v_mfma_f32_16x16x32_bf16 v[72:75], a[32:35], v[136:139], v[72:75]
    ds_read_b64_tr_b16 a[112:113], v14 offset:36864
    buffer_load_dwordx4 v5, s[16:19], s31 offen lds
    v_mfma_f32_16x16x32_bf16 v[76:79], a[24:27], v[140:143], v[76:79]
    ds_read_b64_tr_b16 a[114:115], v14 offset:37632
    ds_read_b128 v[124:127], v17 offset:6912
    v_mfma_f32_16x16x32_bf16 v[80:83], a[28:31], v[140:143], v[80:83]
    ds_read_b64_tr_b16 a[116:117], v15 offset:36864
    v_mfma_f32_16x16x32_bf16 v[84:87], a[32:35], v[140:143], v[84:87]
    ds_read_b64_tr_b16 a[118:119], v15 offset:37632
    s_waitcnt lgkmcnt(8)
    v_mfma_f32_16x16x32_bf16 v[88:91], a[24:27], v[112:115], v[88:91]
    ds_read_b64_tr_b16 a[216:217], v13 offset:43008
    ds_read_b128 v[128:131], v16 offset:3456
    v_mfma_f32_16x16x32_bf16 v[92:95], a[28:31], v[112:115], v[92:95]
    ds_read_b64_tr_b16 a[218:219], v13 offset:43776
    buffer_load_dwordx4 v6, s[16:19], s31 offen offset:1024 lds
    v_mfma_f32_16x16x32_bf16 v[96:99], a[32:35], v[112:115], v[96:99]
    ds_read_b64_tr_b16 a[220:221], v14 offset:43008
    v_mfma_f32_16x16x32_bf16 v[64:67], a[36:39], v[116:119], v[64:67]
    ds_read_b64_tr_b16 a[222:223], v14 offset:43776
    ds_read_b128 v[132:135], v16 offset:6912
    v_mfma_f32_16x16x32_bf16 v[68:71], a[40:43], v[116:119], v[68:71]
    ds_read_b64_tr_b16 a[224:225], v15 offset:43008
    v_mfma_f32_16x16x32_bf16 v[72:75], a[44:47], v[116:119], v[72:75]
    ds_read_b64_tr_b16 a[226:227], v15 offset:43776
    s_waitcnt lgkmcnt(8)
    v_mfma_f32_16x16x32_bf16 v[76:79], a[36:39], v[120:123], v[76:79]
    buffer_load_dwordx4 v7, s[16:19], s31 offen offset:2048 lds
    s_add_u32 m0, s24, 24576
    v_mfma_f32_16x16x32_bf16 v[80:83], a[40:43], v[120:123], v[80:83]
    s_add_u32 s31, s28, 24576
    v_mfma_f32_16x16x32_bf16 v[84:87], a[44:47], v[120:123], v[84:87]
    v_mfma_f32_16x16x32_bf16 v[88:91], a[36:39], v[124:127], v[88:91]
    v_mfma_f32_16x16x32_bf16 v[92:95], a[40:43], v[124:127], v[92:95]
    buffer_load_dwordx4 v5, s[16:19], s31 offen lds
    v_mfma_f32_16x16x32_bf16 v[96:99], a[44:47], v[124:127], v[96:99]
    s_waitcnt vmcnt(7) lgkmcnt(0)
    s_barrier
    v_mfma_f32_16x16x32_bf16 v[64:67], a[108:111], v[128:131], v[64:67]
    ds_read_b128 v[136:139], v16 offset:10368
    ds_read_b64_tr_b16 a[120:121], v13 offset:49152
    v_mfma_f32_16x16x32_bf16 v[68:71], a[112:115], v[128:131], v[68:71]
    ds_read_b64_tr_b16 a[122:123], v13 offset:49920
    v_mfma_f32_16x16x32_bf16 v[72:75], a[116:119], v[128:131], v[72:75]
    ds_read_b64_tr_b16 a[124:125], v14 offset:49152
    buffer_load_dwordx4 v6, s[16:19], s31 offen offset:1024 lds
    v_mfma_f32_16x16x32_bf16 v[76:79], a[108:111], v[132:135], v[76:79]
    ds_read_b64_tr_b16 a[126:127], v14 offset:49920
    ds_read_b128 v[140:143], v16 offset:13824
    v_mfma_f32_16x16x32_bf16 v[80:83], a[112:115], v[132:135], v[80:83]
    ds_read_b64_tr_b16 a[128:129], v15 offset:49152
    v_mfma_f32_16x16x32_bf16 v[84:87], a[116:119], v[132:135], v[84:87]
    ds_read_b64_tr_b16 a[130:131], v15 offset:49920
    s_waitcnt lgkmcnt(7)
    v_mfma_f32_16x16x32_bf16 v[88:91], a[108:111], v[136:139], v[88:91]
    ds_read_b64_tr_b16 a[228:229], v13 offset:55296
    ds_read_b128 v[112:115], v16 offset:3520
    v_mfma_f32_16x16x32_bf16 v[92:95], a[112:115], v[136:139], v[92:95]
    ds_read_b64_tr_b16 a[230:231], v13 offset:56064
    buffer_load_dwordx4 v7, s[16:19], s31 offen offset:2048 lds
    v_mfma_f32_16x16x32_bf16 v[96:99], a[116:119], v[136:139], v[96:99]
    ds_read_b64_tr_b16 a[232:233], v14 offset:55296
    s_add_u32 m0, s24, 36864
    v_mfma_f32_16x16x32_bf16 v[64:67], a[216:219], v[132:135], v[64:67]
    ds_read_b64_tr_b16 a[234:235], v14 offset:56064
    ds_read_b128 v[116:119], v16 offset:6976
    v_mfma_f32_16x16x32_bf16 v[68:71], a[220:223], v[132:135], v[68:71]
    ds_read_b64_tr_b16 a[236:237], v15 offset:55296
    s_add_u32 s31, s26, 135168
    v_mfma_f32_16x16x32_bf16 v[72:75], a[224:227], v[132:135], v[72:75]
    ds_read_b64_tr_b16 a[238:239], v15 offset:56064
    buffer_load_dwordx4 v5, s[16:19], s31 offen lds
    v_mfma_f32_16x16x32_bf16 v[76:79], a[216:219], v[136:139], v[76:79]
    ds_read_b128 v[120:123], v16 offset:10432
    v_mfma_f32_16x16x32_bf16 v[80:83], a[220:223], v[136:139], v[80:83]
    v_mfma_f32_16x16x32_bf16 v[84:87], a[224:227], v[136:139], v[84:87]
    s_waitcnt lgkmcnt(5)
    v_mfma_f32_16x16x32_bf16 v[88:91], a[216:219], v[140:143], v[88:91]
    buffer_load_dwordx4 v6, s[16:19], s31 offen offset:1024 lds
    v_mfma_f32_16x16x32_bf16 v[92:95], a[220:223], v[140:143], v[92:95]
    v_mfma_f32_16x16x32_bf16 v[96:99], a[224:227], v[140:143], v[96:99]
    s_waitcnt vmcnt(8) lgkmcnt(1)
    s_barrier
    v_mfma_f32_16x16x32_bf16 v[64:67], a[120:123], v[112:115], v[64:67]
    ds_read_b64_tr_b16 a[132:133], v13 offset:0
    v_mfma_f32_16x16x32_bf16 v[68:71], a[124:127], v[112:115], v[68:71]
    ds_read_b64_tr_b16 a[134:135], v13 offset:768
    buffer_load_dwordx4 v7, s[16:19], s31 offen offset:2048 lds
    v_mfma_f32_16x16x32_bf16 v[72:75], a[128:131], v[112:115], v[72:75]
    ds_read_b64_tr_b16 a[136:137], v14 offset:0
    s_add_u32 m0, s24, 49152
    v_mfma_f32_16x16x32_bf16 v[76:79], a[120:123], v[116:119], v[76:79]
    ds_read_b64_tr_b16 a[138:139], v14 offset:768
    ds_read_b128 v[124:127], v16 offset:13888
    v_mfma_f32_16x16x32_bf16 v[80:83], a[124:127], v[116:119], v[80:83]
    ds_read_b64_tr_b16 a[140:141], v15 offset:0
    s_add_u32 s31, s28, 86016
    v_mfma_f32_16x16x32_bf16 v[84:87], a[128:131], v[116:119], v[84:87]
    ds_read_b64_tr_b16 a[142:143], v15 offset:768
    s_waitcnt lgkmcnt(7)
    v_mfma_f32_16x16x32_bf16 v[88:91], a[120:123], v[120:123], v[88:91]
    ds_read_b64_tr_b16 a[240:241], v13 offset:6144
    ds_read_b128 v[128:131], v16 offset:3584
    v_mfma_f32_16x16x32_bf16 v[92:95], a[124:127], v[120:123], v[92:95]
    ds_read_b64_tr_b16 a[242:243], v13 offset:6912
    buffer_load_dwordx4 v5, s[16:19], s31 offen lds
    v_mfma_f32_16x16x32_bf16 v[96:99], a[128:131], v[120:123], v[96:99]
    ds_read_b64_tr_b16 a[244:245], v14 offset:6144
    v_mfma_f32_16x16x32_bf16 v[64:67], a[228:231], v[116:119], v[64:67]
    ds_read_b64_tr_b16 a[246:247], v14 offset:6912
    ds_read_b128 v[132:135], v16 offset:7040
    v_mfma_f32_16x16x32_bf16 v[68:71], a[232:235], v[116:119], v[68:71]
    ds_read_b64_tr_b16 a[248:249], v15 offset:6144
    v_mfma_f32_16x16x32_bf16 v[72:75], a[236:239], v[116:119], v[72:75]
    ds_read_b64_tr_b16 a[250:251], v15 offset:6912
    buffer_load_dwordx4 v6, s[16:19], s31 offen offset:1024 lds
    v_mfma_f32_16x16x32_bf16 v[76:79], a[228:231], v[120:123], v[76:79]
    ds_read_b128 v[136:139], v16 offset:10496
    v_mfma_f32_16x16x32_bf16 v[80:83], a[232:235], v[120:123], v[80:83]
    v_mfma_f32_16x16x32_bf16 v[84:87], a[236:239], v[120:123], v[84:87]
    s_waitcnt lgkmcnt(5)
    v_mfma_f32_16x16x32_bf16 v[88:91], a[228:231], v[124:127], v[88:91]
    buffer_load_dwordx4 v7, s[16:19], s31 offen offset:2048 lds
    v_mfma_f32_16x16x32_bf16 v[92:95], a[232:235], v[124:127], v[92:95]
    v_mfma_f32_16x16x32_bf16 v[96:99], a[236:239], v[124:127], v[96:99]
    s_waitcnt vmcnt(9) lgkmcnt(1)
    s_barrier
    v_mfma_f32_16x16x32_bf16 v[64:67], a[132:135], v[128:131], v[64:67]
    ds_read_b64_tr_b16 a[144:145], v13 offset:12288
    s_add_u32 m0, s24, 0
    v_mfma_f32_16x16x32_bf16 v[68:71], a[136:139], v[128:131], v[68:71]
    ds_read_b64_tr_b16 a[146:147], v13 offset:13056
    s_add_u32 s31, s28, 36864
    v_mfma_f32_16x16x32_bf16 v[72:75], a[140:143], v[128:131], v[72:75]
    ds_read_b64_tr_b16 a[148:149], v14 offset:12288
    buffer_load_dwordx4 v5, s[16:19], s31 offen lds
    v_mfma_f32_16x16x32_bf16 v[76:79], a[132:135], v[132:135], v[76:79]
    ds_read_b64_tr_b16 a[150:151], v14 offset:13056
    ds_read_b128 v[140:143], v16 offset:13952
    v_mfma_f32_16x16x32_bf16 v[80:83], a[136:139], v[132:135], v[80:83]
    ds_read_b64_tr_b16 a[152:153], v15 offset:12288
    v_mfma_f32_16x16x32_bf16 v[84:87], a[140:143], v[132:135], v[84:87]
    ds_read_b64_tr_b16 a[154:155], v15 offset:13056
    s_waitcnt lgkmcnt(7)
    v_mfma_f32_16x16x32_bf16 v[88:91], a[132:135], v[136:139], v[88:91]
    ds_read_b64_tr_b16 a[252:253], v13 offset:18432
    ds_read_b128 v[112:115], v17 offset:3456
    v_mfma_f32_16x16x32_bf16 v[92:95], a[136:139], v[136:139], v[92:95]
    ds_read_b64_tr_b16 a[254:255], v13 offset:19200
    buffer_load_dwordx4 v6, s[16:19], s31 offen offset:1024 lds
    v_mfma_f32_16x16x32_bf16 v[96:99], a[140:143], v[136:139], v[96:99]
    ds_read_b64_tr_b16 v[188:189], v14 offset:18432
    v_mfma_f32_16x16x32_bf16 v[64:67], a[240:243], v[132:135], v[64:67]
    ds_read_b64_tr_b16 v[190:191], v14 offset:19200
    ds_read_b128 v[116:119], v17 offset:6912
    v_mfma_f32_16x16x32_bf16 v[68:71], a[244:247], v[132:135], v[68:71]
    ds_read_b64_tr_b16 v[192:193], v15 offset:18432
    v_mfma_f32_16x16x32_bf16 v[72:75], a[248:251], v[132:135], v[72:75]
    ds_read_b64_tr_b16 v[194:195], v15 offset:19200
    buffer_load_dwordx4 v7, s[16:19], s31 offen offset:2048 lds
    v_mfma_f32_16x16x32_bf16 v[76:79], a[240:243], v[136:139], v[76:79]
    ds_read_b128 v[120:123], v17 offset:10368
    v_mfma_f32_16x16x32_bf16 v[80:83], a[244:247], v[136:139], v[80:83]
    v_mfma_f32_16x16x32_bf16 v[84:87], a[248:251], v[136:139], v[84:87]
    s_waitcnt lgkmcnt(5)
    v_mfma_f32_16x16x32_bf16 v[88:91], a[240:243], v[140:143], v[88:91]
    v_mfma_f32_16x16x32_bf16 v[92:95], a[244:247], v[140:143], v[92:95]
    v_mfma_f32_16x16x32_bf16 v[96:99], a[248:251], v[140:143], v[96:99]
    s_waitcnt vmcnt(9) lgkmcnt(1)
    s_barrier
    v_mfma_f32_16x16x32_bf16 v[64:67], a[144:147], v[112:115], v[64:67]
    ds_read_b64_tr_b16 a[48:49], v13 offset:24576
    s_add_u32 m0, s24, 12288
    v_mfma_f32_16x16x32_bf16 v[68:71], a[148:151], v[112:115], v[68:71]
    ds_read_b64_tr_b16 a[50:51], v13 offset:25344
    s_add_u32 s31, s26, 147456
    v_mfma_f32_16x16x32_bf16 v[72:75], a[152:155], v[112:115], v[72:75]
    ds_read_b64_tr_b16 a[52:53], v14 offset:24576
    buffer_load_dwordx4 v5, s[16:19], s31 offen lds
    v_mfma_f32_16x16x32_bf16 v[76:79], a[144:147], v[116:119], v[76:79]
    ds_read_b64_tr_b16 a[54:55], v14 offset:25344
    ds_read_b128 v[124:127], v17 offset:13824
    v_mfma_f32_16x16x32_bf16 v[80:83], a[148:151], v[116:119], v[80:83]
    ds_read_b64_tr_b16 a[56:57], v15 offset:24576
    v_mfma_f32_16x16x32_bf16 v[84:87], a[152:155], v[116:119], v[84:87]
    ds_read_b64_tr_b16 a[58:59], v15 offset:25344
    s_waitcnt lgkmcnt(7)
    v_mfma_f32_16x16x32_bf16 v[88:91], a[144:147], v[120:123], v[88:91]
    ds_read_b64_tr_b16 a[156:157], v13 offset:30720
    ds_read_b128 v[128:131], v17 offset:64
    v_mfma_f32_16x16x32_bf16 v[92:95], a[148:151], v[120:123], v[92:95]
    ds_read_b64_tr_b16 a[158:159], v13 offset:31488
    buffer_load_dwordx4 v6, s[16:19], s31 offen offset:1024 lds
    v_mfma_f32_16x16x32_bf16 v[96:99], a[152:155], v[120:123], v[96:99]
    ds_read_b64_tr_b16 a[160:161], v14 offset:30720
    v_mfma_f32_16x16x32_bf16 v[64:67], a[252:255], v[116:119], v[64:67]
    ds_read_b64_tr_b16 a[162:163], v14 offset:31488
    ds_read_b128 v[132:135], v17 offset:3520
    v_mfma_f32_16x16x32_bf16 v[68:71], v[188:191], v[116:119], v[68:71]
    ds_read_b64_tr_b16 a[164:165], v15 offset:30720
    v_mfma_f32_16x16x32_bf16 v[72:75], v[192:195], v[116:119], v[72:75]
    ds_read_b64_tr_b16 a[166:167], v15 offset:31488
    buffer_load_dwordx4 v7, s[16:19], s31 offen offset:2048 lds
    v_mfma_f32_16x16x32_bf16 v[76:79], a[252:255], v[120:123], v[76:79]
    ds_read_b128 v[136:139], v17 offset:6976
    v_mfma_f32_16x16x32_bf16 v[80:83], v[188:191], v[120:123], v[80:83]
    v_mfma_f32_16x16x32_bf16 v[84:87], v[192:195], v[120:123], v[84:87]
    s_waitcnt lgkmcnt(5)
    v_mfma_f32_16x16x32_bf16 v[88:91], a[252:255], v[124:127], v[88:91]
    v_mfma_f32_16x16x32_bf16 v[92:95], v[188:191], v[124:127], v[92:95]
    v_mfma_f32_16x16x32_bf16 v[96:99], v[192:195], v[124:127], v[96:99]
    s_waitcnt vmcnt(9) lgkmcnt(1)
    s_barrier
    v_mfma_f32_16x16x32_bf16 v[64:67], a[48:51], v[128:131], v[64:67]
    ds_read_b64_tr_b16 v[196:197], v13 offset:36864
    s_add_u32 m0, s24, 24576
    v_mfma_f32_16x16x32_bf16 v[68:71], a[52:55], v[128:131], v[68:71]
    ds_read_b64_tr_b16 v[198:199], v13 offset:37632
    s_add_u32 s31, s28, 98304
    v_mfma_f32_16x16x32_bf16 v[72:75], a[56:59], v[128:131], v[72:75]
    ds_read_b64_tr_b16 v[200:201], v14 offset:36864
    buffer_load_dwordx4 v5, s[16:19], s31 offen lds
    v_mfma_f32_16x16x32_bf16 v[76:79], a[48:51], v[132:135], v[76:79]
    ds_read_b64_tr_b16 v[202:203], v14 offset:37632
    ds_read_b128 v[140:143], v17 offset:10432
    v_mfma_f32_16x16x32_bf16 v[80:83], a[52:55], v[132:135], v[80:83]
    ds_read_b64_tr_b16 v[204:205], v15 offset:36864
    v_mfma_f32_16x16x32_bf16 v[84:87], a[56:59], v[132:135], v[84:87]
    ds_read_b64_tr_b16 v[206:207], v15 offset:37632
    s_waitcnt lgkmcnt(7)
    v_mfma_f32_16x16x32_bf16 v[88:91], a[48:51], v[136:139], v[88:91]
    ds_read_b64_tr_b16 a[60:61], v13 offset:43008
    buffer_load_dwordx4 v6, s[16:19], s31 offen offset:1024 lds
    v_mfma_f32_16x16x32_bf16 v[92:95], a[52:55], v[136:139], v[92:95]
    ds_read_b64_tr_b16 a[62:63], v13 offset:43776
    v_mfma_f32_16x16x32_bf16 v[96:99], a[56:59], v[136:139], v[96:99]
    ds_read_b64_tr_b16 a[64:65], v14 offset:43008
    v_mfma_f32_16x16x32_bf16 v[64:67], a[156:159], v[132:135], v[64:67]
    ds_read_b64_tr_b16 a[66:67], v14 offset:43776
    v_mfma_f32_16x16x32_bf16 v[68:71], a[160:163], v[132:135], v[68:71]
    ds_read_b64_tr_b16 a[68:69], v15 offset:43008
    buffer_load_dwordx4 v7, s[16:19], s31 offen offset:2048 lds
    v_mfma_f32_16x16x32_bf16 v[72:75], a[164:167], v[132:135], v[72:75]
    ds_read_b64_tr_b16 a[70:71], v15 offset:43776
    v_mfma_f32_16x16x32_bf16 v[76:79], a[156:159], v[136:139], v[76:79]
    ds_read_b128 v[112:115], v17 offset:13888
    v_mfma_f32_16x16x32_bf16 v[80:83], a[160:163], v[136:139], v[80:83]
    v_mfma_f32_16x16x32_bf16 v[84:87], a[164:167], v[136:139], v[84:87]
    s_waitcnt lgkmcnt(4)
    v_mfma_f32_16x16x32_bf16 v[88:91], a[156:159], v[140:143], v[88:91]
    ds_read_b128 v[116:119], v17 offset:128
    v_mfma_f32_16x16x32_bf16 v[92:95], a[160:163], v[140:143], v[92:95]
    v_mfma_f32_16x16x32_bf16 v[96:99], a[164:167], v[140:143], v[96:99]
    s_waitcnt vmcnt(9) lgkmcnt(2)
    s_barrier
    v_mfma_f32_16x16x32_bf16 v[64:67], v[196:199], v[136:139], v[64:67]
    ds_read_b64_tr_b16 a[168:169], v13 offset:49152
    ds_read_b128 v[120:123], v17 offset:3584
    v_mfma_f32_16x16x32_bf16 v[68:71], v[200:203], v[136:139], v[68:71]
    ds_read_b64_tr_b16 a[170:171], v13 offset:49920
    s_add_u32 m0, s24, 36864
    v_mfma_f32_16x16x32_bf16 v[72:75], v[204:207], v[136:139], v[72:75]
    ds_read_b64_tr_b16 a[172:173], v14 offset:49152
    s_add_u32 s31, s28, 49152
    v_mfma_f32_16x16x32_bf16 v[76:79], v[196:199], v[140:143], v[76:79]
    ds_read_b64_tr_b16 a[174:175], v14 offset:49920
    ds_read_b128 v[124:127], v17 offset:7040
    v_mfma_f32_16x16x32_bf16 v[80:83], v[200:203], v[140:143], v[80:83]
    ds_read_b64_tr_b16 a[176:177], v15 offset:49152
    buffer_load_dwordx4 v5, s[16:19], s31 offen lds
    v_mfma_f32_16x16x32_bf16 v[84:87], v[204:207], v[140:143], v[84:87]
    ds_read_b64_tr_b16 a[178:179], v15 offset:49920
    s_waitcnt lgkmcnt(8)
    v_mfma_f32_16x16x32_bf16 v[88:91], v[196:199], v[112:115], v[88:91]
    ds_read_b64_tr_b16 v[208:209], v13 offset:55296
    v_mfma_f32_16x16x32_bf16 v[92:95], v[200:203], v[112:115], v[92:95]
    ds_read_b64_tr_b16 v[210:211], v13 offset:56064
    v_mfma_f32_16x16x32_bf16 v[96:99], v[204:207], v[112:115], v[96:99]
    ds_read_b64_tr_b16 v[212:213], v14 offset:55296
    buffer_load_dwordx4 v6, s[16:19], s31 offen offset:1024 lds
    v_mfma_f32_16x16x32_bf16 v[64:67], a[60:63], v[116:119], v[64:67]
    ds_read_b64_tr_b16 v[214:215], v14 offset:56064
    v_mfma_f32_16x16x32_bf16 v[68:71], a[64:67], v[116:119], v[68:71]
    ds_read_b64_tr_b16 v[216:217], v15 offset:55296
    v_mfma_f32_16x16x32_bf16 v[72:75], a[68:71], v[116:119], v[72:75]
    ds_read_b64_tr_b16 v[218:219], v15 offset:56064
    s_waitcnt lgkmcnt(6)
    v_mfma_f32_16x16x32_bf16 v[76:79], a[60:63], v[120:123], v[76:79]
    ds_read_b128 v[128:131], v17 offset:10496
    buffer_load_dwordx4 v7, s[16:19], s31 offen offset:2048 lds
    v_mfma_f32_16x16x32_bf16 v[80:83], a[64:67], v[120:123], v[80:83]
    v_mfma_f32_16x16x32_bf16 v[84:87], a[68:71], v[120:123], v[84:87]
    v_mfma_f32_16x16x32_bf16 v[88:91], a[60:63], v[124:127], v[88:91]
    v_mfma_f32_16x16x32_bf16 v[92:95], a[64:67], v[124:127], v[92:95]
    v_mfma_f32_16x16x32_bf16 v[96:99], a[68:71], v[124:127], v[96:99]
    s_waitcnt vmcnt(9) lgkmcnt(1)
    s_barrier
    v_mfma_f32_16x16x32_bf16 v[64:67], a[168:171], v[120:123], v[64:67]
    ds_read_b64_tr_b16 a[72:73], v13 offset:0
    s_add_u32 m0, s24, 49152
    v_mfma_f32_16x16x32_bf16 v[68:71], a[172:175], v[120:123], v[68:71]
    ds_read_b64_tr_b16 a[74:75], v13 offset:768
    s_add_u32 s31, s28, 159744
    v_mfma_f32_16x16x32_bf16 v[72:75], a[176:179], v[120:123], v[72:75]
    ds_read_b64_tr_b16 a[76:77], v14 offset:0
    buffer_load_dwordx4 v5, s[16:19], s31 offen lds
    v_mfma_f32_16x16x32_bf16 v[76:79], a[168:171], v[124:127], v[76:79]
    ds_read_b128 v[132:135], v17 offset:13952
    ds_read_b64_tr_b16 a[78:79], v14 offset:768
    v_mfma_f32_16x16x32_bf16 v[80:83], a[172:175], v[124:127], v[80:83]
    ds_read_b64_tr_b16 a[80:81], v15 offset:0
    v_mfma_f32_16x16x32_bf16 v[84:87], a[176:179], v[124:127], v[84:87]
    ds_read_b64_tr_b16 a[82:83], v15 offset:768
    s_waitcnt lgkmcnt(7)
    v_mfma_f32_16x16x32_bf16 v[88:91], a[168:171], v[128:131], v[88:91]
    ds_read_b128 v[136:139], v18 offset:0
    ds_read_b64_tr_b16 a[180:181], v13 offset:6144
    v_mfma_f32_16x16x32_bf16 v[92:95], a[172:175], v[128:131], v[92:95]
    ds_read_b64_tr_b16 a[182:183], v13 offset:6912
    buffer_load_dwordx4 v6, s[16:19], s31 offen offset:1024 lds
    v_mfma_f32_16x16x32_bf16 v[96:99], a[176:179], v[128:131], v[96:99]
    ds_read_b64_tr_b16 a[184:185], v14 offset:6144
    v_mfma_f32_16x16x32_bf16 v[64:67], v[208:211], v[124:127], v[64:67]
    ds_read_b128 v[140:143], v18 offset:3456
    ds_read_b64_tr_b16 a[186:187], v14 offset:6912
    v_mfma_f32_16x16x32_bf16 v[68:71], v[212:215], v[124:127], v[68:71]
    ds_read_b64_tr_b16 a[188:189], v15 offset:6144
    v_mfma_f32_16x16x32_bf16 v[72:75], v[216:219], v[124:127], v[72:75]
    ds_read_b64_tr_b16 a[190:191], v15 offset:6912
    buffer_load_dwordx4 v7, s[16:19], s31 offen offset:2048 lds
    v_mfma_f32_16x16x32_bf16 v[76:79], v[208:211], v[128:131], v[76:79]
    ds_read_b128 v[112:115], v18 offset:6912
    s_add_u32 m0, s25, 27648
    v_mfma_f32_16x16x32_bf16 v[80:83], v[212:215], v[128:131], v[80:83]
    s_add_u32 s31, s44, 344064
    v_mfma_f32_16x16x32_bf16 v[84:87], v[216:219], v[128:131], v[84:87]
    s_waitcnt lgkmcnt(5)
    v_mfma_f32_16x16x32_bf16 v[88:91], v[208:211], v[132:135], v[88:91]
    buffer_load_dwordx4 v8, s[8:11], s31 offen  lds
    s_add_u32 m0, s25, 31104
    v_mfma_f32_16x16x32_bf16 v[92:95], v[212:215], v[132:135], v[92:95]
    s_add_u32 s31, s44, 387072
    v_mfma_f32_16x16x32_bf16 v[96:99], v[216:219], v[132:135], v[96:99]
    s_waitcnt vmcnt(10) lgkmcnt(1)
    s_barrier
    v_mfma_f32_16x16x32_bf16 v[64:67], a[72:75], v[136:139], v[64:67]
    ds_read_b64_tr_b16 v[220:221], v13 offset:12288
    v_mfma_f32_16x16x32_bf16 v[68:71], a[76:79], v[136:139], v[68:71]
    ds_read_b64_tr_b16 v[222:223], v13 offset:13056
    buffer_load_dwordx4 v8, s[8:11], s31 offen  lds
    v_mfma_f32_16x16x32_bf16 v[72:75], a[80:83], v[136:139], v[72:75]
    ds_read_b64_tr_b16 v[224:225], v14 offset:12288
    v_mfma_f32_16x16x32_bf16 v[76:79], a[72:75], v[140:143], v[76:79]
    ds_read_b128 v[116:119], v18 offset:10368
    ds_read_b64_tr_b16 v[226:227], v14 offset:13056
    v_mfma_f32_16x16x32_bf16 v[80:83], a[76:79], v[140:143], v[80:83]
    ds_read_b64_tr_b16 v[228:229], v15 offset:12288
    v_mfma_f32_16x16x32_bf16 v[84:87], a[80:83], v[140:143], v[84:87]
    ds_read_b64_tr_b16 v[230:231], v15 offset:13056
    s_waitcnt lgkmcnt(7)
    v_mfma_f32_16x16x32_bf16 v[88:91], a[72:75], v[112:115], v[88:91]
    ds_read_b64_tr_b16 a[84:85], v13 offset:18432
    buffer_load_dwordx4 v[180:183], v30, s[12:15], s55 offen
    v_mfma_f32_16x16x32_bf16 v[92:95], a[76:79], v[112:115], v[92:95]
    ds_read_b64_tr_b16 a[86:87], v13 offset:19200
    v_mfma_f32_16x16x32_bf16 v[96:99], a[80:83], v[112:115], v[96:99]
    ds_read_b64_tr_b16 a[88:89], v14 offset:18432
    v_mfma_f32_16x16x32_bf16 v[64:67], a[180:183], v[140:143], v[64:67]
    ds_read_b64_tr_b16 a[90:91], v14 offset:19200
    v_mfma_f32_16x16x32_bf16 v[68:71], a[184:187], v[140:143], v[68:71]
    ds_read_b64_tr_b16 a[92:93], v15 offset:18432
    buffer_load_dwordx4 v[184:187], v31, s[12:15], s55 offen
    v_mfma_f32_16x16x32_bf16 v[72:75], a[188:191], v[140:143], v[72:75]
    ds_read_b64_tr_b16 a[94:95], v15 offset:19200
    s_add_u32 m0, s25, 34560
    v_mfma_f32_16x16x32_bf16 v[76:79], a[180:183], v[112:115], v[76:79]
    ds_read_b128 v[120:123], v18 offset:13824
    s_add_u32 s31, s44, 430080
    v_mfma_f32_16x16x32_bf16 v[80:83], a[184:187], v[112:115], v[80:83]
    v_mfma_f32_16x16x32_bf16 v[84:87], a[188:191], v[112:115], v[84:87]
    buffer_load_dwordx4 v8, s[8:11], s31 offen  lds
    s_waitcnt lgkmcnt(4)
    v_mfma_f32_16x16x32_bf16 v[88:91], a[180:183], v[116:119], v[88:91]
    ds_read_b128 v[124:127], v18 offset:64
    s_add_u32 m0, s25, 38016
    v_mfma_f32_16x16x32_bf16 v[92:95], a[184:187], v[116:119], v[92:95]
    s_add_u32 s31, s44, 473088
    v_mfma_f32_16x16x32_bf16 v[96:99], a[188:191], v[116:119], v[96:99]
    s_waitcnt vmcnt(11) lgkmcnt(2)
    s_barrier
    v_mfma_f32_16x16x32_bf16 v[64:67], v[220:223], v[112:115], v[64:67]
    ds_read_b128 v[128:131], v18 offset:3520
    ds_read_b64_tr_b16 a[192:193], v13 offset:24576
    v_mfma_f32_16x16x32_bf16 v[68:71], v[224:227], v[112:115], v[68:71]
    ds_read_b64_tr_b16 a[194:195], v13 offset:25344
    buffer_load_dwordx4 v8, s[8:11], s31 offen  lds
    v_mfma_f32_16x16x32_bf16 v[72:75], v[228:231], v[112:115], v[72:75]
    ds_read_b64_tr_b16 a[196:197], v14 offset:24576
    s_add_u32 m0, s25, 41472
    v_mfma_f32_16x16x32_bf16 v[76:79], v[220:223], v[116:119], v[76:79]
    ds_read_b128 v[132:135], v18 offset:6976
    ds_read_b64_tr_b16 a[198:199], v14 offset:25344
    v_mfma_f32_16x16x32_bf16 v[80:83], v[224:227], v[116:119], v[80:83]
    ds_read_b64_tr_b16 a[200:201], v15 offset:24576
    s_add_u32 s31, s44, 516096
    v_mfma_f32_16x16x32_bf16 v[84:87], v[228:231], v[116:119], v[84:87]
    ds_read_b64_tr_b16 a[202:203], v15 offset:25344
    s_waitcnt lgkmcnt(8)
    v_mfma_f32_16x16x32_bf16 v[88:91], v[220:223], v[120:123], v[88:91]
    ds_read_b64_tr_b16 v[232:233], v13 offset:30720
    buffer_load_dwordx4 v8, s[8:11], s31 offen  lds
    v_mfma_f32_16x16x32_bf16 v[92:95], v[224:227], v[120:123], v[92:95]
    ds_read_b64_tr_b16 v[234:235], v13 offset:31488
    s_add_u32 m0, s25, 44928
    v_mfma_f32_16x16x32_bf16 v[96:99], v[228:231], v[120:123], v[96:99]
    ds_read_b64_tr_b16 v[236:237], v14 offset:30720
    s_add_u32 s31, s44, 559104
    v_mfma_f32_16x16x32_bf16 v[64:67], a[84:87], v[124:127], v[64:67]
    ds_read_b64_tr_b16 v[238:239], v14 offset:31488
    v_mfma_f32_16x16x32_bf16 v[68:71], a[88:91], v[124:127], v[68:71]
    ds_read_b64_tr_b16 v[240:241], v15 offset:30720
    buffer_load_dwordx4 v8, s[8:11], s31 offen  lds
    v_mfma_f32_16x16x32_bf16 v[72:75], a[92:95], v[124:127], v[72:75]
    ds_read_b64_tr_b16 v[242:243], v15 offset:31488
    s_waitcnt lgkmcnt(6)
    v_mfma_f32_16x16x32_bf16 v[76:79], a[84:87], v[128:131], v[76:79]
    ds_read_b128 v[136:139], v18 offset:10432
    v_mfma_f32_16x16x32_bf16 v[80:83], a[88:91], v[128:131], v[80:83]
    v_mfma_f32_16x16x32_bf16 v[84:87], a[92:95], v[128:131], v[84:87]
    v_mfma_f32_16x16x32_bf16 v[88:91], a[84:87], v[132:135], v[88:91]
    v_mfma_f32_16x16x32_bf16 v[92:95], a[88:91], v[132:135], v[92:95]
    v_mfma_f32_16x16x32_bf16 v[96:99], a[92:95], v[132:135], v[96:99]
    s_waitcnt vmcnt(11) lgkmcnt(1)
    s_barrier
    v_mfma_f32_16x16x32_bf16 v[64:67], a[192:195], v[128:131], v[64:67]
    ds_read_b64_tr_b16 a[96:97], v13 offset:36864
    s_add_u32 m0, s25, 48384
    v_mfma_f32_16x16x32_bf16 v[68:71], a[196:199], v[128:131], v[68:71]
    ds_read_b64_tr_b16 a[98:99], v13 offset:37632
    s_add_u32 s31, s44, 602112
    v_mfma_f32_16x16x32_bf16 v[72:75], a[200:203], v[128:131], v[72:75]
    ds_read_b64_tr_b16 a[100:101], v14 offset:36864
    buffer_load_dwordx4 v8, s[8:11], s31 offen  lds
    v_mfma_f32_16x16x32_bf16 v[76:79], a[192:195], v[132:135], v[76:79]
    ds_read_b128 v[140:143], v18 offset:13888
    ds_read_b64_tr_b16 a[102:103], v14 offset:37632
    v_mfma_f32_16x16x32_bf16 v[80:83], a[196:199], v[132:135], v[80:83]
    ds_read_b64_tr_b16 a[104:105], v15 offset:36864
    s_add_u32 m0, s25, 51840
    v_mfma_f32_16x16x32_bf16 v[84:87], a[200:203], v[132:135], v[84:87]
    ds_read_b64_tr_b16 a[106:107], v15 offset:37632
    s_waitcnt lgkmcnt(7)
    v_mfma_f32_16x16x32_bf16 v[88:91], a[192:195], v[136:139], v[88:91]
    ds_read_b128 v[112:115], v18 offset:128
    ds_read_b64_tr_b16 a[204:205], v13 offset:43008
    v_mfma_f32_16x16x32_bf16 v[92:95], a[196:199], v[136:139], v[92:95]
    ds_read_b64_tr_b16 a[206:207], v13 offset:43776
    s_add_u32 s31, s53, 645120
    v_mfma_f32_16x16x32_bf16 v[96:99], a[200:203], v[136:139], v[96:99]
    ds_read_b64_tr_b16 a[208:209], v14 offset:43008
    buffer_load_dwordx4 v8, s[8:11], s31 offen  lds
    v_mfma_f32_16x16x32_bf16 v[64:67], v[232:235], v[132:135], v[64:67]
    ds_read_b128 v[116:119], v18 offset:3584
    ds_read_b64_tr_b16 a[210:211], v14 offset:43776
    v_mfma_f32_16x16x32_bf16 v[68:71], v[236:239], v[132:135], v[68:71]
    ds_read_b64_tr_b16 a[212:213], v15 offset:43008
    v_mfma_f32_16x16x32_bf16 v[72:75], v[240:243], v[132:135], v[72:75]
    ds_read_b64_tr_b16 a[214:215], v15 offset:43776
    v_mfma_f32_16x16x32_bf16 v[76:79], v[232:235], v[136:139], v[76:79]
    ds_read_b128 v[120:123], v18 offset:7040
    v_mfma_f32_16x16x32_bf16 v[80:83], v[236:239], v[136:139], v[80:83]
    v_mfma_f32_16x16x32_bf16 v[84:87], v[240:243], v[136:139], v[84:87]
    s_waitcnt lgkmcnt(5)
    v_mfma_f32_16x16x32_bf16 v[88:91], v[232:235], v[140:143], v[88:91]
    v_mfma_f32_16x16x32_bf16 v[92:95], v[236:239], v[140:143], v[92:95]
    v_mfma_f32_16x16x32_bf16 v[96:99], v[240:243], v[140:143], v[96:99]
    s_waitcnt vmcnt(10) lgkmcnt(1)
    s_barrier
    v_mfma_f32_16x16x32_bf16 v[64:67], a[96:99], v[112:115], v[64:67]
    ds_read_b64_tr_b16 v[244:245], v13 offset:49152
    v_mfma_f32_16x16x32_bf16 v[68:71], a[100:103], v[112:115], v[68:71]
    ds_read_b64_tr_b16 v[246:247], v13 offset:49920
    v_mfma_f32_16x16x32_bf16 v[72:75], a[104:107], v[112:115], v[72:75]
    ds_read_b64_tr_b16 v[248:249], v14 offset:49152
    v_mfma_f32_16x16x32_bf16 v[76:79], a[96:99], v[116:119], v[76:79]
    ds_read_b128 v[124:127], v18 offset:10496
    ds_read_b64_tr_b16 v[250:251], v14 offset:49920
    v_mfma_f32_16x16x32_bf16 v[80:83], a[100:103], v[116:119], v[80:83]
    ds_read_b64_tr_b16 v[252:253], v15 offset:49152
    v_mfma_f32_16x16x32_bf16 v[84:87], a[104:107], v[116:119], v[84:87]
    ds_read_b64_tr_b16 v[254:255], v15 offset:49920
    s_waitcnt lgkmcnt(7)
    v_mfma_f32_16x16x32_bf16 v[88:91], a[96:99], v[120:123], v[88:91]
    v_mfma_f32_16x16x32_bf16 v[92:95], a[100:103], v[120:123], v[92:95]
    v_mfma_f32_16x16x32_bf16 v[96:99], a[104:107], v[120:123], v[96:99]
    v_mfma_f32_16x16x32_bf16 v[64:67], a[204:207], v[116:119], v[64:67]
    v_mfma_f32_16x16x32_bf16 v[68:71], a[208:211], v[116:119], v[68:71]
    v_mfma_f32_16x16x32_bf16 v[72:75], a[212:215], v[116:119], v[72:75]
    v_mfma_f32_16x16x32_bf16 v[76:79], a[204:207], v[120:123], v[76:79]
    ds_read_b128 v[128:131], v18 offset:13952
    v_mfma_f32_16x16x32_bf16 v[80:83], a[208:211], v[120:123], v[80:83]
    v_mfma_f32_16x16x32_bf16 v[84:87], a[212:215], v[120:123], v[84:87]
    s_waitcnt lgkmcnt(1)
    v_mfma_f32_16x16x32_bf16 v[88:91], a[204:207], v[124:127], v[88:91]
    ds_read_b128 v[132:135], v40 offset:20736
    v_mfma_f32_16x16x32_bf16 v[92:95], a[208:211], v[124:127], v[92:95]
    v_mfma_f32_16x16x32_bf16 v[96:99], a[212:215], v[124:127], v[96:99]
    s_waitcnt vmcnt(9)
    s_barrier
    v_mfma_f32_16x16x32_bf16 v[64:67], v[244:247], v[120:123], v[64:67]
    ds_read_b128 v[136:139], v40 offset:20800
    v_mfma_f32_16x16x32_bf16 v[68:71], v[248:251], v[120:123], v[68:71]
    v_mfma_f32_16x16x32_bf16 v[72:75], v[252:255], v[120:123], v[72:75]
    v_mfma_f32_16x16x32_bf16 v[76:79], v[244:247], v[124:127], v[76:79]
    ds_read_b128 v[140:143], v40 offset:20864
    v_mfma_f32_16x16x32_bf16 v[80:83], v[248:251], v[124:127], v[80:83]
    v_mfma_f32_16x16x32_bf16 v[84:87], v[252:255], v[124:127], v[84:87]
    s_waitcnt lgkmcnt(2)
    v_mfma_f32_16x16x32_bf16 v[88:91], v[244:247], v[128:131], v[88:91]
    ds_read_b128 v[112:115], v41 offset:20736
    v_mfma_f32_16x16x32_bf16 v[92:95], v[248:251], v[128:131], v[92:95]
    v_mfma_f32_16x16x32_bf16 v[96:99], v[252:255], v[128:131], v[96:99]
    v_mfma_f32_16x16x32_bf16 v[100:103], a[0:3], v[132:135], 0
    ds_read_b128 v[116:119], v41 offset:20800
    v_mfma_f32_16x16x32_bf16 v[104:107], a[4:7], v[132:135], 0
    v_mfma_f32_16x16x32_bf16 v[108:111], a[8:11], v[132:135], 0
    v_cvt_pk_bf16_f32 v72, v72, v73
    s_waitcnt lgkmcnt(2)
    v_mfma_f32_16x16x32_bf16 v[100:103], a[12:15], v[136:139], v[100:103]
    ds_read_b128 v[120:123], v41 offset:20864
    v_cvt_pk_bf16_f32 v73, v74, v75
    v_mfma_f32_16x16x32_bf16 v[104:107], a[16:19], v[136:139], v[104:107]
    ds_write_b64 v38, v[72:73] offset:0
    v_mfma_f32_16x16x32_bf16 v[108:111], a[20:23], v[136:139], v[108:111]
    v_mfma_f32_16x16x32_bf16 v[100:103], a[24:27], v[140:143], v[100:103]
    ds_read_b128 v[124:127], v42 offset:20736
    v_cvt_pk_bf16_f32 v84, v84, v85
    v_mfma_f32_16x16x32_bf16 v[104:107], a[28:31], v[140:143], v[104:107]
    v_cvt_pk_bf16_f32 v85, v86, v87
    ds_write_b64 v38, v[84:85] offset:2048
    v_mfma_f32_16x16x32_bf16 v[108:111], a[32:35], v[140:143], v[108:111]
    s_waitcnt lgkmcnt(4)
    v_mfma_f32_16x16x32_bf16 v[100:103], a[36:39], v[112:115], v[100:103]
    ds_read_b128 v[128:131], v42 offset:20800
    v_mfma_f32_16x16x32_bf16 v[104:107], a[40:43], v[112:115], v[104:107]
    v_cvt_pk_bf16_f32 v96, v96, v97
    v_cvt_pk_bf16_f32 v97, v98, v99
    v_mfma_f32_16x16x32_bf16 v[108:111], a[44:47], v[112:115], v[108:111]
    ds_write_b64 v38, v[96:97] offset:4096
    v_cvt_pk_bf16_f32 v64, v64, v65
    v_mfma_f32_16x16x32_bf16 v[100:103], a[48:51], v[116:119], v[100:103]
    ds_read_b128 v[132:135], v42 offset:20864
    v_cvt_pk_bf16_f32 v65, v66, v67
    v_mfma_f32_16x16x32_bf16 v[104:107], a[52:55], v[116:119], v[104:107]
    v_cvt_pk_bf16_f32 v66, v68, v69
    v_cvt_pk_bf16_f32 v67, v70, v71
    v_mfma_f32_16x16x32_bf16 v[108:111], a[56:59], v[116:119], v[108:111]
    v_permlane16_swap_b32 v64, v66
    s_waitcnt lgkmcnt(3)
    v_mfma_f32_16x16x32_bf16 v[100:103], a[60:63], v[120:123], v[100:103]
    ds_read_b128 v[136:139], v40 offset:24192
    v_permlane16_swap_b32 v65, v67
    v_mfma_f32_16x16x32_bf16 v[104:107], a[64:67], v[120:123], v[104:107]
    v_mfma_f32_16x16x32_bf16 v[108:111], a[68:71], v[120:123], v[108:111]
    buffer_store_dwordx4 v[64:67], v19, s[20:23], s56 offen sc1
    v_mfma_f32_16x16x32_bf16 v[100:103], a[72:75], v[124:127], v[100:103]
    ds_read_b128 v[140:143], v40 offset:24256
    v_mfma_f32_16x16x32_bf16 v[104:107], a[76:79], v[124:127], v[104:107]
    v_mfma_f32_16x16x32_bf16 v[108:111], a[80:83], v[124:127], v[108:111]
    s_waitcnt lgkmcnt(2)
    v_mfma_f32_16x16x32_bf16 v[100:103], a[84:87], v[128:131], v[100:103]
    ds_read_b128 v[112:115], v40 offset:24320
    v_mfma_f32_16x16x32_bf16 v[104:107], a[88:91], v[128:131], v[104:107]
    v_mfma_f32_16x16x32_bf16 v[108:111], a[92:95], v[128:131], v[108:111]
    v_mfma_f32_16x16x32_bf16 v[100:103], a[96:99], v[132:135], v[100:103]
    ds_read_b128 v[116:119], v41 offset:24192
    v_mfma_f32_16x16x32_bf16 v[104:107], a[100:103], v[132:135], v[104:107]
    v_mfma_f32_16x16x32_bf16 v[108:111], a[104:107], v[132:135], v[108:111]
    s_waitcnt lgkmcnt(2)
    v_mfma_f32_16x16x32_bf16 v[100:103], a[108:111], v[136:139], v[100:103]
    ds_read_b128 v[120:123], v41 offset:24256
    v_mfma_f32_16x16x32_bf16 v[104:107], a[112:115], v[136:139], v[104:107]
    v_mfma_f32_16x16x32_bf16 v[108:111], a[116:119], v[136:139], v[108:111]
    s_waitcnt vmcnt(6) lgkmcnt(2)
    s_barrier
    v_mfma_f32_16x16x32_bf16 v[100:103], a[120:123], v[140:143], v[100:103]
    ds_read_b128 v[124:127], v41 offset:24320
    ds_read_b64 v[74:75], v39 offset:0
    v_mfma_f32_16x16x32_bf16 v[104:107], a[124:127], v[140:143], v[104:107]
    v_mfma_f32_16x16x32_bf16 v[108:111], a[128:131], v[140:143], v[108:111]
    v_mfma_f32_16x16x32_bf16 v[100:103], a[132:135], v[112:115], v[100:103]
    ds_read_b128 v[128:131], v42 offset:24192
    v_mfma_f32_16x16x32_bf16 v[104:107], a[136:139], v[112:115], v[104:107]
    v_cvt_pk_bf16_f32 v76, v76, v77
    v_mfma_f32_16x16x32_bf16 v[108:111], a[140:143], v[112:115], v[108:111]
    v_cvt_pk_bf16_f32 v77, v78, v79
    s_waitcnt lgkmcnt(3)
    v_mfma_f32_16x16x32_bf16 v[100:103], a[144:147], v[116:119], v[100:103]
    ds_read_b128 v[132:135], v42 offset:24256
    v_cvt_pk_bf16_f32 v78, v80, v81
    v_mfma_f32_16x16x32_bf16 v[104:107], a[148:151], v[116:119], v[104:107]
    v_cvt_pk_bf16_f32 v79, v82, v83
    v_mfma_f32_16x16x32_bf16 v[108:111], a[152:155], v[116:119], v[108:111]
    v_permlane16_swap_b32 v76, v78
    v_mfma_f32_16x16x32_bf16 v[100:103], a[156:159], v[120:123], v[100:103]
    ds_read_b128 v[136:139], v42 offset:24320
    v_permlane16_swap_b32 v77, v79
    v_mfma_f32_16x16x32_bf16 v[104:107], a[160:163], v[120:123], v[104:107]
    v_mfma_f32_16x16x32_bf16 v[108:111], a[164:167], v[120:123], v[108:111]
    buffer_store_dwordx4 v[76:79], v19, s[20:23], s4 offen sc1
    s_waitcnt lgkmcnt(2)
    v_mfma_f32_16x16x32_bf16 v[100:103], a[168:171], v[124:127], v[100:103]
    ds_read_b128 v[140:143], v40 offset:27648
    v_mfma_f32_16x16x32_bf16 v[104:107], a[172:175], v[124:127], v[104:107]
    v_mfma_f32_16x16x32_bf16 v[108:111], a[176:179], v[124:127], v[108:111]
    v_mfma_f32_16x16x32_bf16 v[100:103], a[180:183], v[128:131], v[100:103]
    ds_read_b128 v[112:115], v40 offset:27712
    buffer_store_dwordx2 v[74:75], v20, s[20:23], s56 offen sc1
    v_mfma_f32_16x16x32_bf16 v[104:107], a[184:187], v[128:131], v[104:107]
    v_mfma_f32_16x16x32_bf16 v[108:111], a[188:191], v[128:131], v[108:111]
    s_waitcnt lgkmcnt(2)
    v_mfma_f32_16x16x32_bf16 v[100:103], a[192:195], v[132:135], v[100:103]
    ds_read_b128 v[116:119], v40 offset:27776
    ds_read_b64 v[86:87], v39 offset:2048
    v_mfma_f32_16x16x32_bf16 v[104:107], a[196:199], v[132:135], v[104:107]
    v_mfma_f32_16x16x32_bf16 v[108:111], a[200:203], v[132:135], v[108:111]
    v_mfma_f32_16x16x32_bf16 v[100:103], a[204:207], v[136:139], v[100:103]
    ds_read_b128 v[120:123], v41 offset:27648
    v_mfma_f32_16x16x32_bf16 v[104:107], a[208:211], v[136:139], v[104:107]
    v_mfma_f32_16x16x32_bf16 v[108:111], a[212:215], v[136:139], v[108:111]
    s_waitcnt lgkmcnt(3)
    v_mfma_f32_16x16x32_bf16 v[100:103], a[216:219], v[140:143], v[100:103]
    ds_read_b128 v[124:127], v41 offset:27712
    v_mfma_f32_16x16x32_bf16 v[104:107], a[220:223], v[140:143], v[104:107]
    v_mfma_f32_16x16x32_bf16 v[108:111], a[224:227], v[140:143], v[108:111]
    v_mfma_f32_16x16x32_bf16 v[100:103], a[228:231], v[112:115], v[100:103]
    ds_read_b128 v[128:131], v41 offset:27776
    v_mfma_f32_16x16x32_bf16 v[104:107], a[232:235], v[112:115], v[104:107]
    v_cvt_pk_bf16_f32 v88, v88, v89
    v_mfma_f32_16x16x32_bf16 v[108:111], a[236:239], v[112:115], v[108:111]
    v_cvt_pk_bf16_f32 v89, v90, v91
    s_waitcnt lgkmcnt(2)
    v_mfma_f32_16x16x32_bf16 v[100:103], a[240:243], v[116:119], v[100:103]
    ds_read_b128 v[132:135], v42 offset:27648
    v_cvt_pk_bf16_f32 v90, v92, v93
    v_mfma_f32_16x16x32_bf16 v[104:107], a[244:247], v[116:119], v[104:107]
    v_cvt_pk_bf16_f32 v91, v94, v95
    buffer_store_dwordx2 v[86:87], v20, s[20:23], s4 offen sc1
    v_mfma_f32_16x16x32_bf16 v[108:111], a[248:251], v[116:119], v[108:111]
    v_permlane16_swap_b32 v88, v90
    v_mfma_f32_16x16x32_bf16 v[100:103], a[252:255], v[120:123], v[100:103]
    ds_read_b128 v[136:139], v42 offset:27712
    v_permlane16_swap_b32 v89, v91
    v_mfma_f32_16x16x32_bf16 v[104:107], v[188:191], v[120:123], v[104:107]
    v_mfma_f32_16x16x32_bf16 v[108:111], v[192:195], v[120:123], v[108:111]
    buffer_store_dwordx4 v[88:91], v19, s[20:23], s5 offen sc1
    s_waitcnt lgkmcnt(2)
    v_mfma_f32_16x16x32_bf16 v[100:103], v[196:199], v[124:127], v[100:103]
    ds_read_b128 v[140:143], v42 offset:27776
    ds_read_b64 v[98:99], v39 offset:4096
    v_mfma_f32_16x16x32_bf16 v[104:107], v[200:203], v[124:127], v[104:107]
    v_mfma_f32_16x16x32_bf16 v[108:111], v[204:207], v[124:127], v[108:111]
    v_mfma_f32_16x16x32_bf16 v[100:103], v[208:211], v[128:131], v[100:103]
    ds_read_b128 v[112:115], v40 offset:27648
    v_mfma_f32_16x16x32_bf16 v[104:107], v[212:215], v[128:131], v[104:107]
    v_mfma_f32_16x16x32_bf16 v[108:111], v[216:219], v[128:131], v[108:111]
    s_waitcnt lgkmcnt(3)
    v_mfma_f32_16x16x32_bf16 v[100:103], v[220:223], v[132:135], v[100:103]
    ds_read_b128 v[116:119], v40 offset:27712
    v_mfma_f32_16x16x32_bf16 v[104:107], v[224:227], v[132:135], v[104:107]
    v_mfma_f32_16x16x32_bf16 v[108:111], v[228:231], v[132:135], v[108:111]
    v_mfma_f32_16x16x32_bf16 v[100:103], v[232:235], v[136:139], v[100:103]
    ds_read_b128 v[120:123], v40 offset:27776
    v_mfma_f32_16x16x32_bf16 v[104:107], v[236:239], v[136:139], v[104:107]
    v_mfma_f32_16x16x32_bf16 v[108:111], v[240:243], v[136:139], v[108:111]
    s_waitcnt lgkmcnt(2)
    v_mfma_f32_16x16x32_bf16 v[100:103], v[244:247], v[140:143], v[100:103]
    ds_read_b128 v[124:127], v41 offset:27648
    buffer_store_dwordx2 v[98:99], v20, s[20:23], s5 offen sc1
    v_mfma_f32_16x16x32_bf16 v[104:107], v[248:251], v[140:143], v[104:107]
    v_mfma_f32_16x16x32_bf16 v[108:111], v[252:255], v[140:143], v[108:111]
    v_mfma_f32_16x16x32_bf16 v[64:67], a[0:3], v[112:115], 0
    ds_read_b128 v[128:131], v41 offset:27712
    v_mfma_f32_16x16x32_bf16 v[68:71], a[4:7], v[112:115], 0
    v_mfma_f32_16x16x32_bf16 v[72:75], a[8:11], v[112:115], 0
    s_waitcnt lgkmcnt(2)
    v_mfma_f32_16x16x32_bf16 v[64:67], a[12:15], v[116:119], v[64:67]
    ds_read_b128 v[132:135], v41 offset:27776
    v_mfma_f32_16x16x32_bf16 v[68:71], a[16:19], v[116:119], v[68:71]
    v_cvt_pk_bf16_f32 v108, v108, v109
    v_cvt_pk_bf16_f32 v109, v110, v111
    v_mfma_f32_16x16x32_bf16 v[72:75], a[20:23], v[116:119], v[72:75]
    ds_write_b64 v38, v[108:109] offset:6144
    v_mfma_f32_16x16x32_bf16 v[64:67], a[24:27], v[120:123], v[64:67]
    ds_read_b128 v[136:139], v42 offset:27648
    v_mfma_f32_16x16x32_bf16 v[68:71], a[28:31], v[120:123], v[68:71]
    v_cvt_pk_bf16_f32 v100, v100, v101
    v_mfma_f32_16x16x32_bf16 v[72:75], a[32:35], v[120:123], v[72:75]
    v_cvt_pk_bf16_f32 v101, v102, v103
    s_waitcnt lgkmcnt(3)
    v_mfma_f32_16x16x32_bf16 v[64:67], a[36:39], v[124:127], v[64:67]
    ds_read_b128 v[140:143], v42 offset:27712
    v_cvt_pk_bf16_f32 v102, v104, v105
    v_mfma_f32_16x16x32_bf16 v[68:71], a[40:43], v[124:127], v[68:71]
    v_cvt_pk_bf16_f32 v103, v106, v107
    v_mfma_f32_16x16x32_bf16 v[72:75], a[44:47], v[124:127], v[72:75]
    v_permlane16_swap_b32 v100, v102
    v_mfma_f32_16x16x32_bf16 v[64:67], a[48:51], v[128:131], v[64:67]
    ds_read_b128 v[112:115], v42 offset:27776
    v_permlane16_swap_b32 v101, v103
    v_mfma_f32_16x16x32_bf16 v[68:71], a[52:55], v[128:131], v[68:71]
    v_mfma_f32_16x16x32_bf16 v[72:75], a[56:59], v[128:131], v[72:75]
    buffer_store_dwordx4 v[100:103], v21, s[20:23], s74 offen sc1
    s_waitcnt lgkmcnt(2)
    v_mfma_f32_16x16x32_bf16 v[64:67], a[60:63], v[132:135], v[64:67]
    ds_read_b128 v[116:119], v40 offset:31104
    v_mfma_f32_16x16x32_bf16 v[68:71], a[64:67], v[132:135], v[68:71]
    v_mfma_f32_16x16x32_bf16 v[72:75], a[68:71], v[132:135], v[72:75]
    v_mfma_f32_16x16x32_bf16 v[64:67], a[72:75], v[136:139], v[64:67]
    ds_read_b128 v[120:123], v40 offset:31168
    v_mfma_f32_16x16x32_bf16 v[68:71], a[76:79], v[136:139], v[68:71]
    v_mfma_f32_16x16x32_bf16 v[72:75], a[80:83], v[136:139], v[72:75]
    s_waitcnt lgkmcnt(2)
    v_mfma_f32_16x16x32_bf16 v[64:67], a[84:87], v[140:143], v[64:67]
    ds_read_b128 v[124:127], v40 offset:31232
    v_mfma_f32_16x16x32_bf16 v[68:71], a[88:91], v[140:143], v[68:71]
    v_mfma_f32_16x16x32_bf16 v[72:75], a[92:95], v[140:143], v[72:75]
    s_waitcnt vmcnt(10) lgkmcnt(2)
    s_barrier
    v_mfma_f32_16x16x32_bf16 v[64:67], a[96:99], v[112:115], v[64:67]
    ds_read_b128 v[128:131], v41 offset:31104
    ds_read_b64 v[110:111], v39 offset:6144
    v_mfma_f32_16x16x32_bf16 v[68:71], a[100:103], v[112:115], v[68:71]
    v_mfma_f32_16x16x32_bf16 v[72:75], a[104:107], v[112:115], v[72:75]
    v_mfma_f32_16x16x32_bf16 v[64:67], a[108:111], v[116:119], v[64:67]
    ds_read_b128 v[132:135], v41 offset:31168
    v_mfma_f32_16x16x32_bf16 v[68:71], a[112:115], v[116:119], v[68:71]
    v_mfma_f32_16x16x32_bf16 v[72:75], a[116:119], v[116:119], v[72:75]
    s_waitcnt lgkmcnt(3)
    v_mfma_f32_16x16x32_bf16 v[64:67], a[120:123], v[120:123], v[64:67]
    ds_read_b128 v[136:139], v41 offset:31232
    v_mfma_f32_16x16x32_bf16 v[68:71], a[124:127], v[120:123], v[68:71]
    v_mfma_f32_16x16x32_bf16 v[72:75], a[128:131], v[120:123], v[72:75]
    v_mfma_f32_16x16x32_bf16 v[64:67], a[132:135], v[124:127], v[64:67]
    ds_read_b128 v[140:143], v42 offset:31104
    v_mfma_f32_16x16x32_bf16 v[68:71], a[136:139], v[124:127], v[68:71]
    v_mfma_f32_16x16x32_bf16 v[72:75], a[140:143], v[124:127], v[72:75]
    s_waitcnt lgkmcnt(2)
    v_mfma_f32_16x16x32_bf16 v[64:67], a[144:147], v[128:131], v[64:67]
    ds_read_b128 v[112:115], v42 offset:31168
    buffer_store_dwordx2 v[110:111], v22, s[20:23], s74 offen sc1
    v_mfma_f32_16x16x32_bf16 v[68:71], a[148:151], v[128:131], v[68:71]
    v_mfma_f32_16x16x32_bf16 v[72:75], a[152:155], v[128:131], v[72:75]
    v_mfma_f32_16x16x32_bf16 v[64:67], a[156:159], v[132:135], v[64:67]
    ds_read_b128 v[116:119], v42 offset:31232
    v_mfma_f32_16x16x32_bf16 v[68:71], a[160:163], v[132:135], v[68:71]
    v_mfma_f32_16x16x32_bf16 v[72:75], a[164:167], v[132:135], v[72:75]
    s_waitcnt lgkmcnt(2)
    v_mfma_f32_16x16x32_bf16 v[64:67], a[168:171], v[136:139], v[64:67]
    ds_read_b128 v[120:123], v40 offset:34560
    v_mfma_f32_16x16x32_bf16 v[68:71], a[172:175], v[136:139], v[68:71]
    v_mfma_f32_16x16x32_bf16 v[72:75], a[176:179], v[136:139], v[72:75]
    v_mfma_f32_16x16x32_bf16 v[64:67], a[180:183], v[140:143], v[64:67]
    ds_read_b128 v[124:127], v40 offset:34624
    v_mfma_f32_16x16x32_bf16 v[68:71], a[184:187], v[140:143], v[68:71]
    v_mfma_f32_16x16x32_bf16 v[72:75], a[188:191], v[140:143], v[72:75]
    s_waitcnt lgkmcnt(2)
    v_mfma_f32_16x16x32_bf16 v[64:67], a[192:195], v[112:115], v[64:67]
    ds_read_b128 v[128:131], v40 offset:34688
    v_mfma_f32_16x16x32_bf16 v[68:71], a[196:199], v[112:115], v[68:71]
    v_mfma_f32_16x16x32_bf16 v[72:75], a[200:203], v[112:115], v[72:75]
    v_mfma_f32_16x16x32_bf16 v[64:67], a[204:207], v[116:119], v[64:67]
    ds_read_b128 v[132:135], v41 offset:34560
    v_mfma_f32_16x16x32_bf16 v[68:71], a[208:211], v[116:119], v[68:71]
    v_mfma_f32_16x16x32_bf16 v[72:75], a[212:215], v[116:119], v[72:75]
    s_waitcnt lgkmcnt(2)
    v_mfma_f32_16x16x32_bf16 v[64:67], a[216:219], v[120:123], v[64:67]
    ds_read_b128 v[136:139], v41 offset:34624
    v_mfma_f32_16x16x32_bf16 v[68:71], a[220:223], v[120:123], v[68:71]
    v_mfma_f32_16x16x32_bf16 v[72:75], a[224:227], v[120:123], v[72:75]
    v_mfma_f32_16x16x32_bf16 v[64:67], a[228:231], v[124:127], v[64:67]
    ds_read_b128 v[140:143], v41 offset:34688
    v_mfma_f32_16x16x32_bf16 v[68:71], a[232:235], v[124:127], v[68:71]
    v_mfma_f32_16x16x32_bf16 v[72:75], a[236:239], v[124:127], v[72:75]
    s_waitcnt lgkmcnt(2)
    v_mfma_f32_16x16x32_bf16 v[64:67], a[240:243], v[128:131], v[64:67]
    ds_read_b128 v[112:115], v42 offset:34560
    v_mfma_f32_16x16x32_bf16 v[68:71], a[244:247], v[128:131], v[68:71]
    v_mfma_f32_16x16x32_bf16 v[72:75], a[248:251], v[128:131], v[72:75]
    v_mfma_f32_16x16x32_bf16 v[64:67], a[252:255], v[132:135], v[64:67]
    ds_read_b128 v[116:119], v42 offset:34624
    v_mfma_f32_16x16x32_bf16 v[68:71], v[188:191], v[132:135], v[68:71]
    v_mfma_f32_16x16x32_bf16 v[72:75], v[192:195], v[132:135], v[72:75]
    s_waitcnt lgkmcnt(2)
    v_mfma_f32_16x16x32_bf16 v[64:67], v[196:199], v[136:139], v[64:67]
    ds_read_b128 v[120:123], v42 offset:34688
    v_mfma_f32_16x16x32_bf16 v[68:71], v[200:203], v[136:139], v[68:71]
    v_mfma_f32_16x16x32_bf16 v[72:75], v[204:207], v[136:139], v[72:75]
    v_mfma_f32_16x16x32_bf16 v[64:67], v[208:211], v[140:143], v[64:67]
    ds_read_b128 v[124:127], v40 offset:34560
    v_mfma_f32_16x16x32_bf16 v[68:71], v[212:215], v[140:143], v[68:71]
    v_mfma_f32_16x16x32_bf16 v[72:75], v[216:219], v[140:143], v[72:75]
    s_waitcnt lgkmcnt(2)
    v_mfma_f32_16x16x32_bf16 v[64:67], v[220:223], v[112:115], v[64:67]
    ds_read_b128 v[128:131], v40 offset:34624
    v_mfma_f32_16x16x32_bf16 v[68:71], v[224:227], v[112:115], v[68:71]
    v_mfma_f32_16x16x32_bf16 v[72:75], v[228:231], v[112:115], v[72:75]
    v_mfma_f32_16x16x32_bf16 v[64:67], v[232:235], v[116:119], v[64:67]
    ds_read_b128 v[132:135], v40 offset:34688
    v_mfma_f32_16x16x32_bf16 v[68:71], v[236:239], v[116:119], v[68:71]
    v_mfma_f32_16x16x32_bf16 v[72:75], v[240:243], v[116:119], v[72:75]
    s_waitcnt lgkmcnt(2)
    v_mfma_f32_16x16x32_bf16 v[64:67], v[244:247], v[120:123], v[64:67]
    ds_read_b128 v[136:139], v41 offset:34560
    v_mfma_f32_16x16x32_bf16 v[68:71], v[248:251], v[120:123], v[68:71]
    v_mfma_f32_16x16x32_bf16 v[72:75], v[252:255], v[120:123], v[72:75]
    v_mfma_f32_16x16x32_bf16 v[76:79], a[0:3], v[124:127], 0
    ds_read_b128 v[140:143], v41 offset:34624
    v_and_b32 v180, s96, v180
    v_mfma_f32_16x16x32_bf16 v[80:83], a[4:7], v[124:127], 0
    v_and_b32 v181, s96, v181
    v_and_b32 v182, s96, v182
    v_mfma_f32_16x16x32_bf16 v[84:87], a[8:11], v[124:127], 0
    v_and_b32 v183, s96, v183
    s_waitcnt lgkmcnt(2)
    v_mfma_f32_16x16x32_bf16 v[76:79], a[12:15], v[128:131], v[76:79]
    ds_read_b128 v[112:115], v41 offset:34688
    v_pk_max_u16 v180, v180, v181
    v_mfma_f32_16x16x32_bf16 v[80:83], a[16:19], v[128:131], v[80:83]
    v_pk_max_u16 v182, v182, v183
    v_pk_max_u16 v180, v180, s37
    v_mfma_f32_16x16x32_bf16 v[84:87], a[20:23], v[128:131], v[84:87]
    v_pk_max_u16 v180, v180, v182
    v_cvt_pk_bf16_f32 v72, v72, v73
    v_mfma_f32_16x16x32_bf16 v[76:79], a[24:27], v[132:135], v[76:79]
    ds_read_b128 v[116:119], v42 offset:34560
    v_cmp_ne_u32 s[80:81], s37, v180
    v_mfma_f32_16x16x32_bf16 v[80:83], a[28:31], v[132:135], v[80:83]
    v_cvt_pk_bf16_f32 v73, v74, v75
    v_and_b32 v184, s96, v184
    v_mfma_f32_16x16x32_bf16 v[84:87], a[32:35], v[132:135], v[84:87]
    v_and_b32 v185, s96, v185
    s_waitcnt lgkmcnt(2)
    v_mfma_f32_16x16x32_bf16 v[76:79], a[36:39], v[136:139], v[76:79]
    ds_read_b128 v[120:123], v42 offset:34624
    v_and_b32 v186, s96, v186
    v_mfma_f32_16x16x32_bf16 v[80:83], a[40:43], v[136:139], v[80:83]
    v_and_b32 v187, s96, v187
    ds_write_b64 v38, v[72:73] offset:8192
    v_mfma_f32_16x16x32_bf16 v[84:87], a[44:47], v[136:139], v[84:87]
    v_pk_max_u16 v184, v184, v185
    v_pk_max_u16 v186, v186, v187
    v_mfma_f32_16x16x32_bf16 v[76:79], a[48:51], v[140:143], v[76:79]
    ds_read_b128 v[124:127], v42 offset:34688
    v_pk_max_u16 v184, v184, s37
    v_mfma_f32_16x16x32_bf16 v[80:83], a[52:55], v[140:143], v[80:83]
    v_pk_max_u16 v184, v184, v186
    v_cmp_ne_u32 s[82:83], s37, v184
    v_mfma_f32_16x16x32_bf16 v[84:87], a[56:59], v[140:143], v[84:87]
    v_cvt_pk_bf16_f32 v64, v64, v65
    s_waitcnt lgkmcnt(3)
    v_mfma_f32_16x16x32_bf16 v[76:79], a[60:63], v[112:115], v[76:79]
    ds_read_b128 v[128:131], v40 offset:38016
    v_cvt_pk_bf16_f32 v65, v66, v67
    v_mfma_f32_16x16x32_bf16 v[80:83], a[64:67], v[112:115], v[80:83]
    s_or_b64 vcc, s[80:81], s[82:83]
    s_cbranch_scc1 L_afailX
L_afailX_back:
    v_mfma_f32_16x16x32_bf16 v[84:87], a[68:71], v[112:115], v[84:87]
    v_cvt_pk_bf16_f32 v66, v68, v69
    v_cvt_pk_bf16_f32 v67, v70, v71
    v_mfma_f32_16x16x32_bf16 v[76:79], a[72:75], v[116:119], v[76:79]
    ds_read_b128 v[132:135], v40 offset:38080
    v_permlane16_swap_b32 v64, v66
    v_mfma_f32_16x16x32_bf16 v[80:83], a[76:79], v[116:119], v[80:83]
    v_permlane16_swap_b32 v65, v67
    buffer_store_dwordx4 v[64:67], v21, s[20:23], s75 offen sc1
    v_mfma_f32_16x16x32_bf16 v[84:87], a[80:83], v[116:119], v[84:87]
    s_waitcnt lgkmcnt(2)
    v_mfma_f32_16x16x32_bf16 v[76:79], a[84:87], v[120:123], v[76:79]
    ds_read_b128 v[136:139], v40 offset:38144
    v_mfma_f32_16x16x32_bf16 v[80:83], a[88:91], v[120:123], v[80:83]
    v_mfma_f32_16x16x32_bf16 v[84:87], a[92:95], v[120:123], v[84:87]
    s_waitcnt vmcnt(10) lgkmcnt(2)
    s_barrier
    v_mfma_f32_16x16x32_bf16 v[76:79], a[96:99], v[124:127], v[76:79]
    ds_read_b128 v[140:143], v41 offset:38016
    ds_read_b32 v35, v34
    v_mfma_f32_16x16x32_bf16 v[80:83], a[100:103], v[124:127], v[80:83]
    ds_read_b64 v[74:75], v39 offset:8192
    v_mfma_f32_16x16x32_bf16 v[84:87], a[104:107], v[124:127], v[84:87]
    v_mfma_f32_16x16x32_bf16 v[76:79], a[108:111], v[128:131], v[76:79]
    ds_read_b128 v[112:115], v41 offset:38080
    v_mfma_f32_16x16x32_bf16 v[80:83], a[112:115], v[128:131], v[80:83]
    v_mfma_f32_16x16x32_bf16 v[84:87], a[116:119], v[128:131], v[84:87]
    s_waitcnt lgkmcnt(4)
    v_mfma_f32_16x16x32_bf16 v[76:79], a[120:123], v[132:135], v[76:79]
    ds_read_b128 v[116:119], v41 offset:38144
    v_mfma_f32_16x16x32_bf16 v[80:83], a[124:127], v[132:135], v[80:83]
    v_mfma_f32_16x16x32_bf16 v[84:87], a[128:131], v[132:135], v[84:87]
    v_mfma_f32_16x16x32_bf16 v[76:79], a[132:135], v[136:139], v[76:79]
    ds_read_b128 v[120:123], v42 offset:38016
    v_mfma_f32_16x16x32_bf16 v[80:83], a[136:139], v[136:139], v[80:83]
    v_mfma_f32_16x16x32_bf16 v[84:87], a[140:143], v[136:139], v[84:87]
    s_waitcnt lgkmcnt(2)
    v_mfma_f32_16x16x32_bf16 v[76:79], a[144:147], v[140:143], v[76:79]
    ds_read_b128 v[124:127], v42 offset:38080
    v_readfirstlane_b32 s63, v35
    v_mfma_f32_16x16x32_bf16 v[80:83], a[148:151], v[140:143], v[80:83]
    buffer_store_dwordx2 v[74:75], v22, s[20:23], s75 offen sc1
    v_mfma_f32_16x16x32_bf16 v[84:87], a[152:155], v[140:143], v[84:87]
    v_mfma_f32_16x16x32_bf16 v[76:79], a[156:159], v[112:115], v[76:79]
    ds_read_b128 v[128:131], v42 offset:38144
    v_mfma_f32_16x16x32_bf16 v[80:83], a[160:163], v[112:115], v[80:83]
    v_mfma_f32_16x16x32_bf16 v[84:87], a[164:167], v[112:115], v[84:87]
    s_waitcnt lgkmcnt(2)
    v_mfma_f32_16x16x32_bf16 v[76:79], a[168:171], v[116:119], v[76:79]
    ds_read_b128 v[132:135], v40 offset:41472
    v_mfma_f32_16x16x32_bf16 v[80:83], a[172:175], v[116:119], v[80:83]
    v_mfma_f32_16x16x32_bf16 v[84:87], a[176:179], v[116:119], v[84:87]
    v_mfma_f32_16x16x32_bf16 v[76:79], a[180:183], v[120:123], v[76:79]
    ds_read_b128 v[136:139], v40 offset:41536
    v_mfma_f32_16x16x32_bf16 v[80:83], a[184:187], v[120:123], v[80:83]
    v_mfma_f32_16x16x32_bf16 v[84:87], a[188:191], v[120:123], v[84:87]
    s_waitcnt lgkmcnt(2)
    v_mfma_f32_16x16x32_bf16 v[76:79], a[192:195], v[124:127], v[76:79]
    ds_read_b128 v[140:143], v40 offset:41600
    v_mfma_f32_16x16x32_bf16 v[80:83], a[196:199], v[124:127], v[80:83]
    v_mfma_f32_16x16x32_bf16 v[84:87], a[200:203], v[124:127], v[84:87]
    v_mfma_f32_16x16x32_bf16 v[76:79], a[204:207], v[128:131], v[76:79]
    ds_read_b128 v[112:115], v41 offset:41472
    v_mfma_f32_16x16x32_bf16 v[80:83], a[208:211], v[128:131], v[80:83]
    v_mfma_f32_16x16x32_bf16 v[84:87], a[212:215], v[128:131], v[84:87]
    s_waitcnt lgkmcnt(2)
    v_mfma_f32_16x16x32_bf16 v[76:79], a[216:219], v[132:135], v[76:79]
    ds_read_b128 v[116:119], v41 offset:41536
    v_mfma_f32_16x16x32_bf16 v[80:83], a[220:223], v[132:135], v[80:83]
    v_mfma_f32_16x16x32_bf16 v[84:87], a[224:227], v[132:135], v[84:87]
    v_mfma_f32_16x16x32_bf16 v[76:79], a[228:231], v[136:139], v[76:79]
    ds_read_b128 v[120:123], v41 offset:41600
    v_mfma_f32_16x16x32_bf16 v[80:83], a[232:235], v[136:139], v[80:83]
    v_mfma_f32_16x16x32_bf16 v[84:87], a[236:239], v[136:139], v[84:87]
    s_waitcnt lgkmcnt(2)
    v_mfma_f32_16x16x32_bf16 v[76:79], a[240:243], v[140:143], v[76:79]
    ds_read_b128 v[124:127], v42 offset:41472
    v_mfma_f32_16x16x32_bf16 v[80:83], a[244:247], v[140:143], v[80:83]
    v_mfma_f32_16x16x32_bf16 v[84:87], a[248:251], v[140:143], v[84:87]
    v_mfma_f32_16x16x32_bf16 v[76:79], a[252:255], v[112:115], v[76:79]
    ds_read_b128 v[128:131], v42 offset:41536
    v_mfma_f32_16x16x32_bf16 v[80:83], v[188:191], v[112:115], v[80:83]
    v_mfma_f32_16x16x32_bf16 v[84:87], v[192:195], v[112:115], v[84:87]
    s_waitcnt lgkmcnt(2)
    v_mfma_f32_16x16x32_bf16 v[76:79], v[196:199], v[116:119], v[76:79]
    ds_read_b128 v[132:135], v42 offset:41600
    v_mfma_f32_16x16x32_bf16 v[80:83], v[200:203], v[116:119], v[80:83]
    v_mfma_f32_16x16x32_bf16 v[84:87], v[204:207], v[116:119], v[84:87]
    v_mfma_f32_16x16x32_bf16 v[76:79], v[208:211], v[120:123], v[76:79]
    ds_read_b128 v[136:139], v40 offset:41472
    v_mfma_f32_16x16x32_bf16 v[80:83], v[212:215], v[120:123], v[80:83]
    v_mfma_f32_16x16x32_bf16 v[84:87], v[216:219], v[120:123], v[84:87]
    s_waitcnt lgkmcnt(2)
    v_mfma_f32_16x16x32_bf16 v[76:79], v[220:223], v[124:127], v[76:79]
    ds_read_b128 v[140:143], v40 offset:41536
    v_mfma_f32_16x16x32_bf16 v[80:83], v[224:227], v[124:127], v[80:83]
    v_mfma_f32_16x16x32_bf16 v[84:87], v[228:231], v[124:127], v[84:87]
    v_mfma_f32_16x16x32_bf16 v[76:79], v[232:235], v[128:131], v[76:79]
    ds_read_b128 v[112:115], v40 offset:41600
    v_mfma_f32_16x16x32_bf16 v[80:83], v[236:239], v[128:131], v[80:83]
    v_mfma_f32_16x16x32_bf16 v[84:87], v[240:243], v[128:131], v[84:87]
    s_waitcnt lgkmcnt(2)
    v_mfma_f32_16x16x32_bf16 v[76:79], v[244:247], v[132:135], v[76:79]
    ds_read_b128 v[116:119], v41 offset:41472
    v_mfma_f32_16x16x32_bf16 v[80:83], v[248:251], v[132:135], v[80:83]
    v_mfma_f32_16x16x32_bf16 v[84:87], v[252:255], v[132:135], v[84:87]
    v_mfma_f32_16x16x32_bf16 v[88:91], a[0:3], v[136:139], 0
    ds_read_b128 v[120:123], v41 offset:41536
    v_mfma_f32_16x16x32_bf16 v[92:95], a[4:7], v[136:139], 0
    v_mfma_f32_16x16x32_bf16 v[96:99], a[8:11], v[136:139], 0
    s_waitcnt lgkmcnt(2)
    v_mfma_f32_16x16x32_bf16 v[88:91], a[12:15], v[140:143], v[88:91]
    ds_read_b128 v[124:127], v41 offset:41600
    v_mfma_f32_16x16x32_bf16 v[92:95], a[16:19], v[140:143], v[92:95]
    v_cvt_pk_bf16_f32 v84, v84, v85
    v_cvt_pk_bf16_f32 v85, v86, v87
    v_mfma_f32_16x16x32_bf16 v[96:99], a[20:23], v[140:143], v[96:99]
    ds_write_b64 v38, v[84:85] offset:10240
    v_mfma_f32_16x16x32_bf16 v[88:91], a[24:27], v[112:115], v[88:91]
    ds_read_b128 v[128:131], v42 offset:41472
    v_mfma_f32_16x16x32_bf16 v[92:95], a[28:31], v[112:115], v[92:95]
    v_cvt_pk_bf16_f32 v76, v76, v77
    v_mfma_f32_16x16x32_bf16 v[96:99], a[32:35], v[112:115], v[96:99]
    v_cvt_pk_bf16_f32 v77, v78, v79
    s_waitcnt lgkmcnt(3)
    v_mfma_f32_16x16x32_bf16 v[88:91], a[36:39], v[116:119], v[88:91]
    ds_read_b128 v[132:135], v42 offset:41536
    v_cvt_pk_bf16_f32 v78, v80, v81
    v_mfma_f32_16x16x32_bf16 v[92:95], a[40:43], v[116:119], v[92:95]
    v_cvt_pk_bf16_f32 v79, v82, v83
    v_mfma_f32_16x16x32_bf16 v[96:99], a[44:47], v[116:119], v[96:99]
    v_permlane16_swap_b32 v76, v78
    v_mfma_f32_16x16x32_bf16 v[88:91], a[48:51], v[120:123], v[88:91]
    ds_read_b128 v[136:139], v42 offset:41600
    v_permlane16_swap_b32 v77, v79
    v_mfma_f32_16x16x32_bf16 v[92:95], a[52:55], v[120:123], v[92:95]
    v_mfma_f32_16x16x32_bf16 v[96:99], a[56:59], v[120:123], v[96:99]
    buffer_store_dwordx4 v[76:79], v21, s[20:23], s76 offen sc1
    s_waitcnt lgkmcnt(2)
    v_mfma_f32_16x16x32_bf16 v[88:91], a[60:63], v[124:127], v[88:91]
    ds_read_b128 v[140:143], v40 offset:44928
    v_mfma_f32_16x16x32_bf16 v[92:95], a[64:67], v[124:127], v[92:95]
    v_mfma_f32_16x16x32_bf16 v[96:99], a[68:71], v[124:127], v[96:99]
    v_mfma_f32_16x16x32_bf16 v[88:91], a[72:75], v[128:131], v[88:91]
    ds_read_b128 v[112:115], v40 offset:44992
    v_mfma_f32_16x16x32_bf16 v[92:95], a[76:79], v[128:131], v[92:95]
    v_mfma_f32_16x16x32_bf16 v[96:99], a[80:83], v[128:131], v[96:99]
    s_waitcnt lgkmcnt(2)
    v_mfma_f32_16x16x32_bf16 v[88:91], a[84:87], v[132:135], v[88:91]
    ds_read_b128 v[116:119], v40 offset:45056
    v_mfma_f32_16x16x32_bf16 v[92:95], a[88:91], v[132:135], v[92:95]
    v_mfma_f32_16x16x32_bf16 v[96:99], a[92:95], v[132:135], v[96:99]
    s_waitcnt vmcnt(11) lgkmcnt(2)
    s_barrier
    v_mfma_f32_16x16x32_bf16 v[88:91], a[96:99], v[136:139], v[88:91]
    ds_read_b128 v[120:123], v41 offset:44928
    ds_read_b64 v[86:87], v39 offset:10240
    v_mfma_f32_16x16x32_bf16 v[92:95], a[100:103], v[136:139], v[92:95]
    v_mfma_f32_16x16x32_bf16 v[96:99], a[104:107], v[136:139], v[96:99]
    v_mfma_f32_16x16x32_bf16 v[88:91], a[108:111], v[140:143], v[88:91]
    ds_read_b128 v[124:127], v41 offset:44992
    v_mfma_f32_16x16x32_bf16 v[92:95], a[112:115], v[140:143], v[92:95]
    v_mfma_f32_16x16x32_bf16 v[96:99], a[116:119], v[140:143], v[96:99]
    s_waitcnt lgkmcnt(3)
    v_mfma_f32_16x16x32_bf16 v[88:91], a[120:123], v[112:115], v[88:91]
    ds_read_b128 v[128:131], v41 offset:45056
    v_mfma_f32_16x16x32_bf16 v[92:95], a[124:127], v[112:115], v[92:95]
    v_mfma_f32_16x16x32_bf16 v[96:99], a[128:131], v[112:115], v[96:99]
    v_mfma_f32_16x16x32_bf16 v[88:91], a[132:135], v[116:119], v[88:91]
    ds_read_b128 v[132:135], v42 offset:44928
    v_mfma_f32_16x16x32_bf16 v[92:95], a[136:139], v[116:119], v[92:95]
    v_mfma_f32_16x16x32_bf16 v[96:99], a[140:143], v[116:119], v[96:99]
    s_waitcnt lgkmcnt(2)
    v_mfma_f32_16x16x32_bf16 v[88:91], a[144:147], v[120:123], v[88:91]
    ds_read_b128 v[136:139], v42 offset:44992
    buffer_store_dwordx2 v[86:87], v22, s[20:23], s76 offen sc1
    v_mfma_f32_16x16x32_bf16 v[92:95], a[148:151], v[120:123], v[92:95]
    v_mfma_f32_16x16x32_bf16 v[96:99], a[152:155], v[120:123], v[96:99]
    v_mfma_f32_16x16x32_bf16 v[88:91], a[156:159], v[124:127], v[88:91]
    ds_read_b128 v[140:143], v42 offset:45056
    v_mfma_f32_16x16x32_bf16 v[92:95], a[160:163], v[124:127], v[92:95]
    v_mfma_f32_16x16x32_bf16 v[96:99], a[164:167], v[124:127], v[96:99]
    s_waitcnt lgkmcnt(2)
    v_mfma_f32_16x16x32_bf16 v[88:91], a[168:171], v[128:131], v[88:91]
    ds_read_b128 v[112:115], v40 offset:48384
    v_mfma_f32_16x16x32_bf16 v[92:95], a[172:175], v[128:131], v[92:95]
    v_mfma_f32_16x16x32_bf16 v[96:99], a[176:179], v[128:131], v[96:99]
    v_mfma_f32_16x16x32_bf16 v[88:91], a[180:183], v[132:135], v[88:91]
    ds_read_b128 v[116:119], v40 offset:48448
    v_mfma_f32_16x16x32_bf16 v[92:95], a[184:187], v[132:135], v[92:95]
    v_mfma_f32_16x16x32_bf16 v[96:99], a[188:191], v[132:135], v[96:99]
    s_waitcnt lgkmcnt(2)
    v_mfma_f32_16x16x32_bf16 v[88:91], a[192:195], v[136:139], v[88:91]
    ds_read_b128 v[120:123], v40 offset:48512
    v_mfma_f32_16x16x32_bf16 v[92:95], a[196:199], v[136:139], v[92:95]
    v_mfma_f32_16x16x32_bf16 v[96:99], a[200:203], v[136:139], v[96:99]
    v_mfma_f32_16x16x32_bf16 v[88:91], a[204:207], v[140:143], v[88:91]
    ds_read_b128 v[124:127], v41 offset:48384
    v_mfma_f32_16x16x32_bf16 v[92:95], a[208:211], v[140:143], v[92:95]
    v_mfma_f32_16x16x32_bf16 v[96:99], a[212:215], v[140:143], v[96:99]
    s_waitcnt lgkmcnt(2)
    v_mfma_f32_16x16x32_bf16 v[88:91], a[216:219], v[112:115], v[88:91]
    ds_read_b128 v[128:131], v41 offset:48448
    v_mfma_f32_16x16x32_bf16 v[92:95], a[220:223], v[112:115], v[92:95]
    v_mfma_f32_16x16x32_bf16 v[96:99], a[224:227], v[112:115], v[96:99]
    v_mfma_f32_16x16x32_bf16 v[88:91], a[228:231], v[116:119], v[88:91]
    ds_read_b128 v[132:135], v41 offset:48512
    v_mfma_f32_16x16x32_bf16 v[92:95], a[232:235], v[116:119], v[92:95]
    v_mfma_f32_16x16x32_bf16 v[96:99], a[236:239], v[116:119], v[96:99]
    s_waitcnt lgkmcnt(2)
    v_mfma_f32_16x16x32_bf16 v[88:91], a[240:243], v[120:123], v[88:91]
    ds_read_b128 v[136:139], v42 offset:48384
    v_mfma_f32_16x16x32_bf16 v[92:95], a[244:247], v[120:123], v[92:95]
    v_mfma_f32_16x16x32_bf16 v[96:99], a[248:251], v[120:123], v[96:99]
    v_mfma_f32_16x16x32_bf16 v[88:91], a[252:255], v[124:127], v[88:91]
    ds_read_b128 v[140:143], v42 offset:48448
    v_mfma_f32_16x16x32_bf16 v[92:95], v[188:191], v[124:127], v[92:95]
    v_mfma_f32_16x16x32_bf16 v[96:99], v[192:195], v[124:127], v[96:99]
    s_waitcnt lgkmcnt(2)
    v_mfma_f32_16x16x32_bf16 v[88:91], v[196:199], v[128:131], v[88:91]
    ds_read_b128 v[112:115], v42 offset:48512
    v_mfma_f32_16x16x32_bf16 v[92:95], v[200:203], v[128:131], v[92:95]
    v_mfma_f32_16x16x32_bf16 v[96:99], v[204:207], v[128:131], v[96:99]
    v_mfma_f32_16x16x32_bf16 v[88:91], v[208:211], v[132:135], v[88:91]
    v_mfma_f32_16x16x32_bf16 v[92:95], v[212:215], v[132:135], v[92:95]
    v_mfma_f32_16x16x32_bf16 v[96:99], v[216:219], v[132:135], v[96:99]
    s_waitcnt lgkmcnt(1)
    v_mfma_f32_16x16x32_bf16 v[88:91], v[220:223], v[136:139], v[88:91]
    v_mfma_f32_16x16x32_bf16 v[92:95], v[224:227], v[136:139], v[92:95]
    v_mfma_f32_16x16x32_bf16 v[96:99], v[228:231], v[136:139], v[96:99]
    v_mfma_f32_16x16x32_bf16 v[88:91], v[232:235], v[140:143], v[88:91]
    v_mfma_f32_16x16x32_bf16 v[92:95], v[236:239], v[140:143], v[92:95]
    v_mfma_f32_16x16x32_bf16 v[96:99], v[240:243], v[140:143], v[96:99]
    s_waitcnt lgkmcnt(0)
    v_mfma_f32_16x16x32_bf16 v[96:99], v[252:255], v[112:115], v[96:99]
    v_mfma_f32_16x16x32_bf16 v[88:91], v[244:247], v[112:115], v[88:91]
    v_mfma_f32_16x16x32_bf16 v[92:95], v[248:251], v[112:115], v[92:95]
    s_nop 5
    v_cvt_pk_bf16_f32 v96, v96, v97
    v_cvt_pk_bf16_f32 v97, v98, v99
    ds_write_b64 v38, v[96:97] offset:12288
    v_cvt_pk_bf16_f32 v88, v88, v89
    v_cvt_pk_bf16_f32 v89, v90, v91
    v_cvt_pk_bf16_f32 v90, v92, v93
    v_cvt_pk_bf16_f32 v91, v94, v95
    s_waitcnt lgkmcnt(0)
    s_barrier
    ds_read_b64 v[98:99], v39 offset:12288
    v_permlane16_swap_b32 v88, v90
    v_permlane16_swap_b32 v89, v91
    buffer_store_dwordx4 v[88:91], v21, s[20:23], s77 offen sc1
    s_waitcnt lgkmcnt(0)
    buffer_store_dwordx2 v[98:99], v22, s[20:23], s77 offen sc1
    s_branch L_check
L_hot_end:
L_bfail0:
    v_mov_b32 v144, s60
    ds_write_b32 v110, v144 offset:4
    s_mov_b64 s[80:81], 0
    s_mov_b64 s[82:83], 0
    s_mov_b64 s[84:85], 0
    s_mov_b64 s[86:87], 0
    s_branch L_singles
L_bfail1:
    v_mov_b32 v144, s60
    ds_write_b32 v110, v144 offset:4
    s_mov_b64 s[80:81], 0
    s_mov_b64 s[82:83], 0
    s_mov_b64 s[84:85], 0
    s_mov_b64 s[86:87], 0
    s_mov_b32 s62, 0
    s_branch L_bfail1_back
L_bfail2:
    v_mov_b32 v144, s38
    ds_or_b32 v34, v144
    s_branch L_bfail2_back
L_afailX:
    s_mov_b64 exec, s[80:81]
    ds_or_b32 v34, v32
    s_mov_b64 exec, s[82:83]
    ds_or_b32 v34, v33
    s_mov_b64 exec, -1
    s_waitcnt lgkmcnt(0)
    s_branch L_afailX_back
L_afailY:
    s_mov_b64 exec, s[80:81]
    ds_or_b32 v34, v32
    s_mov_b64 exec, s[82:83]
    ds_or_b32 v34, v33
    s_mov_b64 exec, -1
    s_waitcnt lgkmcnt(0)
    s_branch L_afailY_back
L_slow:
    s_waitcnt vmcnt(0) lgkmcnt(0)
    s_barrier
    s_ff1_i32_b32 s80, s63
    s_bitset0_b32 s63, s80
    s_mul_i32 s81, s80, 224
    s_add_u32 s81, s81, s45
    s_mov_b32 s82, 1
    s_cmp_lt_u32 s80, 16
    s_cbranch_scc1 L_s1
    s_bfe_u32 s40, s80, 0x10002
    s_add_u32 s40, s40, s53
    s_and_b32 s41, s80, 3
    s_lshl_b32 s41, s41, 4
    s_cmp_eq_u32 s47, 0
    s_cselect_b32 s82, 1, 224
    s_cselect_b32 s81, 224, 1
    s_mul_i32 s81, s81, s40
    s_mul_i32 s41, s41, s82
    s_add_u32 s81, s81, s41
L_s1:
    s_movk_i32 s43, 224
    v_mul_u32_u24 v79, s82, v2
    v_lshl_add_u32 v49, s2, 2, v3
    v_lshl_add_u32 v49, v49, 3, 64
    v_mad_u32_u24 v49, v79, s42, v49
    v_add_u32 v79, s81, v79
    v_lshrrev_b32 v80, 4, v0
    v_min_u32 v80, 8, v80
    v_mul_u32_u24 v85, 36, v79
    v_lshl_add_u32 v85, v80, 2, v85
    buffer_load_dword v85, v85, s[12:15], 0 offen
    v_mul_u32_u24 v81, 74899, v79
    v_lshrrev_b32 v81, 24, v81
    v_mul_u32_u24 v82, 224, v81
    v_sub_u32 v82, v79, v82
    v_mul_u32_u24 v83, 11, v80
    v_lshrrev_b32 v83, 5, v83
    v_mad_i32_i24 v84, v83, -3, v80
    v_add3_u32 v81, v81, v83, -1
    v_add3_u32 v82, v82, v84, -1
    v_cvt_f32_i32 v81, v81
    v_cvt_f32_i32 v82, v82
    s_waitcnt vmcnt(0)
    v_lshlrev_b32 v65, 16, v85
    v_and_b32 v66, 0xffff0000, v85
    v_add_f32 v65, v81, v65
    v_add_f32 v66, v82, v66
    v_cvt_pk_bf16_f32 v64, v65, v66
    v_pk_max_i16 v64, v64, 0
    v_pk_min_i16 v64, v64, s60
    v_lshlrev_b32 v65, 16, v64
    v_and_b32 v66, 0xffff0000, v64
    v_fract_f32 v71, v65
    v_fract_f32 v72, v66
    v_ceil_f32 v68, v65
    v_ceil_f32 v70, v66
    v_sub_f32 v73, 1.0, v71
    v_sub_f32 v74, 1.0, v72
    v_cvt_u32_f32 v67, v65
    v_cvt_u32_f32 v69, v66
    v_cvt_pk_bf16_f32 v74, v73, v74
    v_cvt_u32_f32 v68, v68
    v_cvt_u32_f32 v70, v70
    v_lshlrev_b32 v73, 16, v74
    v_and_b32 v74, 0xffff0000, v74
    v_mul_f32 v78, v71, v72
    v_mul_f32 v76, v73, v72
    v_mul_f32 v77, v71, v74
    v_mul_f32 v75, v73, v74
    v_mad_u32_u24 v88, v67, s43, v69
    v_mul_u32_u24 v88, 192, v88
    v_mad_u32_u24 v89, v67, s43, v70
    v_mul_u32_u24 v89, 192, v89
    v_mad_u32_u24 v90, v68, s43, v69
    v_mul_u32_u24 v90, 192, v90
    v_mad_u32_u24 v91, v68, s43, v70
    v_mul_u32_u24 v91, 192, v91
    v_cvt_pk_bf16_f32 v92, v75, v76
    v_cvt_pk_bf16_f32 v93, v77, v78
    v_lshlrev_b32 v79, 5, v0
    v_add_u32 v79, 61440, v79
    ds_write_b128 v79, v[88:91]
    ds_write_b64 v79, v[92:93] offset:16
    s_mov_b32 s83, 0
    s_waitcnt lgkmcnt(0)
    s_barrier
L_s2:
    s_add_u32 s40, s83, 0
    v_add_u32 v96, s40, v0
    v_mul_u32_u24 v70, 5462, v96
    v_lshrrev_b32 v70, 16, v70
    v_mad_i32_i24 v71, v70, -12, v96
    v_lshlrev_b32 v70, 5, v70
    v_add_u32 v70, 61440, v70
    ds_read_b128 v[64:67], v70
    ds_read_b64 v[68:69], v70 offset:16
    v_lshlrev_b32 v96, 4, v96
    s_add_u32 s40, s83, 256
    v_add_u32 v97, s40, v0
    v_mul_u32_u24 v78, 5462, v97
    v_lshrrev_b32 v78, 16, v78
    v_mad_i32_i24 v79, v78, -12, v97
    v_lshlrev_b32 v78, 5, v78
    v_add_u32 v78, 61440, v78
    ds_read_b128 v[72:75], v78
    ds_read_b64 v[76:77], v78 offset:16
    v_lshlrev_b32 v97, 4, v97
    s_add_u32 s40, s83, 512
    v_add_u32 v98, s40, v0
    v_mul_u32_u24 v86, 5462, v98
    v_lshrrev_b32 v86, 16, v86
    v_mad_i32_i24 v87, v86, -12, v98
    v_lshlrev_b32 v86, 5, v86
    v_add_u32 v86, 61440, v86
    ds_read_b128 v[80:83], v86
    ds_read_b64 v[84:85], v86 offset:16
    v_lshlrev_b32 v98, 4, v98
    s_add_u32 s40, s83, 768
    v_add_u32 v99, s40, v0
    v_mul_u32_u24 v94, 5462, v99
    v_lshrrev_b32 v94, 16, v94
    v_mad_i32_i24 v95, v94, -12, v99
    v_lshlrev_b32 v94, 5, v94
    v_add_u32 v94, 61440, v94
    ds_read_b128 v[88:91], v94
    ds_read_b64 v[92:93], v94 offset:16
    v_lshlrev_b32 v99, 4, v99
    s_waitcnt lgkmcnt(0)
    v_lshl_add_u32 v64, v71, 4, v64
    buffer_load_dwordx4 v[100:103], v64, s[8:11], 0 offen
    v_lshl_add_u32 v65, v71, 4, v65
    buffer_load_dwordx4 v[104:107], v65, s[8:11], 0 offen
    v_lshl_add_u32 v66, v71, 4, v66
    buffer_load_dwordx4 v[108:111], v66, s[8:11], 0 offen
    v_lshl_add_u32 v67, v71, 4, v67
    buffer_load_dwordx4 v[112:115], v67, s[8:11], 0 offen
    v_lshl_add_u32 v72, v79, 4, v72
    buffer_load_dwordx4 v[116:119], v72, s[8:11], 0 offen
    v_lshl_add_u32 v73, v79, 4, v73
    buffer_load_dwordx4 v[120:123], v73, s[8:11], 0 offen
    v_lshl_add_u32 v74, v79, 4, v74
    buffer_load_dwordx4 v[124:127], v74, s[8:11], 0 offen
    v_lshl_add_u32 v75, v79, 4, v75
    buffer_load_dwordx4 v[128:131], v75, s[8:11], 0 offen
    v_lshl_add_u32 v80, v87, 4, v80
    buffer_load_dwordx4 v[132:135], v80, s[8:11], 0 offen
    v_lshl_add_u32 v81, v87, 4, v81
    buffer_load_dwordx4 v[136:139], v81, s[8:11], 0 offen
    v_lshl_add_u32 v82, v87, 4, v82
    buffer_load_dwordx4 v[140:143], v82, s[8:11], 0 offen
    v_lshl_add_u32 v83, v87, 4, v83
    buffer_load_dwordx4 v[144:147], v83, s[8:11], 0 offen
    v_lshl_add_u32 v88, v95, 4, v88
    buffer_load_dwordx4 v[148:151], v88, s[8:11], 0 offen
    v_lshl_add_u32 v89, v95, 4, v89
    buffer_load_dwordx4 v[152:155], v89, s[8:11], 0 offen
    v_lshl_add_u32 v90, v95, 4, v90
    buffer_load_dwordx4 v[156:159], v90, s[8:11], 0 offen
    v_lshl_add_u32 v91, v95, 4, v91
    buffer_load_dwordx4 v[160:163], v91, s[8:11], 0 offen
    s_waitcnt vmcnt(12)
    v_lshlrev_b32 v172, 16, v68
    v_lshlrev_b32 v173, 16, v100
    v_and_b32 v174, 0xffff0000, v100
    v_mul_f32 v164, v172, v173
    v_mul_f32 v165, v172, v174
    v_lshlrev_b32 v173, 16, v101
    v_and_b32 v174, 0xffff0000, v101
    v_mul_f32 v166, v172, v173
    v_mul_f32 v167, v172, v174
    v_lshlrev_b32 v173, 16, v102
    v_and_b32 v174, 0xffff0000, v102
    v_mul_f32 v168, v172, v173
    v_mul_f32 v169, v172, v174
    v_lshlrev_b32 v173, 16, v103
    v_and_b32 v174, 0xffff0000, v103
    v_mul_f32 v170, v172, v173
    v_mul_f32 v171, v172, v174
    v_and_b32 v172, 0xffff0000, v68
    v_lshlrev_b32 v173, 16, v104
    v_and_b32 v174, 0xffff0000, v104
    v_fmac_f32 v164, v172, v173
    v_fmac_f32 v165, v172, v174
    v_lshlrev_b32 v173, 16, v105
    v_and_b32 v174, 0xffff0000, v105
    v_fmac_f32 v166, v172, v173
    v_fmac_f32 v167, v172, v174
    v_lshlrev_b32 v173, 16, v106
    v_and_b32 v174, 0xffff0000, v106
    v_fmac_f32 v168, v172, v173
    v_fmac_f32 v169, v172, v174
    v_lshlrev_b32 v173, 16, v107
    v_and_b32 v174, 0xffff0000, v107
    v_fmac_f32 v170, v172, v173
    v_fmac_f32 v171, v172, v174
    v_lshlrev_b32 v172, 16, v69
    v_lshlrev_b32 v173, 16, v108
    v_and_b32 v174, 0xffff0000, v108
    v_fmac_f32 v164, v172, v173
    v_fmac_f32 v165, v172, v174
    v_lshlrev_b32 v173, 16, v109
    v_and_b32 v174, 0xffff0000, v109
    v_fmac_f32 v166, v172, v173
    v_fmac_f32 v167, v172, v174
    v_lshlrev_b32 v173, 16, v110
    v_and_b32 v174, 0xffff0000, v110
    v_fmac_f32 v168, v172, v173
    v_fmac_f32 v169, v172, v174
    v_lshlrev_b32 v173, 16, v111
    v_and_b32 v174, 0xffff0000, v111
    v_fmac_f32 v170, v172, v173
    v_fmac_f32 v171, v172, v174
    v_and_b32 v172, 0xffff0000, v69
    v_lshlrev_b32 v173, 16, v112
    v_and_b32 v174, 0xffff0000, v112
    v_fmac_f32 v164, v172, v173
    v_fmac_f32 v165, v172, v174
    v_lshlrev_b32 v173, 16, v113
    v_and_b32 v174, 0xffff0000, v113
    v_fmac_f32 v166, v172, v173
    v_fmac_f32 v167, v172, v174
    v_lshlrev_b32 v173, 16, v114
    v_and_b32 v174, 0xffff0000, v114
    v_fmac_f32 v168, v172, v173
    v_fmac_f32 v169, v172, v174
    v_lshlrev_b32 v173, 16, v115
    v_and_b32 v174, 0xffff0000, v115
    v_fmac_f32 v170, v172, v173
    v_fmac_f32 v171, v172, v174
    v_cvt_pk_bf16_f32 v176, v164, v165
    v_cvt_pk_bf16_f32 v177, v166, v167
    v_cvt_pk_bf16_f32 v178, v168, v169
    v_cvt_pk_bf16_f32 v179, v170, v171
    ds_write_b128 v96, v[176:179]
    s_waitcnt vmcnt(8)
    v_lshlrev_b32 v172, 16, v76
    v_lshlrev_b32 v173, 16, v116
    v_and_b32 v174, 0xffff0000, v116
    v_mul_f32 v164, v172, v173
    v_mul_f32 v165, v172, v174
    v_lshlrev_b32 v173, 16, v117
    v_and_b32 v174, 0xffff0000, v117
    v_mul_f32 v166, v172, v173
    v_mul_f32 v167, v172, v174
    v_lshlrev_b32 v173, 16, v118
    v_and_b32 v174, 0xffff0000, v118
    v_mul_f32 v168, v172, v173
    v_mul_f32 v169, v172, v174
    v_lshlrev_b32 v173, 16, v119
    v_and_b32 v174, 0xffff0000, v119
    v_mul_f32 v170, v172, v173
    v_mul_f32 v171, v172, v174
    v_and_b32 v172, 0xffff0000, v76
    v_lshlrev_b32 v173, 16, v120
    v_and_b32 v174, 0xffff0000, v120
    v_fmac_f32 v164, v172, v173
    v_fmac_f32 v165, v172, v174
    v_lshlrev_b32 v173, 16, v121
    v_and_b32 v174, 0xffff0000, v121
    v_fmac_f32 v166, v172, v173
    v_fmac_f32 v167, v172, v174
    v_lshlrev_b32 v173, 16, v122
    v_and_b32 v174, 0xffff0000, v122
    v_fmac_f32 v168, v172, v173
    v_fmac_f32 v169, v172, v174
    v_lshlrev_b32 v173, 16, v123
    v_and_b32 v174, 0xffff0000, v123
    v_fmac_f32 v170, v172, v173
    v_fmac_f32 v171, v172, v174
    v_lshlrev_b32 v172, 16, v77
    v_lshlrev_b32 v173, 16, v124
    v_and_b32 v174, 0xffff0000, v124
    v_fmac_f32 v164, v172, v173
    v_fmac_f32 v165, v172, v174
    v_lshlrev_b32 v173, 16, v125
    v_and_b32 v174, 0xffff0000, v125
    v_fmac_f32 v166, v172, v173
    v_fmac_f32 v167, v172, v174
    v_lshlrev_b32 v173, 16, v126
    v_and_b32 v174, 0xffff0000, v126
    v_fmac_f32 v168, v172, v173
    v_fmac_f32 v169, v172, v174
    v_lshlrev_b32 v173, 16, v127
    v_and_b32 v174, 0xffff0000, v127
    v_fmac_f32 v170, v172, v173
    v_fmac_f32 v171, v172, v174
    v_and_b32 v172, 0xffff0000, v77
    v_lshlrev_b32 v173, 16, v128
    v_and_b32 v174, 0xffff0000, v128
    v_fmac_f32 v164, v172, v173
    v_fmac_f32 v165, v172, v174
    v_lshlrev_b32 v173, 16, v129
    v_and_b32 v174, 0xffff0000, v129
    v_fmac_f32 v166, v172, v173
    v_fmac_f32 v167, v172, v174
    v_lshlrev_b32 v173, 16, v130
    v_and_b32 v174, 0xffff0000, v130
    v_fmac_f32 v168, v172, v173
    v_fmac_f32 v169, v172, v174
    v_lshlrev_b32 v173, 16, v131
    v_and_b32 v174, 0xffff0000, v131
    v_fmac_f32 v170, v172, v173
    v_fmac_f32 v171, v172, v174
    v_cvt_pk_bf16_f32 v176, v164, v165
    v_cvt_pk_bf16_f32 v177, v166, v167
    v_cvt_pk_bf16_f32 v178, v168, v169
    v_cvt_pk_bf16_f32 v179, v170, v171
    ds_write_b128 v97, v[176:179]
    s_waitcnt vmcnt(4)
    v_lshlrev_b32 v172, 16, v84
    v_lshlrev_b32 v173, 16, v132
    v_and_b32 v174, 0xffff0000, v132
    v_mul_f32 v164, v172, v173
    v_mul_f32 v165, v172, v174
    v_lshlrev_b32 v173, 16, v133
    v_and_b32 v174, 0xffff0000, v133
    v_mul_f32 v166, v172, v173
    v_mul_f32 v167, v172, v174
    v_lshlrev_b32 v173, 16, v134
    v_and_b32 v174, 0xffff0000, v134
    v_mul_f32 v168, v172, v173
    v_mul_f32 v169, v172, v174
    v_lshlrev_b32 v173, 16, v135
    v_and_b32 v174, 0xffff0000, v135
    v_mul_f32 v170, v172, v173
    v_mul_f32 v171, v172, v174
    v_and_b32 v172, 0xffff0000, v84
    v_lshlrev_b32 v173, 16, v136
    v_and_b32 v174, 0xffff0000, v136
    v_fmac_f32 v164, v172, v173
    v_fmac_f32 v165, v172, v174
    v_lshlrev_b32 v173, 16, v137
    v_and_b32 v174, 0xffff0000, v137
    v_fmac_f32 v166, v172, v173
    v_fmac_f32 v167, v172, v174
    v_lshlrev_b32 v173, 16, v138
    v_and_b32 v174, 0xffff0000, v138
    v_fmac_f32 v168, v172, v173
    v_fmac_f32 v169, v172, v174
    v_lshlrev_b32 v173, 16, v139
    v_and_b32 v174, 0xffff0000, v139
    v_fmac_f32 v170, v172, v173
    v_fmac_f32 v171, v172, v174
    v_lshlrev_b32 v172, 16, v85
    v_lshlrev_b32 v173, 16, v140
    v_and_b32 v174, 0xffff0000, v140
    v_fmac_f32 v164, v172, v173
    v_fmac_f32 v165, v172, v174
    v_lshlrev_b32 v173, 16, v141
    v_and_b32 v174, 0xffff0000, v141
    v_fmac_f32 v166, v172, v173
    v_fmac_f32 v167, v172, v174
    v_lshlrev_b32 v173, 16, v142
    v_and_b32 v174, 0xffff0000, v142
    v_fmac_f32 v168, v172, v173
    v_fmac_f32 v169, v172, v174
    v_lshlrev_b32 v173, 16, v143
    v_and_b32 v174, 0xffff0000, v143
    v_fmac_f32 v170, v172, v173
    v_fmac_f32 v171, v172, v174
    v_and_b32 v172, 0xffff0000, v85
    v_lshlrev_b32 v173, 16, v144
    v_and_b32 v174, 0xffff0000, v144
    v_fmac_f32 v164, v172, v173
    v_fmac_f32 v165, v172, v174
    v_lshlrev_b32 v173, 16, v145
    v_and_b32 v174, 0xffff0000, v145
    v_fmac_f32 v166, v172, v173
    v_fmac_f32 v167, v172, v174
    v_lshlrev_b32 v173, 16, v146
    v_and_b32 v174, 0xffff0000, v146
    v_fmac_f32 v168, v172, v173
    v_fmac_f32 v169, v172, v174
    v_lshlrev_b32 v173, 16, v147
    v_and_b32 v174, 0xffff0000, v147
    v_fmac_f32 v170, v172, v173
    v_fmac_f32 v171, v172, v174
    v_cvt_pk_bf16_f32 v176, v164, v165
    v_cvt_pk_bf16_f32 v177, v166, v167
    v_cvt_pk_bf16_f32 v178, v168, v169
    v_cvt_pk_bf16_f32 v179, v170, v171
    ds_write_b128 v98, v[176:179]
    s_waitcnt vmcnt(0)
    v_lshlrev_b32 v172, 16, v92
    v_lshlrev_b32 v173, 16, v148
    v_and_b32 v174, 0xffff0000, v148
    v_mul_f32 v164, v172, v173
    v_mul_f32 v165, v172, v174
    v_lshlrev_b32 v173, 16, v149
    v_and_b32 v174, 0xffff0000, v149
    v_mul_f32 v166, v172, v173
    v_mul_f32 v167, v172, v174
    v_lshlrev_b32 v173, 16, v150
    v_and_b32 v174, 0xffff0000, v150
    v_mul_f32 v168, v172, v173
    v_mul_f32 v169, v172, v174
    v_lshlrev_b32 v173, 16, v151
    v_and_b32 v174, 0xffff0000, v151
    v_mul_f32 v170, v172, v173
    v_mul_f32 v171, v172, v174
    v_and_b32 v172, 0xffff0000, v92
    v_lshlrev_b32 v173, 16, v152
    v_and_b32 v174, 0xffff0000, v152
    v_fmac_f32 v164, v172, v173
    v_fmac_f32 v165, v172, v174
    v_lshlrev_b32 v173, 16, v153
    v_and_b32 v174, 0xffff0000, v153
    v_fmac_f32 v166, v172, v173
    v_fmac_f32 v167, v172, v174
    v_lshlrev_b32 v173, 16, v154
    v_and_b32 v174, 0xffff0000, v154
    v_fmac_f32 v168, v172, v173
    v_fmac_f32 v169, v172, v174
    v_lshlrev_b32 v173, 16, v155
    v_and_b32 v174, 0xffff0000, v155
    v_fmac_f32 v170, v172, v173
    v_fmac_f32 v171, v172, v174
    v_lshlrev_b32 v172, 16, v93
    v_lshlrev_b32 v173, 16, v156
    v_and_b32 v174, 0xffff0000, v156
    v_fmac_f32 v164, v172, v173
    v_fmac_f32 v165, v172, v174
    v_lshlrev_b32 v173, 16, v157
    v_and_b32 v174, 0xffff0000, v157
    v_fmac_f32 v166, v172, v173
    v_fmac_f32 v167, v172, v174
    v_lshlrev_b32 v173, 16, v158
    v_and_b32 v174, 0xffff0000, v158
    v_fmac_f32 v168, v172, v173
    v_fmac_f32 v169, v172, v174
    v_lshlrev_b32 v173, 16, v159
    v_and_b32 v174, 0xffff0000, v159
    v_fmac_f32 v170, v172, v173
    v_fmac_f32 v171, v172, v174
    v_and_b32 v172, 0xffff0000, v93
    v_lshlrev_b32 v173, 16, v160
    v_and_b32 v174, 0xffff0000, v160
    v_fmac_f32 v164, v172, v173
    v_fmac_f32 v165, v172, v174
    v_lshlrev_b32 v173, 16, v161
    v_and_b32 v174, 0xffff0000, v161
    v_fmac_f32 v166, v172, v173
    v_fmac_f32 v167, v172, v174
    v_lshlrev_b32 v173, 16, v162
    v_and_b32 v174, 0xffff0000, v162
    v_fmac_f32 v168, v172, v173
    v_fmac_f32 v169, v172, v174
    v_lshlrev_b32 v173, 16, v163
    v_and_b32 v174, 0xffff0000, v163
    v_fmac_f32 v170, v172, v173
    v_fmac_f32 v171, v172, v174
    v_cvt_pk_bf16_f32 v176, v164, v165
    v_cvt_pk_bf16_f32 v177, v166, v167
    v_cvt_pk_bf16_f32 v178, v168, v169
    v_cvt_pk_bf16_f32 v179, v170, v171
    ds_write_b128 v99, v[176:179]
    s_add_u32 s83, s83, 1024
    s_cmp_lt_u32 s83, 1728
    s_cbranch_scc1 L_s2
    s_waitcnt lgkmcnt(0)
    s_barrier
    s_cmp_ge_u32 s3, 2
    s_cbranch_scc1 L_s3
    v_mad_u32_u24 v40, v2, s42, v4
    ds_read_b128 v[112:115], v40 offset:0
    ds_read_b128 v[116:119], v40 offset:64
    ds_read_b128 v[120:123], v40 offset:128
    s_waitcnt lgkmcnt(0)
    v_mfma_f32_16x16x32_bf16 v[64:67], a[0:3], v[112:115], 0
    v_mfma_f32_16x16x32_bf16 v[68:71], a[4:7], v[112:115], 0
    v_mfma_f32_16x16x32_bf16 v[72:75], a[8:11], v[112:115], 0
    v_mfma_f32_16x16x32_bf16 v[64:67], a[12:15], v[116:119], v[64:67]
    v_mfma_f32_16x16x32_bf16 v[68:71], a[16:19], v[116:119], v[68:71]
    v_mfma_f32_16x16x32_bf16 v[72:75], a[20:23], v[116:119], v[72:75]
    v_mfma_f32_16x16x32_bf16 v[64:67], a[24:27], v[120:123], v[64:67]
    v_mfma_f32_16x16x32_bf16 v[68:71], a[28:31], v[120:123], v[68:71]
    v_mfma_f32_16x16x32_bf16 v[72:75], a[32:35], v[120:123], v[72:75]
    s_nop 1
    ds_read_b128 v[112:115], v40 offset:3072
    ds_read_b128 v[116:119], v40 offset:3136
    ds_read_b128 v[120:123], v40 offset:3200
    s_waitcnt lgkmcnt(0)
    v_mfma_f32_16x16x32_bf16 v[64:67], a[36:39], v[112:115], v[64:67]
    v_mfma_f32_16x16x32_bf16 v[68:71], a[40:43], v[112:115], v[68:71]
    v_mfma_f32_16x16x32_bf16 v[72:75], a[44:47], v[112:115], v[72:75]
    v_mfma_f32_16x16x32_bf16 v[64:67], a[48:51], v[116:119], v[64:67]
    v_mfma_f32_16x16x32_bf16 v[68:71], a[52:55], v[116:119], v[68:71]
    v_mfma_f32_16x16x32_bf16 v[72:75], a[56:59], v[116:119], v[72:75]
    v_mfma_f32_16x16x32_bf16 v[64:67], a[60:63], v[120:123], v[64:67]
    v_mfma_f32_16x16x32_bf16 v[68:71], a[64:67], v[120:123], v[68:71]
    v_mfma_f32_16x16x32_bf16 v[72:75], a[68:71], v[120:123], v[72:75]
    s_nop 1
    ds_read_b128 v[112:115], v40 offset:6144
    ds_read_b128 v[116:119], v40 offset:6208
    ds_read_b128 v[120:123], v40 offset:6272
    s_waitcnt lgkmcnt(0)
    v_mfma_f32_16x16x32_bf16 v[64:67], a[72:75], v[112:115], v[64:67]
    v_mfma_f32_16x16x32_bf16 v[68:71], a[76:79], v[112:115], v[68:71]
    v_mfma_f32_16x16x32_bf16 v[72:75], a[80:83], v[112:115], v[72:75]
    v_mfma_f32_16x16x32_bf16 v[64:67], a[84:87], v[116:119], v[64:67]
    v_mfma_f32_16x16x32_bf16 v[68:71], a[88:91], v[116:119], v[68:71]
    v_mfma_f32_16x16x32_bf16 v[72:75], a[92:95], v[116:119], v[72:75]
    v_mfma_f32_16x16x32_bf16 v[64:67], a[96:99], v[120:123], v[64:67]
    v_mfma_f32_16x16x32_bf16 v[68:71], a[100:103], v[120:123], v[68:71]
    v_mfma_f32_16x16x32_bf16 v[72:75], a[104:107], v[120:123], v[72:75]
    s_nop 1
    ds_read_b128 v[112:115], v40 offset:9216
    ds_read_b128 v[116:119], v40 offset:9280
    ds_read_b128 v[120:123], v40 offset:9344
    s_waitcnt lgkmcnt(0)
    v_mfma_f32_16x16x32_bf16 v[64:67], a[108:111], v[112:115], v[64:67]
    v_mfma_f32_16x16x32_bf16 v[68:71], a[112:115], v[112:115], v[68:71]
    v_mfma_f32_16x16x32_bf16 v[72:75], a[116:119], v[112:115], v[72:75]
    v_mfma_f32_16x16x32_bf16 v[64:67], a[120:123], v[116:119], v[64:67]
    v_mfma_f32_16x16x32_bf16 v[68:71], a[124:127], v[116:119], v[68:71]
    v_mfma_f32_16x16x32_bf16 v[72:75], a[128:131], v[116:119], v[72:75]
    v_mfma_f32_16x16x32_bf16 v[64:67], a[132:135], v[120:123], v[64:67]
    v_mfma_f32_16x16x32_bf16 v[68:71], a[136:139], v[120:123], v[68:71]
    v_mfma_f32_16x16x32_bf16 v[72:75], a[140:143], v[120:123], v[72:75]
    s_nop 1
    ds_read_b128 v[112:115], v40 offset:12288
    ds_read_b128 v[116:119], v40 offset:12352
    ds_read_b128 v[120:123], v40 offset:12416
    s_waitcnt lgkmcnt(0)
    v_mfma_f32_16x16x32_bf16 v[64:67], a[144:147], v[112:115], v[64:67]
    v_mfma_f32_16x16x32_bf16 v[68:71], a[148:151], v[112:115], v[68:71]
    v_mfma_f32_16x16x32_bf16 v[72:75], a[152:155], v[112:115], v[72:75]
    v_mfma_f32_16x16x32_bf16 v[64:67], a[156:159], v[116:119], v[64:67]
    v_mfma_f32_16x16x32_bf16 v[68:71], a[160:163], v[116:119], v[68:71]
    v_mfma_f32_16x16x32_bf16 v[72:75], a[164:167], v[116:119], v[72:75]
    v_mfma_f32_16x16x32_bf16 v[64:67], a[168:171], v[120:123], v[64:67]
    v_mfma_f32_16x16x32_bf16 v[68:71], a[172:175], v[120:123], v[68:71]
    v_mfma_f32_16x16x32_bf16 v[72:75], a[176:179], v[120:123], v[72:75]
    s_nop 1
    ds_read_b128 v[112:115], v40 offset:15360
    ds_read_b128 v[116:119], v40 offset:15424
    ds_read_b128 v[120:123], v40 offset:15488
    s_waitcnt lgkmcnt(0)
    v_mfma_f32_16x16x32_bf16 v[64:67], a[180:183], v[112:115], v[64:67]
    v_mfma_f32_16x16x32_bf16 v[68:71], a[184:187], v[112:115], v[68:71]
    v_mfma_f32_16x16x32_bf16 v[72:75], a[188:191], v[112:115], v[72:75]
    v_mfma_f32_16x16x32_bf16 v[64:67], a[192:195], v[116:119], v[64:67]
    v_mfma_f32_16x16x32_bf16 v[68:71], a[196:199], v[116:119], v[68:71]
    v_mfma_f32_16x16x32_bf16 v[72:75], a[200:203], v[116:119], v[72:75]
    v_mfma_f32_16x16x32_bf16 v[64:67], a[204:207], v[120:123], v[64:67]
    v_mfma_f32_16x16x32_bf16 v[68:71], a[208:211], v[120:123], v[68:71]
    v_mfma_f32_16x16x32_bf16 v[72:75], a[212:215], v[120:123], v[72:75]
    s_nop 1
    ds_read_b128 v[112:115], v40 offset:18432
    ds_read_b128 v[116:119], v40 offset:18496
    ds_read_b128 v[120:123], v40 offset:18560
    s_waitcnt lgkmcnt(0)
    v_mfma_f32_16x16x32_bf16 v[64:67], a[216:219], v[112:115], v[64:67]
    v_mfma_f32_16x16x32_bf16 v[68:71], a[220:223], v[112:115], v[68:71]
    v_mfma_f32_16x16x32_bf16 v[72:75], a[224:227], v[112:115], v[72:75]
    v_mfma_f32_16x16x32_bf16 v[64:67], a[228:231], v[116:119], v[64:67]
    v_mfma_f32_16x16x32_bf16 v[68:71], a[232:235], v[116:119], v[68:71]
    v_mfma_f32_16x16x32_bf16 v[72:75], a[236:239], v[116:119], v[72:75]
    v_mfma_f32_16x16x32_bf16 v[64:67], a[240:243], v[120:123], v[64:67]
    v_mfma_f32_16x16x32_bf16 v[68:71], a[244:247], v[120:123], v[68:71]
    v_mfma_f32_16x16x32_bf16 v[72:75], a[248:251], v[120:123], v[72:75]
    s_nop 1
    ds_read_b128 v[112:115], v40 offset:21504
    ds_read_b128 v[116:119], v40 offset:21568
    ds_read_b128 v[120:123], v40 offset:21632
    s_waitcnt lgkmcnt(0)
    v_mfma_f32_16x16x32_bf16 v[64:67], a[252:255], v[112:115], v[64:67]
    v_mfma_f32_16x16x32_bf16 v[68:71], v[188:191], v[112:115], v[68:71]
    v_mfma_f32_16x16x32_bf16 v[72:75], v[192:195], v[112:115], v[72:75]
    v_mfma_f32_16x16x32_bf16 v[64:67], v[196:199], v[116:119], v[64:67]
    v_mfma_f32_16x16x32_bf16 v[68:71], v[200:203], v[116:119], v[68:71]
    v_mfma_f32_16x16x32_bf16 v[72:75], v[204:207], v[116:119], v[72:75]
    v_mfma_f32_16x16x32_bf16 v[64:67], v[208:211], v[120:123], v[64:67]
    v_mfma_f32_16x16x32_bf16 v[68:71], v[212:215], v[120:123], v[68:71]
    v_mfma_f32_16x16x32_bf16 v[72:75], v[216:219], v[120:123], v[72:75]
    s_nop 1
    ds_read_b128 v[112:115], v40 offset:24576
    ds_read_b128 v[116:119], v40 offset:24640
    ds_read_b128 v[120:123], v40 offset:24704
    s_waitcnt lgkmcnt(0)
    v_mfma_f32_16x16x32_bf16 v[64:67], v[220:223], v[112:115], v[64:67]
    v_mfma_f32_16x16x32_bf16 v[68:71], v[224:227], v[112:115], v[68:71]
    v_mfma_f32_16x16x32_bf16 v[72:75], v[228:231], v[112:115], v[72:75]
    v_mfma_f32_16x16x32_bf16 v[64:67], v[232:235], v[116:119], v[64:67]
    v_mfma_f32_16x16x32_bf16 v[68:71], v[236:239], v[116:119], v[68:71]
    v_mfma_f32_16x16x32_bf16 v[72:75], v[240:243], v[116:119], v[72:75]
    v_mfma_f32_16x16x32_bf16 v[64:67], v[244:247], v[120:123], v[64:67]
    v_mfma_f32_16x16x32_bf16 v[68:71], v[248:251], v[120:123], v[68:71]
    v_mfma_f32_16x16x32_bf16 v[72:75], v[252:255], v[120:123], v[72:75]
    s_nop 1
    s_mul_i32 s81, s81, 192
    s_cmp_lt_u32 s80, 16
    s_cselect_b64 vcc, -1, 0
    v_cndmask_b32 v40, v21, v19, vcc
    s_nop 5
    v_cvt_pk_bf16_f32 v64, v64, v65
    v_cvt_pk_bf16_f32 v65, v66, v67
    v_cvt_pk_bf16_f32 v66, v68, v69
    v_cvt_pk_bf16_f32 v67, v70, v71
    v_cvt_pk_bf16_f32 v72, v72, v73
    v_cvt_pk_bf16_f32 v73, v74, v75
    v_permlane16_swap_b32 v64, v66
    v_permlane16_swap_b32 v65, v67
    buffer_store_dwordx4 v[64:67], v40, s[20:23], s81 offen sc1
    buffer_store_dwordx2 v[72:73], v49, s[20:23], s81 offen sc1
L_s3:
    s_branch L_check
L_code_end:
    s_endpgm
.section .rodata,"a"
.p2align 6
.amdhsa_kernel standalone__deformable_dcnv1__vision_kernel
  .amdhsa_next_free_vgpr 512
  .amdhsa_next_free_sgpr 102
  .amdhsa_accum_offset 256
  .amdhsa_group_segment_fixed_size 0
  .amdhsa_kernarg_size 48
  .amdhsa_user_sgpr_count 2
  .amdhsa_user_sgpr_kernarg_segment_ptr 1
  .amdhsa_system_sgpr_workgroup_id_x 1
  .amdhsa_float_denorm_mode_32 3
.end_amdhsa_kernel
```

```asm
; @launch grid=(256,1,1) block=(256,1,1) lds=159040

.amdgcn_target "amdgcn-amd-amdhsa--gfx950"
.text
.globl standalone__deformable_dcnv1__vision_kernel
.p2align 12
.type standalone__deformable_dcnv1__vision_kernel,@function
standalone__deformable_dcnv1__vision_kernel:
    s_cmpk_ge_u32 s2, 256
    s_cbranch_scc1 L_end
    s_load_dwordx2 s[8:9], s[0:1], 0
    s_load_dwordx2 s[16:17], s[0:1], 16
    s_load_dwordx2 s[12:13], s[0:1], 8
    s_load_dwordx2 s[20:21], s[0:1], 24
    s_getpc_b64 s[6:7]
L_pc:
    s_lshr_b32 s41, s2, 3
    v_lshrrev_b32 v144, 6, v0
    s_mul_i32 s40, s41, 768
    v_lshl_add_u32 v145, v0, 2, s40
    v_readfirstlane_b32 s3, v144
    global_load_dword v37, v145, s[6:7]
    s_and_b32 s85, s2, 7
    s_lshl_b32 s85, s85, 5
    s_add_u32 s85, s85, s41
    s_add_u32 s81, s85, 8
    s_mul_i32 s80, s81, 2731
    s_lshr_b32 s80, s80, 16
    s_mul_i32 s86, s80, 24
    s_sub_u32 s81, s81, s86
    s_cmp_lt_u32 s80, 3
    s_cselect_b32 s82, 16, 20
    s_cselect_b32 s83, 4, 8
    s_cmp_eq_u32 s80, 0
    s_cselect_b32 s82, 8, s82
    s_cselect_b32 s83, 5, s83
    s_cselect_b32 s86, -1, 47
    s_sub_u32 s84, s81, s82
    s_cselect_b32 s46, 0, s83
    s_mul_i32 s44, s81, 6
    s_mul_i32 s40, s84, s46
    s_add_u32 s86, s86, s44
    s_add_u32 s86, s86, s40
    s_mul_i32 s86, s86, 14
    s_add_u32 s44, s86, s80
    s_mulk_i32 s44, 3072
    s_addk_i32 s44, 9024
    v_and_b32 v1, 63, v0
    s_lshl2_add_u32 s41, s41, s3
    s_mulk_i32 s41, 1296
    v_min_u32 v70, 10, v1
    s_lshl_b32 s40, s3, 6
    v_lshl_add_u32 v70, v70, 7, s41
    s_min_u32 s40, s40, 152
    v_add_u32 v144, s40, v1
    s_lshl4_add_u32 s25, s40, 61440
    v_mul_u32_u24 v64, 5462, v144
    v_lshlrev_b32 v144, 4, v144
    v_lshrrev_b32 v64, 13, v64
    v_bitop3_b32 v8, v64, 32, v144 bitop3:0x6a
    v_lshlrev_b32 v5, 4, v1
    v_and_b32 v144, 32, v1
    v_xor_b32 v7, 32, v5
    v_xor_b32 v6, v144, v5
    s_mul_i32 s24, s3, 3072
    s_mov_b32 s41, 43008
    s_mov_b32 s10, 9633792
    s_mov_b32 s11, 0x20000
    s_mov_b32 s18, 165888
    s_mov_b32 s19, s11
    s_add_u32 m0, s24, 24576
    s_waitcnt lgkmcnt(0)
    buffer_load_dword v37, v70, s[16:19], 0 offen
    buffer_load_dwordx4 v5, s[16:19], s24 offen lds
    buffer_load_dwordx4 v6, s[16:19], s24 offen offset:1024 lds
    buffer_load_dwordx4 v7, s[16:19], s24 offen offset:2048 lds
    s_mov_b32 m0, s25
    s_lshr_b32 s57, s3, 1
    buffer_load_dwordx4 v8, s[8:11], s44 offen  lds
    s_addk_i32 m0, 3456
    s_add_u32 s31, s44, s41
    buffer_load_dwordx4 v8, s[8:11], s31 offen  lds
    s_addk_i32 m0, 3456
    s_add_u32 s31, s31, s41
    buffer_load_dwordx4 v8, s[8:11], s31 offen  lds
    s_addk_i32 m0, 3456
    s_add_u32 s31, s31, s41
    buffer_load_dwordx4 v8, s[8:11], s31 offen  lds
    s_addk_i32 m0, 3456
    s_add_u32 s31, s31, s41
    buffer_load_dwordx4 v8, s[8:11], s31 offen  lds
    s_addk_i32 m0, 3456
    s_add_u32 s31, s31, s41
    buffer_load_dwordx4 v8, s[8:11], s31 offen  lds
L_issued:
    v_and_b32 v4, 48, v0
    s_add_u32 s86, s86, s80
    s_and_b32 s2, s3, 1
    s_lshl4_add_u32 s45, s86, 272
    s_mov_b32 s14, 1806336
    s_mov_b32 s15, 0x20000
    s_mov_b32 s22, 9633792
    s_mov_b32 s23, 0x20000
    s_mul_i32 s40, s2, 3072
    s_mul_i32 s26, s57, -104448
    s_add_u32 s26, s26, s40
    s_mul_i32 s27, s57, 6144
    s_add_u32 s27, s27, s40
    s_mul_i32 s28, s57, 55296
    s_add_u32 s28, s28, s40
    s_cmp_eq_u32 s46, 8
    s_cbranch_scc1 L_x
    v_mul_u32_u24 v65, 7282, v1
    s_mul_i32 s85, s82, s80
    s_mul_i32 s86, s83, 3
    v_lshrrev_b32 v65, 16, v65
    s_add_u32 s85, s85, s81
    s_sub_u32 s85, s85, s86
    v_mad_i32_i24 v66, v65, -9, v1
    s_cmp_ge_i32 s85, 92
    s_cselect_b32 s86, -168, 40
    s_cselect_b32 s47, 1, 0
    s_cselect_b32 s52, 8064, 36
    s_cselect_b32 s41, 36, 8064
    v_lshl_add_u32 v67, v65, 2, s3
    s_lshl1_add_u32 s53, s85, s86
    s_lshl3_add_u32 s86, s80, s84
    s_lshl_b32 s86, s86, 1
    v_lshlrev_b32 v71, 2, v66
    s_cmp_eq_u32 s46, 4
    s_cselect_b32 s53, s86, s53
    s_sub_u32 s86, s84, 1
    v_mad_u32_u24 v71, v67, s52, v71
    s_cmp_eq_u32 s46, 5
    s_cselect_b32 s53, s86, s53
    s_cselect_b32 s86, 0x7f000000, 0
    s_mul_i32 s40, s52, 24
    s_cmp_eq_u32 s46, 0
    s_cselect_b32 s40, s40, 0x7f000000
    s_cselect_b32 s85, 54, 36
    v_cmp_gt_u32 vcc, s85, v1
    v_mov_b32 v146, 0x7f000000
    s_mul_i32 s48, s53, s41
    s_add_u32 s49, s48, s41
    v_cndmask_b32 v71, v146, v71, vcc
    s_add_u32 s50, s48, s40
    s_add_u32 s51, s49, s40
    s_add_u32 s48, s48, s86
    v_and_b32 v2, 15, v0
    s_mul_i32 s54, s47, 42816
    s_addk_i32 s54, 192
    s_mul_i32 s40, s57, 3072
    s_add_u32 s40, s40, 146688
    v_mad_u32_u24 v23, v2, 48, s40
    s_sub_u32 s61, 43200, s54
    s_cmp_lt_u32 s45, 14784
    s_cselect_b32 s37, 0, 0x80
    s_cmp_lt_u32 s80, 2
    s_cselect_b32 s40, 0, 0x800000
    s_or_b32 s37, s37, s40
    s_or_b32 s37, s37, 0x3e003e00
    s_mul_i32 s35, s46, 3456
    s_add_u32 s35, s35, 89088
    s_add_u32 s43, s53, s57
    s_mul_i32 s76, s43, s61
    s_cmp_lg_u32 s46, 0
    s_cbranch_scc1 L_mc
    s_mov_b32 s41, 0x7f000000
    s_cmp_lt_u32 s53, 34
    s_cselect_b32 s39, 768, s41
    s_cselect_b32 s33, 6, 4
    s_subb_u32 s32, s53, 1
    s_movk_i32 s34, 9600
    s_movk_i32 s36, 50
    s_mov_b32 s38, 0x770000
    s_lshl_b32 s40, s54, 4
    s_add_u32 s75, s76, s40
    s_add_u32 s74, s75, s40
    s_add_u32 s65, s32, s3
    s_min_u32 s65, s65, 223
    s_mul_i32 s65, s65, s61
    s_add_u32 s67, s65, s40
    s_add_u32 s69, s67, s40
    s_mul_i32 s64, s3, s34
    s_add_u32 s64, s64, s35
    s_add_u32 s66, s64, 3072
    s_add_u32 s68, s64, 6144
    s_sub_u32 s43, s43, s32
    s_mul_i32 s43, s43, s34
    s_add_u32 s77, s43, 0x80015c00
    s_add_u32 s78, s77, 0x400000
    s_add_u32 s79, s77, 0x800000
    s_branch L_mc_back
L_mc:
    s_mov_b32 s39, 0x7f000000
    s_sub_u32 s33, 10, s46
    s_add_u32 s32, s53, s46
    s_sub_u32 s32, s32, 6
    s_max_i32 s32, s32, 0
    s_movk_i32 s34, 3456
    s_movk_i32 s36, 18
    s_mul_i32 s64, s3, 3456
    s_add_u32 s64, s64, 89088
    s_add_u32 s66, s64, 13824
    s_add_u32 s68, s64, 27648
    s_min_u32 s68, s68, 123648
    s_mul_i32 s40, s80, 3072
    s_add_u32 s40, s40, 9599808
    s_add_u32 s69, s3, 8
    s_mul_i32 s65, s69, s61
    s_add_u32 s65, s65, s44
    s_min_u32 s65, s65, s40
    s_add_u32 s41, s44, 516096
    s_min_u32 s41, s41, s40
    s_sub_u32 s40, s69, s46
    s_add_u32 s69, s40, s32
    s_mul_i32 s69, s69, s61
    s_sub_u32 s67, s69, 172032
    s_cmp_lt_u32 s40, 4
    s_cselect_b32 s67, s41, s67
    s_mul_i32 s40, s57, 43008
    s_add_u32 s40, s44, s40
    s_add_u32 s74, s40, 301248
    s_add_u32 s75, s40, 387264
    s_add_u32 s40, s40, 473280
    s_mul_i32 s79, s57, 3456
    s_add_u32 s79, s79, 0x80054e80
    s_add_u32 s78, s79, 6912
    s_add_u32 s41, s79, 13824
    s_sub_u32 s77, s43, s32
    s_mul_i32 s77, s77, 3456
    s_add_u32 s77, s77, s35
    s_cmp_eq_u32 s43, 0
    s_cselect_b32 s43, 0, 0x80000000
    s_or_b32 s77, s77, s43
    s_sub_u32 s38, 21, s46
    s_lshl_b32 s38, s38, 16
    s_sub_u32 s43, s46, s57
    s_cmp_eq_u32 s43, 5
    s_cselect_b32 s76, s40, s76
    s_cselect_b32 s77, s41, s77
L_mc_back:
    v_mov_b32 v84, s79
    s_mov_b32 exec_hi, 0
    v_mov_b32 v84, s78
    s_mov_b32 exec_lo, 0xffff
    v_mov_b32 v84, s77
    s_mov_b64 exec, -1
    v_bfe_u32 v155, v84, 18, 6
    v_and_b32 v148, 0x3ffff, v84
    v_ashrrev_i32 v147, 31, v84
    v_add_lshl_u32 v155, v155, v2, 3
    v_add_u32 v149, s34, v148
    v_mad_i32_i24 v147, v147, s34, v148
    v_add_u32 v154, -8, v155
    v_add_u32 v156, 8, v155
    v_max_i32 v154, 0, v154
    v_and_b32 v144, 32, v154
    v_mad_u32_u24 v144, v154, 24, v144
    v_and_b32 v145, 32, v155
    v_mad_u32_u24 v145, v155, 24, v145
    v_and_b32 v146, 32, v156
    v_mad_u32_u24 v146, v156, 24, v146
    s_cmp_eq_u32 s47, 0
    s_cbranch_scc1 L_notr
    v_swap_b32 v144, v147
    v_swap_b32 v145, v148
    v_swap_b32 v146, v149
L_notr:
    v_add_u32 v88, v147, v144
    v_add_u32 v89, v147, v145
    v_add_u32 v90, v147, v146
    v_add_u32 v91, v148, v144
    v_add_u32 v92, v148, v145
    v_add_u32 v93, v148, v146
    v_add_u32 v94, v149, v144
    v_add_u32 v95, v149, v145
    v_add_u32 v96, v149, v146
    v_mad_u32_u24 v144, v4, 48, v23
    ds_write_b128 v144, v[88:91]
    ds_write_b128 v144, v[92:95] offset:16
    ds_write_b32 v144, v96 offset:32
    v_lshrrev_b32 v3, 4, v1
    s_movk_i32 s42, 192
    v_mov_b32 v34, 158976
    v_mov_b32 v147, 0
    ds_write_b32 v34, v147
    v_bfe_u32 v144, v1, 2, 2
    v_lshl_add_u32 v144, v3, 3, v144
    v_lshrrev_b32 v145, 2, v1
    v_mul_u32_u24 v144, 192, v144
    v_bfi_b32 v145, 3, v1, v145
    s_lshl_b32 s40, s2, 5
    v_and_b32 v145, 7, v145
    v_lshl_add_u32 v144, v145, 3, v144
    v_xad_u32 v15, v144, s40, 64
    v_lshl_add_u32 v13, s2, 7, v144
    s_mul_i32 s40, s57, 10368
    v_xor_b32 v14, 32, v13
    s_add_u32 s40, s40, 61440
    s_cmp_eq_u32 s80, 10
    s_cselect_b32 s41, 16, 17
    v_add_u32 v144, 2, v2
    v_add_u32 v147, s40, v4
    v_min_u32 v144, s41, v144
    v_lshl_add_u32 v144, v144, 3, 0
    s_add_u32 m0, s24, 36864
    s_add_u32 s31, s27, 12288
    buffer_load_dwordx4 v5, s[16:19], s31 offen lds
    v_bitop3_b32 v145, v144, 32, v147 bitop3:0x6a
    v_mad_u32_u24 v18, v144, 24, v145
    v_lshl_add_u32 v144, v2, 3, 8
    v_bitop3_b32 v145, v144, 32, v147 bitop3:0x6a
    v_mad_u32_u24 v17, v144, 24, v145
    v_lshl_add_u32 v144, v2, 3, 0
    buffer_load_dwordx4 v6, s[16:19], s31 offen offset:1024 lds
    v_bitop3_b32 v145, v144, 32, v147 bitop3:0x6a
    v_mad_u32_u24 v16, v144, 24, v145
    v_mul_u32_u24 v144, 5462, v1
    s_sub_u32 s40, s54, 192
    v_lshrrev_b32 v145, 13, v144
    v_bitop3_b32 v145, v145, 32, v5 bitop3:0x6a
    buffer_load_dwordx4 v7, s[16:19], s31 offen offset:2048 lds
    v_mad_u32_u16 v9, v144, s40, v145 op_sel:[1,0,0,0]
    v_add_u32 v146, 349568, v144
    v_lshrrev_b32 v145, 13, v146
    s_waitcnt vmcnt(9)
    s_barrier
    ds_read_b64_tr_b16 a[0:1], v13 offset:24576
    ds_read_b64_tr_b16 a[2:3], v13 offset:25344
    ds_read_b64_tr_b16 a[4:5], v14 offset:24576
    ds_read_b64_tr_b16 a[6:7], v14 offset:25344
    v_bitop3_b32 v145, v145, 32, v5 bitop3:0x6a
    v_mad_u32_u16 v10, v146, s40, v145 op_sel:[1,0,0,0]
    v_add_u32 v146, 699136, v144
    buffer_load_dword v176, v71, s[12:15], s48 offen
    ds_read_b64_tr_b16 a[8:9], v15 offset:24576
    buffer_load_dword v177, v71, s[12:15], s49 offen
    ds_read_b64_tr_b16 a[10:11], v15 offset:25344
    buffer_load_dword v178, v71, s[12:15], s50 offen
    ds_read_b64_tr_b16 a[12:13], v13 offset:30720
    buffer_load_dword v179, v71, s[12:15], s51 offen
    ds_read_b64_tr_b16 a[14:15], v13 offset:31488
    s_add_u32 m0, s25, 20736
    s_add_u32 s31, s44, 258048
    buffer_load_dwordx4 v8, s[8:11], s31 offen  lds
    ds_read_b64_tr_b16 a[16:17], v14 offset:30720
    v_lshrrev_b32 v145, 13, v146
    v_bitop3_b32 v145, v145, 32, v5 bitop3:0x6a
    v_mad_u32_u16 v11, v146, s40, v145 op_sel:[1,0,0,0]
    v_add_u32 v146, 830224, v144
    v_lshrrev_b32 v145, 13, v146
    ds_read_b64_tr_b16 a[18:19], v14 offset:31488
    ds_read_b64_tr_b16 a[20:21], v15 offset:30720
    ds_read_b64_tr_b16 a[22:23], v15 offset:31488
    v_bitop3_b32 v145, v145, 32, v5 bitop3:0x6a
    s_add_u32 m0, s25, 24192
    s_add_u32 s31, s44, 301056
    buffer_load_dwordx4 v8, s[8:11], s31 offen  lds
    v_mad_u32_u16 v12, v146, s40, v145 op_sel:[1,0,0,0]
    s_cmp_eq_u32 s46, 0
    s_cselect_b64 vcc, -1, 0
    v_cndmask_b32 v50, v12, v9, vcc
    v_mul_u32_u24 v68, 11, v66
    v_lshrrev_b32 v68, 5, v68
    s_mul_i32 s31, s57, 3456
    s_add_u32 s31, s31, s24
    s_add_u32 m0, s31, 127488
    s_add_u32 s31, s28, 55296
    buffer_load_dwordx4 v5, s[16:19], s31 offen lds
    v_mad_i32_i24 v69, v68, -3, v66
    s_mov_b32 s60, 0x435f435f
    s_mov_b32 s59, 0x03020c0c
    s_cmp_eq_u32 s47, 0
    s_cselect_b32 s58, 0x01000c0c, s59
    s_cselect_b32 s59, s59, 0x01000c0c
    s_cselect_b64 vcc, -1, 0
    buffer_load_dwordx4 v6, s[16:19], s31 offen offset:1024 lds
    v_cndmask_b32 v144, v69, v68, vcc
    v_cndmask_b32 v145, v68, v69, vcc
    v_add3_u32 v144, s53, v144, -1
    v_add3_u32 v145, v67, v145, -1
    v_cvt_f32_i32 v100, v144
    v_cvt_f32_i32 v102, v145
    buffer_load_dwordx4 v7, s[16:19], s31 offen offset:2048 lds
    v_add_f32 v101, 1.0, v100
    v_add_f32 v103, 0x41c00000, v102
    s_mov_b32 s40, 0x435f0000
    v_med3_f32 v144, v100, 0, s40
    v_med3_f32 v145, v101, 0, s40
    v_med3_f32 v146, v102, 0, s40
    s_add_u32 m0, s24, 49152
    s_add_u32 s31, s28, 61440
    buffer_load_dwordx4 v5, s[16:19], s31 offen lds
    v_med3_f32 v147, v103, 0, s40
    v_cvt_pk_bf16_f32 v105, v145, v146
    v_cvt_pk_bf16_f32 v104, v144, v146
    v_cvt_pk_bf16_f32 v106, v144, v147
    v_cvt_pk_bf16_f32 v107, v145, v147
    v_mul_u32_u24 v168, 12, v67
    buffer_load_dwordx4 v6, s[16:19], s31 offen offset:1024 lds
    v_readfirstlane_b32 s41, v105
    v_add_lshl_u32 v168, v168, v66, 2
    v_lshlrev_b32 v110, 3, v0
    v_lshlrev_b32 v144, 2, v1
    v_mov_b32 v145, s41
    v_add_u32 v110, 156928, v110
    buffer_load_dwordx4 v7, s[16:19], s31 offen offset:2048 lds
    v_add_u32 v144, 148992, v144
    ds_write_b64 v110, v[144:145]
    v_add_u32 v61, 127488, v13
    v_add_u32 v62, 127488, v14
    v_add_u32 v63, 127488, v15
    v_add_u32 v174, 150912, v168
    v_add_u32 v172, 147840, v168
    v_add_u32 v170, 149760, v168
    v_add_u32 v168, 146688, v168
    v_subrev_u32 v108, 36, v1
    v_lshrrev_b32 v108, 31, v108
    v_lshlrev_b32 v111, 4, v0
    v_add_u32 v111, 152832, v111
    v_mul_u32_u24 v41, 192, v2
    v_lshlrev_b32 v40, 2, v2
    v_add_u32 v41, s24, v41
    v_and_or_b32 v109, v40, 48, v41
    v_and_or_b32 v40, v40, 56, v41
    v_mul_u32_u24 v42, 768, v4
    v_xor_b32 v28, v40, v4
    v_add_u32 v109, v109, v42
    v_xor_b32 v29, 8, v28
    s_mov_b64 exec, 0
    s_cmp_eq_u32 s3, 0
    s_cbranch_scc1 L_pgY0
    s_cmp_eq_u32 s3, 1
    s_cbranch_scc1 L_pgY1
    s_cmp_eq_u32 s3, 2
    s_cbranch_scc1 L_pgY2
L_retY:
    s_mov_b64 exec, -1
    s_waitcnt lgkmcnt(0)
    s_waitcnt vmcnt(12)
    s_barrier
    ds_read_b128 v[112:115], v16 offset:0
    ds_read_b128 v[116:119], v16 offset:3456
    ds_read_b128 v[120:123], v16 offset:6912
    ds_read_b128 v[124:127], v16 offset:64
    s_waitcnt lgkmcnt(3)
    v_mfma_f32_16x16x32_bf16 v[64:67], a[0:3], v[112:115], 0
    s_add_u32 m0, s24, 0
    ds_read_b64_tr_b16 a[24:25], v13 offset:36864
    s_add_u32 s31, s28, 67584
    ds_read_b64_tr_b16 a[26:27], v13 offset:37632
    v_mfma_f32_16x16x32_bf16 v[68:71], a[4:7], v[112:115], 0
    s_mul_i32 s72, s2, 9600
    ds_read_b64_tr_b16 a[28:29], v14 offset:36864
    buffer_load_dwordx4 v5, s[16:19], s31 offen lds
    v_mfma_f32_16x16x32_bf16 v[72:75], a[8:11], v[112:115], 0
    s_waitcnt lgkmcnt(5)
    ds_read_b64_tr_b16 a[30:31], v14 offset:37632
    s_add_u32 s72, s72, 127488
    ds_read_b64_tr_b16 a[32:33], v15 offset:36864
    v_mfma_f32_16x16x32_bf16 v[76:79], a[0:3], v[116:119], 0
    s_mul_i32 s77, s57, 1536
    ds_read_b64_tr_b16 a[34:35], v15 offset:37632
    v_mul_u32_u24 v30, 1821, v0
    v_mfma_f32_16x16x32_bf16 v[80:83], a[4:7], v[116:119], 0
    s_lshl1_add_u32 s70, s77, s72
    ds_read_b128 v[128:131], v16 offset:3520
    v_lshlrev_b32 v31, 4, v0
    v_mfma_f32_16x16x32_bf16 v[84:87], a[8:11], v[116:119], 0
    s_waitcnt lgkmcnt(7)
    ds_read_b64_tr_b16 a[36:37], v13 offset:43008
    buffer_load_dwordx4 v6, s[16:19], s31 offen offset:1024 lds
    v_mfma_f32_16x16x32_bf16 v[88:91], a[0:3], v[120:123], 0
    s_add_u32 s77, s77, s72
    ds_read_b64_tr_b16 a[38:39], v13 offset:43776
    v_lshrrev_b32 v40, 3, v1
    v_mfma_f32_16x16x32_bf16 v[92:95], a[4:7], v[120:123], 0
    s_addk_i32 s77, 4608
    ds_read_b64_tr_b16 a[40:41], v14 offset:43008
    v_lshrrev_b32 v41, 1, v1
    v_mfma_f32_16x16x32_bf16 v[96:99], a[8:11], v[120:123], 0
    s_add_u32 s73, s32, s2
    ds_read_b128 v[132:135], v16 offset:6976
    v_and_or_b32 v41, v41, 8, 32
    v_mfma_f32_16x16x32_bf16 v[64:67], a[12:15], v[124:127], v[64:67]
    s_mulk_i32 s73, 192
    ds_read_b64_tr_b16 a[42:43], v14 offset:43776
    buffer_load_dwordx4 v7, s[16:19], s31 offen offset:2048 lds
    v_mfma_f32_16x16x32_bf16 v[68:71], a[16:19], v[124:127], v[68:71]
    s_add_u32 m0, s24, 12288
    ds_read_b64_tr_b16 a[44:45], v15 offset:43008
    v_bitop3_b32 v26, v7, 48, v41 bitop3:0x6a
    v_mfma_f32_16x16x32_bf16 v[72:75], a[20:23], v[124:127], v[72:75]
    s_waitcnt lgkmcnt(5)
    ds_read_b64_tr_b16 a[46:47], v15 offset:43776
    v_xor_b32 v27, 8, v26
    v_mfma_f32_16x16x32_bf16 v[76:79], a[12:15], v[128:131], v[76:79]
    s_add_u32 s31, s28, 73728
    ds_read_b128 v[136:139], v16 offset:128
    v_lshrrev_b32 v52, 1, v4
    v_mfma_f32_16x16x32_bf16 v[80:83], a[16:19], v[128:131], v[80:83]
    s_add_u32 s73, s73, s39
    ds_read_b128 v[140:143], v16 offset:3584
    buffer_load_dwordx4 v5, s[16:19], s31 offen lds
    v_mfma_f32_16x16x32_bf16 v[84:87], a[20:23], v[128:131], v[84:87]
    s_waitcnt lgkmcnt(5)
    ds_read_b128 v[112:115], v16 offset:7040
    v_lshl_or_b32 v21, v4, 1, v52
    v_mfma_f32_16x16x32_bf16 v[88:91], a[12:15], v[132:135], v[88:91]
    s_mul_i32 s78, s57, 344064
    ds_read_b128 v[116:119], v17 offset:0
    v_and_b32 v21, 48, v21
    v_mfma_f32_16x16x32_bf16 v[92:95], a[16:19], v[132:135], v[92:95]
    s_lshl1_add_u32 s71, s78, s73
    v_lshl_add_u32 v21, s2, 7, v21
    v_mad_u32_u24 v19, v2, s42, v21
    v_mfma_f32_16x16x32_bf16 v[96:99], a[20:23], v[132:135], v[96:99]
    s_waitcnt vmcnt(7) lgkmcnt(3)
    s_barrier
    v_mfma_f32_16x16x32_bf16 v[64:67], a[24:27], v[136:139], v[64:67]
    s_lshl_b32 s6, s3, 5
    ds_read_b64_tr_b16 a[108:109], v61 offset:0
    buffer_load_dwordx4 v6, s[16:19], s31 offen offset:1024 lds
    v_mfma_f32_16x16x32_bf16 v[68:71], a[28:31], v[136:139], v[68:71]
    s_add_u32 s6, s6, 9808
    ds_read_b64_tr_b16 a[110:111], v61 offset:768
    s_add_u32 s33, s33, s32
    ds_read_b64_tr_b16 a[112:113], v62 offset:0
    v_mfma_f32_16x16x32_bf16 v[72:75], a[32:35], v[136:139], v[72:75]
    s_waitcnt lgkmcnt(4)
    ds_read_b64_tr_b16 a[114:115], v62 offset:768
    v_perm_b32 v144, v176, v176, s58
    v_mfma_f32_16x16x32_bf16 v[76:79], a[24:27], v[140:143], v[76:79]
    s_mul_i32 s40, s32, s34
    ds_read_b64_tr_b16 a[116:117], v63 offset:0
    v_perm_b32 v145, v176, v176, s59
    v_mfma_f32_16x16x32_bf16 v[80:83], a[28:31], v[140:143], v[80:83]
    s_sub_u32 s35, s35, s40
    ds_read_b64_tr_b16 a[118:119], v63 offset:768
    buffer_load_dwordx4 v7, s[16:19], s31 offen offset:2048 lds
    v_mfma_f32_16x16x32_bf16 v[84:87], a[32:35], v[140:143], v[84:87]
    s_add_u32 m0, s24, 24576
    ds_read_b128 v[120:123], v17 offset:3456
    v_perm_b32 v146, v177, v177, s58
    v_mfma_f32_16x16x32_bf16 v[88:91], a[24:27], v[112:115], v[88:91]
    s_add_u32 s31, s28, 24576
    ds_read_b64_tr_b16 a[216:217], v61 offset:9600
    v_perm_b32 v147, v177, v177, s59
    v_mfma_f32_16x16x32_bf16 v[92:95], a[28:31], v[112:115], v[92:95]
    s_add_u32 s78, s78, s73
    ds_read_b64_tr_b16 a[218:219], v61 offset:10368
    v_perm_b32 v148, v178, v178, s58
    v_mfma_f32_16x16x32_bf16 v[96:99], a[32:35], v[112:115], v[96:99]
    s_waitcnt lgkmcnt(5)
    ds_read_b64_tr_b16 a[220:221], v62 offset:9600
    buffer_load_dwordx4 v5, s[16:19], s31 offen lds
    v_mfma_f32_16x16x32_bf16 v[64:67], a[36:39], v[116:119], v[64:67]
L_pgY0:
  s_cbranch_execz L_retY
    s_add_u32 s73, s78, 1373824
    ds_read_b128 v[124:127], v17 offset:6912
    v_perm_b32 v149, v178, v178, s59
    v_mfma_f32_16x16x32_bf16 v[68:71], a[40:43], v[116:119], v[68:71]
    s_add_u32 s78, s78, 1032192
    ds_read_b64_tr_b16 a[222:223], v62 offset:10368
    v_perm_b32 v150, v179, v179, s58
    v_mfma_f32_16x16x32_bf16 v[72:75], a[44:47], v[116:119], v[72:75]
    s_waitcnt lgkmcnt(5)
    ds_read_b64_tr_b16 a[224:225], v63 offset:9600
    v_perm_b32 v151, v179, v179, s59
    v_mfma_f32_16x16x32_bf16 v[76:79], a[36:39], v[120:123], v[76:79]
    s_sub_u32 s72, s77, 896
    ds_read_b64_tr_b16 a[226:227], v63 offset:10368
    buffer_load_dwordx4 v6, s[16:19], s31 offen offset:1024 lds
    v_mfma_f32_16x16x32_bf16 v[80:83], a[40:43], v[120:123], v[80:83]
    s_cmp_eq_u32 s46, 0
    s_cselect_b32 s72, s72, s64
    ds_read_b128 v[128:131], v16 offset:3456
    v_mfma_f32_16x16x32_bf16 v[84:87], a[44:47], v[120:123], v[84:87]
    s_waitcnt lgkmcnt(4)
    ds_read_b128 v[132:135], v16 offset:6912
    v_add_f32 v144, v100, v144
    v_mfma_f32_16x16x32_bf16 v[88:91], a[36:39], v[124:127], v[88:91]
    s_cmp_eq_u32 s46, 0
    s_cselect_b32 s73, s73, s65
    v_add_f32 v145, v102, v145
    v_mfma_f32_16x16x32_bf16 v[92:95], a[40:43], v[124:127], v[92:95]
    buffer_load_dwordx4 v7, s[16:19], s31 offen offset:2048 lds
    v_mfma_f32_16x16x32_bf16 v[96:99], a[44:47], v[124:127], v[96:99]
    s_waitcnt vmcnt(6) lgkmcnt(1)
    s_barrier
    v_mfma_f32_16x16x32_bf16 v[64:67], a[108:111], v[128:131], v[64:67]
    s_add_u32 m0, s24, 36864
    ds_read_b128 v[136:139], v16 offset:10368
    v_add_f32 v146, v101, v146
    v_mfma_f32_16x16x32_bf16 v[68:71], a[112:115], v[128:131], v[68:71]
    s_add_u32 s31, s26, 135168
    ds_read_b64_tr_b16 a[120:121], v13 offset:49152
    v_add_f32 v147, v102, v147
    v_mfma_f32_16x16x32_bf16 v[72:75], a[116:119], v[128:131], v[72:75]
    s_waitcnt lgkmcnt(2)
    ds_read_b64_tr_b16 a[122:123], v13 offset:49920
    buffer_load_dwordx4 v5, s[16:19], s31 offen lds
    v_mfma_f32_16x16x32_bf16 v[76:79], a[108:111], v[132:135], v[76:79]
    s_cmp_eq_u32 s46, 0
    s_cselect_b32 s77, s77, s66
    ds_read_b64_tr_b16 a[124:125], v14 offset:49152
    v_mfma_f32_16x16x32_bf16 v[80:83], a[112:115], v[132:135], v[80:83]
    s_cmp_eq_u32 s46, 0
    s_cselect_b32 s78, s78, s67
    ds_read_b128 v[140:143], v16 offset:13824
    v_mfma_f32_16x16x32_bf16 v[84:87], a[116:119], v[132:135], v[84:87]
    s_waitcnt lgkmcnt(4)
    ds_read_b64_tr_b16 a[126:127], v14 offset:49920
    v_add_f32 v148, v100, v148
    v_mfma_f32_16x16x32_bf16 v[88:91], a[108:111], v[136:139], v[88:91]
    s_mul_i32 s56, s46, 36
    ds_read_b64_tr_b16 a[128:129], v15 offset:49152
    buffer_load_dwordx4 v6, s[16:19], s31 offen offset:1024 lds
    v_mfma_f32_16x16x32_bf16 v[92:95], a[112:115], v[136:139], v[92:95]
    s_movk_i32 s5, 7488
    ds_read_b64_tr_b16 a[130:131], v15 offset:49920
    v_mad_u32_u16 v30, v30, s5, v31 op_sel:[1,0,0,0]
    v_mfma_f32_16x16x32_bf16 v[96:99], a[116:119], v[136:139], v[96:99]
    s_addk_i32 s56, 215
    ds_read_b128 v[112:115], v16 offset:3520
    v_sub_u32 v32, s56, v0
    v_mfma_f32_16x16x32_bf16 v[64:67], a[216:219], v[132:135], v[64:67]
    s_mov_b32 s5, 56448
    ds_read_b64_tr_b16 a[228:229], v13 offset:55296
    v_add_u32 v31, -252, v32
    v_mfma_f32_16x16x32_bf16 v[68:71], a[220:223], v[132:135], v[68:71]
    s_mul_i32 s55, s45, 36
    ds_read_b64_tr_b16 a[230:231], v13 offset:56064
    buffer_load_dwordx4 v7, s[16:19], s31 offen offset:2048 lds
    v_mfma_f32_16x16x32_bf16 v[72:75], a[224:227], v[132:135], v[72:75]
    s_mul_i32 s31, s57, 3456
    ds_read_b64_tr_b16 a[232:233], v14 offset:55296
    v_and_b32 v31, 2.0, v31
    v_mfma_f32_16x16x32_bf16 v[76:79], a[216:219], v[136:139], v[76:79]
    s_add_u32 s31, s31, s24
    ds_read_b128 v[116:119], v16 offset:6976
    v_add3_u32 v31, v30, v31, s5
    v_mfma_f32_16x16x32_bf16 v[80:83], a[220:223], v[136:139], v[80:83]
    s_add_u32 m0, s31, 127488
    ds_read_b64_tr_b16 a[234:235], v14 offset:56064
    v_and_or_b32 v30, v32, 2.0, v30
    v_mfma_f32_16x16x32_bf16 v[84:87], a[224:227], v[136:139], v[84:87]
    s_waitcnt lgkmcnt(5)
    ds_read_b64_tr_b16 a[236:237], v15 offset:55296
    v_add_f32 v149, v103, v149
    v_mfma_f32_16x16x32_bf16 v[88:91], a[216:219], v[140:143], v[88:91]
    s_add_u32 s31, s28, 86016
    ds_read_b64_tr_b16 a[238:239], v15 offset:56064
    v_add_f32 v150, v101, v150
    v_mfma_f32_16x16x32_bf16 v[92:95], a[220:223], v[140:143], v[92:95]
    s_lshl_b32 s4, s3, 10
    ds_read_b128 v[120:123], v16 offset:10432
    buffer_load_dwordx4 v5, s[16:19], s31 offen lds
    v_mfma_f32_16x16x32_bf16 v[96:99], a[224:227], v[140:143], v[96:99]
    s_add_u32 s4, s4, 152832
    ds_read_b64_tr_b16 a[132:133], v13 offset:0
    v_add_f32 v151, v103, v151
    v_mfma_f32_16x16x32_bf16 v[64:67], a[120:123], v[112:115], v[64:67]
    s_add_u32 s56, s44, 43200
    ds_read_b64_tr_b16 a[134:135], v13 offset:768
    v_cvt_pk_bf16_f32 v169, v144, v145
    v_mfma_f32_16x16x32_bf16 v[68:71], a[124:127], v[112:115], v[68:71]
    ds_read_b64_tr_b16 a[136:137], v14 offset:0
    v_cvt_pk_bf16_f32 v171, v146, v147
    v_mfma_f32_16x16x32_bf16 v[72:75], a[128:131], v[112:115], v[72:75]
    s_waitcnt lgkmcnt(5)
    ds_read_b64_tr_b16 a[138:139], v14 offset:768
    buffer_load_dwordx4 v6, s[16:19], s31 offen offset:1024 lds
    v_mfma_f32_16x16x32_bf16 v[76:79], a[120:123], v[116:119], v[76:79]
    ds_read_b64_tr_b16 a[140:141], v15 offset:0
    v_cvt_pk_bf16_f32 v173, v148, v149
    v_mfma_f32_16x16x32_bf16 v[80:83], a[124:127], v[116:119], v[80:83]
    ds_read_b64_tr_b16 a[142:143], v15 offset:768
    v_cvt_pk_bf16_f32 v175, v150, v151
    v_mfma_f32_16x16x32_bf16 v[84:87], a[128:131], v[116:119], v[84:87]
    s_waitcnt lgkmcnt(5)
    ds_read_b64_tr_b16 a[240:241], v13 offset:6144
    v_pk_max_i16 v169, v169, 0
    v_mfma_f32_16x16x32_bf16 v[88:91], a[120:123], v[120:123], v[88:91]
    ds_read_b64_tr_b16 a[242:243], v13 offset:6912
    buffer_load_dwordx4 v7, s[16:19], s31 offen offset:2048 lds
    v_mfma_f32_16x16x32_bf16 v[92:95], a[124:127], v[120:123], v[92:95]
    s_mov_b32 m0, s64
    ds_read_b64_tr_b16 a[244:245], v14 offset:6144
    v_pk_max_i16 v171, v171, 0
    v_mfma_f32_16x16x32_bf16 v[96:99], a[128:131], v[120:123], v[96:99]
    ds_read_b128 v[124:127], v16 offset:13888
    v_pk_max_i16 v173, v173, 0
    v_mfma_f32_16x16x32_bf16 v[64:67], a[228:231], v[116:119], v[64:67]
    ds_read_b64_tr_b16 a[246:247], v14 offset:6912
    v_pk_max_i16 v175, v175, 0
    v_mfma_f32_16x16x32_bf16 v[68:71], a[232:235], v[116:119], v[68:71]
    ds_read_b64_tr_b16 a[248:249], v15 offset:6144
    buffer_load_dwordx4 v9, s[8:11], s65 offen  lds
    v_mfma_f32_16x16x32_bf16 v[72:75], a[236:239], v[116:119], v[72:75]
    ds_read_b64_tr_b16 a[250:251], v15 offset:6912
    v_pk_min_i16 v169, v169, s60
    v_mfma_f32_16x16x32_bf16 v[76:79], a[228:231], v[120:123], v[76:79]
    ds_read_b128 v[128:131], v16 offset:3584
    v_pk_min_i16 v171, v171, s60
    v_mfma_f32_16x16x32_bf16 v[80:83], a[232:235], v[120:123], v[80:83]
    ds_read_b128 v[132:135], v16 offset:7040
    v_pk_min_i16 v173, v173, s60
    v_mfma_f32_16x16x32_bf16 v[84:87], a[236:239], v[120:123], v[84:87]
    s_waitcnt lgkmcnt(5)
    ds_read_b128 v[136:139], v16 offset:10496
    buffer_load_dwordx4 v10, s[8:11], s65 offen offset:1024  lds
    v_mfma_f32_16x16x32_bf16 v[88:91], a[228:231], v[124:127], v[88:91]
    v_pk_min_i16 v175, v175, s60
    v_cmp_ne_u16_e64 s[80:81], v169, v104
    v_mfma_f32_16x16x32_bf16 v[92:95], a[232:235], v[124:127], v[92:95]
    v_cmp_ne_u16_sdwa s[88:89], v169, v104 src0_sel:WORD_1 src1_sel:WORD_1
    v_cmp_ne_u16_e64 s[82:83], v171, v105
    v_mfma_f32_16x16x32_bf16 v[96:99], a[236:239], v[124:127], v[96:99]
    s_waitcnt vmcnt(8) lgkmcnt(2)
    s_barrier
    v_mfma_f32_16x16x32_bf16 v[64:67], a[132:135], v[128:131], v[64:67]
    s_xor_b64 s[80:81], s[80:81], s[88:89]
    ds_read_b64_tr_b16 a[144:145], v13 offset:12288
    buffer_load_dwordx4 v11, s[8:11], s65 offen offset:2048  lds
    v_mfma_f32_16x16x32_bf16 v[68:71], a[136:139], v[128:131], v[68:71]
    s_mov_b32 m0, s66
    ds_read_b64_tr_b16 a[146:147], v13 offset:13056
    v_cmp_ne_u16_sdwa s[90:91], v171, v105 src0_sel:WORD_1 src1_sel:WORD_1
    v_mfma_f32_16x16x32_bf16 v[72:75], a[140:143], v[128:131], v[72:75]
    s_waitcnt lgkmcnt(2)
    ds_read_b64_tr_b16 a[148:149], v14 offset:12288
    v_cmp_ne_u16_e64 s[84:85], v173, v106
    v_mfma_f32_16x16x32_bf16 v[76:79], a[132:135], v[132:135], v[76:79]
    ds_read_b128 v[140:143], v16 offset:13952
    v_cmp_ne_u16_sdwa s[92:93], v173, v106 src0_sel:WORD_1 src1_sel:WORD_1
    v_mfma_f32_16x16x32_bf16 v[80:83], a[136:139], v[132:135], v[80:83]
    ds_read_b64_tr_b16 a[150:151], v14 offset:13056
    buffer_load_dwordx4 v9, s[8:11], s67 offen  lds
    v_mfma_f32_16x16x32_bf16 v[84:87], a[140:143], v[132:135], v[84:87]
    s_andn2_b64 s[88:89], s[88:89], s[80:81]
    ds_read_b64_tr_b16 a[152:153], v15 offset:12288
    v_cmp_ne_u16_e64 s[86:87], v175, v107
    v_mfma_f32_16x16x32_bf16 v[88:91], a[132:135], v[136:139], v[88:91]
    ds_read_b64_tr_b16 a[154:155], v15 offset:13056
    v_cmp_ne_u16_sdwa s[94:95], v175, v107 src0_sel:WORD_1 src1_sel:WORD_1
    v_mfma_f32_16x16x32_bf16 v[92:95], a[136:139], v[136:139], v[92:95]
    ds_read_b128 v[112:115], v17 offset:3456
    v_mbcnt_lo_u32_b32 v148, s88, 0
    v_mfma_f32_16x16x32_bf16 v[96:99], a[140:143], v[136:139], v[96:99]
    s_xor_b64 s[82:83], s[82:83], s[90:91]
    ds_read_b64_tr_b16 a[252:253], v13 offset:18432
    buffer_load_dwordx4 v10, s[8:11], s67 offen offset:1024  lds
    v_mfma_f32_16x16x32_bf16 v[64:67], a[240:243], v[132:135], v[64:67]
    s_andn2_b64 s[90:91], s[90:91], s[82:83]
    ds_read_b64_tr_b16 a[254:255], v13 offset:19200
    v_mbcnt_lo_u32_b32 v149, s90, 0
    v_mfma_f32_16x16x32_bf16 v[68:71], a[244:247], v[132:135], v[68:71]
    s_xor_b64 s[84:85], s[84:85], s[92:93]
    ds_read_b64_tr_b16 v[188:189], v14 offset:18432
    v_mbcnt_hi_u32_b32 v148, s89, v148
    v_mfma_f32_16x16x32_bf16 v[72:75], a[248:251], v[132:135], v[72:75]
    s_andn2_b64 s[92:93], s[92:93], s[84:85]
    ds_read_b128 v[116:119], v17 offset:6912
    v_mbcnt_lo_u32_b32 v150, s92, 0
    v_mfma_f32_16x16x32_bf16 v[76:79], a[240:243], v[136:139], v[76:79]
    s_xor_b64 s[86:87], s[86:87], s[94:95]
    ds_read_b64_tr_b16 v[190:191], v14 offset:19200
    buffer_load_dwordx4 v11, s[8:11], s67 offen offset:2048  lds
    v_mfma_f32_16x16x32_bf16 v[80:83], a[244:247], v[136:139], v[80:83]
    s_add_u32 m0, s24, 49152
    ds_read_b64_tr_b16 v[192:193], v15 offset:18432
    v_mbcnt_hi_u32_b32 v149, s91, v149
    v_mfma_f32_16x16x32_bf16 v[84:87], a[248:251], v[136:139], v[84:87]
    s_waitcnt lgkmcnt(5)
    ds_read_b64_tr_b16 v[194:195], v15 offset:19200
    v_mbcnt_hi_u32_b32 v150, s93, v150
    v_mfma_f32_16x16x32_bf16 v[88:91], a[240:243], v[140:143], v[88:91]
    s_add_u32 s31, s28, 36864
    ds_read_b128 v[120:123], v17 offset:10368
    v_mbcnt_lo_u32_b32 v144, s80, 0
    v_mfma_f32_16x16x32_bf16 v[92:95], a[244:247], v[140:143], v[92:95]
    s_andn2_b64 s[94:95], s[94:95], s[86:87]
    ds_read_b64_tr_b16 a[48:49], v13 offset:24576
    buffer_load_dwordx4 v5, s[16:19], s31 offen lds
    v_mfma_f32_16x16x32_bf16 v[96:99], a[248:251], v[140:143], v[96:99]
    s_bcnt1_i32_b64 s48, s[88:89]
    ds_read_b64_tr_b16 a[50:51], v13 offset:25344
    v_mbcnt_lo_u32_b32 v151, s94, 0
    v_mfma_f32_16x16x32_bf16 v[64:67], a[144:147], v[112:115], v[64:67]
    s_bcnt1_i32_b64 s49, s[90:91]
    ds_read_b64_tr_b16 a[52:53], v14 offset:24576
    v_mbcnt_hi_u32_b32 v151, s95, v151
    v_mfma_f32_16x16x32_bf16 v[68:71], a[148:151], v[112:115], v[68:71]
    s_bcnt1_i32_b64 s50, s[92:93]
    ds_read_b64_tr_b16 a[54:55], v14 offset:25344
    v_mbcnt_lo_u32_b32 v145, s82, 0
    v_mfma_f32_16x16x32_bf16 v[72:75], a[152:155], v[112:115], v[72:75]
    s_waitcnt lgkmcnt(5)
    ds_read_b64_tr_b16 a[56:57], v15 offset:24576
    buffer_load_dwordx4 v6, s[16:19], s31 offen offset:1024 lds
    v_mfma_f32_16x16x32_bf16 v[76:79], a[144:147], v[116:119], v[76:79]
    s_bcnt1_i32_b64 s51, s[94:95]
    ds_read_b64_tr_b16 a[58:59], v15 offset:25344
    v_mbcnt_lo_u32_b32 v146, s84, 0
    v_mfma_f32_16x16x32_bf16 v[80:83], a[148:151], v[116:119], v[80:83]
    s_lshr_b32 s52, s89, 4
    ds_read_b64_tr_b16 a[156:157], v13 offset:30720
    v_mbcnt_lo_u32_b32 v147, s86, 0
    v_mfma_f32_16x16x32_bf16 v[84:87], a[152:155], v[116:119], v[84:87]
    s_waitcnt lgkmcnt(5)
    ds_read_b64_tr_b16 a[158:159], v13 offset:31488
    v_mbcnt_hi_u32_b32 v144, s81, v144
    v_mfma_f32_16x16x32_bf16 v[88:91], a[144:147], v[120:123], v[88:91]
    s_lshr_b32 s61, s91, 4
    ds_read_b64_tr_b16 a[160:161], v14 offset:30720
    buffer_load_dwordx4 v7, s[16:19], s31 offen offset:2048 lds
    v_mfma_f32_16x16x32_bf16 v[92:95], a[148:151], v[120:123], v[92:95]
    s_add_u32 m0, s24, 0
    ds_read_b128 v[124:127], v17 offset:13824
    v_mbcnt_hi_u32_b32 v145, s83, v145
    v_mfma_f32_16x16x32_bf16 v[96:99], a[152:155], v[120:123], v[96:99]
    s_add_u32 s31, s26, 147456
    ds_read_b64_tr_b16 a[162:163], v14 offset:31488
    v_mbcnt_hi_u32_b32 v146, s85, v146
    v_mfma_f32_16x16x32_bf16 v[64:67], a[252:255], v[116:119], v[64:67]
    s_bcnt1_i32_b32 s52, s52
    ds_read_b64_tr_b16 a[164:165], v15 offset:30720
    v_mbcnt_hi_u32_b32 v147, s87, v147
    v_mfma_f32_16x16x32_bf16 v[68:71], v[188:191], v[116:119], v[68:71]
    s_bcnt1_i32_b32 s61, s61
    ds_read_b64_tr_b16 a[166:167], v15 offset:31488
    buffer_load_dwordx4 v5, s[16:19], s31 offen lds
    v_mfma_f32_16x16x32_bf16 v[72:75], v[192:195], v[116:119], v[72:75]
    s_add_u32 s51, s51, s50
    ds_read_b128 v[128:131], v17 offset:64
    v_mad_i32_i24 v148, 32, v108, v148
    v_mfma_f32_16x16x32_bf16 v[76:79], a[252:255], v[120:123], v[76:79]
    s_add_u32 s43, s48, s49
    ds_read_b128 v[132:135], v17 offset:3520
    v_lshl_add_u32 v40, v40, 4, s4
    v_mfma_f32_16x16x32_bf16 v[80:83], v[188:191], v[120:123], v[80:83]
    s_add_u32 s43, s43, s51
    ds_read_b128 v[136:139], v17 offset:6976
    v_and_or_b32 v24, v1, 4, v40
    v_mfma_f32_16x16x32_bf16 v[84:87], v[192:195], v[120:123], v[84:87]
    s_waitcnt lgkmcnt(5)
    buffer_load_dwordx4 v6, s[16:19], s31 offen offset:1024 lds
    v_mfma_f32_16x16x32_bf16 v[88:91], a[252:255], v[124:127], v[88:91]
    s_add_u32 s51, s51, s52
    v_lshl_add_u32 v25, v2, 4, s4
    v_lshl_add_u32 v53, s2, 2, v3
    v_mfma_f32_16x16x32_bf16 v[92:95], v[188:191], v[124:127], v[92:95]
    s_add_u32 s51, s51, s61
    v_lshrrev_b32 v52, 1, v2
    v_bitop3_b32 v52, v52, 6, v53 bitop3:0x6a
    v_mfma_f32_16x16x32_bf16 v[96:99], v[192:195], v[124:127], v[96:99]
    s_waitcnt vmcnt(11) lgkmcnt(2)
    s_barrier
    v_mfma_f32_16x16x32_bf16 v[64:67], a[48:51], v[128:131], v[64:67]
    s_lshl_b32 s96, s51, 1
    ds_read_b64_tr_b16 v[196:197], v13 offset:36864
    buffer_load_dwordx4 v7, s[16:19], s31 offen offset:2048 lds
    v_mfma_f32_16x16x32_bf16 v[68:71], a[52:55], v[128:131], v[68:71]
    s_mov_b32 m0, s68
    ds_read_b64_tr_b16 v[198:199], v13 offset:37632
    v_lshl_add_u32 v52, v2, 3, v52
    v_mfma_f32_16x16x32_bf16 v[72:75], a[56:59], v[128:131], v[72:75]
    s_waitcnt lgkmcnt(2)
    ds_read_b64_tr_b16 v[200:201], v14 offset:36864
    v_mad_u32_u24 v21, v2, s54, v21
    v_mfma_f32_16x16x32_bf16 v[76:79], a[48:51], v[132:135], v[76:79]
    s_lshl_b32 s43, s43, 1
    ds_read_b128 v[140:143], v17 offset:10432
    v_lshlrev_b32 v39, 3, v0
    v_mfma_f32_16x16x32_bf16 v[80:83], a[52:55], v[132:135], v[80:83]
    s_sub_u32 s40, 64, s43
    ds_read_b64_tr_b16 v[202:203], v14 offset:37632
    buffer_load_dwordx4 v9, s[8:11], s69 offen  lds
    v_mfma_f32_16x16x32_bf16 v[84:87], a[56:59], v[132:135], v[84:87]
    s_add_u32 s41, s6, s52
    ds_read_b64_tr_b16 v[204:205], v15 offset:36864
    v_mad_i32_i24 v144, s40, v108, v144
    v_mfma_f32_16x16x32_bf16 v[88:91], a[48:51], v[136:139], v[88:91]
    s_sub_u32 s52, 32, s48
    ds_read_b64_tr_b16 v[206:207], v15 offset:37632
    v_mad_i32_i24 v149, s52, v108, v149
    v_mfma_f32_16x16x32_bf16 v[92:95], a[52:55], v[136:139], v[92:95]
    s_sub_u32 s48, s41, s48
    ds_read_b64_tr_b16 a[60:61], v13 offset:43008
    v_add_lshl_u32 v148, v148, s48, 4
    v_mfma_f32_16x16x32_bf16 v[96:99], a[56:59], v[136:139], v[96:99]
    s_bcnt1_i32_b64 s7, s[80:81]
    ds_read_b64_tr_b16 a[62:63], v13 offset:43776
    buffer_load_dwordx4 v10, s[8:11], s69 offen offset:1024  lds
    v_mfma_f32_16x16x32_bf16 v[64:67], a[156:159], v[132:135], v[64:67]
    s_bcnt1_i32_b64 s59, s[82:83]
    ds_read_b64_tr_b16 a[64:65], v14 offset:43008
    v_lshrrev_b32 v22, 1, v0
    v_mfma_f32_16x16x32_bf16 v[68:71], a[160:163], v[132:135], v[68:71]
    s_bcnt1_i32_b64 s79, s[84:85]
    ds_read_b64_tr_b16 a[66:67], v14 offset:43776
    v_bitop3_b32 v22, v22, 48, v39 bitop3:0x6a
    v_mfma_f32_16x16x32_bf16 v[72:75], a[164:167], v[132:135], v[72:75]
    s_bcnt1_i32_b64 s62, s[86:87]
    ds_read_b64_tr_b16 a[68:69], v15 offset:43008
    v_bfe_u32 v37, v0, 3, 4
    v_mfma_f32_16x16x32_bf16 v[76:79], a[156:159], v[136:139], v[76:79]
    s_lshr_b32 s29, s81, 4
    ds_read_b64_tr_b16 a[70:71], v15 offset:43776
    buffer_load_dwordx4 v11, s[8:11], s69 offen offset:2048  lds
    v_mfma_f32_16x16x32_bf16 v[80:83], a[160:163], v[136:139], v[80:83]
    s_lshr_b32 s30, s83, 4
    ds_read_b128 v[112:115], v17 offset:13888
    v_and_or_b32 v22, v22, 56, 64
    v_mfma_f32_16x16x32_bf16 v[84:87], a[164:167], v[136:139], v[84:87]
    s_waitcnt lgkmcnt(5)
    ds_read_b64_tr_b16 a[168:169], v61 offset:0
    v_mad_u32_u24 v20, v37, s42, v22
    v_mfma_f32_16x16x32_bf16 v[88:91], a[156:159], v[140:143], v[88:91]
    s_bcnt1_i32_b32 s29, s29
    ds_read_b64_tr_b16 a[170:171], v61 offset:768
    v_mad_u32_u24 v22, v37, s54, v22
    v_mfma_f32_16x16x32_bf16 v[92:95], a[160:163], v[140:143], v[92:95]
    s_bcnt1_i32_b32 s30, s30
    ds_read_b64_tr_b16 a[172:173], v62 offset:0
    buffer_load_dwordx4 v12, s[8:11], s69 offen offset:2432  lds
    v_mfma_f32_16x16x32_bf16 v[96:99], a[164:167], v[140:143], v[96:99]
    s_mov_b32 m0, s72
    ds_read_b128 v[116:119], v17 offset:128
    s_add_u32 s62, s62, s79
    v_mfma_f32_16x16x32_bf16 v[64:67], v[196:199], v[136:139], v[64:67]
    s_add_u32 s63, s7, s59
    ds_read_b64_tr_b16 a[174:175], v62 offset:768
    s_add_u32 s63, s63, s62
    v_mfma_f32_16x16x32_bf16 v[68:71], v[200:203], v[136:139], v[68:71]
    s_add_u32 s62, s62, s29
    ds_read_b64_tr_b16 a[176:177], v63 offset:0
    s_add_u32 s62, s62, s30
    v_mfma_f32_16x16x32_bf16 v[72:75], v[204:207], v[136:139], v[72:75]
    s_lshl1_add_u32 s6, s6, s96
    ds_read_b64_tr_b16 a[178:179], v63 offset:768
    buffer_load_dwordx4 v50, s[8:11], s73 offen offset:2432  lds
    v_mfma_f32_16x16x32_bf16 v[76:79], v[196:199], v[140:143], v[76:79]
    s_mov_b32 m0, s77
    ds_read_b128 v[120:123], v17 offset:3584
    s_add_u32 s62, s62, s96
    v_mfma_f32_16x16x32_bf16 v[80:83], v[200:203], v[140:143], v[80:83]
    s_add_u32 s6, s6, s29
    ds_read_b64_tr_b16 v[208:209], v61 offset:9600
    s_sub_u32 s29, s40, s7
    v_mfma_f32_16x16x32_bf16 v[84:87], v[204:207], v[140:143], v[84:87]
    s_waitcnt lgkmcnt(5)
    ds_read_b64_tr_b16 v[210:211], v61 offset:10368
    v_mad_i32_i24 v145, s29, v108, v145
    v_mfma_f32_16x16x32_bf16 v[88:91], v[196:199], v[112:115], v[88:91]
    s_sub_u32 s7, s6, s7
    ds_read_b64_tr_b16 v[212:213], v62 offset:9600
    buffer_load_dwordx4 v12, s[8:11], s78 offen offset:2432  lds
    v_mfma_f32_16x16x32_bf16 v[92:95], v[200:203], v[112:115], v[92:95]
    s_add_u32 m0, s24, 12288
    ds_read_b128 v[124:127], v17 offset:7040
    v_add_lshl_u32 v144, v144, s7, 3
    v_mfma_f32_16x16x32_bf16 v[96:99], v[204:207], v[112:115], v[96:99]
    s_add_u32 s31, s28, 98304
    ds_read_b64_tr_b16 v[214:215], v62 offset:10368
    s_sub_u32 s97, s43, s96
    v_mfma_f32_16x16x32_bf16 v[64:67], a[60:63], v[116:119], v[64:67]
    s_sub_u32 s43, 64, s97
    ds_read_b64_tr_b16 v[216:217], v63 offset:9600
    s_bfm_b64 s[98:99], s96, 0
    v_mfma_f32_16x16x32_bf16 v[68:71], a[64:67], v[116:119], v[68:71]
    s_bfm_b64 vcc, s97, s43
    ds_read_b64_tr_b16 v[218:219], v63 offset:10368
    buffer_load_dwordx4 v5, s[16:19], s31 offen lds
    v_mfma_f32_16x16x32_bf16 v[72:75], a[68:71], v[116:119], v[72:75]
    s_waitcnt lgkmcnt(5)
    s_or_b64 s[98:99], s[98:99], vcc
    s_add_u32 s41, s41, s61
    v_mfma_f32_16x16x32_bf16 v[76:79], a[60:63], v[120:123], v[76:79]
    s_cmp_gt_u32 s62, 32
    s_cselect_b32 s63, 65, s63
    ds_read_b128 v[128:131], v17 offset:10496
    v_mfma_f32_16x16x32_bf16 v[80:83], a[64:67], v[120:123], v[80:83]
    s_cmp_ge_i32 s63, s40
    s_cbranch_scc1 L_bfail1
L_bfail1_back:
    v_mfma_f32_16x16x32_bf16 v[84:87], a[68:71], v[120:123], v[84:87]
    s_waitcnt lgkmcnt(3)
    buffer_load_dwordx4 v6, s[16:19], s31 offen offset:1024 lds
    v_mfma_f32_16x16x32_bf16 v[88:91], a[60:63], v[124:127], v[88:91]
    s_sub_u32 s49, s41, s49
    v_cndmask_b32 v144, v111, v144, s[80:81]
    v_cndmask_b32 v144, v144, v148, s[88:89]
    v_mfma_f32_16x16x32_bf16 v[92:95], a[64:67], v[124:127], v[92:95]
    s_add_u32 s6, s6, s30
    ds_write_b64 v144, v[168:169]
    v_mfma_f32_16x16x32_bf16 v[96:99], a[68:71], v[124:127], v[96:99]
    s_waitcnt vmcnt(8) lgkmcnt(2)
    s_barrier
    v_mfma_f32_16x16x32_bf16 v[64:67], a[168:171], v[120:123], v[64:67]
    s_sub_u32 s59, s6, s59
    ds_read_b64_tr_b16 a[72:73], v13 offset:49152
    v_add_lshl_u32 v149, v149, s49, 4
    v_mfma_f32_16x16x32_bf16 v[68:71], a[172:175], v[120:123], v[68:71]
    s_add_u32 s50, s50, s41
    ds_read_b64_tr_b16 a[74:75], v13 offset:49920
    v_add_lshl_u32 v145, v145, s59, 3
    v_mfma_f32_16x16x32_bf16 v[72:75], a[176:179], v[120:123], v[72:75]
    s_add_u32 s79, s79, s6
    ds_read_b64_tr_b16 a[76:77], v14 offset:49152
    v_cndmask_b32 v145, v111, v145, s[82:83]
    v_mfma_f32_16x16x32_bf16 v[76:79], a[168:171], v[124:127], v[76:79]
    s_lshl_b32 s4, s57, 10
    ds_read_b128 v[132:135], v17 offset:13952
    buffer_load_dwordx4 v7, s[16:19], s31 offen offset:2048 lds
    v_mfma_f32_16x16x32_bf16 v[80:83], a[172:175], v[124:127], v[80:83]
    s_add_u32 m0, s24, 24576
    ds_read_b64_tr_b16 a[78:79], v14 offset:49920
    v_cndmask_b32 v145, v145, v149, s[90:91]
    v_mfma_f32_16x16x32_bf16 v[84:87], a[176:179], v[124:127], v[84:87]
    s_waitcnt lgkmcnt(5)
    ds_write_b64 v145, v[170:171]
    v_mfma_f32_16x16x32_bf16 v[88:91], a[168:171], v[128:131], v[88:91]
    s_add_u32 s31, s28, 49152
    ds_read_b64_tr_b16 a[80:81], v15 offset:49152
    v_mfma_f32_16x16x32_bf16 v[92:95], a[172:175], v[128:131], v[92:95]
    s_and_b32 s82, s98, 0x55555555
    ds_read_b64_tr_b16 a[82:83], v15 offset:49920
    v_add_lshl_u32 v150, v150, s41, 4
    v_mfma_f32_16x16x32_bf16 v[96:99], a[176:179], v[128:131], v[96:99]
    s_and_b32 s83, s99, 0x55555555
    ds_read_b128 v[136:139], v18 offset:0
    v_add_lshl_u32 v146, v146, s6, 3
    v_mfma_f32_16x16x32_bf16 v[64:67], v[208:211], v[124:127], v[64:67]
    s_andn2_b64 s[80:81], s[98:99], s[82:83]
    ds_read_b128 v[140:143], v18 offset:3456
    v_cndmask_b32 v146, v111, v146, s[84:85]
    v_mfma_f32_16x16x32_bf16 v[68:71], v[212:215], v[124:127], v[68:71]
    s_not_b64 vcc, s[80:81]
    ds_read_b64_tr_b16 a[180:181], v13 offset:55296
    buffer_load_dwordx4 v5, s[16:19], s31 offen lds
    v_mfma_f32_16x16x32_bf16 v[72:75], v[216:219], v[124:127], v[72:75]
    s_mov_b32 s88, 0x00040001
    ds_read_b64_tr_b16 a[182:183], v13 offset:56064
    v_cndmask_b32 v146, v146, v150, s[92:93]
    v_mfma_f32_16x16x32_bf16 v[76:79], v[208:211], v[128:131], v[76:79]
    s_mov_b32 s89, 0x00400010
    ds_write_b64 v146, v[172:173]
    v_mfma_f32_16x16x32_bf16 v[80:83], v[212:215], v[128:131], v[80:83]
    s_lshl_b64 s[90:91], s[88:89], 1
    ds_read_b64_tr_b16 a[184:185], v14 offset:55296
    v_mfma_f32_16x16x32_bf16 v[84:87], v[216:219], v[128:131], v[84:87]
    s_waitcnt lgkmcnt(5)
    ds_read_b128 v[112:115], v18 offset:6912
    v_add_lshl_u32 v151, v151, s50, 4
    v_mfma_f32_16x16x32_bf16 v[88:91], v[208:211], v[132:135], v[88:91]
    s_lshl_b64 s[92:93], s[88:89], 8
    ds_read_b64_tr_b16 a[186:187], v14 offset:56064
    s_mov_b32 s96, 0x7fff7fff
    ds_read_b64_tr_b16 a[188:189], v15 offset:55296
    v_mfma_f32_16x16x32_bf16 v[92:95], v[212:215], v[132:135], v[92:95]
    ds_read_b64_tr_b16 a[190:191], v15 offset:56064
    v_add_lshl_u32 v147, v147, s79, 3
    v_mfma_f32_16x16x32_bf16 v[96:99], v[216:219], v[132:135], v[96:99]
    ds_read_b64_tr_b16 v[220:221], v13 offset:0
    buffer_load_dwordx4 v6, s[16:19], s31 offen offset:1024 lds
    v_mfma_f32_16x16x32_bf16 v[64:67], a[72:75], v[136:139], v[64:67]
    ds_read_b64_tr_b16 v[222:223], v13 offset:768
    v_cndmask_b32 v147, v111, v147, s[86:87]
    v_mfma_f32_16x16x32_bf16 v[68:71], a[76:79], v[136:139], v[68:71]
    ds_read_b64_tr_b16 v[224:225], v14 offset:0
    v_cndmask_b32 v147, v147, v151, s[94:95]
    v_mfma_f32_16x16x32_bf16 v[72:75], a[80:83], v[136:139], v[72:75]
    s_waitcnt lgkmcnt(6)
    ds_write_b64 v147, v[174:175]
    v_mfma_f32_16x16x32_bf16 v[76:79], a[72:75], v[140:143], v[76:79]
    s_lshl_b64 s[94:95], s[88:89], 9
    ds_read_b64 v[144:145], v110
    v_mfma_f32_16x16x32_bf16 v[80:83], a[76:79], v[140:143], v[80:83]
    ds_read_b128 v[116:119], v18 offset:10368
    v_lshl_add_u32 v38, v52, 3, s4
    v_mfma_f32_16x16x32_bf16 v[84:87], a[80:83], v[140:143], v[84:87]
    s_mul_i32 s4, s57, 129024
    ds_read_b64_tr_b16 v[226:227], v14 offset:768
    s_add_u32 s56, s56, s4
    v_mfma_f32_16x16x32_bf16 v[88:91], a[72:75], v[112:115], v[88:91]
    s_add_u32 s4, s56, 43008
    ds_read_b64_tr_b16 v[228:229], v15 offset:0
    buffer_load_dwordx4 v7, s[16:19], s31 offen offset:2048 lds
    v_mfma_f32_16x16x32_bf16 v[92:95], a[76:79], v[112:115], v[92:95]
    s_mov_b32 m0, s70
    ds_read_b64_tr_b16 v[230:231], v15 offset:768
    s_add_u32 s5, s56, 86016
    ds_read_b64_tr_b16 a[84:85], v13 offset:6144
    v_mfma_f32_16x16x32_bf16 v[96:99], a[80:83], v[112:115], v[96:99]
    s_waitcnt lgkmcnt(6)
    ds_read_b64_tr_b16 a[86:87], v13 offset:6912
    v_mfma_f32_16x16x32_bf16 v[64:67], a[180:183], v[140:143], v[64:67]
    ds_read_b64_tr_b16 a[88:89], v14 offset:6144
    v_mfma_f32_16x16x32_bf16 v[68:71], a[184:187], v[140:143], v[68:71]
    ds_read_b64_tr_b16 a[90:91], v14 offset:6912
    buffer_load_dwordx4 v9, s[8:11], s71 offen  lds
    v_mfma_f32_16x16x32_bf16 v[72:75], a[188:191], v[140:143], v[72:75]
    s_waitcnt lgkmcnt(6)
    ds_write_b32 v144, v109
    v_mfma_f32_16x16x32_bf16 v[76:79], a[180:183], v[112:115], v[76:79]
    ds_read_b128 v[120:123], v18 offset:13824
    ds_read_b64_tr_b16 a[92:93], v15 offset:6144
    v_mfma_f32_16x16x32_bf16 v[80:83], a[184:187], v[112:115], v[80:83]
    ds_read_b64_tr_b16 a[94:95], v15 offset:6912
    v_cndmask_b32_dpp v145, v145, v145, vcc quad_perm:[0,0,2,2] row_mask:0xf bank_mask:0xf
    v_mfma_f32_16x16x32_bf16 v[84:87], a[188:191], v[112:115], v[84:87]
    v_lshlrev_b32 v146, 16, v145
    v_and_b32 v147, 0xffff0000, v145
    v_mfma_f32_16x16x32_bf16 v[88:91], a[180:183], v[116:119], v[88:91]
    ds_read_b128 v[124:127], v18 offset:64
    v_ceil_f32 v149, v146
    v_mfma_f32_16x16x32_bf16 v[92:95], a[184:187], v[116:119], v[92:95]
    buffer_load_dwordx4 v10, s[8:11], s71 offen offset:1024  lds
    v_mfma_f32_16x16x32_bf16 v[96:99], a[188:191], v[116:119], v[96:99]
    s_waitcnt vmcnt(2) lgkmcnt(4)
    s_barrier
    v_mfma_f32_16x16x32_bf16 v[64:67], v[220:223], v[112:115], v[64:67]
    ds_read_b128 v[128:131], v18 offset:3520
    ds_read_b64_tr_b16 a[192:193], v13 offset:12288
    v_mfma_f32_16x16x32_bf16 v[68:71], v[224:227], v[112:115], v[68:71]
    ds_read_b64_tr_b16 a[194:195], v13 offset:13056
    ds_read_b64_tr_b16 a[196:197], v14 offset:12288
    v_mfma_f32_16x16x32_bf16 v[72:75], v[228:231], v[112:115], v[72:75]
    ds_read_b64_tr_b16 a[198:199], v14 offset:13056
    buffer_load_dwordx4 v11, s[8:11], s71 offen offset:2048  lds
    v_mfma_f32_16x16x32_bf16 v[76:79], v[220:223], v[116:119], v[76:79]
    s_lshl_b32 s31, s2, 5
    ds_read_b128 v[132:135], v18 offset:6976
    ds_read_b64_tr_b16 a[200:201], v15 offset:12288
    v_mfma_f32_16x16x32_bf16 v[80:83], v[224:227], v[116:119], v[80:83]
L_pgY1:
  s_cbranch_execz L_retY
    ds_read_b64_tr_b16 a[202:203], v15 offset:13056
    ds_read_b64_tr_b16 v[232:233], v13 offset:18432
    v_mfma_f32_16x16x32_bf16 v[84:87], v[228:231], v[116:119], v[84:87]
    s_waitcnt lgkmcnt(9)
    ds_read_b64_tr_b16 v[234:235], v13 offset:19200
    v_xor_b32 v5, s31, v5
    v_mfma_f32_16x16x32_bf16 v[88:91], v[220:223], v[120:123], v[88:91]
    s_lshr_b32 s31, s24, 1
    ds_read_b64_tr_b16 v[236:237], v14 offset:18432
    v_ceil_f32 v151, v147
    v_mfma_f32_16x16x32_bf16 v[92:95], v[224:227], v[120:123], v[92:95]
    s_add_u32 m0, s31, 36864
    ds_read_b64_tr_b16 v[238:239], v14 offset:19200
    v_cvt_u32_f32 v148, v146
    v_mfma_f32_16x16x32_bf16 v[96:99], v[228:231], v[120:123], v[96:99]
    s_add_u32 s31, s31, 159744
    ds_read_b64_tr_b16 v[240:241], v15 offset:18432
    v_cvt_u32_f32 v150, v147
    v_mfma_f32_16x16x32_bf16 v[64:67], a[84:87], v[124:127], v[64:67]
    ds_read_b64_tr_b16 v[242:243], v15 offset:19200
    buffer_load_dwordx4 v5, s[16:19], s31 offen lds
    v_mfma_f32_16x16x32_bf16 v[68:71], a[88:91], v[124:127], v[68:71]
    ds_read_b64_tr_b16 a[96:97], v13 offset:24576
    v_cvt_u32_f32 v149, v149
    v_mfma_f32_16x16x32_bf16 v[72:75], a[92:95], v[124:127], v[72:75]
    s_waitcnt lgkmcnt(5)
    ds_read_b64_tr_b16 a[98:99], v13 offset:25344
    v_cvt_u32_f32 v151, v151
    v_mfma_f32_16x16x32_bf16 v[76:79], a[84:87], v[128:131], v[76:79]
    ds_read_b128 v[136:139], v18 offset:10432
    v_cndmask_b32 v164, v148, v149, s[80:81]
    v_mfma_f32_16x16x32_bf16 v[80:83], a[88:91], v[128:131], v[80:83]
    ds_read_b64_tr_b16 a[100:101], v14 offset:24576
    buffer_load_dwordx4 v5, s[16:19], s31 offen offset:512 lds
    v_mfma_f32_16x16x32_bf16 v[84:87], a[92:95], v[128:131], v[84:87]
    ds_read_b64_tr_b16 a[102:103], v14 offset:25344
    v_cndmask_b32 v165, v149, v148, s[82:83]
    v_mfma_f32_16x16x32_bf16 v[88:91], a[84:87], v[132:135], v[88:91]
    ds_read_b64_tr_b16 a[104:105], v15 offset:24576
    v_and_b32 v160, 4, v150
    v_mfma_f32_16x16x32_bf16 v[92:95], a[88:91], v[132:135], v[92:95]
    ds_read_b64_tr_b16 a[106:107], v15 offset:25344
    v_lshl_add_u32 v160, v160, 3, s35
    v_mfma_f32_16x16x32_bf16 v[96:99], a[92:95], v[132:135], v[96:99]
    ds_read_b64_tr_b16 a[204:205], v13 offset:30720
    buffer_load_dwordx4 v[180:183], v30, s[12:15], s55 offen
    v_mfma_f32_16x16x32_bf16 v[64:67], a[192:195], v[128:131], v[64:67]
    ds_read_b64_tr_b16 a[206:207], v13 offset:31488
    v_mad_u32_u24 v160, v150, s42, v160
    v_mfma_f32_16x16x32_bf16 v[68:71], a[196:199], v[128:131], v[68:71]
    ds_read_b64_tr_b16 a[208:209], v14 offset:30720
    v_mad_u32_u24 v164, v164, s34, v160
    v_mfma_f32_16x16x32_bf16 v[72:75], a[200:203], v[128:131], v[72:75]
    ds_read_b64_tr_b16 a[210:211], v14 offset:31488
    v_and_b32 v160, 4, v151
    v_mfma_f32_16x16x32_bf16 v[76:79], a[192:195], v[132:135], v[76:79]
    ds_read_b128 v[140:143], v18 offset:13888
    buffer_load_dwordx4 v[184:187], v31, s[12:15], s55 offen
    v_mfma_f32_16x16x32_bf16 v[80:83], a[196:199], v[132:135], v[80:83]
    ds_read_b64_tr_b16 a[212:213], v15 offset:30720
    v_lshl_add_u32 v160, v160, 3, s35
    v_mfma_f32_16x16x32_bf16 v[84:87], a[200:203], v[132:135], v[84:87]
    s_waitcnt lgkmcnt(5)
    ds_read_b64_tr_b16 a[214:215], v15 offset:31488
    v_mad_u32_u24 v160, v151, s42, v160
    v_mfma_f32_16x16x32_bf16 v[88:91], a[192:195], v[136:139], v[88:91]
    ds_read_b128 v[112:115], v18 offset:128
    v_mad_u32_u24 v165, v165, s34, v160
    v_mfma_f32_16x16x32_bf16 v[92:95], a[196:199], v[136:139], v[92:95]
    ds_write_b64 v111, v[164:165]
    v_mfma_f32_16x16x32_bf16 v[96:99], a[200:203], v[136:139], v[96:99]
    ds_read2_b32 v[176:177], v24 offset0:0 offset1:32
    v_mfma_f32_16x16x32_bf16 v[64:67], v[232:235], v[132:135], v[64:67]
    ds_read_b128 v[116:119], v18 offset:3584
    v_fract_f32 v152, v146
    v_fract_f32 v153, v147
    v_mfma_f32_16x16x32_bf16 v[68:71], v[236:239], v[132:135], v[68:71]
    ds_read_b128 v[52:55], v23 offset:1536
    v_mul_f32 v159, v152, v153
    v_add_f32 v155, v152, v153
    v_mfma_f32_16x16x32_bf16 v[72:75], v[240:243], v[132:135], v[72:75]
    ds_read_b128 v[56:59], v23 offset:1552
    v_cndmask_b32 v152, 0, v152, s[98:99]
    v_sub_f32 v155, v155, v159
    v_sub_f32 v158, v152, v159
    v_mfma_f32_16x16x32_bf16 v[76:79], v[232:235], v[136:139], v[76:79]
    ds_read_b128 v[120:123], v18 offset:7040
    v_sub_f32 v156, 1.0, v155
    v_sub_f32 v157, v155, v152
    v_cvt_pk_bf16_f32 v167, v158, v159
    v_cvt_pk_bf16_f32 v166, v156, v157
    v_mfma_f32_16x16x32_bf16 v[80:83], v[236:239], v[136:139], v[80:83]
    ds_write_b64 v111, v[166:167] offset:8
    v_mfma_f32_16x16x32_bf16 v[84:87], v[240:243], v[136:139], v[84:87]
    s_waitcnt lgkmcnt(5)
    ds_read_b64 v[178:179], v25 offset:8
    v_cmp_gt_u32 vcc, s32, v148
    v_cmp_le_u32 s[84:85], s33, v149
    v_cmp_le_u32 s[86:87], s36, v151
    v_mfma_f32_16x16x32_bf16 v[88:91], v[232:235], v[140:143], v[88:91]
    ds_read_b32 v60, v23 offset:1568
    v_xor_b32 v172, v176, v26
    s_or_b64 vcc, vcc, s[84:85]
    s_or_b64 vcc, vcc, s[86:87]
    s_cbranch_scc1 L_bfail2
L_bfail2_back:
    v_mfma_f32_16x16x32_bf16 v[92:95], v[236:239], v[140:143], v[92:95]
    v_xor_b32 v174, v177, v26
    v_xor_b32 v173, v176, v27
    v_mfma_f32_16x16x32_bf16 v[96:99], v[240:243], v[140:143], v[96:99]
    s_waitcnt vmcnt(2) lgkmcnt(4)
    s_barrier
    v_mfma_f32_16x16x32_bf16 v[64:67], a[96:99], v[112:115], v[64:67]
    ds_read_b64_tr_b16 v[144:145], v172 offset:0
    ds_read_b64_tr_b16 v[146:147], v174 offset:0
    v_mfma_f32_16x16x32_bf16 v[68:71], a[100:103], v[112:115], v[68:71]
    ds_read_b64_tr_b16 v[148:149], v173 offset:0
    ds_read_b64_tr_b16 v[244:245], v13 offset:36864
    v_mfma_f32_16x16x32_bf16 v[72:75], a[104:107], v[112:115], v[72:75]
    s_waitcnt lgkmcnt(5)
    ds_read_b64_tr_b16 v[246:247], v13 offset:37632
    v_xor_b32 v175, v177, v27
    v_mfma_f32_16x16x32_bf16 v[76:79], a[96:99], v[116:119], v[76:79]
    ds_read_b64_tr_b16 v[150:151], v175 offset:0
    v_cndmask_b32 v169, 0, v179, s[88:89]
    v_mfma_f32_16x16x32_bf16 v[80:83], a[100:103], v[116:119], v[80:83]
    ds_read_b64_tr_b16 v[152:153], v172 offset:64
    v_cndmask_b32 v171, 0, v179, s[92:93]
    v_mfma_f32_16x16x32_bf16 v[84:87], a[104:107], v[116:119], v[84:87]
    s_waitcnt lgkmcnt(7)
    ds_read_b64_tr_b16 v[154:155], v174 offset:64
    v_cndmask_b32 v168, 0, v178, s[88:89]
    v_mfma_f32_16x16x32_bf16 v[88:91], a[96:99], v[120:123], v[88:91]
    ds_read_b64_tr_b16 v[156:157], v173 offset:64
    v_cndmask_b32 v170, 0, v178, s[92:93]
    v_mfma_f32_16x16x32_bf16 v[92:95], a[100:103], v[120:123], v[92:95]
    ds_read_b64_tr_b16 v[158:159], v175 offset:64
    v_cndmask_b32 v169, v169, v178, s[90:91]
    v_mfma_f32_16x16x32_bf16 v[96:99], a[104:107], v[120:123], v[96:99]
    ds_read_b64_tr_b16 v[160:161], v172 offset:128
    v_cndmask_b32 v171, v171, v178, s[94:95]
    v_mfma_f32_16x16x32_bf16 v[64:67], a[204:207], v[116:119], v[64:67]
    ds_read_b64_tr_b16 v[162:163], v174 offset:128
    v_xor_b32 v40, v52, v4
    v_mfma_f32_16x16x32_bf16 v[68:71], a[208:211], v[116:119], v[68:71]
    ds_read_b64_tr_b16 v[164:165], v173 offset:128
    v_xor_b32 v41, v53, v4
    v_mfma_f32_16x16x32_bf16 v[72:75], a[212:215], v[116:119], v[72:75]
    s_waitcnt lgkmcnt(5)
    ds_read_b64_tr_b16 v[166:167], v175 offset:128
    v_xor_b32 v42, v54, v4
    v_mfma_f32_16x16x32_bf16 v[144:147], v[144:147], v[168:171], 0
    ds_read_b64_tr_b16 v[248:249], v14 offset:36864
    v_xor_b32 v43, v55, v4
    v_mfma_f32_16x16x32_bf16 v[148:151], v[148:151], v[168:171], 0
    ds_read_b128 v[124:127], v18 offset:10496
    v_xor_b32 v44, v56, v4
    v_mfma_f32_16x16x32_bf16 v[152:155], v[152:155], v[168:171], 0
    ds_read_b64_tr_b16 v[250:251], v14 offset:37632
    v_xor_b32 v45, v57, v4
    v_mfma_f32_16x16x32_bf16 v[76:79], a[204:207], v[120:123], v[76:79]
    ds_read_b64_tr_b16 v[252:253], v15 offset:36864
    v_cvt_pk_bf16_f32 v144, v144, v145
    v_cvt_pk_bf16_f32 v145, v146, v147
    v_mfma_f32_16x16x32_bf16 v[80:83], a[208:211], v[120:123], v[80:83]
    ds_write_b64 v28, v[144:145] offset:0
    v_mfma_f32_16x16x32_bf16 v[84:87], a[212:215], v[120:123], v[84:87]
    s_waitcnt lgkmcnt(5)
    ds_read_b64_tr_b16 v[254:255], v15 offset:37632
    v_cvt_pk_bf16_f32 v148, v148, v149
    v_cvt_pk_bf16_f32 v149, v150, v151
    v_mfma_f32_16x16x32_bf16 v[156:159], v[156:159], v[168:171], 0
    ds_write_b64 v29, v[148:149] offset:0
    v_mfma_f32_16x16x32_bf16 v[160:163], v[160:163], v[168:171], 0
    ds_read_b128 v[128:131], v18 offset:13952
    v_cvt_pk_bf16_f32 v152, v152, v153
    v_cvt_pk_bf16_f32 v153, v154, v155
    v_mfma_f32_16x16x32_bf16 v[164:167], v[164:167], v[168:171], 0
    s_waitcnt lgkmcnt(5)
    ds_write_b64 v28, v[152:153] offset:64
    v_mfma_f32_16x16x32_bf16 v[88:91], a[204:207], v[124:127], v[88:91]
    v_cvt_pk_bf16_f32 v156, v156, v157
    v_cvt_pk_bf16_f32 v157, v158, v159
    v_mfma_f32_16x16x32_bf16 v[92:95], a[208:211], v[124:127], v[92:95]
    ds_write_b64 v29, v[156:157] offset:64
    v_mfma_f32_16x16x32_bf16 v[96:99], a[212:215], v[124:127], v[96:99]
    s_waitcnt lgkmcnt(4)
    v_cvt_pk_bf16_f32 v160, v160, v161
    v_cvt_pk_bf16_f32 v161, v162, v163
    v_mfma_f32_16x16x32_bf16 v[64:67], v[244:247], v[120:123], v[64:67]
    ds_write_b64 v28, v[160:161] offset:128
    v_mfma_f32_16x16x32_bf16 v[68:71], v[248:251], v[120:123], v[68:71]
    v_cvt_pk_bf16_f32 v164, v164, v165
    v_cvt_pk_bf16_f32 v165, v166, v167
    v_mfma_f32_16x16x32_bf16 v[72:75], v[252:255], v[120:123], v[72:75]
    ds_write_b64 v29, v[164:165] offset:128
    v_mfma_f32_16x16x32_bf16 v[76:79], v[244:247], v[124:127], v[76:79]
    s_cmp_gt_u32 s62, 16
    s_cbranch_scc1 L_more
L_more_back:
    v_mfma_f32_16x16x32_bf16 v[80:83], v[248:251], v[124:127], v[80:83]
    v_xor_b32 v46, v58, v4
    v_xor_b32 v47, v59, v4
    v_mfma_f32_16x16x32_bf16 v[84:87], v[252:255], v[124:127], v[84:87]
    s_waitcnt lgkmcnt(0)
    s_barrier
    ds_read_b128 v[132:135], v40 offset:0
    v_mfma_f32_16x16x32_bf16 v[88:91], v[244:247], v[128:131], v[88:91]
    ds_read_b128 v[136:139], v40 offset:64
    v_xor_b32 v48, v60, v4
    v_mfma_f32_16x16x32_bf16 v[92:95], v[248:251], v[128:131], v[92:95]
    ds_read_b128 v[140:143], v40 offset:128
    v_mfma_f32_16x16x32_bf16 v[96:99], v[252:255], v[128:131], v[96:99]
    s_waitcnt lgkmcnt(2)
    ds_read_b128 v[112:115], v41 offset:0
    v_mfma_f32_16x16x32_bf16 v[100:103], a[0:3], v[132:135], 0
    ds_read_b128 v[116:119], v41 offset:64
    v_cvt_pk_bf16_f32 v64, v64, v65
    v_mfma_f32_16x16x32_bf16 v[104:107], a[4:7], v[132:135], 0
    ds_read_b128 v[52:55], v23 offset:768
    v_cvt_pk_bf16_f32 v65, v66, v67
    v_mfma_f32_16x16x32_bf16 v[108:111], a[8:11], v[132:135], 0
    s_waitcnt lgkmcnt(4)
    ds_read_b128 v[56:59], v23 offset:784
    v_cvt_pk_bf16_f32 v66, v68, v69
    v_mfma_f32_16x16x32_bf16 v[100:103], a[12:15], v[136:139], v[100:103]
    ds_read_b128 v[120:123], v41 offset:128
    v_cvt_pk_bf16_f32 v67, v70, v71
    v_mfma_f32_16x16x32_bf16 v[104:107], a[16:19], v[136:139], v[104:107]
    v_permlane16_swap_b32 v64, v66
    v_mfma_f32_16x16x32_bf16 v[108:111], a[20:23], v[136:139], v[108:111]
    s_waitcnt lgkmcnt(4)
    v_permlane16_swap_b32 v65, v67
    v_mfma_f32_16x16x32_bf16 v[100:103], a[24:27], v[140:143], v[100:103]
    ds_read_b128 v[124:127], v42 offset:0
    v_cvt_pk_bf16_f32 v72, v72, v73
    v_mfma_f32_16x16x32_bf16 v[104:107], a[28:31], v[140:143], v[104:107]
    buffer_store_dwordx4 v[64:67], v19, s[20:23], s56 offen sc1
    v_cvt_pk_bf16_f32 v73, v74, v75
    v_cvt_pk_bf16_f32 v84, v84, v85
    v_cvt_pk_bf16_f32 v85, v86, v87
    v_mfma_f32_16x16x32_bf16 v[108:111], a[32:35], v[140:143], v[108:111]
    s_waitcnt lgkmcnt(2)
    ds_write_b64 v38, v[72:73] offset:49152
    v_mfma_f32_16x16x32_bf16 v[100:103], a[36:39], v[112:115], v[100:103]
    ds_read_b128 v[128:131], v42 offset:64
    v_mfma_f32_16x16x32_bf16 v[104:107], a[40:43], v[112:115], v[104:107]
    ds_read_b32 v60, v23 offset:800
    v_xor_b32 v40, v52, v4
    v_mfma_f32_16x16x32_bf16 v[108:111], a[44:47], v[112:115], v[108:111]
    ds_read2_b32 v[176:177], v24 offset0:64 offset1:96
    v_xor_b32 v41, v53, v4
    v_mfma_f32_16x16x32_bf16 v[100:103], a[48:51], v[116:119], v[100:103]
    ds_read_b128 v[132:135], v42 offset:128
    v_xor_b32 v42, v54, v4
    v_mfma_f32_16x16x32_bf16 v[104:107], a[52:55], v[116:119], v[104:107]
    ds_read_b64 v[178:179], v25 offset:264
    v_cvt_pk_bf16_f32 v96, v96, v97
    v_mfma_f32_16x16x32_bf16 v[108:111], a[56:59], v[116:119], v[108:111]
    s_waitcnt lgkmcnt(5)
    ds_write_b64 v38, v[84:85] offset:51200
    v_mfma_f32_16x16x32_bf16 v[100:103], a[60:63], v[120:123], v[100:103]
    ds_read_b128 v[136:139], v43 offset:0
    v_mfma_f32_16x16x32_bf16 v[104:107], a[64:67], v[120:123], v[104:107]
    v_cvt_pk_bf16_f32 v97, v98, v99
    v_cvt_pk_bf16_f32 v76, v76, v77
    v_mfma_f32_16x16x32_bf16 v[108:111], a[68:71], v[120:123], v[108:111]
    s_waitcnt lgkmcnt(4)
    ds_write_b64 v38, v[96:97] offset:53248
    v_mfma_f32_16x16x32_bf16 v[100:103], a[72:75], v[124:127], v[100:103]
    ds_read_b128 v[140:143], v43 offset:64
    v_mfma_f32_16x16x32_bf16 v[104:107], a[76:79], v[124:127], v[104:107]
    v_xor_b32 v172, v176, v26
    v_xor_b32 v174, v177, v26
    v_mfma_f32_16x16x32_bf16 v[108:111], a[80:83], v[124:127], v[108:111]
    s_waitcnt lgkmcnt(3)
    v_xor_b32 v173, v176, v27
    v_xor_b32 v175, v177, v27
    v_mfma_f32_16x16x32_bf16 v[100:103], a[84:87], v[128:131], v[100:103]
    ds_read_b128 v[112:115], v43 offset:128
    v_cndmask_b32 v169, 0, v179, s[88:89]
    v_mfma_f32_16x16x32_bf16 v[104:107], a[88:91], v[128:131], v[104:107]
    v_cndmask_b32 v171, 0, v179, s[92:93]
    v_cndmask_b32 v168, 0, v178, s[88:89]
    v_mfma_f32_16x16x32_bf16 v[108:111], a[92:95], v[128:131], v[108:111]
    v_cndmask_b32 v170, 0, v178, s[92:93]
    v_cndmask_b32 v169, v169, v178, s[90:91]
    v_mfma_f32_16x16x32_bf16 v[100:103], a[96:99], v[132:135], v[100:103]
    ds_read_b128 v[116:119], v44 offset:0
    v_cndmask_b32 v171, v171, v178, s[94:95]
    v_mfma_f32_16x16x32_bf16 v[104:107], a[100:103], v[132:135], v[104:107]
    v_xor_b32 v43, v55, v4
    v_cvt_pk_bf16_f32 v77, v78, v79
    v_mfma_f32_16x16x32_bf16 v[108:111], a[104:107], v[132:135], v[108:111]
    s_waitcnt lgkmcnt(2)
    v_cvt_pk_bf16_f32 v78, v80, v81
    v_cvt_pk_bf16_f32 v79, v82, v83
    v_mfma_f32_16x16x32_bf16 v[100:103], a[108:111], v[136:139], v[100:103]
    ds_read_b128 v[120:123], v44 offset:64
    v_cvt_pk_bf16_f32 v88, v88, v89
    v_mfma_f32_16x16x32_bf16 v[104:107], a[112:115], v[136:139], v[104:107]
    v_permlane16_swap_b32 v76, v78
    v_mfma_f32_16x16x32_bf16 v[108:111], a[116:119], v[136:139], v[108:111]
    v_permlane16_swap_b32 v77, v79
    v_mfma_f32_16x16x32_bf16 v[100:103], a[120:123], v[140:143], v[100:103]
    ds_read_b128 v[124:127], v44 offset:128
    v_xor_b32 v44, v56, v4
    v_mfma_f32_16x16x32_bf16 v[104:107], a[124:127], v[140:143], v[104:107]
    ds_read_b64_tr_b16 v[144:145], v172 offset:0
    v_cvt_pk_bf16_f32 v89, v90, v91
    v_mfma_f32_16x16x32_bf16 v[108:111], a[128:131], v[140:143], v[108:111]
    s_waitcnt lgkmcnt(3)
    ds_read_b64_tr_b16 v[146:147], v174 offset:0
    v_cvt_pk_bf16_f32 v90, v92, v93
    v_mfma_f32_16x16x32_bf16 v[100:103], a[132:135], v[112:115], v[100:103]
    ds_read_b64_tr_b16 v[148:149], v173 offset:0
    v_cvt_pk_bf16_f32 v91, v94, v95
    v_mfma_f32_16x16x32_bf16 v[104:107], a[136:139], v[112:115], v[104:107]
    ds_read_b128 v[128:131], v45 offset:0
    v_mfma_f32_16x16x32_bf16 v[108:111], a[140:143], v[112:115], v[108:111]
    ds_read_b64_tr_b16 v[150:151], v175 offset:0
    v_mfma_f32_16x16x32_bf16 v[100:103], a[144:147], v[116:119], v[100:103]
    ds_read_b64_tr_b16 v[152:153], v172 offset:64
    v_mfma_f32_16x16x32_bf16 v[104:107], a[148:151], v[116:119], v[104:107]
    ds_read_b64_tr_b16 v[154:155], v174 offset:64
    v_mfma_f32_16x16x32_bf16 v[108:111], a[152:155], v[116:119], v[108:111]
    s_waitcnt lgkmcnt(5)
    ds_read_b128 v[132:135], v45 offset:64
    v_mfma_f32_16x16x32_bf16 v[100:103], a[156:159], v[120:123], v[100:103]
    ds_read_b64_tr_b16 v[156:157], v173 offset:64
    v_mfma_f32_16x16x32_bf16 v[104:107], a[160:163], v[120:123], v[104:107]
    ds_read_b64_tr_b16 v[158:159], v175 offset:64
    v_mfma_f32_16x16x32_bf16 v[108:111], a[164:167], v[120:123], v[108:111]
    ds_read_b64_tr_b16 v[160:161], v172 offset:128
    v_mfma_f32_16x16x32_bf16 v[100:103], a[168:171], v[124:127], v[100:103]
    ds_read_b64_tr_b16 v[162:163], v174 offset:128
    v_mfma_f32_16x16x32_bf16 v[104:107], a[172:175], v[124:127], v[104:107]
    ds_read_b64_tr_b16 v[164:165], v173 offset:128
    v_mfma_f32_16x16x32_bf16 v[108:111], a[176:179], v[124:127], v[108:111]
    s_waitcnt lgkmcnt(5)
    ds_read_b64_tr_b16 v[166:167], v175 offset:128
    v_mfma_f32_16x16x32_bf16 v[100:103], a[180:183], v[128:131], v[100:103]
    ds_read_b128 v[136:139], v45 offset:128
    v_xor_b32 v45, v57, v4
    v_mfma_f32_16x16x32_bf16 v[104:107], a[184:187], v[128:131], v[104:107]
    buffer_store_dwordx4 v[76:79], v19, s[20:23], s4 offen sc1
    v_mfma_f32_16x16x32_bf16 v[108:111], a[188:191], v[128:131], v[108:111]
    v_permlane16_swap_b32 v88, v90
    v_mfma_f32_16x16x32_bf16 v[100:103], a[192:195], v[132:135], v[100:103]
    ds_read_b128 v[140:143], v46 offset:0
    v_mfma_f32_16x16x32_bf16 v[104:107], a[196:199], v[132:135], v[104:107]
    v_permlane16_swap_b32 v89, v91
    v_mfma_f32_16x16x32_bf16 v[108:111], a[200:203], v[132:135], v[108:111]
    buffer_store_dwordx4 v[88:91], v19, s[20:23], s5 offen sc1
    v_mfma_f32_16x16x32_bf16 v[144:147], v[144:147], v[168:171], 0
    ds_read_b128 v[112:115], v46 offset:64
    v_mfma_f32_16x16x32_bf16 v[148:151], v[148:151], v[168:171], 0
    v_mfma_f32_16x16x32_bf16 v[152:155], v[152:155], v[168:171], 0
    s_waitcnt lgkmcnt(2)
    v_mfma_f32_16x16x32_bf16 v[156:159], v[156:159], v[168:171], 0
    ds_read_b128 v[116:119], v46 offset:128
    v_xor_b32 v46, v58, v4
    v_mfma_f32_16x16x32_bf16 v[160:163], v[160:163], v[168:171], 0
    v_cvt_pk_bf16_f32 v144, v144, v145
    v_cvt_pk_bf16_f32 v145, v146, v147
    v_mfma_f32_16x16x32_bf16 v[164:167], v[164:167], v[168:171], 0
    ds_write_b64 v28, v[144:145] offset:12288
    v_mfma_f32_16x16x32_bf16 v[100:103], a[204:207], v[136:139], v[100:103]
    ds_read_b128 v[120:123], v47 offset:0
    v_mfma_f32_16x16x32_bf16 v[104:107], a[208:211], v[136:139], v[104:107]
    v_cvt_pk_bf16_f32 v148, v148, v149
    v_cvt_pk_bf16_f32 v149, v150, v151
    v_mfma_f32_16x16x32_bf16 v[108:111], a[212:215], v[136:139], v[108:111]
    s_waitcnt lgkmcnt(3)
    ds_write_b64 v29, v[148:149] offset:12288
    v_mfma_f32_16x16x32_bf16 v[100:103], a[216:219], v[140:143], v[100:103]
    ds_read_b128 v[124:127], v47 offset:64
    v_mfma_f32_16x16x32_bf16 v[104:107], a[220:223], v[140:143], v[104:107]
    v_cvt_pk_bf16_f32 v152, v152, v153
    v_cvt_pk_bf16_f32 v153, v154, v155
    v_mfma_f32_16x16x32_bf16 v[108:111], a[224:227], v[140:143], v[108:111]
    ds_read2_b32 v[176:177], v24 offset0:128 offset1:160
    v_cvt_pk_bf16_f32 v156, v156, v157
    v_mfma_f32_16x16x32_bf16 v[100:103], a[228:231], v[112:115], v[100:103]
    ds_read_b128 v[128:131], v47 offset:128
    v_cvt_pk_bf16_f32 v157, v158, v159
    v_mfma_f32_16x16x32_bf16 v[104:107], a[232:235], v[112:115], v[104:107]
    ds_write_b64 v28, v[152:153] offset:12352
    v_mfma_f32_16x16x32_bf16 v[108:111], a[236:239], v[112:115], v[108:111]
    s_waitcnt lgkmcnt(4)
    ds_read_b64 v[178:179], v25 offset:520
    v_mfma_f32_16x16x32_bf16 v[100:103], a[240:243], v[116:119], v[100:103]
    ds_read_b128 v[132:135], v48 offset:0
    v_cvt_pk_bf16_f32 v160, v160, v161
    v_mfma_f32_16x16x32_bf16 v[104:107], a[244:247], v[116:119], v[104:107]
    ds_write_b64 v29, v[156:157] offset:12352
    v_mfma_f32_16x16x32_bf16 v[108:111], a[248:251], v[116:119], v[108:111]
    s_waitcnt lgkmcnt(5)
    v_xor_b32 v172, v176, v26
    v_xor_b32 v174, v177, v26
    v_mfma_f32_16x16x32_bf16 v[100:103], a[252:255], v[120:123], v[100:103]
    ds_read_b128 v[136:139], v48 offset:64
    v_xor_b32 v173, v176, v27
    v_mfma_f32_16x16x32_bf16 v[104:107], v[188:191], v[120:123], v[104:107]
    v_xor_b32 v175, v177, v27
    v_cvt_pk_bf16_f32 v161, v162, v163
    v_mfma_f32_16x16x32_bf16 v[108:111], v[192:195], v[120:123], v[108:111]
    s_waitcnt lgkmcnt(3)
    ds_write_b64 v28, v[160:161] offset:12416
    v_mfma_f32_16x16x32_bf16 v[100:103], v[196:199], v[124:127], v[100:103]
    ds_read_b128 v[140:143], v48 offset:128
    v_mfma_f32_16x16x32_bf16 v[104:107], v[200:203], v[124:127], v[104:107]
    v_cvt_pk_bf16_f32 v164, v164, v165
    v_cvt_pk_bf16_f32 v165, v166, v167
    v_mfma_f32_16x16x32_bf16 v[108:111], v[204:207], v[124:127], v[108:111]
    ds_write_b64 v29, v[164:165] offset:12416
    v_mfma_f32_16x16x32_bf16 v[100:103], v[208:211], v[128:131], v[100:103]
    ds_read_b128 v[112:115], v40 offset:0
    v_mfma_f32_16x16x32_bf16 v[104:107], v[212:215], v[128:131], v[104:107]
    v_cndmask_b32 v169, 0, v179, s[88:89]
    v_cndmask_b32 v171, 0, v179, s[92:93]
    v_mfma_f32_16x16x32_bf16 v[108:111], v[216:219], v[128:131], v[108:111]
    s_waitcnt lgkmcnt(3)
    v_cndmask_b32 v168, 0, v178, s[88:89]
    v_cndmask_b32 v170, 0, v178, s[92:93]
    v_mfma_f32_16x16x32_bf16 v[100:103], v[220:223], v[132:135], v[100:103]
    ds_read_b128 v[116:119], v40 offset:64
    v_cndmask_b32 v169, v169, v178, s[90:91]
    v_mfma_f32_16x16x32_bf16 v[104:107], v[224:227], v[132:135], v[104:107]
    v_cndmask_b32 v171, v171, v178, s[94:95]
    v_xor_b32 v47, v59, v4
    v_mfma_f32_16x16x32_bf16 v[108:111], v[228:231], v[132:135], v[108:111]
    v_xor_b32 v48, v60, v4
    v_mfma_f32_16x16x32_bf16 v[100:103], v[232:235], v[136:139], v[100:103]
    ds_read_b128 v[120:123], v40 offset:128
    v_mfma_f32_16x16x32_bf16 v[104:107], v[236:239], v[136:139], v[104:107]
    ds_read_b64_tr_b16 v[144:145], v172 offset:0
    v_mfma_f32_16x16x32_bf16 v[108:111], v[240:243], v[136:139], v[108:111]
    s_waitcnt lgkmcnt(3)
    ds_read_b64_tr_b16 v[146:147], v174 offset:0
    v_mfma_f32_16x16x32_bf16 v[100:103], v[244:247], v[140:143], v[100:103]
    ds_read_b64_tr_b16 v[148:149], v173 offset:0
    v_mfma_f32_16x16x32_bf16 v[104:107], v[248:251], v[140:143], v[104:107]
    ds_read_b128 v[124:127], v41 offset:0
    v_mfma_f32_16x16x32_bf16 v[108:111], v[252:255], v[140:143], v[108:111]
    s_waitcnt vmcnt(3) lgkmcnt(5)
    ds_read_b64_tr_b16 v[150:151], v175 offset:0
    v_mfma_f32_16x16x32_bf16 v[64:67], a[0:3], v[112:115], 0
    ds_read_b64_tr_b16 v[152:153], v172 offset:64
    v_and_b32 v180, s96, v180
    v_mfma_f32_16x16x32_bf16 v[68:71], a[4:7], v[112:115], 0
    ds_read_b64_tr_b16 v[154:155], v174 offset:64
    v_and_b32 v181, s96, v181
    v_mfma_f32_16x16x32_bf16 v[72:75], a[8:11], v[112:115], 0
    ds_read_b128 v[128:131], v41 offset:64
    v_cvt_pk_bf16_f32 v108, v108, v109
    v_mfma_f32_16x16x32_bf16 v[64:67], a[12:15], v[116:119], v[64:67]
    ds_read_b64_tr_b16 v[156:157], v173 offset:64
    v_cvt_pk_bf16_f32 v109, v110, v111
    v_mfma_f32_16x16x32_bf16 v[68:71], a[16:19], v[116:119], v[68:71]
    ds_read_b64_tr_b16 v[158:159], v175 offset:64
    v_and_b32 v182, s96, v182
    v_mfma_f32_16x16x32_bf16 v[72:75], a[20:23], v[116:119], v[72:75]
    s_waitcnt lgkmcnt(5)
    ds_read_b64_tr_b16 v[160:161], v172 offset:128
    v_and_b32 v183, s96, v183
    v_mfma_f32_16x16x32_bf16 v[64:67], a[24:27], v[120:123], v[64:67]
    ds_read_b64_tr_b16 v[162:163], v174 offset:128
    v_pk_max_u16 v180, v180, v181
    v_mfma_f32_16x16x32_bf16 v[68:71], a[28:31], v[120:123], v[68:71]
    ds_read_b64_tr_b16 v[164:165], v173 offset:128
    v_pk_max_u16 v182, v182, v183
    v_mfma_f32_16x16x32_bf16 v[72:75], a[32:35], v[120:123], v[72:75]
    ds_read_b64_tr_b16 v[166:167], v175 offset:128
    v_pk_max_u16 v180, v180, s37
    v_mfma_f32_16x16x32_bf16 v[64:67], a[36:39], v[124:127], v[64:67]
    ds_read_b128 v[132:135], v41 offset:128
    v_pk_max_u16 v180, v180, v182
    v_mfma_f32_16x16x32_bf16 v[68:71], a[40:43], v[124:127], v[68:71]
    ds_read_b128 v[52:55], v23 offset:0
    v_cmp_ne_u32 s[80:81], s37, v180
    v_mfma_f32_16x16x32_bf16 v[72:75], a[44:47], v[124:127], v[72:75]
    s_waitcnt lgkmcnt(5)
    ds_read2_b32 v[176:177], v24 offset0:192 offset1:224
    v_and_b32 v184, s96, v184
    v_mfma_f32_16x16x32_bf16 v[64:67], a[48:51], v[128:131], v[64:67]
    ds_read_b128 v[136:139], v42 offset:0
    v_and_b32 v185, s96, v185
    v_mfma_f32_16x16x32_bf16 v[68:71], a[52:55], v[128:131], v[68:71]
    ds_read_b64 v[178:179], v25 offset:776
    v_and_b32 v186, s96, v186
    v_mfma_f32_16x16x32_bf16 v[72:75], a[56:59], v[128:131], v[72:75]
    ds_write_b64 v38, v[108:109] offset:55296
    v_mfma_f32_16x16x32_bf16 v[144:147], v[144:147], v[168:171], 0
    ds_read_b128 v[140:143], v42 offset:64
    v_mfma_f32_16x16x32_bf16 v[148:151], v[148:151], v[168:171], 0
    ds_read_b128 v[56:59], v23 offset:16
    v_and_b32 v187, s96, v187
    v_mfma_f32_16x16x32_bf16 v[152:155], v[152:155], v[168:171], 0
    s_waitcnt lgkmcnt(5)
    ds_read_b32 v60, v23 offset:32
    v_xor_b32 v172, v176, v26
    v_mfma_f32_16x16x32_bf16 v[156:159], v[156:159], v[168:171], 0
    ds_read_b128 v[112:115], v42 offset:128
    v_cvt_pk_bf16_f32 v144, v144, v145
    v_mfma_f32_16x16x32_bf16 v[160:163], v[160:163], v[168:171], 0
    v_cvt_pk_bf16_f32 v145, v146, v147
    v_cvt_pk_bf16_f32 v148, v148, v149
    v_mfma_f32_16x16x32_bf16 v[164:167], v[164:167], v[168:171], 0
    s_waitcnt lgkmcnt(4)
    ds_write_b64 v28, v[144:145] offset:24576
    v_mfma_f32_16x16x32_bf16 v[64:67], a[60:63], v[132:135], v[64:67]
    ds_read_b128 v[116:119], v43 offset:0
    v_mfma_f32_16x16x32_bf16 v[68:71], a[64:67], v[132:135], v[68:71]
    v_cvt_pk_bf16_f32 v149, v150, v151
    v_xor_b32 v174, v177, v26
    v_mfma_f32_16x16x32_bf16 v[72:75], a[68:71], v[132:135], v[72:75]
    s_waitcnt lgkmcnt(3)
    ds_write_b64 v29, v[148:149] offset:24576
    v_mfma_f32_16x16x32_bf16 v[64:67], a[72:75], v[136:139], v[64:67]
    ds_read_b128 v[120:123], v43 offset:64
    v_mfma_f32_16x16x32_bf16 v[68:71], a[76:79], v[136:139], v[68:71]
    v_xor_b32 v173, v176, v27
    v_cvt_pk_bf16_f32 v152, v152, v153
    v_mfma_f32_16x16x32_bf16 v[72:75], a[80:83], v[136:139], v[72:75]
    v_cvt_pk_bf16_f32 v153, v154, v155
    v_xor_b32 v175, v177, v27
    v_mfma_f32_16x16x32_bf16 v[64:67], a[84:87], v[140:143], v[64:67]
    ds_read_b128 v[124:127], v43 offset:128
    v_cvt_pk_bf16_f32 v156, v156, v157
    v_mfma_f32_16x16x32_bf16 v[68:71], a[88:91], v[140:143], v[68:71]
    ds_write_b64 v28, v[152:153] offset:24640
    v_mfma_f32_16x16x32_bf16 v[72:75], a[92:95], v[140:143], v[72:75]
    s_waitcnt lgkmcnt(3)
    v_cvt_pk_bf16_f32 v157, v158, v159
    v_cvt_pk_bf16_f32 v160, v160, v161
    v_mfma_f32_16x16x32_bf16 v[64:67], a[96:99], v[112:115], v[64:67]
    ds_read_b128 v[128:131], v44 offset:0
    v_cvt_pk_bf16_f32 v161, v162, v163
    v_mfma_f32_16x16x32_bf16 v[68:71], a[100:103], v[112:115], v[68:71]
    ds_read_b64_tr_b16 v[144:145], v172 offset:0
    v_cvt_pk_bf16_f32 v164, v164, v165
    v_mfma_f32_16x16x32_bf16 v[72:75], a[104:107], v[112:115], v[72:75]
    ds_read_b64_tr_b16 v[146:147], v174 offset:0
    v_cvt_pk_bf16_f32 v165, v166, v167
    v_mfma_f32_16x16x32_bf16 v[64:67], a[108:111], v[116:119], v[64:67]
    ds_read_b64_tr_b16 v[148:149], v173 offset:0
    v_cndmask_b32 v169, 0, v179, s[88:89]
    v_mfma_f32_16x16x32_bf16 v[68:71], a[112:115], v[116:119], v[68:71]
    ds_read_b128 v[132:135], v44 offset:64
    v_cndmask_b32 v171, 0, v179, s[92:93]
    v_mfma_f32_16x16x32_bf16 v[72:75], a[116:119], v[116:119], v[72:75]
    s_waitcnt lgkmcnt(5)
    ds_read_b64_tr_b16 v[150:151], v175 offset:0
    v_cndmask_b32 v168, 0, v178, s[88:89]
    v_mfma_f32_16x16x32_bf16 v[64:67], a[120:123], v[120:123], v[64:67]
    ds_read_b64_tr_b16 v[152:153], v172 offset:64
    v_cndmask_b32 v170, 0, v178, s[92:93]
    v_mfma_f32_16x16x32_bf16 v[68:71], a[124:127], v[120:123], v[68:71]
    ds_read_b64_tr_b16 v[154:155], v174 offset:64
    v_cndmask_b32 v169, v169, v178, s[90:91]
    v_mfma_f32_16x16x32_bf16 v[72:75], a[128:131], v[120:123], v[72:75]
    ds_write_b64 v29, v[156:157] offset:24640
    v_mfma_f32_16x16x32_bf16 v[64:67], a[132:135], v[124:127], v[64:67]
    ds_read_b128 v[136:139], v44 offset:128
    v_mfma_f32_16x16x32_bf16 v[68:71], a[136:139], v[124:127], v[68:71]
    ds_read_b64_tr_b16 v[156:157], v173 offset:64
    v_cndmask_b32 v171, v171, v178, s[94:95]
    v_mfma_f32_16x16x32_bf16 v[72:75], a[140:143], v[124:127], v[72:75]
L_pgY2:
  s_cbranch_execz L_retY
    s_waitcnt lgkmcnt(5)
    ds_read_b64_tr_b16 v[158:159], v175 offset:64
    v_pk_max_u16 v184, v184, v185
    v_mfma_f32_16x16x32_bf16 v[64:67], a[144:147], v[128:131], v[64:67]
    ds_write_b64 v28, v[160:161] offset:24704
    v_mfma_f32_16x16x32_bf16 v[68:71], a[148:151], v[128:131], v[68:71]
    ds_read_b64_tr_b16 v[160:161], v172 offset:128
    v_mfma_f32_16x16x32_bf16 v[72:75], a[152:155], v[128:131], v[72:75]
    ds_read_b64_tr_b16 v[162:163], v174 offset:128
    v_pk_max_u16 v186, v186, v187
    v_mfma_f32_16x16x32_bf16 v[64:67], a[156:159], v[132:135], v[64:67]
    ds_write_b64 v29, v[164:165] offset:24704
    v_mfma_f32_16x16x32_bf16 v[68:71], a[160:163], v[132:135], v[68:71]
    ds_read_b64_tr_b16 v[164:165], v173 offset:128
    v_mfma_f32_16x16x32_bf16 v[72:75], a[164:167], v[132:135], v[72:75]
    s_waitcnt lgkmcnt(5)
    ds_read_b64_tr_b16 v[166:167], v175 offset:128
    v_pk_max_u16 v184, v184, s37
    v_mfma_f32_16x16x32_bf16 v[64:67], a[168:171], v[136:139], v[64:67]
    ds_read_b128 v[140:143], v45 offset:0
    v_pk_max_u16 v184, v184, v186
    v_mfma_f32_16x16x32_bf16 v[68:71], a[172:175], v[136:139], v[68:71]
    ds_read_b128 v[112:115], v45 offset:64
    v_cmp_ne_u32 s[82:83], s37, v184
    v_mfma_f32_16x16x32_bf16 v[72:75], a[176:179], v[136:139], v[72:75]
    v_xor_b32 v40, v52, v4
    v_xor_b32 v41, v53, v4
    v_mfma_f32_16x16x32_bf16 v[144:147], v[144:147], v[168:171], 0
    ds_read_b128 v[116:119], v45 offset:128
    v_xor_b32 v42, v54, v4
    v_mfma_f32_16x16x32_bf16 v[148:151], v[148:151], v[168:171], 0
    s_or_b64 vcc, s[80:81], s[82:83]
    s_cbranch_scc1 L_afailY
L_afailY_back:
    v_mfma_f32_16x16x32_bf16 v[152:155], v[152:155], v[168:171], 0
    s_waitcnt lgkmcnt(3)
    v_xor_b32 v43, v55, v4
    v_cvt_pk_bf16_f32 v144, v144, v145
    v_mfma_f32_16x16x32_bf16 v[156:159], v[156:159], v[168:171], 0
    ds_read_b128 v[120:123], v46 offset:0
    v_cvt_pk_bf16_f32 v145, v146, v147
    v_mfma_f32_16x16x32_bf16 v[160:163], v[160:163], v[168:171], 0
    ds_write_b64 v28, v[144:145] offset:36864
    v_mfma_f32_16x16x32_bf16 v[164:167], v[164:167], v[168:171], 0
    s_waitcnt lgkmcnt(3)
    v_cvt_pk_bf16_f32 v148, v148, v149
    v_cvt_pk_bf16_f32 v149, v150, v151
    v_mfma_f32_16x16x32_bf16 v[64:67], a[180:183], v[140:143], v[64:67]
    ds_read_b128 v[124:127], v46 offset:64
    v_cvt_pk_bf16_f32 v152, v152, v153
    v_mfma_f32_16x16x32_bf16 v[68:71], a[184:187], v[140:143], v[68:71]
    ds_write_b64 v29, v[148:149] offset:36864
    v_mfma_f32_16x16x32_bf16 v[72:75], a[188:191], v[140:143], v[72:75]
    v_cvt_pk_bf16_f32 v153, v154, v155
    v_cvt_pk_bf16_f32 v156, v156, v157
    v_mfma_f32_16x16x32_bf16 v[64:67], a[192:195], v[112:115], v[64:67]
    ds_read_b128 v[128:131], v46 offset:128
    v_cvt_pk_bf16_f32 v157, v158, v159
    v_mfma_f32_16x16x32_bf16 v[68:71], a[196:199], v[112:115], v[68:71]
    ds_write_b64 v28, v[152:153] offset:36928
    v_mfma_f32_16x16x32_bf16 v[72:75], a[200:203], v[112:115], v[72:75]
    s_waitcnt lgkmcnt(4)
    v_cvt_pk_bf16_f32 v160, v160, v161
    v_cvt_pk_bf16_f32 v161, v162, v163
    v_mfma_f32_16x16x32_bf16 v[64:67], a[204:207], v[116:119], v[64:67]
    ds_read_b128 v[132:135], v47 offset:0
    v_cvt_pk_bf16_f32 v164, v164, v165
    v_mfma_f32_16x16x32_bf16 v[68:71], a[208:211], v[116:119], v[68:71]
    ds_write_b64 v29, v[156:157] offset:36928
    v_mfma_f32_16x16x32_bf16 v[72:75], a[212:215], v[116:119], v[72:75]
    v_cvt_pk_bf16_f32 v165, v166, v167
    v_xor_b32 v44, v56, v4
    v_mfma_f32_16x16x32_bf16 v[64:67], a[216:219], v[120:123], v[64:67]
    ds_read_b128 v[136:139], v47 offset:64
    v_xor_b32 v45, v57, v4
    v_mfma_f32_16x16x32_bf16 v[68:71], a[220:223], v[120:123], v[68:71]
    ds_write_b64 v28, v[160:161] offset:36992
    v_mfma_f32_16x16x32_bf16 v[72:75], a[224:227], v[120:123], v[72:75]
    s_waitcnt lgkmcnt(4)
    v_xor_b32 v46, v58, v4
    v_cvt_pk_bf16_f32 v100, v100, v101
    v_mfma_f32_16x16x32_bf16 v[64:67], a[228:231], v[124:127], v[64:67]
    ds_read_b128 v[140:143], v47 offset:128
    v_xor_b32 v47, v59, v4
    v_mfma_f32_16x16x32_bf16 v[68:71], a[232:235], v[124:127], v[68:71]
    ds_write_b64 v29, v[164:165] offset:36992
    v_mfma_f32_16x16x32_bf16 v[72:75], a[236:239], v[124:127], v[72:75]
    v_cvt_pk_bf16_f32 v101, v102, v103
    v_cvt_pk_bf16_f32 v102, v104, v105
    v_mfma_f32_16x16x32_bf16 v[64:67], a[240:243], v[128:131], v[64:67]
    ds_read_b128 v[112:115], v48 offset:0
    v_cvt_pk_bf16_f32 v103, v106, v107
    v_mfma_f32_16x16x32_bf16 v[68:71], a[244:247], v[128:131], v[68:71]
    v_permlane16_swap_b32 v100, v102
    v_mfma_f32_16x16x32_bf16 v[72:75], a[248:251], v[128:131], v[72:75]
    s_waitcnt lgkmcnt(3)
    v_permlane16_swap_b32 v101, v103
    v_mfma_f32_16x16x32_bf16 v[64:67], a[252:255], v[132:135], v[64:67]
    ds_read_b128 v[116:119], v48 offset:64
    v_mfma_f32_16x16x32_bf16 v[68:71], v[188:191], v[132:135], v[68:71]
    buffer_store_dwordx4 v[100:103], v21, s[20:23], s74 offen sc1
    v_mfma_f32_16x16x32_bf16 v[72:75], v[192:195], v[132:135], v[72:75]
    v_mfma_f32_16x16x32_bf16 v[64:67], v[196:199], v[136:139], v[64:67]
    ds_read_b128 v[120:123], v48 offset:128
    v_xor_b32 v48, v60, v4
    v_mfma_f32_16x16x32_bf16 v[68:71], v[200:203], v[136:139], v[68:71]
    v_mfma_f32_16x16x32_bf16 v[72:75], v[204:207], v[136:139], v[72:75]
    s_waitcnt lgkmcnt(2)
    s_barrier
    v_mfma_f32_16x16x32_bf16 v[64:67], v[208:211], v[140:143], v[64:67]
    ds_read_b128 v[124:127], v40 offset:0
    v_mfma_f32_16x16x32_bf16 v[68:71], v[212:215], v[140:143], v[68:71]
    ds_read_b32 v35, v34
    v_mfma_f32_16x16x32_bf16 v[72:75], v[216:219], v[140:143], v[72:75]
    ds_read_b64 v[6:7], v39 offset:49152
    v_mfma_f32_16x16x32_bf16 v[64:67], v[220:223], v[112:115], v[64:67]
    ds_read_b128 v[128:131], v40 offset:64
    v_mfma_f32_16x16x32_bf16 v[68:71], v[224:227], v[112:115], v[68:71]
    ds_read_b64 v[12:13], v39 offset:55296
    v_mfma_f32_16x16x32_bf16 v[72:75], v[228:231], v[112:115], v[72:75]
    s_waitcnt lgkmcnt(5)
    v_mfma_f32_16x16x32_bf16 v[64:67], v[232:235], v[116:119], v[64:67]
    ds_read_b128 v[132:135], v40 offset:128
    v_mfma_f32_16x16x32_bf16 v[68:71], v[236:239], v[116:119], v[68:71]
    v_mfma_f32_16x16x32_bf16 v[72:75], v[240:243], v[116:119], v[72:75]
    s_waitcnt lgkmcnt(3)
    v_readfirstlane_b32 s63, v35
    v_mfma_f32_16x16x32_bf16 v[64:67], v[244:247], v[120:123], v[64:67]
    ds_read_b128 v[136:139], v41 offset:0
    v_mfma_f32_16x16x32_bf16 v[68:71], v[248:251], v[120:123], v[68:71]
    buffer_store_dwordx2 v[6:7], v20, s[20:23], s56 offen sc1
    v_mfma_f32_16x16x32_bf16 v[72:75], v[252:255], v[120:123], v[72:75]
    s_waitcnt lgkmcnt(2)
    v_mfma_f32_16x16x32_bf16 v[76:79], a[0:3], v[124:127], 0
    ds_read_b128 v[140:143], v41 offset:64
    v_mfma_f32_16x16x32_bf16 v[80:83], a[4:7], v[124:127], 0
    v_cvt_pk_bf16_f32 v64, v64, v65
    v_cvt_pk_bf16_f32 v65, v66, v67
    v_mfma_f32_16x16x32_bf16 v[84:87], a[8:11], v[124:127], 0
    buffer_store_dwordx2 v[12:13], v22, s[20:23], s74 offen sc1
    v_cvt_pk_bf16_f32 v66, v68, v69
    v_mfma_f32_16x16x32_bf16 v[76:79], a[12:15], v[128:131], v[76:79]
    ds_read_b128 v[112:115], v41 offset:128
    v_cvt_pk_bf16_f32 v67, v70, v71
    v_mfma_f32_16x16x32_bf16 v[80:83], a[16:19], v[128:131], v[80:83]
    v_permlane16_swap_b32 v64, v66
    v_mfma_f32_16x16x32_bf16 v[84:87], a[20:23], v[128:131], v[84:87]
    s_waitcnt lgkmcnt(2)
    v_permlane16_swap_b32 v65, v67
    v_mfma_f32_16x16x32_bf16 v[76:79], a[24:27], v[132:135], v[76:79]
    ds_read_b128 v[116:119], v42 offset:0
    v_cvt_pk_bf16_f32 v72, v72, v73
    v_mfma_f32_16x16x32_bf16 v[80:83], a[28:31], v[132:135], v[80:83]
    ds_read_b64 v[8:9], v39 offset:51200
    v_cvt_pk_bf16_f32 v73, v74, v75
    v_mfma_f32_16x16x32_bf16 v[84:87], a[32:35], v[132:135], v[84:87]
    ds_write_b64 v38, v[72:73] offset:57344
    v_mfma_f32_16x16x32_bf16 v[76:79], a[36:39], v[136:139], v[76:79]
    ds_read_b128 v[120:123], v42 offset:64
    v_mfma_f32_16x16x32_bf16 v[80:83], a[40:43], v[136:139], v[80:83]
    buffer_store_dwordx4 v[64:67], v21, s[20:23], s75 offen sc1
    v_mfma_f32_16x16x32_bf16 v[84:87], a[44:47], v[136:139], v[84:87]
    s_waitcnt lgkmcnt(4)
    v_mfma_f32_16x16x32_bf16 v[76:79], a[48:51], v[140:143], v[76:79]
    ds_read_b128 v[124:127], v42 offset:128
    v_mfma_f32_16x16x32_bf16 v[80:83], a[52:55], v[140:143], v[80:83]
    v_mfma_f32_16x16x32_bf16 v[84:87], a[56:59], v[140:143], v[84:87]
    s_waitcnt lgkmcnt(2)
    v_mfma_f32_16x16x32_bf16 v[76:79], a[60:63], v[112:115], v[76:79]
    ds_read_b128 v[128:131], v43 offset:0
    v_mfma_f32_16x16x32_bf16 v[80:83], a[64:67], v[112:115], v[80:83]
    buffer_store_dwordx2 v[8:9], v20, s[20:23], s4 offen sc1
    v_mfma_f32_16x16x32_bf16 v[84:87], a[68:71], v[112:115], v[84:87]
    v_mfma_f32_16x16x32_bf16 v[76:79], a[72:75], v[116:119], v[76:79]
    ds_read_b128 v[132:135], v43 offset:64
    v_mfma_f32_16x16x32_bf16 v[80:83], a[76:79], v[116:119], v[80:83]
    v_mfma_f32_16x16x32_bf16 v[84:87], a[80:83], v[116:119], v[84:87]
    s_waitcnt lgkmcnt(2)
    v_mfma_f32_16x16x32_bf16 v[76:79], a[84:87], v[120:123], v[76:79]
    ds_read_b128 v[136:139], v43 offset:128
    v_mfma_f32_16x16x32_bf16 v[80:83], a[88:91], v[120:123], v[80:83]
    v_mfma_f32_16x16x32_bf16 v[84:87], a[92:95], v[120:123], v[84:87]
    v_mfma_f32_16x16x32_bf16 v[76:79], a[96:99], v[124:127], v[76:79]
    ds_read_b128 v[140:143], v44 offset:0
    v_mfma_f32_16x16x32_bf16 v[80:83], a[100:103], v[124:127], v[80:83]
    ds_read_b64 v[10:11], v39 offset:53248
    v_mfma_f32_16x16x32_bf16 v[84:87], a[104:107], v[124:127], v[84:87]
    s_waitcnt lgkmcnt(3)
    v_mfma_f32_16x16x32_bf16 v[76:79], a[108:111], v[128:131], v[76:79]
    ds_read_b128 v[112:115], v44 offset:64
    v_mfma_f32_16x16x32_bf16 v[80:83], a[112:115], v[128:131], v[80:83]
    v_mfma_f32_16x16x32_bf16 v[84:87], a[116:119], v[128:131], v[84:87]
    v_mfma_f32_16x16x32_bf16 v[76:79], a[120:123], v[132:135], v[76:79]
    ds_read_b128 v[116:119], v44 offset:128
    v_mfma_f32_16x16x32_bf16 v[80:83], a[124:127], v[132:135], v[80:83]
    v_mfma_f32_16x16x32_bf16 v[84:87], a[128:131], v[132:135], v[84:87]
    s_waitcnt lgkmcnt(2)
    v_mfma_f32_16x16x32_bf16 v[76:79], a[132:135], v[136:139], v[76:79]
    ds_read_b128 v[120:123], v45 offset:0
    v_mfma_f32_16x16x32_bf16 v[80:83], a[136:139], v[136:139], v[80:83]
    buffer_store_dwordx2 v[10:11], v20, s[20:23], s5 offen sc1
    v_mfma_f32_16x16x32_bf16 v[84:87], a[140:143], v[136:139], v[84:87]
    v_mfma_f32_16x16x32_bf16 v[76:79], a[144:147], v[140:143], v[76:79]
    ds_read_b128 v[124:127], v45 offset:64
    v_mfma_f32_16x16x32_bf16 v[80:83], a[148:151], v[140:143], v[80:83]
    v_mfma_f32_16x16x32_bf16 v[84:87], a[152:155], v[140:143], v[84:87]
    s_waitcnt lgkmcnt(2)
    v_mfma_f32_16x16x32_bf16 v[76:79], a[156:159], v[112:115], v[76:79]
    ds_read_b128 v[128:131], v45 offset:128
    v_mfma_f32_16x16x32_bf16 v[80:83], a[160:163], v[112:115], v[80:83]
    v_mfma_f32_16x16x32_bf16 v[84:87], a[164:167], v[112:115], v[84:87]
    v_mfma_f32_16x16x32_bf16 v[76:79], a[168:171], v[116:119], v[76:79]
    ds_read_b128 v[132:135], v46 offset:0
    v_mfma_f32_16x16x32_bf16 v[80:83], a[172:175], v[116:119], v[80:83]
    v_mfma_f32_16x16x32_bf16 v[84:87], a[176:179], v[116:119], v[84:87]
    s_waitcnt lgkmcnt(2)
    v_mfma_f32_16x16x32_bf16 v[76:79], a[180:183], v[120:123], v[76:79]
    ds_read_b128 v[136:139], v46 offset:64
    v_mfma_f32_16x16x32_bf16 v[80:83], a[184:187], v[120:123], v[80:83]
    v_mfma_f32_16x16x32_bf16 v[84:87], a[188:191], v[120:123], v[84:87]
    v_mfma_f32_16x16x32_bf16 v[76:79], a[192:195], v[124:127], v[76:79]
    ds_read_b128 v[140:143], v46 offset:128
    v_mfma_f32_16x16x32_bf16 v[80:83], a[196:199], v[124:127], v[80:83]
    v_mfma_f32_16x16x32_bf16 v[84:87], a[200:203], v[124:127], v[84:87]
    s_waitcnt lgkmcnt(2)
    v_mfma_f32_16x16x32_bf16 v[76:79], a[204:207], v[128:131], v[76:79]
    ds_read_b128 v[112:115], v47 offset:0
    v_mfma_f32_16x16x32_bf16 v[80:83], a[208:211], v[128:131], v[80:83]
    ds_read_b128 v[116:119], v47 offset:64
    v_mfma_f32_16x16x32_bf16 v[84:87], a[212:215], v[128:131], v[84:87]
    ds_read_b128 v[120:123], v47 offset:128
    v_mfma_f32_16x16x32_bf16 v[76:79], a[216:219], v[132:135], v[76:79]
    ds_read_b128 v[124:127], v48 offset:0
    v_mfma_f32_16x16x32_bf16 v[80:83], a[220:223], v[132:135], v[80:83]
    ds_read_b128 v[128:131], v48 offset:64
    v_mfma_f32_16x16x32_bf16 v[84:87], a[224:227], v[132:135], v[84:87]
    s_waitcnt lgkmcnt(5)
    ds_read_b128 v[132:135], v48 offset:128
    v_mfma_f32_16x16x32_bf16 v[76:79], a[228:231], v[136:139], v[76:79]
    v_mfma_f32_16x16x32_bf16 v[80:83], a[232:235], v[136:139], v[80:83]
    v_mfma_f32_16x16x32_bf16 v[84:87], a[236:239], v[136:139], v[84:87]
    v_mfma_f32_16x16x32_bf16 v[76:79], a[240:243], v[140:143], v[76:79]
    v_mfma_f32_16x16x32_bf16 v[80:83], a[244:247], v[140:143], v[80:83]
    v_mfma_f32_16x16x32_bf16 v[84:87], a[248:251], v[140:143], v[84:87]
    s_waitcnt lgkmcnt(0)
    v_mfma_f32_16x16x32_bf16 v[84:87], v[192:195], v[112:115], v[84:87]
    v_mfma_f32_16x16x32_bf16 v[84:87], v[204:207], v[116:119], v[84:87]
    v_mfma_f32_16x16x32_bf16 v[84:87], v[216:219], v[120:123], v[84:87]
    v_mfma_f32_16x16x32_bf16 v[84:87], v[228:231], v[124:127], v[84:87]
    v_mfma_f32_16x16x32_bf16 v[84:87], v[240:243], v[128:131], v[84:87]
    v_mfma_f32_16x16x32_bf16 v[84:87], v[252:255], v[132:135], v[84:87]
    s_nop 2
    v_mfma_f32_16x16x32_bf16 v[76:79], a[252:255], v[112:115], v[76:79]
    s_nop 2
    v_mfma_f32_16x16x32_bf16 v[76:79], v[196:199], v[116:119], v[76:79]
    v_cvt_pk_bf16_f32 v84, v84, v85
    v_cvt_pk_bf16_f32 v85, v86, v87
    v_mfma_f32_16x16x32_bf16 v[76:79], v[208:211], v[120:123], v[76:79]
    ds_write_b64 v38, v[84:85] offset:59392
    v_mfma_f32_16x16x32_bf16 v[76:79], v[220:223], v[124:127], v[76:79]
    v_mfma_f32_16x16x32_bf16 v[76:79], v[232:235], v[128:131], v[76:79]
    v_mfma_f32_16x16x32_bf16 v[76:79], v[244:247], v[132:135], v[76:79]
    v_mfma_f32_16x16x32_bf16 v[80:83], v[188:191], v[112:115], v[80:83]
    s_waitcnt lgkmcnt(0)
    s_barrier
    v_mfma_f32_16x16x32_bf16 v[80:83], v[200:203], v[116:119], v[80:83]
    ds_read_b64 v[14:15], v39 offset:57344
    v_mfma_f32_16x16x32_bf16 v[80:83], v[212:215], v[120:123], v[80:83]
    ds_read_b64 v[62:63], v39 offset:59392
    v_mfma_f32_16x16x32_bf16 v[80:83], v[224:227], v[124:127], v[80:83]
    v_mfma_f32_16x16x32_bf16 v[80:83], v[236:239], v[128:131], v[80:83]
    v_cvt_pk_bf16_f32 v76, v76, v77
    v_cvt_pk_bf16_f32 v77, v78, v79
    v_mfma_f32_16x16x32_bf16 v[80:83], v[248:251], v[132:135], v[80:83]
    s_waitcnt lgkmcnt(0)
    buffer_store_dwordx2 v[14:15], v22, s[20:23], s75 offen sc1
    buffer_store_dwordx2 v[62:63], v22, s[20:23], s76 offen sc1
    s_nop 4
    v_cvt_pk_bf16_f32 v78, v80, v81
    v_cvt_pk_bf16_f32 v79, v82, v83
    s_nop 0
    v_permlane16_swap_b32 v76, v78
    v_permlane16_swap_b32 v77, v79
    buffer_store_dwordx4 v[76:79], v21, s[20:23], s76 offen sc1
    s_cmp_lg_u32 s63, 0
    s_cbranch_scc1 L_slow
    s_endpgm
L_y_end:
.p2align 6
L_x:
    v_and_b32 v2, 15, v0
    v_lshrrev_b32 v3, 4, v1
    s_movk_i32 s42, 192
    v_mov_b32 v34, 158976
    v_mov_b32 v147, 0
    ds_write_b32 v34, v147
    v_bfe_u32 v144, v1, 2, 2
    v_lshl_add_u32 v144, v3, 3, v144
    v_lshrrev_b32 v145, 2, v1
    v_mul_u32_u24 v144, 192, v144
    v_bfi_b32 v145, 3, v1, v145
    s_lshl_b32 s40, s2, 5
    v_and_b32 v145, 7, v145
    v_lshl_add_u32 v144, v145, 3, v144
    v_xad_u32 v15, v144, s40, 64
    v_lshl_add_u32 v13, s2, 7, v144
    s_mul_i32 s40, s57, 10368
    v_xor_b32 v14, 32, v13
    s_add_u32 s40, s40, 61440
    s_cmp_eq_u32 s80, 10
    s_cselect_b32 s41, 16, 17
    s_add_u32 m0, s24, 36864
    s_add_u32 s31, s27, 12288
    buffer_load_dwordx4 v5, s[16:19], s31 offen lds
    v_add_u32 v144, 2, v2
    v_add_u32 v147, s40, v4
    v_min_u32 v144, s41, v144
    v_lshl_add_u32 v144, v144, 3, 0
    v_bitop3_b32 v145, v144, 32, v147 bitop3:0x6a
    v_mad_u32_u24 v18, v144, 24, v145
    buffer_load_dwordx4 v6, s[16:19], s31 offen offset:1024 lds
    v_lshl_add_u32 v144, v2, 3, 8
    v_bitop3_b32 v145, v144, 32, v147 bitop3:0x6a
    v_mad_u32_u24 v17, v144, 24, v145
    v_lshl_add_u32 v144, v2, 3, 0
    v_bitop3_b32 v145, v144, 32, v147 bitop3:0x6a
    v_mad_u32_u24 v16, v144, 24, v145
    buffer_load_dwordx4 v7, s[16:19], s31 offen offset:2048 lds
    s_add_u32 m0, s25, 20736
    s_add_u32 s31, s44, 258048
    buffer_load_dwordx4 v8, s[8:11], s31 offen  lds
    s_add_u32 m0, s25, 24192
    s_add_u32 s31, s44, 301056
    buffer_load_dwordx4 v8, s[8:11], s31 offen  lds
    s_mul_i32 s31, s57, 3456
    s_add_u32 s31, s31, s24
    s_add_u32 m0, s31, 127488
    s_add_u32 s31, s28, 55296
    buffer_load_dwordx4 v5, s[16:19], s31 offen lds
    buffer_load_dwordx4 v6, s[16:19], s31 offen offset:1024 lds
    buffer_load_dwordx4 v7, s[16:19], s31 offen offset:2048 lds
    s_waitcnt vmcnt(14)
    s_barrier
    s_add_u32 m0, s24, 49152
    s_add_u32 s31, s28, 61440
    buffer_load_dwordx4 v5, s[16:19], s31 offen lds
    ds_read_b64_tr_b16 a[0:1], v13 offset:24576
    buffer_load_dwordx4 v6, s[16:19], s31 offen offset:1024 lds
    ds_read_b64_tr_b16 a[2:3], v13 offset:25344
    buffer_load_dwordx4 v7, s[16:19], s31 offen offset:2048 lds
    ds_read_b64_tr_b16 a[4:5], v14 offset:24576
    s_mov_b64 exec, 0
    s_cmp_eq_u32 s3, 0
    s_cbranch_scc1 L_pgX0
    s_cmp_eq_u32 s3, 1
    s_cbranch_scc1 L_pgX1
    s_cmp_eq_u32 s3, 2
    s_cbranch_scc1 L_pgX2
L_retX:
L_pgX2:
    s_mov_b64 exec, -1
    ds_read_b64_tr_b16 a[6:7], v14 offset:25344
    ds_read_b64_tr_b16 a[8:9], v15 offset:24576
    ds_read_b64_tr_b16 a[10:11], v15 offset:25344
    ds_read_b64_tr_b16 a[12:13], v13 offset:30720
    ds_read_b64_tr_b16 a[14:15], v13 offset:31488
    ds_read_b64_tr_b16 a[16:17], v14 offset:30720
    ds_read_b64_tr_b16 a[18:19], v14 offset:31488
    ds_read_b64_tr_b16 a[20:21], v15 offset:30720
    ds_read_b64_tr_b16 a[22:23], v15 offset:31488
    s_waitcnt lgkmcnt(0)
    s_waitcnt vmcnt(8)
    s_barrier
    ds_read_b128 v[112:115], v16 offset:0
    ds_read_b128 v[116:119], v16 offset:3456
    ds_read_b128 v[120:123], v16 offset:6912
    ds_read_b128 v[124:127], v16 offset:64
    s_waitcnt lgkmcnt(3)
    v_mfma_f32_16x16x32_bf16 v[64:67], a[0:3], v[112:115], 0
    s_add_u32 m0, s24, 0
    ds_read_b64_tr_b16 a[24:25], v13 offset:36864
    s_add_u32 s31, s28, 67584
    ds_read_b64_tr_b16 a[26:27], v13 offset:37632
    v_mfma_f32_16x16x32_bf16 v[68:71], a[4:7], v[112:115], 0
    s_mul_i32 s56, s46, 36
    ds_read_b64_tr_b16 a[28:29], v14 offset:36864
    buffer_load_dwordx4 v5, s[16:19], s31 offen lds
    v_mfma_f32_16x16x32_bf16 v[72:75], a[8:11], v[112:115], 0
    s_waitcnt lgkmcnt(5)
    ds_read_b64_tr_b16 a[30:31], v14 offset:37632
    s_movk_i32 s5, 7488
    ds_read_b64_tr_b16 a[32:33], v15 offset:36864
    v_mfma_f32_16x16x32_bf16 v[76:79], a[0:3], v[116:119], 0
    s_addk_i32 s56, 215
    ds_read_b64_tr_b16 a[34:35], v15 offset:37632
    v_add_u32 v61, 127488, v13
    v_mfma_f32_16x16x32_bf16 v[80:83], a[4:7], v[116:119], 0
    s_mul_i32 s55, s45, 36
    ds_read_b128 v[128:131], v16 offset:3520
    v_add_u32 v62, 127488, v14
    v_mfma_f32_16x16x32_bf16 v[84:87], a[8:11], v[116:119], 0
    s_waitcnt lgkmcnt(7)
    ds_read_b64_tr_b16 a[36:37], v13 offset:43008
    buffer_load_dwordx4 v6, s[16:19], s31 offen offset:1024 lds
    v_mfma_f32_16x16x32_bf16 v[88:91], a[0:3], v[120:123], 0
    s_mul_i32 s40, s57, 6912
    ds_read_b64_tr_b16 a[38:39], v13 offset:43776
    v_add_u32 v63, 127488, v15
    v_mfma_f32_16x16x32_bf16 v[92:95], a[4:7], v[120:123], 0
    s_mul_i32 s41, s57, 43008
    ds_read_b64_tr_b16 a[40:41], v14 offset:43008
    v_mul_u32_u24 v30, 1821, v0
    v_mfma_f32_16x16x32_bf16 v[96:99], a[8:11], v[120:123], 0
    s_add_u32 s41, s44, s41
    ds_read_b128 v[132:135], v16 offset:6976
    v_lshlrev_b32 v31, 4, v0
    v_mfma_f32_16x16x32_bf16 v[64:67], a[12:15], v[124:127], v[64:67]
    s_add_u32 s74, s41, 301248
    ds_read_b64_tr_b16 a[42:43], v14 offset:43776
    buffer_load_dwordx4 v7, s[16:19], s31 offen offset:2048 lds
    v_mfma_f32_16x16x32_bf16 v[68:71], a[16:19], v[124:127], v[68:71]
    s_add_u32 m0, s24, 12288
    ds_read_b64_tr_b16 a[44:45], v15 offset:43008
    v_mad_u32_u16 v30, v30, s5, v31 op_sel:[1,0,0,0]
    v_mfma_f32_16x16x32_bf16 v[72:75], a[20:23], v[124:127], v[72:75]
    s_waitcnt lgkmcnt(5)
    ds_read_b64_tr_b16 a[46:47], v15 offset:43776
    v_sub_u32 v32, s56, v0
    v_mfma_f32_16x16x32_bf16 v[76:79], a[12:15], v[128:131], v[76:79]
    s_add_u32 s31, s28, 73728
    ds_read_b128 v[136:139], v16 offset:128
    v_add_u32 v31, -252, v32
    v_mfma_f32_16x16x32_bf16 v[80:83], a[16:19], v[128:131], v[80:83]
    s_mov_b32 s5, 56448
    ds_read_b128 v[140:143], v16 offset:3584
    buffer_load_dwordx4 v5, s[16:19], s31 offen lds
    v_mfma_f32_16x16x32_bf16 v[84:87], a[20:23], v[128:131], v[84:87]
    s_waitcnt lgkmcnt(5)
    ds_read_b128 v[112:115], v16 offset:7040
    v_and_b32 v31, 2.0, v31
    v_mfma_f32_16x16x32_bf16 v[88:91], a[12:15], v[132:135], v[88:91]
    s_add_u32 s75, s41, 387264
    ds_read_b128 v[116:119], v17 offset:0
    v_add3_u32 v31, v30, v31, s5
    v_mfma_f32_16x16x32_bf16 v[92:95], a[16:19], v[132:135], v[92:95]
    s_add_u32 s76, s41, 473280
    v_and_or_b32 v30, v32, 2.0, v30
    v_subrev_u32 v40, s40, v16
    v_mfma_f32_16x16x32_bf16 v[96:99], a[20:23], v[132:135], v[96:99]
    s_waitcnt vmcnt(7) lgkmcnt(3)
    s_barrier
    v_mfma_f32_16x16x32_bf16 v[64:67], a[24:27], v[136:139], v[64:67]
    s_add_u32 s77, s41, 559296
    ds_read_b64_tr_b16 a[108:109], v61 offset:0
    buffer_load_dwordx4 v6, s[16:19], s31 offen offset:1024 lds
    v_mfma_f32_16x16x32_bf16 v[68:71], a[28:31], v[136:139], v[68:71]
    s_cmp_ge_u32 s45, 47040
    s_cselect_b32 s43, 43008, 0
    ds_read_b64_tr_b16 a[110:111], v61 offset:768
    s_sub_u32 s53, s44, s43
    ds_read_b64_tr_b16 a[112:113], v62 offset:0
    v_mfma_f32_16x16x32_bf16 v[72:75], a[32:35], v[136:139], v[72:75]
    s_waitcnt lgkmcnt(4)
    ds_read_b64_tr_b16 a[114:115], v62 offset:768
    v_subrev_u32 v41, s40, v17
    v_mfma_f32_16x16x32_bf16 v[76:79], a[24:27], v[140:143], v[76:79]
    s_mov_b32 s37, 0x3e803e80
    ds_read_b64_tr_b16 a[116:117], v63 offset:0
    v_subrev_u32 v42, s40, v18
    v_mfma_f32_16x16x32_bf16 v[80:83], a[28:31], v[140:143], v[80:83]
    s_mov_b32 s96, 0x7fff7fff
    ds_read_b64_tr_b16 a[118:119], v63 offset:768
    buffer_load_dwordx4 v7, s[16:19], s31 offen offset:2048 lds
    v_mfma_f32_16x16x32_bf16 v[84:87], a[32:35], v[140:143], v[84:87]
    s_add_u32 m0, s24, 24576
    ds_read_b128 v[120:123], v17 offset:3456
    v_lshrrev_b32 v52, 1, v4
    v_mfma_f32_16x16x32_bf16 v[88:91], a[24:27], v[112:115], v[88:91]
    s_add_u32 s31, s28, 24576
    ds_read_b64_tr_b16 a[216:217], v61 offset:9600
    v_lshl_or_b32 v21, v4, 1, v52
    v_mfma_f32_16x16x32_bf16 v[92:95], a[28:31], v[112:115], v[92:95]
    s_mov_b32 s60, 0x435f435f
    ds_read_b64_tr_b16 a[218:219], v61 offset:10368
    v_and_b32 v21, 48, v21
    v_mfma_f32_16x16x32_bf16 v[96:99], a[32:35], v[112:115], v[96:99]
    s_waitcnt lgkmcnt(5)
    ds_read_b64_tr_b16 a[220:221], v62 offset:9600
    buffer_load_dwordx4 v5, s[16:19], s31 offen lds
    v_mfma_f32_16x16x32_bf16 v[64:67], a[36:39], v[116:119], v[64:67]
    s_lshl_b32 s4, s57, 10
    ds_read_b128 v[124:127], v17 offset:6912
    v_lshl_add_u32 v21, s2, 7, v21
    v_mfma_f32_16x16x32_bf16 v[68:71], a[40:43], v[116:119], v[68:71]
    s_add_u32 s56, s44, 43200
    ds_read_b64_tr_b16 a[222:223], v62 offset:10368
    v_mad_u32_u24 v19, v2, s42, v21
    v_mfma_f32_16x16x32_bf16 v[72:75], a[44:47], v[116:119], v[72:75]
    s_waitcnt lgkmcnt(5)
    ds_read_b64_tr_b16 a[224:225], v63 offset:9600
    v_lshl_add_u32 v53, s2, 2, v3
    v_mfma_f32_16x16x32_bf16 v[76:79], a[36:39], v[120:123], v[76:79]
    ds_read_b64_tr_b16 a[226:227], v63 offset:10368
    buffer_load_dwordx4 v6, s[16:19], s31 offen offset:1024 lds
    v_mfma_f32_16x16x32_bf16 v[80:83], a[40:43], v[120:123], v[80:83]
    ds_read_b128 v[128:131], v16 offset:3456
    v_lshrrev_b32 v52, 1, v2
    v_mfma_f32_16x16x32_bf16 v[84:87], a[44:47], v[120:123], v[84:87]
    s_waitcnt lgkmcnt(4)
    ds_read_b128 v[132:135], v16 offset:6912
    v_bitop3_b32 v52, v52, 6, v53 bitop3:0x6a
    v_mfma_f32_16x16x32_bf16 v[88:91], a[36:39], v[124:127], v[88:91]
    v_lshl_add_u32 v52, v2, 3, v52
    v_lshl_add_u32 v38, v52, 3, s4
    v_mfma_f32_16x16x32_bf16 v[92:95], a[40:43], v[124:127], v[92:95]
    buffer_load_dwordx4 v7, s[16:19], s31 offen offset:2048 lds
    v_mfma_f32_16x16x32_bf16 v[96:99], a[44:47], v[124:127], v[96:99]
    s_waitcnt vmcnt(6) lgkmcnt(1)
    s_barrier
    v_mfma_f32_16x16x32_bf16 v[64:67], a[108:111], v[128:131], v[64:67]
    s_add_u32 m0, s24, 36864
    ds_read_b128 v[136:139], v16 offset:10368
    v_mad_u32_u24 v21, v2, s42, v21
    v_mfma_f32_16x16x32_bf16 v[68:71], a[112:115], v[128:131], v[68:71]
    s_add_u32 s31, s26, 135168
    ds_read_b64_tr_b16 a[120:121], v13 offset:49152
    v_lshlrev_b32 v39, 3, v0
    v_mfma_f32_16x16x32_bf16 v[72:75], a[116:119], v[128:131], v[72:75]
    s_waitcnt lgkmcnt(2)
    ds_read_b64_tr_b16 a[122:123], v13 offset:49920
    buffer_load_dwordx4 v5, s[16:19], s31 offen lds
    v_mfma_f32_16x16x32_bf16 v[76:79], a[108:111], v[132:135], v[76:79]
    s_mul_i32 s4, s57, 129024
    ds_read_b64_tr_b16 a[124:125], v14 offset:49152
    v_lshrrev_b32 v22, 1, v0
    v_mfma_f32_16x16x32_bf16 v[80:83], a[112:115], v[132:135], v[80:83]
    s_add_u32 s56, s56, s4
    ds_read_b128 v[140:143], v16 offset:13824
    v_bitop3_b32 v22, v22, 48, v39 bitop3:0x6a
    v_mfma_f32_16x16x32_bf16 v[84:87], a[116:119], v[132:135], v[84:87]
    s_waitcnt lgkmcnt(4)
    ds_read_b64_tr_b16 a[126:127], v14 offset:49920
    v_bfe_u32 v37, v0, 3, 4
    v_mfma_f32_16x16x32_bf16 v[88:91], a[108:111], v[136:139], v[88:91]
    s_add_u32 s4, s56, 43008
    ds_read_b64_tr_b16 a[128:129], v15 offset:49152
    buffer_load_dwordx4 v6, s[16:19], s31 offen offset:1024 lds
    v_mfma_f32_16x16x32_bf16 v[92:95], a[112:115], v[136:139], v[92:95]
    s_add_u32 s5, s56, 86016
    ds_read_b64_tr_b16 a[130:131], v15 offset:49920
    v_and_or_b32 v22, v22, 56, 64
    v_mfma_f32_16x16x32_bf16 v[96:99], a[116:119], v[136:139], v[96:99]
    ds_read_b128 v[112:115], v16 offset:3520
    v_mad_u32_u24 v20, v37, s42, v22
    v_mfma_f32_16x16x32_bf16 v[64:67], a[216:219], v[132:135], v[64:67]
    ds_read_b64_tr_b16 a[228:229], v13 offset:55296
    v_mad_u32_u24 v22, v37, s42, v22
    v_mfma_f32_16x16x32_bf16 v[68:71], a[220:223], v[132:135], v[68:71]
    ds_read_b64_tr_b16 a[230:231], v13 offset:56064
    buffer_load_dwordx4 v7, s[16:19], s31 offen offset:2048 lds
    v_mfma_f32_16x16x32_bf16 v[72:75], a[224:227], v[132:135], v[72:75]
    s_mul_i32 s31, s57, 3456
    ds_read_b64_tr_b16 a[232:233], v14 offset:55296
    s_add_u32 s31, s31, s24
    v_mfma_f32_16x16x32_bf16 v[76:79], a[216:219], v[136:139], v[76:79]
    s_add_u32 m0, s31, 127488
    ds_read_b128 v[116:119], v16 offset:6976
    s_add_u32 s31, s28, 86016
    v_mfma_f32_16x16x32_bf16 v[80:83], a[220:223], v[136:139], v[80:83]
    ds_read_b64_tr_b16 a[234:235], v14 offset:56064
    v_mfma_f32_16x16x32_bf16 v[84:87], a[224:227], v[136:139], v[84:87]
    s_waitcnt lgkmcnt(5)
    ds_read_b64_tr_b16 a[236:237], v15 offset:55296
    buffer_load_dwordx4 v5, s[16:19], s31 offen lds
    v_mfma_f32_16x16x32_bf16 v[88:91], a[216:219], v[140:143], v[88:91]
L_pgX0:
  s_cbranch_execz L_retX
    ds_read_b64_tr_b16 a[238:239], v15 offset:56064
    v_mfma_f32_16x16x32_bf16 v[92:95], a[220:223], v[140:143], v[92:95]
    ds_read_b128 v[120:123], v16 offset:10432
    v_mfma_f32_16x16x32_bf16 v[96:99], a[224:227], v[140:143], v[96:99]
    ds_read_b64_tr_b16 a[132:133], v13 offset:0
    v_mfma_f32_16x16x32_bf16 v[64:67], a[120:123], v[112:115], v[64:67]
    ds_read_b64_tr_b16 a[134:135], v13 offset:768
    buffer_load_dwordx4 v6, s[16:19], s31 offen offset:1024 lds
    v_mfma_f32_16x16x32_bf16 v[68:71], a[124:127], v[112:115], v[68:71]
    ds_read_b64_tr_b16 a[136:137], v14 offset:0
    v_mfma_f32_16x16x32_bf16 v[72:75], a[128:131], v[112:115], v[72:75]
    s_waitcnt lgkmcnt(5)
    ds_read_b64_tr_b16 a[138:139], v14 offset:768
    v_mfma_f32_16x16x32_bf16 v[76:79], a[120:123], v[116:119], v[76:79]
    ds_read_b64_tr_b16 a[140:141], v15 offset:0
    v_mfma_f32_16x16x32_bf16 v[80:83], a[124:127], v[116:119], v[80:83]
    ds_read_b64_tr_b16 a[142:143], v15 offset:768
    buffer_load_dwordx4 v7, s[16:19], s31 offen offset:2048 lds
    v_mfma_f32_16x16x32_bf16 v[84:87], a[128:131], v[116:119], v[84:87]
    s_waitcnt lgkmcnt(5)
    ds_read_b64_tr_b16 a[240:241], v13 offset:6144
    s_add_u32 m0, s24, 49152
    v_mfma_f32_16x16x32_bf16 v[88:91], a[120:123], v[120:123], v[88:91]
    s_add_u32 s31, s28, 36864
    ds_read_b64_tr_b16 a[242:243], v13 offset:6912
    v_mfma_f32_16x16x32_bf16 v[92:95], a[124:127], v[120:123], v[92:95]
    ds_read_b64_tr_b16 a[244:245], v14 offset:6144
    v_mfma_f32_16x16x32_bf16 v[96:99], a[128:131], v[120:123], v[96:99]
    ds_read_b128 v[124:127], v16 offset:13888
    v_mfma_f32_16x16x32_bf16 v[64:67], a[228:231], v[116:119], v[64:67]
    ds_read_b64_tr_b16 a[246:247], v14 offset:6912
    v_mfma_f32_16x16x32_bf16 v[68:71], a[232:235], v[116:119], v[68:71]
    ds_read_b64_tr_b16 a[248:249], v15 offset:6144
    v_mfma_f32_16x16x32_bf16 v[72:75], a[236:239], v[116:119], v[72:75]
    ds_read_b64_tr_b16 a[250:251], v15 offset:6912
    v_mfma_f32_16x16x32_bf16 v[76:79], a[228:231], v[120:123], v[76:79]
    ds_read_b128 v[128:131], v16 offset:3584
    v_mfma_f32_16x16x32_bf16 v[80:83], a[232:235], v[120:123], v[80:83]
    ds_read_b128 v[132:135], v16 offset:7040
    v_mfma_f32_16x16x32_bf16 v[84:87], a[236:239], v[120:123], v[84:87]
    s_waitcnt lgkmcnt(5)
    ds_read_b128 v[136:139], v16 offset:10496
    v_mfma_f32_16x16x32_bf16 v[88:91], a[228:231], v[124:127], v[88:91]
    v_mfma_f32_16x16x32_bf16 v[92:95], a[232:235], v[124:127], v[92:95]
    v_mfma_f32_16x16x32_bf16 v[96:99], a[236:239], v[124:127], v[96:99]
    s_waitcnt vmcnt(6) lgkmcnt(2)
    s_barrier
    v_mfma_f32_16x16x32_bf16 v[64:67], a[132:135], v[128:131], v[64:67]
    ds_read_b64_tr_b16 a[144:145], v13 offset:12288
    buffer_load_dwordx4 v5, s[16:19], s31 offen lds
    v_mfma_f32_16x16x32_bf16 v[68:71], a[136:139], v[128:131], v[68:71]
    ds_read_b64_tr_b16 a[146:147], v13 offset:13056
    v_mfma_f32_16x16x32_bf16 v[72:75], a[140:143], v[128:131], v[72:75]
    s_waitcnt lgkmcnt(2)
    ds_read_b64_tr_b16 a[148:149], v14 offset:12288
    v_mfma_f32_16x16x32_bf16 v[76:79], a[132:135], v[132:135], v[76:79]
    ds_read_b128 v[140:143], v16 offset:13952
    v_mfma_f32_16x16x32_bf16 v[80:83], a[136:139], v[132:135], v[80:83]
    ds_read_b64_tr_b16 a[150:151], v14 offset:13056
    buffer_load_dwordx4 v6, s[16:19], s31 offen offset:1024 lds
    v_mfma_f32_16x16x32_bf16 v[84:87], a[140:143], v[132:135], v[84:87]
    ds_read_b64_tr_b16 a[152:153], v15 offset:12288
    v_mfma_f32_16x16x32_bf16 v[88:91], a[132:135], v[136:139], v[88:91]
    ds_read_b64_tr_b16 a[154:155], v15 offset:13056
    v_mfma_f32_16x16x32_bf16 v[92:95], a[136:139], v[136:139], v[92:95]
    ds_read_b128 v[112:115], v17 offset:3456
    v_mfma_f32_16x16x32_bf16 v[96:99], a[140:143], v[136:139], v[96:99]
    ds_read_b64_tr_b16 a[252:253], v13 offset:18432
    buffer_load_dwordx4 v7, s[16:19], s31 offen offset:2048 lds
    v_mfma_f32_16x16x32_bf16 v[64:67], a[240:243], v[132:135], v[64:67]
    s_add_u32 m0, s24, 0
    ds_read_b64_tr_b16 a[254:255], v13 offset:19200
    s_add_u32 s31, s26, 147456
    v_mfma_f32_16x16x32_bf16 v[68:71], a[244:247], v[132:135], v[68:71]
    ds_read_b64_tr_b16 v[188:189], v14 offset:18432
    v_mfma_f32_16x16x32_bf16 v[72:75], a[248:251], v[132:135], v[72:75]
    ds_read_b128 v[116:119], v17 offset:6912
    v_mfma_f32_16x16x32_bf16 v[76:79], a[240:243], v[136:139], v[76:79]
    ds_read_b64_tr_b16 v[190:191], v14 offset:19200
    buffer_load_dwordx4 v5, s[16:19], s31 offen lds
    v_mfma_f32_16x16x32_bf16 v[80:83], a[244:247], v[136:139], v[80:83]
    ds_read_b64_tr_b16 v[192:193], v15 offset:18432
    v_mfma_f32_16x16x32_bf16 v[84:87], a[248:251], v[136:139], v[84:87]
    s_waitcnt lgkmcnt(5)
    ds_read_b64_tr_b16 v[194:195], v15 offset:19200
    v_mfma_f32_16x16x32_bf16 v[88:91], a[240:243], v[140:143], v[88:91]
    ds_read_b128 v[120:123], v17 offset:10368
    v_mfma_f32_16x16x32_bf16 v[92:95], a[244:247], v[140:143], v[92:95]
    buffer_load_dwordx4 v6, s[16:19], s31 offen offset:1024 lds
    v_mfma_f32_16x16x32_bf16 v[96:99], a[248:251], v[140:143], v[96:99]
    ds_read_b64_tr_b16 a[48:49], v13 offset:24576
    v_mfma_f32_16x16x32_bf16 v[64:67], a[144:147], v[112:115], v[64:67]
    ds_read_b64_tr_b16 a[50:51], v13 offset:25344
    v_mfma_f32_16x16x32_bf16 v[68:71], a[148:151], v[112:115], v[68:71]
    ds_read_b64_tr_b16 a[52:53], v14 offset:24576
    v_mfma_f32_16x16x32_bf16 v[72:75], a[152:155], v[112:115], v[72:75]
    s_waitcnt lgkmcnt(4)
    buffer_load_dwordx4 v7, s[16:19], s31 offen offset:2048 lds
    v_mfma_f32_16x16x32_bf16 v[76:79], a[144:147], v[116:119], v[76:79]
    s_add_u32 m0, s24, 12288
    ds_read_b64_tr_b16 a[54:55], v14 offset:25344
    s_add_u32 s31, s28, 98304
    v_mfma_f32_16x16x32_bf16 v[80:83], a[148:151], v[116:119], v[80:83]
    ds_read_b64_tr_b16 a[56:57], v15 offset:24576
    v_mfma_f32_16x16x32_bf16 v[84:87], a[152:155], v[116:119], v[84:87]
    s_waitcnt lgkmcnt(4)
    ds_read_b64_tr_b16 a[58:59], v15 offset:25344
    v_mfma_f32_16x16x32_bf16 v[88:91], a[144:147], v[120:123], v[88:91]
    ds_read_b64_tr_b16 a[156:157], v13 offset:30720
    v_mfma_f32_16x16x32_bf16 v[92:95], a[148:151], v[120:123], v[92:95]
    ds_read_b64_tr_b16 a[158:159], v13 offset:31488
    v_mfma_f32_16x16x32_bf16 v[96:99], a[152:155], v[120:123], v[96:99]
    ds_read_b64_tr_b16 a[160:161], v14 offset:30720
    v_mfma_f32_16x16x32_bf16 v[64:67], a[252:255], v[116:119], v[64:67]
    ds_read_b128 v[124:127], v17 offset:13824
    v_mfma_f32_16x16x32_bf16 v[68:71], v[188:191], v[116:119], v[68:71]
    ds_read_b64_tr_b16 a[162:163], v14 offset:31488
    v_mfma_f32_16x16x32_bf16 v[72:75], v[192:195], v[116:119], v[72:75]
    ds_read_b64_tr_b16 a[164:165], v15 offset:30720
    v_mfma_f32_16x16x32_bf16 v[76:79], a[252:255], v[120:123], v[76:79]
    ds_read_b64_tr_b16 a[166:167], v15 offset:31488
    v_mfma_f32_16x16x32_bf16 v[80:83], v[188:191], v[120:123], v[80:83]
    ds_read_b128 v[128:131], v17 offset:64
    v_mfma_f32_16x16x32_bf16 v[84:87], v[192:195], v[120:123], v[84:87]
    s_waitcnt lgkmcnt(4)
    ds_read_b128 v[132:135], v17 offset:3520
    v_mfma_f32_16x16x32_bf16 v[88:91], a[252:255], v[124:127], v[88:91]
    ds_read_b128 v[136:139], v17 offset:6976
    v_mfma_f32_16x16x32_bf16 v[92:95], v[188:191], v[124:127], v[92:95]
    v_mfma_f32_16x16x32_bf16 v[96:99], v[192:195], v[124:127], v[96:99]
    s_waitcnt vmcnt(6) lgkmcnt(2)
    s_barrier
    v_mfma_f32_16x16x32_bf16 v[64:67], a[48:51], v[128:131], v[64:67]
    buffer_load_dwordx4 v5, s[16:19], s31 offen lds
    v_mfma_f32_16x16x32_bf16 v[68:71], a[52:55], v[128:131], v[68:71]
    ds_read_b64_tr_b16 v[196:197], v13 offset:36864
    v_mfma_f32_16x16x32_bf16 v[72:75], a[56:59], v[128:131], v[72:75]
    s_waitcnt lgkmcnt(2)
    ds_read_b64_tr_b16 v[198:199], v13 offset:37632
    v_mfma_f32_16x16x32_bf16 v[76:79], a[48:51], v[132:135], v[76:79]
    ds_read_b64_tr_b16 v[200:201], v14 offset:36864
    v_mfma_f32_16x16x32_bf16 v[80:83], a[52:55], v[132:135], v[80:83]
    buffer_load_dwordx4 v6, s[16:19], s31 offen offset:1024 lds
    v_mfma_f32_16x16x32_bf16 v[84:87], a[56:59], v[132:135], v[84:87]
    s_waitcnt lgkmcnt(3)
    ds_read_b128 v[140:143], v17 offset:10432
    v_mfma_f32_16x16x32_bf16 v[88:91], a[48:51], v[136:139], v[88:91]
    ds_read_b64_tr_b16 v[202:203], v14 offset:37632
    v_mfma_f32_16x16x32_bf16 v[92:95], a[52:55], v[136:139], v[92:95]
    ds_read_b64_tr_b16 v[204:205], v15 offset:36864
    v_mfma_f32_16x16x32_bf16 v[96:99], a[56:59], v[136:139], v[96:99]
    ds_read_b64_tr_b16 v[206:207], v15 offset:37632
    buffer_load_dwordx4 v7, s[16:19], s31 offen offset:2048 lds
    v_mfma_f32_16x16x32_bf16 v[64:67], a[156:159], v[132:135], v[64:67]
    s_add_u32 m0, s24, 24576
    ds_read_b64_tr_b16 a[60:61], v13 offset:43008
    s_add_u32 s31, s28, 49152
    v_mfma_f32_16x16x32_bf16 v[68:71], a[160:163], v[132:135], v[68:71]
    ds_read_b64_tr_b16 a[62:63], v13 offset:43776
    v_mfma_f32_16x16x32_bf16 v[72:75], a[164:167], v[132:135], v[72:75]
    ds_read_b64_tr_b16 a[64:65], v14 offset:43008
    v_mfma_f32_16x16x32_bf16 v[76:79], a[156:159], v[136:139], v[76:79]
    buffer_load_dwordx4 v5, s[16:19], s31 offen lds
    v_mfma_f32_16x16x32_bf16 v[80:83], a[160:163], v[136:139], v[80:83]
    ds_read_b128 v[112:115], v17 offset:13888
    v_mfma_f32_16x16x32_bf16 v[84:87], a[164:167], v[136:139], v[84:87]
    s_waitcnt lgkmcnt(4)
    ds_read_b64_tr_b16 a[66:67], v14 offset:43776
    v_mfma_f32_16x16x32_bf16 v[88:91], a[156:159], v[140:143], v[88:91]
    ds_read_b64_tr_b16 a[68:69], v15 offset:43008
    v_mfma_f32_16x16x32_bf16 v[92:95], a[160:163], v[140:143], v[92:95]
    ds_read_b64_tr_b16 a[70:71], v15 offset:43776
    buffer_load_dwordx4 v6, s[16:19], s31 offen offset:1024 lds
    v_mfma_f32_16x16x32_bf16 v[96:99], a[164:167], v[140:143], v[96:99]
    ds_read_b128 v[116:119], v17 offset:128
    v_mfma_f32_16x16x32_bf16 v[64:67], v[196:199], v[136:139], v[64:67]
    ds_read_b128 v[120:123], v17 offset:3584
    v_mfma_f32_16x16x32_bf16 v[68:71], v[200:203], v[136:139], v[68:71]
    ds_read_b64_tr_b16 a[168:169], v61 offset:0
    v_mfma_f32_16x16x32_bf16 v[72:75], v[204:207], v[136:139], v[72:75]
    buffer_load_dwordx4 v7, s[16:19], s31 offen offset:2048 lds
    v_mfma_f32_16x16x32_bf16 v[76:79], v[196:199], v[140:143], v[76:79]
    s_lshl_b32 s31, s2, 5
    ds_read_b64_tr_b16 a[170:171], v61 offset:768
    v_xor_b32 v5, s31, v5
    v_mfma_f32_16x16x32_bf16 v[80:83], v[200:203], v[140:143], v[80:83]
    s_lshr_b32 s31, s24, 1
    ds_read_b64_tr_b16 a[172:173], v62 offset:0
    s_add_u32 m0, s31, 36864
    v_mfma_f32_16x16x32_bf16 v[84:87], v[204:207], v[140:143], v[84:87]
    s_waitcnt lgkmcnt(4)
    ds_read_b128 v[124:127], v17 offset:7040
    s_add_u32 s31, s31, 159744
    v_mfma_f32_16x16x32_bf16 v[88:91], v[196:199], v[112:115], v[88:91]
    ds_read_b64_tr_b16 a[174:175], v62 offset:768
    v_mfma_f32_16x16x32_bf16 v[92:95], v[200:203], v[112:115], v[92:95]
    ds_read_b64_tr_b16 a[176:177], v63 offset:0
    v_mfma_f32_16x16x32_bf16 v[96:99], v[204:207], v[112:115], v[96:99]
    ds_read_b64_tr_b16 a[178:179], v63 offset:768
    v_mfma_f32_16x16x32_bf16 v[64:67], a[60:63], v[116:119], v[64:67]
    ds_read_b64_tr_b16 v[208:209], v61 offset:9600
    v_mfma_f32_16x16x32_bf16 v[68:71], a[64:67], v[116:119], v[68:71]
    ds_read_b64_tr_b16 v[210:211], v61 offset:10368
    v_mfma_f32_16x16x32_bf16 v[72:75], a[68:71], v[116:119], v[72:75]
    s_waitcnt lgkmcnt(5)
    ds_read_b64_tr_b16 v[212:213], v62 offset:9600
    v_mfma_f32_16x16x32_bf16 v[76:79], a[60:63], v[120:123], v[76:79]
    ds_read_b128 v[128:131], v17 offset:10496
    v_mfma_f32_16x16x32_bf16 v[80:83], a[64:67], v[120:123], v[80:83]
    ds_read_b64_tr_b16 v[214:215], v62 offset:10368
    v_mfma_f32_16x16x32_bf16 v[84:87], a[68:71], v[120:123], v[84:87]
    ds_read_b64_tr_b16 v[216:217], v63 offset:9600
    v_mfma_f32_16x16x32_bf16 v[88:91], a[60:63], v[124:127], v[88:91]
    ds_read_b64_tr_b16 v[218:219], v63 offset:10368
    v_mfma_f32_16x16x32_bf16 v[92:95], a[64:67], v[124:127], v[92:95]
    v_mfma_f32_16x16x32_bf16 v[96:99], a[68:71], v[124:127], v[96:99]
    s_waitcnt vmcnt(6) lgkmcnt(4)
    s_barrier
    v_mfma_f32_16x16x32_bf16 v[64:67], a[168:171], v[120:123], v[64:67]
    ds_read_b64_tr_b16 a[72:73], v13 offset:49152
    buffer_load_dwordx4 v5, s[16:19], s31 offen lds
    v_mfma_f32_16x16x32_bf16 v[68:71], a[172:175], v[120:123], v[68:71]
    ds_read_b64_tr_b16 a[74:75], v13 offset:49920
    v_mfma_f32_16x16x32_bf16 v[72:75], a[176:179], v[120:123], v[72:75]
    ds_read_b64_tr_b16 a[76:77], v14 offset:49152
    v_mfma_f32_16x16x32_bf16 v[76:79], a[168:171], v[124:127], v[76:79]
    ds_read_b128 v[132:135], v17 offset:13952
    v_mfma_f32_16x16x32_bf16 v[80:83], a[172:175], v[124:127], v[80:83]
    buffer_load_dwordx4 v5, s[16:19], s31 offen offset:512 lds
    v_mfma_f32_16x16x32_bf16 v[84:87], a[176:179], v[124:127], v[84:87]
    s_waitcnt lgkmcnt(4)
    ds_read_b64_tr_b16 a[78:79], v14 offset:49920
    s_add_u32 m0, s25, 27648
    v_mfma_f32_16x16x32_bf16 v[88:91], a[168:171], v[128:131], v[88:91]
    s_add_u32 s31, s44, 344064
    ds_read_b64_tr_b16 a[80:81], v15 offset:49152
    v_mfma_f32_16x16x32_bf16 v[92:95], a[172:175], v[128:131], v[92:95]
    ds_read_b64_tr_b16 a[82:83], v15 offset:49920
    v_mfma_f32_16x16x32_bf16 v[96:99], a[176:179], v[128:131], v[96:99]
    buffer_load_dwordx4 v8, s[8:11], s31 offen  lds
    v_mfma_f32_16x16x32_bf16 v[64:67], v[208:211], v[124:127], v[64:67]
    s_add_u32 m0, s25, 31104
    ds_read_b128 v[136:139], v18 offset:0
    s_add_u32 s31, s44, 387072
    v_mfma_f32_16x16x32_bf16 v[68:71], v[212:215], v[124:127], v[68:71]
    ds_read_b128 v[140:143], v18 offset:3456
    v_mfma_f32_16x16x32_bf16 v[72:75], v[216:219], v[124:127], v[72:75]
    ds_read_b64_tr_b16 a[180:181], v13 offset:55296
    v_mfma_f32_16x16x32_bf16 v[76:79], v[208:211], v[128:131], v[76:79]
    buffer_load_dwordx4 v8, s[8:11], s31 offen  lds
    v_mfma_f32_16x16x32_bf16 v[80:83], v[212:215], v[128:131], v[80:83]
    ds_read_b64_tr_b16 a[182:183], v13 offset:56064
    v_mfma_f32_16x16x32_bf16 v[84:87], v[216:219], v[128:131], v[84:87]
    s_waitcnt lgkmcnt(4)
    ds_read_b64_tr_b16 a[184:185], v14 offset:55296
    v_mfma_f32_16x16x32_bf16 v[88:91], v[208:211], v[132:135], v[88:91]
    ds_read_b128 v[112:115], v18 offset:6912
    v_mfma_f32_16x16x32_bf16 v[92:95], v[212:215], v[132:135], v[92:95]
    ds_read_b64_tr_b16 a[186:187], v14 offset:56064
    v_mfma_f32_16x16x32_bf16 v[96:99], v[216:219], v[132:135], v[96:99]
    s_waitcnt lgkmcnt(4)
    ds_read_b64_tr_b16 a[188:189], v15 offset:55296
    v_mfma_f32_16x16x32_bf16 v[64:67], a[72:75], v[136:139], v[64:67]
    buffer_load_dwordx4 v[180:183], v30, s[12:15], s55 offen
    v_mfma_f32_16x16x32_bf16 v[68:71], a[76:79], v[136:139], v[68:71]
    ds_read_b64_tr_b16 a[190:191], v15 offset:56064
    v_mfma_f32_16x16x32_bf16 v[72:75], a[80:83], v[136:139], v[72:75]
    ds_read_b64_tr_b16 v[220:221], v13 offset:0
    v_mfma_f32_16x16x32_bf16 v[76:79], a[72:75], v[140:143], v[76:79]
    ds_read_b64_tr_b16 v[222:223], v13 offset:768
    v_mfma_f32_16x16x32_bf16 v[80:83], a[76:79], v[140:143], v[80:83]
    buffer_load_dwordx4 v[184:187], v31, s[12:15], s55 offen
    v_mfma_f32_16x16x32_bf16 v[84:87], a[80:83], v[140:143], v[84:87]
    s_waitcnt lgkmcnt(3)
    ds_read_b64_tr_b16 v[224:225], v14 offset:0
    s_add_u32 m0, s25, 34560
    v_mfma_f32_16x16x32_bf16 v[88:91], a[72:75], v[112:115], v[88:91]
    s_add_u32 s31, s44, 430080
    ds_read_b128 v[116:119], v18 offset:10368
    v_mfma_f32_16x16x32_bf16 v[92:95], a[76:79], v[112:115], v[92:95]
    ds_read_b64_tr_b16 v[226:227], v14 offset:768
    v_mfma_f32_16x16x32_bf16 v[96:99], a[80:83], v[112:115], v[96:99]
    s_waitcnt lgkmcnt(4)
    buffer_load_dwordx4 v8, s[8:11], s31 offen  lds
    v_mfma_f32_16x16x32_bf16 v[64:67], a[180:183], v[140:143], v[64:67]
    s_add_u32 m0, s25, 38016
    ds_read_b64_tr_b16 v[228:229], v15 offset:0
    s_add_u32 s31, s44, 473088
    v_mfma_f32_16x16x32_bf16 v[68:71], a[184:187], v[140:143], v[68:71]
    ds_read_b64_tr_b16 v[230:231], v15 offset:768
    v_mfma_f32_16x16x32_bf16 v[72:75], a[188:191], v[140:143], v[72:75]
    ds_read_b64_tr_b16 a[84:85], v13 offset:6144
    v_mfma_f32_16x16x32_bf16 v[76:79], a[180:183], v[112:115], v[76:79]
    buffer_load_dwordx4 v8, s[8:11], s31 offen  lds
    v_mfma_f32_16x16x32_bf16 v[80:83], a[184:187], v[112:115], v[80:83]
    s_add_u32 m0, s25, 41472
    ds_read_b64_tr_b16 a[86:87], v13 offset:6912
    s_add_u32 s31, s44, 516096
    v_mfma_f32_16x16x32_bf16 v[84:87], a[188:191], v[112:115], v[84:87]
    s_waitcnt lgkmcnt(4)
    ds_read_b64_tr_b16 a[88:89], v14 offset:6144
    v_mfma_f32_16x16x32_bf16 v[88:91], a[180:183], v[116:119], v[88:91]
    ds_read_b128 v[120:123], v18 offset:13824
    v_mfma_f32_16x16x32_bf16 v[92:95], a[184:187], v[116:119], v[92:95]
    ds_read_b64_tr_b16 a[90:91], v14 offset:6912
    v_mfma_f32_16x16x32_bf16 v[96:99], a[188:191], v[116:119], v[96:99]
    s_waitcnt vmcnt(8) lgkmcnt(4)
    s_barrier
    v_mfma_f32_16x16x32_bf16 v[64:67], v[220:223], v[112:115], v[64:67]
    buffer_load_dwordx4 v8, s[8:11], s31 offen  lds
    v_mfma_f32_16x16x32_bf16 v[68:71], v[224:227], v[112:115], v[68:71]
    s_add_u32 m0, s25, 44928
    ds_read_b64_tr_b16 a[92:93], v15 offset:6144
    s_add_u32 s31, s44, 559104
    v_mfma_f32_16x16x32_bf16 v[72:75], v[228:231], v[112:115], v[72:75]
    ds_read_b64_tr_b16 a[94:95], v15 offset:6912
    v_mfma_f32_16x16x32_bf16 v[76:79], v[220:223], v[116:119], v[76:79]
    ds_read_b128 v[124:127], v18 offset:64
    v_mfma_f32_16x16x32_bf16 v[80:83], v[224:227], v[116:119], v[80:83]
    buffer_load_dwordx4 v8, s[8:11], s31 offen  lds
    v_mfma_f32_16x16x32_bf16 v[84:87], v[228:231], v[116:119], v[84:87]
    s_waitcnt lgkmcnt(3)
    ds_read_b128 v[128:131], v18 offset:3520
    s_add_u32 m0, s25, 48384
    v_mfma_f32_16x16x32_bf16 v[88:91], v[220:223], v[120:123], v[88:91]
    s_add_u32 s31, s44, 602112
    ds_read_b64_tr_b16 a[192:193], v13 offset:12288
    v_mfma_f32_16x16x32_bf16 v[92:95], v[224:227], v[120:123], v[92:95]
    ds_read_b64_tr_b16 a[194:195], v13 offset:13056
    v_mfma_f32_16x16x32_bf16 v[96:99], v[228:231], v[120:123], v[96:99]
    s_waitcnt lgkmcnt(3)
    ds_read_b64_tr_b16 a[196:197], v14 offset:12288
    v_mfma_f32_16x16x32_bf16 v[64:67], a[84:87], v[124:127], v[64:67]
    ds_read_b128 v[132:135], v18 offset:6976
    v_mfma_f32_16x16x32_bf16 v[68:71], a[88:91], v[124:127], v[68:71]
    ds_read_b64_tr_b16 a[198:199], v14 offset:13056
    v_mfma_f32_16x16x32_bf16 v[72:75], a[92:95], v[124:127], v[72:75]
    s_waitcnt lgkmcnt(5)
    ds_read_b64_tr_b16 a[200:201], v15 offset:12288
    v_mfma_f32_16x16x32_bf16 v[76:79], a[84:87], v[128:131], v[76:79]
    ds_read_b64_tr_b16 a[202:203], v15 offset:13056
    v_mfma_f32_16x16x32_bf16 v[80:83], a[88:91], v[128:131], v[80:83]
    ds_read_b64_tr_b16 v[232:233], v13 offset:18432
    v_mfma_f32_16x16x32_bf16 v[84:87], a[92:95], v[128:131], v[84:87]
    s_waitcnt lgkmcnt(4)
    ds_read_b64_tr_b16 v[234:235], v13 offset:19200
    v_mfma_f32_16x16x32_bf16 v[88:91], a[84:87], v[132:135], v[88:91]
    ds_read_b64_tr_b16 v[236:237], v14 offset:18432
    v_mfma_f32_16x16x32_bf16 v[92:95], a[88:91], v[132:135], v[92:95]
    ds_read_b128 v[136:139], v18 offset:10432
    v_mfma_f32_16x16x32_bf16 v[96:99], a[92:95], v[132:135], v[96:99]
    s_waitcnt lgkmcnt(4)
    ds_read_b64_tr_b16 v[238:239], v14 offset:19200
    v_mfma_f32_16x16x32_bf16 v[64:67], a[192:195], v[128:131], v[64:67]
    buffer_load_dwordx4 v8, s[8:11], s31 offen  lds
    v_mfma_f32_16x16x32_bf16 v[68:71], a[196:199], v[128:131], v[68:71]
    s_add_u32 m0, s25, 51840
    ds_read_b64_tr_b16 v[240:241], v15 offset:18432
    s_add_u32 s31, s53, 645120
    v_mfma_f32_16x16x32_bf16 v[72:75], a[200:203], v[128:131], v[72:75]
    ds_read_b64_tr_b16 v[242:243], v15 offset:19200
    v_mfma_f32_16x16x32_bf16 v[76:79], a[192:195], v[132:135], v[76:79]
    ds_read_b64_tr_b16 a[96:97], v13 offset:24576
    v_mfma_f32_16x16x32_bf16 v[80:83], a[196:199], v[132:135], v[80:83]
    buffer_load_dwordx4 v8, s[8:11], s31 offen  lds
    v_mfma_f32_16x16x32_bf16 v[84:87], a[200:203], v[132:135], v[84:87]
    s_waitcnt lgkmcnt(3)
    ds_read_b64_tr_b16 a[98:99], v13 offset:25344
    v_mfma_f32_16x16x32_bf16 v[88:91], a[192:195], v[136:139], v[88:91]
    ds_read_b64_tr_b16 a[100:101], v14 offset:24576
    v_mfma_f32_16x16x32_bf16 v[92:95], a[196:199], v[136:139], v[92:95]
    ds_read_b128 v[140:143], v18 offset:13888
    v_mfma_f32_16x16x32_bf16 v[96:99], a[200:203], v[136:139], v[96:99]
    s_waitcnt lgkmcnt(4)
    ds_read_b64_tr_b16 a[102:103], v14 offset:25344
    v_mfma_f32_16x16x32_bf16 v[64:67], v[232:235], v[132:135], v[64:67]
    ds_read_b64_tr_b16 a[104:105], v15 offset:24576
    v_mfma_f32_16x16x32_bf16 v[68:71], v[236:239], v[132:135], v[68:71]
    ds_read_b64_tr_b16 a[106:107], v15 offset:25344
    v_mfma_f32_16x16x32_bf16 v[72:75], v[240:243], v[132:135], v[72:75]
    ds_read_b128 v[112:115], v18 offset:128
    v_mfma_f32_16x16x32_bf16 v[76:79], v[232:235], v[136:139], v[76:79]
    ds_read_b64_tr_b16 a[204:205], v13 offset:30720
    v_mfma_f32_16x16x32_bf16 v[80:83], v[236:239], v[136:139], v[80:83]
    ds_read_b128 v[116:119], v18 offset:3584
    v_mfma_f32_16x16x32_bf16 v[84:87], v[240:243], v[136:139], v[84:87]
    s_waitcnt lgkmcnt(5)
    ds_read_b64_tr_b16 a[206:207], v13 offset:31488
    v_mfma_f32_16x16x32_bf16 v[88:91], v[232:235], v[140:143], v[88:91]
    ds_read_b64_tr_b16 a[208:209], v14 offset:30720
    v_mfma_f32_16x16x32_bf16 v[92:95], v[236:239], v[140:143], v[92:95]
    ds_read_b128 v[120:123], v18 offset:7040
    v_mfma_f32_16x16x32_bf16 v[96:99], v[240:243], v[140:143], v[96:99]
    s_waitcnt vmcnt(9) lgkmcnt(5)
    s_barrier
    v_mfma_f32_16x16x32_bf16 v[64:67], a[96:99], v[112:115], v[64:67]
    ds_read_b64_tr_b16 a[210:211], v14 offset:31488
    v_mfma_f32_16x16x32_bf16 v[68:71], a[100:103], v[112:115], v[68:71]
    ds_read_b64_tr_b16 a[212:213], v15 offset:30720
    v_mfma_f32_16x16x32_bf16 v[72:75], a[104:107], v[112:115], v[72:75]
    s_waitcnt lgkmcnt(4)
    ds_read_b64_tr_b16 a[214:215], v15 offset:31488
    v_mfma_f32_16x16x32_bf16 v[76:79], a[96:99], v[116:119], v[76:79]
    ds_read_b64_tr_b16 v[244:245], v13 offset:36864
    v_mfma_f32_16x16x32_bf16 v[80:83], a[100:103], v[116:119], v[80:83]
    ds_read_b64_tr_b16 v[246:247], v13 offset:37632
    v_mfma_f32_16x16x32_bf16 v[84:87], a[104:107], v[116:119], v[84:87]
    s_waitcnt lgkmcnt(5)
    ds_read_b64_tr_b16 v[248:249], v14 offset:36864
    v_mfma_f32_16x16x32_bf16 v[88:91], a[96:99], v[120:123], v[88:91]
    ds_read_b128 v[124:127], v18 offset:10496
    v_mfma_f32_16x16x32_bf16 v[92:95], a[100:103], v[120:123], v[92:95]
    ds_read_b64_tr_b16 v[250:251], v14 offset:37632
    v_mfma_f32_16x16x32_bf16 v[96:99], a[104:107], v[120:123], v[96:99]
    s_waitcnt lgkmcnt(5)
    ds_read_b64_tr_b16 v[252:253], v15 offset:36864
    v_mfma_f32_16x16x32_bf16 v[64:67], a[204:207], v[116:119], v[64:67]
    ds_read_b64_tr_b16 v[254:255], v15 offset:37632
    v_mfma_f32_16x16x32_bf16 v[68:71], a[208:211], v[116:119], v[68:71]
    v_mfma_f32_16x16x32_bf16 v[72:75], a[212:215], v[116:119], v[72:75]
    v_mfma_f32_16x16x32_bf16 v[76:79], a[204:207], v[120:123], v[76:79]
    ds_read_b128 v[128:131], v18 offset:13952
    v_mfma_f32_16x16x32_bf16 v[80:83], a[208:211], v[120:123], v[80:83]
    v_mfma_f32_16x16x32_bf16 v[84:87], a[212:215], v[120:123], v[84:87]
    s_waitcnt lgkmcnt(2)
    v_mfma_f32_16x16x32_bf16 v[88:91], a[204:207], v[124:127], v[88:91]
    ds_read_b128 v[132:135], v40 offset:20736
    v_mfma_f32_16x16x32_bf16 v[92:95], a[208:211], v[124:127], v[92:95]
    v_mfma_f32_16x16x32_bf16 v[96:99], a[212:215], v[124:127], v[96:99]
    s_waitcnt lgkmcnt(2)
    v_mfma_f32_16x16x32_bf16 v[64:67], v[244:247], v[120:123], v[64:67]
    ds_read_b128 v[136:139], v40 offset:20800
    v_mfma_f32_16x16x32_bf16 v[68:71], v[248:251], v[120:123], v[68:71]
    v_mfma_f32_16x16x32_bf16 v[72:75], v[252:255], v[120:123], v[72:75]
    v_mfma_f32_16x16x32_bf16 v[76:79], v[244:247], v[124:127], v[76:79]
    ds_read_b128 v[140:143], v40 offset:20864
    v_mfma_f32_16x16x32_bf16 v[80:83], v[248:251], v[124:127], v[80:83]
    v_mfma_f32_16x16x32_bf16 v[84:87], v[252:255], v[124:127], v[84:87]
    s_waitcnt lgkmcnt(2)
    v_mfma_f32_16x16x32_bf16 v[88:91], v[244:247], v[128:131], v[88:91]
    ds_read_b128 v[112:115], v41 offset:20736
    v_mfma_f32_16x16x32_bf16 v[92:95], v[248:251], v[128:131], v[92:95]
    v_mfma_f32_16x16x32_bf16 v[96:99], v[252:255], v[128:131], v[96:99]
    v_mfma_f32_16x16x32_bf16 v[100:103], a[0:3], v[132:135], 0
    ds_read_b128 v[116:119], v41 offset:20800
    v_cvt_pk_bf16_f32 v72, v72, v73
    v_mfma_f32_16x16x32_bf16 v[104:107], a[4:7], v[132:135], 0
    v_cvt_pk_bf16_f32 v73, v74, v75
    v_cvt_pk_bf16_f32 v84, v84, v85
    v_mfma_f32_16x16x32_bf16 v[108:111], a[8:11], v[132:135], 0
    s_waitcnt lgkmcnt(2)
    ds_write_b64 v38, v[72:73] offset:0
    v_mfma_f32_16x16x32_bf16 v[100:103], a[12:15], v[136:139], v[100:103]
    ds_read_b128 v[120:123], v41 offset:20864
    v_mfma_f32_16x16x32_bf16 v[104:107], a[16:19], v[136:139], v[104:107]
    v_cvt_pk_bf16_f32 v85, v86, v87
    v_cvt_pk_bf16_f32 v96, v96, v97
    v_mfma_f32_16x16x32_bf16 v[108:111], a[20:23], v[136:139], v[108:111]
    ds_write_b64 v38, v[84:85] offset:2048
    v_mfma_f32_16x16x32_bf16 v[100:103], a[24:27], v[140:143], v[100:103]
    ds_read_b128 v[124:127], v42 offset:20736
    v_mfma_f32_16x16x32_bf16 v[104:107], a[28:31], v[140:143], v[104:107]
    v_cvt_pk_bf16_f32 v97, v98, v99
    v_cvt_pk_bf16_f32 v64, v64, v65
    v_mfma_f32_16x16x32_bf16 v[108:111], a[32:35], v[140:143], v[108:111]
    s_waitcnt lgkmcnt(3)
    ds_write_b64 v38, v[96:97] offset:4096
    v_mfma_f32_16x16x32_bf16 v[100:103], a[36:39], v[112:115], v[100:103]
    ds_read_b128 v[128:131], v42 offset:20800
    v_mfma_f32_16x16x32_bf16 v[104:107], a[40:43], v[112:115], v[104:107]
    v_cvt_pk_bf16_f32 v65, v66, v67
    v_cvt_pk_bf16_f32 v66, v68, v69
    v_mfma_f32_16x16x32_bf16 v[108:111], a[44:47], v[112:115], v[108:111]
    v_cvt_pk_bf16_f32 v67, v70, v71
    v_cvt_pk_bf16_f32 v76, v76, v77
    v_mfma_f32_16x16x32_bf16 v[100:103], a[48:51], v[116:119], v[100:103]
    ds_read_b128 v[132:135], v42 offset:20864
    v_cvt_pk_bf16_f32 v77, v78, v79
    v_mfma_f32_16x16x32_bf16 v[104:107], a[52:55], v[116:119], v[104:107]
    v_permlane16_swap_b32 v64, v66
    v_mfma_f32_16x16x32_bf16 v[108:111], a[56:59], v[116:119], v[108:111]
    s_waitcnt lgkmcnt(2)
    v_permlane16_swap_b32 v65, v67
    v_mfma_f32_16x16x32_bf16 v[100:103], a[60:63], v[120:123], v[100:103]
    ds_read_b128 v[136:139], v40 offset:24192
    v_cvt_pk_bf16_f32 v78, v80, v81
    v_mfma_f32_16x16x32_bf16 v[104:107], a[64:67], v[120:123], v[104:107]
    buffer_store_dwordx4 v[64:67], v19, s[20:23], s56 offen sc1
    v_cvt_pk_bf16_f32 v79, v82, v83
    v_cvt_pk_bf16_f32 v88, v88, v89
    v_cvt_pk_bf16_f32 v89, v90, v91
    v_mfma_f32_16x16x32_bf16 v[108:111], a[68:71], v[120:123], v[108:111]
    v_permlane16_swap_b32 v76, v78
    v_mfma_f32_16x16x32_bf16 v[100:103], a[72:75], v[124:127], v[100:103]
    ds_read_b128 v[140:143], v40 offset:24256
    v_cvt_pk_bf16_f32 v90, v92, v93
    v_mfma_f32_16x16x32_bf16 v[104:107], a[76:79], v[124:127], v[104:107]
    v_permlane16_swap_b32 v77, v79
    v_mfma_f32_16x16x32_bf16 v[108:111], a[80:83], v[124:127], v[108:111]
    s_waitcnt lgkmcnt(2)
    v_permlane16_swap_b32 v88, v90
    v_mfma_f32_16x16x32_bf16 v[100:103], a[84:87], v[128:131], v[100:103]
    ds_read_b128 v[112:115], v40 offset:24320
    v_cvt_pk_bf16_f32 v91, v94, v95
    v_mfma_f32_16x16x32_bf16 v[104:107], a[88:91], v[128:131], v[104:107]
    buffer_store_dwordx4 v[76:79], v19, s[20:23], s4 offen sc1
    v_mfma_f32_16x16x32_bf16 v[108:111], a[92:95], v[128:131], v[108:111]
    v_permlane16_swap_b32 v89, v91
    v_mfma_f32_16x16x32_bf16 v[100:103], a[96:99], v[132:135], v[100:103]
    ds_read_b128 v[116:119], v41 offset:24192
    v_mfma_f32_16x16x32_bf16 v[104:107], a[100:103], v[132:135], v[104:107]
    v_mfma_f32_16x16x32_bf16 v[108:111], a[104:107], v[132:135], v[108:111]
    s_waitcnt lgkmcnt(2)
    v_mfma_f32_16x16x32_bf16 v[100:103], a[108:111], v[136:139], v[100:103]
    ds_read_b128 v[120:123], v41 offset:24256
    v_mfma_f32_16x16x32_bf16 v[104:107], a[112:115], v[136:139], v[104:107]
    v_mfma_f32_16x16x32_bf16 v[108:111], a[116:119], v[136:139], v[108:111]
    s_waitcnt vmcnt(5) lgkmcnt(2)
    s_barrier
    v_mfma_f32_16x16x32_bf16 v[100:103], a[120:123], v[140:143], v[100:103]
    ds_read_b128 v[124:127], v41 offset:24320
    v_mfma_f32_16x16x32_bf16 v[104:107], a[124:127], v[140:143], v[104:107]
    ds_read_b64 v[6:7], v39 offset:0
    v_mfma_f32_16x16x32_bf16 v[108:111], a[128:131], v[140:143], v[108:111]
    v_mfma_f32_16x16x32_bf16 v[100:103], a[132:135], v[112:115], v[100:103]
    ds_read_b128 v[128:131], v42 offset:24192
    v_mfma_f32_16x16x32_bf16 v[104:107], a[136:139], v[112:115], v[104:107]
    v_mfma_f32_16x16x32_bf16 v[108:111], a[140:143], v[112:115], v[108:111]
    s_waitcnt lgkmcnt(3)
    v_mfma_f32_16x16x32_bf16 v[100:103], a[144:147], v[116:119], v[100:103]
    ds_read_b128 v[132:135], v42 offset:24256
    v_mfma_f32_16x16x32_bf16 v[104:107], a[148:151], v[116:119], v[104:107]
    buffer_store_dwordx4 v[88:91], v19, s[20:23], s5 offen sc1
    v_mfma_f32_16x16x32_bf16 v[108:111], a[152:155], v[116:119], v[108:111]
    s_waitcnt lgkmcnt(2)
    v_mfma_f32_16x16x32_bf16 v[100:103], a[156:159], v[120:123], v[100:103]
    ds_read_b128 v[136:139], v42 offset:24320
    v_mfma_f32_16x16x32_bf16 v[104:107], a[160:163], v[120:123], v[104:107]
    v_mfma_f32_16x16x32_bf16 v[108:111], a[164:167], v[120:123], v[108:111]
    buffer_store_dwordx2 v[6:7], v20, s[20:23], s56 offen sc1
    v_mfma_f32_16x16x32_bf16 v[100:103], a[168:171], v[124:127], v[100:103]
L_pgX1:
  s_cbranch_execz L_retX
    ds_read_b128 v[140:143], v40 offset:27648
    v_mfma_f32_16x16x32_bf16 v[104:107], a[172:175], v[124:127], v[104:107]
    v_mfma_f32_16x16x32_bf16 v[108:111], a[176:179], v[124:127], v[108:111]
    s_waitcnt lgkmcnt(2)
    v_mfma_f32_16x16x32_bf16 v[100:103], a[180:183], v[128:131], v[100:103]
    ds_read_b128 v[112:115], v40 offset:27712
    v_mfma_f32_16x16x32_bf16 v[104:107], a[184:187], v[128:131], v[104:107]
    v_mfma_f32_16x16x32_bf16 v[108:111], a[188:191], v[128:131], v[108:111]
    v_mfma_f32_16x16x32_bf16 v[100:103], a[192:195], v[132:135], v[100:103]
    ds_read_b128 v[116:119], v40 offset:27776
    v_mfma_f32_16x16x32_bf16 v[104:107], a[196:199], v[132:135], v[104:107]
    ds_read_b64 v[8:9], v39 offset:2048
    v_mfma_f32_16x16x32_bf16 v[108:111], a[200:203], v[132:135], v[108:111]
    s_waitcnt lgkmcnt(3)
    v_mfma_f32_16x16x32_bf16 v[100:103], a[204:207], v[136:139], v[100:103]
    ds_read_b128 v[120:123], v41 offset:27648
    v_mfma_f32_16x16x32_bf16 v[104:107], a[208:211], v[136:139], v[104:107]
    v_mfma_f32_16x16x32_bf16 v[108:111], a[212:215], v[136:139], v[108:111]
    v_mfma_f32_16x16x32_bf16 v[100:103], a[216:219], v[140:143], v[100:103]
    ds_read_b128 v[124:127], v41 offset:27712
    v_mfma_f32_16x16x32_bf16 v[104:107], a[220:223], v[140:143], v[104:107]
    v_mfma_f32_16x16x32_bf16 v[108:111], a[224:227], v[140:143], v[108:111]
    s_waitcnt lgkmcnt(2)
    v_mfma_f32_16x16x32_bf16 v[100:103], a[228:231], v[112:115], v[100:103]
    ds_read_b128 v[128:131], v41 offset:27776
    v_mfma_f32_16x16x32_bf16 v[104:107], a[232:235], v[112:115], v[104:107]
    buffer_store_dwordx2 v[8:9], v20, s[20:23], s4 offen sc1
    v_mfma_f32_16x16x32_bf16 v[108:111], a[236:239], v[112:115], v[108:111]
    v_mfma_f32_16x16x32_bf16 v[100:103], a[240:243], v[116:119], v[100:103]
    ds_read_b128 v[132:135], v42 offset:27648
    v_mfma_f32_16x16x32_bf16 v[104:107], a[244:247], v[116:119], v[104:107]
    v_mfma_f32_16x16x32_bf16 v[108:111], a[248:251], v[116:119], v[108:111]
    s_waitcnt lgkmcnt(2)
    v_mfma_f32_16x16x32_bf16 v[100:103], a[252:255], v[120:123], v[100:103]
    ds_read_b128 v[136:139], v42 offset:27712
    v_mfma_f32_16x16x32_bf16 v[104:107], v[188:191], v[120:123], v[104:107]
    v_mfma_f32_16x16x32_bf16 v[108:111], v[192:195], v[120:123], v[108:111]
    v_mfma_f32_16x16x32_bf16 v[100:103], v[196:199], v[124:127], v[100:103]
    ds_read_b128 v[140:143], v42 offset:27776
    v_mfma_f32_16x16x32_bf16 v[104:107], v[200:203], v[124:127], v[104:107]
    ds_read_b64 v[10:11], v39 offset:4096
    v_mfma_f32_16x16x32_bf16 v[108:111], v[204:207], v[124:127], v[108:111]
    s_waitcnt lgkmcnt(3)
    v_mfma_f32_16x16x32_bf16 v[100:103], v[208:211], v[128:131], v[100:103]
    ds_read_b128 v[112:115], v40 offset:27648
    v_mfma_f32_16x16x32_bf16 v[104:107], v[212:215], v[128:131], v[104:107]
    v_mfma_f32_16x16x32_bf16 v[108:111], v[216:219], v[128:131], v[108:111]
    v_mfma_f32_16x16x32_bf16 v[100:103], v[220:223], v[132:135], v[100:103]
    ds_read_b128 v[116:119], v40 offset:27712
    v_mfma_f32_16x16x32_bf16 v[104:107], v[224:227], v[132:135], v[104:107]
    v_mfma_f32_16x16x32_bf16 v[108:111], v[228:231], v[132:135], v[108:111]
    s_waitcnt lgkmcnt(2)
    v_mfma_f32_16x16x32_bf16 v[100:103], v[232:235], v[136:139], v[100:103]
    ds_read_b128 v[120:123], v40 offset:27776
    v_mfma_f32_16x16x32_bf16 v[104:107], v[236:239], v[136:139], v[104:107]
    buffer_store_dwordx2 v[10:11], v20, s[20:23], s5 offen sc1
    v_mfma_f32_16x16x32_bf16 v[108:111], v[240:243], v[136:139], v[108:111]
    v_mfma_f32_16x16x32_bf16 v[100:103], v[244:247], v[140:143], v[100:103]
    ds_read_b128 v[124:127], v41 offset:27648
    v_mfma_f32_16x16x32_bf16 v[104:107], v[248:251], v[140:143], v[104:107]
    v_mfma_f32_16x16x32_bf16 v[108:111], v[252:255], v[140:143], v[108:111]
    s_waitcnt lgkmcnt(2)
    v_mfma_f32_16x16x32_bf16 v[64:67], a[0:3], v[112:115], 0
    ds_read_b128 v[128:131], v41 offset:27712
    v_mfma_f32_16x16x32_bf16 v[68:71], a[4:7], v[112:115], 0
    v_mfma_f32_16x16x32_bf16 v[72:75], a[8:11], v[112:115], 0
    v_cvt_pk_bf16_f32 v100, v100, v101
    v_cvt_pk_bf16_f32 v101, v102, v103
    v_mfma_f32_16x16x32_bf16 v[64:67], a[12:15], v[116:119], v[64:67]
    ds_read_b128 v[132:135], v41 offset:27776
    v_cvt_pk_bf16_f32 v108, v108, v109
    v_mfma_f32_16x16x32_bf16 v[68:71], a[16:19], v[116:119], v[68:71]
    v_cvt_pk_bf16_f32 v109, v110, v111
    v_cvt_pk_bf16_f32 v102, v104, v105
    v_mfma_f32_16x16x32_bf16 v[72:75], a[20:23], v[116:119], v[72:75]
    s_waitcnt lgkmcnt(2)
    ds_write_b64 v38, v[108:109] offset:6144
    v_mfma_f32_16x16x32_bf16 v[64:67], a[24:27], v[120:123], v[64:67]
    ds_read_b128 v[136:139], v42 offset:27648
    v_mfma_f32_16x16x32_bf16 v[68:71], a[28:31], v[120:123], v[68:71]
    v_permlane16_swap_b32 v100, v102
    v_mfma_f32_16x16x32_bf16 v[72:75], a[32:35], v[120:123], v[72:75]
    v_cvt_pk_bf16_f32 v103, v106, v107
    v_mfma_f32_16x16x32_bf16 v[64:67], a[36:39], v[124:127], v[64:67]
    ds_read_b128 v[140:143], v42 offset:27712
    v_mfma_f32_16x16x32_bf16 v[68:71], a[40:43], v[124:127], v[68:71]
    v_permlane16_swap_b32 v101, v103
    v_mfma_f32_16x16x32_bf16 v[72:75], a[44:47], v[124:127], v[72:75]
    s_waitcnt lgkmcnt(2)
    v_mfma_f32_16x16x32_bf16 v[64:67], a[48:51], v[128:131], v[64:67]
    ds_read_b128 v[112:115], v42 offset:27776
    v_mfma_f32_16x16x32_bf16 v[68:71], a[52:55], v[128:131], v[68:71]
    buffer_store_dwordx4 v[100:103], v21, s[20:23], s74 offen sc1
    v_mfma_f32_16x16x32_bf16 v[72:75], a[56:59], v[128:131], v[72:75]
    v_mfma_f32_16x16x32_bf16 v[64:67], a[60:63], v[132:135], v[64:67]
    ds_read_b128 v[116:119], v40 offset:31104
    v_mfma_f32_16x16x32_bf16 v[68:71], a[64:67], v[132:135], v[68:71]
    v_mfma_f32_16x16x32_bf16 v[72:75], a[68:71], v[132:135], v[72:75]
    s_waitcnt lgkmcnt(2)
    v_mfma_f32_16x16x32_bf16 v[64:67], a[72:75], v[136:139], v[64:67]
    ds_read_b128 v[120:123], v40 offset:31168
    v_mfma_f32_16x16x32_bf16 v[68:71], a[76:79], v[136:139], v[68:71]
    v_mfma_f32_16x16x32_bf16 v[72:75], a[80:83], v[136:139], v[72:75]
    v_mfma_f32_16x16x32_bf16 v[64:67], a[84:87], v[140:143], v[64:67]
    ds_read_b128 v[124:127], v40 offset:31232
    v_mfma_f32_16x16x32_bf16 v[68:71], a[88:91], v[140:143], v[68:71]
    v_mfma_f32_16x16x32_bf16 v[72:75], a[92:95], v[140:143], v[72:75]
    s_waitcnt vmcnt(13) lgkmcnt(2)
    v_mfma_f32_16x16x32_bf16 v[64:67], a[96:99], v[112:115], v[64:67]
    ds_read_b128 v[128:131], v41 offset:31104
    v_and_b32 v180, s96, v180
    v_mfma_f32_16x16x32_bf16 v[68:71], a[100:103], v[112:115], v[68:71]
    v_and_b32 v181, s96, v181
    v_and_b32 v182, s96, v182
    v_mfma_f32_16x16x32_bf16 v[72:75], a[104:107], v[112:115], v[72:75]
    v_and_b32 v183, s96, v183
    v_pk_max_u16 v180, v180, v181
    v_mfma_f32_16x16x32_bf16 v[64:67], a[108:111], v[116:119], v[64:67]
    ds_read_b128 v[132:135], v41 offset:31168
    v_pk_max_u16 v182, v182, v183
    v_mfma_f32_16x16x32_bf16 v[68:71], a[112:115], v[116:119], v[68:71]
    v_pk_max_u16 v180, v180, s37
    v_pk_max_u16 v180, v180, v182
    v_mfma_f32_16x16x32_bf16 v[72:75], a[116:119], v[116:119], v[72:75]
    s_waitcnt lgkmcnt(2)
    v_cmp_ne_u32 s[80:81], s37, v180
    v_and_b32 v184, s96, v184
    v_mfma_f32_16x16x32_bf16 v[64:67], a[120:123], v[120:123], v[64:67]
    ds_read_b128 v[136:139], v41 offset:31232
    v_and_b32 v185, s96, v185
    v_mfma_f32_16x16x32_bf16 v[68:71], a[124:127], v[120:123], v[68:71]
    v_and_b32 v186, s96, v186
    v_and_b32 v187, s96, v187
    v_mfma_f32_16x16x32_bf16 v[72:75], a[128:131], v[120:123], v[72:75]
    v_pk_max_u16 v184, v184, v185
    v_pk_max_u16 v186, v186, v187
    v_mfma_f32_16x16x32_bf16 v[64:67], a[132:135], v[124:127], v[64:67]
    ds_read_b128 v[140:143], v42 offset:31104
    v_pk_max_u16 v184, v184, s37
    v_mfma_f32_16x16x32_bf16 v[68:71], a[136:139], v[124:127], v[68:71]
    v_pk_max_u16 v184, v184, v186
    v_cmp_ne_u32 s[82:83], s37, v184
    v_mfma_f32_16x16x32_bf16 v[72:75], a[140:143], v[124:127], v[72:75]
    s_waitcnt lgkmcnt(2)
    v_mfma_f32_16x16x32_bf16 v[64:67], a[144:147], v[128:131], v[64:67]
    ds_read_b128 v[112:115], v42 offset:31168
    v_mfma_f32_16x16x32_bf16 v[68:71], a[148:151], v[128:131], v[68:71]
    s_or_b64 vcc, s[80:81], s[82:83]
    s_cbranch_scc1 L_afailX
L_afailX_back:
    v_mfma_f32_16x16x32_bf16 v[72:75], a[152:155], v[128:131], v[72:75]
    v_mfma_f32_16x16x32_bf16 v[64:67], a[156:159], v[132:135], v[64:67]
    ds_read_b128 v[116:119], v42 offset:31232
    v_mfma_f32_16x16x32_bf16 v[68:71], a[160:163], v[132:135], v[68:71]
    v_mfma_f32_16x16x32_bf16 v[72:75], a[164:167], v[132:135], v[72:75]
    s_waitcnt lgkmcnt(2)
    v_mfma_f32_16x16x32_bf16 v[64:67], a[168:171], v[136:139], v[64:67]
    ds_read_b128 v[120:123], v40 offset:34560
    v_mfma_f32_16x16x32_bf16 v[68:71], a[172:175], v[136:139], v[68:71]
    v_mfma_f32_16x16x32_bf16 v[72:75], a[176:179], v[136:139], v[72:75]
    v_mfma_f32_16x16x32_bf16 v[64:67], a[180:183], v[140:143], v[64:67]
    ds_read_b128 v[124:127], v40 offset:34624
    v_mfma_f32_16x16x32_bf16 v[68:71], a[184:187], v[140:143], v[68:71]
    v_mfma_f32_16x16x32_bf16 v[72:75], a[188:191], v[140:143], v[72:75]
    s_waitcnt lgkmcnt(2)
    v_mfma_f32_16x16x32_bf16 v[64:67], a[192:195], v[112:115], v[64:67]
    ds_read_b128 v[128:131], v40 offset:34688
    v_mfma_f32_16x16x32_bf16 v[68:71], a[196:199], v[112:115], v[68:71]
    v_mfma_f32_16x16x32_bf16 v[72:75], a[200:203], v[112:115], v[72:75]
    v_mfma_f32_16x16x32_bf16 v[64:67], a[204:207], v[116:119], v[64:67]
    ds_read_b128 v[132:135], v41 offset:34560
    v_mfma_f32_16x16x32_bf16 v[68:71], a[208:211], v[116:119], v[68:71]
    v_mfma_f32_16x16x32_bf16 v[72:75], a[212:215], v[116:119], v[72:75]
    s_waitcnt lgkmcnt(2)
    v_mfma_f32_16x16x32_bf16 v[64:67], a[216:219], v[120:123], v[64:67]
    ds_read_b128 v[136:139], v41 offset:34624
    v_mfma_f32_16x16x32_bf16 v[68:71], a[220:223], v[120:123], v[68:71]
    v_mfma_f32_16x16x32_bf16 v[72:75], a[224:227], v[120:123], v[72:75]
    v_mfma_f32_16x16x32_bf16 v[64:67], a[228:231], v[124:127], v[64:67]
    ds_read_b128 v[140:143], v41 offset:34688
    v_mfma_f32_16x16x32_bf16 v[68:71], a[232:235], v[124:127], v[68:71]
    v_mfma_f32_16x16x32_bf16 v[72:75], a[236:239], v[124:127], v[72:75]
    s_waitcnt lgkmcnt(2)
    v_mfma_f32_16x16x32_bf16 v[64:67], a[240:243], v[128:131], v[64:67]
    ds_read_b128 v[112:115], v42 offset:34560
    v_mfma_f32_16x16x32_bf16 v[68:71], a[244:247], v[128:131], v[68:71]
    v_mfma_f32_16x16x32_bf16 v[72:75], a[248:251], v[128:131], v[72:75]
    v_mfma_f32_16x16x32_bf16 v[64:67], a[252:255], v[132:135], v[64:67]
    ds_read_b128 v[116:119], v42 offset:34624
    v_mfma_f32_16x16x32_bf16 v[68:71], v[188:191], v[132:135], v[68:71]
    v_mfma_f32_16x16x32_bf16 v[72:75], v[192:195], v[132:135], v[72:75]
    s_waitcnt lgkmcnt(2)
    v_mfma_f32_16x16x32_bf16 v[64:67], v[196:199], v[136:139], v[64:67]
    ds_read_b128 v[120:123], v42 offset:34688
    v_mfma_f32_16x16x32_bf16 v[68:71], v[200:203], v[136:139], v[68:71]
    v_mfma_f32_16x16x32_bf16 v[72:75], v[204:207], v[136:139], v[72:75]
    v_mfma_f32_16x16x32_bf16 v[64:67], v[208:211], v[140:143], v[64:67]
    ds_read_b128 v[124:127], v40 offset:34560
    v_mfma_f32_16x16x32_bf16 v[68:71], v[212:215], v[140:143], v[68:71]
    v_mfma_f32_16x16x32_bf16 v[72:75], v[216:219], v[140:143], v[72:75]
    s_waitcnt lgkmcnt(2)
    v_mfma_f32_16x16x32_bf16 v[64:67], v[220:223], v[112:115], v[64:67]
    ds_read_b128 v[128:131], v40 offset:34624
    v_mfma_f32_16x16x32_bf16 v[68:71], v[224:227], v[112:115], v[68:71]
    v_mfma_f32_16x16x32_bf16 v[72:75], v[228:231], v[112:115], v[72:75]
    v_mfma_f32_16x16x32_bf16 v[64:67], v[232:235], v[116:119], v[64:67]
    ds_read_b128 v[132:135], v40 offset:34688
    v_mfma_f32_16x16x32_bf16 v[68:71], v[236:239], v[116:119], v[68:71]
    v_mfma_f32_16x16x32_bf16 v[72:75], v[240:243], v[116:119], v[72:75]
    s_waitcnt lgkmcnt(2)
    v_mfma_f32_16x16x32_bf16 v[64:67], v[244:247], v[120:123], v[64:67]
    ds_read_b128 v[136:139], v41 offset:34560
    v_mfma_f32_16x16x32_bf16 v[68:71], v[248:251], v[120:123], v[68:71]
    v_mfma_f32_16x16x32_bf16 v[72:75], v[252:255], v[120:123], v[72:75]
    v_mfma_f32_16x16x32_bf16 v[76:79], a[0:3], v[124:127], 0
    ds_read_b128 v[140:143], v41 offset:34624
    v_mfma_f32_16x16x32_bf16 v[80:83], a[4:7], v[124:127], 0
    v_mfma_f32_16x16x32_bf16 v[84:87], a[8:11], v[124:127], 0
    s_waitcnt lgkmcnt(2)
    v_cvt_pk_bf16_f32 v64, v64, v65
    v_cvt_pk_bf16_f32 v65, v66, v67
    v_mfma_f32_16x16x32_bf16 v[76:79], a[12:15], v[128:131], v[76:79]
    ds_read_b128 v[112:115], v41 offset:34688
    v_cvt_pk_bf16_f32 v72, v72, v73
    v_mfma_f32_16x16x32_bf16 v[80:83], a[16:19], v[128:131], v[80:83]
    v_cvt_pk_bf16_f32 v73, v74, v75
    v_cvt_pk_bf16_f32 v66, v68, v69
    v_mfma_f32_16x16x32_bf16 v[84:87], a[20:23], v[128:131], v[84:87]
    ds_write_b64 v38, v[72:73] offset:8192
    v_mfma_f32_16x16x32_bf16 v[76:79], a[24:27], v[132:135], v[76:79]
    ds_read_b128 v[116:119], v42 offset:34560
    v_mfma_f32_16x16x32_bf16 v[80:83], a[28:31], v[132:135], v[80:83]
    v_permlane16_swap_b32 v64, v66
    v_mfma_f32_16x16x32_bf16 v[84:87], a[32:35], v[132:135], v[84:87]
    s_waitcnt lgkmcnt(3)
    v_cvt_pk_bf16_f32 v67, v70, v71
    v_mfma_f32_16x16x32_bf16 v[76:79], a[36:39], v[136:139], v[76:79]
    ds_read_b128 v[120:123], v42 offset:34624
    v_mfma_f32_16x16x32_bf16 v[80:83], a[40:43], v[136:139], v[80:83]
    v_permlane16_swap_b32 v65, v67
    v_mfma_f32_16x16x32_bf16 v[84:87], a[44:47], v[136:139], v[84:87]
    buffer_store_dwordx4 v[64:67], v21, s[20:23], s75 offen sc1
    v_mfma_f32_16x16x32_bf16 v[76:79], a[48:51], v[140:143], v[76:79]
    ds_read_b128 v[124:127], v42 offset:34688
    v_mfma_f32_16x16x32_bf16 v[80:83], a[52:55], v[140:143], v[80:83]
    v_mfma_f32_16x16x32_bf16 v[84:87], a[56:59], v[140:143], v[84:87]
    s_waitcnt lgkmcnt(2)
    v_mfma_f32_16x16x32_bf16 v[76:79], a[60:63], v[112:115], v[76:79]
    ds_read_b128 v[128:131], v40 offset:38016
    v_mfma_f32_16x16x32_bf16 v[80:83], a[64:67], v[112:115], v[80:83]
    v_mfma_f32_16x16x32_bf16 v[84:87], a[68:71], v[112:115], v[84:87]
    v_mfma_f32_16x16x32_bf16 v[76:79], a[72:75], v[116:119], v[76:79]
    ds_read_b128 v[132:135], v40 offset:38080
    v_mfma_f32_16x16x32_bf16 v[80:83], a[76:79], v[116:119], v[80:83]
    v_mfma_f32_16x16x32_bf16 v[84:87], a[80:83], v[116:119], v[84:87]
    s_waitcnt lgkmcnt(2)
    v_mfma_f32_16x16x32_bf16 v[76:79], a[84:87], v[120:123], v[76:79]
    ds_read_b128 v[136:139], v40 offset:38144
    v_mfma_f32_16x16x32_bf16 v[80:83], a[88:91], v[120:123], v[80:83]
    v_mfma_f32_16x16x32_bf16 v[84:87], a[92:95], v[120:123], v[84:87]
    s_waitcnt vmcnt(8) lgkmcnt(2)
    s_barrier
    v_mfma_f32_16x16x32_bf16 v[76:79], a[96:99], v[124:127], v[76:79]
    ds_read_b128 v[140:143], v41 offset:38016
    v_mfma_f32_16x16x32_bf16 v[80:83], a[100:103], v[124:127], v[80:83]
    ds_read_b32 v35, v34
    v_mfma_f32_16x16x32_bf16 v[84:87], a[104:107], v[124:127], v[84:87]
    ds_read_b64 v[12:13], v39 offset:6144
    v_mfma_f32_16x16x32_bf16 v[76:79], a[108:111], v[128:131], v[76:79]
    ds_read_b128 v[112:115], v41 offset:38080
    v_mfma_f32_16x16x32_bf16 v[80:83], a[112:115], v[128:131], v[80:83]
    ds_read_b64 v[14:15], v39 offset:8192
    v_mfma_f32_16x16x32_bf16 v[84:87], a[116:119], v[128:131], v[84:87]
    s_waitcnt lgkmcnt(5)
    v_mfma_f32_16x16x32_bf16 v[76:79], a[120:123], v[132:135], v[76:79]
    ds_read_b128 v[116:119], v41 offset:38144
    v_mfma_f32_16x16x32_bf16 v[80:83], a[124:127], v[132:135], v[80:83]
    v_mfma_f32_16x16x32_bf16 v[84:87], a[128:131], v[132:135], v[84:87]
    s_waitcnt lgkmcnt(3)
    v_readfirstlane_b32 s63, v35
    v_mfma_f32_16x16x32_bf16 v[76:79], a[132:135], v[136:139], v[76:79]
    ds_read_b128 v[120:123], v42 offset:38016
    v_mfma_f32_16x16x32_bf16 v[80:83], a[136:139], v[136:139], v[80:83]
    buffer_store_dwordx2 v[12:13], v22, s[20:23], s74 offen sc1
    v_mfma_f32_16x16x32_bf16 v[84:87], a[140:143], v[136:139], v[84:87]
    s_waitcnt lgkmcnt(2)
    v_mfma_f32_16x16x32_bf16 v[76:79], a[144:147], v[140:143], v[76:79]
    ds_read_b128 v[124:127], v42 offset:38080
    v_mfma_f32_16x16x32_bf16 v[80:83], a[148:151], v[140:143], v[80:83]
    v_mfma_f32_16x16x32_bf16 v[84:87], a[152:155], v[140:143], v[84:87]
    buffer_store_dwordx2 v[14:15], v22, s[20:23], s75 offen sc1
    v_mfma_f32_16x16x32_bf16 v[76:79], a[156:159], v[112:115], v[76:79]
    ds_read_b128 v[128:131], v42 offset:38144
    v_mfma_f32_16x16x32_bf16 v[80:83], a[160:163], v[112:115], v[80:83]
    v_mfma_f32_16x16x32_bf16 v[84:87], a[164:167], v[112:115], v[84:87]
    s_waitcnt lgkmcnt(2)
    v_mfma_f32_16x16x32_bf16 v[76:79], a[168:171], v[116:119], v[76:79]
    ds_read_b128 v[132:135], v40 offset:41472
    v_mfma_f32_16x16x32_bf16 v[80:83], a[172:175], v[116:119], v[80:83]
    v_mfma_f32_16x16x32_bf16 v[84:87], a[176:179], v[116:119], v[84:87]
    v_mfma_f32_16x16x32_bf16 v[76:79], a[180:183], v[120:123], v[76:79]
    ds_read_b128 v[136:139], v40 offset:41536
    v_mfma_f32_16x16x32_bf16 v[80:83], a[184:187], v[120:123], v[80:83]
    v_mfma_f32_16x16x32_bf16 v[84:87], a[188:191], v[120:123], v[84:87]
    s_waitcnt lgkmcnt(2)
    v_mfma_f32_16x16x32_bf16 v[76:79], a[192:195], v[124:127], v[76:79]
    ds_read_b128 v[140:143], v40 offset:41600
    v_mfma_f32_16x16x32_bf16 v[80:83], a[196:199], v[124:127], v[80:83]
    v_mfma_f32_16x16x32_bf16 v[84:87], a[200:203], v[124:127], v[84:87]
    v_mfma_f32_16x16x32_bf16 v[76:79], a[204:207], v[128:131], v[76:79]
    ds_read_b128 v[112:115], v41 offset:41472
    v_mfma_f32_16x16x32_bf16 v[80:83], a[208:211], v[128:131], v[80:83]
    v_mfma_f32_16x16x32_bf16 v[84:87], a[212:215], v[128:131], v[84:87]
    s_waitcnt lgkmcnt(2)
    v_mfma_f32_16x16x32_bf16 v[76:79], a[216:219], v[132:135], v[76:79]
    ds_read_b128 v[116:119], v41 offset:41536
    v_mfma_f32_16x16x32_bf16 v[80:83], a[220:223], v[132:135], v[80:83]
    v_mfma_f32_16x16x32_bf16 v[84:87], a[224:227], v[132:135], v[84:87]
    v_mfma_f32_16x16x32_bf16 v[76:79], a[228:231], v[136:139], v[76:79]
    ds_read_b128 v[120:123], v41 offset:41600
    v_mfma_f32_16x16x32_bf16 v[80:83], a[232:235], v[136:139], v[80:83]
    v_mfma_f32_16x16x32_bf16 v[84:87], a[236:239], v[136:139], v[84:87]
    s_waitcnt lgkmcnt(2)
    v_mfma_f32_16x16x32_bf16 v[76:79], a[240:243], v[140:143], v[76:79]
    ds_read_b128 v[124:127], v42 offset:41472
    v_mfma_f32_16x16x32_bf16 v[80:83], a[244:247], v[140:143], v[80:83]
    v_mfma_f32_16x16x32_bf16 v[84:87], a[248:251], v[140:143], v[84:87]
    v_mfma_f32_16x16x32_bf16 v[76:79], a[252:255], v[112:115], v[76:79]
    ds_read_b128 v[128:131], v42 offset:41536
    v_mfma_f32_16x16x32_bf16 v[80:83], v[188:191], v[112:115], v[80:83]
    v_mfma_f32_16x16x32_bf16 v[84:87], v[192:195], v[112:115], v[84:87]
    s_waitcnt lgkmcnt(2)
    v_mfma_f32_16x16x32_bf16 v[76:79], v[196:199], v[116:119], v[76:79]
    ds_read_b128 v[132:135], v42 offset:41600
    v_mfma_f32_16x16x32_bf16 v[80:83], v[200:203], v[116:119], v[80:83]
    v_mfma_f32_16x16x32_bf16 v[84:87], v[204:207], v[116:119], v[84:87]
    v_mfma_f32_16x16x32_bf16 v[76:79], v[208:211], v[120:123], v[76:79]
    ds_read_b128 v[136:139], v40 offset:41472
    v_mfma_f32_16x16x32_bf16 v[80:83], v[212:215], v[120:123], v[80:83]
    v_mfma_f32_16x16x32_bf16 v[84:87], v[216:219], v[120:123], v[84:87]
    s_waitcnt lgkmcnt(2)
    v_mfma_f32_16x16x32_bf16 v[76:79], v[220:223], v[124:127], v[76:79]
    ds_read_b128 v[140:143], v40 offset:41536
    v_mfma_f32_16x16x32_bf16 v[80:83], v[224:227], v[124:127], v[80:83]
    v_mfma_f32_16x16x32_bf16 v[84:87], v[228:231], v[124:127], v[84:87]
    v_mfma_f32_16x16x32_bf16 v[76:79], v[232:235], v[128:131], v[76:79]
    ds_read_b128 v[112:115], v40 offset:41600
    v_mfma_f32_16x16x32_bf16 v[80:83], v[236:239], v[128:131], v[80:83]
    v_mfma_f32_16x16x32_bf16 v[84:87], v[240:243], v[128:131], v[84:87]
    s_waitcnt lgkmcnt(2)
    v_mfma_f32_16x16x32_bf16 v[76:79], v[244:247], v[132:135], v[76:79]
    ds_read_b128 v[116:119], v41 offset:41472
    v_mfma_f32_16x16x32_bf16 v[80:83], v[248:251], v[132:135], v[80:83]
    v_mfma_f32_16x16x32_bf16 v[84:87], v[252:255], v[132:135], v[84:87]
    v_mfma_f32_16x16x32_bf16 v[88:91], a[0:3], v[136:139], 0
    ds_read_b128 v[120:123], v41 offset:41536
    v_mfma_f32_16x16x32_bf16 v[92:95], a[4:7], v[136:139], 0
    v_mfma_f32_16x16x32_bf16 v[96:99], a[8:11], v[136:139], 0
    s_waitcnt lgkmcnt(2)
    v_cvt_pk_bf16_f32 v76, v76, v77
    v_cvt_pk_bf16_f32 v77, v78, v79
    v_mfma_f32_16x16x32_bf16 v[88:91], a[12:15], v[140:143], v[88:91]
    ds_read_b128 v[124:127], v41 offset:41600
    v_cvt_pk_bf16_f32 v78, v80, v81
    v_mfma_f32_16x16x32_bf16 v[92:95], a[16:19], v[140:143], v[92:95]
    v_cvt_pk_bf16_f32 v79, v82, v83
    v_cvt_pk_bf16_f32 v84, v84, v85
    v_mfma_f32_16x16x32_bf16 v[96:99], a[20:23], v[140:143], v[96:99]
    v_permlane16_swap_b32 v76, v78
    v_mfma_f32_16x16x32_bf16 v[88:91], a[24:27], v[112:115], v[88:91]
    ds_read_b128 v[128:131], v42 offset:41472
    v_cvt_pk_bf16_f32 v85, v86, v87
    v_mfma_f32_16x16x32_bf16 v[92:95], a[28:31], v[112:115], v[92:95]
    v_permlane16_swap_b32 v77, v79
    v_mfma_f32_16x16x32_bf16 v[96:99], a[32:35], v[112:115], v[96:99]
    s_waitcnt lgkmcnt(2)
    ds_write_b64 v38, v[84:85] offset:10240
    v_mfma_f32_16x16x32_bf16 v[88:91], a[36:39], v[116:119], v[88:91]
    ds_read_b128 v[132:135], v42 offset:41536
    v_mfma_f32_16x16x32_bf16 v[92:95], a[40:43], v[116:119], v[92:95]
    buffer_store_dwordx4 v[76:79], v21, s[20:23], s76 offen sc1
    v_mfma_f32_16x16x32_bf16 v[96:99], a[44:47], v[116:119], v[96:99]
    v_mfma_f32_16x16x32_bf16 v[88:91], a[48:51], v[120:123], v[88:91]
    ds_read_b128 v[136:139], v42 offset:41600
    v_mfma_f32_16x16x32_bf16 v[92:95], a[52:55], v[120:123], v[92:95]
    v_mfma_f32_16x16x32_bf16 v[96:99], a[56:59], v[120:123], v[96:99]
    s_waitcnt lgkmcnt(2)
    v_mfma_f32_16x16x32_bf16 v[88:91], a[60:63], v[124:127], v[88:91]
    ds_read_b128 v[140:143], v40 offset:44928
    v_mfma_f32_16x16x32_bf16 v[92:95], a[64:67], v[124:127], v[92:95]
    v_mfma_f32_16x16x32_bf16 v[96:99], a[68:71], v[124:127], v[96:99]
    v_mfma_f32_16x16x32_bf16 v[88:91], a[72:75], v[128:131], v[88:91]
    ds_read_b128 v[112:115], v40 offset:44992
    v_mfma_f32_16x16x32_bf16 v[92:95], a[76:79], v[128:131], v[92:95]
    v_mfma_f32_16x16x32_bf16 v[96:99], a[80:83], v[128:131], v[96:99]
    s_waitcnt lgkmcnt(2)
    v_mfma_f32_16x16x32_bf16 v[88:91], a[84:87], v[132:135], v[88:91]
    ds_read_b128 v[116:119], v40 offset:45056
    v_mfma_f32_16x16x32_bf16 v[92:95], a[88:91], v[132:135], v[92:95]
    v_mfma_f32_16x16x32_bf16 v[96:99], a[92:95], v[132:135], v[96:99]
    v_mfma_f32_16x16x32_bf16 v[88:91], a[96:99], v[136:139], v[88:91]
    ds_read_b128 v[120:123], v41 offset:44928
    v_mfma_f32_16x16x32_bf16 v[92:95], a[100:103], v[136:139], v[92:95]
    v_mfma_f32_16x16x32_bf16 v[96:99], a[104:107], v[136:139], v[96:99]
    s_waitcnt lgkmcnt(2)
    v_mfma_f32_16x16x32_bf16 v[88:91], a[108:111], v[140:143], v[88:91]
    ds_read_b128 v[124:127], v41 offset:44992
    v_mfma_f32_16x16x32_bf16 v[92:95], a[112:115], v[140:143], v[92:95]
    v_mfma_f32_16x16x32_bf16 v[96:99], a[116:119], v[140:143], v[96:99]
    v_mfma_f32_16x16x32_bf16 v[88:91], a[120:123], v[112:115], v[88:91]
    ds_read_b128 v[128:131], v41 offset:45056
    v_mfma_f32_16x16x32_bf16 v[92:95], a[124:127], v[112:115], v[92:95]
    v_mfma_f32_16x16x32_bf16 v[96:99], a[128:131], v[112:115], v[96:99]
    s_waitcnt lgkmcnt(2)
    v_mfma_f32_16x16x32_bf16 v[88:91], a[132:135], v[116:119], v[88:91]
    ds_read_b128 v[132:135], v42 offset:44928
    v_mfma_f32_16x16x32_bf16 v[92:95], a[136:139], v[116:119], v[92:95]
    v_mfma_f32_16x16x32_bf16 v[96:99], a[140:143], v[116:119], v[96:99]
    v_mfma_f32_16x16x32_bf16 v[88:91], a[144:147], v[120:123], v[88:91]
    ds_read_b128 v[136:139], v42 offset:44992
    v_mfma_f32_16x16x32_bf16 v[92:95], a[148:151], v[120:123], v[92:95]
    v_mfma_f32_16x16x32_bf16 v[96:99], a[152:155], v[120:123], v[96:99]
    s_waitcnt lgkmcnt(2)
    v_mfma_f32_16x16x32_bf16 v[88:91], a[156:159], v[124:127], v[88:91]
    ds_read_b128 v[140:143], v42 offset:45056
    v_mfma_f32_16x16x32_bf16 v[92:95], a[160:163], v[124:127], v[92:95]
    v_mfma_f32_16x16x32_bf16 v[96:99], a[164:167], v[124:127], v[96:99]
    v_mfma_f32_16x16x32_bf16 v[88:91], a[168:171], v[128:131], v[88:91]
    ds_read_b128 v[112:115], v40 offset:48384
    v_mfma_f32_16x16x32_bf16 v[92:95], a[172:175], v[128:131], v[92:95]
    v_mfma_f32_16x16x32_bf16 v[96:99], a[176:179], v[128:131], v[96:99]
    s_waitcnt lgkmcnt(2)
    v_mfma_f32_16x16x32_bf16 v[88:91], a[180:183], v[132:135], v[88:91]
    ds_read_b128 v[116:119], v40 offset:48448
    v_mfma_f32_16x16x32_bf16 v[92:95], a[184:187], v[132:135], v[92:95]
    v_mfma_f32_16x16x32_bf16 v[96:99], a[188:191], v[132:135], v[96:99]
    v_mfma_f32_16x16x32_bf16 v[88:91], a[192:195], v[136:139], v[88:91]
    ds_read_b128 v[120:123], v40 offset:48512
    v_mfma_f32_16x16x32_bf16 v[92:95], a[196:199], v[136:139], v[92:95]
    v_mfma_f32_16x16x32_bf16 v[96:99], a[200:203], v[136:139], v[96:99]
    s_waitcnt lgkmcnt(2)
    v_mfma_f32_16x16x32_bf16 v[88:91], a[204:207], v[140:143], v[88:91]
    ds_read_b128 v[124:127], v41 offset:48384
    v_mfma_f32_16x16x32_bf16 v[92:95], a[208:211], v[140:143], v[92:95]
    ds_read_b128 v[128:131], v41 offset:48448
    v_mfma_f32_16x16x32_bf16 v[96:99], a[212:215], v[140:143], v[96:99]
    ds_read_b128 v[132:135], v41 offset:48512
    v_mfma_f32_16x16x32_bf16 v[88:91], a[216:219], v[112:115], v[88:91]
    ds_read_b128 v[136:139], v42 offset:48384
    v_mfma_f32_16x16x32_bf16 v[92:95], a[220:223], v[112:115], v[92:95]
    ds_read_b128 v[140:143], v42 offset:48448
    v_mfma_f32_16x16x32_bf16 v[96:99], a[224:227], v[112:115], v[96:99]
    s_waitcnt lgkmcnt(5)
    ds_read_b128 v[112:115], v42 offset:48512
    v_mfma_f32_16x16x32_bf16 v[88:91], a[228:231], v[116:119], v[88:91]
    v_mfma_f32_16x16x32_bf16 v[92:95], a[232:235], v[116:119], v[92:95]
    v_mfma_f32_16x16x32_bf16 v[96:99], a[236:239], v[116:119], v[96:99]
    v_mfma_f32_16x16x32_bf16 v[88:91], a[240:243], v[120:123], v[88:91]
    v_mfma_f32_16x16x32_bf16 v[92:95], a[244:247], v[120:123], v[92:95]
    v_mfma_f32_16x16x32_bf16 v[96:99], a[248:251], v[120:123], v[96:99]
    s_waitcnt lgkmcnt(0)
    v_mfma_f32_16x16x32_bf16 v[96:99], v[192:195], v[124:127], v[96:99]
    v_mfma_f32_16x16x32_bf16 v[96:99], v[204:207], v[128:131], v[96:99]
    v_mfma_f32_16x16x32_bf16 v[96:99], v[216:219], v[132:135], v[96:99]
    v_mfma_f32_16x16x32_bf16 v[96:99], v[228:231], v[136:139], v[96:99]
    v_mfma_f32_16x16x32_bf16 v[96:99], v[240:243], v[140:143], v[96:99]
    v_mfma_f32_16x16x32_bf16 v[96:99], v[252:255], v[112:115], v[96:99]
    s_nop 2
    v_mfma_f32_16x16x32_bf16 v[88:91], a[252:255], v[124:127], v[88:91]
    s_nop 2
    v_mfma_f32_16x16x32_bf16 v[88:91], v[196:199], v[128:131], v[88:91]
    v_cvt_pk_bf16_f32 v96, v96, v97
    v_cvt_pk_bf16_f32 v97, v98, v99
    v_mfma_f32_16x16x32_bf16 v[88:91], v[208:211], v[132:135], v[88:91]
    ds_write_b64 v38, v[96:97] offset:12288
    v_mfma_f32_16x16x32_bf16 v[88:91], v[220:223], v[136:139], v[88:91]
    v_mfma_f32_16x16x32_bf16 v[88:91], v[232:235], v[140:143], v[88:91]
    v_mfma_f32_16x16x32_bf16 v[88:91], v[244:247], v[112:115], v[88:91]
    v_mfma_f32_16x16x32_bf16 v[92:95], v[188:191], v[124:127], v[92:95]
    s_waitcnt lgkmcnt(0)
    s_barrier
    v_mfma_f32_16x16x32_bf16 v[92:95], v[200:203], v[128:131], v[92:95]
    ds_read_b64 v[62:63], v39 offset:10240
    v_mfma_f32_16x16x32_bf16 v[92:95], v[212:215], v[132:135], v[92:95]
    ds_read_b64 v[50:51], v39 offset:12288
    v_mfma_f32_16x16x32_bf16 v[92:95], v[224:227], v[136:139], v[92:95]
    v_mfma_f32_16x16x32_bf16 v[92:95], v[236:239], v[140:143], v[92:95]
    v_cvt_pk_bf16_f32 v88, v88, v89
    v_cvt_pk_bf16_f32 v89, v90, v91
    v_mfma_f32_16x16x32_bf16 v[92:95], v[248:251], v[112:115], v[92:95]
    s_waitcnt lgkmcnt(0)
    buffer_store_dwordx2 v[62:63], v22, s[20:23], s76 offen sc1
    buffer_store_dwordx2 v[50:51], v22, s[20:23], s77 offen sc1
    s_nop 4
    v_cvt_pk_bf16_f32 v90, v92, v93
    v_cvt_pk_bf16_f32 v91, v94, v95
    s_nop 0
    v_permlane16_swap_b32 v88, v90
    v_permlane16_swap_b32 v89, v91
    buffer_store_dwordx4 v[88:91], v21, s[20:23], s77 offen sc1
L_check:
    s_cmp_lg_u32 s63, 0
    s_cbranch_scc1 L_slow
    s_endpgm
L_x_end:
L_more:
    ds_read2_b32 v[176:177], v24 offset0:64 offset1:96
    ds_read_b64 v[178:179], v25 offset:264
    s_waitcnt lgkmcnt(0)
    v_xor_b32 v172, v176, v26
    v_xor_b32 v174, v177, v26
    v_xor_b32 v173, v176, v27
    v_xor_b32 v175, v177, v27
    ds_read_b64_tr_b16 v[144:145], v172 offset:0
    ds_read_b64_tr_b16 v[146:147], v174 offset:0
    ds_read_b64_tr_b16 v[148:149], v173 offset:0
    ds_read_b64_tr_b16 v[150:151], v175 offset:0
    ds_read_b64_tr_b16 v[152:153], v172 offset:64
    ds_read_b64_tr_b16 v[154:155], v174 offset:64
    v_cndmask_b32 v169, 0, v179, s[88:89]
    v_cndmask_b32 v171, 0, v179, s[92:93]
    v_cndmask_b32 v168, 0, v178, s[88:89]
    v_cndmask_b32 v170, 0, v178, s[92:93]
    v_cndmask_b32 v169, v169, v178, s[90:91]
    v_cndmask_b32 v171, v171, v178, s[94:95]
    ds_read_b64_tr_b16 v[156:157], v173 offset:64
    ds_read_b64_tr_b16 v[158:159], v175 offset:64
    ds_read_b64_tr_b16 v[160:161], v172 offset:128
    ds_read_b64_tr_b16 v[162:163], v174 offset:128
    ds_read_b64_tr_b16 v[164:165], v173 offset:128
    ds_read_b64_tr_b16 v[166:167], v175 offset:128
    s_waitcnt lgkmcnt(0)
    v_mfma_f32_16x16x32_bf16 v[144:147], v[144:147], v[168:171], 0
    v_mfma_f32_16x16x32_bf16 v[148:151], v[148:151], v[168:171], 0
    v_mfma_f32_16x16x32_bf16 v[152:155], v[152:155], v[168:171], 0
    v_mfma_f32_16x16x32_bf16 v[156:159], v[156:159], v[168:171], 0
    v_mfma_f32_16x16x32_bf16 v[160:163], v[160:163], v[168:171], 0
    v_mfma_f32_16x16x32_bf16 v[164:167], v[164:167], v[168:171], 0
    s_nop 3
    v_cvt_pk_bf16_f32 v144, v144, v145
    v_cvt_pk_bf16_f32 v145, v146, v147
    ds_write_b64 v28, v[144:145] offset:12288
    v_cvt_pk_bf16_f32 v148, v148, v149
    v_cvt_pk_bf16_f32 v149, v150, v151
    ds_write_b64 v29, v[148:149] offset:12288
    v_cvt_pk_bf16_f32 v152, v152, v153
    v_cvt_pk_bf16_f32 v153, v154, v155
    ds_write_b64 v28, v[152:153] offset:12352
    v_cvt_pk_bf16_f32 v156, v156, v157
    v_cvt_pk_bf16_f32 v157, v158, v159
    ds_write_b64 v29, v[156:157] offset:12352
    v_cvt_pk_bf16_f32 v160, v160, v161
    v_cvt_pk_bf16_f32 v161, v162, v163
    ds_write_b64 v28, v[160:161] offset:12416
    v_cvt_pk_bf16_f32 v164, v164, v165
    v_cvt_pk_bf16_f32 v165, v166, v167
    ds_write_b64 v29, v[164:165] offset:12416
    s_waitcnt lgkmcnt(0)
    s_branch L_more_back
L_hot_end:
L_bfail1:
    v_mov_b32 v152, s60
    ds_write_b32 v110, v152 offset:4
    s_mov_b64 s[80:81], 0
    s_mov_b64 s[88:89], 0
    s_mov_b64 s[82:83], 0
    s_mov_b64 s[90:91], 0
    s_mov_b64 s[84:85], 0
    s_mov_b64 s[92:93], 0
    s_mov_b64 s[86:87], 0
    s_mov_b64 s[94:95], 0
    s_mov_b64 s[98:99], 0
    s_mov_b32 s62, 0
    s_branch L_bfail1_back
L_bfail2:
    v_mov_b32 v144, s38
    ds_or_b32 v34, v144
    s_branch L_bfail2_back
L_afailX:
    v_mul_u32_u24 v32, 1821, v0
    v_lshrrev_b32 v32, 16, v32
    v_lshlrev_b32 v32, v32, 1
    v_lshlrev_b32 v33, 7, v32
    s_mov_b64 exec, s[80:81]
    ds_or_b32 v34, v32
    s_mov_b64 exec, s[82:83]
    ds_or_b32 v34, v33
    s_mov_b64 exec, -1
    s_waitcnt lgkmcnt(0)
    s_branch L_afailX_back
L_afailY:
    v_mul_u32_u24 v32, 1821, v0
    v_lshrrev_b32 v32, 16, v32
    v_lshlrev_b32 v32, v32, 1
    v_lshlrev_b32 v33, 7, v32
    s_mov_b64 exec, s[80:81]
    ds_or_b32 v34, v32
    s_mov_b64 exec, s[82:83]
    ds_or_b32 v34, v33
    s_mov_b64 exec, -1
    s_waitcnt lgkmcnt(0)
    s_branch L_afailY_back
L_slow:
    s_waitcnt vmcnt(0) lgkmcnt(0)
    s_barrier
    s_ff1_i32_b32 s80, s63
    s_bitset0_b32 s63, s80
    s_mul_i32 s81, s80, 224
    s_add_u32 s81, s81, s45
    s_mov_b32 s82, 1
    s_cmp_lt_u32 s80, 16
    s_cbranch_scc1 L_s1
    s_bfe_u32 s40, s80, 0x10002
    s_add_u32 s40, s40, s53
    s_and_b32 s41, s80, 3
    s_lshl_b32 s41, s41, 4
    s_cmp_eq_u32 s47, 0
    s_cselect_b32 s82, 1, 224
    s_cselect_b32 s81, 224, 1
    s_mul_i32 s81, s81, s40
    s_mul_i32 s41, s41, s82
    s_add_u32 s81, s81, s41
L_s1:
    s_movk_i32 s43, 224
    v_mul_u32_u24 v79, s82, v2
    v_lshl_add_u32 v49, s2, 2, v3
    v_lshl_add_u32 v49, v49, 3, 64
    v_mad_u32_u24 v49, v79, s42, v49
    v_add_u32 v79, s81, v79
    v_lshrrev_b32 v80, 4, v0
    v_min_u32 v80, 8, v80
    v_mul_u32_u24 v85, 36, v79
    v_lshl_add_u32 v85, v80, 2, v85
    buffer_load_dword v85, v85, s[12:15], 0 offen
    v_mul_u32_u24 v81, 74899, v79
    v_lshrrev_b32 v81, 24, v81
    v_mul_u32_u24 v82, 224, v81
    v_sub_u32 v82, v79, v82
    v_mul_u32_u24 v83, 11, v80
    v_lshrrev_b32 v83, 5, v83
    v_mad_i32_i24 v84, v83, -3, v80
    v_add3_u32 v81, v81, v83, -1
    v_add3_u32 v82, v82, v84, -1
    v_cvt_f32_i32 v81, v81
    v_cvt_f32_i32 v82, v82
    s_waitcnt vmcnt(0)
    v_lshlrev_b32 v65, 16, v85
    v_and_b32 v66, 0xffff0000, v85
    v_add_f32 v65, v81, v65
    v_add_f32 v66, v82, v66
    v_cvt_pk_bf16_f32 v64, v65, v66
    v_pk_max_i16 v64, v64, 0
    v_pk_min_i16 v64, v64, s60
    v_lshlrev_b32 v65, 16, v64
    v_and_b32 v66, 0xffff0000, v64
    v_fract_f32 v71, v65
    v_fract_f32 v72, v66
    v_ceil_f32 v68, v65
    v_ceil_f32 v70, v66
    v_sub_f32 v73, 1.0, v71
    v_sub_f32 v74, 1.0, v72
    v_cvt_u32_f32 v67, v65
    v_cvt_u32_f32 v69, v66
    v_cvt_pk_bf16_f32 v74, v73, v74
    v_cvt_u32_f32 v68, v68
    v_cvt_u32_f32 v70, v70
    v_lshlrev_b32 v73, 16, v74
    v_and_b32 v74, 0xffff0000, v74
    v_mul_f32 v78, v71, v72
    v_mul_f32 v76, v73, v72
    v_mul_f32 v77, v71, v74
    v_mul_f32 v75, v73, v74
    v_mad_u32_u24 v88, v67, s43, v69
    v_mul_u32_u24 v88, 192, v88
    v_mad_u32_u24 v89, v67, s43, v70
    v_mul_u32_u24 v89, 192, v89
    v_mad_u32_u24 v90, v68, s43, v69
    v_mul_u32_u24 v90, 192, v90
    v_mad_u32_u24 v91, v68, s43, v70
    v_mul_u32_u24 v91, 192, v91
    v_cvt_pk_bf16_f32 v92, v75, v76
    v_cvt_pk_bf16_f32 v93, v77, v78
    v_lshlrev_b32 v79, 5, v0
    v_add_u32 v79, 61440, v79
    ds_write_b128 v79, v[88:91]
    ds_write_b64 v79, v[92:93] offset:16
    s_mov_b32 s83, 0
    s_waitcnt lgkmcnt(0)
    s_barrier
L_s2:
    s_add_u32 s40, s83, 0
    v_add_u32 v96, s40, v0
    v_mul_u32_u24 v70, 5462, v96
    v_lshrrev_b32 v70, 16, v70
    v_mad_i32_i24 v71, v70, -12, v96
    v_lshlrev_b32 v70, 5, v70
    v_add_u32 v70, 61440, v70
    ds_read_b128 v[64:67], v70
    ds_read_b64 v[68:69], v70 offset:16
    v_lshlrev_b32 v96, 4, v96
    s_add_u32 s40, s83, 256
    v_add_u32 v97, s40, v0
    v_mul_u32_u24 v78, 5462, v97
    v_lshrrev_b32 v78, 16, v78
    v_mad_i32_i24 v79, v78, -12, v97
    v_lshlrev_b32 v78, 5, v78
    v_add_u32 v78, 61440, v78
    ds_read_b128 v[72:75], v78
    ds_read_b64 v[76:77], v78 offset:16
    v_lshlrev_b32 v97, 4, v97
    s_add_u32 s40, s83, 512
    v_add_u32 v98, s40, v0
    v_mul_u32_u24 v86, 5462, v98
    v_lshrrev_b32 v86, 16, v86
    v_mad_i32_i24 v87, v86, -12, v98
    v_lshlrev_b32 v86, 5, v86
    v_add_u32 v86, 61440, v86
    ds_read_b128 v[80:83], v86
    ds_read_b64 v[84:85], v86 offset:16
    v_lshlrev_b32 v98, 4, v98
    s_add_u32 s40, s83, 768
    v_add_u32 v99, s40, v0
    v_mul_u32_u24 v94, 5462, v99
    v_lshrrev_b32 v94, 16, v94
    v_mad_i32_i24 v95, v94, -12, v99
    v_lshlrev_b32 v94, 5, v94
    v_add_u32 v94, 61440, v94
    ds_read_b128 v[88:91], v94
    ds_read_b64 v[92:93], v94 offset:16
    v_lshlrev_b32 v99, 4, v99
    s_waitcnt lgkmcnt(0)
    v_lshl_add_u32 v64, v71, 4, v64
    buffer_load_dwordx4 v[100:103], v64, s[8:11], 0 offen
    v_lshl_add_u32 v65, v71, 4, v65
    buffer_load_dwordx4 v[104:107], v65, s[8:11], 0 offen
    v_lshl_add_u32 v66, v71, 4, v66
    buffer_load_dwordx4 v[108:111], v66, s[8:11], 0 offen
    v_lshl_add_u32 v67, v71, 4, v67
    buffer_load_dwordx4 v[112:115], v67, s[8:11], 0 offen
    v_lshl_add_u32 v72, v79, 4, v72
    buffer_load_dwordx4 v[116:119], v72, s[8:11], 0 offen
    v_lshl_add_u32 v73, v79, 4, v73
    buffer_load_dwordx4 v[120:123], v73, s[8:11], 0 offen
    v_lshl_add_u32 v74, v79, 4, v74
    buffer_load_dwordx4 v[124:127], v74, s[8:11], 0 offen
    v_lshl_add_u32 v75, v79, 4, v75
    buffer_load_dwordx4 v[128:131], v75, s[8:11], 0 offen
    v_lshl_add_u32 v80, v87, 4, v80
    buffer_load_dwordx4 v[132:135], v80, s[8:11], 0 offen
    v_lshl_add_u32 v81, v87, 4, v81
    buffer_load_dwordx4 v[136:139], v81, s[8:11], 0 offen
    v_lshl_add_u32 v82, v87, 4, v82
    buffer_load_dwordx4 v[140:143], v82, s[8:11], 0 offen
    v_lshl_add_u32 v83, v87, 4, v83
    buffer_load_dwordx4 v[144:147], v83, s[8:11], 0 offen
    v_lshl_add_u32 v88, v95, 4, v88
    buffer_load_dwordx4 v[148:151], v88, s[8:11], 0 offen
    v_lshl_add_u32 v89, v95, 4, v89
    buffer_load_dwordx4 v[152:155], v89, s[8:11], 0 offen
    v_lshl_add_u32 v90, v95, 4, v90
    buffer_load_dwordx4 v[156:159], v90, s[8:11], 0 offen
    v_lshl_add_u32 v91, v95, 4, v91
    buffer_load_dwordx4 v[160:163], v91, s[8:11], 0 offen
    s_waitcnt vmcnt(12)
    v_lshlrev_b32 v172, 16, v68
    v_lshlrev_b32 v173, 16, v100
    v_and_b32 v174, 0xffff0000, v100
    v_mul_f32 v164, v172, v173
    v_mul_f32 v165, v172, v174
    v_lshlrev_b32 v173, 16, v101
    v_and_b32 v174, 0xffff0000, v101
    v_mul_f32 v166, v172, v173
    v_mul_f32 v167, v172, v174
    v_lshlrev_b32 v173, 16, v102
    v_and_b32 v174, 0xffff0000, v102
    v_mul_f32 v168, v172, v173
    v_mul_f32 v169, v172, v174
    v_lshlrev_b32 v173, 16, v103
    v_and_b32 v174, 0xffff0000, v103
    v_mul_f32 v170, v172, v173
    v_mul_f32 v171, v172, v174
    v_and_b32 v172, 0xffff0000, v68
    v_lshlrev_b32 v173, 16, v104
    v_and_b32 v174, 0xffff0000, v104
    v_fmac_f32 v164, v172, v173
    v_fmac_f32 v165, v172, v174
    v_lshlrev_b32 v173, 16, v105
    v_and_b32 v174, 0xffff0000, v105
    v_fmac_f32 v166, v172, v173
    v_fmac_f32 v167, v172, v174
    v_lshlrev_b32 v173, 16, v106
    v_and_b32 v174, 0xffff0000, v106
    v_fmac_f32 v168, v172, v173
    v_fmac_f32 v169, v172, v174
    v_lshlrev_b32 v173, 16, v107
    v_and_b32 v174, 0xffff0000, v107
    v_fmac_f32 v170, v172, v173
    v_fmac_f32 v171, v172, v174
    v_lshlrev_b32 v172, 16, v69
    v_lshlrev_b32 v173, 16, v108
    v_and_b32 v174, 0xffff0000, v108
    v_fmac_f32 v164, v172, v173
    v_fmac_f32 v165, v172, v174
    v_lshlrev_b32 v173, 16, v109
    v_and_b32 v174, 0xffff0000, v109
    v_fmac_f32 v166, v172, v173
    v_fmac_f32 v167, v172, v174
    v_lshlrev_b32 v173, 16, v110
    v_and_b32 v174, 0xffff0000, v110
    v_fmac_f32 v168, v172, v173
    v_fmac_f32 v169, v172, v174
    v_lshlrev_b32 v173, 16, v111
    v_and_b32 v174, 0xffff0000, v111
    v_fmac_f32 v170, v172, v173
    v_fmac_f32 v171, v172, v174
    v_and_b32 v172, 0xffff0000, v69
    v_lshlrev_b32 v173, 16, v112
    v_and_b32 v174, 0xffff0000, v112
    v_fmac_f32 v164, v172, v173
    v_fmac_f32 v165, v172, v174
    v_lshlrev_b32 v173, 16, v113
    v_and_b32 v174, 0xffff0000, v113
    v_fmac_f32 v166, v172, v173
    v_fmac_f32 v167, v172, v174
    v_lshlrev_b32 v173, 16, v114
    v_and_b32 v174, 0xffff0000, v114
    v_fmac_f32 v168, v172, v173
    v_fmac_f32 v169, v172, v174
    v_lshlrev_b32 v173, 16, v115
    v_and_b32 v174, 0xffff0000, v115
    v_fmac_f32 v170, v172, v173
    v_fmac_f32 v171, v172, v174
    v_cvt_pk_bf16_f32 v176, v164, v165
    v_cvt_pk_bf16_f32 v177, v166, v167
    v_cvt_pk_bf16_f32 v178, v168, v169
    v_cvt_pk_bf16_f32 v179, v170, v171
    ds_write_b128 v96, v[176:179]
    s_waitcnt vmcnt(8)
    v_lshlrev_b32 v172, 16, v76
    v_lshlrev_b32 v173, 16, v116
    v_and_b32 v174, 0xffff0000, v116
    v_mul_f32 v164, v172, v173
    v_mul_f32 v165, v172, v174
    v_lshlrev_b32 v173, 16, v117
    v_and_b32 v174, 0xffff0000, v117
    v_mul_f32 v166, v172, v173
    v_mul_f32 v167, v172, v174
    v_lshlrev_b32 v173, 16, v118
    v_and_b32 v174, 0xffff0000, v118
    v_mul_f32 v168, v172, v173
    v_mul_f32 v169, v172, v174
    v_lshlrev_b32 v173, 16, v119
    v_and_b32 v174, 0xffff0000, v119
    v_mul_f32 v170, v172, v173
    v_mul_f32 v171, v172, v174
    v_and_b32 v172, 0xffff0000, v76
    v_lshlrev_b32 v173, 16, v120
    v_and_b32 v174, 0xffff0000, v120
    v_fmac_f32 v164, v172, v173
    v_fmac_f32 v165, v172, v174
    v_lshlrev_b32 v173, 16, v121
    v_and_b32 v174, 0xffff0000, v121
    v_fmac_f32 v166, v172, v173
    v_fmac_f32 v167, v172, v174
    v_lshlrev_b32 v173, 16, v122
    v_and_b32 v174, 0xffff0000, v122
    v_fmac_f32 v168, v172, v173
    v_fmac_f32 v169, v172, v174
    v_lshlrev_b32 v173, 16, v123
    v_and_b32 v174, 0xffff0000, v123
    v_fmac_f32 v170, v172, v173
    v_fmac_f32 v171, v172, v174
    v_lshlrev_b32 v172, 16, v77
    v_lshlrev_b32 v173, 16, v124
    v_and_b32 v174, 0xffff0000, v124
    v_fmac_f32 v164, v172, v173
    v_fmac_f32 v165, v172, v174
    v_lshlrev_b32 v173, 16, v125
    v_and_b32 v174, 0xffff0000, v125
    v_fmac_f32 v166, v172, v173
    v_fmac_f32 v167, v172, v174
    v_lshlrev_b32 v173, 16, v126
    v_and_b32 v174, 0xffff0000, v126
    v_fmac_f32 v168, v172, v173
    v_fmac_f32 v169, v172, v174
    v_lshlrev_b32 v173, 16, v127
    v_and_b32 v174, 0xffff0000, v127
    v_fmac_f32 v170, v172, v173
    v_fmac_f32 v171, v172, v174
    v_and_b32 v172, 0xffff0000, v77
    v_lshlrev_b32 v173, 16, v128
    v_and_b32 v174, 0xffff0000, v128
    v_fmac_f32 v164, v172, v173
    v_fmac_f32 v165, v172, v174
    v_lshlrev_b32 v173, 16, v129
    v_and_b32 v174, 0xffff0000, v129
    v_fmac_f32 v166, v172, v173
    v_fmac_f32 v167, v172, v174
    v_lshlrev_b32 v173, 16, v130
    v_and_b32 v174, 0xffff0000, v130
    v_fmac_f32 v168, v172, v173
    v_fmac_f32 v169, v172, v174
    v_lshlrev_b32 v173, 16, v131
    v_and_b32 v174, 0xffff0000, v131
    v_fmac_f32 v170, v172, v173
    v_fmac_f32 v171, v172, v174
    v_cvt_pk_bf16_f32 v176, v164, v165
    v_cvt_pk_bf16_f32 v177, v166, v167
    v_cvt_pk_bf16_f32 v178, v168, v169
    v_cvt_pk_bf16_f32 v179, v170, v171
    ds_write_b128 v97, v[176:179]
    s_waitcnt vmcnt(4)
    v_lshlrev_b32 v172, 16, v84
    v_lshlrev_b32 v173, 16, v132
    v_and_b32 v174, 0xffff0000, v132
    v_mul_f32 v164, v172, v173
    v_mul_f32 v165, v172, v174
    v_lshlrev_b32 v173, 16, v133
    v_and_b32 v174, 0xffff0000, v133
    v_mul_f32 v166, v172, v173
    v_mul_f32 v167, v172, v174
    v_lshlrev_b32 v173, 16, v134
    v_and_b32 v174, 0xffff0000, v134
    v_mul_f32 v168, v172, v173
    v_mul_f32 v169, v172, v174
    v_lshlrev_b32 v173, 16, v135
    v_and_b32 v174, 0xffff0000, v135
    v_mul_f32 v170, v172, v173
    v_mul_f32 v171, v172, v174
    v_and_b32 v172, 0xffff0000, v84
    v_lshlrev_b32 v173, 16, v136
    v_and_b32 v174, 0xffff0000, v136
    v_fmac_f32 v164, v172, v173
    v_fmac_f32 v165, v172, v174
    v_lshlrev_b32 v173, 16, v137
    v_and_b32 v174, 0xffff0000, v137
    v_fmac_f32 v166, v172, v173
    v_fmac_f32 v167, v172, v174
    v_lshlrev_b32 v173, 16, v138
    v_and_b32 v174, 0xffff0000, v138
    v_fmac_f32 v168, v172, v173
    v_fmac_f32 v169, v172, v174
    v_lshlrev_b32 v173, 16, v139
    v_and_b32 v174, 0xffff0000, v139
    v_fmac_f32 v170, v172, v173
    v_fmac_f32 v171, v172, v174
    v_lshlrev_b32 v172, 16, v85
    v_lshlrev_b32 v173, 16, v140
    v_and_b32 v174, 0xffff0000, v140
    v_fmac_f32 v164, v172, v173
    v_fmac_f32 v165, v172, v174
    v_lshlrev_b32 v173, 16, v141
    v_and_b32 v174, 0xffff0000, v141
    v_fmac_f32 v166, v172, v173
    v_fmac_f32 v167, v172, v174
    v_lshlrev_b32 v173, 16, v142
    v_and_b32 v174, 0xffff0000, v142
    v_fmac_f32 v168, v172, v173
    v_fmac_f32 v169, v172, v174
    v_lshlrev_b32 v173, 16, v143
    v_and_b32 v174, 0xffff0000, v143
    v_fmac_f32 v170, v172, v173
    v_fmac_f32 v171, v172, v174
    v_and_b32 v172, 0xffff0000, v85
    v_lshlrev_b32 v173, 16, v144
    v_and_b32 v174, 0xffff0000, v144
    v_fmac_f32 v164, v172, v173
    v_fmac_f32 v165, v172, v174
    v_lshlrev_b32 v173, 16, v145
    v_and_b32 v174, 0xffff0000, v145
    v_fmac_f32 v166, v172, v173
    v_fmac_f32 v167, v172, v174
    v_lshlrev_b32 v173, 16, v146
    v_and_b32 v174, 0xffff0000, v146
    v_fmac_f32 v168, v172, v173
    v_fmac_f32 v169, v172, v174
    v_lshlrev_b32 v173, 16, v147
    v_and_b32 v174, 0xffff0000, v147
    v_fmac_f32 v170, v172, v173
    v_fmac_f32 v171, v172, v174
    v_cvt_pk_bf16_f32 v176, v164, v165
    v_cvt_pk_bf16_f32 v177, v166, v167
    v_cvt_pk_bf16_f32 v178, v168, v169
    v_cvt_pk_bf16_f32 v179, v170, v171
    ds_write_b128 v98, v[176:179]
    s_waitcnt vmcnt(0)
    v_lshlrev_b32 v172, 16, v92
    v_lshlrev_b32 v173, 16, v148
    v_and_b32 v174, 0xffff0000, v148
    v_mul_f32 v164, v172, v173
    v_mul_f32 v165, v172, v174
    v_lshlrev_b32 v173, 16, v149
    v_and_b32 v174, 0xffff0000, v149
    v_mul_f32 v166, v172, v173
    v_mul_f32 v167, v172, v174
    v_lshlrev_b32 v173, 16, v150
    v_and_b32 v174, 0xffff0000, v150
    v_mul_f32 v168, v172, v173
    v_mul_f32 v169, v172, v174
    v_lshlrev_b32 v173, 16, v151
    v_and_b32 v174, 0xffff0000, v151
    v_mul_f32 v170, v172, v173
    v_mul_f32 v171, v172, v174
    v_and_b32 v172, 0xffff0000, v92
    v_lshlrev_b32 v173, 16, v152
    v_and_b32 v174, 0xffff0000, v152
    v_fmac_f32 v164, v172, v173
    v_fmac_f32 v165, v172, v174
    v_lshlrev_b32 v173, 16, v153
    v_and_b32 v174, 0xffff0000, v153
    v_fmac_f32 v166, v172, v173
    v_fmac_f32 v167, v172, v174
    v_lshlrev_b32 v173, 16, v154
    v_and_b32 v174, 0xffff0000, v154
    v_fmac_f32 v168, v172, v173
    v_fmac_f32 v169, v172, v174
    v_lshlrev_b32 v173, 16, v155
    v_and_b32 v174, 0xffff0000, v155
    v_fmac_f32 v170, v172, v173
    v_fmac_f32 v171, v172, v174
    v_lshlrev_b32 v172, 16, v93
    v_lshlrev_b32 v173, 16, v156
    v_and_b32 v174, 0xffff0000, v156
    v_fmac_f32 v164, v172, v173
    v_fmac_f32 v165, v172, v174
    v_lshlrev_b32 v173, 16, v157
    v_and_b32 v174, 0xffff0000, v157
    v_fmac_f32 v166, v172, v173
    v_fmac_f32 v167, v172, v174
    v_lshlrev_b32 v173, 16, v158
    v_and_b32 v174, 0xffff0000, v158
    v_fmac_f32 v168, v172, v173
    v_fmac_f32 v169, v172, v174
    v_lshlrev_b32 v173, 16, v159
    v_and_b32 v174, 0xffff0000, v159
    v_fmac_f32 v170, v172, v173
    v_fmac_f32 v171, v172, v174
    v_and_b32 v172, 0xffff0000, v93
    v_lshlrev_b32 v173, 16, v160
    v_and_b32 v174, 0xffff0000, v160
    v_fmac_f32 v164, v172, v173
    v_fmac_f32 v165, v172, v174
    v_lshlrev_b32 v173, 16, v161
    v_and_b32 v174, 0xffff0000, v161
    v_fmac_f32 v166, v172, v173
    v_fmac_f32 v167, v172, v174
    v_lshlrev_b32 v173, 16, v162
    v_and_b32 v174, 0xffff0000, v162
    v_fmac_f32 v168, v172, v173
    v_fmac_f32 v169, v172, v174
    v_lshlrev_b32 v173, 16, v163
    v_and_b32 v174, 0xffff0000, v163
    v_fmac_f32 v170, v172, v173
    v_fmac_f32 v171, v172, v174
    v_cvt_pk_bf16_f32 v176, v164, v165
    v_cvt_pk_bf16_f32 v177, v166, v167
    v_cvt_pk_bf16_f32 v178, v168, v169
    v_cvt_pk_bf16_f32 v179, v170, v171
    ds_write_b128 v99, v[176:179]
    s_add_u32 s83, s83, 1024
    s_cmp_lt_u32 s83, 1728
    s_cbranch_scc1 L_s2
    s_waitcnt lgkmcnt(0)
    s_barrier
    s_cmp_ge_u32 s3, 2
    s_cbranch_scc1 L_s3
    v_mad_u32_u24 v40, v2, s42, v4
    ds_read_b128 v[112:115], v40 offset:0
    ds_read_b128 v[116:119], v40 offset:64
    ds_read_b128 v[120:123], v40 offset:128
    s_waitcnt lgkmcnt(0)
    v_mfma_f32_16x16x32_bf16 v[64:67], a[0:3], v[112:115], 0
    v_mfma_f32_16x16x32_bf16 v[68:71], a[4:7], v[112:115], 0
    v_mfma_f32_16x16x32_bf16 v[72:75], a[8:11], v[112:115], 0
    v_mfma_f32_16x16x32_bf16 v[64:67], a[12:15], v[116:119], v[64:67]
    v_mfma_f32_16x16x32_bf16 v[68:71], a[16:19], v[116:119], v[68:71]
    v_mfma_f32_16x16x32_bf16 v[72:75], a[20:23], v[116:119], v[72:75]
    v_mfma_f32_16x16x32_bf16 v[64:67], a[24:27], v[120:123], v[64:67]
    v_mfma_f32_16x16x32_bf16 v[68:71], a[28:31], v[120:123], v[68:71]
    v_mfma_f32_16x16x32_bf16 v[72:75], a[32:35], v[120:123], v[72:75]
    s_nop 1
    ds_read_b128 v[112:115], v40 offset:3072
    ds_read_b128 v[116:119], v40 offset:3136
    ds_read_b128 v[120:123], v40 offset:3200
    s_waitcnt lgkmcnt(0)
    v_mfma_f32_16x16x32_bf16 v[64:67], a[36:39], v[112:115], v[64:67]
    v_mfma_f32_16x16x32_bf16 v[68:71], a[40:43], v[112:115], v[68:71]
    v_mfma_f32_16x16x32_bf16 v[72:75], a[44:47], v[112:115], v[72:75]
    v_mfma_f32_16x16x32_bf16 v[64:67], a[48:51], v[116:119], v[64:67]
    v_mfma_f32_16x16x32_bf16 v[68:71], a[52:55], v[116:119], v[68:71]
    v_mfma_f32_16x16x32_bf16 v[72:75], a[56:59], v[116:119], v[72:75]
    v_mfma_f32_16x16x32_bf16 v[64:67], a[60:63], v[120:123], v[64:67]
    v_mfma_f32_16x16x32_bf16 v[68:71], a[64:67], v[120:123], v[68:71]
    v_mfma_f32_16x16x32_bf16 v[72:75], a[68:71], v[120:123], v[72:75]
    s_nop 1
    ds_read_b128 v[112:115], v40 offset:6144
    ds_read_b128 v[116:119], v40 offset:6208
    ds_read_b128 v[120:123], v40 offset:6272
    s_waitcnt lgkmcnt(0)
    v_mfma_f32_16x16x32_bf16 v[64:67], a[72:75], v[112:115], v[64:67]
    v_mfma_f32_16x16x32_bf16 v[68:71], a[76:79], v[112:115], v[68:71]
    v_mfma_f32_16x16x32_bf16 v[72:75], a[80:83], v[112:115], v[72:75]
    v_mfma_f32_16x16x32_bf16 v[64:67], a[84:87], v[116:119], v[64:67]
    v_mfma_f32_16x16x32_bf16 v[68:71], a[88:91], v[116:119], v[68:71]
    v_mfma_f32_16x16x32_bf16 v[72:75], a[92:95], v[116:119], v[72:75]
    v_mfma_f32_16x16x32_bf16 v[64:67], a[96:99], v[120:123], v[64:67]
    v_mfma_f32_16x16x32_bf16 v[68:71], a[100:103], v[120:123], v[68:71]
    v_mfma_f32_16x16x32_bf16 v[72:75], a[104:107], v[120:123], v[72:75]
    s_nop 1
    ds_read_b128 v[112:115], v40 offset:9216
    ds_read_b128 v[116:119], v40 offset:9280
    ds_read_b128 v[120:123], v40 offset:9344
    s_waitcnt lgkmcnt(0)
    v_mfma_f32_16x16x32_bf16 v[64:67], a[108:111], v[112:115], v[64:67]
    v_mfma_f32_16x16x32_bf16 v[68:71], a[112:115], v[112:115], v[68:71]
    v_mfma_f32_16x16x32_bf16 v[72:75], a[116:119], v[112:115], v[72:75]
    v_mfma_f32_16x16x32_bf16 v[64:67], a[120:123], v[116:119], v[64:67]
    v_mfma_f32_16x16x32_bf16 v[68:71], a[124:127], v[116:119], v[68:71]
    v_mfma_f32_16x16x32_bf16 v[72:75], a[128:131], v[116:119], v[72:75]
    v_mfma_f32_16x16x32_bf16 v[64:67], a[132:135], v[120:123], v[64:67]
    v_mfma_f32_16x16x32_bf16 v[68:71], a[136:139], v[120:123], v[68:71]
    v_mfma_f32_16x16x32_bf16 v[72:75], a[140:143], v[120:123], v[72:75]
    s_nop 1
    ds_read_b128 v[112:115], v40 offset:12288
    ds_read_b128 v[116:119], v40 offset:12352
    ds_read_b128 v[120:123], v40 offset:12416
    s_waitcnt lgkmcnt(0)
    v_mfma_f32_16x16x32_bf16 v[64:67], a[144:147], v[112:115], v[64:67]
    v_mfma_f32_16x16x32_bf16 v[68:71], a[148:151], v[112:115], v[68:71]
    v_mfma_f32_16x16x32_bf16 v[72:75], a[152:155], v[112:115], v[72:75]
    v_mfma_f32_16x16x32_bf16 v[64:67], a[156:159], v[116:119], v[64:67]
    v_mfma_f32_16x16x32_bf16 v[68:71], a[160:163], v[116:119], v[68:71]
    v_mfma_f32_16x16x32_bf16 v[72:75], a[164:167], v[116:119], v[72:75]
    v_mfma_f32_16x16x32_bf16 v[64:67], a[168:171], v[120:123], v[64:67]
    v_mfma_f32_16x16x32_bf16 v[68:71], a[172:175], v[120:123], v[68:71]
    v_mfma_f32_16x16x32_bf16 v[72:75], a[176:179], v[120:123], v[72:75]
    s_nop 1
    ds_read_b128 v[112:115], v40 offset:15360
    ds_read_b128 v[116:119], v40 offset:15424
    ds_read_b128 v[120:123], v40 offset:15488
    s_waitcnt lgkmcnt(0)
    v_mfma_f32_16x16x32_bf16 v[64:67], a[180:183], v[112:115], v[64:67]
    v_mfma_f32_16x16x32_bf16 v[68:71], a[184:187], v[112:115], v[68:71]
    v_mfma_f32_16x16x32_bf16 v[72:75], a[188:191], v[112:115], v[72:75]
    v_mfma_f32_16x16x32_bf16 v[64:67], a[192:195], v[116:119], v[64:67]
    v_mfma_f32_16x16x32_bf16 v[68:71], a[196:199], v[116:119], v[68:71]
    v_mfma_f32_16x16x32_bf16 v[72:75], a[200:203], v[116:119], v[72:75]
    v_mfma_f32_16x16x32_bf16 v[64:67], a[204:207], v[120:123], v[64:67]
    v_mfma_f32_16x16x32_bf16 v[68:71], a[208:211], v[120:123], v[68:71]
    v_mfma_f32_16x16x32_bf16 v[72:75], a[212:215], v[120:123], v[72:75]
    s_nop 1
    ds_read_b128 v[112:115], v40 offset:18432
    ds_read_b128 v[116:119], v40 offset:18496
    ds_read_b128 v[120:123], v40 offset:18560
    s_waitcnt lgkmcnt(0)
    v_mfma_f32_16x16x32_bf16 v[64:67], a[216:219], v[112:115], v[64:67]
    v_mfma_f32_16x16x32_bf16 v[68:71], a[220:223], v[112:115], v[68:71]
    v_mfma_f32_16x16x32_bf16 v[72:75], a[224:227], v[112:115], v[72:75]
    v_mfma_f32_16x16x32_bf16 v[64:67], a[228:231], v[116:119], v[64:67]
    v_mfma_f32_16x16x32_bf16 v[68:71], a[232:235], v[116:119], v[68:71]
    v_mfma_f32_16x16x32_bf16 v[72:75], a[236:239], v[116:119], v[72:75]
    v_mfma_f32_16x16x32_bf16 v[64:67], a[240:243], v[120:123], v[64:67]
    v_mfma_f32_16x16x32_bf16 v[68:71], a[244:247], v[120:123], v[68:71]
    v_mfma_f32_16x16x32_bf16 v[72:75], a[248:251], v[120:123], v[72:75]
    s_nop 1
    ds_read_b128 v[112:115], v40 offset:21504
    ds_read_b128 v[116:119], v40 offset:21568
    ds_read_b128 v[120:123], v40 offset:21632
    s_waitcnt lgkmcnt(0)
    v_mfma_f32_16x16x32_bf16 v[64:67], a[252:255], v[112:115], v[64:67]
    v_mfma_f32_16x16x32_bf16 v[68:71], v[188:191], v[112:115], v[68:71]
    v_mfma_f32_16x16x32_bf16 v[72:75], v[192:195], v[112:115], v[72:75]
    v_mfma_f32_16x16x32_bf16 v[64:67], v[196:199], v[116:119], v[64:67]
    v_mfma_f32_16x16x32_bf16 v[68:71], v[200:203], v[116:119], v[68:71]
    v_mfma_f32_16x16x32_bf16 v[72:75], v[204:207], v[116:119], v[72:75]
    v_mfma_f32_16x16x32_bf16 v[64:67], v[208:211], v[120:123], v[64:67]
    v_mfma_f32_16x16x32_bf16 v[68:71], v[212:215], v[120:123], v[68:71]
    v_mfma_f32_16x16x32_bf16 v[72:75], v[216:219], v[120:123], v[72:75]
    s_nop 1
    ds_read_b128 v[112:115], v40 offset:24576
    ds_read_b128 v[116:119], v40 offset:24640
    ds_read_b128 v[120:123], v40 offset:24704
    s_waitcnt lgkmcnt(0)
    v_mfma_f32_16x16x32_bf16 v[64:67], v[220:223], v[112:115], v[64:67]
    v_mfma_f32_16x16x32_bf16 v[68:71], v[224:227], v[112:115], v[68:71]
    v_mfma_f32_16x16x32_bf16 v[72:75], v[228:231], v[112:115], v[72:75]
    v_mfma_f32_16x16x32_bf16 v[64:67], v[232:235], v[116:119], v[64:67]
    v_mfma_f32_16x16x32_bf16 v[68:71], v[236:239], v[116:119], v[68:71]
    v_mfma_f32_16x16x32_bf16 v[72:75], v[240:243], v[116:119], v[72:75]
    v_mfma_f32_16x16x32_bf16 v[64:67], v[244:247], v[120:123], v[64:67]
    v_mfma_f32_16x16x32_bf16 v[68:71], v[248:251], v[120:123], v[68:71]
    v_mfma_f32_16x16x32_bf16 v[72:75], v[252:255], v[120:123], v[72:75]
    s_nop 1
    s_mul_i32 s81, s81, 192
    s_cmp_lt_u32 s80, 16
    s_cselect_b64 vcc, -1, 0
    v_cndmask_b32 v40, v21, v19, vcc
    s_nop 5
    v_cvt_pk_bf16_f32 v64, v64, v65
    v_cvt_pk_bf16_f32 v65, v66, v67
    v_cvt_pk_bf16_f32 v66, v68, v69
    v_cvt_pk_bf16_f32 v67, v70, v71
    v_cvt_pk_bf16_f32 v72, v72, v73
    v_cvt_pk_bf16_f32 v73, v74, v75
    v_permlane16_swap_b32 v64, v66
    v_permlane16_swap_b32 v65, v67
    buffer_store_dwordx4 v[64:67], v40, s[20:23], s81 offen sc1
    buffer_store_dwordx2 v[72:73], v49, s[20:23], s81 offen sc1
L_s3:
    s_branch L_check
L_code_end:
L_end:
    s_endpgm
.section .rodata,"a"
.p2align 6
.amdhsa_kernel standalone__deformable_dcnv1__vision_kernel
  .amdhsa_next_free_vgpr 512
  .amdhsa_next_free_sgpr 102
  .amdhsa_accum_offset 256
  .amdhsa_group_segment_fixed_size 0
  .amdhsa_kernarg_size 48
  .amdhsa_user_sgpr_count 2
  .amdhsa_user_sgpr_kernarg_segment_ptr 1
  .amdhsa_system_sgpr_workgroup_id_x 1
  .amdhsa_float_denorm_mode_32 3
.end_amdhsa_kernel
```

```asm
; @launch grid=(256,1,1) block=(256,1,1) lds=159040

.amdgcn_target "amdgcn-amd-amdhsa--gfx950"
.text
.globl standalone__deformable_dcnv1__vision_kernel
.p2align 12
.type standalone__deformable_dcnv1__vision_kernel,@function
standalone__deformable_dcnv1__vision_kernel:
    s_cmpk_ge_u32 s2, 256
    s_cbranch_scc1 L_end
    s_load_dwordx2 s[8:9], s[0:1], 0
    s_load_dwordx2 s[16:17], s[0:1], 16
    s_load_dwordx2 s[12:13], s[0:1], 8
    s_load_dwordx2 s[20:21], s[0:1], 24
    s_getpc_b64 s[6:7]
L_pc:
    s_lshr_b32 s41, s2, 3
    v_lshrrev_b32 v144, 6, v0
    s_mul_i32 s40, s41, 768
    v_lshl_add_u32 v145, v0, 2, s40
    v_readfirstlane_b32 s3, v144
    global_load_dword v37, v145, s[6:7]
    s_and_b32 s85, s2, 7
    s_lshl_b32 s85, s85, 5
    s_add_u32 s85, s85, s41
    s_add_u32 s81, s85, 8
    s_mul_i32 s80, s81, 2731
    s_lshr_b32 s80, s80, 16
    s_mul_i32 s86, s80, 24
    s_sub_u32 s81, s81, s86
    s_cmp_lt_u32 s80, 3
    s_cselect_b32 s82, 16, 20
    s_cselect_b32 s83, 4, 8
    s_cmp_eq_u32 s80, 0
    s_cselect_b32 s82, 8, s82
    s_cselect_b32 s83, 5, s83
    s_cselect_b32 s86, -1, 47
    s_sub_u32 s84, s81, s82
    s_cselect_b32 s46, 0, s83
    s_mul_i32 s44, s81, 6
    s_mul_i32 s40, s84, s46
    s_add_u32 s86, s86, s44
    s_add_u32 s86, s86, s40
    s_mul_i32 s86, s86, 14
    s_add_u32 s44, s86, s80
    s_mulk_i32 s44, 3072
    s_addk_i32 s44, 9024
    v_and_b32 v1, 63, v0
    s_lshl2_add_u32 s41, s41, s3

    s_mulk_i32 s41, 1296
    v_min_u32 v70, 10, v1
    s_lshl_b32 s40, s3, 6
    v_lshl_add_u32 v70, v70, 7, s41
    s_min_u32 s40, s40, 152
    v_add_u32 v144, s40, v1
    s_lshl4_add_u32 s25, s40, 61440
    v_mul_u32_u24 v64, 5462, v144
    v_lshlrev_b32 v144, 4, v144
    v_lshrrev_b32 v64, 13, v64
    v_bitop3_b32 v8, v64, 32, v144 bitop3:0x6a
    v_lshlrev_b32 v5, 4, v1
    v_and_b32 v144, 32, v1
    v_xor_b32 v7, 32, v5
    v_xor_b32 v6, v144, v5
    s_mul_i32 s24, s3, 3072
    s_mov_b32 s41, 43008
    s_mov_b32 s10, 9633792
    s_mov_b32 s11, 0x20000
    s_mov_b32 s18, 165888
    s_mov_b32 s19, s11
    s_add_u32 m0, s24, 24576
    s_waitcnt lgkmcnt(0)
    buffer_load_dword v37, v70, s[16:19], 0 offen
    buffer_load_dwordx4 v5, s[16:19], s24 offen lds
    buffer_load_dwordx4 v6, s[16:19], s24 offen offset:1024 lds
    buffer_load_dwordx4 v7, s[16:19], s24 offen offset:2048 lds
    s_mov_b32 m0, s25
    s_lshr_b32 s57, s3, 1
    buffer_load_dwordx4 v8, s[8:11], s44 offen  lds
    s_addk_i32 m0, 10368
    s_add_u32 s31, s44, 129024
    buffer_load_dwordx4 v8, s[8:11], s31 offen  lds
    s_add_u32 m0, s24, 36864
    s_add_u32 s31, s24, 12288
    buffer_load_dwordx4 v5, s[16:19], s31 offen lds
    buffer_load_dwordx4 v6, s[16:19], s31 offen offset:1024 lds
    buffer_load_dwordx4 v7, s[16:19], s31 offen offset:2048 lds
    s_add_u32 m0, s25, 3456
    s_add_u32 s31, s44, 43008
    buffer_load_dwordx4 v8, s[8:11], s31 offen  lds
    s_addk_i32 m0, 10368
    s_add_u32 s31, s44, 172032
    buffer_load_dwordx4 v8, s[8:11], s31 offen  lds
L_issued:
    v_and_b32 v4, 48, v0
    s_add_u32 s86, s86, s80
    s_and_b32 s2, s3, 1
    s_lshl4_add_u32 s45, s86, 272
    s_mov_b32 s14, 1806336
    s_mov_b32 s15, 0x20000
    s_mov_b32 s22, 9633792
    s_mov_b32 s23, 0x20000
    s_mul_i32 s40, s2, 3072
    s_mul_i32 s26, s57, -104448
    s_add_u32 s26, s26, s40
    s_mul_i32 s27, s57, 6144
    s_add_u32 s27, s27, s40
    s_mul_i32 s28, s57, 55296
    s_add_u32 s28, s28, s40
    s_cmp_eq_u32 s46, 8
    s_cbranch_scc1 L_x
    v_mul_u32_u24 v65, 7282, v1
    s_mul_i32 s85, s82, s80
    s_mul_i32 s86, s83, 3
    v_lshrrev_b32 v65, 16, v65
    s_add_u32 s85, s85, s81
    s_sub_u32 s85, s85, s86
    v_mad_i32_i24 v66, v65, -9, v1
    s_cmp_ge_i32 s85, 92
    s_cselect_b32 s86, -168, 40
    s_cselect_b32 s47, 1, 0
    s_cselect_b32 s52, 8064, 36
    s_cselect_b32 s41, 36, 8064
    v_lshl_add_u32 v67, v65, 2, s3
    s_lshl1_add_u32 s53, s85, s86
    s_lshl3_add_u32 s86, s80, s84
    s_lshl_b32 s86, s86, 1
    v_lshlrev_b32 v71, 2, v66
    s_cmp_eq_u32 s46, 4
    s_cselect_b32 s53, s86, s53
    s_sub_u32 s86, s84, 1
    v_mad_u32_u24 v71, v67, s52, v71
    s_cmp_eq_u32 s46, 5
    s_cselect_b32 s53, s86, s53
    s_cselect_b32 s86, 0x7f000000, 0
    s_mul_i32 s40, s52, 24
    s_cmp_eq_u32 s46, 0
    s_cselect_b32 s40, s40, 0x7f000000
    s_cselect_b32 s85, 54, 36
    v_cmp_gt_u32 vcc, s85, v1
    v_mov_b32 v146, 0x7f000000
    s_mul_i32 s48, s53, s41
    s_add_u32 s49, s48, s41
    v_cndmask_b32 v71, v146, v71, vcc
    s_add_u32 s50, s48, s40
    s_add_u32 s51, s49, s40
    s_add_u32 s48, s48, s86
    buffer_load_dword v176, v71, s[12:15], s48 offen
    buffer_load_dword v177, v71, s[12:15], s49 offen
    buffer_load_dword v178, v71, s[12:15], s50 offen
    buffer_load_dword v179, v71, s[12:15], s51 offen
    v_and_b32 v2, 15, v0
    s_mul_i32 s54, s47, 42816
    s_addk_i32 s54, 192
    v_mul_u32_u24 v68, 11, v66
    v_lshrrev_b32 v68, 5, v68
    v_mad_i32_i24 v69, v68, -3, v66
    s_mov_b32 s60, 0x435f435f
    s_mov_b32 s59, 0x03020c0c
    s_cmp_eq_u32 s47, 0
    s_cselect_b32 s58, 0x01000c0c, s59
    s_cselect_b32 s59, s59, 0x01000c0c
    s_cselect_b64 vcc, -1, 0
    v_cndmask_b32 v144, v69, v68, vcc
    v_cndmask_b32 v145, v68, v69, vcc
    v_add3_u32 v144, s53, v144, -1
    v_add3_u32 v145, v67, v145, -1
    v_cvt_f32_i32 v100, v144
    v_cvt_f32_i32 v102, v145
    v_add_f32 v101, 1.0, v100
    v_add_f32 v103, 0x41c00000, v102
    s_mov_b32 s40, 0x435f0000
    v_med3_f32 v144, v100, 0, s40
    v_med3_f32 v145, v101, 0, s40
    v_med3_f32 v146, v102, 0, s40
    v_med3_f32 v147, v103, 0, s40
    v_cvt_pk_bf16_f32 v105, v145, v146
    v_cvt_pk_bf16_f32 v104, v144, v146
    v_cvt_pk_bf16_f32 v106, v144, v147
    v_cvt_pk_bf16_f32 v107, v145, v147
    v_mul_u32_u24 v168, 12, v67
    v_readfirstlane_b32 s41, v105
    v_add_lshl_u32 v168, v168, v66, 2
    v_lshlrev_b32 v110, 3, v0
    v_lshlrev_b32 v162, 2, v1
    v_mov_b32 v163, s41
    v_add_u32 v110, 156928, v110
    s_mov_b64 exec, 0
    s_cmp_eq_u32 s3, 0
    s_cbranch_scc1 L_pgY0
    s_cmp_eq_u32 s3, 1
    s_cbranch_scc1 L_pgY1
    s_cmp_eq_u32 s3, 2
    s_cbranch_scc1 L_pgY2
L_retY:
    s_mov_b64 exec, -1
    v_add_u32 v162, 148992, v162
    ds_write_b64 v110, v[162:163]
    s_mul_i32 s40, s57, 3072
    s_add_u32 s40, s40, 146688
    v_mad_u32_u24 v23, v2, 48, s40
    s_sub_u32 s61, 43200, s54
    s_cmp_lt_u32 s45, 14784
    s_cselect_b32 s37, 0, 0x80
    s_cmp_lt_u32 s80, 2
    s_cselect_b32 s40, 0, 0x800000
    s_or_b32 s37, s37, s40
    s_or_b32 s37, s37, 0x3e003e00
    s_mul_i32 s35, s46, 3456
    s_add_u32 s35, s35, 89088
    s_add_u32 s43, s53, s57
    s_mul_i32 s76, s43, s61
    s_cmp_lg_u32 s46, 0
    s_cbranch_scc1 L_mc
    s_mov_b32 s41, 0x7f000000
    s_cmp_lt_u32 s53, 34
    s_cselect_b32 s39, 768, s41
    s_cselect_b32 s33, 6, 4
    s_subb_u32 s32, s53, 1
    s_movk_i32 s34, 9600
    s_movk_i32 s36, 50
    s_mov_b32 s38, 0x770000
    s_lshl_b32 s40, s54, 4
    s_add_u32 s75, s76, s40
    s_add_u32 s74, s75, s40
    s_add_u32 s65, s32, s3
    s_min_u32 s65, s65, 223
    s_mul_i32 s65, s65, s61
    s_add_u32 s67, s65, s40
    s_add_u32 s69, s67, s40
    s_mul_i32 s64, s3, s34
    s_add_u32 s64, s64, s35
    s_add_u32 s66, s64, 3072
    s_add_u32 s68, s64, 6144
    s_sub_u32 s43, s43, s32
    s_mul_i32 s43, s43, s34
    s_add_u32 s77, s43, 0x80015c00
    s_add_u32 s78, s77, 0x400000
    s_add_u32 s79, s77, 0x800000
    s_branch L_mc_back
L_mc:
    s_mov_b32 s39, 0x7f000000
    s_sub_u32 s33, 10, s46
    s_add_u32 s32, s53, s46
    s_sub_u32 s32, s32, 6
    s_max_i32 s32, s32, 0
    s_movk_i32 s34, 3456
    s_movk_i32 s36, 18
    s_mul_i32 s64, s3, 3456
    s_add_u32 s64, s64, 89088
    s_add_u32 s66, s64, 13824
    s_add_u32 s68, s64, 27648
    s_min_u32 s68, s68, 123648
    s_mul_i32 s40, s80, 3072
    s_add_u32 s40, s40, 9599808
    s_add_u32 s69, s3, 8
    s_mul_i32 s65, s69, s61
    s_add_u32 s65, s65, s44
    s_min_u32 s65, s65, s40
    s_add_u32 s41, s44, 516096
    s_min_u32 s41, s41, s40
    s_sub_u32 s40, s69, s46
    s_add_u32 s69, s40, s32
    s_mul_i32 s69, s69, s61
    s_sub_u32 s67, s69, 172032
    s_cmp_lt_u32 s40, 4
    s_cselect_b32 s67, s41, s67
    s_mul_i32 s40, s57, 43008
    s_add_u32 s40, s44, s40
    s_add_u32 s74, s40, 301248
    s_add_u32 s75, s40, 387264
    s_add_u32 s40, s40, 473280
    s_mul_i32 s79, s57, 3456
    s_add_u32 s79, s79, 0x80054e80
    s_add_u32 s78, s79, 6912
    s_add_u32 s41, s79, 13824
    s_sub_u32 s77, s43, s32
    s_mul_i32 s77, s77, 3456
    s_add_u32 s77, s77, s35
    s_cmp_eq_u32 s43, 0
    s_cselect_b32 s43, 0, 0x80000000
    s_or_b32 s77, s77, s43
    s_sub_u32 s38, 21, s46
    s_lshl_b32 s38, s38, 16
    s_sub_u32 s43, s46, s57
    s_cmp_eq_u32 s43, 5
    s_cselect_b32 s76, s40, s76
    s_cselect_b32 s77, s41, s77
L_mc_back:
    v_mov_b32 v84, s79
    s_mov_b32 exec_hi, 0
    v_mov_b32 v84, s78
    s_mov_b32 exec_lo, 0xffff
    v_mov_b32 v84, s77
    s_mov_b64 exec, -1
    v_bfe_u32 v155, v84, 18, 6
    v_and_b32 v148, 0x3ffff, v84
    v_ashrrev_i32 v147, 31, v84
    v_add_lshl_u32 v155, v155, v2, 3
    v_add_u32 v149, s34, v148
    v_mad_i32_i24 v147, v147, s34, v148
    v_add_u32 v154, -8, v155
    v_add_u32 v156, 8, v155
    v_max_i32 v154, 0, v154
    v_and_b32 v144, 32, v154
    v_mad_u32_u24 v144, v154, 24, v144
    v_and_b32 v145, 32, v155
    v_mad_u32_u24 v145, v155, 24, v145
    v_and_b32 v146, 32, v156
    v_mad_u32_u24 v146, v156, 24, v146
    s_cmp_eq_u32 s47, 0
    s_cbranch_scc1 L_notr
    v_swap_b32 v144, v147
    v_swap_b32 v145, v148
    v_swap_b32 v146, v149
L_notr:
    v_add_u32 v88, v147, v144
    v_add_u32 v89, v147, v145
    v_add_u32 v90, v147, v146
    v_add_u32 v91, v148, v144
    v_add_u32 v92, v148, v145
    v_add_u32 v93, v148, v146
    v_add_u32 v94, v149, v144
    v_add_u32 v95, v149, v145
    v_add_u32 v96, v149, v146
    v_mad_u32_u24 v144, v4, 48, v23
    ds_write_b128 v144, v[88:91]
    ds_write_b128 v144, v[92:95] offset:16
    s_add_u32 m0, s25, 6912
    s_add_u32 s31, s44, 86016
    buffer_load_dwordx4 v8, s[8:11], s31 offen  lds
    ds_write_b32 v144, v96 offset:32
    v_lshrrev_b32 v3, 4, v1
    s_movk_i32 s42, 192
    v_mov_b32 v34, 158976
    v_mov_b32 v147, 0
    ds_write_b32 v34, v147
    v_bfe_u32 v144, v1, 2, 2
    s_add_u32 m0, s25, 17280
    s_add_u32 s31, s44, 215040
    buffer_load_dwordx4 v8, s[8:11], s31 offen  lds
    v_lshl_add_u32 v144, v3, 3, v144
    v_lshrrev_b32 v145, 2, v1
    v_mul_u32_u24 v144, 192, v144
    v_bfi_b32 v145, 3, v1, v145
    s_lshl_b32 s40, s2, 5
    v_and_b32 v145, 7, v145
    v_lshl_add_u32 v144, v145, 3, v144
    s_mul_i32 s31, s57, 3456
    s_add_u32 s31, s31, s24
    s_add_u32 m0, s31, 127488
    s_add_u32 s31, s28, 55296
    buffer_load_dwordx4 v5, s[16:19], s31 offen lds
    v_xad_u32 v15, v144, s40, 64
    v_lshl_add_u32 v13, s2, 7, v144
    s_mul_i32 s40, s57, 10368
    v_xor_b32 v14, 32, v13
    s_add_u32 s40, s40, 61440
    s_cmp_eq_u32 s80, 10
    s_cselect_b32 s41, 16, 17
    buffer_load_dwordx4 v6, s[16:19], s31 offen offset:1024 lds
    v_add_u32 v144, 2, v2
    v_add_u32 v147, s40, v4
    v_min_u32 v144, s41, v144
    v_lshl_add_u32 v144, v144, 3, 0
    v_bitop3_b32 v145, v144, 32, v147 bitop3:0x6a
    v_mad_u32_u24 v18, v144, 24, v145
    v_lshl_add_u32 v144, v2, 3, 8
    buffer_load_dwordx4 v7, s[16:19], s31 offen offset:2048 lds
    v_bitop3_b32 v145, v144, 32, v147 bitop3:0x6a
    v_mad_u32_u24 v17, v144, 24, v145
    v_lshl_add_u32 v144, v2, 3, 0
    v_bitop3_b32 v145, v144, 32, v147 bitop3:0x6a
    v_mad_u32_u24 v16, v144, 24, v145
    v_mul_u32_u24 v144, 5462, v1
    s_sub_u32 s40, s54, 192
    s_waitcnt vmcnt(16)
    s_barrier
    s_add_u32 m0, s25, 20736
    s_add_u32 s31, s44, 258048
    buffer_load_dwordx4 v8, s[8:11], s31 offen  lds
    ds_read_b64_tr_b16 a[0:1], v13 offset:24576
    ds_read_b64_tr_b16 a[2:3], v13 offset:25344
    ds_read_b64_tr_b16 a[4:5], v14 offset:24576
    ds_read_b64_tr_b16 a[6:7], v14 offset:25344
    ds_read_b64_tr_b16 a[8:9], v15 offset:24576
    ds_read_b64_tr_b16 a[10:11], v15 offset:25344
    ds_read_b64_tr_b16 a[12:13], v13 offset:30720
    v_lshrrev_b32 v145, 13, v144
    v_bitop3_b32 v145, v145, 32, v5 bitop3:0x6a
    v_mad_u32_u16 v9, v144, s40, v145 op_sel:[1,0,0,0]
    v_add_u32 v146, 349568, v144
    v_lshrrev_b32 v145, 13, v146
    v_bitop3_b32 v145, v145, 32, v5 bitop3:0x6a
    v_mad_u32_u16 v10, v146, s40, v145 op_sel:[1,0,0,0]
    s_add_u32 m0, s25, 24192
    s_add_u32 s31, s44, 301056
    buffer_load_dwordx4 v8, s[8:11], s31 offen  lds
    ds_read_b64_tr_b16 a[14:15], v13 offset:31488
    v_add_u32 v146, 699136, v144
    ds_read_b64_tr_b16 a[16:17], v14 offset:30720
    ds_read_b64_tr_b16 a[18:19], v14 offset:31488
    ds_read_b64_tr_b16 a[20:21], v15 offset:30720
    ds_read_b64_tr_b16 a[22:23], v15 offset:31488
    v_lshrrev_b32 v145, 13, v146
    v_bitop3_b32 v145, v145, 32, v5 bitop3:0x6a
    v_mad_u32_u16 v11, v146, s40, v145 op_sel:[1,0,0,0]
    v_add_u32 v146, 830224, v144
    v_lshrrev_b32 v145, 13, v146
    v_bitop3_b32 v145, v145, 32, v5 bitop3:0x6a
    s_add_u32 m0, s24, 49152
    s_add_u32 s31, s28, 61440
    buffer_load_dwordx4 v5, s[16:19], s31 offen lds
    v_mad_u32_u16 v12, v146, s40, v145 op_sel:[1,0,0,0]
    s_cmp_eq_u32 s46, 0
    s_cselect_b64 vcc, -1, 0
    v_cndmask_b32 v50, v12, v9, vcc
    v_add_u32 v61, 127488, v13
    v_add_u32 v62, 127488, v14
    v_add_u32 v63, 127488, v15
    buffer_load_dwordx4 v6, s[16:19], s31 offen offset:1024 lds
    v_add_u32 v174, 150912, v168
    v_add_u32 v172, 147840, v168
    v_add_u32 v170, 149760, v168
    v_add_u32 v168, 146688, v168
    v_subrev_u32 v108, 36, v1
    v_lshrrev_b32 v108, 31, v108
    v_lshlrev_b32 v111, 4, v0
    buffer_load_dwordx4 v7, s[16:19], s31 offen offset:2048 lds
    v_add_u32 v111, 152832, v111
    v_mul_u32_u24 v41, 192, v2
    v_lshlrev_b32 v40, 2, v2
    v_add_u32 v41, s24, v41
    v_and_or_b32 v109, v40, 48, v41
    v_and_or_b32 v40, v40, 56, v41
    v_mul_u32_u24 v42, 768, v4
    v_xor_b32 v28, v40, v4
    v_add_u32 v109, v109, v42
    v_xor_b32 v29, 8, v28
    s_waitcnt lgkmcnt(0)
    s_waitcnt vmcnt(14)
    s_barrier
    ds_read_b128 v[112:115], v16 offset:0
    ds_read_b128 v[116:119], v16 offset:3456
    ds_read_b128 v[120:123], v16 offset:64
    ds_read_b128 v[124:127], v16 offset:3520
    s_waitcnt lgkmcnt(3)
    v_mfma_f32_16x16x32_bf16 v[64:67], a[0:3], v[112:115], 0
    s_add_u32 m0, s24, 0
    ds_read_b64_tr_b16 a[24:25], v13 offset:36864
    s_add_u32 s31, s28, 67584
    ds_read_b64_tr_b16 a[26:27], v13 offset:37632
    v_mfma_f32_16x16x32_bf16 v[68:71], a[4:7], v[112:115], 0
    s_mul_i32 s56, s46, 36
    ds_read_b64_tr_b16 a[28:29], v14 offset:36864
    buffer_load_dwordx4 v5, s[16:19], s31 offen lds
    v_mfma_f32_16x16x32_bf16 v[72:75], a[8:11], v[112:115], 0
    s_waitcnt lgkmcnt(5)
    ds_read_b64_tr_b16 a[30:31], v14 offset:37632
    s_movk_i32 s5, 7488
    ds_read_b64_tr_b16 a[32:33], v15 offset:36864
    v_mfma_f32_16x16x32_bf16 v[76:79], a[0:3], v[116:119], 0
    s_addk_i32 s56, 215
    ds_read_b64_tr_b16 a[34:35], v15 offset:37632
    v_mul_u32_u24 v30, 1821, v0
    v_mfma_f32_16x16x32_bf16 v[80:83], a[4:7], v[116:119], 0
    s_mul_i32 s55, s45, 36
    ds_read_b128 v[128:131], v16 offset:128
    v_lshlrev_b32 v31, 4, v0
    v_mfma_f32_16x16x32_bf16 v[84:87], a[8:11], v[116:119], 0
    s_waitcnt vmcnt(11) lgkmcnt(7)
    ds_read_b64_tr_b16 a[36:37], v13 offset:43008
    buffer_load_dwordx4 v6, s[16:19], s31 offen offset:1024 lds
    v_mfma_f32_16x16x32_bf16 v[64:67], a[12:15], v[120:123], v[64:67]
    s_lshl_b32 s6, s3, 5
    ds_read_b64_tr_b16 a[38:39], v13 offset:43776
    v_perm_b32 v144, v176, v176, s58
    v_mfma_f32_16x16x32_bf16 v[68:71], a[16:19], v[120:123], v[68:71]
    s_add_u32 s6, s6, 9808
    ds_read_b64_tr_b16 a[40:41], v14 offset:43008
    v_perm_b32 v145, v176, v176, s59
    v_mfma_f32_16x16x32_bf16 v[72:75], a[20:23], v[120:123], v[72:75]
    s_add_u32 s33, s33, s32
    ds_read_b128 v[132:135], v16 offset:3584
    v_perm_b32 v146, v177, v177, s58
    v_mfma_f32_16x16x32_bf16 v[76:79], a[12:15], v[124:127], v[76:79]
    s_mul_i32 s40, s32, s34
    ds_read_b64_tr_b16 a[42:43], v14 offset:43776
    buffer_load_dwordx4 v7, s[16:19], s31 offen offset:2048 lds
    v_mfma_f32_16x16x32_bf16 v[80:83], a[16:19], v[124:127], v[80:83]
    s_add_u32 m0, s24, 12288
    ds_read_b64_tr_b16 a[44:45], v15 offset:43008
    v_perm_b32 v147, v177, v177, s59
    v_mfma_f32_16x16x32_bf16 v[84:87], a[20:23], v[124:127], v[84:87]
    s_waitcnt lgkmcnt(5)
    ds_read_b64_tr_b16 a[46:47], v15 offset:43776
    v_perm_b32 v148, v178, v178, s58
    v_mfma_f32_16x16x32_bf16 v[64:67], a[24:27], v[128:131], v[64:67]
    s_add_u32 s31, s28, 73728
    ds_read_b128 v[136:139], v17 offset:0
    v_perm_b32 v149, v178, v178, s59
    v_mfma_f32_16x16x32_bf16 v[68:71], a[28:31], v[128:131], v[68:71]
    s_sub_u32 s35, s35, s40
    ds_read_b128 v[140:143], v17 offset:3456
    buffer_load_dwordx4 v5, s[16:19], s31 offen lds
    v_mfma_f32_16x16x32_bf16 v[72:75], a[32:35], v[128:131], v[72:75]
    s_waitcnt lgkmcnt(5)
    v_perm_b32 v150, v179, v179, s58
    v_perm_b32 v151, v179, v179, s59
    v_mfma_f32_16x16x32_bf16 v[76:79], a[24:27], v[132:135], v[76:79]
    s_lshl_b32 s4, s3, 10
    v_add_f32 v144, v100, v144
    v_add_f32 v145, v102, v145
    v_mfma_f32_16x16x32_bf16 v[80:83], a[28:31], v[132:135], v[80:83]
    s_add_u32 s4, s4, 152832
    v_add_f32 v146, v101, v146
    v_add_f32 v147, v102, v147
    v_mfma_f32_16x16x32_bf16 v[84:87], a[32:35], v[132:135], v[84:87]
    s_waitcnt vmcnt(9) lgkmcnt(1)
    s_barrier
    v_mfma_f32_16x16x32_bf16 v[64:67], a[36:39], v[136:139], v[64:67]
    s_mul_i32 s72, s2, 9600
    ds_read_b128 v[112:115], v16 offset:6912
    buffer_load_dwordx4 v6, s[16:19], s31 offen offset:1024 lds
    v_mfma_f32_16x16x32_bf16 v[68:71], a[40:43], v[136:139], v[68:71]
    s_add_u32 s72, s72, 127488
    ds_read_b64_tr_b16 a[108:109], v61 offset:0
    s_mul_i32 s77, s57, 1536
    ds_read_b64_tr_b16 a[110:111], v61 offset:768
    v_mfma_f32_16x16x32_bf16 v[72:75], a[44:47], v[136:139], v[72:75]
    s_waitcnt lgkmcnt(3)
    ds_read_b64_tr_b16 a[112:113], v62 offset:0
    s_lshl1_add_u32 s70, s77, s72
    ds_read_b128 v[116:119], v16 offset:6976
    v_mfma_f32_16x16x32_bf16 v[76:79], a[36:39], v[140:143], v[76:79]
    s_add_u32 s77, s77, s72
    ds_read_b64_tr_b16 a[114:115], v62 offset:768
    s_addk_i32 s77, 4608
    ds_read_b64_tr_b16 a[116:117], v63 offset:0
    v_mfma_f32_16x16x32_bf16 v[80:83], a[40:43], v[140:143], v[80:83]
    s_add_u32 s73, s32, s2
    ds_read_b64_tr_b16 a[118:119], v63 offset:768
    buffer_load_dwordx4 v7, s[16:19], s31 offen offset:2048 lds
    v_mfma_f32_16x16x32_bf16 v[84:87], a[44:47], v[140:143], v[84:87]
    s_waitcnt lgkmcnt(7)
    ds_read_b128 v[120:123], v16 offset:7040
    v_add_f32 v148, v100, v148
    v_mfma_f32_16x16x32_bf16 v[88:91], a[0:3], v[112:115], 0
    s_add_u32 m0, s24, 24576
    ds_read_b64_tr_b16 a[216:217], v61 offset:9600
    v_add_f32 v149, v103, v149
    v_mfma_f32_16x16x32_bf16 v[92:95], a[4:7], v[112:115], 0
    s_add_u32 s31, s28, 24576
    ds_read_b64_tr_b16 a[218:219], v61 offset:10368
    v_add_f32 v150, v101, v150
    v_mfma_f32_16x16x32_bf16 v[96:99], a[8:11], v[112:115], 0
L_pgY0:
  s_cbranch_execz L_retY
    s_waitcnt lgkmcnt(6)
    ds_read_b64_tr_b16 a[220:221], v62 offset:9600
    buffer_load_dwordx4 v5, s[16:19], s31 offen lds
    v_mfma_f32_16x16x32_bf16 v[88:91], a[12:15], v[116:119], v[88:91]
    s_mulk_i32 s73, 192
    ds_read_b128 v[124:127], v17 offset:6912
    v_add_f32 v151, v103, v151
    v_mfma_f32_16x16x32_bf16 v[92:95], a[16:19], v[116:119], v[92:95]
    s_add_u32 s73, s73, s39
    ds_read_b64_tr_b16 a[222:223], v62 offset:10368
    v_cvt_pk_bf16_f32 v169, v144, v145
    v_mfma_f32_16x16x32_bf16 v[96:99], a[20:23], v[116:119], v[96:99]
    s_waitcnt lgkmcnt(5)
    ds_read_b64_tr_b16 a[224:225], v63 offset:9600
    v_cvt_pk_bf16_f32 v171, v146, v147
    v_mfma_f32_16x16x32_bf16 v[88:91], a[24:27], v[120:123], v[88:91]
    s_mul_i32 s78, s57, 344064
    ds_read_b64_tr_b16 a[226:227], v63 offset:10368
    buffer_load_dwordx4 v6, s[16:19], s31 offen offset:1024 lds
    v_mfma_f32_16x16x32_bf16 v[92:95], a[28:31], v[120:123], v[92:95]
    s_lshl1_add_u32 s71, s78, s73
    ds_read_b128 v[128:131], v16 offset:3456
    v_cvt_pk_bf16_f32 v173, v148, v149
    v_mfma_f32_16x16x32_bf16 v[96:99], a[32:35], v[120:123], v[96:99]
    s_waitcnt lgkmcnt(4)
    ds_read_b128 v[132:135], v16 offset:6912
    v_cvt_pk_bf16_f32 v175, v150, v151
    v_mfma_f32_16x16x32_bf16 v[88:91], a[36:39], v[124:127], v[88:91]
    s_add_u32 s78, s78, s73
    v_pk_max_i16 v169, v169, 0
    v_pk_max_i16 v171, v171, 0
    v_mfma_f32_16x16x32_bf16 v[92:95], a[40:43], v[124:127], v[92:95]
    buffer_load_dwordx4 v7, s[16:19], s31 offen offset:2048 lds
    v_mfma_f32_16x16x32_bf16 v[96:99], a[44:47], v[124:127], v[96:99]
    s_waitcnt vmcnt(6) lgkmcnt(1)
    s_barrier
    v_mfma_f32_16x16x32_bf16 v[64:67], a[108:111], v[128:131], v[64:67]
    s_add_u32 m0, s24, 36864
    ds_read_b128 v[136:139], v16 offset:10368
    v_pk_max_i16 v173, v173, 0
    v_mfma_f32_16x16x32_bf16 v[68:71], a[112:115], v[128:131], v[68:71]
    s_add_u32 s31, s26, 135168
    ds_read_b64_tr_b16 a[120:121], v13 offset:49152
    v_pk_max_i16 v175, v175, 0
    v_mfma_f32_16x16x32_bf16 v[72:75], a[116:119], v[128:131], v[72:75]
    s_waitcnt lgkmcnt(2)
    ds_read_b64_tr_b16 a[122:123], v13 offset:49920
    buffer_load_dwordx4 v5, s[16:19], s31 offen lds
    v_mfma_f32_16x16x32_bf16 v[76:79], a[108:111], v[132:135], v[76:79]
    s_add_u32 s73, s78, 1373824
    ds_read_b64_tr_b16 a[124:125], v14 offset:49152
    v_pk_min_i16 v169, v169, s60
    v_mfma_f32_16x16x32_bf16 v[80:83], a[112:115], v[132:135], v[80:83]
    s_add_u32 s78, s78, 1032192
    ds_read_b128 v[140:143], v16 offset:13824
    v_pk_min_i16 v171, v171, s60
    v_mfma_f32_16x16x32_bf16 v[84:87], a[116:119], v[132:135], v[84:87]
    s_waitcnt lgkmcnt(4)
    ds_read_b64_tr_b16 a[126:127], v14 offset:49920
    v_pk_min_i16 v173, v173, s60
    v_mfma_f32_16x16x32_bf16 v[88:91], a[108:111], v[136:139], v[88:91]
    s_sub_u32 s72, s77, 896
    ds_read_b64_tr_b16 a[128:129], v15 offset:49152
    buffer_load_dwordx4 v6, s[16:19], s31 offen offset:1024 lds
    v_mfma_f32_16x16x32_bf16 v[92:95], a[112:115], v[136:139], v[92:95]
    s_cmp_eq_u32 s46, 0
    s_cselect_b32 s72, s72, s64
    ds_read_b64_tr_b16 a[130:131], v15 offset:49920
    v_mfma_f32_16x16x32_bf16 v[96:99], a[116:119], v[136:139], v[96:99]
    s_cmp_eq_u32 s46, 0
    s_cselect_b32 s73, s73, s65
    ds_read_b128 v[112:115], v16 offset:3520
    v_mfma_f32_16x16x32_bf16 v[64:67], a[216:219], v[132:135], v[64:67]
    s_cmp_eq_u32 s46, 0
    s_cselect_b32 s77, s77, s66
    ds_read_b64_tr_b16 a[228:229], v13 offset:55296
    v_mfma_f32_16x16x32_bf16 v[68:71], a[220:223], v[132:135], v[68:71]
    ds_read_b64_tr_b16 a[230:231], v13 offset:56064
    buffer_load_dwordx4 v7, s[16:19], s31 offen offset:2048 lds
    v_mfma_f32_16x16x32_bf16 v[72:75], a[224:227], v[132:135], v[72:75]
    s_mul_i32 s31, s57, 3456
    ds_read_b64_tr_b16 a[232:233], v14 offset:55296
    v_pk_min_i16 v175, v175, s60
    v_mfma_f32_16x16x32_bf16 v[76:79], a[216:219], v[136:139], v[76:79]
    s_add_u32 s31, s31, s24
    ds_read_b128 v[116:119], v16 offset:6976
    v_cmp_ne_u16_e64 s[80:81], v169, v104
    v_mfma_f32_16x16x32_bf16 v[80:83], a[220:223], v[136:139], v[80:83]
    ds_read_b64_tr_b16 a[234:235], v14 offset:56064
    v_cmp_ne_u16_sdwa s[88:89], v169, v104 src0_sel:WORD_1 src1_sel:WORD_1
    v_mfma_f32_16x16x32_bf16 v[84:87], a[224:227], v[136:139], v[84:87]
    s_waitcnt lgkmcnt(5)
    ds_read_b64_tr_b16 a[236:237], v15 offset:55296
    v_cmp_ne_u16_e64 s[82:83], v171, v105
    v_mfma_f32_16x16x32_bf16 v[88:91], a[216:219], v[140:143], v[88:91]
    ds_read_b64_tr_b16 a[238:239], v15 offset:56064
    v_cmp_ne_u16_sdwa s[90:91], v171, v105 src0_sel:WORD_1 src1_sel:WORD_1
    v_mfma_f32_16x16x32_bf16 v[92:95], a[220:223], v[140:143], v[92:95]
    ds_read_b128 v[120:123], v16 offset:10432
    v_cmp_ne_u16_e64 s[84:85], v173, v106
    v_mfma_f32_16x16x32_bf16 v[96:99], a[224:227], v[140:143], v[96:99]
    ds_read_b64_tr_b16 a[132:133], v13 offset:0
    v_cmp_ne_u16_sdwa s[92:93], v173, v106 src0_sel:WORD_1 src1_sel:WORD_1
    v_mfma_f32_16x16x32_bf16 v[64:67], a[120:123], v[112:115], v[64:67]
    ds_read_b64_tr_b16 a[134:135], v13 offset:768
    v_cmp_ne_u16_e64 s[86:87], v175, v107
    v_mfma_f32_16x16x32_bf16 v[68:71], a[124:127], v[112:115], v[68:71]
    ds_read_b64_tr_b16 a[136:137], v14 offset:0
    v_cmp_ne_u16_sdwa s[94:95], v175, v107 src0_sel:WORD_1 src1_sel:WORD_1
    v_mfma_f32_16x16x32_bf16 v[72:75], a[128:131], v[112:115], v[72:75]
    s_waitcnt lgkmcnt(5)
    ds_read_b64_tr_b16 a[138:139], v14 offset:768
    v_mad_u32_u16 v30, v30, s5, v31 op_sel:[1,0,0,0]
    v_mfma_f32_16x16x32_bf16 v[76:79], a[120:123], v[116:119], v[76:79]
    s_add_u32 m0, s31, 127488
    ds_read_b64_tr_b16 a[140:141], v15 offset:0
    v_sub_u32 v32, s56, v0
    v_mfma_f32_16x16x32_bf16 v[80:83], a[124:127], v[116:119], v[80:83]
    s_add_u32 s31, s28, 86016
    ds_read_b64_tr_b16 a[142:143], v15 offset:768
    v_add_u32 v31, -252, v32
    v_mfma_f32_16x16x32_bf16 v[84:87], a[128:131], v[116:119], v[84:87]
    s_waitcnt lgkmcnt(5)
    ds_read_b64_tr_b16 a[240:241], v13 offset:6144
    buffer_load_dwordx4 v5, s[16:19], s31 offen lds
    v_mfma_f32_16x16x32_bf16 v[88:91], a[120:123], v[120:123], v[88:91]
    s_xor_b64 s[80:81], s[80:81], s[88:89]
    ds_read_b64_tr_b16 a[242:243], v13 offset:6912
    v_mbcnt_lo_u32_b32 v144, s80, 0
    v_mfma_f32_16x16x32_bf16 v[92:95], a[124:127], v[120:123], v[92:95]
    s_andn2_b64 s[88:89], s[88:89], s[80:81]
    ds_read_b64_tr_b16 a[244:245], v14 offset:6144
    v_mbcnt_lo_u32_b32 v148, s88, 0
    v_mfma_f32_16x16x32_bf16 v[96:99], a[128:131], v[120:123], v[96:99]
    s_xor_b64 s[82:83], s[82:83], s[90:91]
    ds_read_b128 v[124:127], v16 offset:13888
    v_mbcnt_hi_u32_b32 v148, s89, v148
    v_mfma_f32_16x16x32_bf16 v[64:67], a[228:231], v[116:119], v[64:67]
    s_andn2_b64 s[90:91], s[90:91], s[82:83]
    ds_read_b64_tr_b16 a[246:247], v14 offset:6912
    buffer_load_dwordx4 v6, s[16:19], s31 offen offset:1024 lds
    v_mfma_f32_16x16x32_bf16 v[68:71], a[232:235], v[116:119], v[68:71]
    s_xor_b64 s[84:85], s[84:85], s[92:93]
    ds_read_b64_tr_b16 a[248:249], v15 offset:6144
    v_mbcnt_lo_u32_b32 v149, s90, 0
    v_mfma_f32_16x16x32_bf16 v[72:75], a[236:239], v[116:119], v[72:75]
    s_andn2_b64 s[92:93], s[92:93], s[84:85]
    ds_read_b64_tr_b16 a[250:251], v15 offset:6912
    v_mbcnt_lo_u32_b32 v150, s92, 0
    v_mfma_f32_16x16x32_bf16 v[76:79], a[228:231], v[120:123], v[76:79]
    s_xor_b64 s[86:87], s[86:87], s[94:95]
    ds_read_b128 v[128:131], v16 offset:3584
    v_mbcnt_hi_u32_b32 v149, s91, v149
    v_mfma_f32_16x16x32_bf16 v[80:83], a[232:235], v[120:123], v[80:83]
    s_andn2_b64 s[94:95], s[94:95], s[86:87]
    ds_read_b128 v[132:135], v16 offset:7040
    buffer_load_dwordx4 v7, s[16:19], s31 offen offset:2048 lds
    v_mfma_f32_16x16x32_bf16 v[84:87], a[236:239], v[120:123], v[84:87]
    s_waitcnt lgkmcnt(5)
    ds_read_b128 v[136:139], v16 offset:10496
    v_mbcnt_lo_u32_b32 v151, s94, 0
    v_mfma_f32_16x16x32_bf16 v[88:91], a[228:231], v[124:127], v[88:91]
    s_add_u32 m0, s24, 49152
    v_mbcnt_hi_u32_b32 v150, s93, v150
    v_mbcnt_hi_u32_b32 v151, s95, v151
    v_mfma_f32_16x16x32_bf16 v[92:95], a[232:235], v[124:127], v[92:95]
    s_add_u32 s31, s28, 36864
    s_bcnt1_i32_b64 s48, s[88:89]
    v_mad_i32_i24 v148, 32, v108, v148
    v_mfma_f32_16x16x32_bf16 v[96:99], a[236:239], v[124:127], v[96:99]
    s_waitcnt vmcnt(9) lgkmcnt(2)
    s_barrier
    v_mfma_f32_16x16x32_bf16 v[64:67], a[132:135], v[128:131], v[64:67]
    s_bcnt1_i32_b64 s49, s[90:91]
    ds_read_b64_tr_b16 a[144:145], v13 offset:12288
    buffer_load_dwordx4 v5, s[16:19], s31 offen lds
    v_mfma_f32_16x16x32_bf16 v[68:71], a[136:139], v[128:131], v[68:71]
    s_bcnt1_i32_b64 s50, s[92:93]
    ds_read_b64_tr_b16 a[146:147], v13 offset:13056
    v_mbcnt_lo_u32_b32 v145, s82, 0
    v_mfma_f32_16x16x32_bf16 v[72:75], a[140:143], v[128:131], v[72:75]
    s_waitcnt lgkmcnt(2)
    ds_read_b64_tr_b16 a[148:149], v14 offset:12288
    s_bcnt1_i32_b64 s51, s[94:95]
    v_mfma_f32_16x16x32_bf16 v[76:79], a[132:135], v[132:135], v[76:79]
    s_lshr_b32 s52, s89, 4
    ds_read_b64_tr_b16 a[150:151], v14 offset:13056
    v_mbcnt_lo_u32_b32 v146, s84, 0
    v_mfma_f32_16x16x32_bf16 v[80:83], a[136:139], v[132:135], v[80:83]
    s_lshr_b32 s61, s91, 4
    ds_read_b64_tr_b16 a[152:153], v15 offset:12288
    buffer_load_dwordx4 v6, s[16:19], s31 offen offset:1024 lds
    v_mfma_f32_16x16x32_bf16 v[84:87], a[140:143], v[132:135], v[84:87]
    s_bcnt1_i32_b32 s52, s52
    ds_read_b64_tr_b16 a[154:155], v15 offset:13056
    v_mbcnt_lo_u32_b32 v147, s86, 0
    v_mfma_f32_16x16x32_bf16 v[88:91], a[132:135], v[136:139], v[88:91]
    s_bcnt1_i32_b32 s61, s61
    ds_read_b64_tr_b16 a[252:253], v13 offset:18432
    v_mbcnt_hi_u32_b32 v144, s81, v144
    v_mfma_f32_16x16x32_bf16 v[92:95], a[136:139], v[136:139], v[92:95]
    s_add_u32 s51, s51, s50
    ds_read_b64_tr_b16 a[254:255], v13 offset:19200
    v_mbcnt_hi_u32_b32 v145, s83, v145
    v_mfma_f32_16x16x32_bf16 v[96:99], a[140:143], v[136:139], v[96:99]
    s_add_u32 s43, s48, s49
    ds_read_b64_tr_b16 v[188:189], v14 offset:18432
    buffer_load_dwordx4 v7, s[16:19], s31 offen offset:2048 lds
    v_mfma_f32_16x16x32_bf16 v[64:67], a[240:243], v[132:135], v[64:67]
    s_add_u32 m0, s24, 0
    ds_read_b128 v[140:143], v16 offset:13952
    v_mbcnt_hi_u32_b32 v146, s85, v146
    v_mfma_f32_16x16x32_bf16 v[68:71], a[244:247], v[132:135], v[68:71]
    s_add_u32 s31, s26, 147456
    ds_read_b64_tr_b16 v[190:191], v14 offset:19200
    s_add_u32 s43, s43, s51
    v_mfma_f32_16x16x32_bf16 v[72:75], a[248:251], v[132:135], v[72:75]
    s_add_u32 s51, s51, s52
    ds_read_b64_tr_b16 v[192:193], v15 offset:18432
    v_mbcnt_hi_u32_b32 v147, s87, v147
    v_mfma_f32_16x16x32_bf16 v[76:79], a[240:243], v[136:139], v[76:79]
    s_add_u32 s51, s51, s61
    ds_read_b64_tr_b16 v[194:195], v15 offset:19200
    buffer_load_dwordx4 v5, s[16:19], s31 offen lds
    v_mfma_f32_16x16x32_bf16 v[80:83], a[244:247], v[136:139], v[80:83]
    s_lshl_b32 s96, s51, 1
    ds_read_b128 v[112:115], v17 offset:3456
    s_lshl_b32 s43, s43, 1
    v_mfma_f32_16x16x32_bf16 v[84:87], a[248:251], v[136:139], v[84:87]
    s_waitcnt lgkmcnt(4)
    ds_read_b128 v[116:119], v17 offset:6912
    s_sub_u32 s40, 64, s43
    v_mfma_f32_16x16x32_bf16 v[88:91], a[240:243], v[140:143], v[88:91]
    s_add_u32 s41, s6, s52
    ds_read_b128 v[120:123], v17 offset:10368
    v_mad_i32_i24 v144, s40, v108, v144
    v_mfma_f32_16x16x32_bf16 v[92:95], a[244:247], v[140:143], v[92:95]
    buffer_load_dwordx4 v6, s[16:19], s31 offen offset:1024 lds
    v_mfma_f32_16x16x32_bf16 v[96:99], a[248:251], v[140:143], v[96:99]
    s_waitcnt vmcnt(11) lgkmcnt(2)
    s_barrier
    v_mfma_f32_16x16x32_bf16 v[64:67], a[144:147], v[112:115], v[64:67]
    s_sub_u32 s52, 32, s48
    ds_read_b64_tr_b16 a[48:49], v13 offset:24576
    v_mad_i32_i24 v149, s52, v108, v149
    v_mfma_f32_16x16x32_bf16 v[68:71], a[148:151], v[112:115], v[68:71]
    s_sub_u32 s48, s41, s48
    ds_read_b64_tr_b16 a[50:51], v13 offset:25344
    s_add_u32 s41, s41, s61
    v_mfma_f32_16x16x32_bf16 v[72:75], a[152:155], v[112:115], v[72:75]
    s_waitcnt lgkmcnt(3)
    ds_read_b64_tr_b16 a[52:53], v14 offset:24576
    buffer_load_dwordx4 v7, s[16:19], s31 offen offset:2048 lds
    v_mfma_f32_16x16x32_bf16 v[76:79], a[144:147], v[116:119], v[76:79]
    s_add_u32 m0, s24, 12288
    ds_read_b64_tr_b16 a[54:55], v14 offset:25344
    v_add_lshl_u32 v148, v148, s48, 4
    v_mfma_f32_16x16x32_bf16 v[80:83], a[148:151], v[116:119], v[80:83]
    s_add_u32 s31, s28, 98304
    ds_read_b64_tr_b16 a[56:57], v15 offset:24576
    s_sub_u32 s49, s41, s49
    v_mfma_f32_16x16x32_bf16 v[84:87], a[152:155], v[116:119], v[84:87]
    s_waitcnt lgkmcnt(5)
    ds_read_b64_tr_b16 a[58:59], v15 offset:25344
    s_add_u32 s50, s50, s41
    v_mfma_f32_16x16x32_bf16 v[88:91], a[144:147], v[120:123], v[88:91]
    s_bcnt1_i32_b64 s7, s[80:81]
    ds_read_b64_tr_b16 a[156:157], v13 offset:30720
    buffer_load_dwordx4 v5, s[16:19], s31 offen lds
    v_mfma_f32_16x16x32_bf16 v[92:95], a[148:151], v[120:123], v[92:95]
    s_bcnt1_i32_b64 s59, s[82:83]
    ds_read_b64_tr_b16 a[158:159], v13 offset:31488
    v_add_lshl_u32 v149, v149, s49, 4
    v_mfma_f32_16x16x32_bf16 v[96:99], a[152:155], v[120:123], v[96:99]
    s_bcnt1_i32_b64 s79, s[84:85]
    ds_read_b64_tr_b16 a[160:161], v14 offset:30720
    v_add_lshl_u32 v150, v150, s41, 4
    v_mfma_f32_16x16x32_bf16 v[64:67], a[252:255], v[116:119], v[64:67]
    s_bcnt1_i32_b64 s62, s[86:87]
    ds_read_b128 v[124:127], v17 offset:13824
    v_add_lshl_u32 v151, v151, s50, 4
    v_mfma_f32_16x16x32_bf16 v[68:71], v[188:191], v[116:119], v[68:71]
    s_lshr_b32 s29, s81, 4
    ds_read_b64_tr_b16 a[162:163], v14 offset:31488
    buffer_load_dwordx4 v6, s[16:19], s31 offen offset:1024 lds
    v_mfma_f32_16x16x32_bf16 v[72:75], v[192:195], v[116:119], v[72:75]
    s_lshr_b32 s30, s83, 4
    ds_read_b64_tr_b16 a[164:165], v15 offset:30720
    v_and_b32 v31, 2.0, v31
    v_mfma_f32_16x16x32_bf16 v[76:79], a[252:255], v[120:123], v[76:79]
    s_bcnt1_i32_b32 s29, s29
    ds_read_b64_tr_b16 a[166:167], v15 offset:31488
    v_lshrrev_b32 v40, 3, v1
    v_mfma_f32_16x16x32_bf16 v[80:83], v[188:191], v[120:123], v[80:83]
    s_bcnt1_i32_b32 s30, s30
    ds_read_b128 v[128:131], v17 offset:64
    v_lshl_add_u32 v40, v40, 4, s4
    v_mfma_f32_16x16x32_bf16 v[84:87], v[192:195], v[120:123], v[84:87]
    s_waitcnt lgkmcnt(4)
    ds_read_b128 v[132:135], v17 offset:3520
    buffer_load_dwordx4 v7, s[16:19], s31 offen offset:2048 lds
    v_mfma_f32_16x16x32_bf16 v[88:91], a[252:255], v[124:127], v[88:91]
    s_add_u32 m0, s24, 24576
    ds_read_b128 v[136:139], v17 offset:6976
    v_and_or_b32 v24, v1, 4, v40
    v_mfma_f32_16x16x32_bf16 v[92:95], v[188:191], v[124:127], v[92:95]
    s_add_u32 s31, s28, 49152
    v_lshl_add_u32 v25, v2, 4, s4
    v_lshrrev_b32 v41, 1, v1
    v_mfma_f32_16x16x32_bf16 v[96:99], v[192:195], v[124:127], v[96:99]
    s_waitcnt vmcnt(9) lgkmcnt(2)
    s_barrier
    v_mfma_f32_16x16x32_bf16 v[64:67], a[48:51], v[128:131], v[64:67]
    s_add_u32 s62, s62, s79
    ds_read_b64_tr_b16 v[196:197], v13 offset:36864
    buffer_load_dwordx4 v5, s[16:19], s31 offen lds
    v_mfma_f32_16x16x32_bf16 v[68:71], a[52:55], v[128:131], v[68:71]
    s_add_u32 s63, s7, s59
    ds_read_b64_tr_b16 v[198:199], v13 offset:37632
    s_add_u32 s63, s63, s62
    ds_read_b64_tr_b16 v[200:201], v14 offset:36864
    v_mfma_f32_16x16x32_bf16 v[72:75], a[56:59], v[128:131], v[72:75]
    s_waitcnt lgkmcnt(4)
    ds_read_b64_tr_b16 v[202:203], v14 offset:37632
    s_add_u32 s62, s62, s29
    v_mfma_f32_16x16x32_bf16 v[76:79], a[48:51], v[132:135], v[76:79]
    s_add_u32 s62, s62, s30
    ds_read_b128 v[140:143], v17 offset:10432
    s_lshl1_add_u32 s6, s6, s96
    v_mfma_f32_16x16x32_bf16 v[80:83], a[52:55], v[132:135], v[80:83]
    s_add_u32 s62, s62, s96
    ds_read_b64_tr_b16 v[204:205], v15 offset:36864
    buffer_load_dwordx4 v6, s[16:19], s31 offen offset:1024 lds
    v_mfma_f32_16x16x32_bf16 v[84:87], a[56:59], v[132:135], v[84:87]
    s_waitcnt lgkmcnt(6)
    ds_read_b64_tr_b16 v[206:207], v15 offset:37632
    s_add_u32 s6, s6, s29
    v_mfma_f32_16x16x32_bf16 v[88:91], a[48:51], v[136:139], v[88:91]
    s_sub_u32 s29, s40, s7
    ds_read_b64_tr_b16 a[60:61], v13 offset:43008
    v_mad_i32_i24 v145, s29, v108, v145
    v_mfma_f32_16x16x32_bf16 v[92:95], a[52:55], v[136:139], v[92:95]
    s_sub_u32 s7, s6, s7
    ds_read_b64_tr_b16 a[62:63], v13 offset:43776
    s_add_u32 s6, s6, s30
    v_mfma_f32_16x16x32_bf16 v[96:99], a[56:59], v[136:139], v[96:99]
    s_sub_u32 s59, s6, s59
    ds_read_b64_tr_b16 a[64:65], v14 offset:43008
    buffer_load_dwordx4 v7, s[16:19], s31 offen offset:2048 lds
    v_mfma_f32_16x16x32_bf16 v[64:67], a[156:159], v[132:135], v[64:67]
    s_mov_b32 m0, s64
    ds_read_b64_tr_b16 a[66:67], v14 offset:43776
    s_add_u32 s79, s79, s6
    v_mfma_f32_16x16x32_bf16 v[68:71], a[160:163], v[132:135], v[68:71]
    s_sub_u32 s97, s43, s96
    ds_read_b64_tr_b16 a[68:69], v15 offset:43008
    v_add_lshl_u32 v144, v144, s7, 3
    v_mfma_f32_16x16x32_bf16 v[72:75], a[164:167], v[132:135], v[72:75]
    s_sub_u32 s43, 64, s97
    ds_read_b64_tr_b16 a[70:71], v15 offset:43776
    v_add_lshl_u32 v145, v145, s59, 3
    v_mfma_f32_16x16x32_bf16 v[76:79], a[156:159], v[136:139], v[76:79]
    s_bfm_b64 s[98:99], s96, 0
    ds_read_b128 v[112:115], v17 offset:13888
    buffer_load_dwordx4 v9, s[8:11], s65 offen  lds
    v_mfma_f32_16x16x32_bf16 v[80:83], a[160:163], v[136:139], v[80:83]
    s_bfm_b64 vcc, s97, s43
    ds_read_b64_tr_b16 a[168:169], v61 offset:0
    v_add_lshl_u32 v146, v146, s6, 3
    v_mfma_f32_16x16x32_bf16 v[84:87], a[164:167], v[136:139], v[84:87]
    s_waitcnt lgkmcnt(5)
    ds_read_b64_tr_b16 a[170:171], v61 offset:768
    v_add_lshl_u32 v147, v147, s79, 3
    v_mfma_f32_16x16x32_bf16 v[88:91], a[156:159], v[140:143], v[88:91]
    s_or_b64 s[98:99], s[98:99], vcc
    ds_read_b64_tr_b16 a[172:173], v62 offset:0
    v_and_or_b32 v41, v41, 8, 32
    v_mfma_f32_16x16x32_bf16 v[92:95], a[160:163], v[140:143], v[92:95]
    s_mov_b32 s5, 56448
    ds_read_b128 v[116:119], v17 offset:128
    buffer_load_dwordx4 v10, s[8:11], s65 offen offset:1024  lds
    v_mfma_f32_16x16x32_bf16 v[96:99], a[164:167], v[140:143], v[96:99]
    s_cmp_gt_u32 s62, 32
    s_cselect_b32 s63, 65, s63
    ds_read_b64_tr_b16 a[174:175], v62 offset:768
    v_mfma_f32_16x16x32_bf16 v[64:67], v[196:199], v[136:139], v[64:67]
    s_cmp_ge_i32 s63, s40
    s_cbranch_scc1 L_bfail1
L_bfail1_back:
    v_mfma_f32_16x16x32_bf16 v[68:71], v[200:203], v[136:139], v[68:71]
    s_mov_b32 s96, 0x7fff7fff
    ds_read_b64_tr_b16 a[176:177], v63 offset:0
    v_cndmask_b32 v144, v111, v144, s[80:81]
    v_mfma_f32_16x16x32_bf16 v[72:75], v[204:207], v[136:139], v[72:75]
    s_lshl_b32 s4, s57, 10
    ds_read_b64_tr_b16 a[178:179], v63 offset:768
    buffer_load_dwordx4 v11, s[8:11], s65 offen offset:2048  lds
    v_mfma_f32_16x16x32_bf16 v[76:79], v[196:199], v[140:143], v[76:79]
    s_mov_b32 m0, s66
    ds_read_b128 v[120:123], v17 offset:3584
    v_cndmask_b32 v144, v144, v148, s[88:89]
    v_mfma_f32_16x16x32_bf16 v[80:83], v[200:203], v[140:143], v[80:83]
    s_mov_b32 s88, 0x00040001
    ds_read_b64_tr_b16 v[208:209], v61 offset:9600
    v_cndmask_b32 v145, v111, v145, s[82:83]
    v_mfma_f32_16x16x32_bf16 v[84:87], v[204:207], v[140:143], v[84:87]
    s_waitcnt lgkmcnt(4)
    ds_read_b64_tr_b16 v[210:211], v61 offset:10368
    v_cndmask_b32 v145, v145, v149, s[90:91]
    v_mfma_f32_16x16x32_bf16 v[88:91], v[196:199], v[112:115], v[88:91]
    s_and_b32 s82, s98, 0x55555555
    ds_read_b64_tr_b16 v[212:213], v62 offset:9600
    buffer_load_dwordx4 v9, s[8:11], s67 offen  lds
    v_mfma_f32_16x16x32_bf16 v[92:95], v[200:203], v[112:115], v[92:95]
    s_and_b32 s83, s99, 0x55555555
    ds_read_b128 v[124:127], v17 offset:7040
    v_cndmask_b32 v146, v111, v146, s[84:85]
    v_mfma_f32_16x16x32_bf16 v[96:99], v[204:207], v[112:115], v[96:99]
    s_andn2_b64 s[80:81], s[98:99], s[82:83]
    ds_read_b64_tr_b16 v[214:215], v62 offset:10368
    v_cndmask_b32 v146, v146, v150, s[92:93]
    v_mfma_f32_16x16x32_bf16 v[64:67], a[60:63], v[116:119], v[64:67]
    s_not_b64 vcc, s[80:81]
    ds_write_b64 v144, v[168:169]
    v_mfma_f32_16x16x32_bf16 v[68:71], a[64:67], v[116:119], v[68:71]
    s_mov_b32 s89, 0x00400010
    ds_read_b64_tr_b16 v[216:217], v63 offset:9600
    buffer_load_dwordx4 v10, s[8:11], s67 offen offset:1024  lds
    v_mfma_f32_16x16x32_bf16 v[72:75], a[68:71], v[116:119], v[72:75]
    s_waitcnt lgkmcnt(5)
    ds_write_b64 v145, v[170:171]
    v_mfma_f32_16x16x32_bf16 v[76:79], a[60:63], v[120:123], v[76:79]
    s_lshl_b64 s[90:91], s[88:89], 1
    ds_read_b64_tr_b16 v[218:219], v63 offset:10368
    v_mfma_f32_16x16x32_bf16 v[80:83], a[64:67], v[120:123], v[80:83]
    s_lshl_b64 s[92:93], s[88:89], 8
    ds_write_b64 v146, v[172:173]
    v_mfma_f32_16x16x32_bf16 v[84:87], a[68:71], v[120:123], v[84:87]
    s_waitcnt lgkmcnt(5)
    ds_read_b128 v[128:131], v17 offset:10496
    buffer_load_dwordx4 v11, s[8:11], s67 offen offset:2048  lds
    v_cndmask_b32 v147, v111, v147, s[86:87]
    v_cndmask_b32 v147, v147, v151, s[94:95]
    v_mfma_f32_16x16x32_bf16 v[88:91], a[60:63], v[124:127], v[88:91]
    s_mov_b32 m0, s68
    ds_write_b64 v147, v[174:175]
    v_mfma_f32_16x16x32_bf16 v[92:95], a[64:67], v[124:127], v[92:95]
    s_lshl_b64 s[94:95], s[88:89], 9
    ds_read_b64 v[144:145], v110
    v_add3_u32 v31, v30, v31, s5
    v_and_or_b32 v30, v32, 2.0, v30
    v_mfma_f32_16x16x32_bf16 v[96:99], a[68:71], v[124:127], v[96:99]
    s_waitcnt vmcnt(12) lgkmcnt(4)
    s_barrier
    v_mfma_f32_16x16x32_bf16 v[64:67], a[168:171], v[120:123], v[64:67]
    s_add_u32 s56, s44, 43200
    ds_read_b64_tr_b16 a[72:73], v13 offset:49152
    buffer_load_dwordx4 v9, s[8:11], s69 offen  lds
    v_mfma_f32_16x16x32_bf16 v[68:71], a[172:175], v[120:123], v[68:71]
    s_cmp_eq_u32 s46, 0
    s_cselect_b32 s78, s78, s67
    ds_read_b64_tr_b16 a[74:75], v13 offset:49920
    v_mfma_f32_16x16x32_bf16 v[72:75], a[176:179], v[120:123], v[72:75]
    ds_read_b64_tr_b16 a[76:77], v14 offset:49152
    v_bitop3_b32 v26, v7, 48, v41 bitop3:0x6a
    v_mfma_f32_16x16x32_bf16 v[76:79], a[168:171], v[124:127], v[76:79]
    ds_read_b128 v[132:135], v17 offset:13952
    v_xor_b32 v27, 8, v26
    v_mfma_f32_16x16x32_bf16 v[80:83], a[172:175], v[124:127], v[80:83]
    buffer_load_dwordx4 v10, s[8:11], s69 offen offset:1024  lds
    v_mfma_f32_16x16x32_bf16 v[84:87], a[176:179], v[124:127], v[84:87]
    s_waitcnt lgkmcnt(4)
    ds_write_b32 v144, v109
    v_mfma_f32_16x16x32_bf16 v[88:91], a[168:171], v[128:131], v[88:91]
    ds_read_b64_tr_b16 a[78:79], v14 offset:49920
    v_cndmask_b32_dpp v145, v145, v145, vcc quad_perm:[0,0,2,2] row_mask:0xf bank_mask:0xf
    v_mfma_f32_16x16x32_bf16 v[92:95], a[172:175], v[128:131], v[92:95]
    ds_read_b64_tr_b16 a[80:81], v15 offset:49152
    v_lshrrev_b32 v52, 1, v4
    v_mfma_f32_16x16x32_bf16 v[96:99], a[176:179], v[128:131], v[96:99]
    buffer_load_dwordx4 v11, s[8:11], s69 offen offset:2048  lds
    v_mfma_f32_16x16x32_bf16 v[64:67], v[208:211], v[124:127], v[64:67]
    ds_read_b64_tr_b16 a[82:83], v15 offset:49920
    v_lshl_or_b32 v21, v4, 1, v52
    v_mfma_f32_16x16x32_bf16 v[68:71], v[212:215], v[124:127], v[68:71]
    ds_read_b128 v[136:139], v18 offset:0
    v_and_b32 v21, 48, v21
    v_mfma_f32_16x16x32_bf16 v[72:75], v[216:219], v[124:127], v[72:75]
    ds_read_b128 v[140:143], v18 offset:3456
    v_lshl_add_u32 v21, s2, 7, v21
    v_mfma_f32_16x16x32_bf16 v[76:79], v[208:211], v[128:131], v[76:79]
    buffer_load_dwordx4 v12, s[8:11], s69 offen offset:2432  lds
    v_mfma_f32_16x16x32_bf16 v[80:83], v[212:215], v[128:131], v[80:83]
    s_bitcmp1_b32 s73, 30
    s_cbranch_scc1 L_noj3
    s_mov_b32 m0, s72
    s_nop 0
    buffer_load_dwordx4 v50, s[8:11], s73 offen offset:2432  lds
    s_mov_b32 m0, s77
    s_nop 0
    buffer_load_dwordx4 v12, s[8:11], s78 offen offset:2432  lds
    s_mov_b32 m0, s70
    s_bitcmp1_b32 s39, 30
    s_cbranch_scc1 L_noj3
    buffer_load_dwordx4 v9, s[8:11], s71 offen  lds
    buffer_load_dwordx4 v10, s[8:11], s71 offen offset:1024  lds
    buffer_load_dwordx4 v11, s[8:11], s71 offen offset:2048  lds
L_noj3:
    v_mfma_f32_16x16x32_bf16 v[84:87], v[216:219], v[128:131], v[84:87]
    s_waitcnt lgkmcnt(3)
    ds_read_b64_tr_b16 a[180:181], v13 offset:55296
    v_mad_u32_u24 v19, v2, s42, v21
    v_mfma_f32_16x16x32_bf16 v[88:91], v[208:211], v[132:135], v[88:91]
    s_lshl_b32 s31, s2, 5
    ds_read_b64_tr_b16 a[182:183], v13 offset:56064
    ds_read_b64_tr_b16 a[184:185], v14 offset:55296
    v_mfma_f32_16x16x32_bf16 v[92:95], v[212:215], v[132:135], v[92:95]
    ds_read_b128 v[112:115], v18 offset:6912
    v_xor_b32 v5, s31, v5
    v_mfma_f32_16x16x32_bf16 v[96:99], v[216:219], v[132:135], v[96:99]
    s_waitcnt lgkmcnt(4)
    ds_read_b64_tr_b16 a[186:187], v14 offset:56064
    v_lshl_add_u32 v53, s2, 2, v3
    v_mfma_f32_16x16x32_bf16 v[64:67], a[72:75], v[136:139], v[64:67]
    s_lshr_b32 s31, s24, 1
    ds_read_b64_tr_b16 a[188:189], v15 offset:55296
    v_lshrrev_b32 v52, 1, v2
    v_mfma_f32_16x16x32_bf16 v[68:71], a[76:79], v[136:139], v[68:71]
    s_add_u32 m0, s31, 36864
    ds_read_b64_tr_b16 a[190:191], v15 offset:56064
    v_bitop3_b32 v52, v52, 6, v53 bitop3:0x6a
    v_mfma_f32_16x16x32_bf16 v[72:75], a[80:83], v[136:139], v[72:75]
    s_add_u32 s31, s31, 159744
    ds_read_b64_tr_b16 v[220:221], v13 offset:0
    v_lshl_add_u32 v52, v2, 3, v52
    v_mfma_f32_16x16x32_bf16 v[76:79], a[72:75], v[140:143], v[76:79]
    ds_read_b64_tr_b16 v[222:223], v13 offset:768
    buffer_load_dwordx4 v5, s[16:19], s31 offen lds
    v_mfma_f32_16x16x32_bf16 v[80:83], a[76:79], v[140:143], v[80:83]
    ds_read_b64_tr_b16 v[224:225], v14 offset:0
    v_lshl_add_u32 v38, v52, 3, s4
    v_mfma_f32_16x16x32_bf16 v[84:87], a[80:83], v[140:143], v[84:87]
    s_waitcnt lgkmcnt(5)
    ds_read_b128 v[116:119], v18 offset:10368
    v_lshlrev_b32 v146, 16, v145
    v_mfma_f32_16x16x32_bf16 v[88:91], a[72:75], v[112:115], v[88:91]
    s_mul_i32 s4, s57, 129024
    ds_read_b64_tr_b16 v[226:227], v14 offset:768
    s_add_u32 s56, s56, s4
    ds_read_b64_tr_b16 v[228:229], v15 offset:0
    v_mfma_f32_16x16x32_bf16 v[92:95], a[76:79], v[112:115], v[92:95]
    s_add_u32 s4, s56, 43008
    ds_read_b64_tr_b16 v[230:231], v15 offset:768
    buffer_load_dwordx4 v5, s[16:19], s31 offen offset:512 lds
    v_mfma_f32_16x16x32_bf16 v[96:99], a[80:83], v[112:115], v[96:99]
    s_waitcnt lgkmcnt(6)
    ds_read_b64_tr_b16 a[84:85], v13 offset:6144
    s_add_u32 s5, s56, 86016
    v_mfma_f32_16x16x32_bf16 v[64:67], a[180:183], v[140:143], v[64:67]
    ds_read_b64_tr_b16 a[86:87], v13 offset:6912
    v_and_b32 v147, 0xffff0000, v145
    v_mfma_f32_16x16x32_bf16 v[68:71], a[184:187], v[140:143], v[68:71]
    ds_read_b64_tr_b16 a[88:89], v14 offset:6144
    ds_read_b64_tr_b16 a[90:91], v14 offset:6912
    v_mfma_f32_16x16x32_bf16 v[72:75], a[188:191], v[140:143], v[72:75]
    ds_read_b64_tr_b16 a[92:93], v15 offset:6144
    buffer_load_dwordx4 v[180:183], v30, s[12:15], s55 offen
    v_mfma_f32_16x16x32_bf16 v[76:79], a[180:183], v[112:115], v[76:79]
    ds_read_b128 v[120:123], v18 offset:13824
    ds_read_b64_tr_b16 a[94:95], v15 offset:6912
    v_mfma_f32_16x16x32_bf16 v[80:83], a[184:187], v[112:115], v[80:83]
    v_ceil_f32 v149, v146
    v_ceil_f32 v151, v147
    v_mfma_f32_16x16x32_bf16 v[84:87], a[188:191], v[112:115], v[84:87]
    s_waitcnt lgkmcnt(6)
    v_cvt_u32_f32 v148, v146
    v_cvt_u32_f32 v150, v147
    v_mfma_f32_16x16x32_bf16 v[88:91], a[180:183], v[116:119], v[88:91]
    ds_read_b128 v[124:127], v18 offset:64
    buffer_load_dwordx4 v[184:187], v31, s[12:15], s55 offen
    v_mfma_f32_16x16x32_bf16 v[92:95], a[184:187], v[116:119], v[92:95]
    v_cvt_u32_f32 v149, v149
    v_cvt_u32_f32 v151, v151
    v_mfma_f32_16x16x32_bf16 v[96:99], a[188:191], v[116:119], v[96:99]
L_pgY1:
  s_cbranch_execz L_retY
    s_waitcnt vmcnt(14) lgkmcnt(3)
    s_barrier
    v_mfma_f32_16x16x32_bf16 v[64:67], v[220:223], v[112:115], v[64:67]
    ds_read_b128 v[128:131], v18 offset:3520
    ds_read_b64_tr_b16 a[192:193], v13 offset:12288
    v_mfma_f32_16x16x32_bf16 v[68:71], v[224:227], v[112:115], v[68:71]
    ds_read_b64_tr_b16 a[194:195], v13 offset:13056
    ds_read_b64_tr_b16 a[196:197], v14 offset:12288
    v_mfma_f32_16x16x32_bf16 v[72:75], v[228:231], v[112:115], v[72:75]
    ds_read_b64_tr_b16 a[198:199], v14 offset:13056
    ds_read_b64_tr_b16 a[200:201], v15 offset:12288
    v_mfma_f32_16x16x32_bf16 v[76:79], v[220:223], v[116:119], v[76:79]
    ds_read_b128 v[132:135], v18 offset:6976
    ds_read_b64_tr_b16 a[202:203], v15 offset:13056
    v_mfma_f32_16x16x32_bf16 v[80:83], v[224:227], v[116:119], v[80:83]
    ds_read_b64_tr_b16 v[232:233], v13 offset:18432
    v_cndmask_b32 v164, v148, v149, s[80:81]
    v_mfma_f32_16x16x32_bf16 v[84:87], v[228:231], v[116:119], v[84:87]
    s_waitcnt lgkmcnt(9)
    ds_read_b64_tr_b16 v[234:235], v13 offset:19200
    v_cndmask_b32 v165, v149, v148, s[82:83]
    v_mfma_f32_16x16x32_bf16 v[88:91], v[220:223], v[120:123], v[88:91]
    ds_read_b64_tr_b16 v[236:237], v14 offset:18432
    v_and_b32 v160, 4, v150
    v_mfma_f32_16x16x32_bf16 v[92:95], v[224:227], v[120:123], v[92:95]
    ds_read_b64_tr_b16 v[238:239], v14 offset:19200
    v_lshl_add_u32 v160, v160, 3, s35
    v_mfma_f32_16x16x32_bf16 v[96:99], v[228:231], v[120:123], v[96:99]
    ds_read_b64_tr_b16 v[240:241], v15 offset:18432
    v_mad_u32_u24 v160, v150, s42, v160
    v_mfma_f32_16x16x32_bf16 v[64:67], a[84:87], v[124:127], v[64:67]
    ds_read_b64_tr_b16 v[242:243], v15 offset:19200
    v_mad_u32_u24 v164, v164, s34, v160
    v_mfma_f32_16x16x32_bf16 v[68:71], a[88:91], v[124:127], v[68:71]
    ds_read_b64_tr_b16 a[96:97], v13 offset:24576
    v_and_b32 v160, 4, v151
    v_mfma_f32_16x16x32_bf16 v[72:75], a[92:95], v[124:127], v[72:75]
    s_waitcnt lgkmcnt(5)
    ds_read_b64_tr_b16 a[98:99], v13 offset:25344
    v_lshl_add_u32 v160, v160, 3, s35
    v_mfma_f32_16x16x32_bf16 v[76:79], a[84:87], v[128:131], v[76:79]
    ds_read_b128 v[136:139], v18 offset:10432
    v_mad_u32_u24 v160, v151, s42, v160
    v_mfma_f32_16x16x32_bf16 v[80:83], a[88:91], v[128:131], v[80:83]
    ds_read_b64_tr_b16 a[100:101], v14 offset:24576
    v_mad_u32_u24 v165, v165, s34, v160
    v_mfma_f32_16x16x32_bf16 v[84:87], a[92:95], v[128:131], v[84:87]
    ds_read_b64_tr_b16 a[102:103], v14 offset:25344
    v_fract_f32 v152, v146
    v_mfma_f32_16x16x32_bf16 v[88:91], a[84:87], v[132:135], v[88:91]
    ds_read_b64_tr_b16 a[104:105], v15 offset:24576
    v_fract_f32 v153, v147
    v_mfma_f32_16x16x32_bf16 v[92:95], a[88:91], v[132:135], v[92:95]
    ds_read_b64_tr_b16 a[106:107], v15 offset:25344
    v_mul_f32 v159, v152, v153
    v_mfma_f32_16x16x32_bf16 v[96:99], a[92:95], v[132:135], v[96:99]
    ds_read_b64_tr_b16 a[204:205], v13 offset:30720
    v_add_f32 v155, v152, v153
    v_mfma_f32_16x16x32_bf16 v[64:67], a[192:195], v[128:131], v[64:67]
    ds_read_b64_tr_b16 a[206:207], v13 offset:31488
    v_cndmask_b32 v152, 0, v152, s[98:99]
    v_mfma_f32_16x16x32_bf16 v[68:71], a[196:199], v[128:131], v[68:71]
    ds_read_b64_tr_b16 a[208:209], v14 offset:30720
    v_sub_f32 v155, v155, v159
    v_mfma_f32_16x16x32_bf16 v[72:75], a[200:203], v[128:131], v[72:75]
    ds_write_b64 v111, v[164:165]
    v_mfma_f32_16x16x32_bf16 v[76:79], a[192:195], v[132:135], v[76:79]
    ds_read_b128 v[140:143], v18 offset:13888
    v_mfma_f32_16x16x32_bf16 v[80:83], a[196:199], v[132:135], v[80:83]
    ds_read2_b32 v[176:177], v24 offset0:0 offset1:32
    v_sub_f32 v158, v152, v159
    v_mfma_f32_16x16x32_bf16 v[84:87], a[200:203], v[132:135], v[84:87]
    s_waitcnt lgkmcnt(5)
    ds_read_b64_tr_b16 a[210:211], v14 offset:31488
    v_sub_f32 v156, 1.0, v155
    v_mfma_f32_16x16x32_bf16 v[88:91], a[192:195], v[136:139], v[88:91]
    ds_read_b128 v[112:115], v18 offset:128
    v_sub_f32 v157, v155, v152
    v_mfma_f32_16x16x32_bf16 v[92:95], a[196:199], v[136:139], v[92:95]
    ds_read_b64_tr_b16 a[212:213], v15 offset:30720
    v_cvt_pk_bf16_f32 v167, v158, v159
    v_mfma_f32_16x16x32_bf16 v[96:99], a[200:203], v[136:139], v[96:99]
    ds_read_b64_tr_b16 a[214:215], v15 offset:31488
    v_cvt_pk_bf16_f32 v166, v156, v157
    v_mfma_f32_16x16x32_bf16 v[64:67], v[232:235], v[132:135], v[64:67]
    ds_write_b64 v111, v[166:167] offset:8
    v_mfma_f32_16x16x32_bf16 v[68:71], v[236:239], v[132:135], v[68:71]
    ds_read_b128 v[116:119], v18 offset:3584
    v_mfma_f32_16x16x32_bf16 v[72:75], v[240:243], v[132:135], v[72:75]
    s_waitcnt lgkmcnt(5)
    ds_read_b64 v[178:179], v25 offset:8
    v_cmp_gt_u32 vcc, s32, v148
    v_mfma_f32_16x16x32_bf16 v[76:79], v[232:235], v[136:139], v[76:79]
    ds_read_b128 v[120:123], v18 offset:7040
    v_cmp_le_u32 s[84:85], s33, v149
    v_mfma_f32_16x16x32_bf16 v[80:83], v[236:239], v[136:139], v[80:83]
    ds_read_b128 v[52:55], v23 offset:1536
    v_cmp_le_u32 s[86:87], s36, v151
    v_mfma_f32_16x16x32_bf16 v[84:87], v[240:243], v[136:139], v[84:87]
    ds_read_b128 v[56:59], v23 offset:1552
    v_xor_b32 v172, v176, v26
    v_mfma_f32_16x16x32_bf16 v[88:91], v[232:235], v[140:143], v[88:91]
    s_or_b64 vcc, vcc, s[84:85]
    ds_read_b32 v60, v23 offset:1568
    s_or_b64 vcc, vcc, s[86:87]
    s_cbranch_scc1 L_bfail2
L_bfail2_back:
    v_mfma_f32_16x16x32_bf16 v[92:95], v[236:239], v[140:143], v[92:95]
    v_xor_b32 v174, v177, v26
    v_xor_b32 v173, v176, v27
    v_mfma_f32_16x16x32_bf16 v[96:99], v[240:243], v[140:143], v[96:99]
    s_waitcnt vmcnt(2) lgkmcnt(4)
    s_barrier
    v_mfma_f32_16x16x32_bf16 v[64:67], a[96:99], v[112:115], v[64:67]
    ds_read_b64_tr_b16 v[144:145], v172 offset:0
    ds_read_b64_tr_b16 v[146:147], v174 offset:0
    v_mfma_f32_16x16x32_bf16 v[68:71], a[100:103], v[112:115], v[68:71]
    ds_read_b64_tr_b16 v[148:149], v173 offset:0
    ds_read_b64_tr_b16 v[244:245], v13 offset:36864
    v_mfma_f32_16x16x32_bf16 v[72:75], a[104:107], v[112:115], v[72:75]
    s_waitcnt lgkmcnt(5)
    ds_read_b64_tr_b16 v[246:247], v13 offset:37632
    v_xor_b32 v175, v177, v27
    v_mfma_f32_16x16x32_bf16 v[76:79], a[96:99], v[116:119], v[76:79]
    ds_read_b64_tr_b16 v[150:151], v175 offset:0
    v_cndmask_b32 v169, 0, v179, s[88:89]
    v_mfma_f32_16x16x32_bf16 v[80:83], a[100:103], v[116:119], v[80:83]
    ds_read_b64_tr_b16 v[152:153], v172 offset:64
    v_cndmask_b32 v171, 0, v179, s[92:93]
    v_mfma_f32_16x16x32_bf16 v[84:87], a[104:107], v[116:119], v[84:87]
    s_waitcnt lgkmcnt(7)
    ds_read_b64_tr_b16 v[154:155], v174 offset:64
    v_cndmask_b32 v168, 0, v178, s[88:89]
    v_mfma_f32_16x16x32_bf16 v[88:91], a[96:99], v[120:123], v[88:91]
    ds_read_b64_tr_b16 v[156:157], v173 offset:64
    v_cndmask_b32 v170, 0, v178, s[92:93]
    v_mfma_f32_16x16x32_bf16 v[92:95], a[100:103], v[120:123], v[92:95]
    ds_read_b64_tr_b16 v[158:159], v175 offset:64
    v_cndmask_b32 v169, v169, v178, s[90:91]
    v_mfma_f32_16x16x32_bf16 v[96:99], a[104:107], v[120:123], v[96:99]
    ds_read_b64_tr_b16 v[160:161], v172 offset:128
    v_cndmask_b32 v171, v171, v178, s[94:95]
    v_mfma_f32_16x16x32_bf16 v[64:67], a[204:207], v[116:119], v[64:67]
    ds_read_b64_tr_b16 v[162:163], v174 offset:128
    v_xor_b32 v40, v52, v4
    v_mfma_f32_16x16x32_bf16 v[68:71], a[208:211], v[116:119], v[68:71]
    ds_read_b64_tr_b16 v[164:165], v173 offset:128
    v_xor_b32 v41, v53, v4
    v_mfma_f32_16x16x32_bf16 v[72:75], a[212:215], v[116:119], v[72:75]
    s_waitcnt lgkmcnt(5)
    ds_read_b64_tr_b16 v[166:167], v175 offset:128
    v_xor_b32 v42, v54, v4
    v_mfma_f32_16x16x32_bf16 v[144:147], v[144:147], v[168:171], 0
    ds_read_b64_tr_b16 v[248:249], v14 offset:36864
    v_xor_b32 v43, v55, v4
    v_mfma_f32_16x16x32_bf16 v[148:151], v[148:151], v[168:171], 0
    ds_read_b128 v[124:127], v18 offset:10496
    v_xor_b32 v44, v56, v4
    v_mfma_f32_16x16x32_bf16 v[152:155], v[152:155], v[168:171], 0
    ds_read_b64_tr_b16 v[250:251], v14 offset:37632
    v_xor_b32 v45, v57, v4
    v_mfma_f32_16x16x32_bf16 v[76:79], a[204:207], v[120:123], v[76:79]
    ds_read_b64_tr_b16 v[252:253], v15 offset:36864
    v_cvt_pk_bf16_f32 v144, v144, v145
    v_cvt_pk_bf16_f32 v145, v146, v147
    v_mfma_f32_16x16x32_bf16 v[80:83], a[208:211], v[120:123], v[80:83]
    ds_write_b64 v28, v[144:145] offset:0
    v_mfma_f32_16x16x32_bf16 v[84:87], a[212:215], v[120:123], v[84:87]
    s_waitcnt lgkmcnt(5)
    ds_read_b64_tr_b16 v[254:255], v15 offset:37632
    v_cvt_pk_bf16_f32 v148, v148, v149
    v_cvt_pk_bf16_f32 v149, v150, v151
    v_mfma_f32_16x16x32_bf16 v[156:159], v[156:159], v[168:171], 0
    ds_write_b64 v29, v[148:149] offset:0
    v_mfma_f32_16x16x32_bf16 v[160:163], v[160:163], v[168:171], 0
    ds_read_b128 v[128:131], v18 offset:13952
    v_cvt_pk_bf16_f32 v152, v152, v153
    v_cvt_pk_bf16_f32 v153, v154, v155
    v_mfma_f32_16x16x32_bf16 v[164:167], v[164:167], v[168:171], 0
    s_waitcnt lgkmcnt(5)
    ds_write_b64 v28, v[152:153] offset:64
    v_mfma_f32_16x16x32_bf16 v[88:91], a[204:207], v[124:127], v[88:91]
    v_cvt_pk_bf16_f32 v156, v156, v157
    v_cvt_pk_bf16_f32 v157, v158, v159
    v_mfma_f32_16x16x32_bf16 v[92:95], a[208:211], v[124:127], v[92:95]
    ds_write_b64 v29, v[156:157] offset:64
    v_mfma_f32_16x16x32_bf16 v[96:99], a[212:215], v[124:127], v[96:99]
    s_waitcnt lgkmcnt(4)
    v_cvt_pk_bf16_f32 v160, v160, v161
    v_cvt_pk_bf16_f32 v161, v162, v163
    v_mfma_f32_16x16x32_bf16 v[64:67], v[244:247], v[120:123], v[64:67]
    ds_write_b64 v28, v[160:161] offset:128
    v_mfma_f32_16x16x32_bf16 v[68:71], v[248:251], v[120:123], v[68:71]
    v_cvt_pk_bf16_f32 v164, v164, v165
    v_cvt_pk_bf16_f32 v165, v166, v167
    v_mfma_f32_16x16x32_bf16 v[72:75], v[252:255], v[120:123], v[72:75]
    ds_write_b64 v29, v[164:165] offset:128
    v_mfma_f32_16x16x32_bf16 v[76:79], v[244:247], v[124:127], v[76:79]
    s_cmp_gt_u32 s62, 16
    s_cbranch_scc1 L_more
L_more_back:
    v_mfma_f32_16x16x32_bf16 v[80:83], v[248:251], v[124:127], v[80:83]
    v_xor_b32 v46, v58, v4
    v_xor_b32 v47, v59, v4
    v_mfma_f32_16x16x32_bf16 v[84:87], v[252:255], v[124:127], v[84:87]
    s_waitcnt lgkmcnt(0)
    s_barrier
    ds_read_b128 v[132:135], v40 offset:0
    v_mfma_f32_16x16x32_bf16 v[88:91], v[244:247], v[128:131], v[88:91]
    ds_read_b128 v[136:139], v40 offset:64
    v_xor_b32 v48, v60, v4
    v_mfma_f32_16x16x32_bf16 v[92:95], v[248:251], v[128:131], v[92:95]
    ds_read_b128 v[140:143], v40 offset:128
    v_mad_u32_u24 v21, v2, s54, v21
    v_mfma_f32_16x16x32_bf16 v[96:99], v[252:255], v[128:131], v[96:99]
    s_waitcnt lgkmcnt(2)
    ds_read_b128 v[112:115], v41 offset:0
    v_lshlrev_b32 v39, 3, v0
    v_mfma_f32_16x16x32_bf16 v[100:103], a[0:3], v[132:135], 0
    ds_read_b128 v[116:119], v41 offset:64
    v_cvt_pk_bf16_f32 v64, v64, v65
    v_mfma_f32_16x16x32_bf16 v[104:107], a[4:7], v[132:135], 0
    ds_read_b128 v[52:55], v23 offset:768
    v_cvt_pk_bf16_f32 v65, v66, v67
    v_mfma_f32_16x16x32_bf16 v[108:111], a[8:11], v[132:135], 0
    s_waitcnt lgkmcnt(4)
    ds_read_b128 v[56:59], v23 offset:784
    v_cvt_pk_bf16_f32 v66, v68, v69
    v_mfma_f32_16x16x32_bf16 v[100:103], a[12:15], v[136:139], v[100:103]
    ds_read_b128 v[120:123], v41 offset:128
    v_cvt_pk_bf16_f32 v67, v70, v71
    v_mfma_f32_16x16x32_bf16 v[104:107], a[16:19], v[136:139], v[104:107]
    v_permlane16_swap_b32 v64, v66
    v_mfma_f32_16x16x32_bf16 v[108:111], a[20:23], v[136:139], v[108:111]
    s_waitcnt lgkmcnt(4)
    v_permlane16_swap_b32 v65, v67
    v_mfma_f32_16x16x32_bf16 v[100:103], a[24:27], v[140:143], v[100:103]
    ds_read_b128 v[124:127], v42 offset:0
    v_cvt_pk_bf16_f32 v72, v72, v73
    v_mfma_f32_16x16x32_bf16 v[104:107], a[28:31], v[140:143], v[104:107]
    buffer_store_dwordx4 v[64:67], v19, s[20:23], s56 offen sc1
    v_cvt_pk_bf16_f32 v73, v74, v75
    v_lshrrev_b32 v22, 1, v0
    v_bitop3_b32 v22, v22, 48, v39 bitop3:0x6a
    v_mfma_f32_16x16x32_bf16 v[108:111], a[32:35], v[140:143], v[108:111]
    s_waitcnt lgkmcnt(2)
    ds_write_b64 v38, v[72:73] offset:49152
    v_mfma_f32_16x16x32_bf16 v[100:103], a[36:39], v[112:115], v[100:103]
    ds_read_b128 v[128:131], v42 offset:64
    v_mfma_f32_16x16x32_bf16 v[104:107], a[40:43], v[112:115], v[104:107]
    ds_read_b32 v60, v23 offset:800
    v_xor_b32 v40, v52, v4
    v_mfma_f32_16x16x32_bf16 v[108:111], a[44:47], v[112:115], v[108:111]
    ds_read2_b32 v[176:177], v24 offset0:64 offset1:96
    v_xor_b32 v41, v53, v4
    v_mfma_f32_16x16x32_bf16 v[100:103], a[48:51], v[116:119], v[100:103]
    ds_read_b128 v[132:135], v42 offset:128
    v_bfe_u32 v37, v0, 3, 4
    v_mfma_f32_16x16x32_bf16 v[104:107], a[52:55], v[116:119], v[104:107]
    ds_read_b64 v[178:179], v25 offset:264
    v_and_or_b32 v22, v22, 56, 64
    v_mfma_f32_16x16x32_bf16 v[108:111], a[56:59], v[116:119], v[108:111]
    s_waitcnt lgkmcnt(5)
    v_mad_u32_u24 v20, v37, s42, v22
    v_mad_u32_u24 v22, v37, s54, v22
    v_mfma_f32_16x16x32_bf16 v[100:103], a[60:63], v[120:123], v[100:103]
    ds_read_b128 v[136:139], v43 offset:0
    v_xor_b32 v42, v54, v4
    v_mfma_f32_16x16x32_bf16 v[104:107], a[64:67], v[120:123], v[104:107]
    v_cvt_pk_bf16_f32 v84, v84, v85
    v_cvt_pk_bf16_f32 v85, v86, v87
    v_mfma_f32_16x16x32_bf16 v[108:111], a[68:71], v[120:123], v[108:111]
    s_waitcnt lgkmcnt(3)
    ds_write_b64 v38, v[84:85] offset:51200
    v_mfma_f32_16x16x32_bf16 v[100:103], a[72:75], v[124:127], v[100:103]
    ds_read_b128 v[140:143], v43 offset:64
    v_mfma_f32_16x16x32_bf16 v[104:107], a[76:79], v[124:127], v[104:107]
    v_xor_b32 v172, v176, v26
    v_xor_b32 v174, v177, v26
    v_mfma_f32_16x16x32_bf16 v[108:111], a[80:83], v[124:127], v[108:111]
    s_waitcnt lgkmcnt(3)
    v_xor_b32 v173, v176, v27
    v_xor_b32 v175, v177, v27
    v_mfma_f32_16x16x32_bf16 v[100:103], a[84:87], v[128:131], v[100:103]
    ds_read_b128 v[112:115], v43 offset:128
    v_cndmask_b32 v169, 0, v179, s[88:89]
    v_mfma_f32_16x16x32_bf16 v[104:107], a[88:91], v[128:131], v[104:107]
    v_cndmask_b32 v171, 0, v179, s[92:93]
    v_cndmask_b32 v168, 0, v178, s[88:89]
    v_mfma_f32_16x16x32_bf16 v[108:111], a[92:95], v[128:131], v[108:111]
    v_cndmask_b32 v170, 0, v178, s[92:93]
    v_cndmask_b32 v169, v169, v178, s[90:91]
    v_mfma_f32_16x16x32_bf16 v[100:103], a[96:99], v[132:135], v[100:103]
    ds_read_b128 v[116:119], v44 offset:0
    v_cndmask_b32 v171, v171, v178, s[94:95]
    v_mfma_f32_16x16x32_bf16 v[104:107], a[100:103], v[132:135], v[104:107]
    v_xor_b32 v43, v55, v4
    v_cvt_pk_bf16_f32 v96, v96, v97
    v_mfma_f32_16x16x32_bf16 v[108:111], a[104:107], v[132:135], v[108:111]
    s_waitcnt lgkmcnt(2)
    v_cvt_pk_bf16_f32 v97, v98, v99
    v_cvt_pk_bf16_f32 v76, v76, v77
    v_mfma_f32_16x16x32_bf16 v[100:103], a[108:111], v[136:139], v[100:103]
    ds_read_b128 v[120:123], v44 offset:64
    v_cvt_pk_bf16_f32 v77, v78, v79
    v_mfma_f32_16x16x32_bf16 v[104:107], a[112:115], v[136:139], v[104:107]
    ds_write_b64 v38, v[96:97] offset:53248
    v_mfma_f32_16x16x32_bf16 v[108:111], a[116:119], v[136:139], v[108:111]
    v_cvt_pk_bf16_f32 v78, v80, v81
    v_cvt_pk_bf16_f32 v79, v82, v83
    v_mfma_f32_16x16x32_bf16 v[100:103], a[120:123], v[140:143], v[100:103]
    ds_read_b128 v[124:127], v44 offset:128
    v_xor_b32 v44, v56, v4
    v_mfma_f32_16x16x32_bf16 v[104:107], a[124:127], v[140:143], v[104:107]
    ds_read_b64_tr_b16 v[144:145], v172 offset:0
    v_cvt_pk_bf16_f32 v88, v88, v89
    v_mfma_f32_16x16x32_bf16 v[108:111], a[128:131], v[140:143], v[108:111]
    s_waitcnt lgkmcnt(4)
    ds_read_b64_tr_b16 v[146:147], v174 offset:0
    v_cvt_pk_bf16_f32 v89, v90, v91
    v_mfma_f32_16x16x32_bf16 v[100:103], a[132:135], v[112:115], v[100:103]
    ds_read_b64_tr_b16 v[148:149], v173 offset:0
    v_cvt_pk_bf16_f32 v90, v92, v93
    v_mfma_f32_16x16x32_bf16 v[104:107], a[136:139], v[112:115], v[104:107]
    ds_read_b128 v[128:131], v45 offset:0
    v_cvt_pk_bf16_f32 v91, v94, v95
    v_mfma_f32_16x16x32_bf16 v[108:111], a[140:143], v[112:115], v[108:111]
    ds_read_b64_tr_b16 v[150:151], v175 offset:0
    v_mfma_f32_16x16x32_bf16 v[100:103], a[144:147], v[116:119], v[100:103]
    ds_read_b64_tr_b16 v[152:153], v172 offset:64
    v_mfma_f32_16x16x32_bf16 v[104:107], a[148:151], v[116:119], v[104:107]
    ds_read_b64_tr_b16 v[154:155], v174 offset:64
    v_mfma_f32_16x16x32_bf16 v[108:111], a[152:155], v[116:119], v[108:111]
    s_waitcnt lgkmcnt(5)
    ds_read_b128 v[132:135], v45 offset:64
    v_mfma_f32_16x16x32_bf16 v[100:103], a[156:159], v[120:123], v[100:103]
    ds_read_b64_tr_b16 v[156:157], v173 offset:64
    v_mfma_f32_16x16x32_bf16 v[104:107], a[160:163], v[120:123], v[104:107]
    ds_read_b64_tr_b16 v[158:159], v175 offset:64
    v_mfma_f32_16x16x32_bf16 v[108:111], a[164:167], v[120:123], v[108:111]
    ds_read_b64_tr_b16 v[160:161], v172 offset:128
    v_mfma_f32_16x16x32_bf16 v[100:103], a[168:171], v[124:127], v[100:103]
    ds_read_b64_tr_b16 v[162:163], v174 offset:128
    v_mfma_f32_16x16x32_bf16 v[104:107], a[172:175], v[124:127], v[104:107]
    ds_read_b64_tr_b16 v[164:165], v173 offset:128
    v_mfma_f32_16x16x32_bf16 v[108:111], a[176:179], v[124:127], v[108:111]
    s_waitcnt lgkmcnt(5)
    ds_read_b64_tr_b16 v[166:167], v175 offset:128
    v_mfma_f32_16x16x32_bf16 v[100:103], a[180:183], v[128:131], v[100:103]
    ds_read_b128 v[136:139], v45 offset:128
    v_xor_b32 v45, v57, v4
    v_mfma_f32_16x16x32_bf16 v[104:107], a[184:187], v[128:131], v[104:107]
    v_permlane16_swap_b32 v76, v78
    v_mfma_f32_16x16x32_bf16 v[108:111], a[188:191], v[128:131], v[108:111]
    v_permlane16_swap_b32 v77, v79
    v_mfma_f32_16x16x32_bf16 v[100:103], a[192:195], v[132:135], v[100:103]
    ds_read_b128 v[140:143], v46 offset:0
    v_mfma_f32_16x16x32_bf16 v[104:107], a[196:199], v[132:135], v[104:107]
    buffer_store_dwordx4 v[76:79], v19, s[20:23], s4 offen sc1
    v_mfma_f32_16x16x32_bf16 v[108:111], a[200:203], v[132:135], v[108:111]
    v_permlane16_swap_b32 v88, v90
    v_mfma_f32_16x16x32_bf16 v[144:147], v[144:147], v[168:171], 0
    ds_read_b128 v[112:115], v46 offset:64
    v_mfma_f32_16x16x32_bf16 v[148:151], v[148:151], v[168:171], 0
    v_permlane16_swap_b32 v89, v91
    v_mfma_f32_16x16x32_bf16 v[152:155], v[152:155], v[168:171], 0
    s_waitcnt lgkmcnt(2)
    v_mfma_f32_16x16x32_bf16 v[156:159], v[156:159], v[168:171], 0
    ds_read_b128 v[116:119], v46 offset:128
    v_xor_b32 v46, v58, v4
    v_mfma_f32_16x16x32_bf16 v[160:163], v[160:163], v[168:171], 0
    buffer_store_dwordx4 v[88:91], v19, s[20:23], s5 offen sc1
    v_cvt_pk_bf16_f32 v144, v144, v145
    v_cvt_pk_bf16_f32 v145, v146, v147
    v_cvt_pk_bf16_f32 v148, v148, v149
    v_mfma_f32_16x16x32_bf16 v[164:167], v[164:167], v[168:171], 0
    ds_write_b64 v28, v[144:145] offset:12288
    v_mfma_f32_16x16x32_bf16 v[100:103], a[204:207], v[136:139], v[100:103]
    ds_read_b128 v[120:123], v47 offset:0
    v_mfma_f32_16x16x32_bf16 v[104:107], a[208:211], v[136:139], v[104:107]
    v_cvt_pk_bf16_f32 v149, v150, v151
    v_cvt_pk_bf16_f32 v152, v152, v153
    v_mfma_f32_16x16x32_bf16 v[108:111], a[212:215], v[136:139], v[108:111]
    s_waitcnt lgkmcnt(3)
    ds_write_b64 v29, v[148:149] offset:12288
    v_mfma_f32_16x16x32_bf16 v[100:103], a[216:219], v[140:143], v[100:103]
    ds_read_b128 v[124:127], v47 offset:64
    v_mfma_f32_16x16x32_bf16 v[104:107], a[220:223], v[140:143], v[104:107]
    v_cvt_pk_bf16_f32 v153, v154, v155
    v_cvt_pk_bf16_f32 v156, v156, v157
    v_mfma_f32_16x16x32_bf16 v[108:111], a[224:227], v[140:143], v[108:111]
    ds_read2_b32 v[176:177], v24 offset0:128 offset1:160
    v_cvt_pk_bf16_f32 v157, v158, v159
    v_mfma_f32_16x16x32_bf16 v[100:103], a[228:231], v[112:115], v[100:103]
    ds_read_b128 v[128:131], v47 offset:128
    v_cvt_pk_bf16_f32 v160, v160, v161
    v_mfma_f32_16x16x32_bf16 v[104:107], a[232:235], v[112:115], v[104:107]
    ds_write_b64 v28, v[152:153] offset:12352
    v_mfma_f32_16x16x32_bf16 v[108:111], a[236:239], v[112:115], v[108:111]
    s_waitcnt lgkmcnt(4)
    ds_read_b64 v[178:179], v25 offset:520
    v_mfma_f32_16x16x32_bf16 v[100:103], a[240:243], v[116:119], v[100:103]
    ds_read_b128 v[132:135], v48 offset:0
    v_cvt_pk_bf16_f32 v161, v162, v163
    v_mfma_f32_16x16x32_bf16 v[104:107], a[244:247], v[116:119], v[104:107]
    ds_write_b64 v29, v[156:157] offset:12352
    v_mfma_f32_16x16x32_bf16 v[108:111], a[248:251], v[116:119], v[108:111]
    s_waitcnt lgkmcnt(5)
    v_xor_b32 v172, v176, v26
    v_xor_b32 v174, v177, v26
    v_mfma_f32_16x16x32_bf16 v[100:103], a[252:255], v[120:123], v[100:103]
    ds_read_b128 v[136:139], v48 offset:64
    v_xor_b32 v173, v176, v27
    v_mfma_f32_16x16x32_bf16 v[104:107], v[188:191], v[120:123], v[104:107]
    ds_write_b64 v28, v[160:161] offset:12416
    v_mfma_f32_16x16x32_bf16 v[108:111], v[192:195], v[120:123], v[108:111]
    s_waitcnt lgkmcnt(4)
    v_xor_b32 v175, v177, v27
    v_cvt_pk_bf16_f32 v164, v164, v165
    v_mfma_f32_16x16x32_bf16 v[100:103], v[196:199], v[124:127], v[100:103]
    ds_read_b128 v[140:143], v48 offset:128
    v_cvt_pk_bf16_f32 v165, v166, v167
    v_mfma_f32_16x16x32_bf16 v[104:107], v[200:203], v[124:127], v[104:107]
    ds_write_b64 v29, v[164:165] offset:12416
    v_mfma_f32_16x16x32_bf16 v[108:111], v[204:207], v[124:127], v[108:111]
    v_cndmask_b32 v169, 0, v179, s[88:89]
    v_cndmask_b32 v171, 0, v179, s[92:93]
    v_mfma_f32_16x16x32_bf16 v[100:103], v[208:211], v[128:131], v[100:103]
    ds_read_b128 v[112:115], v40 offset:0
    v_cndmask_b32 v168, 0, v178, s[88:89]
    v_mfma_f32_16x16x32_bf16 v[104:107], v[212:215], v[128:131], v[104:107]
    v_cndmask_b32 v170, 0, v178, s[92:93]
    v_cndmask_b32 v169, v169, v178, s[90:91]
    v_mfma_f32_16x16x32_bf16 v[108:111], v[216:219], v[128:131], v[108:111]
    s_waitcnt lgkmcnt(3)
    v_cndmask_b32 v171, v171, v178, s[94:95]
    v_xor_b32 v47, v59, v4
    v_mfma_f32_16x16x32_bf16 v[100:103], v[220:223], v[132:135], v[100:103]
    ds_read_b128 v[116:119], v40 offset:64
    v_xor_b32 v48, v60, v4
    v_mfma_f32_16x16x32_bf16 v[104:107], v[224:227], v[132:135], v[104:107]
    v_mfma_f32_16x16x32_bf16 v[108:111], v[228:231], v[132:135], v[108:111]
    v_mfma_f32_16x16x32_bf16 v[100:103], v[232:235], v[136:139], v[100:103]
    ds_read_b128 v[120:123], v40 offset:128
    v_mfma_f32_16x16x32_bf16 v[104:107], v[236:239], v[136:139], v[104:107]
    ds_read_b64_tr_b16 v[144:145], v172 offset:0
    v_mfma_f32_16x16x32_bf16 v[108:111], v[240:243], v[136:139], v[108:111]
    s_waitcnt lgkmcnt(3)
    ds_read_b64_tr_b16 v[146:147], v174 offset:0
    v_mfma_f32_16x16x32_bf16 v[100:103], v[244:247], v[140:143], v[100:103]
    ds_read_b64_tr_b16 v[148:149], v173 offset:0
    v_mfma_f32_16x16x32_bf16 v[104:107], v[248:251], v[140:143], v[104:107]
    ds_read_b128 v[124:127], v41 offset:0
    v_mfma_f32_16x16x32_bf16 v[108:111], v[252:255], v[140:143], v[108:111]
    s_waitcnt vmcnt(3) lgkmcnt(5)
    ds_read_b64_tr_b16 v[150:151], v175 offset:0
    v_mfma_f32_16x16x32_bf16 v[64:67], a[0:3], v[112:115], 0
    ds_read_b64_tr_b16 v[152:153], v172 offset:64
    v_and_b32 v180, s96, v180
    v_mfma_f32_16x16x32_bf16 v[68:71], a[4:7], v[112:115], 0
    ds_read_b64_tr_b16 v[154:155], v174 offset:64
    v_and_b32 v181, s96, v181
    v_mfma_f32_16x16x32_bf16 v[72:75], a[8:11], v[112:115], 0
    ds_read_b128 v[128:131], v41 offset:64
    v_cvt_pk_bf16_f32 v108, v108, v109
    v_mfma_f32_16x16x32_bf16 v[64:67], a[12:15], v[116:119], v[64:67]
    ds_read_b64_tr_b16 v[156:157], v173 offset:64
    v_cvt_pk_bf16_f32 v109, v110, v111
    v_mfma_f32_16x16x32_bf16 v[68:71], a[16:19], v[116:119], v[68:71]
    ds_read_b64_tr_b16 v[158:159], v175 offset:64
    v_and_b32 v182, s96, v182
    v_mfma_f32_16x16x32_bf16 v[72:75], a[20:23], v[116:119], v[72:75]
    s_waitcnt lgkmcnt(5)
    ds_read_b64_tr_b16 v[160:161], v172 offset:128
    v_and_b32 v183, s96, v183
    v_mfma_f32_16x16x32_bf16 v[64:67], a[24:27], v[120:123], v[64:67]
    ds_read_b64_tr_b16 v[162:163], v174 offset:128
    v_pk_max_u16 v180, v180, v181
    v_mfma_f32_16x16x32_bf16 v[68:71], a[28:31], v[120:123], v[68:71]
    ds_read_b64_tr_b16 v[164:165], v173 offset:128
    v_pk_max_u16 v182, v182, v183
    v_mfma_f32_16x16x32_bf16 v[72:75], a[32:35], v[120:123], v[72:75]
    ds_read_b64_tr_b16 v[166:167], v175 offset:128
    v_pk_max_u16 v180, v180, s37
    v_mfma_f32_16x16x32_bf16 v[64:67], a[36:39], v[124:127], v[64:67]
    ds_read_b128 v[132:135], v41 offset:128
    v_pk_max_u16 v180, v180, v182
    v_mfma_f32_16x16x32_bf16 v[68:71], a[40:43], v[124:127], v[68:71]
    ds_read_b128 v[52:55], v23 offset:0
    v_cmp_ne_u32 s[80:81], s37, v180
    v_mfma_f32_16x16x32_bf16 v[72:75], a[44:47], v[124:127], v[72:75]
    s_waitcnt lgkmcnt(5)
    ds_read2_b32 v[176:177], v24 offset0:192 offset1:224
    v_and_b32 v184, s96, v184
    v_mfma_f32_16x16x32_bf16 v[64:67], a[48:51], v[128:131], v[64:67]
    ds_read_b128 v[136:139], v42 offset:0
    v_and_b32 v185, s96, v185
    v_mfma_f32_16x16x32_bf16 v[68:71], a[52:55], v[128:131], v[68:71]
    ds_read_b64 v[178:179], v25 offset:776
    v_and_b32 v186, s96, v186
    v_mfma_f32_16x16x32_bf16 v[72:75], a[56:59], v[128:131], v[72:75]
    ds_write_b64 v38, v[108:109] offset:55296
    v_mfma_f32_16x16x32_bf16 v[144:147], v[144:147], v[168:171], 0
    ds_read_b128 v[140:143], v42 offset:64
    v_mfma_f32_16x16x32_bf16 v[148:151], v[148:151], v[168:171], 0
    ds_read_b128 v[56:59], v23 offset:16
    v_and_b32 v187, s96, v187
    v_mfma_f32_16x16x32_bf16 v[152:155], v[152:155], v[168:171], 0
    s_waitcnt lgkmcnt(5)
    ds_read_b32 v60, v23 offset:32
    v_xor_b32 v172, v176, v26
    v_mfma_f32_16x16x32_bf16 v[156:159], v[156:159], v[168:171], 0
    ds_read_b128 v[112:115], v42 offset:128
    v_cvt_pk_bf16_f32 v144, v144, v145
    v_mfma_f32_16x16x32_bf16 v[160:163], v[160:163], v[168:171], 0
    v_cvt_pk_bf16_f32 v145, v146, v147
    v_cvt_pk_bf16_f32 v148, v148, v149
    v_mfma_f32_16x16x32_bf16 v[164:167], v[164:167], v[168:171], 0
    s_waitcnt lgkmcnt(4)
    ds_write_b64 v28, v[144:145] offset:24576
    v_mfma_f32_16x16x32_bf16 v[64:67], a[60:63], v[132:135], v[64:67]
    ds_read_b128 v[116:119], v43 offset:0
    v_mfma_f32_16x16x32_bf16 v[68:71], a[64:67], v[132:135], v[68:71]
    v_cvt_pk_bf16_f32 v149, v150, v151
    v_xor_b32 v174, v177, v26
    v_mfma_f32_16x16x32_bf16 v[72:75], a[68:71], v[132:135], v[72:75]
    s_waitcnt lgkmcnt(3)
    ds_write_b64 v29, v[148:149] offset:24576
    v_mfma_f32_16x16x32_bf16 v[64:67], a[72:75], v[136:139], v[64:67]
    ds_read_b128 v[120:123], v43 offset:64
    v_mfma_f32_16x16x32_bf16 v[68:71], a[76:79], v[136:139], v[68:71]
    v_xor_b32 v173, v176, v27
    v_cvt_pk_bf16_f32 v152, v152, v153
    v_mfma_f32_16x16x32_bf16 v[72:75], a[80:83], v[136:139], v[72:75]
    v_cvt_pk_bf16_f32 v153, v154, v155
    v_xor_b32 v175, v177, v27
    v_mfma_f32_16x16x32_bf16 v[64:67], a[84:87], v[140:143], v[64:67]
    ds_read_b128 v[124:127], v43 offset:128
    v_cvt_pk_bf16_f32 v156, v156, v157
    v_mfma_f32_16x16x32_bf16 v[68:71], a[88:91], v[140:143], v[68:71]
    ds_write_b64 v28, v[152:153] offset:24640
    v_mfma_f32_16x16x32_bf16 v[72:75], a[92:95], v[140:143], v[72:75]
    s_waitcnt lgkmcnt(3)
    v_cvt_pk_bf16_f32 v157, v158, v159
    v_cvt_pk_bf16_f32 v160, v160, v161
    v_mfma_f32_16x16x32_bf16 v[64:67], a[96:99], v[112:115], v[64:67]
    ds_read_b128 v[128:131], v44 offset:0
    v_cvt_pk_bf16_f32 v161, v162, v163
    v_mfma_f32_16x16x32_bf16 v[68:71], a[100:103], v[112:115], v[68:71]
    ds_read_b64_tr_b16 v[144:145], v172 offset:0
    v_cvt_pk_bf16_f32 v164, v164, v165
    v_mfma_f32_16x16x32_bf16 v[72:75], a[104:107], v[112:115], v[72:75]
    ds_read_b64_tr_b16 v[146:147], v174 offset:0
    v_cvt_pk_bf16_f32 v165, v166, v167
    v_mfma_f32_16x16x32_bf16 v[64:67], a[108:111], v[116:119], v[64:67]
    ds_read_b64_tr_b16 v[148:149], v173 offset:0
    v_cndmask_b32 v169, 0, v179, s[88:89]
    v_mfma_f32_16x16x32_bf16 v[68:71], a[112:115], v[116:119], v[68:71]
    ds_read_b128 v[132:135], v44 offset:64
    v_cndmask_b32 v171, 0, v179, s[92:93]
    v_mfma_f32_16x16x32_bf16 v[72:75], a[116:119], v[116:119], v[72:75]
    s_waitcnt lgkmcnt(5)
    ds_read_b64_tr_b16 v[150:151], v175 offset:0
    v_cndmask_b32 v168, 0, v178, s[88:89]
    v_mfma_f32_16x16x32_bf16 v[64:67], a[120:123], v[120:123], v[64:67]
    ds_read_b64_tr_b16 v[152:153], v172 offset:64
    v_cndmask_b32 v170, 0, v178, s[92:93]
    v_mfma_f32_16x16x32_bf16 v[68:71], a[124:127], v[120:123], v[68:71]
L_pgY2:
  s_cbranch_execz L_retY
    ds_read_b64_tr_b16 v[154:155], v174 offset:64
    v_cndmask_b32 v169, v169, v178, s[90:91]
    v_mfma_f32_16x16x32_bf16 v[72:75], a[128:131], v[120:123], v[72:75]
    ds_write_b64 v29, v[156:157] offset:24640
    v_mfma_f32_16x16x32_bf16 v[64:67], a[132:135], v[124:127], v[64:67]
    ds_read_b128 v[136:139], v44 offset:128
    v_mfma_f32_16x16x32_bf16 v[68:71], a[136:139], v[124:127], v[68:71]
    ds_read_b64_tr_b16 v[156:157], v173 offset:64
    v_cndmask_b32 v171, v171, v178, s[94:95]
    v_mfma_f32_16x16x32_bf16 v[72:75], a[140:143], v[124:127], v[72:75]
    s_waitcnt lgkmcnt(5)
    ds_read_b64_tr_b16 v[158:159], v175 offset:64
    v_pk_max_u16 v184, v184, v185
    v_mfma_f32_16x16x32_bf16 v[64:67], a[144:147], v[128:131], v[64:67]
    ds_write_b64 v28, v[160:161] offset:24704
    v_mfma_f32_16x16x32_bf16 v[68:71], a[148:151], v[128:131], v[68:71]
    ds_read_b64_tr_b16 v[160:161], v172 offset:128
    v_mfma_f32_16x16x32_bf16 v[72:75], a[152:155], v[128:131], v[72:75]
    ds_read_b64_tr_b16 v[162:163], v174 offset:128
    v_pk_max_u16 v186, v186, v187
    v_mfma_f32_16x16x32_bf16 v[64:67], a[156:159], v[132:135], v[64:67]
    ds_write_b64 v29, v[164:165] offset:24704
    v_mfma_f32_16x16x32_bf16 v[68:71], a[160:163], v[132:135], v[68:71]
    ds_read_b64_tr_b16 v[164:165], v173 offset:128
    v_mfma_f32_16x16x32_bf16 v[72:75], a[164:167], v[132:135], v[72:75]
    s_waitcnt lgkmcnt(5)
    ds_read_b64_tr_b16 v[166:167], v175 offset:128
    v_pk_max_u16 v184, v184, s37
    v_mfma_f32_16x16x32_bf16 v[64:67], a[168:171], v[136:139], v[64:67]
    ds_read_b128 v[140:143], v45 offset:0
    v_pk_max_u16 v184, v184, v186
    v_mfma_f32_16x16x32_bf16 v[68:71], a[172:175], v[136:139], v[68:71]
    ds_read_b128 v[112:115], v45 offset:64
    v_cmp_ne_u32 s[82:83], s37, v184
    v_mfma_f32_16x16x32_bf16 v[72:75], a[176:179], v[136:139], v[72:75]
    v_xor_b32 v40, v52, v4
    v_xor_b32 v41, v53, v4
    v_mfma_f32_16x16x32_bf16 v[144:147], v[144:147], v[168:171], 0
    ds_read_b128 v[116:119], v45 offset:128
    v_xor_b32 v42, v54, v4
    v_mfma_f32_16x16x32_bf16 v[148:151], v[148:151], v[168:171], 0
    s_or_b64 vcc, s[80:81], s[82:83]
    s_cbranch_scc1 L_afailY
L_afailY_back:
    v_mfma_f32_16x16x32_bf16 v[152:155], v[152:155], v[168:171], 0
    s_waitcnt lgkmcnt(3)
    v_xor_b32 v43, v55, v4
    v_cvt_pk_bf16_f32 v144, v144, v145
    v_mfma_f32_16x16x32_bf16 v[156:159], v[156:159], v[168:171], 0
    ds_read_b128 v[120:123], v46 offset:0
    v_cvt_pk_bf16_f32 v145, v146, v147
    v_mfma_f32_16x16x32_bf16 v[160:163], v[160:163], v[168:171], 0
    ds_write_b64 v28, v[144:145] offset:36864
    v_mfma_f32_16x16x32_bf16 v[164:167], v[164:167], v[168:171], 0
    s_waitcnt lgkmcnt(3)
    v_cvt_pk_bf16_f32 v148, v148, v149
    v_cvt_pk_bf16_f32 v149, v150, v151
    v_mfma_f32_16x16x32_bf16 v[64:67], a[180:183], v[140:143], v[64:67]
    ds_read_b128 v[124:127], v46 offset:64
    v_cvt_pk_bf16_f32 v152, v152, v153
    v_mfma_f32_16x16x32_bf16 v[68:71], a[184:187], v[140:143], v[68:71]
    ds_write_b64 v29, v[148:149] offset:36864
    v_mfma_f32_16x16x32_bf16 v[72:75], a[188:191], v[140:143], v[72:75]
    v_cvt_pk_bf16_f32 v153, v154, v155
    v_cvt_pk_bf16_f32 v156, v156, v157
    v_mfma_f32_16x16x32_bf16 v[64:67], a[192:195], v[112:115], v[64:67]
    ds_read_b128 v[128:131], v46 offset:128
    v_cvt_pk_bf16_f32 v157, v158, v159
    v_mfma_f32_16x16x32_bf16 v[68:71], a[196:199], v[112:115], v[68:71]
    ds_write_b64 v28, v[152:153] offset:36928
    v_mfma_f32_16x16x32_bf16 v[72:75], a[200:203], v[112:115], v[72:75]
    s_waitcnt lgkmcnt(4)
    v_cvt_pk_bf16_f32 v160, v160, v161
    v_cvt_pk_bf16_f32 v161, v162, v163
    v_mfma_f32_16x16x32_bf16 v[64:67], a[204:207], v[116:119], v[64:67]
    ds_read_b128 v[132:135], v47 offset:0
    v_cvt_pk_bf16_f32 v164, v164, v165
    v_mfma_f32_16x16x32_bf16 v[68:71], a[208:211], v[116:119], v[68:71]
    ds_write_b64 v29, v[156:157] offset:36928
    v_mfma_f32_16x16x32_bf16 v[72:75], a[212:215], v[116:119], v[72:75]
    v_cvt_pk_bf16_f32 v165, v166, v167
    v_xor_b32 v44, v56, v4
    v_mfma_f32_16x16x32_bf16 v[64:67], a[216:219], v[120:123], v[64:67]
    ds_read_b128 v[136:139], v47 offset:64
    v_xor_b32 v45, v57, v4
    v_mfma_f32_16x16x32_bf16 v[68:71], a[220:223], v[120:123], v[68:71]
    ds_write_b64 v28, v[160:161] offset:36992
    v_mfma_f32_16x16x32_bf16 v[72:75], a[224:227], v[120:123], v[72:75]
    s_waitcnt lgkmcnt(4)
    v_xor_b32 v46, v58, v4
    v_cvt_pk_bf16_f32 v100, v100, v101
    v_mfma_f32_16x16x32_bf16 v[64:67], a[228:231], v[124:127], v[64:67]
    ds_read_b128 v[140:143], v47 offset:128
    v_xor_b32 v47, v59, v4
    v_mfma_f32_16x16x32_bf16 v[68:71], a[232:235], v[124:127], v[68:71]
    ds_write_b64 v29, v[164:165] offset:36992
    v_mfma_f32_16x16x32_bf16 v[72:75], a[236:239], v[124:127], v[72:75]
    v_cvt_pk_bf16_f32 v101, v102, v103
    v_cvt_pk_bf16_f32 v102, v104, v105
    v_mfma_f32_16x16x32_bf16 v[64:67], a[240:243], v[128:131], v[64:67]
    ds_read_b128 v[112:115], v48 offset:0
    v_cvt_pk_bf16_f32 v103, v106, v107
    v_mfma_f32_16x16x32_bf16 v[68:71], a[244:247], v[128:131], v[68:71]
    v_permlane16_swap_b32 v100, v102
    v_mfma_f32_16x16x32_bf16 v[72:75], a[248:251], v[128:131], v[72:75]
    s_waitcnt lgkmcnt(3)
    v_permlane16_swap_b32 v101, v103
    v_mfma_f32_16x16x32_bf16 v[64:67], a[252:255], v[132:135], v[64:67]
    ds_read_b128 v[116:119], v48 offset:64
    v_mfma_f32_16x16x32_bf16 v[68:71], v[188:191], v[132:135], v[68:71]
    buffer_store_dwordx4 v[100:103], v21, s[20:23], s74 offen sc1
    v_mfma_f32_16x16x32_bf16 v[72:75], v[192:195], v[132:135], v[72:75]
    v_mfma_f32_16x16x32_bf16 v[64:67], v[196:199], v[136:139], v[64:67]
    ds_read_b128 v[120:123], v48 offset:128
    v_xor_b32 v48, v60, v4
    v_mfma_f32_16x16x32_bf16 v[68:71], v[200:203], v[136:139], v[68:71]
    v_mfma_f32_16x16x32_bf16 v[72:75], v[204:207], v[136:139], v[72:75]
    s_waitcnt lgkmcnt(2)
    s_barrier
    v_mfma_f32_16x16x32_bf16 v[64:67], v[208:211], v[140:143], v[64:67]
    ds_read_b128 v[124:127], v40 offset:0
    v_mfma_f32_16x16x32_bf16 v[68:71], v[212:215], v[140:143], v[68:71]
    ds_read_b32 v35, v34
    v_mfma_f32_16x16x32_bf16 v[72:75], v[216:219], v[140:143], v[72:75]
    ds_read_b64 v[6:7], v39 offset:49152
    v_mfma_f32_16x16x32_bf16 v[64:67], v[220:223], v[112:115], v[64:67]
    ds_read_b128 v[128:131], v40 offset:64
    v_mfma_f32_16x16x32_bf16 v[68:71], v[224:227], v[112:115], v[68:71]
    ds_read_b64 v[12:13], v39 offset:55296
    v_mfma_f32_16x16x32_bf16 v[72:75], v[228:231], v[112:115], v[72:75]
    s_waitcnt lgkmcnt(5)
    v_mfma_f32_16x16x32_bf16 v[64:67], v[232:235], v[116:119], v[64:67]
    ds_read_b128 v[132:135], v40 offset:128
    v_mfma_f32_16x16x32_bf16 v[68:71], v[236:239], v[116:119], v[68:71]
    v_mfma_f32_16x16x32_bf16 v[72:75], v[240:243], v[116:119], v[72:75]
    s_waitcnt lgkmcnt(3)
    v_readfirstlane_b32 s63, v35
    v_mfma_f32_16x16x32_bf16 v[64:67], v[244:247], v[120:123], v[64:67]
    ds_read_b128 v[136:139], v41 offset:0
    v_mfma_f32_16x16x32_bf16 v[68:71], v[248:251], v[120:123], v[68:71]
    buffer_store_dwordx2 v[6:7], v20, s[20:23], s56 offen sc1
    v_mfma_f32_16x16x32_bf16 v[72:75], v[252:255], v[120:123], v[72:75]
    s_waitcnt lgkmcnt(2)
    v_mfma_f32_16x16x32_bf16 v[76:79], a[0:3], v[124:127], 0
    ds_read_b128 v[140:143], v41 offset:64
    v_mfma_f32_16x16x32_bf16 v[80:83], a[4:7], v[124:127], 0
    v_cvt_pk_bf16_f32 v64, v64, v65
    v_cvt_pk_bf16_f32 v65, v66, v67
    v_mfma_f32_16x16x32_bf16 v[84:87], a[8:11], v[124:127], 0
    buffer_store_dwordx2 v[12:13], v22, s[20:23], s74 offen sc1
    v_cvt_pk_bf16_f32 v66, v68, v69
    v_mfma_f32_16x16x32_bf16 v[76:79], a[12:15], v[128:131], v[76:79]
    ds_read_b128 v[112:115], v41 offset:128
    v_cvt_pk_bf16_f32 v67, v70, v71
    v_mfma_f32_16x16x32_bf16 v[80:83], a[16:19], v[128:131], v[80:83]
    v_permlane16_swap_b32 v64, v66
    v_mfma_f32_16x16x32_bf16 v[84:87], a[20:23], v[128:131], v[84:87]
    s_waitcnt lgkmcnt(2)
    v_permlane16_swap_b32 v65, v67
    v_mfma_f32_16x16x32_bf16 v[76:79], a[24:27], v[132:135], v[76:79]
    ds_read_b128 v[116:119], v42 offset:0
    v_cvt_pk_bf16_f32 v72, v72, v73
    v_mfma_f32_16x16x32_bf16 v[80:83], a[28:31], v[132:135], v[80:83]
    ds_read_b64 v[8:9], v39 offset:51200
    v_cvt_pk_bf16_f32 v73, v74, v75
    v_mfma_f32_16x16x32_bf16 v[84:87], a[32:35], v[132:135], v[84:87]
    ds_write_b64 v38, v[72:73] offset:57344
    v_mfma_f32_16x16x32_bf16 v[76:79], a[36:39], v[136:139], v[76:79]
    ds_read_b128 v[120:123], v42 offset:64
    v_mfma_f32_16x16x32_bf16 v[80:83], a[40:43], v[136:139], v[80:83]
    buffer_store_dwordx4 v[64:67], v21, s[20:23], s75 offen sc1
    v_mfma_f32_16x16x32_bf16 v[84:87], a[44:47], v[136:139], v[84:87]
    s_waitcnt lgkmcnt(4)
    v_mfma_f32_16x16x32_bf16 v[76:79], a[48:51], v[140:143], v[76:79]
    ds_read_b128 v[124:127], v42 offset:128
    v_mfma_f32_16x16x32_bf16 v[80:83], a[52:55], v[140:143], v[80:83]
    v_mfma_f32_16x16x32_bf16 v[84:87], a[56:59], v[140:143], v[84:87]
    s_waitcnt lgkmcnt(2)
    v_mfma_f32_16x16x32_bf16 v[76:79], a[60:63], v[112:115], v[76:79]
    ds_read_b128 v[128:131], v43 offset:0
    v_mfma_f32_16x16x32_bf16 v[80:83], a[64:67], v[112:115], v[80:83]
    buffer_store_dwordx2 v[8:9], v20, s[20:23], s4 offen sc1
    v_mfma_f32_16x16x32_bf16 v[84:87], a[68:71], v[112:115], v[84:87]
    v_mfma_f32_16x16x32_bf16 v[76:79], a[72:75], v[116:119], v[76:79]
    ds_read_b128 v[132:135], v43 offset:64
    v_mfma_f32_16x16x32_bf16 v[80:83], a[76:79], v[116:119], v[80:83]
    v_mfma_f32_16x16x32_bf16 v[84:87], a[80:83], v[116:119], v[84:87]
    s_waitcnt lgkmcnt(2)
    v_mfma_f32_16x16x32_bf16 v[76:79], a[84:87], v[120:123], v[76:79]
    ds_read_b128 v[136:139], v43 offset:128
    v_mfma_f32_16x16x32_bf16 v[80:83], a[88:91], v[120:123], v[80:83]
    v_mfma_f32_16x16x32_bf16 v[84:87], a[92:95], v[120:123], v[84:87]
    v_mfma_f32_16x16x32_bf16 v[76:79], a[96:99], v[124:127], v[76:79]
    ds_read_b128 v[140:143], v44 offset:0
    v_mfma_f32_16x16x32_bf16 v[80:83], a[100:103], v[124:127], v[80:83]
    ds_read_b64 v[10:11], v39 offset:53248
    v_mfma_f32_16x16x32_bf16 v[84:87], a[104:107], v[124:127], v[84:87]
    s_waitcnt lgkmcnt(3)
    v_mfma_f32_16x16x32_bf16 v[76:79], a[108:111], v[128:131], v[76:79]
    ds_read_b128 v[112:115], v44 offset:64
    v_mfma_f32_16x16x32_bf16 v[80:83], a[112:115], v[128:131], v[80:83]
    v_mfma_f32_16x16x32_bf16 v[84:87], a[116:119], v[128:131], v[84:87]
    v_mfma_f32_16x16x32_bf16 v[76:79], a[120:123], v[132:135], v[76:79]
    ds_read_b128 v[116:119], v44 offset:128
    v_mfma_f32_16x16x32_bf16 v[80:83], a[124:127], v[132:135], v[80:83]
    v_mfma_f32_16x16x32_bf16 v[84:87], a[128:131], v[132:135], v[84:87]
    s_waitcnt lgkmcnt(2)
    v_mfma_f32_16x16x32_bf16 v[76:79], a[132:135], v[136:139], v[76:79]
    ds_read_b128 v[120:123], v45 offset:0
    v_mfma_f32_16x16x32_bf16 v[80:83], a[136:139], v[136:139], v[80:83]
    buffer_store_dwordx2 v[10:11], v20, s[20:23], s5 offen sc1
    v_mfma_f32_16x16x32_bf16 v[84:87], a[140:143], v[136:139], v[84:87]
    v_mfma_f32_16x16x32_bf16 v[76:79], a[144:147], v[140:143], v[76:79]
    ds_read_b128 v[124:127], v45 offset:64
    v_mfma_f32_16x16x32_bf16 v[80:83], a[148:151], v[140:143], v[80:83]
    v_mfma_f32_16x16x32_bf16 v[84:87], a[152:155], v[140:143], v[84:87]
    s_waitcnt lgkmcnt(2)
    v_mfma_f32_16x16x32_bf16 v[76:79], a[156:159], v[112:115], v[76:79]
    ds_read_b128 v[128:131], v45 offset:128
    v_mfma_f32_16x16x32_bf16 v[80:83], a[160:163], v[112:115], v[80:83]
    v_mfma_f32_16x16x32_bf16 v[84:87], a[164:167], v[112:115], v[84:87]
    v_mfma_f32_16x16x32_bf16 v[76:79], a[168:171], v[116:119], v[76:79]
    ds_read_b128 v[132:135], v46 offset:0
    v_mfma_f32_16x16x32_bf16 v[80:83], a[172:175], v[116:119], v[80:83]
    v_mfma_f32_16x16x32_bf16 v[84:87], a[176:179], v[116:119], v[84:87]
    s_waitcnt lgkmcnt(2)
    v_mfma_f32_16x16x32_bf16 v[76:79], a[180:183], v[120:123], v[76:79]
    ds_read_b128 v[136:139], v46 offset:64
    v_mfma_f32_16x16x32_bf16 v[80:83], a[184:187], v[120:123], v[80:83]
    v_mfma_f32_16x16x32_bf16 v[84:87], a[188:191], v[120:123], v[84:87]
    v_mfma_f32_16x16x32_bf16 v[76:79], a[192:195], v[124:127], v[76:79]
    ds_read_b128 v[140:143], v46 offset:128
    v_mfma_f32_16x16x32_bf16 v[80:83], a[196:199], v[124:127], v[80:83]
    v_mfma_f32_16x16x32_bf16 v[84:87], a[200:203], v[124:127], v[84:87]
    s_waitcnt lgkmcnt(2)
    v_mfma_f32_16x16x32_bf16 v[76:79], a[204:207], v[128:131], v[76:79]
    ds_read_b128 v[112:115], v47 offset:0
    v_mfma_f32_16x16x32_bf16 v[80:83], a[208:211], v[128:131], v[80:83]
    ds_read_b128 v[116:119], v47 offset:64
    v_mfma_f32_16x16x32_bf16 v[84:87], a[212:215], v[128:131], v[84:87]
    ds_read_b128 v[120:123], v47 offset:128
    v_mfma_f32_16x16x32_bf16 v[76:79], a[216:219], v[132:135], v[76:79]
    ds_read_b128 v[124:127], v48 offset:0
    v_mfma_f32_16x16x32_bf16 v[80:83], a[220:223], v[132:135], v[80:83]
    ds_read_b128 v[128:131], v48 offset:64
    v_mfma_f32_16x16x32_bf16 v[84:87], a[224:227], v[132:135], v[84:87]
    s_waitcnt lgkmcnt(5)
    ds_read_b128 v[132:135], v48 offset:128
    v_mfma_f32_16x16x32_bf16 v[76:79], a[228:231], v[136:139], v[76:79]
    v_mfma_f32_16x16x32_bf16 v[80:83], a[232:235], v[136:139], v[80:83]
    v_mfma_f32_16x16x32_bf16 v[84:87], a[236:239], v[136:139], v[84:87]
    v_mfma_f32_16x16x32_bf16 v[76:79], a[240:243], v[140:143], v[76:79]
    v_mfma_f32_16x16x32_bf16 v[80:83], a[244:247], v[140:143], v[80:83]
    v_mfma_f32_16x16x32_bf16 v[84:87], a[248:251], v[140:143], v[84:87]
    s_waitcnt lgkmcnt(0)
    v_mfma_f32_16x16x32_bf16 v[84:87], v[192:195], v[112:115], v[84:87]
    v_mfma_f32_16x16x32_bf16 v[84:87], v[204:207], v[116:119], v[84:87]
    v_mfma_f32_16x16x32_bf16 v[84:87], v[216:219], v[120:123], v[84:87]
    v_mfma_f32_16x16x32_bf16 v[84:87], v[228:231], v[124:127], v[84:87]
    v_mfma_f32_16x16x32_bf16 v[84:87], v[240:243], v[128:131], v[84:87]
    v_mfma_f32_16x16x32_bf16 v[84:87], v[252:255], v[132:135], v[84:87]
    s_nop 2
    v_mfma_f32_16x16x32_bf16 v[76:79], a[252:255], v[112:115], v[76:79]
    s_nop 2
    v_mfma_f32_16x16x32_bf16 v[76:79], v[196:199], v[116:119], v[76:79]
    v_cvt_pk_bf16_f32 v84, v84, v85
    v_cvt_pk_bf16_f32 v85, v86, v87
    v_mfma_f32_16x16x32_bf16 v[76:79], v[208:211], v[120:123], v[76:79]
    ds_write_b64 v38, v[84:85] offset:59392
    v_mfma_f32_16x16x32_bf16 v[76:79], v[220:223], v[124:127], v[76:79]
    v_mfma_f32_16x16x32_bf16 v[76:79], v[232:235], v[128:131], v[76:79]
    v_mfma_f32_16x16x32_bf16 v[76:79], v[244:247], v[132:135], v[76:79]
    v_mfma_f32_16x16x32_bf16 v[80:83], v[188:191], v[112:115], v[80:83]
    s_waitcnt lgkmcnt(0)
    s_barrier
    v_mfma_f32_16x16x32_bf16 v[80:83], v[200:203], v[116:119], v[80:83]
    ds_read_b64 v[14:15], v39 offset:57344
    v_mfma_f32_16x16x32_bf16 v[80:83], v[212:215], v[120:123], v[80:83]
    ds_read_b64 v[62:63], v39 offset:59392
    v_mfma_f32_16x16x32_bf16 v[80:83], v[224:227], v[124:127], v[80:83]
    v_mfma_f32_16x16x32_bf16 v[80:83], v[236:239], v[128:131], v[80:83]
    v_cvt_pk_bf16_f32 v76, v76, v77
    v_cvt_pk_bf16_f32 v77, v78, v79
    v_mfma_f32_16x16x32_bf16 v[80:83], v[248:251], v[132:135], v[80:83]
    s_waitcnt lgkmcnt(0)
    buffer_store_dwordx2 v[14:15], v22, s[20:23], s75 offen sc1
    buffer_store_dwordx2 v[62:63], v22, s[20:23], s76 offen sc1
    s_nop 4
    v_cvt_pk_bf16_f32 v78, v80, v81
    v_cvt_pk_bf16_f32 v79, v82, v83
    s_nop 0
    v_permlane16_swap_b32 v76, v78
    v_permlane16_swap_b32 v77, v79
    buffer_store_dwordx4 v[76:79], v21, s[20:23], s76 offen sc1
    s_cmp_lg_u32 s63, 0
    s_cbranch_scc1 L_slow
    s_endpgm
L_y_end:
.p2align 6
L_x:
    v_and_b32 v2, 15, v0
    v_lshrrev_b32 v3, 4, v1
    s_movk_i32 s42, 192
    v_mov_b32 v34, 158976
    v_mov_b32 v147, 0
    ds_write_b32 v34, v147
    v_bfe_u32 v144, v1, 2, 2
    v_lshl_add_u32 v144, v3, 3, v144
    v_lshrrev_b32 v145, 2, v1
    v_mul_u32_u24 v144, 192, v144
    v_bfi_b32 v145, 3, v1, v145
    s_lshl_b32 s40, s2, 5
    v_and_b32 v145, 7, v145
    v_lshl_add_u32 v144, v145, 3, v144
    v_xad_u32 v15, v144, s40, 64
    v_lshl_add_u32 v13, s2, 7, v144
    s_mul_i32 s40, s57, 10368
    v_xor_b32 v14, 32, v13
    s_add_u32 s40, s40, 61440
    s_cmp_eq_u32 s80, 10
    s_cselect_b32 s41, 16, 17
    v_add_u32 v144, 2, v2
    v_add_u32 v147, s40, v4
    v_min_u32 v144, s41, v144
    v_lshl_add_u32 v144, v144, 3, 0
    v_bitop3_b32 v145, v144, 32, v147 bitop3:0x6a
    v_mad_u32_u24 v18, v144, 24, v145
    v_lshl_add_u32 v144, v2, 3, 8
    v_bitop3_b32 v145, v144, 32, v147 bitop3:0x6a
    v_mad_u32_u24 v17, v144, 24, v145
    v_lshl_add_u32 v144, v2, 3, 0
    v_bitop3_b32 v145, v144, 32, v147 bitop3:0x6a
    v_mad_u32_u24 v16, v144, 24, v145
    s_mov_b64 exec, 0
    s_cmp_eq_u32 s3, 0
    s_cbranch_scc1 L_pgX0
    s_cmp_eq_u32 s3, 1
    s_cbranch_scc1 L_pgX1
    s_cmp_eq_u32 s3, 2
    s_cbranch_scc1 L_pgX2
L_retX:
L_pgX2:
    s_mov_b64 exec, -1
    s_add_u32 m0, s25, 6912
    s_add_u32 s31, s44, 86016
    buffer_load_dwordx4 v8, s[8:11], s31 offen  lds
    s_add_u32 m0, s25, 17280
    s_add_u32 s31, s44, 215040
    buffer_load_dwordx4 v8, s[8:11], s31 offen  lds
    s_waitcnt vmcnt(9)
    s_barrier
    s_mul_i32 s31, s57, 3456
    s_add_u32 s31, s31, s24
    s_add_u32 m0, s31, 127488
    s_add_u32 s31, s28, 55296
    buffer_load_dwordx4 v5, s[16:19], s31 offen lds
    ds_read_b64_tr_b16 a[0:1], v13 offset:24576
    buffer_load_dwordx4 v6, s[16:19], s31 offen offset:1024 lds
    ds_read_b64_tr_b16 a[2:3], v13 offset:25344
    buffer_load_dwordx4 v7, s[16:19], s31 offen offset:2048 lds
    ds_read_b64_tr_b16 a[4:5], v14 offset:24576
    s_add_u32 m0, s25, 20736
    s_add_u32 s31, s44, 258048
    buffer_load_dwordx4 v8, s[8:11], s31 offen  lds
    ds_read_b64_tr_b16 a[6:7], v14 offset:25344
    s_add_u32 m0, s25, 24192
    s_add_u32 s31, s44, 301056
    buffer_load_dwordx4 v8, s[8:11], s31 offen  lds
    ds_read_b64_tr_b16 a[8:9], v15 offset:24576
    s_add_u32 m0, s24, 49152
    s_add_u32 s31, s28, 61440
    buffer_load_dwordx4 v5, s[16:19], s31 offen lds
    ds_read_b64_tr_b16 a[10:11], v15 offset:25344
    buffer_load_dwordx4 v6, s[16:19], s31 offen offset:1024 lds
    ds_read_b64_tr_b16 a[12:13], v13 offset:30720
    buffer_load_dwordx4 v7, s[16:19], s31 offen offset:2048 lds
    ds_read_b64_tr_b16 a[14:15], v13 offset:31488
    ds_read_b64_tr_b16 a[16:17], v14 offset:30720
    ds_read_b64_tr_b16 a[18:19], v14 offset:31488
    ds_read_b64_tr_b16 a[20:21], v15 offset:30720
    ds_read_b64_tr_b16 a[22:23], v15 offset:31488
    s_waitcnt lgkmcnt(0)
    s_waitcnt vmcnt(10)
    s_barrier
    ds_read_b128 v[112:115], v16 offset:0
    ds_read_b128 v[116:119], v16 offset:3456
    ds_read_b128 v[120:123], v16 offset:64
    ds_read_b128 v[124:127], v16 offset:3520
    s_waitcnt lgkmcnt(3)
    v_mfma_f32_16x16x32_bf16 v[64:67], a[0:3], v[112:115], 0
    s_add_u32 m0, s24, 0
    ds_read_b64_tr_b16 a[24:25], v13 offset:36864
    s_add_u32 s31, s28, 67584
    ds_read_b64_tr_b16 a[26:27], v13 offset:37632
    v_mfma_f32_16x16x32_bf16 v[68:71], a[4:7], v[112:115], 0
    s_mul_i32 s56, s46, 36
    ds_read_b64_tr_b16 a[28:29], v14 offset:36864
    buffer_load_dwordx4 v5, s[16:19], s31 offen lds
    v_mfma_f32_16x16x32_bf16 v[72:75], a[8:11], v[112:115], 0
    s_waitcnt lgkmcnt(5)
    ds_read_b64_tr_b16 a[30:31], v14 offset:37632
    v_add_u32 v61, 127488, v13
    v_mfma_f32_16x16x32_bf16 v[76:79], a[0:3], v[116:119], 0
    s_movk_i32 s5, 7488
    ds_read_b64_tr_b16 a[32:33], v15 offset:36864
    v_add_u32 v62, 127488, v14
    v_mfma_f32_16x16x32_bf16 v[80:83], a[4:7], v[116:119], 0
    s_addk_i32 s56, 215
    ds_read_b64_tr_b16 a[34:35], v15 offset:37632
    v_add_u32 v63, 127488, v15
    v_mfma_f32_16x16x32_bf16 v[84:87], a[8:11], v[116:119], 0
    s_waitcnt lgkmcnt(6)
    ds_read_b128 v[128:131], v16 offset:128
    buffer_load_dwordx4 v6, s[16:19], s31 offen offset:1024 lds
    v_mfma_f32_16x16x32_bf16 v[64:67], a[12:15], v[120:123], v[64:67]
    s_mul_i32 s55, s45, 36
    ds_read_b64_tr_b16 a[36:37], v13 offset:43008
    v_mul_u32_u24 v30, 1821, v0
    v_mfma_f32_16x16x32_bf16 v[68:71], a[16:19], v[120:123], v[68:71]
    s_mul_i32 s40, s57, 6912
    ds_read_b64_tr_b16 a[38:39], v13 offset:43776
    v_lshlrev_b32 v31, 4, v0
    v_mfma_f32_16x16x32_bf16 v[72:75], a[20:23], v[120:123], v[72:75]
    s_mul_i32 s41, s57, 43008
    ds_read_b64_tr_b16 a[40:41], v14 offset:43008
    v_mad_u32_u16 v30, v30, s5, v31 op_sel:[1,0,0,0]
    v_mfma_f32_16x16x32_bf16 v[76:79], a[12:15], v[124:127], v[76:79]
    s_mov_b32 s5, 56448
    ds_read_b128 v[132:135], v16 offset:3584
    buffer_load_dwordx4 v7, s[16:19], s31 offen offset:2048 lds
    v_mfma_f32_16x16x32_bf16 v[80:83], a[16:19], v[124:127], v[80:83]
    s_add_u32 m0, s24, 12288
    ds_read_b64_tr_b16 a[42:43], v14 offset:43776
    v_sub_u32 v32, s56, v0
    v_mfma_f32_16x16x32_bf16 v[84:87], a[20:23], v[124:127], v[84:87]
    s_waitcnt lgkmcnt(5)
    ds_read_b64_tr_b16 a[44:45], v15 offset:43008
    v_add_u32 v31, -252, v32
    v_mfma_f32_16x16x32_bf16 v[64:67], a[24:27], v[128:131], v[64:67]
    s_add_u32 s31, s28, 73728
    ds_read_b64_tr_b16 a[46:47], v15 offset:43776
    v_and_b32 v31, 2.0, v31
    v_mfma_f32_16x16x32_bf16 v[68:71], a[28:31], v[128:131], v[68:71]
    s_add_u32 s41, s44, s41
    ds_read_b128 v[136:139], v17 offset:0
    buffer_load_dwordx4 v5, s[16:19], s31 offen lds
    v_mfma_f32_16x16x32_bf16 v[72:75], a[32:35], v[128:131], v[72:75]
    s_waitcnt lgkmcnt(4)
    ds_read_b128 v[140:143], v17 offset:3456
    v_add3_u32 v31, v30, v31, s5
    v_mfma_f32_16x16x32_bf16 v[76:79], a[24:27], v[132:135], v[76:79]
    s_add_u32 s74, s41, 301248
    v_and_or_b32 v30, v32, 2.0, v30
    v_subrev_u32 v40, s40, v16
    v_mfma_f32_16x16x32_bf16 v[80:83], a[28:31], v[132:135], v[80:83]
    s_add_u32 s75, s41, 387264
    v_subrev_u32 v41, s40, v17
    v_subrev_u32 v42, s40, v18
    v_mfma_f32_16x16x32_bf16 v[84:87], a[32:35], v[132:135], v[84:87]
    s_waitcnt vmcnt(12) lgkmcnt(1)
    s_barrier
    v_mfma_f32_16x16x32_bf16 v[64:67], a[36:39], v[136:139], v[64:67]
    s_add_u32 s76, s41, 473280
    ds_read_b128 v[112:115], v16 offset:6912
    buffer_load_dwordx4 v6, s[16:19], s31 offen offset:1024 lds
    v_mfma_f32_16x16x32_bf16 v[68:71], a[40:43], v[136:139], v[68:71]
    s_add_u32 s77, s41, 559296
    ds_read_b128 v[116:119], v16 offset:6976
    s_mov_b32 s37, 0x3e803e80
    ds_read_b128 v[120:123], v16 offset:7040
    v_mfma_f32_16x16x32_bf16 v[72:75], a[44:47], v[136:139], v[72:75]
    s_waitcnt lgkmcnt(3)
    v_lshrrev_b32 v52, 1, v4
    v_lshl_or_b32 v21, v4, 1, v52
    v_mfma_f32_16x16x32_bf16 v[76:79], a[36:39], v[140:143], v[76:79]
    s_cmp_ge_u32 s45, 47040
    s_cselect_b32 s43, 43008, 0
    ds_read_b128 v[124:127], v17 offset:6912
    v_mfma_f32_16x16x32_bf16 v[80:83], a[40:43], v[140:143], v[80:83]
    buffer_load_dwordx4 v7, s[16:19], s31 offen offset:2048 lds
    v_mfma_f32_16x16x32_bf16 v[84:87], a[44:47], v[140:143], v[84:87]
    s_waitcnt lgkmcnt(3)
    v_and_b32 v21, 48, v21
    v_lshl_add_u32 v21, s2, 7, v21
    v_mfma_f32_16x16x32_bf16 v[88:91], a[0:3], v[112:115], 0
    s_add_u32 m0, s24, 24576
    ds_read_b128 v[128:131], v16 offset:3456
    v_mad_u32_u24 v19, v2, s42, v21
    v_mfma_f32_16x16x32_bf16 v[92:95], a[4:7], v[112:115], 0
    s_add_u32 s31, s28, 24576
    v_lshl_add_u32 v53, s2, 2, v3
    v_lshrrev_b32 v52, 1, v2
    v_mfma_f32_16x16x32_bf16 v[96:99], a[8:11], v[112:115], 0
    s_waitcnt lgkmcnt(2)
    buffer_load_dwordx4 v5, s[16:19], s31 offen lds
    v_mfma_f32_16x16x32_bf16 v[88:91], a[12:15], v[116:119], v[88:91]
    s_sub_u32 s53, s44, s43
    ds_read_b128 v[132:135], v16 offset:6912
    v_bitop3_b32 v52, v52, 6, v53 bitop3:0x6a
    v_mfma_f32_16x16x32_bf16 v[92:95], a[16:19], v[116:119], v[92:95]
    s_mov_b32 s96, 0x7fff7fff
    v_lshl_add_u32 v52, v2, 3, v52
    v_mad_u32_u24 v21, v2, s42, v21
    v_mfma_f32_16x16x32_bf16 v[96:99], a[20:23], v[116:119], v[96:99]
    s_waitcnt vmcnt(11) lgkmcnt(2)
    s_barrier
    v_mfma_f32_16x16x32_bf16 v[88:91], a[24:27], v[120:123], v[88:91]
    s_mov_b32 s60, 0x435f435f
    ds_read_b64_tr_b16 a[108:109], v61 offset:0
    buffer_load_dwordx4 v6, s[16:19], s31 offen offset:1024 lds
    ds_read_b64_tr_b16 a[110:111], v61 offset:768
    ds_read_b64_tr_b16 a[112:113], v62 offset:0
    ds_read_b64_tr_b16 a[114:115], v62 offset:768
    ds_read_b64_tr_b16 a[116:117], v63 offset:0
    ds_read_b64_tr_b16 a[118:119], v63 offset:768
    v_mfma_f32_16x16x32_bf16 v[92:95], a[28:31], v[120:123], v[92:95]
    s_lshl_b32 s4, s57, 10
    ds_read_b64_tr_b16 a[216:217], v61 offset:9600
    s_add_u32 s56, s44, 43200
    ds_read_b64_tr_b16 a[218:219], v61 offset:10368
    v_mfma_f32_16x16x32_bf16 v[96:99], a[32:35], v[120:123], v[96:99]
    ds_read_b64_tr_b16 a[220:221], v62 offset:9600
    v_lshl_add_u32 v38, v52, 3, s4
    v_mfma_f32_16x16x32_bf16 v[88:91], a[36:39], v[124:127], v[88:91]
    s_mul_i32 s4, s57, 129024
    ds_read_b128 v[136:139], v16 offset:10368
    v_lshlrev_b32 v39, 3, v0
    v_mfma_f32_16x16x32_bf16 v[92:95], a[40:43], v[124:127], v[92:95]
    s_add_u32 s56, s56, s4
    ds_read_b64_tr_b16 a[222:223], v62 offset:10368
    buffer_load_dwordx4 v7, s[16:19], s31 offen offset:2048 lds
    v_mfma_f32_16x16x32_bf16 v[96:99], a[44:47], v[124:127], v[96:99]
    s_waitcnt lgkmcnt(5)
    ds_read_b64_tr_b16 a[224:225], v63 offset:9600
    v_lshrrev_b32 v22, 1, v0
    v_mfma_f32_16x16x32_bf16 v[64:67], a[108:111], v[128:131], v[64:67]
    s_add_u32 m0, s24, 36864
    ds_read_b64_tr_b16 a[226:227], v63 offset:10368
    v_bitop3_b32 v22, v22, 48, v39 bitop3:0x6a
    v_mfma_f32_16x16x32_bf16 v[68:71], a[112:115], v[128:131], v[68:71]
    s_add_u32 s31, s26, 135168
    v_bfe_u32 v37, v0, 3, 4
    v_and_or_b32 v22, v22, 56, 64
    v_mfma_f32_16x16x32_bf16 v[72:75], a[116:119], v[128:131], v[72:75]
    buffer_load_dwordx4 v5, s[16:19], s31 offen lds
    v_mfma_f32_16x16x32_bf16 v[76:79], a[108:111], v[132:135], v[76:79]
    s_add_u32 s4, s56, 43008
    v_mad_u32_u24 v20, v37, s42, v22
    v_mad_u32_u24 v22, v37, s42, v22
    v_mfma_f32_16x16x32_bf16 v[80:83], a[112:115], v[132:135], v[80:83]
    s_add_u32 s5, s56, 86016
    v_mfma_f32_16x16x32_bf16 v[84:87], a[116:119], v[132:135], v[84:87]
    s_waitcnt lgkmcnt(1)
    v_mfma_f32_16x16x32_bf16 v[88:91], a[108:111], v[136:139], v[88:91]
    buffer_load_dwordx4 v6, s[16:19], s31 offen offset:1024 lds
    v_mfma_f32_16x16x32_bf16 v[92:95], a[112:115], v[136:139], v[92:95]
    v_mfma_f32_16x16x32_bf16 v[96:99], a[116:119], v[136:139], v[96:99]
    s_waitcnt vmcnt(8) lgkmcnt(0)
    s_barrier
    v_mfma_f32_16x16x32_bf16 v[64:67], a[216:219], v[132:135], v[64:67]
    ds_read_b64_tr_b16 a[120:121], v13 offset:49152
    ds_read_b64_tr_b16 a[122:123], v13 offset:49920
    ds_read_b64_tr_b16 a[124:125], v14 offset:49152
    v_mfma_f32_16x16x32_bf16 v[68:71], a[220:223], v[132:135], v[68:71]
    ds_read_b128 v[140:143], v16 offset:13824
    buffer_load_dwordx4 v7, s[16:19], s31 offen offset:2048 lds
    ds_read_b64_tr_b16 a[126:127], v14 offset:49920
    v_mfma_f32_16x16x32_bf16 v[72:75], a[224:227], v[132:135], v[72:75]
    s_mul_i32 s31, s57, 3456
    ds_read_b64_tr_b16 a[128:129], v15 offset:49152
    s_add_u32 s31, s31, s24
    ds_read_b64_tr_b16 a[130:131], v15 offset:49920
    v_mfma_f32_16x16x32_bf16 v[76:79], a[216:219], v[136:139], v[76:79]
    s_add_u32 m0, s31, 127488
    ds_read_b128 v[112:115], v16 offset:3520
    s_add_u32 s31, s28, 86016
    ds_read_b64_tr_b16 a[228:229], v13 offset:55296
    v_mfma_f32_16x16x32_bf16 v[80:83], a[220:223], v[136:139], v[80:83]
L_pgX0:
  s_cbranch_execz L_retX
    ds_read_b64_tr_b16 a[230:231], v13 offset:56064
    ds_read_b64_tr_b16 a[232:233], v14 offset:55296
    v_mfma_f32_16x16x32_bf16 v[84:87], a[224:227], v[136:139], v[84:87]
    s_waitcnt lgkmcnt(7)
    ds_read_b128 v[116:119], v16 offset:6976
    buffer_load_dwordx4 v5, s[16:19], s31 offen lds
    v_mfma_f32_16x16x32_bf16 v[88:91], a[216:219], v[140:143], v[88:91]
    ds_read_b64_tr_b16 a[234:235], v14 offset:56064
    ds_read_b64_tr_b16 a[236:237], v15 offset:55296
    v_mfma_f32_16x16x32_bf16 v[92:95], a[220:223], v[140:143], v[92:95]
    ds_read_b64_tr_b16 a[238:239], v15 offset:56064
    v_mfma_f32_16x16x32_bf16 v[96:99], a[224:227], v[140:143], v[96:99]
    s_waitcnt lgkmcnt(7)
    ds_read_b128 v[120:123], v16 offset:10432
    v_mfma_f32_16x16x32_bf16 v[64:67], a[120:123], v[112:115], v[64:67]
    ds_read_b64_tr_b16 a[132:133], v13 offset:0
    buffer_load_dwordx4 v6, s[16:19], s31 offen offset:1024 lds
    v_mfma_f32_16x16x32_bf16 v[68:71], a[124:127], v[112:115], v[68:71]
    ds_read_b64_tr_b16 a[134:135], v13 offset:768
    v_mfma_f32_16x16x32_bf16 v[72:75], a[128:131], v[112:115], v[72:75]
    s_waitcnt lgkmcnt(6)
    ds_read_b64_tr_b16 a[136:137], v14 offset:0
    v_mfma_f32_16x16x32_bf16 v[76:79], a[120:123], v[116:119], v[76:79]
    ds_read_b64_tr_b16 a[138:139], v14 offset:768
    v_mfma_f32_16x16x32_bf16 v[80:83], a[124:127], v[116:119], v[80:83]
    ds_read_b64_tr_b16 a[140:141], v15 offset:0
    buffer_load_dwordx4 v7, s[16:19], s31 offen offset:2048 lds
    v_mfma_f32_16x16x32_bf16 v[84:87], a[128:131], v[116:119], v[84:87]
    s_waitcnt lgkmcnt(5)
    ds_read_b64_tr_b16 a[142:143], v15 offset:768
    s_add_u32 m0, s24, 49152
    v_mfma_f32_16x16x32_bf16 v[88:91], a[120:123], v[120:123], v[88:91]
    s_add_u32 s31, s28, 36864
    ds_read_b64_tr_b16 a[240:241], v13 offset:6144
    v_mfma_f32_16x16x32_bf16 v[92:95], a[124:127], v[120:123], v[92:95]
    ds_read_b64_tr_b16 a[242:243], v13 offset:6912
    v_mfma_f32_16x16x32_bf16 v[96:99], a[128:131], v[120:123], v[96:99]
    ds_read_b64_tr_b16 a[244:245], v14 offset:6144
    v_mfma_f32_16x16x32_bf16 v[64:67], a[228:231], v[116:119], v[64:67]
    ds_read_b128 v[124:127], v16 offset:13888
    v_mfma_f32_16x16x32_bf16 v[68:71], a[232:235], v[116:119], v[68:71]
    ds_read_b64_tr_b16 a[246:247], v14 offset:6912
    v_mfma_f32_16x16x32_bf16 v[72:75], a[236:239], v[116:119], v[72:75]
    ds_read_b64_tr_b16 a[248:249], v15 offset:6144
    v_mfma_f32_16x16x32_bf16 v[76:79], a[228:231], v[120:123], v[76:79]
    ds_read_b64_tr_b16 a[250:251], v15 offset:6912
    v_mfma_f32_16x16x32_bf16 v[80:83], a[232:235], v[120:123], v[80:83]
    ds_read_b128 v[128:131], v16 offset:3584
    v_mfma_f32_16x16x32_bf16 v[84:87], a[236:239], v[120:123], v[84:87]
    s_waitcnt lgkmcnt(4)
    ds_read_b128 v[132:135], v16 offset:7040
    v_mfma_f32_16x16x32_bf16 v[88:91], a[228:231], v[124:127], v[88:91]
    ds_read_b128 v[136:139], v16 offset:10496
    v_mfma_f32_16x16x32_bf16 v[92:95], a[232:235], v[124:127], v[92:95]
    v_mfma_f32_16x16x32_bf16 v[96:99], a[236:239], v[124:127], v[96:99]
    s_waitcnt vmcnt(6) lgkmcnt(2)
    s_barrier
    v_mfma_f32_16x16x32_bf16 v[64:67], a[132:135], v[128:131], v[64:67]
    ds_read_b64_tr_b16 a[144:145], v13 offset:12288
    buffer_load_dwordx4 v5, s[16:19], s31 offen lds
    v_mfma_f32_16x16x32_bf16 v[68:71], a[136:139], v[128:131], v[68:71]
    ds_read_b64_tr_b16 a[146:147], v13 offset:13056
    v_mfma_f32_16x16x32_bf16 v[72:75], a[140:143], v[128:131], v[72:75]
    s_waitcnt lgkmcnt(3)
    ds_read_b64_tr_b16 a[148:149], v14 offset:12288
    v_mfma_f32_16x16x32_bf16 v[76:79], a[132:135], v[132:135], v[76:79]
    ds_read_b128 v[140:143], v16 offset:13952
    v_mfma_f32_16x16x32_bf16 v[80:83], a[136:139], v[132:135], v[80:83]
    ds_read_b64_tr_b16 a[150:151], v14 offset:13056
    buffer_load_dwordx4 v6, s[16:19], s31 offen offset:1024 lds
    v_mfma_f32_16x16x32_bf16 v[84:87], a[140:143], v[132:135], v[84:87]
    s_waitcnt lgkmcnt(5)
    ds_read_b64_tr_b16 a[152:153], v15 offset:12288
    v_mfma_f32_16x16x32_bf16 v[88:91], a[132:135], v[136:139], v[88:91]
    ds_read_b64_tr_b16 a[154:155], v15 offset:13056
    v_mfma_f32_16x16x32_bf16 v[92:95], a[136:139], v[136:139], v[92:95]
    ds_read_b128 v[112:115], v17 offset:3456
    v_mfma_f32_16x16x32_bf16 v[96:99], a[140:143], v[136:139], v[96:99]
    ds_read_b64_tr_b16 a[252:253], v13 offset:18432
    buffer_load_dwordx4 v7, s[16:19], s31 offen offset:2048 lds
    v_mfma_f32_16x16x32_bf16 v[64:67], a[240:243], v[132:135], v[64:67]
    s_add_u32 m0, s24, 0
    ds_read_b64_tr_b16 a[254:255], v13 offset:19200
    s_add_u32 s31, s26, 147456
    v_mfma_f32_16x16x32_bf16 v[68:71], a[244:247], v[132:135], v[68:71]
    ds_read_b64_tr_b16 v[188:189], v14 offset:18432
    v_mfma_f32_16x16x32_bf16 v[72:75], a[248:251], v[132:135], v[72:75]
    ds_read_b128 v[116:119], v17 offset:6912
    v_mfma_f32_16x16x32_bf16 v[76:79], a[240:243], v[136:139], v[76:79]
    ds_read_b64_tr_b16 v[190:191], v14 offset:19200
    buffer_load_dwordx4 v5, s[16:19], s31 offen lds
    v_mfma_f32_16x16x32_bf16 v[80:83], a[244:247], v[136:139], v[80:83]
    ds_read_b64_tr_b16 v[192:193], v15 offset:18432
    v_mfma_f32_16x16x32_bf16 v[84:87], a[248:251], v[136:139], v[84:87]
    s_waitcnt lgkmcnt(5)
    ds_read_b64_tr_b16 v[194:195], v15 offset:19200
    v_mfma_f32_16x16x32_bf16 v[88:91], a[240:243], v[140:143], v[88:91]
    ds_read_b128 v[120:123], v17 offset:10368
    v_mfma_f32_16x16x32_bf16 v[92:95], a[244:247], v[140:143], v[92:95]
    buffer_load_dwordx4 v6, s[16:19], s31 offen offset:1024 lds
    v_mfma_f32_16x16x32_bf16 v[96:99], a[248:251], v[140:143], v[96:99]
    ds_read_b64_tr_b16 a[48:49], v13 offset:24576
    v_mfma_f32_16x16x32_bf16 v[64:67], a[144:147], v[112:115], v[64:67]
    ds_read_b64_tr_b16 a[50:51], v13 offset:25344
    v_mfma_f32_16x16x32_bf16 v[68:71], a[148:151], v[112:115], v[68:71]
    ds_read_b64_tr_b16 a[52:53], v14 offset:24576
    v_mfma_f32_16x16x32_bf16 v[72:75], a[152:155], v[112:115], v[72:75]
    s_waitcnt lgkmcnt(4)
    buffer_load_dwordx4 v7, s[16:19], s31 offen offset:2048 lds
    v_mfma_f32_16x16x32_bf16 v[76:79], a[144:147], v[116:119], v[76:79]
    s_add_u32 m0, s24, 12288
    ds_read_b64_tr_b16 a[54:55], v14 offset:25344
    s_add_u32 s31, s28, 98304
    v_mfma_f32_16x16x32_bf16 v[80:83], a[148:151], v[116:119], v[80:83]
    ds_read_b64_tr_b16 a[56:57], v15 offset:24576
    v_mfma_f32_16x16x32_bf16 v[84:87], a[152:155], v[116:119], v[84:87]
    s_waitcnt lgkmcnt(4)
    ds_read_b64_tr_b16 a[58:59], v15 offset:25344
    v_mfma_f32_16x16x32_bf16 v[88:91], a[144:147], v[120:123], v[88:91]
    ds_read_b64_tr_b16 a[156:157], v13 offset:30720
    v_mfma_f32_16x16x32_bf16 v[92:95], a[148:151], v[120:123], v[92:95]
    ds_read_b64_tr_b16 a[158:159], v13 offset:31488
    v_mfma_f32_16x16x32_bf16 v[96:99], a[152:155], v[120:123], v[96:99]
    ds_read_b64_tr_b16 a[160:161], v14 offset:30720
    v_mfma_f32_16x16x32_bf16 v[64:67], a[252:255], v[116:119], v[64:67]
    ds_read_b128 v[124:127], v17 offset:13824
    v_mfma_f32_16x16x32_bf16 v[68:71], v[188:191], v[116:119], v[68:71]
    ds_read_b64_tr_b16 a[162:163], v14 offset:31488
    v_mfma_f32_16x16x32_bf16 v[72:75], v[192:195], v[116:119], v[72:75]
    ds_read_b64_tr_b16 a[164:165], v15 offset:30720
    v_mfma_f32_16x16x32_bf16 v[76:79], a[252:255], v[120:123], v[76:79]
    ds_read_b64_tr_b16 a[166:167], v15 offset:31488
    v_mfma_f32_16x16x32_bf16 v[80:83], v[188:191], v[120:123], v[80:83]
    ds_read_b128 v[128:131], v17 offset:64
    v_mfma_f32_16x16x32_bf16 v[84:87], v[192:195], v[120:123], v[84:87]
    s_waitcnt lgkmcnt(4)
    ds_read_b128 v[132:135], v17 offset:3520
    v_mfma_f32_16x16x32_bf16 v[88:91], a[252:255], v[124:127], v[88:91]
    ds_read_b128 v[136:139], v17 offset:6976
    v_mfma_f32_16x16x32_bf16 v[92:95], v[188:191], v[124:127], v[92:95]
    v_mfma_f32_16x16x32_bf16 v[96:99], v[192:195], v[124:127], v[96:99]
    s_waitcnt vmcnt(6) lgkmcnt(2)
    s_barrier
    v_mfma_f32_16x16x32_bf16 v[64:67], a[48:51], v[128:131], v[64:67]
    buffer_load_dwordx4 v5, s[16:19], s31 offen lds
    v_mfma_f32_16x16x32_bf16 v[68:71], a[52:55], v[128:131], v[68:71]
    ds_read_b64_tr_b16 v[196:197], v13 offset:36864
    v_mfma_f32_16x16x32_bf16 v[72:75], a[56:59], v[128:131], v[72:75]
    s_waitcnt lgkmcnt(2)
    ds_read_b64_tr_b16 v[198:199], v13 offset:37632
    v_mfma_f32_16x16x32_bf16 v[76:79], a[48:51], v[132:135], v[76:79]
    ds_read_b64_tr_b16 v[200:201], v14 offset:36864
    v_mfma_f32_16x16x32_bf16 v[80:83], a[52:55], v[132:135], v[80:83]
    buffer_load_dwordx4 v6, s[16:19], s31 offen offset:1024 lds
    v_mfma_f32_16x16x32_bf16 v[84:87], a[56:59], v[132:135], v[84:87]
    s_waitcnt lgkmcnt(3)
    ds_read_b128 v[140:143], v17 offset:10432
    v_mfma_f32_16x16x32_bf16 v[88:91], a[48:51], v[136:139], v[88:91]
    ds_read_b64_tr_b16 v[202:203], v14 offset:37632
    v_mfma_f32_16x16x32_bf16 v[92:95], a[52:55], v[136:139], v[92:95]
    ds_read_b64_tr_b16 v[204:205], v15 offset:36864
    v_mfma_f32_16x16x32_bf16 v[96:99], a[56:59], v[136:139], v[96:99]
    ds_read_b64_tr_b16 v[206:207], v15 offset:37632
    buffer_load_dwordx4 v7, s[16:19], s31 offen offset:2048 lds
    v_mfma_f32_16x16x32_bf16 v[64:67], a[156:159], v[132:135], v[64:67]
    s_add_u32 m0, s24, 24576
    ds_read_b64_tr_b16 a[60:61], v13 offset:43008
    s_add_u32 s31, s28, 49152
    v_mfma_f32_16x16x32_bf16 v[68:71], a[160:163], v[132:135], v[68:71]
    ds_read_b64_tr_b16 a[62:63], v13 offset:43776
    v_mfma_f32_16x16x32_bf16 v[72:75], a[164:167], v[132:135], v[72:75]
    ds_read_b64_tr_b16 a[64:65], v14 offset:43008
    v_mfma_f32_16x16x32_bf16 v[76:79], a[156:159], v[136:139], v[76:79]
    buffer_load_dwordx4 v5, s[16:19], s31 offen lds
    v_mfma_f32_16x16x32_bf16 v[80:83], a[160:163], v[136:139], v[80:83]
    ds_read_b128 v[112:115], v17 offset:13888
    v_mfma_f32_16x16x32_bf16 v[84:87], a[164:167], v[136:139], v[84:87]
    s_waitcnt lgkmcnt(4)
    ds_read_b64_tr_b16 a[66:67], v14 offset:43776
    v_mfma_f32_16x16x32_bf16 v[88:91], a[156:159], v[140:143], v[88:91]
    ds_read_b64_tr_b16 a[68:69], v15 offset:43008
    v_mfma_f32_16x16x32_bf16 v[92:95], a[160:163], v[140:143], v[92:95]
    ds_read_b64_tr_b16 a[70:71], v15 offset:43776
    buffer_load_dwordx4 v6, s[16:19], s31 offen offset:1024 lds
    v_mfma_f32_16x16x32_bf16 v[96:99], a[164:167], v[140:143], v[96:99]
    ds_read_b128 v[116:119], v17 offset:128
    v_mfma_f32_16x16x32_bf16 v[64:67], v[196:199], v[136:139], v[64:67]
    ds_read_b128 v[120:123], v17 offset:3584
    v_mfma_f32_16x16x32_bf16 v[68:71], v[200:203], v[136:139], v[68:71]
    ds_read_b64_tr_b16 a[168:169], v61 offset:0
    v_mfma_f32_16x16x32_bf16 v[72:75], v[204:207], v[136:139], v[72:75]
    buffer_load_dwordx4 v7, s[16:19], s31 offen offset:2048 lds
    v_mfma_f32_16x16x32_bf16 v[76:79], v[196:199], v[140:143], v[76:79]
    s_lshl_b32 s31, s2, 5
    ds_read_b64_tr_b16 a[170:171], v61 offset:768
    v_xor_b32 v5, s31, v5
    v_mfma_f32_16x16x32_bf16 v[80:83], v[200:203], v[140:143], v[80:83]
    s_lshr_b32 s31, s24, 1
    ds_read_b64_tr_b16 a[172:173], v62 offset:0
    s_add_u32 m0, s31, 36864
    v_mfma_f32_16x16x32_bf16 v[84:87], v[204:207], v[140:143], v[84:87]
    s_waitcnt lgkmcnt(4)
    ds_read_b128 v[124:127], v17 offset:7040
    s_add_u32 s31, s31, 159744
    v_mfma_f32_16x16x32_bf16 v[88:91], v[196:199], v[112:115], v[88:91]
    ds_read_b64_tr_b16 a[174:175], v62 offset:768
    v_mfma_f32_16x16x32_bf16 v[92:95], v[200:203], v[112:115], v[92:95]
    ds_read_b64_tr_b16 a[176:177], v63 offset:0
    v_mfma_f32_16x16x32_bf16 v[96:99], v[204:207], v[112:115], v[96:99]
    ds_read_b64_tr_b16 a[178:179], v63 offset:768
    v_mfma_f32_16x16x32_bf16 v[64:67], a[60:63], v[116:119], v[64:67]
    ds_read_b64_tr_b16 v[208:209], v61 offset:9600
    v_mfma_f32_16x16x32_bf16 v[68:71], a[64:67], v[116:119], v[68:71]
    ds_read_b64_tr_b16 v[210:211], v61 offset:10368
    v_mfma_f32_16x16x32_bf16 v[72:75], a[68:71], v[116:119], v[72:75]
    s_waitcnt lgkmcnt(5)
    ds_read_b64_tr_b16 v[212:213], v62 offset:9600
    v_mfma_f32_16x16x32_bf16 v[76:79], a[60:63], v[120:123], v[76:79]
    ds_read_b128 v[128:131], v17 offset:10496
    v_mfma_f32_16x16x32_bf16 v[80:83], a[64:67], v[120:123], v[80:83]
    ds_read_b64_tr_b16 v[214:215], v62 offset:10368
    v_mfma_f32_16x16x32_bf16 v[84:87], a[68:71], v[120:123], v[84:87]
    ds_read_b64_tr_b16 v[216:217], v63 offset:9600
    v_mfma_f32_16x16x32_bf16 v[88:91], a[60:63], v[124:127], v[88:91]
    ds_read_b64_tr_b16 v[218:219], v63 offset:10368
    v_mfma_f32_16x16x32_bf16 v[92:95], a[64:67], v[124:127], v[92:95]
    v_mfma_f32_16x16x32_bf16 v[96:99], a[68:71], v[124:127], v[96:99]
    s_waitcnt vmcnt(6) lgkmcnt(4)
    s_barrier
    v_mfma_f32_16x16x32_bf16 v[64:67], a[168:171], v[120:123], v[64:67]
    ds_read_b64_tr_b16 a[72:73], v13 offset:49152
    buffer_load_dwordx4 v5, s[16:19], s31 offen lds
    v_mfma_f32_16x16x32_bf16 v[68:71], a[172:175], v[120:123], v[68:71]
    ds_read_b64_tr_b16 a[74:75], v13 offset:49920
    v_mfma_f32_16x16x32_bf16 v[72:75], a[176:179], v[120:123], v[72:75]
    ds_read_b64_tr_b16 a[76:77], v14 offset:49152
    v_mfma_f32_16x16x32_bf16 v[76:79], a[168:171], v[124:127], v[76:79]
    ds_read_b128 v[132:135], v17 offset:13952
    v_mfma_f32_16x16x32_bf16 v[80:83], a[172:175], v[124:127], v[80:83]
    buffer_load_dwordx4 v5, s[16:19], s31 offen offset:512 lds
    v_mfma_f32_16x16x32_bf16 v[84:87], a[176:179], v[124:127], v[84:87]
    s_waitcnt lgkmcnt(4)
    ds_read_b64_tr_b16 a[78:79], v14 offset:49920
    s_add_u32 m0, s25, 27648
    v_mfma_f32_16x16x32_bf16 v[88:91], a[168:171], v[128:131], v[88:91]
    s_add_u32 s31, s44, 344064
    ds_read_b64_tr_b16 a[80:81], v15 offset:49152
    v_mfma_f32_16x16x32_bf16 v[92:95], a[172:175], v[128:131], v[92:95]
    ds_read_b64_tr_b16 a[82:83], v15 offset:49920
    v_mfma_f32_16x16x32_bf16 v[96:99], a[176:179], v[128:131], v[96:99]
    buffer_load_dwordx4 v8, s[8:11], s31 offen  lds
    v_mfma_f32_16x16x32_bf16 v[64:67], v[208:211], v[124:127], v[64:67]
    s_add_u32 m0, s25, 31104
    ds_read_b128 v[136:139], v18 offset:0
    s_add_u32 s31, s44, 387072
    v_mfma_f32_16x16x32_bf16 v[68:71], v[212:215], v[124:127], v[68:71]
    ds_read_b128 v[140:143], v18 offset:3456
    v_mfma_f32_16x16x32_bf16 v[72:75], v[216:219], v[124:127], v[72:75]
    ds_read_b64_tr_b16 a[180:181], v13 offset:55296
    v_mfma_f32_16x16x32_bf16 v[76:79], v[208:211], v[128:131], v[76:79]
    buffer_load_dwordx4 v8, s[8:11], s31 offen  lds
    v_mfma_f32_16x16x32_bf16 v[80:83], v[212:215], v[128:131], v[80:83]
    ds_read_b64_tr_b16 a[182:183], v13 offset:56064
    v_mfma_f32_16x16x32_bf16 v[84:87], v[216:219], v[128:131], v[84:87]
    s_waitcnt lgkmcnt(4)
    ds_read_b64_tr_b16 a[184:185], v14 offset:55296
    v_mfma_f32_16x16x32_bf16 v[88:91], v[208:211], v[132:135], v[88:91]
    ds_read_b128 v[112:115], v18 offset:6912
    v_mfma_f32_16x16x32_bf16 v[92:95], v[212:215], v[132:135], v[92:95]
    ds_read_b64_tr_b16 a[186:187], v14 offset:56064
    v_mfma_f32_16x16x32_bf16 v[96:99], v[216:219], v[132:135], v[96:99]
    s_waitcnt lgkmcnt(4)
    ds_read_b64_tr_b16 a[188:189], v15 offset:55296
    v_mfma_f32_16x16x32_bf16 v[64:67], a[72:75], v[136:139], v[64:67]
    buffer_load_dwordx4 v[180:183], v30, s[12:15], s55 offen
    v_mfma_f32_16x16x32_bf16 v[68:71], a[76:79], v[136:139], v[68:71]
    ds_read_b64_tr_b16 a[190:191], v15 offset:56064
    v_mfma_f32_16x16x32_bf16 v[72:75], a[80:83], v[136:139], v[72:75]
    ds_read_b64_tr_b16 v[220:221], v13 offset:0
    v_mfma_f32_16x16x32_bf16 v[76:79], a[72:75], v[140:143], v[76:79]
    ds_read_b64_tr_b16 v[222:223], v13 offset:768
    v_mfma_f32_16x16x32_bf16 v[80:83], a[76:79], v[140:143], v[80:83]
    buffer_load_dwordx4 v[184:187], v31, s[12:15], s55 offen
    v_mfma_f32_16x16x32_bf16 v[84:87], a[80:83], v[140:143], v[84:87]
    s_waitcnt lgkmcnt(3)
    ds_read_b64_tr_b16 v[224:225], v14 offset:0
    s_add_u32 m0, s25, 34560
    v_mfma_f32_16x16x32_bf16 v[88:91], a[72:75], v[112:115], v[88:91]
    s_add_u32 s31, s44, 430080
    ds_read_b128 v[116:119], v18 offset:10368
    v_mfma_f32_16x16x32_bf16 v[92:95], a[76:79], v[112:115], v[92:95]
    ds_read_b64_tr_b16 v[226:227], v14 offset:768
    v_mfma_f32_16x16x32_bf16 v[96:99], a[80:83], v[112:115], v[96:99]
    s_waitcnt lgkmcnt(4)
    buffer_load_dwordx4 v8, s[8:11], s31 offen  lds
    v_mfma_f32_16x16x32_bf16 v[64:67], a[180:183], v[140:143], v[64:67]
    s_add_u32 m0, s25, 38016
    ds_read_b64_tr_b16 v[228:229], v15 offset:0
    s_add_u32 s31, s44, 473088
    v_mfma_f32_16x16x32_bf16 v[68:71], a[184:187], v[140:143], v[68:71]
    ds_read_b64_tr_b16 v[230:231], v15 offset:768
    v_mfma_f32_16x16x32_bf16 v[72:75], a[188:191], v[140:143], v[72:75]
    ds_read_b64_tr_b16 a[84:85], v13 offset:6144
    v_mfma_f32_16x16x32_bf16 v[76:79], a[180:183], v[112:115], v[76:79]
    buffer_load_dwordx4 v8, s[8:11], s31 offen  lds
    v_mfma_f32_16x16x32_bf16 v[80:83], a[184:187], v[112:115], v[80:83]
    s_add_u32 m0, s25, 41472
    ds_read_b64_tr_b16 a[86:87], v13 offset:6912
    s_add_u32 s31, s44, 516096
    v_mfma_f32_16x16x32_bf16 v[84:87], a[188:191], v[112:115], v[84:87]
    s_waitcnt lgkmcnt(4)
    ds_read_b64_tr_b16 a[88:89], v14 offset:6144
    v_mfma_f32_16x16x32_bf16 v[88:91], a[180:183], v[116:119], v[88:91]
    ds_read_b128 v[120:123], v18 offset:13824
    v_mfma_f32_16x16x32_bf16 v[92:95], a[184:187], v[116:119], v[92:95]
    ds_read_b64_tr_b16 a[90:91], v14 offset:6912
    v_mfma_f32_16x16x32_bf16 v[96:99], a[188:191], v[116:119], v[96:99]
    s_waitcnt vmcnt(8) lgkmcnt(4)
    s_barrier
    v_mfma_f32_16x16x32_bf16 v[64:67], v[220:223], v[112:115], v[64:67]
    buffer_load_dwordx4 v8, s[8:11], s31 offen  lds
    v_mfma_f32_16x16x32_bf16 v[68:71], v[224:227], v[112:115], v[68:71]
    s_add_u32 m0, s25, 44928
    ds_read_b64_tr_b16 a[92:93], v15 offset:6144
    s_add_u32 s31, s44, 559104
    v_mfma_f32_16x16x32_bf16 v[72:75], v[228:231], v[112:115], v[72:75]
    ds_read_b64_tr_b16 a[94:95], v15 offset:6912
    v_mfma_f32_16x16x32_bf16 v[76:79], v[220:223], v[116:119], v[76:79]
    ds_read_b128 v[124:127], v18 offset:64
    v_mfma_f32_16x16x32_bf16 v[80:83], v[224:227], v[116:119], v[80:83]
    buffer_load_dwordx4 v8, s[8:11], s31 offen  lds
    v_mfma_f32_16x16x32_bf16 v[84:87], v[228:231], v[116:119], v[84:87]
    s_waitcnt lgkmcnt(3)
    ds_read_b128 v[128:131], v18 offset:3520
    s_add_u32 m0, s25, 48384
    v_mfma_f32_16x16x32_bf16 v[88:91], v[220:223], v[120:123], v[88:91]
    s_add_u32 s31, s44, 602112
    ds_read_b64_tr_b16 a[192:193], v13 offset:12288
    v_mfma_f32_16x16x32_bf16 v[92:95], v[224:227], v[120:123], v[92:95]
    ds_read_b64_tr_b16 a[194:195], v13 offset:13056
    v_mfma_f32_16x16x32_bf16 v[96:99], v[228:231], v[120:123], v[96:99]
    s_waitcnt lgkmcnt(3)
    ds_read_b64_tr_b16 a[196:197], v14 offset:12288
    v_mfma_f32_16x16x32_bf16 v[64:67], a[84:87], v[124:127], v[64:67]
    ds_read_b128 v[132:135], v18 offset:6976
    v_mfma_f32_16x16x32_bf16 v[68:71], a[88:91], v[124:127], v[68:71]
    ds_read_b64_tr_b16 a[198:199], v14 offset:13056
    v_mfma_f32_16x16x32_bf16 v[72:75], a[92:95], v[124:127], v[72:75]
    s_waitcnt lgkmcnt(5)
    ds_read_b64_tr_b16 a[200:201], v15 offset:12288
    v_mfma_f32_16x16x32_bf16 v[76:79], a[84:87], v[128:131], v[76:79]
    ds_read_b64_tr_b16 a[202:203], v15 offset:13056
    v_mfma_f32_16x16x32_bf16 v[80:83], a[88:91], v[128:131], v[80:83]
    ds_read_b64_tr_b16 v[232:233], v13 offset:18432
    v_mfma_f32_16x16x32_bf16 v[84:87], a[92:95], v[128:131], v[84:87]
    s_waitcnt lgkmcnt(4)
    ds_read_b64_tr_b16 v[234:235], v13 offset:19200
    v_mfma_f32_16x16x32_bf16 v[88:91], a[84:87], v[132:135], v[88:91]
    ds_read_b64_tr_b16 v[236:237], v14 offset:18432
    v_mfma_f32_16x16x32_bf16 v[92:95], a[88:91], v[132:135], v[92:95]
    ds_read_b128 v[136:139], v18 offset:10432
    v_mfma_f32_16x16x32_bf16 v[96:99], a[92:95], v[132:135], v[96:99]
    s_waitcnt lgkmcnt(4)
    ds_read_b64_tr_b16 v[238:239], v14 offset:19200
    v_mfma_f32_16x16x32_bf16 v[64:67], a[192:195], v[128:131], v[64:67]
    buffer_load_dwordx4 v8, s[8:11], s31 offen  lds
    v_mfma_f32_16x16x32_bf16 v[68:71], a[196:199], v[128:131], v[68:71]
    s_add_u32 m0, s25, 51840
    ds_read_b64_tr_b16 v[240:241], v15 offset:18432
    s_add_u32 s31, s53, 645120
    v_mfma_f32_16x16x32_bf16 v[72:75], a[200:203], v[128:131], v[72:75]
    ds_read_b64_tr_b16 v[242:243], v15 offset:19200
    v_mfma_f32_16x16x32_bf16 v[76:79], a[192:195], v[132:135], v[76:79]
    ds_read_b64_tr_b16 a[96:97], v13 offset:24576
    v_mfma_f32_16x16x32_bf16 v[80:83], a[196:199], v[132:135], v[80:83]
    buffer_load_dwordx4 v8, s[8:11], s31 offen  lds
    v_mfma_f32_16x16x32_bf16 v[84:87], a[200:203], v[132:135], v[84:87]
    s_waitcnt lgkmcnt(3)
    ds_read_b64_tr_b16 a[98:99], v13 offset:25344
    v_mfma_f32_16x16x32_bf16 v[88:91], a[192:195], v[136:139], v[88:91]
    ds_read_b64_tr_b16 a[100:101], v14 offset:24576
    v_mfma_f32_16x16x32_bf16 v[92:95], a[196:199], v[136:139], v[92:95]
    ds_read_b128 v[140:143], v18 offset:13888
    v_mfma_f32_16x16x32_bf16 v[96:99], a[200:203], v[136:139], v[96:99]
    s_waitcnt lgkmcnt(4)
    ds_read_b64_tr_b16 a[102:103], v14 offset:25344
    v_mfma_f32_16x16x32_bf16 v[64:67], v[232:235], v[132:135], v[64:67]
    ds_read_b64_tr_b16 a[104:105], v15 offset:24576
    v_mfma_f32_16x16x32_bf16 v[68:71], v[236:239], v[132:135], v[68:71]
    ds_read_b64_tr_b16 a[106:107], v15 offset:25344
    v_mfma_f32_16x16x32_bf16 v[72:75], v[240:243], v[132:135], v[72:75]
    ds_read_b128 v[112:115], v18 offset:128
    v_mfma_f32_16x16x32_bf16 v[76:79], v[232:235], v[136:139], v[76:79]
    ds_read_b64_tr_b16 a[204:205], v13 offset:30720
    v_mfma_f32_16x16x32_bf16 v[80:83], v[236:239], v[136:139], v[80:83]
    ds_read_b128 v[116:119], v18 offset:3584
    v_mfma_f32_16x16x32_bf16 v[84:87], v[240:243], v[136:139], v[84:87]
    s_waitcnt lgkmcnt(5)
    ds_read_b64_tr_b16 a[206:207], v13 offset:31488
    v_mfma_f32_16x16x32_bf16 v[88:91], v[232:235], v[140:143], v[88:91]
    ds_read_b64_tr_b16 a[208:209], v14 offset:30720
    v_mfma_f32_16x16x32_bf16 v[92:95], v[236:239], v[140:143], v[92:95]
    ds_read_b128 v[120:123], v18 offset:7040
    v_mfma_f32_16x16x32_bf16 v[96:99], v[240:243], v[140:143], v[96:99]
    s_waitcnt vmcnt(9) lgkmcnt(5)
    s_barrier
    v_mfma_f32_16x16x32_bf16 v[64:67], a[96:99], v[112:115], v[64:67]
    ds_read_b64_tr_b16 a[210:211], v14 offset:31488
    v_mfma_f32_16x16x32_bf16 v[68:71], a[100:103], v[112:115], v[68:71]
    ds_read_b64_tr_b16 a[212:213], v15 offset:30720
    v_mfma_f32_16x16x32_bf16 v[72:75], a[104:107], v[112:115], v[72:75]
    s_waitcnt lgkmcnt(4)
    ds_read_b64_tr_b16 a[214:215], v15 offset:31488
    v_mfma_f32_16x16x32_bf16 v[76:79], a[96:99], v[116:119], v[76:79]
    ds_read_b64_tr_b16 v[244:245], v13 offset:36864
    v_mfma_f32_16x16x32_bf16 v[80:83], a[100:103], v[116:119], v[80:83]
    ds_read_b64_tr_b16 v[246:247], v13 offset:37632
    v_mfma_f32_16x16x32_bf16 v[84:87], a[104:107], v[116:119], v[84:87]
    s_waitcnt lgkmcnt(5)
    ds_read_b64_tr_b16 v[248:249], v14 offset:36864
    v_mfma_f32_16x16x32_bf16 v[88:91], a[96:99], v[120:123], v[88:91]
    ds_read_b128 v[124:127], v18 offset:10496
    v_mfma_f32_16x16x32_bf16 v[92:95], a[100:103], v[120:123], v[92:95]
    ds_read_b64_tr_b16 v[250:251], v14 offset:37632
    v_mfma_f32_16x16x32_bf16 v[96:99], a[104:107], v[120:123], v[96:99]
    s_waitcnt lgkmcnt(5)
    ds_read_b64_tr_b16 v[252:253], v15 offset:36864
    v_mfma_f32_16x16x32_bf16 v[64:67], a[204:207], v[116:119], v[64:67]
    ds_read_b64_tr_b16 v[254:255], v15 offset:37632
    v_mfma_f32_16x16x32_bf16 v[68:71], a[208:211], v[116:119], v[68:71]
    v_mfma_f32_16x16x32_bf16 v[72:75], a[212:215], v[116:119], v[72:75]
    v_mfma_f32_16x16x32_bf16 v[76:79], a[204:207], v[120:123], v[76:79]
    ds_read_b128 v[128:131], v18 offset:13952
    v_mfma_f32_16x16x32_bf16 v[80:83], a[208:211], v[120:123], v[80:83]
    v_mfma_f32_16x16x32_bf16 v[84:87], a[212:215], v[120:123], v[84:87]
    s_waitcnt lgkmcnt(2)
    v_mfma_f32_16x16x32_bf16 v[88:91], a[204:207], v[124:127], v[88:91]
    ds_read_b128 v[132:135], v40 offset:20736
    v_mfma_f32_16x16x32_bf16 v[92:95], a[208:211], v[124:127], v[92:95]
    v_mfma_f32_16x16x32_bf16 v[96:99], a[212:215], v[124:127], v[96:99]
    s_waitcnt lgkmcnt(2)
    v_mfma_f32_16x16x32_bf16 v[64:67], v[244:247], v[120:123], v[64:67]
    ds_read_b128 v[136:139], v40 offset:20800
    v_mfma_f32_16x16x32_bf16 v[68:71], v[248:251], v[120:123], v[68:71]
    v_mfma_f32_16x16x32_bf16 v[72:75], v[252:255], v[120:123], v[72:75]
    v_mfma_f32_16x16x32_bf16 v[76:79], v[244:247], v[124:127], v[76:79]
    ds_read_b128 v[140:143], v40 offset:20864
    v_mfma_f32_16x16x32_bf16 v[80:83], v[248:251], v[124:127], v[80:83]
    v_mfma_f32_16x16x32_bf16 v[84:87], v[252:255], v[124:127], v[84:87]
    s_waitcnt lgkmcnt(2)
    v_mfma_f32_16x16x32_bf16 v[88:91], v[244:247], v[128:131], v[88:91]
    ds_read_b128 v[112:115], v41 offset:20736
    v_mfma_f32_16x16x32_bf16 v[92:95], v[248:251], v[128:131], v[92:95]
    v_mfma_f32_16x16x32_bf16 v[96:99], v[252:255], v[128:131], v[96:99]
    v_mfma_f32_16x16x32_bf16 v[100:103], a[0:3], v[132:135], 0
    ds_read_b128 v[116:119], v41 offset:20800
    v_cvt_pk_bf16_f32 v72, v72, v73
    v_mfma_f32_16x16x32_bf16 v[104:107], a[4:7], v[132:135], 0
    v_cvt_pk_bf16_f32 v73, v74, v75
    v_cvt_pk_bf16_f32 v84, v84, v85
    v_mfma_f32_16x16x32_bf16 v[108:111], a[8:11], v[132:135], 0
    s_waitcnt lgkmcnt(2)
    ds_write_b64 v38, v[72:73] offset:0
    v_mfma_f32_16x16x32_bf16 v[100:103], a[12:15], v[136:139], v[100:103]
    ds_read_b128 v[120:123], v41 offset:20864
    v_mfma_f32_16x16x32_bf16 v[104:107], a[16:19], v[136:139], v[104:107]
    v_cvt_pk_bf16_f32 v85, v86, v87
    v_cvt_pk_bf16_f32 v96, v96, v97
    v_mfma_f32_16x16x32_bf16 v[108:111], a[20:23], v[136:139], v[108:111]
    ds_write_b64 v38, v[84:85] offset:2048
    v_mfma_f32_16x16x32_bf16 v[100:103], a[24:27], v[140:143], v[100:103]
    ds_read_b128 v[124:127], v42 offset:20736
    v_mfma_f32_16x16x32_bf16 v[104:107], a[28:31], v[140:143], v[104:107]
    v_cvt_pk_bf16_f32 v97, v98, v99
    v_cvt_pk_bf16_f32 v64, v64, v65
    v_mfma_f32_16x16x32_bf16 v[108:111], a[32:35], v[140:143], v[108:111]
    s_waitcnt lgkmcnt(3)
    ds_write_b64 v38, v[96:97] offset:4096
    v_mfma_f32_16x16x32_bf16 v[100:103], a[36:39], v[112:115], v[100:103]
    ds_read_b128 v[128:131], v42 offset:20800
    v_mfma_f32_16x16x32_bf16 v[104:107], a[40:43], v[112:115], v[104:107]
    v_cvt_pk_bf16_f32 v65, v66, v67
    v_cvt_pk_bf16_f32 v66, v68, v69
    v_mfma_f32_16x16x32_bf16 v[108:111], a[44:47], v[112:115], v[108:111]
    v_cvt_pk_bf16_f32 v67, v70, v71
    v_cvt_pk_bf16_f32 v76, v76, v77
    v_mfma_f32_16x16x32_bf16 v[100:103], a[48:51], v[116:119], v[100:103]
    ds_read_b128 v[132:135], v42 offset:20864
    v_cvt_pk_bf16_f32 v77, v78, v79
    v_mfma_f32_16x16x32_bf16 v[104:107], a[52:55], v[116:119], v[104:107]
    v_permlane16_swap_b32 v64, v66
    v_mfma_f32_16x16x32_bf16 v[108:111], a[56:59], v[116:119], v[108:111]
    s_waitcnt lgkmcnt(2)
    v_permlane16_swap_b32 v65, v67
    v_mfma_f32_16x16x32_bf16 v[100:103], a[60:63], v[120:123], v[100:103]
    ds_read_b128 v[136:139], v40 offset:24192
    v_cvt_pk_bf16_f32 v78, v80, v81
    v_mfma_f32_16x16x32_bf16 v[104:107], a[64:67], v[120:123], v[104:107]
    buffer_store_dwordx4 v[64:67], v19, s[20:23], s56 offen sc1
    v_cvt_pk_bf16_f32 v79, v82, v83
    v_cvt_pk_bf16_f32 v88, v88, v89
    v_cvt_pk_bf16_f32 v89, v90, v91
    v_mfma_f32_16x16x32_bf16 v[108:111], a[68:71], v[120:123], v[108:111]
    v_permlane16_swap_b32 v76, v78
    v_mfma_f32_16x16x32_bf16 v[100:103], a[72:75], v[124:127], v[100:103]
    ds_read_b128 v[140:143], v40 offset:24256
    v_cvt_pk_bf16_f32 v90, v92, v93
    v_mfma_f32_16x16x32_bf16 v[104:107], a[76:79], v[124:127], v[104:107]
    v_permlane16_swap_b32 v77, v79
    v_mfma_f32_16x16x32_bf16 v[108:111], a[80:83], v[124:127], v[108:111]
    s_waitcnt lgkmcnt(2)
    v_permlane16_swap_b32 v88, v90
    v_mfma_f32_16x16x32_bf16 v[100:103], a[84:87], v[128:131], v[100:103]
    ds_read_b128 v[112:115], v40 offset:24320
    v_cvt_pk_bf16_f32 v91, v94, v95
    v_mfma_f32_16x16x32_bf16 v[104:107], a[88:91], v[128:131], v[104:107]
    buffer_store_dwordx4 v[76:79], v19, s[20:23], s4 offen sc1
    v_mfma_f32_16x16x32_bf16 v[108:111], a[92:95], v[128:131], v[108:111]
    v_permlane16_swap_b32 v89, v91
    v_mfma_f32_16x16x32_bf16 v[100:103], a[96:99], v[132:135], v[100:103]
    ds_read_b128 v[116:119], v41 offset:24192
    v_mfma_f32_16x16x32_bf16 v[104:107], a[100:103], v[132:135], v[104:107]
    v_mfma_f32_16x16x32_bf16 v[108:111], a[104:107], v[132:135], v[108:111]
    s_waitcnt lgkmcnt(2)
    v_mfma_f32_16x16x32_bf16 v[100:103], a[108:111], v[136:139], v[100:103]
    ds_read_b128 v[120:123], v41 offset:24256
    v_mfma_f32_16x16x32_bf16 v[104:107], a[112:115], v[136:139], v[104:107]
    v_mfma_f32_16x16x32_bf16 v[108:111], a[116:119], v[136:139], v[108:111]
    s_waitcnt vmcnt(5) lgkmcnt(2)
    s_barrier
    v_mfma_f32_16x16x32_bf16 v[100:103], a[120:123], v[140:143], v[100:103]
    ds_read_b128 v[124:127], v41 offset:24320
    v_mfma_f32_16x16x32_bf16 v[104:107], a[124:127], v[140:143], v[104:107]
    ds_read_b64 v[6:7], v39 offset:0
    v_mfma_f32_16x16x32_bf16 v[108:111], a[128:131], v[140:143], v[108:111]
    v_mfma_f32_16x16x32_bf16 v[100:103], a[132:135], v[112:115], v[100:103]
    ds_read_b128 v[128:131], v42 offset:24192
    v_mfma_f32_16x16x32_bf16 v[104:107], a[136:139], v[112:115], v[104:107]
    v_mfma_f32_16x16x32_bf16 v[108:111], a[140:143], v[112:115], v[108:111]
L_pgX1:
  s_cbranch_execz L_retX
    s_waitcnt lgkmcnt(3)
    v_mfma_f32_16x16x32_bf16 v[100:103], a[144:147], v[116:119], v[100:103]
    ds_read_b128 v[132:135], v42 offset:24256
    v_mfma_f32_16x16x32_bf16 v[104:107], a[148:151], v[116:119], v[104:107]
    buffer_store_dwordx4 v[88:91], v19, s[20:23], s5 offen sc1
    v_mfma_f32_16x16x32_bf16 v[108:111], a[152:155], v[116:119], v[108:111]
    s_waitcnt lgkmcnt(2)
    v_mfma_f32_16x16x32_bf16 v[100:103], a[156:159], v[120:123], v[100:103]
    ds_read_b128 v[136:139], v42 offset:24320
    v_mfma_f32_16x16x32_bf16 v[104:107], a[160:163], v[120:123], v[104:107]
    v_mfma_f32_16x16x32_bf16 v[108:111], a[164:167], v[120:123], v[108:111]
    buffer_store_dwordx2 v[6:7], v20, s[20:23], s56 offen sc1
    v_mfma_f32_16x16x32_bf16 v[100:103], a[168:171], v[124:127], v[100:103]
    ds_read_b128 v[140:143], v40 offset:27648
    v_mfma_f32_16x16x32_bf16 v[104:107], a[172:175], v[124:127], v[104:107]
    v_mfma_f32_16x16x32_bf16 v[108:111], a[176:179], v[124:127], v[108:111]
    s_waitcnt lgkmcnt(2)
    v_mfma_f32_16x16x32_bf16 v[100:103], a[180:183], v[128:131], v[100:103]
    ds_read_b128 v[112:115], v40 offset:27712
    v_mfma_f32_16x16x32_bf16 v[104:107], a[184:187], v[128:131], v[104:107]
    v_mfma_f32_16x16x32_bf16 v[108:111], a[188:191], v[128:131], v[108:111]
    v_mfma_f32_16x16x32_bf16 v[100:103], a[192:195], v[132:135], v[100:103]
    ds_read_b128 v[116:119], v40 offset:27776
    v_mfma_f32_16x16x32_bf16 v[104:107], a[196:199], v[132:135], v[104:107]
    ds_read_b64 v[8:9], v39 offset:2048
    v_mfma_f32_16x16x32_bf16 v[108:111], a[200:203], v[132:135], v[108:111]
    s_waitcnt lgkmcnt(3)
    v_mfma_f32_16x16x32_bf16 v[100:103], a[204:207], v[136:139], v[100:103]
    ds_read_b128 v[120:123], v41 offset:27648
    v_mfma_f32_16x16x32_bf16 v[104:107], a[208:211], v[136:139], v[104:107]
    v_mfma_f32_16x16x32_bf16 v[108:111], a[212:215], v[136:139], v[108:111]
    v_mfma_f32_16x16x32_bf16 v[100:103], a[216:219], v[140:143], v[100:103]
    ds_read_b128 v[124:127], v41 offset:27712
    v_mfma_f32_16x16x32_bf16 v[104:107], a[220:223], v[140:143], v[104:107]
    v_mfma_f32_16x16x32_bf16 v[108:111], a[224:227], v[140:143], v[108:111]
    s_waitcnt lgkmcnt(2)
    v_mfma_f32_16x16x32_bf16 v[100:103], a[228:231], v[112:115], v[100:103]
    ds_read_b128 v[128:131], v41 offset:27776
    v_mfma_f32_16x16x32_bf16 v[104:107], a[232:235], v[112:115], v[104:107]
    buffer_store_dwordx2 v[8:9], v20, s[20:23], s4 offen sc1
    v_mfma_f32_16x16x32_bf16 v[108:111], a[236:239], v[112:115], v[108:111]
    v_mfma_f32_16x16x32_bf16 v[100:103], a[240:243], v[116:119], v[100:103]
    ds_read_b128 v[132:135], v42 offset:27648
    v_mfma_f32_16x16x32_bf16 v[104:107], a[244:247], v[116:119], v[104:107]
    v_mfma_f32_16x16x32_bf16 v[108:111], a[248:251], v[116:119], v[108:111]
    s_waitcnt lgkmcnt(2)
    v_mfma_f32_16x16x32_bf16 v[100:103], a[252:255], v[120:123], v[100:103]
    ds_read_b128 v[136:139], v42 offset:27712
    v_mfma_f32_16x16x32_bf16 v[104:107], v[188:191], v[120:123], v[104:107]
    v_mfma_f32_16x16x32_bf16 v[108:111], v[192:195], v[120:123], v[108:111]
    v_mfma_f32_16x16x32_bf16 v[100:103], v[196:199], v[124:127], v[100:103]
    ds_read_b128 v[140:143], v42 offset:27776
    v_mfma_f32_16x16x32_bf16 v[104:107], v[200:203], v[124:127], v[104:107]
    ds_read_b64 v[10:11], v39 offset:4096
    v_mfma_f32_16x16x32_bf16 v[108:111], v[204:207], v[124:127], v[108:111]
    s_waitcnt lgkmcnt(3)
    v_mfma_f32_16x16x32_bf16 v[100:103], v[208:211], v[128:131], v[100:103]
    ds_read_b128 v[112:115], v40 offset:27648
    v_mfma_f32_16x16x32_bf16 v[104:107], v[212:215], v[128:131], v[104:107]
    v_mfma_f32_16x16x32_bf16 v[108:111], v[216:219], v[128:131], v[108:111]
    v_mfma_f32_16x16x32_bf16 v[100:103], v[220:223], v[132:135], v[100:103]
    ds_read_b128 v[116:119], v40 offset:27712
    v_mfma_f32_16x16x32_bf16 v[104:107], v[224:227], v[132:135], v[104:107]
    v_mfma_f32_16x16x32_bf16 v[108:111], v[228:231], v[132:135], v[108:111]
    s_waitcnt lgkmcnt(2)
    v_mfma_f32_16x16x32_bf16 v[100:103], v[232:235], v[136:139], v[100:103]
    ds_read_b128 v[120:123], v40 offset:27776
    v_mfma_f32_16x16x32_bf16 v[104:107], v[236:239], v[136:139], v[104:107]
    buffer_store_dwordx2 v[10:11], v20, s[20:23], s5 offen sc1
    v_mfma_f32_16x16x32_bf16 v[108:111], v[240:243], v[136:139], v[108:111]
    v_mfma_f32_16x16x32_bf16 v[100:103], v[244:247], v[140:143], v[100:103]
    ds_read_b128 v[124:127], v41 offset:27648
    v_mfma_f32_16x16x32_bf16 v[104:107], v[248:251], v[140:143], v[104:107]
    v_mfma_f32_16x16x32_bf16 v[108:111], v[252:255], v[140:143], v[108:111]
    s_waitcnt lgkmcnt(2)
    v_mfma_f32_16x16x32_bf16 v[64:67], a[0:3], v[112:115], 0
    ds_read_b128 v[128:131], v41 offset:27712
    v_mfma_f32_16x16x32_bf16 v[68:71], a[4:7], v[112:115], 0
    v_mfma_f32_16x16x32_bf16 v[72:75], a[8:11], v[112:115], 0
    v_cvt_pk_bf16_f32 v100, v100, v101
    v_cvt_pk_bf16_f32 v101, v102, v103
    v_mfma_f32_16x16x32_bf16 v[64:67], a[12:15], v[116:119], v[64:67]
    ds_read_b128 v[132:135], v41 offset:27776
    v_cvt_pk_bf16_f32 v108, v108, v109
    v_mfma_f32_16x16x32_bf16 v[68:71], a[16:19], v[116:119], v[68:71]
    v_cvt_pk_bf16_f32 v109, v110, v111
    v_cvt_pk_bf16_f32 v102, v104, v105
    v_mfma_f32_16x16x32_bf16 v[72:75], a[20:23], v[116:119], v[72:75]
    s_waitcnt lgkmcnt(2)
    ds_write_b64 v38, v[108:109] offset:6144
    v_mfma_f32_16x16x32_bf16 v[64:67], a[24:27], v[120:123], v[64:67]
    ds_read_b128 v[136:139], v42 offset:27648
    v_mfma_f32_16x16x32_bf16 v[68:71], a[28:31], v[120:123], v[68:71]
    v_permlane16_swap_b32 v100, v102
    v_mfma_f32_16x16x32_bf16 v[72:75], a[32:35], v[120:123], v[72:75]
    v_cvt_pk_bf16_f32 v103, v106, v107
    v_mfma_f32_16x16x32_bf16 v[64:67], a[36:39], v[124:127], v[64:67]
    ds_read_b128 v[140:143], v42 offset:27712
    v_mfma_f32_16x16x32_bf16 v[68:71], a[40:43], v[124:127], v[68:71]
    v_permlane16_swap_b32 v101, v103
    v_mfma_f32_16x16x32_bf16 v[72:75], a[44:47], v[124:127], v[72:75]
    s_waitcnt lgkmcnt(2)
    v_mfma_f32_16x16x32_bf16 v[64:67], a[48:51], v[128:131], v[64:67]
    ds_read_b128 v[112:115], v42 offset:27776
    v_mfma_f32_16x16x32_bf16 v[68:71], a[52:55], v[128:131], v[68:71]
    buffer_store_dwordx4 v[100:103], v21, s[20:23], s74 offen sc1
    v_mfma_f32_16x16x32_bf16 v[72:75], a[56:59], v[128:131], v[72:75]
    v_mfma_f32_16x16x32_bf16 v[64:67], a[60:63], v[132:135], v[64:67]
    ds_read_b128 v[116:119], v40 offset:31104
    v_mfma_f32_16x16x32_bf16 v[68:71], a[64:67], v[132:135], v[68:71]
    v_mfma_f32_16x16x32_bf16 v[72:75], a[68:71], v[132:135], v[72:75]
    s_waitcnt lgkmcnt(2)
    v_mfma_f32_16x16x32_bf16 v[64:67], a[72:75], v[136:139], v[64:67]
    ds_read_b128 v[120:123], v40 offset:31168
    v_mfma_f32_16x16x32_bf16 v[68:71], a[76:79], v[136:139], v[68:71]
    v_mfma_f32_16x16x32_bf16 v[72:75], a[80:83], v[136:139], v[72:75]
    v_mfma_f32_16x16x32_bf16 v[64:67], a[84:87], v[140:143], v[64:67]
    ds_read_b128 v[124:127], v40 offset:31232
    v_mfma_f32_16x16x32_bf16 v[68:71], a[88:91], v[140:143], v[68:71]
    v_mfma_f32_16x16x32_bf16 v[72:75], a[92:95], v[140:143], v[72:75]
    s_waitcnt vmcnt(13) lgkmcnt(2)
    v_mfma_f32_16x16x32_bf16 v[64:67], a[96:99], v[112:115], v[64:67]
    ds_read_b128 v[128:131], v41 offset:31104
    v_and_b32 v180, s96, v180
    v_mfma_f32_16x16x32_bf16 v[68:71], a[100:103], v[112:115], v[68:71]
    v_and_b32 v181, s96, v181
    v_and_b32 v182, s96, v182
    v_mfma_f32_16x16x32_bf16 v[72:75], a[104:107], v[112:115], v[72:75]
    v_and_b32 v183, s96, v183
    v_pk_max_u16 v180, v180, v181
    v_mfma_f32_16x16x32_bf16 v[64:67], a[108:111], v[116:119], v[64:67]
    ds_read_b128 v[132:135], v41 offset:31168
    v_pk_max_u16 v182, v182, v183
    v_mfma_f32_16x16x32_bf16 v[68:71], a[112:115], v[116:119], v[68:71]
    v_pk_max_u16 v180, v180, s37
    v_pk_max_u16 v180, v180, v182
    v_mfma_f32_16x16x32_bf16 v[72:75], a[116:119], v[116:119], v[72:75]
    s_waitcnt lgkmcnt(2)
    v_cmp_ne_u32 s[80:81], s37, v180
    v_and_b32 v184, s96, v184
    v_mfma_f32_16x16x32_bf16 v[64:67], a[120:123], v[120:123], v[64:67]
    ds_read_b128 v[136:139], v41 offset:31232
    v_and_b32 v185, s96, v185
    v_mfma_f32_16x16x32_bf16 v[68:71], a[124:127], v[120:123], v[68:71]
    v_and_b32 v186, s96, v186
    v_and_b32 v187, s96, v187
    v_mfma_f32_16x16x32_bf16 v[72:75], a[128:131], v[120:123], v[72:75]
    v_pk_max_u16 v184, v184, v185
    v_pk_max_u16 v186, v186, v187
    v_mfma_f32_16x16x32_bf16 v[64:67], a[132:135], v[124:127], v[64:67]
    ds_read_b128 v[140:143], v42 offset:31104
    v_pk_max_u16 v184, v184, s37
    v_mfma_f32_16x16x32_bf16 v[68:71], a[136:139], v[124:127], v[68:71]
    v_pk_max_u16 v184, v184, v186
    v_cmp_ne_u32 s[82:83], s37, v184
    v_mfma_f32_16x16x32_bf16 v[72:75], a[140:143], v[124:127], v[72:75]
    s_waitcnt lgkmcnt(2)
    v_mfma_f32_16x16x32_bf16 v[64:67], a[144:147], v[128:131], v[64:67]
    ds_read_b128 v[112:115], v42 offset:31168
    v_mfma_f32_16x16x32_bf16 v[68:71], a[148:151], v[128:131], v[68:71]
    s_or_b64 vcc, s[80:81], s[82:83]
    s_cbranch_scc1 L_afailX
L_afailX_back:
    v_mfma_f32_16x16x32_bf16 v[72:75], a[152:155], v[128:131], v[72:75]
    v_mfma_f32_16x16x32_bf16 v[64:67], a[156:159], v[132:135], v[64:67]
    ds_read_b128 v[116:119], v42 offset:31232
    v_mfma_f32_16x16x32_bf16 v[68:71], a[160:163], v[132:135], v[68:71]
    v_mfma_f32_16x16x32_bf16 v[72:75], a[164:167], v[132:135], v[72:75]
    s_waitcnt lgkmcnt(2)
    v_mfma_f32_16x16x32_bf16 v[64:67], a[168:171], v[136:139], v[64:67]
    ds_read_b128 v[120:123], v40 offset:34560
    v_mfma_f32_16x16x32_bf16 v[68:71], a[172:175], v[136:139], v[68:71]
    v_mfma_f32_16x16x32_bf16 v[72:75], a[176:179], v[136:139], v[72:75]
    v_mfma_f32_16x16x32_bf16 v[64:67], a[180:183], v[140:143], v[64:67]
    ds_read_b128 v[124:127], v40 offset:34624
    v_mfma_f32_16x16x32_bf16 v[68:71], a[184:187], v[140:143], v[68:71]
    v_mfma_f32_16x16x32_bf16 v[72:75], a[188:191], v[140:143], v[72:75]
    s_waitcnt lgkmcnt(2)
    v_mfma_f32_16x16x32_bf16 v[64:67], a[192:195], v[112:115], v[64:67]
    ds_read_b128 v[128:131], v40 offset:34688
    v_mfma_f32_16x16x32_bf16 v[68:71], a[196:199], v[112:115], v[68:71]
    v_mfma_f32_16x16x32_bf16 v[72:75], a[200:203], v[112:115], v[72:75]
    v_mfma_f32_16x16x32_bf16 v[64:67], a[204:207], v[116:119], v[64:67]
    ds_read_b128 v[132:135], v41 offset:34560
    v_mfma_f32_16x16x32_bf16 v[68:71], a[208:211], v[116:119], v[68:71]
    v_mfma_f32_16x16x32_bf16 v[72:75], a[212:215], v[116:119], v[72:75]
    s_waitcnt lgkmcnt(2)
    v_mfma_f32_16x16x32_bf16 v[64:67], a[216:219], v[120:123], v[64:67]
    ds_read_b128 v[136:139], v41 offset:34624
    v_mfma_f32_16x16x32_bf16 v[68:71], a[220:223], v[120:123], v[68:71]
    v_mfma_f32_16x16x32_bf16 v[72:75], a[224:227], v[120:123], v[72:75]
    v_mfma_f32_16x16x32_bf16 v[64:67], a[228:231], v[124:127], v[64:67]
    ds_read_b128 v[140:143], v41 offset:34688
    v_mfma_f32_16x16x32_bf16 v[68:71], a[232:235], v[124:127], v[68:71]
    v_mfma_f32_16x16x32_bf16 v[72:75], a[236:239], v[124:127], v[72:75]
    s_waitcnt lgkmcnt(2)
    v_mfma_f32_16x16x32_bf16 v[64:67], a[240:243], v[128:131], v[64:67]
    ds_read_b128 v[112:115], v42 offset:34560
    v_mfma_f32_16x16x32_bf16 v[68:71], a[244:247], v[128:131], v[68:71]
    v_mfma_f32_16x16x32_bf16 v[72:75], a[248:251], v[128:131], v[72:75]
    v_mfma_f32_16x16x32_bf16 v[64:67], a[252:255], v[132:135], v[64:67]
    ds_read_b128 v[116:119], v42 offset:34624
    v_mfma_f32_16x16x32_bf16 v[68:71], v[188:191], v[132:135], v[68:71]
    v_mfma_f32_16x16x32_bf16 v[72:75], v[192:195], v[132:135], v[72:75]
    s_waitcnt lgkmcnt(2)
    v_mfma_f32_16x16x32_bf16 v[64:67], v[196:199], v[136:139], v[64:67]
    ds_read_b128 v[120:123], v42 offset:34688
    v_mfma_f32_16x16x32_bf16 v[68:71], v[200:203], v[136:139], v[68:71]
    v_mfma_f32_16x16x32_bf16 v[72:75], v[204:207], v[136:139], v[72:75]
    v_mfma_f32_16x16x32_bf16 v[64:67], v[208:211], v[140:143], v[64:67]
    ds_read_b128 v[124:127], v40 offset:34560
    v_mfma_f32_16x16x32_bf16 v[68:71], v[212:215], v[140:143], v[68:71]
    v_mfma_f32_16x16x32_bf16 v[72:75], v[216:219], v[140:143], v[72:75]
    s_waitcnt lgkmcnt(2)
    v_mfma_f32_16x16x32_bf16 v[64:67], v[220:223], v[112:115], v[64:67]
    ds_read_b128 v[128:131], v40 offset:34624
    v_mfma_f32_16x16x32_bf16 v[68:71], v[224:227], v[112:115], v[68:71]
    v_mfma_f32_16x16x32_bf16 v[72:75], v[228:231], v[112:115], v[72:75]
    v_mfma_f32_16x16x32_bf16 v[64:67], v[232:235], v[116:119], v[64:67]
    ds_read_b128 v[132:135], v40 offset:34688
    v_mfma_f32_16x16x32_bf16 v[68:71], v[236:239], v[116:119], v[68:71]
    v_mfma_f32_16x16x32_bf16 v[72:75], v[240:243], v[116:119], v[72:75]
    s_waitcnt lgkmcnt(2)
    v_mfma_f32_16x16x32_bf16 v[64:67], v[244:247], v[120:123], v[64:67]
    ds_read_b128 v[136:139], v41 offset:34560
    v_mfma_f32_16x16x32_bf16 v[68:71], v[248:251], v[120:123], v[68:71]
    v_mfma_f32_16x16x32_bf16 v[72:75], v[252:255], v[120:123], v[72:75]
    v_mfma_f32_16x16x32_bf16 v[76:79], a[0:3], v[124:127], 0
    ds_read_b128 v[140:143], v41 offset:34624
    v_mfma_f32_16x16x32_bf16 v[80:83], a[4:7], v[124:127], 0
    v_mfma_f32_16x16x32_bf16 v[84:87], a[8:11], v[124:127], 0
    s_waitcnt lgkmcnt(2)
    v_cvt_pk_bf16_f32 v64, v64, v65
    v_cvt_pk_bf16_f32 v65, v66, v67
    v_mfma_f32_16x16x32_bf16 v[76:79], a[12:15], v[128:131], v[76:79]
    ds_read_b128 v[112:115], v41 offset:34688
    v_cvt_pk_bf16_f32 v72, v72, v73
    v_mfma_f32_16x16x32_bf16 v[80:83], a[16:19], v[128:131], v[80:83]
    v_cvt_pk_bf16_f32 v73, v74, v75
    v_cvt_pk_bf16_f32 v66, v68, v69
    v_mfma_f32_16x16x32_bf16 v[84:87], a[20:23], v[128:131], v[84:87]
    ds_write_b64 v38, v[72:73] offset:8192
    v_mfma_f32_16x16x32_bf16 v[76:79], a[24:27], v[132:135], v[76:79]
    ds_read_b128 v[116:119], v42 offset:34560
    v_mfma_f32_16x16x32_bf16 v[80:83], a[28:31], v[132:135], v[80:83]
    v_permlane16_swap_b32 v64, v66
    v_mfma_f32_16x16x32_bf16 v[84:87], a[32:35], v[132:135], v[84:87]
    s_waitcnt lgkmcnt(3)
    v_cvt_pk_bf16_f32 v67, v70, v71
    v_mfma_f32_16x16x32_bf16 v[76:79], a[36:39], v[136:139], v[76:79]
    ds_read_b128 v[120:123], v42 offset:34624
    v_mfma_f32_16x16x32_bf16 v[80:83], a[40:43], v[136:139], v[80:83]
    v_permlane16_swap_b32 v65, v67
    v_mfma_f32_16x16x32_bf16 v[84:87], a[44:47], v[136:139], v[84:87]
    buffer_store_dwordx4 v[64:67], v21, s[20:23], s75 offen sc1
    v_mfma_f32_16x16x32_bf16 v[76:79], a[48:51], v[140:143], v[76:79]
    ds_read_b128 v[124:127], v42 offset:34688
    v_mfma_f32_16x16x32_bf16 v[80:83], a[52:55], v[140:143], v[80:83]
    v_mfma_f32_16x16x32_bf16 v[84:87], a[56:59], v[140:143], v[84:87]
    s_waitcnt lgkmcnt(2)
    v_mfma_f32_16x16x32_bf16 v[76:79], a[60:63], v[112:115], v[76:79]
    ds_read_b128 v[128:131], v40 offset:38016
    v_mfma_f32_16x16x32_bf16 v[80:83], a[64:67], v[112:115], v[80:83]
    v_mfma_f32_16x16x32_bf16 v[84:87], a[68:71], v[112:115], v[84:87]
    v_mfma_f32_16x16x32_bf16 v[76:79], a[72:75], v[116:119], v[76:79]
    ds_read_b128 v[132:135], v40 offset:38080
    v_mfma_f32_16x16x32_bf16 v[80:83], a[76:79], v[116:119], v[80:83]
    v_mfma_f32_16x16x32_bf16 v[84:87], a[80:83], v[116:119], v[84:87]
    s_waitcnt lgkmcnt(2)
    v_mfma_f32_16x16x32_bf16 v[76:79], a[84:87], v[120:123], v[76:79]
    ds_read_b128 v[136:139], v40 offset:38144
    v_mfma_f32_16x16x32_bf16 v[80:83], a[88:91], v[120:123], v[80:83]
    v_mfma_f32_16x16x32_bf16 v[84:87], a[92:95], v[120:123], v[84:87]
    s_waitcnt vmcnt(8) lgkmcnt(2)
    s_barrier
    v_mfma_f32_16x16x32_bf16 v[76:79], a[96:99], v[124:127], v[76:79]
    ds_read_b128 v[140:143], v41 offset:38016
    v_mfma_f32_16x16x32_bf16 v[80:83], a[100:103], v[124:127], v[80:83]
    ds_read_b32 v35, v34
    v_mfma_f32_16x16x32_bf16 v[84:87], a[104:107], v[124:127], v[84:87]
    ds_read_b64 v[12:13], v39 offset:6144
    v_mfma_f32_16x16x32_bf16 v[76:79], a[108:111], v[128:131], v[76:79]
    ds_read_b128 v[112:115], v41 offset:38080
    v_mfma_f32_16x16x32_bf16 v[80:83], a[112:115], v[128:131], v[80:83]
    ds_read_b64 v[14:15], v39 offset:8192
    v_mfma_f32_16x16x32_bf16 v[84:87], a[116:119], v[128:131], v[84:87]
    s_waitcnt lgkmcnt(5)
    v_mfma_f32_16x16x32_bf16 v[76:79], a[120:123], v[132:135], v[76:79]
    ds_read_b128 v[116:119], v41 offset:38144
    v_mfma_f32_16x16x32_bf16 v[80:83], a[124:127], v[132:135], v[80:83]
    v_mfma_f32_16x16x32_bf16 v[84:87], a[128:131], v[132:135], v[84:87]
    s_waitcnt lgkmcnt(3)
    v_readfirstlane_b32 s63, v35
    v_mfma_f32_16x16x32_bf16 v[76:79], a[132:135], v[136:139], v[76:79]
    ds_read_b128 v[120:123], v42 offset:38016
    v_mfma_f32_16x16x32_bf16 v[80:83], a[136:139], v[136:139], v[80:83]
    buffer_store_dwordx2 v[12:13], v22, s[20:23], s74 offen sc1
    v_mfma_f32_16x16x32_bf16 v[84:87], a[140:143], v[136:139], v[84:87]
    s_waitcnt lgkmcnt(2)
    v_mfma_f32_16x16x32_bf16 v[76:79], a[144:147], v[140:143], v[76:79]
    ds_read_b128 v[124:127], v42 offset:38080
    v_mfma_f32_16x16x32_bf16 v[80:83], a[148:151], v[140:143], v[80:83]
    v_mfma_f32_16x16x32_bf16 v[84:87], a[152:155], v[140:143], v[84:87]
    buffer_store_dwordx2 v[14:15], v22, s[20:23], s75 offen sc1
    v_mfma_f32_16x16x32_bf16 v[76:79], a[156:159], v[112:115], v[76:79]
    ds_read_b128 v[128:131], v42 offset:38144
    v_mfma_f32_16x16x32_bf16 v[80:83], a[160:163], v[112:115], v[80:83]
    v_mfma_f32_16x16x32_bf16 v[84:87], a[164:167], v[112:115], v[84:87]
    s_waitcnt lgkmcnt(2)
    v_mfma_f32_16x16x32_bf16 v[76:79], a[168:171], v[116:119], v[76:79]
    ds_read_b128 v[132:135], v40 offset:41472
    v_mfma_f32_16x16x32_bf16 v[80:83], a[172:175], v[116:119], v[80:83]
    v_mfma_f32_16x16x32_bf16 v[84:87], a[176:179], v[116:119], v[84:87]
    v_mfma_f32_16x16x32_bf16 v[76:79], a[180:183], v[120:123], v[76:79]
    ds_read_b128 v[136:139], v40 offset:41536
    v_mfma_f32_16x16x32_bf16 v[80:83], a[184:187], v[120:123], v[80:83]
    v_mfma_f32_16x16x32_bf16 v[84:87], a[188:191], v[120:123], v[84:87]
    s_waitcnt lgkmcnt(2)
    v_mfma_f32_16x16x32_bf16 v[76:79], a[192:195], v[124:127], v[76:79]
    ds_read_b128 v[140:143], v40 offset:41600
    v_mfma_f32_16x16x32_bf16 v[80:83], a[196:199], v[124:127], v[80:83]
    v_mfma_f32_16x16x32_bf16 v[84:87], a[200:203], v[124:127], v[84:87]
    v_mfma_f32_16x16x32_bf16 v[76:79], a[204:207], v[128:131], v[76:79]
    ds_read_b128 v[112:115], v41 offset:41472
    v_mfma_f32_16x16x32_bf16 v[80:83], a[208:211], v[128:131], v[80:83]
    v_mfma_f32_16x16x32_bf16 v[84:87], a[212:215], v[128:131], v[84:87]
    s_waitcnt lgkmcnt(2)
    v_mfma_f32_16x16x32_bf16 v[76:79], a[216:219], v[132:135], v[76:79]
    ds_read_b128 v[116:119], v41 offset:41536
    v_mfma_f32_16x16x32_bf16 v[80:83], a[220:223], v[132:135], v[80:83]
    v_mfma_f32_16x16x32_bf16 v[84:87], a[224:227], v[132:135], v[84:87]
    v_mfma_f32_16x16x32_bf16 v[76:79], a[228:231], v[136:139], v[76:79]
    ds_read_b128 v[120:123], v41 offset:41600
    v_mfma_f32_16x16x32_bf16 v[80:83], a[232:235], v[136:139], v[80:83]
    v_mfma_f32_16x16x32_bf16 v[84:87], a[236:239], v[136:139], v[84:87]
    s_waitcnt lgkmcnt(2)
    v_mfma_f32_16x16x32_bf16 v[76:79], a[240:243], v[140:143], v[76:79]
    ds_read_b128 v[124:127], v42 offset:41472
    v_mfma_f32_16x16x32_bf16 v[80:83], a[244:247], v[140:143], v[80:83]
    v_mfma_f32_16x16x32_bf16 v[84:87], a[248:251], v[140:143], v[84:87]
    v_mfma_f32_16x16x32_bf16 v[76:79], a[252:255], v[112:115], v[76:79]
    ds_read_b128 v[128:131], v42 offset:41536
    v_mfma_f32_16x16x32_bf16 v[80:83], v[188:191], v[112:115], v[80:83]
    v_mfma_f32_16x16x32_bf16 v[84:87], v[192:195], v[112:115], v[84:87]
    s_waitcnt lgkmcnt(2)
    v_mfma_f32_16x16x32_bf16 v[76:79], v[196:199], v[116:119], v[76:79]
    ds_read_b128 v[132:135], v42 offset:41600
    v_mfma_f32_16x16x32_bf16 v[80:83], v[200:203], v[116:119], v[80:83]
    v_mfma_f32_16x16x32_bf16 v[84:87], v[204:207], v[116:119], v[84:87]
    v_mfma_f32_16x16x32_bf16 v[76:79], v[208:211], v[120:123], v[76:79]
    ds_read_b128 v[136:139], v40 offset:41472
    v_mfma_f32_16x16x32_bf16 v[80:83], v[212:215], v[120:123], v[80:83]
    v_mfma_f32_16x16x32_bf16 v[84:87], v[216:219], v[120:123], v[84:87]
    s_waitcnt lgkmcnt(2)
    v_mfma_f32_16x16x32_bf16 v[76:79], v[220:223], v[124:127], v[76:79]
    ds_read_b128 v[140:143], v40 offset:41536
    v_mfma_f32_16x16x32_bf16 v[80:83], v[224:227], v[124:127], v[80:83]
    v_mfma_f32_16x16x32_bf16 v[84:87], v[228:231], v[124:127], v[84:87]
    v_mfma_f32_16x16x32_bf16 v[76:79], v[232:235], v[128:131], v[76:79]
    ds_read_b128 v[112:115], v40 offset:41600
    v_mfma_f32_16x16x32_bf16 v[80:83], v[236:239], v[128:131], v[80:83]
    v_mfma_f32_16x16x32_bf16 v[84:87], v[240:243], v[128:131], v[84:87]
    s_waitcnt lgkmcnt(2)
    v_mfma_f32_16x16x32_bf16 v[76:79], v[244:247], v[132:135], v[76:79]
    ds_read_b128 v[116:119], v41 offset:41472
    v_mfma_f32_16x16x32_bf16 v[80:83], v[248:251], v[132:135], v[80:83]
    v_mfma_f32_16x16x32_bf16 v[84:87], v[252:255], v[132:135], v[84:87]
    v_mfma_f32_16x16x32_bf16 v[88:91], a[0:3], v[136:139], 0
    ds_read_b128 v[120:123], v41 offset:41536
    v_mfma_f32_16x16x32_bf16 v[92:95], a[4:7], v[136:139], 0
    v_mfma_f32_16x16x32_bf16 v[96:99], a[8:11], v[136:139], 0
    s_waitcnt lgkmcnt(2)
    v_cvt_pk_bf16_f32 v76, v76, v77
    v_cvt_pk_bf16_f32 v77, v78, v79
    v_mfma_f32_16x16x32_bf16 v[88:91], a[12:15], v[140:143], v[88:91]
    ds_read_b128 v[124:127], v41 offset:41600
    v_cvt_pk_bf16_f32 v78, v80, v81
    v_mfma_f32_16x16x32_bf16 v[92:95], a[16:19], v[140:143], v[92:95]
    v_cvt_pk_bf16_f32 v79, v82, v83
    v_cvt_pk_bf16_f32 v84, v84, v85
    v_mfma_f32_16x16x32_bf16 v[96:99], a[20:23], v[140:143], v[96:99]
    v_permlane16_swap_b32 v76, v78
    v_mfma_f32_16x16x32_bf16 v[88:91], a[24:27], v[112:115], v[88:91]
    ds_read_b128 v[128:131], v42 offset:41472
    v_cvt_pk_bf16_f32 v85, v86, v87
    v_mfma_f32_16x16x32_bf16 v[92:95], a[28:31], v[112:115], v[92:95]
    v_permlane16_swap_b32 v77, v79
    v_mfma_f32_16x16x32_bf16 v[96:99], a[32:35], v[112:115], v[96:99]
    s_waitcnt lgkmcnt(2)
    ds_write_b64 v38, v[84:85] offset:10240
    v_mfma_f32_16x16x32_bf16 v[88:91], a[36:39], v[116:119], v[88:91]
    ds_read_b128 v[132:135], v42 offset:41536
    v_mfma_f32_16x16x32_bf16 v[92:95], a[40:43], v[116:119], v[92:95]
    buffer_store_dwordx4 v[76:79], v21, s[20:23], s76 offen sc1
    v_mfma_f32_16x16x32_bf16 v[96:99], a[44:47], v[116:119], v[96:99]
    v_mfma_f32_16x16x32_bf16 v[88:91], a[48:51], v[120:123], v[88:91]
    ds_read_b128 v[136:139], v42 offset:41600
    v_mfma_f32_16x16x32_bf16 v[92:95], a[52:55], v[120:123], v[92:95]
    v_mfma_f32_16x16x32_bf16 v[96:99], a[56:59], v[120:123], v[96:99]
    s_waitcnt lgkmcnt(2)
    v_mfma_f32_16x16x32_bf16 v[88:91], a[60:63], v[124:127], v[88:91]
    ds_read_b128 v[140:143], v40 offset:44928
    v_mfma_f32_16x16x32_bf16 v[92:95], a[64:67], v[124:127], v[92:95]
    v_mfma_f32_16x16x32_bf16 v[96:99], a[68:71], v[124:127], v[96:99]
    v_mfma_f32_16x16x32_bf16 v[88:91], a[72:75], v[128:131], v[88:91]
    ds_read_b128 v[112:115], v40 offset:44992
    v_mfma_f32_16x16x32_bf16 v[92:95], a[76:79], v[128:131], v[92:95]
    v_mfma_f32_16x16x32_bf16 v[96:99], a[80:83], v[128:131], v[96:99]
    s_waitcnt lgkmcnt(2)
    v_mfma_f32_16x16x32_bf16 v[88:91], a[84:87], v[132:135], v[88:91]
    ds_read_b128 v[116:119], v40 offset:45056
    v_mfma_f32_16x16x32_bf16 v[92:95], a[88:91], v[132:135], v[92:95]
    v_mfma_f32_16x16x32_bf16 v[96:99], a[92:95], v[132:135], v[96:99]
    v_mfma_f32_16x16x32_bf16 v[88:91], a[96:99], v[136:139], v[88:91]
    ds_read_b128 v[120:123], v41 offset:44928
    v_mfma_f32_16x16x32_bf16 v[92:95], a[100:103], v[136:139], v[92:95]
    v_mfma_f32_16x16x32_bf16 v[96:99], a[104:107], v[136:139], v[96:99]
    s_waitcnt lgkmcnt(2)
    v_mfma_f32_16x16x32_bf16 v[88:91], a[108:111], v[140:143], v[88:91]
    ds_read_b128 v[124:127], v41 offset:44992
    v_mfma_f32_16x16x32_bf16 v[92:95], a[112:115], v[140:143], v[92:95]
    v_mfma_f32_16x16x32_bf16 v[96:99], a[116:119], v[140:143], v[96:99]
    v_mfma_f32_16x16x32_bf16 v[88:91], a[120:123], v[112:115], v[88:91]
    ds_read_b128 v[128:131], v41 offset:45056
    v_mfma_f32_16x16x32_bf16 v[92:95], a[124:127], v[112:115], v[92:95]
    v_mfma_f32_16x16x32_bf16 v[96:99], a[128:131], v[112:115], v[96:99]
    s_waitcnt lgkmcnt(2)
    v_mfma_f32_16x16x32_bf16 v[88:91], a[132:135], v[116:119], v[88:91]
    ds_read_b128 v[132:135], v42 offset:44928
    v_mfma_f32_16x16x32_bf16 v[92:95], a[136:139], v[116:119], v[92:95]
    v_mfma_f32_16x16x32_bf16 v[96:99], a[140:143], v[116:119], v[96:99]
    v_mfma_f32_16x16x32_bf16 v[88:91], a[144:147], v[120:123], v[88:91]
    ds_read_b128 v[136:139], v42 offset:44992
    v_mfma_f32_16x16x32_bf16 v[92:95], a[148:151], v[120:123], v[92:95]
    v_mfma_f32_16x16x32_bf16 v[96:99], a[152:155], v[120:123], v[96:99]
    s_waitcnt lgkmcnt(2)
    v_mfma_f32_16x16x32_bf16 v[88:91], a[156:159], v[124:127], v[88:91]
    ds_read_b128 v[140:143], v42 offset:45056
    v_mfma_f32_16x16x32_bf16 v[92:95], a[160:163], v[124:127], v[92:95]
    v_mfma_f32_16x16x32_bf16 v[96:99], a[164:167], v[124:127], v[96:99]
    v_mfma_f32_16x16x32_bf16 v[88:91], a[168:171], v[128:131], v[88:91]
    ds_read_b128 v[112:115], v40 offset:48384
    v_mfma_f32_16x16x32_bf16 v[92:95], a[172:175], v[128:131], v[92:95]
    v_mfma_f32_16x16x32_bf16 v[96:99], a[176:179], v[128:131], v[96:99]
    s_waitcnt lgkmcnt(2)
    v_mfma_f32_16x16x32_bf16 v[88:91], a[180:183], v[132:135], v[88:91]
    ds_read_b128 v[116:119], v40 offset:48448
    v_mfma_f32_16x16x32_bf16 v[92:95], a[184:187], v[132:135], v[92:95]
    v_mfma_f32_16x16x32_bf16 v[96:99], a[188:191], v[132:135], v[96:99]
    v_mfma_f32_16x16x32_bf16 v[88:91], a[192:195], v[136:139], v[88:91]
    ds_read_b128 v[120:123], v40 offset:48512
    v_mfma_f32_16x16x32_bf16 v[92:95], a[196:199], v[136:139], v[92:95]
    v_mfma_f32_16x16x32_bf16 v[96:99], a[200:203], v[136:139], v[96:99]
    s_waitcnt lgkmcnt(2)
    v_mfma_f32_16x16x32_bf16 v[88:91], a[204:207], v[140:143], v[88:91]
    ds_read_b128 v[124:127], v41 offset:48384
    v_mfma_f32_16x16x32_bf16 v[92:95], a[208:211], v[140:143], v[92:95]
    ds_read_b128 v[128:131], v41 offset:48448
    v_mfma_f32_16x16x32_bf16 v[96:99], a[212:215], v[140:143], v[96:99]
    ds_read_b128 v[132:135], v41 offset:48512
    v_mfma_f32_16x16x32_bf16 v[88:91], a[216:219], v[112:115], v[88:91]
    ds_read_b128 v[136:139], v42 offset:48384
    v_mfma_f32_16x16x32_bf16 v[92:95], a[220:223], v[112:115], v[92:95]
    ds_read_b128 v[140:143], v42 offset:48448
    v_mfma_f32_16x16x32_bf16 v[96:99], a[224:227], v[112:115], v[96:99]
    s_waitcnt lgkmcnt(5)
    ds_read_b128 v[112:115], v42 offset:48512
    v_mfma_f32_16x16x32_bf16 v[88:91], a[228:231], v[116:119], v[88:91]
    v_mfma_f32_16x16x32_bf16 v[92:95], a[232:235], v[116:119], v[92:95]
    v_mfma_f32_16x16x32_bf16 v[96:99], a[236:239], v[116:119], v[96:99]
    v_mfma_f32_16x16x32_bf16 v[88:91], a[240:243], v[120:123], v[88:91]
    v_mfma_f32_16x16x32_bf16 v[92:95], a[244:247], v[120:123], v[92:95]
    v_mfma_f32_16x16x32_bf16 v[96:99], a[248:251], v[120:123], v[96:99]
    s_waitcnt lgkmcnt(0)
    v_mfma_f32_16x16x32_bf16 v[96:99], v[192:195], v[124:127], v[96:99]
    v_mfma_f32_16x16x32_bf16 v[96:99], v[204:207], v[128:131], v[96:99]
    v_mfma_f32_16x16x32_bf16 v[96:99], v[216:219], v[132:135], v[96:99]
    v_mfma_f32_16x16x32_bf16 v[96:99], v[228:231], v[136:139], v[96:99]
    v_mfma_f32_16x16x32_bf16 v[96:99], v[240:243], v[140:143], v[96:99]
    v_mfma_f32_16x16x32_bf16 v[96:99], v[252:255], v[112:115], v[96:99]
    s_nop 2
    v_mfma_f32_16x16x32_bf16 v[88:91], a[252:255], v[124:127], v[88:91]
    s_nop 2
    v_mfma_f32_16x16x32_bf16 v[88:91], v[196:199], v[128:131], v[88:91]
    v_cvt_pk_bf16_f32 v96, v96, v97
    v_cvt_pk_bf16_f32 v97, v98, v99
    v_mfma_f32_16x16x32_bf16 v[88:91], v[208:211], v[132:135], v[88:91]
    ds_write_b64 v38, v[96:97] offset:12288
    v_mfma_f32_16x16x32_bf16 v[88:91], v[220:223], v[136:139], v[88:91]
    v_mfma_f32_16x16x32_bf16 v[88:91], v[232:235], v[140:143], v[88:91]
    v_mfma_f32_16x16x32_bf16 v[88:91], v[244:247], v[112:115], v[88:91]
    v_mfma_f32_16x16x32_bf16 v[92:95], v[188:191], v[124:127], v[92:95]
    s_waitcnt lgkmcnt(0)
    s_barrier
    v_mfma_f32_16x16x32_bf16 v[92:95], v[200:203], v[128:131], v[92:95]
    ds_read_b64 v[62:63], v39 offset:10240
    v_mfma_f32_16x16x32_bf16 v[92:95], v[212:215], v[132:135], v[92:95]
    ds_read_b64 v[50:51], v39 offset:12288
    v_mfma_f32_16x16x32_bf16 v[92:95], v[224:227], v[136:139], v[92:95]
    v_mfma_f32_16x16x32_bf16 v[92:95], v[236:239], v[140:143], v[92:95]
    v_cvt_pk_bf16_f32 v88, v88, v89
    v_cvt_pk_bf16_f32 v89, v90, v91
    v_mfma_f32_16x16x32_bf16 v[92:95], v[248:251], v[112:115], v[92:95]
    s_waitcnt lgkmcnt(0)
    buffer_store_dwordx2 v[62:63], v22, s[20:23], s76 offen sc1
    buffer_store_dwordx2 v[50:51], v22, s[20:23], s77 offen sc1
    s_nop 4
    v_cvt_pk_bf16_f32 v90, v92, v93
    v_cvt_pk_bf16_f32 v91, v94, v95
    s_nop 0
    v_permlane16_swap_b32 v88, v90
    v_permlane16_swap_b32 v89, v91
    buffer_store_dwordx4 v[88:91], v21, s[20:23], s77 offen sc1
L_check:
    s_cmp_lg_u32 s63, 0
    s_cbranch_scc1 L_slow
    s_endpgm
L_x_end:
L_more:
    ds_read2_b32 v[176:177], v24 offset0:64 offset1:96
    ds_read_b64 v[178:179], v25 offset:264
    s_waitcnt lgkmcnt(0)
    v_xor_b32 v172, v176, v26
    v_xor_b32 v174, v177, v26
    v_xor_b32 v173, v176, v27
    v_xor_b32 v175, v177, v27
    ds_read_b64_tr_b16 v[144:145], v172 offset:0
    ds_read_b64_tr_b16 v[146:147], v174 offset:0
    ds_read_b64_tr_b16 v[148:149], v173 offset:0
    ds_read_b64_tr_b16 v[150:151], v175 offset:0
    ds_read_b64_tr_b16 v[152:153], v172 offset:64
    ds_read_b64_tr_b16 v[154:155], v174 offset:64
    v_cndmask_b32 v169, 0, v179, s[88:89]
    v_cndmask_b32 v171, 0, v179, s[92:93]
    v_cndmask_b32 v168, 0, v178, s[88:89]
    v_cndmask_b32 v170, 0, v178, s[92:93]
    v_cndmask_b32 v169, v169, v178, s[90:91]
    v_cndmask_b32 v171, v171, v178, s[94:95]
    ds_read_b64_tr_b16 v[156:157], v173 offset:64
    ds_read_b64_tr_b16 v[158:159], v175 offset:64
    ds_read_b64_tr_b16 v[160:161], v172 offset:128
    ds_read_b64_tr_b16 v[162:163], v174 offset:128
    ds_read_b64_tr_b16 v[164:165], v173 offset:128
    ds_read_b64_tr_b16 v[166:167], v175 offset:128
    s_waitcnt lgkmcnt(0)
    v_mfma_f32_16x16x32_bf16 v[144:147], v[144:147], v[168:171], 0
    v_mfma_f32_16x16x32_bf16 v[148:151], v[148:151], v[168:171], 0
    v_mfma_f32_16x16x32_bf16 v[152:155], v[152:155], v[168:171], 0
    v_mfma_f32_16x16x32_bf16 v[156:159], v[156:159], v[168:171], 0
    v_mfma_f32_16x16x32_bf16 v[160:163], v[160:163], v[168:171], 0
    v_mfma_f32_16x16x32_bf16 v[164:167], v[164:167], v[168:171], 0
    s_nop 3
    v_cvt_pk_bf16_f32 v144, v144, v145
    v_cvt_pk_bf16_f32 v145, v146, v147
    ds_write_b64 v28, v[144:145] offset:12288
    v_cvt_pk_bf16_f32 v148, v148, v149
    v_cvt_pk_bf16_f32 v149, v150, v151
    ds_write_b64 v29, v[148:149] offset:12288
    v_cvt_pk_bf16_f32 v152, v152, v153
    v_cvt_pk_bf16_f32 v153, v154, v155
    ds_write_b64 v28, v[152:153] offset:12352
    v_cvt_pk_bf16_f32 v156, v156, v157
    v_cvt_pk_bf16_f32 v157, v158, v159
    ds_write_b64 v29, v[156:157] offset:12352
    v_cvt_pk_bf16_f32 v160, v160, v161
    v_cvt_pk_bf16_f32 v161, v162, v163
    ds_write_b64 v28, v[160:161] offset:12416
    v_cvt_pk_bf16_f32 v164, v164, v165
    v_cvt_pk_bf16_f32 v165, v166, v167
    ds_write_b64 v29, v[164:165] offset:12416
    s_waitcnt lgkmcnt(0)
    s_branch L_more_back
L_hot_end:
L_bfail1:
    v_mov_b32 v163, s60
    ds_write_b32 v110, v163 offset:4
    s_mov_b64 s[80:81], 0
    s_mov_b64 s[88:89], 0
    s_mov_b64 s[82:83], 0
    s_mov_b64 s[90:91], 0
    s_mov_b64 s[84:85], 0
    s_mov_b64 s[92:93], 0
    s_mov_b64 s[86:87], 0
    s_mov_b64 s[94:95], 0
    s_mov_b64 s[98:99], 0
    s_mov_b32 s62, 0
    s_branch L_bfail1_back
L_bfail2:
    v_mov_b32 v144, s38
    ds_or_b32 v34, v144
    s_branch L_bfail2_back
L_afailX:
    v_mul_u32_u24 v32, 1821, v0
    v_lshrrev_b32 v32, 16, v32
    v_lshlrev_b32 v32, v32, 1
    v_lshlrev_b32 v33, 7, v32
    s_mov_b64 exec, s[80:81]
    ds_or_b32 v34, v32
    s_mov_b64 exec, s[82:83]
    ds_or_b32 v34, v33
    s_mov_b64 exec, -1
    s_waitcnt lgkmcnt(0)
    s_branch L_afailX_back
L_afailY:
    v_mul_u32_u24 v32, 1821, v0
    v_lshrrev_b32 v32, 16, v32
    v_lshlrev_b32 v32, v32, 1
    v_lshlrev_b32 v33, 7, v32
    s_mov_b64 exec, s[80:81]
    ds_or_b32 v34, v32
    s_mov_b64 exec, s[82:83]
    ds_or_b32 v34, v33
    s_mov_b64 exec, -1
    s_waitcnt lgkmcnt(0)
    s_branch L_afailY_back
L_slow:
    s_waitcnt vmcnt(0) lgkmcnt(0)
    s_barrier
    s_ff1_i32_b32 s80, s63
    s_bitset0_b32 s63, s80
    s_mul_i32 s81, s80, 224
    s_add_u32 s81, s81, s45
    s_mov_b32 s82, 1
    s_cmp_lt_u32 s80, 16
    s_cbranch_scc1 L_s1
    s_bfe_u32 s40, s80, 0x10002
    s_add_u32 s40, s40, s53
    s_and_b32 s41, s80, 3
    s_lshl_b32 s41, s41, 4
    s_cmp_eq_u32 s47, 0
    s_cselect_b32 s82, 1, 224
    s_cselect_b32 s81, 224, 1
    s_mul_i32 s81, s81, s40
    s_mul_i32 s41, s41, s82
    s_add_u32 s81, s81, s41
L_s1:
    s_movk_i32 s43, 224
    v_mul_u32_u24 v79, s82, v2
    v_lshl_add_u32 v49, s2, 2, v3
    v_lshl_add_u32 v49, v49, 3, 64
    v_mad_u32_u24 v49, v79, s42, v49
    v_add_u32 v79, s81, v79
    v_lshrrev_b32 v80, 4, v0
    v_min_u32 v80, 8, v80
    v_mul_u32_u24 v85, 36, v79
    v_lshl_add_u32 v85, v80, 2, v85
    buffer_load_dword v85, v85, s[12:15], 0 offen
    v_mul_u32_u24 v81, 74899, v79
    v_lshrrev_b32 v81, 24, v81
    v_mul_u32_u24 v82, 224, v81
    v_sub_u32 v82, v79, v82
    v_mul_u32_u24 v83, 11, v80
    v_lshrrev_b32 v83, 5, v83
    v_mad_i32_i24 v84, v83, -3, v80
    v_add3_u32 v81, v81, v83, -1
    v_add3_u32 v82, v82, v84, -1
    v_cvt_f32_i32 v81, v81
    v_cvt_f32_i32 v82, v82
    s_waitcnt vmcnt(0)
    v_lshlrev_b32 v65, 16, v85
    v_and_b32 v66, 0xffff0000, v85
    v_add_f32 v65, v81, v65
    v_add_f32 v66, v82, v66
    v_cvt_pk_bf16_f32 v64, v65, v66
    v_pk_max_i16 v64, v64, 0
    v_pk_min_i16 v64, v64, s60
    v_lshlrev_b32 v65, 16, v64
    v_and_b32 v66, 0xffff0000, v64
    v_fract_f32 v71, v65
    v_fract_f32 v72, v66
    v_ceil_f32 v68, v65
    v_ceil_f32 v70, v66
    v_sub_f32 v73, 1.0, v71
    v_sub_f32 v74, 1.0, v72
    v_cvt_u32_f32 v67, v65
    v_cvt_u32_f32 v69, v66
    v_cvt_pk_bf16_f32 v74, v73, v74
    v_cvt_u32_f32 v68, v68
    v_cvt_u32_f32 v70, v70
    v_lshlrev_b32 v73, 16, v74
    v_and_b32 v74, 0xffff0000, v74
    v_mul_f32 v78, v71, v72
    v_mul_f32 v76, v73, v72
    v_mul_f32 v77, v71, v74
    v_mul_f32 v75, v73, v74
    v_mad_u32_u24 v88, v67, s43, v69
    v_mul_u32_u24 v88, 192, v88
    v_mad_u32_u24 v89, v67, s43, v70
    v_mul_u32_u24 v89, 192, v89
    v_mad_u32_u24 v90, v68, s43, v69
    v_mul_u32_u24 v90, 192, v90
    v_mad_u32_u24 v91, v68, s43, v70
    v_mul_u32_u24 v91, 192, v91
    v_cvt_pk_bf16_f32 v92, v75, v76
    v_cvt_pk_bf16_f32 v93, v77, v78
    v_lshlrev_b32 v79, 5, v0
    v_add_u32 v79, 61440, v79
    ds_write_b128 v79, v[88:91]
    ds_write_b64 v79, v[92:93] offset:16
    s_mov_b32 s83, 0
    s_waitcnt lgkmcnt(0)
    s_barrier
L_s2:
    s_add_u32 s40, s83, 0
    v_add_u32 v96, s40, v0
    v_mul_u32_u24 v70, 5462, v96
    v_lshrrev_b32 v70, 16, v70
    v_mad_i32_i24 v71, v70, -12, v96
    v_lshlrev_b32 v70, 5, v70
    v_add_u32 v70, 61440, v70
    ds_read_b128 v[64:67], v70
    ds_read_b64 v[68:69], v70 offset:16
    v_lshlrev_b32 v96, 4, v96
    s_add_u32 s40, s83, 256
    v_add_u32 v97, s40, v0
    v_mul_u32_u24 v78, 5462, v97
    v_lshrrev_b32 v78, 16, v78
    v_mad_i32_i24 v79, v78, -12, v97
    v_lshlrev_b32 v78, 5, v78
    v_add_u32 v78, 61440, v78
    ds_read_b128 v[72:75], v78
    ds_read_b64 v[76:77], v78 offset:16
    v_lshlrev_b32 v97, 4, v97
    s_add_u32 s40, s83, 512
    v_add_u32 v98, s40, v0
    v_mul_u32_u24 v86, 5462, v98
    v_lshrrev_b32 v86, 16, v86
    v_mad_i32_i24 v87, v86, -12, v98
    v_lshlrev_b32 v86, 5, v86
    v_add_u32 v86, 61440, v86
    ds_read_b128 v[80:83], v86
    ds_read_b64 v[84:85], v86 offset:16
    v_lshlrev_b32 v98, 4, v98
    s_add_u32 s40, s83, 768
    v_add_u32 v99, s40, v0
    v_mul_u32_u24 v94, 5462, v99
    v_lshrrev_b32 v94, 16, v94
    v_mad_i32_i24 v95, v94, -12, v99
    v_lshlrev_b32 v94, 5, v94
    v_add_u32 v94, 61440, v94
    ds_read_b128 v[88:91], v94
    ds_read_b64 v[92:93], v94 offset:16
    v_lshlrev_b32 v99, 4, v99
    s_waitcnt lgkmcnt(0)
    v_lshl_add_u32 v64, v71, 4, v64
    buffer_load_dwordx4 v[100:103], v64, s[8:11], 0 offen
    v_lshl_add_u32 v65, v71, 4, v65
    buffer_load_dwordx4 v[104:107], v65, s[8:11], 0 offen
    v_lshl_add_u32 v66, v71, 4, v66
    buffer_load_dwordx4 v[108:111], v66, s[8:11], 0 offen
    v_lshl_add_u32 v67, v71, 4, v67
    buffer_load_dwordx4 v[112:115], v67, s[8:11], 0 offen
    v_lshl_add_u32 v72, v79, 4, v72
    buffer_load_dwordx4 v[116:119], v72, s[8:11], 0 offen
    v_lshl_add_u32 v73, v79, 4, v73
    buffer_load_dwordx4 v[120:123], v73, s[8:11], 0 offen
    v_lshl_add_u32 v74, v79, 4, v74
    buffer_load_dwordx4 v[124:127], v74, s[8:11], 0 offen
    v_lshl_add_u32 v75, v79, 4, v75
    buffer_load_dwordx4 v[128:131], v75, s[8:11], 0 offen
    v_lshl_add_u32 v80, v87, 4, v80
    buffer_load_dwordx4 v[132:135], v80, s[8:11], 0 offen
    v_lshl_add_u32 v81, v87, 4, v81
    buffer_load_dwordx4 v[136:139], v81, s[8:11], 0 offen
    v_lshl_add_u32 v82, v87, 4, v82
    buffer_load_dwordx4 v[140:143], v82, s[8:11], 0 offen
    v_lshl_add_u32 v83, v87, 4, v83
    buffer_load_dwordx4 v[144:147], v83, s[8:11], 0 offen
    v_lshl_add_u32 v88, v95, 4, v88
    buffer_load_dwordx4 v[148:151], v88, s[8:11], 0 offen
    v_lshl_add_u32 v89, v95, 4, v89
    buffer_load_dwordx4 v[152:155], v89, s[8:11], 0 offen
    v_lshl_add_u32 v90, v95, 4, v90
    buffer_load_dwordx4 v[156:159], v90, s[8:11], 0 offen
    v_lshl_add_u32 v91, v95, 4, v91
    buffer_load_dwordx4 v[160:163], v91, s[8:11], 0 offen
    s_waitcnt vmcnt(12)
    v_lshlrev_b32 v172, 16, v68
    v_lshlrev_b32 v173, 16, v100
    v_and_b32 v174, 0xffff0000, v100
    v_mul_f32 v164, v172, v173
    v_mul_f32 v165, v172, v174
    v_lshlrev_b32 v173, 16, v101
    v_and_b32 v174, 0xffff0000, v101
    v_mul_f32 v166, v172, v173
    v_mul_f32 v167, v172, v174
    v_lshlrev_b32 v173, 16, v102
    v_and_b32 v174, 0xffff0000, v102
    v_mul_f32 v168, v172, v173
    v_mul_f32 v169, v172, v174
    v_lshlrev_b32 v173, 16, v103
    v_and_b32 v174, 0xffff0000, v103
    v_mul_f32 v170, v172, v173
    v_mul_f32 v171, v172, v174
    v_and_b32 v172, 0xffff0000, v68
    v_lshlrev_b32 v173, 16, v104
    v_and_b32 v174, 0xffff0000, v104
    v_fmac_f32 v164, v172, v173
    v_fmac_f32 v165, v172, v174
    v_lshlrev_b32 v173, 16, v105
    v_and_b32 v174, 0xffff0000, v105
    v_fmac_f32 v166, v172, v173
    v_fmac_f32 v167, v172, v174
    v_lshlrev_b32 v173, 16, v106
    v_and_b32 v174, 0xffff0000, v106
    v_fmac_f32 v168, v172, v173
    v_fmac_f32 v169, v172, v174
    v_lshlrev_b32 v173, 16, v107
    v_and_b32 v174, 0xffff0000, v107
    v_fmac_f32 v170, v172, v173
    v_fmac_f32 v171, v172, v174
    v_lshlrev_b32 v172, 16, v69
    v_lshlrev_b32 v173, 16, v108
    v_and_b32 v174, 0xffff0000, v108
    v_fmac_f32 v164, v172, v173
    v_fmac_f32 v165, v172, v174
    v_lshlrev_b32 v173, 16, v109
    v_and_b32 v174, 0xffff0000, v109
    v_fmac_f32 v166, v172, v173
    v_fmac_f32 v167, v172, v174
    v_lshlrev_b32 v173, 16, v110
    v_and_b32 v174, 0xffff0000, v110
    v_fmac_f32 v168, v172, v173
    v_fmac_f32 v169, v172, v174
    v_lshlrev_b32 v173, 16, v111
    v_and_b32 v174, 0xffff0000, v111
    v_fmac_f32 v170, v172, v173
    v_fmac_f32 v171, v172, v174
    v_and_b32 v172, 0xffff0000, v69
    v_lshlrev_b32 v173, 16, v112
    v_and_b32 v174, 0xffff0000, v112
    v_fmac_f32 v164, v172, v173
    v_fmac_f32 v165, v172, v174
    v_lshlrev_b32 v173, 16, v113
    v_and_b32 v174, 0xffff0000, v113
    v_fmac_f32 v166, v172, v173
    v_fmac_f32 v167, v172, v174
    v_lshlrev_b32 v173, 16, v114
    v_and_b32 v174, 0xffff0000, v114
    v_fmac_f32 v168, v172, v173
    v_fmac_f32 v169, v172, v174
    v_lshlrev_b32 v173, 16, v115
    v_and_b32 v174, 0xffff0000, v115
    v_fmac_f32 v170, v172, v173
    v_fmac_f32 v171, v172, v174
    v_cvt_pk_bf16_f32 v176, v164, v165
    v_cvt_pk_bf16_f32 v177, v166, v167
    v_cvt_pk_bf16_f32 v178, v168, v169
    v_cvt_pk_bf16_f32 v179, v170, v171
    ds_write_b128 v96, v[176:179]
    s_waitcnt vmcnt(8)
    v_lshlrev_b32 v172, 16, v76
    v_lshlrev_b32 v173, 16, v116
    v_and_b32 v174, 0xffff0000, v116
    v_mul_f32 v164, v172, v173
    v_mul_f32 v165, v172, v174
    v_lshlrev_b32 v173, 16, v117
    v_and_b32 v174, 0xffff0000, v117
    v_mul_f32 v166, v172, v173
    v_mul_f32 v167, v172, v174
    v_lshlrev_b32 v173, 16, v118
    v_and_b32 v174, 0xffff0000, v118
    v_mul_f32 v168, v172, v173
    v_mul_f32 v169, v172, v174
    v_lshlrev_b32 v173, 16, v119
    v_and_b32 v174, 0xffff0000, v119
    v_mul_f32 v170, v172, v173
    v_mul_f32 v171, v172, v174
    v_and_b32 v172, 0xffff0000, v76
    v_lshlrev_b32 v173, 16, v120
    v_and_b32 v174, 0xffff0000, v120
    v_fmac_f32 v164, v172, v173
    v_fmac_f32 v165, v172, v174
    v_lshlrev_b32 v173, 16, v121
    v_and_b32 v174, 0xffff0000, v121
    v_fmac_f32 v166, v172, v173
    v_fmac_f32 v167, v172, v174
    v_lshlrev_b32 v173, 16, v122
    v_and_b32 v174, 0xffff0000, v122
    v_fmac_f32 v168, v172, v173
    v_fmac_f32 v169, v172, v174
    v_lshlrev_b32 v173, 16, v123
    v_and_b32 v174, 0xffff0000, v123
    v_fmac_f32 v170, v172, v173
    v_fmac_f32 v171, v172, v174
    v_lshlrev_b32 v172, 16, v77
    v_lshlrev_b32 v173, 16, v124
    v_and_b32 v174, 0xffff0000, v124
    v_fmac_f32 v164, v172, v173
    v_fmac_f32 v165, v172, v174
    v_lshlrev_b32 v173, 16, v125
    v_and_b32 v174, 0xffff0000, v125
    v_fmac_f32 v166, v172, v173
    v_fmac_f32 v167, v172, v174
    v_lshlrev_b32 v173, 16, v126
    v_and_b32 v174, 0xffff0000, v126
    v_fmac_f32 v168, v172, v173
    v_fmac_f32 v169, v172, v174
    v_lshlrev_b32 v173, 16, v127
    v_and_b32 v174, 0xffff0000, v127
    v_fmac_f32 v170, v172, v173
    v_fmac_f32 v171, v172, v174
    v_and_b32 v172, 0xffff0000, v77
    v_lshlrev_b32 v173, 16, v128
    v_and_b32 v174, 0xffff0000, v128
    v_fmac_f32 v164, v172, v173
    v_fmac_f32 v165, v172, v174
    v_lshlrev_b32 v173, 16, v129
    v_and_b32 v174, 0xffff0000, v129
    v_fmac_f32 v166, v172, v173
    v_fmac_f32 v167, v172, v174
    v_lshlrev_b32 v173, 16, v130
    v_and_b32 v174, 0xffff0000, v130
    v_fmac_f32 v168, v172, v173
    v_fmac_f32 v169, v172, v174
    v_lshlrev_b32 v173, 16, v131
    v_and_b32 v174, 0xffff0000, v131
    v_fmac_f32 v170, v172, v173
    v_fmac_f32 v171, v172, v174
    v_cvt_pk_bf16_f32 v176, v164, v165
    v_cvt_pk_bf16_f32 v177, v166, v167
    v_cvt_pk_bf16_f32 v178, v168, v169
    v_cvt_pk_bf16_f32 v179, v170, v171
    ds_write_b128 v97, v[176:179]
    s_waitcnt vmcnt(4)
    v_lshlrev_b32 v172, 16, v84
    v_lshlrev_b32 v173, 16, v132
    v_and_b32 v174, 0xffff0000, v132
    v_mul_f32 v164, v172, v173
    v_mul_f32 v165, v172, v174
    v_lshlrev_b32 v173, 16, v133
    v_and_b32 v174, 0xffff0000, v133
    v_mul_f32 v166, v172, v173
    v_mul_f32 v167, v172, v174
    v_lshlrev_b32 v173, 16, v134
    v_and_b32 v174, 0xffff0000, v134
    v_mul_f32 v168, v172, v173
    v_mul_f32 v169, v172, v174
    v_lshlrev_b32 v173, 16, v135
    v_and_b32 v174, 0xffff0000, v135
    v_mul_f32 v170, v172, v173
    v_mul_f32 v171, v172, v174
    v_and_b32 v172, 0xffff0000, v84
    v_lshlrev_b32 v173, 16, v136
    v_and_b32 v174, 0xffff0000, v136
    v_fmac_f32 v164, v172, v173
    v_fmac_f32 v165, v172, v174
    v_lshlrev_b32 v173, 16, v137
    v_and_b32 v174, 0xffff0000, v137
    v_fmac_f32 v166, v172, v173
    v_fmac_f32 v167, v172, v174
    v_lshlrev_b32 v173, 16, v138
    v_and_b32 v174, 0xffff0000, v138
    v_fmac_f32 v168, v172, v173
    v_fmac_f32 v169, v172, v174
    v_lshlrev_b32 v173, 16, v139
    v_and_b32 v174, 0xffff0000, v139
    v_fmac_f32 v170, v172, v173
    v_fmac_f32 v171, v172, v174
    v_lshlrev_b32 v172, 16, v85
    v_lshlrev_b32 v173, 16, v140
    v_and_b32 v174, 0xffff0000, v140
    v_fmac_f32 v164, v172, v173
    v_fmac_f32 v165, v172, v174
    v_lshlrev_b32 v173, 16, v141
    v_and_b32 v174, 0xffff0000, v141
    v_fmac_f32 v166, v172, v173
    v_fmac_f32 v167, v172, v174
    v_lshlrev_b32 v173, 16, v142
    v_and_b32 v174, 0xffff0000, v142
    v_fmac_f32 v168, v172, v173
    v_fmac_f32 v169, v172, v174
    v_lshlrev_b32 v173, 16, v143
    v_and_b32 v174, 0xffff0000, v143
    v_fmac_f32 v170, v172, v173
    v_fmac_f32 v171, v172, v174
    v_and_b32 v172, 0xffff0000, v85
    v_lshlrev_b32 v173, 16, v144
    v_and_b32 v174, 0xffff0000, v144
    v_fmac_f32 v164, v172, v173
    v_fmac_f32 v165, v172, v174
    v_lshlrev_b32 v173, 16, v145
    v_and_b32 v174, 0xffff0000, v145
    v_fmac_f32 v166, v172, v173
    v_fmac_f32 v167, v172, v174
    v_lshlrev_b32 v173, 16, v146
    v_and_b32 v174, 0xffff0000, v146
    v_fmac_f32 v168, v172, v173
    v_fmac_f32 v169, v172, v174
    v_lshlrev_b32 v173, 16, v147
    v_and_b32 v174, 0xffff0000, v147
    v_fmac_f32 v170, v172, v173
    v_fmac_f32 v171, v172, v174
    v_cvt_pk_bf16_f32 v176, v164, v165
    v_cvt_pk_bf16_f32 v177, v166, v167
    v_cvt_pk_bf16_f32 v178, v168, v169
    v_cvt_pk_bf16_f32 v179, v170, v171
    ds_write_b128 v98, v[176:179]
    s_waitcnt vmcnt(0)
    v_lshlrev_b32 v172, 16, v92
    v_lshlrev_b32 v173, 16, v148
    v_and_b32 v174, 0xffff0000, v148
    v_mul_f32 v164, v172, v173
    v_mul_f32 v165, v172, v174
    v_lshlrev_b32 v173, 16, v149
    v_and_b32 v174, 0xffff0000, v149
    v_mul_f32 v166, v172, v173
    v_mul_f32 v167, v172, v174
    v_lshlrev_b32 v173, 16, v150
    v_and_b32 v174, 0xffff0000, v150
    v_mul_f32 v168, v172, v173
    v_mul_f32 v169, v172, v174
    v_lshlrev_b32 v173, 16, v151
    v_and_b32 v174, 0xffff0000, v151
    v_mul_f32 v170, v172, v173
    v_mul_f32 v171, v172, v174
    v_and_b32 v172, 0xffff0000, v92
    v_lshlrev_b32 v173, 16, v152
    v_and_b32 v174, 0xffff0000, v152
    v_fmac_f32 v164, v172, v173
    v_fmac_f32 v165, v172, v174
    v_lshlrev_b32 v173, 16, v153
    v_and_b32 v174, 0xffff0000, v153
    v_fmac_f32 v166, v172, v173
    v_fmac_f32 v167, v172, v174
    v_lshlrev_b32 v173, 16, v154
    v_and_b32 v174, 0xffff0000, v154
    v_fmac_f32 v168, v172, v173
    v_fmac_f32 v169, v172, v174
    v_lshlrev_b32 v173, 16, v155
    v_and_b32 v174, 0xffff0000, v155
    v_fmac_f32 v170, v172, v173
    v_fmac_f32 v171, v172, v174
    v_lshlrev_b32 v172, 16, v93
    v_lshlrev_b32 v173, 16, v156
    v_and_b32 v174, 0xffff0000, v156
    v_fmac_f32 v164, v172, v173
    v_fmac_f32 v165, v172, v174
    v_lshlrev_b32 v173, 16, v157
    v_and_b32 v174, 0xffff0000, v157
    v_fmac_f32 v166, v172, v173
    v_fmac_f32 v167, v172, v174
    v_lshlrev_b32 v173, 16, v158
    v_and_b32 v174, 0xffff0000, v158
    v_fmac_f32 v168, v172, v173
    v_fmac_f32 v169, v172, v174
    v_lshlrev_b32 v173, 16, v159
    v_and_b32 v174, 0xffff0000, v159
    v_fmac_f32 v170, v172, v173
    v_fmac_f32 v171, v172, v174
    v_and_b32 v172, 0xffff0000, v93
    v_lshlrev_b32 v173, 16, v160
    v_and_b32 v174, 0xffff0000, v160
    v_fmac_f32 v164, v172, v173
    v_fmac_f32 v165, v172, v174
    v_lshlrev_b32 v173, 16, v161
    v_and_b32 v174, 0xffff0000, v161
    v_fmac_f32 v166, v172, v173
    v_fmac_f32 v167, v172, v174
    v_lshlrev_b32 v173, 16, v162
    v_and_b32 v174, 0xffff0000, v162
    v_fmac_f32 v168, v172, v173
    v_fmac_f32 v169, v172, v174
    v_lshlrev_b32 v173, 16, v163
    v_and_b32 v174, 0xffff0000, v163
    v_fmac_f32 v170, v172, v173
    v_fmac_f32 v171, v172, v174
    v_cvt_pk_bf16_f32 v176, v164, v165
    v_cvt_pk_bf16_f32 v177, v166, v167
    v_cvt_pk_bf16_f32 v178, v168, v169
    v_cvt_pk_bf16_f32 v179, v170, v171
    ds_write_b128 v99, v[176:179]
    s_add_u32 s83, s83, 1024
    s_cmp_lt_u32 s83, 1728
    s_cbranch_scc1 L_s2
    s_waitcnt lgkmcnt(0)
    s_barrier
    s_cmp_ge_u32 s3, 2
    s_cbranch_scc1 L_s3
    v_mad_u32_u24 v40, v2, s42, v4
    ds_read_b128 v[112:115], v40 offset:0
    ds_read_b128 v[116:119], v40 offset:64
    ds_read_b128 v[120:123], v40 offset:128
    s_waitcnt lgkmcnt(0)
    v_mfma_f32_16x16x32_bf16 v[64:67], a[0:3], v[112:115], 0
    v_mfma_f32_16x16x32_bf16 v[68:71], a[4:7], v[112:115], 0
    v_mfma_f32_16x16x32_bf16 v[72:75], a[8:11], v[112:115], 0
    v_mfma_f32_16x16x32_bf16 v[64:67], a[12:15], v[116:119], v[64:67]
    v_mfma_f32_16x16x32_bf16 v[68:71], a[16:19], v[116:119], v[68:71]
    v_mfma_f32_16x16x32_bf16 v[72:75], a[20:23], v[116:119], v[72:75]
    v_mfma_f32_16x16x32_bf16 v[64:67], a[24:27], v[120:123], v[64:67]
    v_mfma_f32_16x16x32_bf16 v[68:71], a[28:31], v[120:123], v[68:71]
    v_mfma_f32_16x16x32_bf16 v[72:75], a[32:35], v[120:123], v[72:75]
    s_nop 1
    ds_read_b128 v[112:115], v40 offset:3072
    ds_read_b128 v[116:119], v40 offset:3136
    ds_read_b128 v[120:123], v40 offset:3200
    s_waitcnt lgkmcnt(0)
    v_mfma_f32_16x16x32_bf16 v[64:67], a[36:39], v[112:115], v[64:67]
    v_mfma_f32_16x16x32_bf16 v[68:71], a[40:43], v[112:115], v[68:71]
    v_mfma_f32_16x16x32_bf16 v[72:75], a[44:47], v[112:115], v[72:75]
    v_mfma_f32_16x16x32_bf16 v[64:67], a[48:51], v[116:119], v[64:67]
    v_mfma_f32_16x16x32_bf16 v[68:71], a[52:55], v[116:119], v[68:71]
    v_mfma_f32_16x16x32_bf16 v[72:75], a[56:59], v[116:119], v[72:75]
    v_mfma_f32_16x16x32_bf16 v[64:67], a[60:63], v[120:123], v[64:67]
    v_mfma_f32_16x16x32_bf16 v[68:71], a[64:67], v[120:123], v[68:71]
    v_mfma_f32_16x16x32_bf16 v[72:75], a[68:71], v[120:123], v[72:75]
    s_nop 1
    ds_read_b128 v[112:115], v40 offset:6144
    ds_read_b128 v[116:119], v40 offset:6208
    ds_read_b128 v[120:123], v40 offset:6272
    s_waitcnt lgkmcnt(0)
    v_mfma_f32_16x16x32_bf16 v[64:67], a[72:75], v[112:115], v[64:67]
    v_mfma_f32_16x16x32_bf16 v[68:71], a[76:79], v[112:115], v[68:71]
    v_mfma_f32_16x16x32_bf16 v[72:75], a[80:83], v[112:115], v[72:75]
    v_mfma_f32_16x16x32_bf16 v[64:67], a[84:87], v[116:119], v[64:67]
    v_mfma_f32_16x16x32_bf16 v[68:71], a[88:91], v[116:119], v[68:71]
    v_mfma_f32_16x16x32_bf16 v[72:75], a[92:95], v[116:119], v[72:75]
    v_mfma_f32_16x16x32_bf16 v[64:67], a[96:99], v[120:123], v[64:67]
    v_mfma_f32_16x16x32_bf16 v[68:71], a[100:103], v[120:123], v[68:71]
    v_mfma_f32_16x16x32_bf16 v[72:75], a[104:107], v[120:123], v[72:75]
    s_nop 1
    ds_read_b128 v[112:115], v40 offset:9216
    ds_read_b128 v[116:119], v40 offset:9280
    ds_read_b128 v[120:123], v40 offset:9344
    s_waitcnt lgkmcnt(0)
    v_mfma_f32_16x16x32_bf16 v[64:67], a[108:111], v[112:115], v[64:67]
    v_mfma_f32_16x16x32_bf16 v[68:71], a[112:115], v[112:115], v[68:71]
    v_mfma_f32_16x16x32_bf16 v[72:75], a[116:119], v[112:115], v[72:75]
    v_mfma_f32_16x16x32_bf16 v[64:67], a[120:123], v[116:119], v[64:67]
    v_mfma_f32_16x16x32_bf16 v[68:71], a[124:127], v[116:119], v[68:71]
    v_mfma_f32_16x16x32_bf16 v[72:75], a[128:131], v[116:119], v[72:75]
    v_mfma_f32_16x16x32_bf16 v[64:67], a[132:135], v[120:123], v[64:67]
    v_mfma_f32_16x16x32_bf16 v[68:71], a[136:139], v[120:123], v[68:71]
    v_mfma_f32_16x16x32_bf16 v[72:75], a[140:143], v[120:123], v[72:75]
    s_nop 1
    ds_read_b128 v[112:115], v40 offset:12288
    ds_read_b128 v[116:119], v40 offset:12352
    ds_read_b128 v[120:123], v40 offset:12416
    s_waitcnt lgkmcnt(0)
    v_mfma_f32_16x16x32_bf16 v[64:67], a[144:147], v[112:115], v[64:67]
    v_mfma_f32_16x16x32_bf16 v[68:71], a[148:151], v[112:115], v[68:71]
    v_mfma_f32_16x16x32_bf16 v[72:75], a[152:155], v[112:115], v[72:75]
    v_mfma_f32_16x16x32_bf16 v[64:67], a[156:159], v[116:119], v[64:67]
    v_mfma_f32_16x16x32_bf16 v[68:71], a[160:163], v[116:119], v[68:71]
    v_mfma_f32_16x16x32_bf16 v[72:75], a[164:167], v[116:119], v[72:75]
    v_mfma_f32_16x16x32_bf16 v[64:67], a[168:171], v[120:123], v[64:67]
    v_mfma_f32_16x16x32_bf16 v[68:71], a[172:175], v[120:123], v[68:71]
    v_mfma_f32_16x16x32_bf16 v[72:75], a[176:179], v[120:123], v[72:75]
    s_nop 1
    ds_read_b128 v[112:115], v40 offset:15360
    ds_read_b128 v[116:119], v40 offset:15424
    ds_read_b128 v[120:123], v40 offset:15488
    s_waitcnt lgkmcnt(0)
    v_mfma_f32_16x16x32_bf16 v[64:67], a[180:183], v[112:115], v[64:67]
    v_mfma_f32_16x16x32_bf16 v[68:71], a[184:187], v[112:115], v[68:71]
    v_mfma_f32_16x16x32_bf16 v[72:75], a[188:191], v[112:115], v[72:75]
    v_mfma_f32_16x16x32_bf16 v[64:67], a[192:195], v[116:119], v[64:67]
    v_mfma_f32_16x16x32_bf16 v[68:71], a[196:199], v[116:119], v[68:71]
    v_mfma_f32_16x16x32_bf16 v[72:75], a[200:203], v[116:119], v[72:75]
    v_mfma_f32_16x16x32_bf16 v[64:67], a[204:207], v[120:123], v[64:67]
    v_mfma_f32_16x16x32_bf16 v[68:71], a[208:211], v[120:123], v[68:71]
    v_mfma_f32_16x16x32_bf16 v[72:75], a[212:215], v[120:123], v[72:75]
    s_nop 1
    ds_read_b128 v[112:115], v40 offset:18432
    ds_read_b128 v[116:119], v40 offset:18496
    ds_read_b128 v[120:123], v40 offset:18560
    s_waitcnt lgkmcnt(0)
    v_mfma_f32_16x16x32_bf16 v[64:67], a[216:219], v[112:115], v[64:67]
    v_mfma_f32_16x16x32_bf16 v[68:71], a[220:223], v[112:115], v[68:71]
    v_mfma_f32_16x16x32_bf16 v[72:75], a[224:227], v[112:115], v[72:75]
    v_mfma_f32_16x16x32_bf16 v[64:67], a[228:231], v[116:119], v[64:67]
    v_mfma_f32_16x16x32_bf16 v[68:71], a[232:235], v[116:119], v[68:71]
    v_mfma_f32_16x16x32_bf16 v[72:75], a[236:239], v[116:119], v[72:75]
    v_mfma_f32_16x16x32_bf16 v[64:67], a[240:243], v[120:123], v[64:67]
    v_mfma_f32_16x16x32_bf16 v[68:71], a[244:247], v[120:123], v[68:71]
    v_mfma_f32_16x16x32_bf16 v[72:75], a[248:251], v[120:123], v[72:75]
    s_nop 1
    ds_read_b128 v[112:115], v40 offset:21504
    ds_read_b128 v[116:119], v40 offset:21568
    ds_read_b128 v[120:123], v40 offset:21632
    s_waitcnt lgkmcnt(0)
    v_mfma_f32_16x16x32_bf16 v[64:67], a[252:255], v[112:115], v[64:67]
    v_mfma_f32_16x16x32_bf16 v[68:71], v[188:191], v[112:115], v[68:71]
    v_mfma_f32_16x16x32_bf16 v[72:75], v[192:195], v[112:115], v[72:75]
    v_mfma_f32_16x16x32_bf16 v[64:67], v[196:199], v[116:119], v[64:67]
    v_mfma_f32_16x16x32_bf16 v[68:71], v[200:203], v[116:119], v[68:71]
    v_mfma_f32_16x16x32_bf16 v[72:75], v[204:207], v[116:119], v[72:75]
    v_mfma_f32_16x16x32_bf16 v[64:67], v[208:211], v[120:123], v[64:67]
    v_mfma_f32_16x16x32_bf16 v[68:71], v[212:215], v[120:123], v[68:71]
    v_mfma_f32_16x16x32_bf16 v[72:75], v[216:219], v[120:123], v[72:75]
    s_nop 1
    ds_read_b128 v[112:115], v40 offset:24576
    ds_read_b128 v[116:119], v40 offset:24640
    ds_read_b128 v[120:123], v40 offset:24704
    s_waitcnt lgkmcnt(0)
    v_mfma_f32_16x16x32_bf16 v[64:67], v[220:223], v[112:115], v[64:67]
    v_mfma_f32_16x16x32_bf16 v[68:71], v[224:227], v[112:115], v[68:71]
    v_mfma_f32_16x16x32_bf16 v[72:75], v[228:231], v[112:115], v[72:75]
    v_mfma_f32_16x16x32_bf16 v[64:67], v[232:235], v[116:119], v[64:67]
    v_mfma_f32_16x16x32_bf16 v[68:71], v[236:239], v[116:119], v[68:71]
    v_mfma_f32_16x16x32_bf16 v[72:75], v[240:243], v[116:119], v[72:75]
    v_mfma_f32_16x16x32_bf16 v[64:67], v[244:247], v[120:123], v[64:67]
    v_mfma_f32_16x16x32_bf16 v[68:71], v[248:251], v[120:123], v[68:71]
    v_mfma_f32_16x16x32_bf16 v[72:75], v[252:255], v[120:123], v[72:75]
    s_nop 1
    s_mul_i32 s81, s81, 192
    s_cmp_lt_u32 s80, 16
    s_cselect_b64 vcc, -1, 0
    v_cndmask_b32 v40, v21, v19, vcc
    s_nop 5
    v_cvt_pk_bf16_f32 v64, v64, v65
    v_cvt_pk_bf16_f32 v65, v66, v67
    v_cvt_pk_bf16_f32 v66, v68, v69
    v_cvt_pk_bf16_f32 v67, v70, v71
    v_cvt_pk_bf16_f32 v72, v72, v73
    v_cvt_pk_bf16_f32 v73, v74, v75
    v_permlane16_swap_b32 v64, v66
    v_permlane16_swap_b32 v65, v67
    buffer_store_dwordx4 v[64:67], v40, s[20:23], s81 offen sc1
    buffer_store_dwordx2 v[72:73], v49, s[20:23], s81 offen sc1
L_s3:
    s_branch L_check
L_code_end:
L_end:
    s_endpgm
.section .rodata,"a"
.p2align 6
.amdhsa_kernel standalone__deformable_dcnv1__vision_kernel
  .amdhsa_next_free_vgpr 512
  .amdhsa_next_free_sgpr 102
  .amdhsa_accum_offset 256
  .amdhsa_group_segment_fixed_size 0
  .amdhsa_kernarg_size 48
  .amdhsa_user_sgpr_count 2
  .amdhsa_user_sgpr_kernarg_segment_ptr 1
  .amdhsa_system_sgpr_workgroup_id_x 1
  .amdhsa_float_denorm_mode_32 3
.end_amdhsa_kernel
```

```asm
; @launch grid=(256,1,1) block=(256,1,1) lds=159040

.amdgcn_target "amdgcn-amd-amdhsa--gfx950"
.text
.globl standalone__deformable_dcnv1__vision_kernel
.p2align 12
.type standalone__deformable_dcnv1__vision_kernel,@function
standalone__deformable_dcnv1__vision_kernel:
    s_cmpk_ge_u32 s2, 256
    s_cbranch_scc1 L_end
    s_load_dwordx2 s[8:9], s[0:1], 0
    s_load_dwordx2 s[16:17], s[0:1], 16
    s_load_dwordx2 s[12:13], s[0:1], 8
    s_load_dwordx2 s[20:21], s[0:1], 24
    s_getpc_b64 s[6:7]
L_pc:
    s_lshr_b32 s41, s2, 3
    v_lshrrev_b32 v144, 6, v0
    s_mul_i32 s40, s41, 768
    v_lshl_add_u32 v145, v0, 2, s40
    v_readfirstlane_b32 s3, v144
    global_load_dword v37, v145, s[6:7]
    s_and_b32 s85, s2, 7
    s_lshl_b32 s85, s85, 5
    s_add_u32 s85, s85, s41
    s_add_u32 s81, s85, 8
    s_mul_i32 s80, s81, 2731
    s_lshr_b32 s80, s80, 16
    s_mul_i32 s86, s80, 24
    s_sub_u32 s81, s81, s86
    s_cmp_lt_u32 s80, 3
    s_cselect_b32 s82, 16, 20
    s_cselect_b32 s83, 4, 8
    s_cmp_eq_u32 s80, 0
    s_cselect_b32 s82, 8, s82
    s_cselect_b32 s83, 5, s83
    s_cselect_b32 s86, -1, 47
    s_sub_u32 s84, s81, s82
    s_cselect_b32 s46, 0, s83
    s_mul_i32 s44, s81, 6
    s_mul_i32 s40, s84, s46
    s_add_u32 s86, s86, s44
    s_add_u32 s86, s86, s40
    s_mul_i32 s86, s86, 14
    s_add_u32 s44, s86, s80
    s_mulk_i32 s44, 3072
    s_addk_i32 s44, 9024
    v_and_b32 v1, 63, v0
    s_lshl2_add_u32 s41, s41, s3

    s_mulk_i32 s41, 1296
    v_min_u32 v70, 10, v1
    s_lshl_b32 s40, s3, 6
    v_lshl_add_u32 v70, v70, 7, s41
    s_min_u32 s40, s40, 152
    v_add_u32 v144, s40, v1
    s_lshl4_add_u32 s25, s40, 61440
    v_mul_u32_u24 v64, 5462, v144
    v_lshlrev_b32 v144, 4, v144
    v_lshrrev_b32 v64, 13, v64
    v_bitop3_b32 v8, v64, 32, v144 bitop3:0x6a
    v_lshlrev_b32 v5, 4, v1
    v_and_b32 v144, 32, v1
    v_xor_b32 v7, 32, v5
    v_xor_b32 v6, v144, v5
    s_mul_i32 s24, s3, 3072
    s_mov_b32 s41, 43008
    s_mov_b32 s10, 9633792
    s_mov_b32 s11, 0x20000
    s_mov_b32 s18, 165888
    s_mov_b32 s19, s11
    s_add_u32 m0, s24, 24576
    s_waitcnt lgkmcnt(0)
    buffer_load_dword v37, v70, s[16:19], 0 offen
    buffer_load_dwordx4 v5, s[16:19], s24 offen lds
    buffer_load_dwordx4 v6, s[16:19], s24 offen offset:1024 lds
    buffer_load_dwordx4 v7, s[16:19], s24 offen offset:2048 lds
    s_mov_b32 m0, s25
    s_lshr_b32 s57, s3, 1
    buffer_load_dwordx4 v8, s[8:11], s44 offen  lds
    s_addk_i32 m0, 10368
    s_add_u32 s31, s44, 129024
    buffer_load_dwordx4 v8, s[8:11], s31 offen  lds
    s_add_u32 m0, s24, 36864
    s_add_u32 s31, s24, 12288
    buffer_load_dwordx4 v5, s[16:19], s31 offen lds
    buffer_load_dwordx4 v6, s[16:19], s31 offen offset:1024 lds
    buffer_load_dwordx4 v7, s[16:19], s31 offen offset:2048 lds
    s_add_u32 m0, s25, 3456
    s_add_u32 s31, s44, 43008
    buffer_load_dwordx4 v8, s[8:11], s31 offen  lds
    s_addk_i32 m0, 10368
    s_add_u32 s31, s44, 172032
    buffer_load_dwordx4 v8, s[8:11], s31 offen  lds
L_issued:
    v_and_b32 v4, 48, v0
    s_add_u32 s86, s86, s80
    s_and_b32 s2, s3, 1
    s_lshl4_add_u32 s45, s86, 272
    s_mov_b32 s14, 1806336
    s_mov_b32 s15, 0x20000
    s_mov_b32 s22, 9633792
    s_mov_b32 s23, 0x20000
    s_mul_i32 s40, s2, 3072
    s_mul_i32 s26, s57, -104448
    s_add_u32 s26, s26, s40
    s_mul_i32 s27, s57, 6144
    s_add_u32 s27, s27, s40
    s_mul_i32 s28, s57, 55296
    s_add_u32 s28, s28, s40
    s_cmp_eq_u32 s46, 8
    s_cbranch_scc1 L_x
    v_mul_u32_u24 v65, 7282, v1
    s_mul_i32 s85, s82, s80
    s_mul_i32 s86, s83, 3
    v_lshrrev_b32 v65, 16, v65
    s_add_u32 s85, s85, s81
    s_sub_u32 s85, s85, s86
    v_mad_i32_i24 v66, v65, -9, v1
    s_cmp_ge_i32 s85, 92
    s_cselect_b32 s86, -168, 40
    s_cselect_b32 s47, 1, 0
    s_cselect_b32 s52, 8064, 36
    s_cselect_b32 s41, 36, 8064
    v_lshl_add_u32 v67, v65, 2, s3
    s_lshl1_add_u32 s53, s85, s86
    s_lshl3_add_u32 s86, s80, s84
    s_lshl_b32 s86, s86, 1
    v_lshlrev_b32 v71, 2, v66
    s_cmp_eq_u32 s46, 4
    s_cselect_b32 s53, s86, s53
    s_sub_u32 s86, s84, 1
    v_mad_u32_u24 v71, v67, s52, v71
    s_cmp_eq_u32 s46, 5
    s_cselect_b32 s53, s86, s53
    s_cselect_b32 s86, 0x7f000000, 0
    s_mul_i32 s40, s52, 24
    s_cmp_eq_u32 s46, 0
    s_cselect_b32 s40, s40, 0x7f000000
    s_cselect_b32 s85, 54, 36
    v_cmp_gt_u32 vcc, s85, v1
    v_mov_b32 v146, 0x7f000000
    s_mul_i32 s48, s53, s41
    s_add_u32 s49, s48, s41
    v_cndmask_b32 v71, v146, v71, vcc
    s_add_u32 s50, s48, s40
    s_add_u32 s51, s49, s40
    s_add_u32 s48, s48, s86
    buffer_load_dword v176, v71, s[12:15], s48 offen
    buffer_load_dword v177, v71, s[12:15], s49 offen
    buffer_load_dword v178, v71, s[12:15], s50 offen
    buffer_load_dword v179, v71, s[12:15], s51 offen
    v_and_b32 v2, 15, v0
    s_mul_i32 s54, s47, 42816
    s_addk_i32 s54, 192
    v_mul_u32_u24 v68, 11, v66
    v_lshrrev_b32 v68, 5, v68
    v_mad_i32_i24 v69, v68, -3, v66
    s_mov_b32 s60, 0x435f435f
    s_mov_b32 s59, 0x03020c0c
    s_cmp_eq_u32 s47, 0
    s_cselect_b32 s58, 0x01000c0c, s59
    s_cselect_b32 s59, s59, 0x01000c0c
    s_cselect_b64 vcc, -1, 0
    v_cndmask_b32 v144, v69, v68, vcc
    v_cndmask_b32 v145, v68, v69, vcc
    v_add3_u32 v144, s53, v144, -1
    v_add3_u32 v145, v67, v145, -1
    v_cvt_f32_i32 v100, v144
    v_cvt_f32_i32 v102, v145
    v_add_f32 v101, 1.0, v100
    v_add_f32 v103, 0x41c00000, v102
    s_mov_b32 s40, 0x435f0000
    v_med3_f32 v144, v100, 0, s40
    v_med3_f32 v145, v101, 0, s40
    v_med3_f32 v146, v102, 0, s40
    v_med3_f32 v147, v103, 0, s40
    v_cvt_pk_bf16_f32 v105, v145, v146
    v_cvt_pk_bf16_f32 v104, v144, v146
    v_cvt_pk_bf16_f32 v106, v144, v147
    v_cvt_pk_bf16_f32 v107, v145, v147
    v_mul_u32_u24 v168, 12, v67
    v_readfirstlane_b32 s41, v105
    v_add_lshl_u32 v168, v168, v66, 2
    v_lshlrev_b32 v110, 3, v0
    v_lshlrev_b32 v162, 2, v1
    v_mov_b32 v163, s41
    v_add_u32 v110, 156928, v110
    s_mov_b64 exec, 0
    s_cmp_eq_u32 s3, 0
    s_cbranch_scc1 L_pgY0
    s_cmp_eq_u32 s3, 1
    s_cbranch_scc1 L_pgY1
    s_cmp_eq_u32 s3, 2
    s_cbranch_scc1 L_pgY2
L_retY:
    s_mov_b64 exec, -1
    v_add_u32 v162, 148992, v162
    ds_write_b64 v110, v[162:163]
    s_mul_i32 s40, s57, 3072
    s_add_u32 s40, s40, 146688
    v_mad_u32_u24 v23, v2, 48, s40
    s_sub_u32 s61, 43200, s54
    s_cmp_lt_u32 s45, 14784
    s_cselect_b32 s37, 0, 0x80
    s_cmp_lt_u32 s80, 2
    s_cselect_b32 s40, 0, 0x800000
    s_or_b32 s37, s37, s40
    s_or_b32 s37, s37, 0x3e003e00
    s_mul_i32 s35, s46, 3456
    s_add_u32 s35, s35, 89088
    s_add_u32 s43, s53, s57
    s_mul_i32 s76, s43, s61
    s_cmp_lg_u32 s46, 0
    s_cbranch_scc1 L_mc
    s_mov_b32 s41, 0x7f000000
    s_cmp_lt_u32 s53, 34
    s_cselect_b32 s39, 768, s41
    s_cselect_b32 s33, 6, 4
    s_subb_u32 s32, s53, 1
    s_movk_i32 s34, 9600
    s_movk_i32 s36, 50
    s_mov_b32 s38, 0x770000
    s_lshl_b32 s40, s54, 4
    s_add_u32 s75, s76, s40
    s_add_u32 s74, s75, s40
    s_add_u32 s65, s32, s3
    s_min_u32 s65, s65, 223
    s_mul_i32 s65, s65, s61
    s_add_u32 s67, s65, s40
    s_add_u32 s69, s67, s40
    s_mul_i32 s64, s3, s34
    s_add_u32 s64, s64, s35
    s_add_u32 s66, s64, 3072
    s_add_u32 s68, s64, 6144
    s_sub_u32 s43, s43, s32
    s_mul_i32 s43, s43, s34
    s_add_u32 s77, s43, 0x80015c00
    s_add_u32 s78, s77, 0x400000
    s_add_u32 s79, s77, 0x800000
    s_branch L_mc_back
L_mc:
    s_mov_b32 s39, 0x7f000000
    s_sub_u32 s33, 10, s46
    s_add_u32 s32, s53, s46
    s_sub_u32 s32, s32, 6
    s_max_i32 s32, s32, 0
    s_movk_i32 s34, 3456
    s_movk_i32 s36, 18
    s_mul_i32 s64, s3, 3456
    s_add_u32 s64, s64, 89088
    s_add_u32 s66, s64, 13824
    s_add_u32 s68, s64, 27648
    s_min_u32 s68, s68, 123648
    s_mul_i32 s40, s80, 3072
    s_add_u32 s40, s40, 9599808
    s_add_u32 s69, s3, 8
    s_mul_i32 s65, s69, s61
    s_add_u32 s65, s65, s44
    s_min_u32 s65, s65, s40
    s_add_u32 s41, s44, 516096
    s_min_u32 s41, s41, s40
    s_sub_u32 s40, s69, s46
    s_add_u32 s69, s40, s32
    s_mul_i32 s69, s69, s61
    s_sub_u32 s67, s69, 172032
    s_cmp_lt_u32 s40, 4
    s_cselect_b32 s67, s41, s67
    s_mul_i32 s40, s57, 43008
    s_add_u32 s40, s44, s40
    s_add_u32 s74, s40, 301248
    s_add_u32 s75, s40, 387264
    s_add_u32 s40, s40, 473280
    s_mul_i32 s79, s57, 3456
    s_add_u32 s79, s79, 0x80054e80
    s_add_u32 s78, s79, 6912
    s_add_u32 s41, s79, 13824
    s_sub_u32 s77, s43, s32
    s_mul_i32 s77, s77, 3456
    s_add_u32 s77, s77, s35
    s_cmp_eq_u32 s43, 0
    s_cselect_b32 s43, 0, 0x80000000
    s_or_b32 s77, s77, s43
    s_sub_u32 s38, 21, s46
    s_lshl_b32 s38, s38, 16
    s_sub_u32 s43, s46, s57
    s_cmp_eq_u32 s43, 5
    s_cselect_b32 s76, s40, s76
    s_cselect_b32 s77, s41, s77
L_mc_back:
    v_mov_b32 v84, s79
    s_mov_b32 exec_hi, 0
    v_mov_b32 v84, s78
    s_mov_b32 exec_lo, 0xffff
    v_mov_b32 v84, s77
    s_mov_b64 exec, -1
    v_bfe_u32 v155, v84, 18, 6
    v_and_b32 v148, 0x3ffff, v84
    v_ashrrev_i32 v147, 31, v84
    v_add_lshl_u32 v155, v155, v2, 3
    v_add_u32 v149, s34, v148
    v_mad_i32_i24 v147, v147, s34, v148
    v_add_u32 v154, -8, v155
    v_add_u32 v156, 8, v155
    v_max_i32 v154, 0, v154
    v_and_b32 v144, 32, v154
    v_mad_u32_u24 v144, v154, 24, v144
    v_and_b32 v145, 32, v155
    v_mad_u32_u24 v145, v155, 24, v145
    v_and_b32 v146, 32, v156
    v_mad_u32_u24 v146, v156, 24, v146
    s_cmp_eq_u32 s47, 0
    s_cbranch_scc1 L_notr
    v_swap_b32 v144, v147
    v_swap_b32 v145, v148
    v_swap_b32 v146, v149
L_notr:
    v_add_u32 v88, v147, v144
    v_add_u32 v89, v147, v145
    v_add_u32 v90, v147, v146
    v_add_u32 v91, v148, v144
    v_add_u32 v92, v148, v145
    v_add_u32 v93, v148, v146
    v_add_u32 v94, v149, v144
    v_add_u32 v95, v149, v145
    v_add_u32 v96, v149, v146
    v_mad_u32_u24 v144, v4, 48, v23
    ds_write_b128 v144, v[88:91]
    ds_write_b128 v144, v[92:95] offset:16
    s_add_u32 m0, s25, 6912
    s_add_u32 s31, s44, 86016
    buffer_load_dwordx4 v8, s[8:11], s31 offen  lds
    ds_write_b32 v144, v96 offset:32
    v_lshrrev_b32 v3, 4, v1
    s_movk_i32 s42, 192
    v_mov_b32 v34, 158976
    v_mov_b32 v147, 0
    ds_write_b32 v34, v147
    v_bfe_u32 v144, v1, 2, 2
    s_add_u32 m0, s25, 17280
    s_add_u32 s31, s44, 215040
    buffer_load_dwordx4 v8, s[8:11], s31 offen  lds
    v_lshl_add_u32 v144, v3, 3, v144
    v_lshrrev_b32 v145, 2, v1
    v_mul_u32_u24 v144, 192, v144
    v_bfi_b32 v145, 3, v1, v145
    s_lshl_b32 s40, s2, 5
    v_and_b32 v145, 7, v145
    v_lshl_add_u32 v144, v145, 3, v144
    s_mul_i32 s31, s57, 3456
    s_add_u32 s31, s31, s24
    s_add_u32 m0, s31, 127488
    s_add_u32 s31, s28, 55296
    buffer_load_dwordx4 v5, s[16:19], s31 offen lds
    v_xad_u32 v15, v144, s40, 64
    v_lshl_add_u32 v13, s2, 7, v144
    s_mul_i32 s40, s57, 10368
    v_xor_b32 v14, 32, v13
    s_add_u32 s40, s40, 61440
    s_cmp_eq_u32 s80, 10
    s_cselect_b32 s41, 16, 17
    buffer_load_dwordx4 v6, s[16:19], s31 offen offset:1024 lds
    v_add_u32 v144, 2, v2
    v_add_u32 v147, s40, v4
    v_min_u32 v144, s41, v144
    v_lshl_add_u32 v144, v144, 3, 0
    v_bitop3_b32 v145, v144, 32, v147 bitop3:0x6a
    v_mad_u32_u24 v18, v144, 24, v145
    v_lshl_add_u32 v144, v2, 3, 8
    buffer_load_dwordx4 v7, s[16:19], s31 offen offset:2048 lds
    v_bitop3_b32 v145, v144, 32, v147 bitop3:0x6a
    v_mad_u32_u24 v17, v144, 24, v145
    v_lshl_add_u32 v144, v2, 3, 0
    v_bitop3_b32 v145, v144, 32, v147 bitop3:0x6a
    v_mad_u32_u24 v16, v144, 24, v145
    v_mul_u32_u24 v144, 5462, v1
    s_sub_u32 s40, s54, 192
    s_waitcnt vmcnt(16)
    s_barrier
    s_add_u32 m0, s25, 20736
    s_add_u32 s31, s44, 258048
    buffer_load_dwordx4 v8, s[8:11], s31 offen  lds
    ds_read_b64_tr_b16 a[0:1], v13 offset:24576
    ds_read_b64_tr_b16 a[2:3], v13 offset:25344
    ds_read_b64_tr_b16 a[4:5], v14 offset:24576
    ds_read_b64_tr_b16 a[6:7], v14 offset:25344
    ds_read_b64_tr_b16 a[8:9], v15 offset:24576
    ds_read_b64_tr_b16 a[10:11], v15 offset:25344
    ds_read_b64_tr_b16 a[12:13], v13 offset:30720
    v_lshrrev_b32 v145, 13, v144
    v_bitop3_b32 v145, v145, 32, v5 bitop3:0x6a
    v_mad_u32_u16 v9, v144, s40, v145 op_sel:[1,0,0,0]
    v_add_u32 v146, 349568, v144
    v_lshrrev_b32 v145, 13, v146
    v_bitop3_b32 v145, v145, 32, v5 bitop3:0x6a
    v_mad_u32_u16 v10, v146, s40, v145 op_sel:[1,0,0,0]
    s_add_u32 m0, s25, 24192
    s_add_u32 s31, s44, 301056
    buffer_load_dwordx4 v8, s[8:11], s31 offen  lds
    ds_read_b64_tr_b16 a[14:15], v13 offset:31488
    v_add_u32 v146, 699136, v144
    ds_read_b64_tr_b16 a[16:17], v14 offset:30720
    ds_read_b64_tr_b16 a[18:19], v14 offset:31488
    ds_read_b64_tr_b16 a[20:21], v15 offset:30720
    ds_read_b64_tr_b16 a[22:23], v15 offset:31488
    v_lshrrev_b32 v145, 13, v146
    v_bitop3_b32 v145, v145, 32, v5 bitop3:0x6a
    v_mad_u32_u16 v11, v146, s40, v145 op_sel:[1,0,0,0]
    v_add_u32 v146, 830224, v144
    v_lshrrev_b32 v145, 13, v146
    v_bitop3_b32 v145, v145, 32, v5 bitop3:0x6a
    s_add_u32 m0, s24, 49152
    s_add_u32 s31, s28, 61440
    buffer_load_dwordx4 v5, s[16:19], s31 offen lds
    v_mad_u32_u16 v12, v146, s40, v145 op_sel:[1,0,0,0]
    s_cmp_eq_u32 s46, 0
    s_cselect_b64 vcc, -1, 0
    v_cndmask_b32 v50, v12, v9, vcc
    v_add_u32 v61, 127488, v13
    v_add_u32 v62, 127488, v14
    v_add_u32 v63, 127488, v15
    buffer_load_dwordx4 v6, s[16:19], s31 offen offset:1024 lds
    v_add_u32 v174, 150912, v168
    v_add_u32 v172, 147840, v168
    v_add_u32 v170, 149760, v168
    v_add_u32 v168, 146688, v168
    v_subrev_u32 v108, 36, v1
    v_lshrrev_b32 v108, 31, v108
    v_lshlrev_b32 v111, 4, v0
    buffer_load_dwordx4 v7, s[16:19], s31 offen offset:2048 lds
    v_add_u32 v111, 152832, v111
    v_mul_u32_u24 v41, 192, v2
    v_lshlrev_b32 v40, 2, v2
    v_add_u32 v41, s24, v41
    v_and_or_b32 v109, v40, 48, v41
    v_and_or_b32 v40, v40, 56, v41
    v_mul_u32_u24 v42, 768, v4
    v_xor_b32 v28, v40, v4
    v_add_u32 v109, v109, v42
    v_xor_b32 v29, 8, v28
    s_waitcnt lgkmcnt(0)
    s_waitcnt vmcnt(14)
    s_barrier
    ds_read_b128 v[112:115], v16 offset:0
    ds_read_b128 v[116:119], v16 offset:3456
    ds_read_b128 v[120:123], v16 offset:64
    ds_read_b128 v[124:127], v16 offset:3520
    s_waitcnt lgkmcnt(3)
    v_mfma_f32_16x16x32_bf16 v[64:67], a[0:3], v[112:115], 0
    s_add_u32 m0, s24, 0
    ds_read_b64_tr_b16 a[24:25], v13 offset:36864
    s_add_u32 s31, s28, 67584
    ds_read_b64_tr_b16 a[26:27], v13 offset:37632
    v_mfma_f32_16x16x32_bf16 v[68:71], a[4:7], v[112:115], 0
    s_mul_i32 s56, s46, 36
    ds_read_b64_tr_b16 a[28:29], v14 offset:36864
    buffer_load_dwordx4 v5, s[16:19], s31 offen lds
    v_mfma_f32_16x16x32_bf16 v[72:75], a[8:11], v[112:115], 0
    s_waitcnt lgkmcnt(5)
    ds_read_b64_tr_b16 a[30:31], v14 offset:37632
    s_movk_i32 s5, 7488
    ds_read_b64_tr_b16 a[32:33], v15 offset:36864
    v_mfma_f32_16x16x32_bf16 v[76:79], a[0:3], v[116:119], 0
    s_addk_i32 s56, 215
    ds_read_b64_tr_b16 a[34:35], v15 offset:37632
    v_mul_u32_u24 v30, 1821, v0
    v_mfma_f32_16x16x32_bf16 v[80:83], a[4:7], v[116:119], 0
    s_lshl_b32 s4, s3, 10
    ds_read_b128 v[128:131], v16 offset:128
    v_lshlrev_b32 v31, 4, v0
    v_mfma_f32_16x16x32_bf16 v[84:87], a[8:11], v[116:119], 0
    s_waitcnt vmcnt(11) lgkmcnt(7)
    ds_read_b64_tr_b16 a[36:37], v13 offset:43008
    buffer_load_dwordx4 v6, s[16:19], s31 offen offset:1024 lds
    v_mfma_f32_16x16x32_bf16 v[64:67], a[12:15], v[120:123], v[64:67]
    s_lshl_b32 s6, s3, 5
    ds_read_b64_tr_b16 a[38:39], v13 offset:43776
    v_perm_b32 v144, v176, v176, s58
    v_mfma_f32_16x16x32_bf16 v[68:71], a[16:19], v[120:123], v[68:71]
    s_add_u32 s6, s6, 9808
    ds_read_b64_tr_b16 a[40:41], v14 offset:43008
    v_perm_b32 v145, v176, v176, s59
    v_mfma_f32_16x16x32_bf16 v[72:75], a[20:23], v[120:123], v[72:75]
    s_add_u32 s33, s33, s32
    ds_read_b128 v[132:135], v16 offset:3584
    v_perm_b32 v146, v177, v177, s58
    v_mfma_f32_16x16x32_bf16 v[76:79], a[12:15], v[124:127], v[76:79]
    s_mul_i32 s40, s32, s34
    ds_read_b64_tr_b16 a[42:43], v14 offset:43776
    buffer_load_dwordx4 v7, s[16:19], s31 offen offset:2048 lds
    v_mfma_f32_16x16x32_bf16 v[80:83], a[16:19], v[124:127], v[80:83]
    s_add_u32 m0, s24, 12288
    ds_read_b64_tr_b16 a[44:45], v15 offset:43008
    v_perm_b32 v147, v177, v177, s59
    v_mfma_f32_16x16x32_bf16 v[84:87], a[20:23], v[124:127], v[84:87]
    s_waitcnt lgkmcnt(5)
    ds_read_b64_tr_b16 a[46:47], v15 offset:43776
    v_perm_b32 v148, v178, v178, s58
    v_mfma_f32_16x16x32_bf16 v[64:67], a[24:27], v[128:131], v[64:67]
    s_add_u32 s31, s28, 73728
    ds_read_b128 v[136:139], v17 offset:0
    v_perm_b32 v149, v178, v178, s59
    v_mfma_f32_16x16x32_bf16 v[68:71], a[28:31], v[128:131], v[68:71]
    s_sub_u32 s35, s35, s40
    ds_read_b128 v[140:143], v17 offset:3456
    buffer_load_dwordx4 v5, s[16:19], s31 offen lds
    v_mfma_f32_16x16x32_bf16 v[72:75], a[32:35], v[128:131], v[72:75]
    s_waitcnt lgkmcnt(5)
    v_perm_b32 v150, v179, v179, s58
    v_perm_b32 v151, v179, v179, s59
    v_mfma_f32_16x16x32_bf16 v[76:79], a[24:27], v[132:135], v[76:79]
    s_add_u32 s4, s4, 152832
    v_add_f32 v144, v100, v144
    v_add_f32 v145, v102, v145
    v_mfma_f32_16x16x32_bf16 v[80:83], a[28:31], v[132:135], v[80:83]
    s_mul_i32 s55, s45, 36
    v_add_f32 v146, v101, v146
    v_add_f32 v147, v102, v147
    v_mfma_f32_16x16x32_bf16 v[84:87], a[32:35], v[132:135], v[84:87]
    s_waitcnt vmcnt(9) lgkmcnt(1)
    s_barrier
    v_mfma_f32_16x16x32_bf16 v[64:67], a[36:39], v[136:139], v[64:67]
    s_mul_i32 s72, s2, 9600
    ds_read_b128 v[112:115], v16 offset:6912
    buffer_load_dwordx4 v6, s[16:19], s31 offen offset:1024 lds
    v_mfma_f32_16x16x32_bf16 v[68:71], a[40:43], v[136:139], v[68:71]
    s_add_u32 s72, s72, 127488
    ds_read_b64_tr_b16 a[108:109], v61 offset:0
    s_mul_i32 s77, s57, 1536
    ds_read_b64_tr_b16 a[110:111], v61 offset:768
    v_mfma_f32_16x16x32_bf16 v[72:75], a[44:47], v[136:139], v[72:75]
    s_waitcnt lgkmcnt(3)
    ds_read_b64_tr_b16 a[112:113], v62 offset:0
    s_lshl1_add_u32 s70, s77, s72
    ds_read_b128 v[116:119], v16 offset:6976
    v_mfma_f32_16x16x32_bf16 v[76:79], a[36:39], v[140:143], v[76:79]
    s_add_u32 s77, s77, s72
    ds_read_b64_tr_b16 a[114:115], v62 offset:768
    s_addk_i32 s77, 4608
    ds_read_b64_tr_b16 a[116:117], v63 offset:0
    v_mfma_f32_16x16x32_bf16 v[80:83], a[40:43], v[140:143], v[80:83]
    s_add_u32 s73, s32, s2
    ds_read_b64_tr_b16 a[118:119], v63 offset:768
    buffer_load_dwordx4 v7, s[16:19], s31 offen offset:2048 lds
    v_mfma_f32_16x16x32_bf16 v[84:87], a[44:47], v[140:143], v[84:87]
    s_waitcnt lgkmcnt(7)
    ds_read_b128 v[120:123], v16 offset:7040
    v_add_f32 v148, v100, v148
    v_mfma_f32_16x16x32_bf16 v[88:91], a[0:3], v[112:115], 0
    s_add_u32 m0, s24, 24576
    ds_read_b64_tr_b16 a[216:217], v61 offset:9600
    v_add_f32 v149, v103, v149
    v_mfma_f32_16x16x32_bf16 v[92:95], a[4:7], v[112:115], 0
    s_add_u32 s31, s28, 24576
    ds_read_b64_tr_b16 a[218:219], v61 offset:10368
    v_add_f32 v150, v101, v150
    v_mfma_f32_16x16x32_bf16 v[96:99], a[8:11], v[112:115], 0
L_pgY0:
  s_cbranch_execz L_retY
    s_waitcnt lgkmcnt(6)
    ds_read_b64_tr_b16 a[220:221], v62 offset:9600
    buffer_load_dwordx4 v5, s[16:19], s31 offen lds
    v_mfma_f32_16x16x32_bf16 v[88:91], a[12:15], v[116:119], v[88:91]
    s_mulk_i32 s73, 192
    ds_read_b128 v[124:127], v17 offset:6912
    v_add_f32 v151, v103, v151
    v_mfma_f32_16x16x32_bf16 v[92:95], a[16:19], v[116:119], v[92:95]
    s_add_u32 s73, s73, s39
    ds_read_b64_tr_b16 a[222:223], v62 offset:10368
    v_cvt_pk_bf16_f32 v169, v144, v145
    v_mfma_f32_16x16x32_bf16 v[96:99], a[20:23], v[116:119], v[96:99]
    s_waitcnt lgkmcnt(5)
    ds_read_b64_tr_b16 a[224:225], v63 offset:9600
    v_cvt_pk_bf16_f32 v171, v146, v147
    v_mfma_f32_16x16x32_bf16 v[88:91], a[24:27], v[120:123], v[88:91]
    s_mul_i32 s78, s57, 344064
    ds_read_b64_tr_b16 a[226:227], v63 offset:10368
    buffer_load_dwordx4 v6, s[16:19], s31 offen offset:1024 lds
    v_mfma_f32_16x16x32_bf16 v[92:95], a[28:31], v[120:123], v[92:95]
    s_lshl1_add_u32 s71, s78, s73
    ds_read_b128 v[128:131], v16 offset:3456
    v_cvt_pk_bf16_f32 v173, v148, v149
    v_mfma_f32_16x16x32_bf16 v[96:99], a[32:35], v[120:123], v[96:99]
    s_waitcnt lgkmcnt(4)
    ds_read_b128 v[132:135], v16 offset:6912
    v_cvt_pk_bf16_f32 v175, v150, v151
    v_mfma_f32_16x16x32_bf16 v[88:91], a[36:39], v[124:127], v[88:91]
    s_add_u32 s78, s78, s73
    v_pk_max_i16 v169, v169, 0
    v_pk_max_i16 v171, v171, 0
    v_mfma_f32_16x16x32_bf16 v[92:95], a[40:43], v[124:127], v[92:95]
    buffer_load_dwordx4 v7, s[16:19], s31 offen offset:2048 lds
    v_mfma_f32_16x16x32_bf16 v[96:99], a[44:47], v[124:127], v[96:99]
    s_waitcnt vmcnt(9) lgkmcnt(1)
    s_barrier
    v_mfma_f32_16x16x32_bf16 v[64:67], a[108:111], v[128:131], v[64:67]
    s_add_u32 m0, s24, 36864
    ds_read_b128 v[136:139], v16 offset:10368
    s_add_u32 s31, s26, 135168
    ds_read_b64_tr_b16 a[120:121], v13 offset:49152
    v_mfma_f32_16x16x32_bf16 v[68:71], a[112:115], v[128:131], v[68:71]
    s_add_u32 s73, s78, 1373824
    ds_read_b64_tr_b16 a[122:123], v13 offset:49920
    v_pk_max_i16 v173, v173, 0
    v_mfma_f32_16x16x32_bf16 v[72:75], a[116:119], v[128:131], v[72:75]
    s_waitcnt lgkmcnt(3)
    ds_read_b64_tr_b16 a[124:125], v14 offset:49152
    buffer_load_dwordx4 v5, s[16:19], s31 offen lds
    v_mfma_f32_16x16x32_bf16 v[76:79], a[108:111], v[132:135], v[76:79]
    s_add_u32 s78, s78, 1032192
    ds_read_b64_tr_b16 a[126:127], v14 offset:49920
    v_pk_max_i16 v175, v175, 0
    v_mfma_f32_16x16x32_bf16 v[80:83], a[112:115], v[132:135], v[80:83]
    s_sub_u32 s72, s77, 896
    ds_read_b64_tr_b16 a[128:129], v15 offset:49152
    v_pk_min_i16 v169, v169, s60
    v_mfma_f32_16x16x32_bf16 v[84:87], a[116:119], v[132:135], v[84:87]
    s_waitcnt lgkmcnt(5)
    ds_read_b64_tr_b16 a[130:131], v15 offset:49920
    v_pk_min_i16 v171, v171, s60
    v_mfma_f32_16x16x32_bf16 v[88:91], a[108:111], v[136:139], v[88:91]
    ds_read_b64_tr_b16 a[228:229], v13 offset:55296
    buffer_load_dwordx4 v6, s[16:19], s31 offen offset:1024 lds
    v_mfma_f32_16x16x32_bf16 v[92:95], a[112:115], v[136:139], v[92:95]
    s_cmp_eq_u32 s46, 0
    s_cselect_b32 s72, s72, s64
    ds_read_b64_tr_b16 a[230:231], v13 offset:56064
    v_mfma_f32_16x16x32_bf16 v[96:99], a[116:119], v[136:139], v[96:99]
    s_cmp_eq_u32 s46, 0
    s_cselect_b32 s73, s73, s65
    ds_read_b64_tr_b16 a[232:233], v14 offset:55296
    v_mfma_f32_16x16x32_bf16 v[64:67], a[216:219], v[132:135], v[64:67]
    s_cmp_eq_u32 s46, 0
    s_cselect_b32 s77, s77, s66
    ds_read_b128 v[140:143], v16 offset:13824
    v_mfma_f32_16x16x32_bf16 v[68:71], a[220:223], v[132:135], v[68:71]
    ds_read_b64_tr_b16 a[234:235], v14 offset:56064
    buffer_load_dwordx4 v7, s[16:19], s31 offen offset:2048 lds
    v_mfma_f32_16x16x32_bf16 v[72:75], a[224:227], v[132:135], v[72:75]
    s_mul_i32 s31, s57, 3456
    ds_read_b64_tr_b16 a[236:237], v15 offset:55296
    v_pk_min_i16 v173, v173, s60
    v_mfma_f32_16x16x32_bf16 v[76:79], a[216:219], v[136:139], v[76:79]
    s_add_u32 s31, s31, s24
    ds_read_b64_tr_b16 a[238:239], v15 offset:56064
    v_pk_min_i16 v175, v175, s60
    v_mfma_f32_16x16x32_bf16 v[80:83], a[220:223], v[136:139], v[80:83]
    s_add_u32 m0, s31, 127488
    ds_read_b128 v[112:115], v16 offset:3520
    v_cmp_ne_u16_e64 s[80:81], v169, v104
    v_mfma_f32_16x16x32_bf16 v[84:87], a[224:227], v[136:139], v[84:87]
    s_waitcnt lgkmcnt(4)
    ds_read_b128 v[116:119], v16 offset:6976
    v_cmp_ne_u16_sdwa s[88:89], v169, v104 src0_sel:WORD_1 src1_sel:WORD_1
    v_mfma_f32_16x16x32_bf16 v[88:91], a[216:219], v[140:143], v[88:91]
    ds_read_b128 v[120:123], v16 offset:10432
    v_cmp_ne_u16_e64 s[82:83], v171, v105
    v_mfma_f32_16x16x32_bf16 v[92:95], a[220:223], v[140:143], v[92:95]
    v_cmp_ne_u16_sdwa s[90:91], v171, v105 src0_sel:WORD_1 src1_sel:WORD_1
    v_cmp_ne_u16_e64 s[84:85], v173, v106
    v_mfma_f32_16x16x32_bf16 v[96:99], a[224:227], v[140:143], v[96:99]
    s_waitcnt vmcnt(9) lgkmcnt(2)
    s_barrier
    v_mfma_f32_16x16x32_bf16 v[64:67], a[120:123], v[112:115], v[64:67]
    s_add_u32 s31, s28, 86016
    ds_read_b64_tr_b16 a[132:133], v13 offset:0
    v_cmp_ne_u16_sdwa s[92:93], v173, v106 src0_sel:WORD_1 src1_sel:WORD_1
    v_mfma_f32_16x16x32_bf16 v[68:71], a[124:127], v[112:115], v[68:71]
    ds_read_b64_tr_b16 a[134:135], v13 offset:768
    buffer_load_dwordx4 v5, s[16:19], s31 offen lds
    v_mfma_f32_16x16x32_bf16 v[72:75], a[128:131], v[112:115], v[72:75]
    s_waitcnt lgkmcnt(3)
    ds_read_b64_tr_b16 a[136:137], v14 offset:0
    v_cmp_ne_u16_e64 s[86:87], v175, v107
    v_mfma_f32_16x16x32_bf16 v[76:79], a[120:123], v[116:119], v[76:79]
    ds_read_b64_tr_b16 a[138:139], v14 offset:768
    v_cmp_ne_u16_sdwa s[94:95], v175, v107 src0_sel:WORD_1 src1_sel:WORD_1
    v_mfma_f32_16x16x32_bf16 v[80:83], a[124:127], v[116:119], v[80:83]
    ds_read_b64_tr_b16 a[140:141], v15 offset:0
    v_mad_u32_u16 v30, v30, s5, v31 op_sel:[1,0,0,0]
    v_mfma_f32_16x16x32_bf16 v[84:87], a[128:131], v[116:119], v[84:87]
    s_waitcnt lgkmcnt(5)
    ds_read_b64_tr_b16 a[142:143], v15 offset:768
    buffer_load_dwordx4 v6, s[16:19], s31 offen offset:1024 lds
    v_mfma_f32_16x16x32_bf16 v[88:91], a[120:123], v[120:123], v[88:91]
    s_xor_b64 s[80:81], s[80:81], s[88:89]
    ds_read_b64_tr_b16 a[240:241], v13 offset:6144
    s_andn2_b64 s[88:89], s[88:89], s[80:81]
    v_mfma_f32_16x16x32_bf16 v[92:95], a[124:127], v[120:123], v[92:95]
    s_xor_b64 s[82:83], s[82:83], s[90:91]
    ds_read_b64_tr_b16 a[242:243], v13 offset:6912
    s_andn2_b64 s[90:91], s[90:91], s[82:83]
    v_mfma_f32_16x16x32_bf16 v[96:99], a[128:131], v[120:123], v[96:99]
    s_xor_b64 s[84:85], s[84:85], s[92:93]
    ds_read_b64_tr_b16 a[244:245], v14 offset:6144
    s_andn2_b64 s[92:93], s[92:93], s[84:85]
    v_mfma_f32_16x16x32_bf16 v[64:67], a[228:231], v[116:119], v[64:67]
    s_xor_b64 s[86:87], s[86:87], s[94:95]
    ds_read_b128 v[124:127], v16 offset:13888
    buffer_load_dwordx4 v7, s[16:19], s31 offen offset:2048 lds
    v_mfma_f32_16x16x32_bf16 v[68:71], a[232:235], v[116:119], v[68:71]
    s_add_u32 m0, s24, 49152
    ds_read_b64_tr_b16 a[246:247], v14 offset:6912
    v_mbcnt_lo_u32_b32 v148, s88, 0
    v_mfma_f32_16x16x32_bf16 v[72:75], a[236:239], v[116:119], v[72:75]
    s_add_u32 s31, s28, 36864
    ds_read_b64_tr_b16 a[248:249], v15 offset:6144
    s_andn2_b64 s[94:95], s[94:95], s[86:87]
    v_mfma_f32_16x16x32_bf16 v[76:79], a[228:231], v[120:123], v[76:79]
    s_bcnt1_i32_b64 s48, s[88:89]
    ds_read_b64_tr_b16 a[250:251], v15 offset:6912
    s_bcnt1_i32_b64 s49, s[90:91]
    v_mfma_f32_16x16x32_bf16 v[80:83], a[232:235], v[120:123], v[80:83]
    s_bcnt1_i32_b64 s50, s[92:93]
    ds_read_b128 v[128:131], v16 offset:3584
    buffer_load_dwordx4 v5, s[16:19], s31 offen lds
    v_mfma_f32_16x16x32_bf16 v[84:87], a[236:239], v[120:123], v[84:87]
    s_waitcnt lgkmcnt(4)
    ds_read_b128 v[132:135], v16 offset:7040
    v_mbcnt_lo_u32_b32 v149, s90, 0
    v_mfma_f32_16x16x32_bf16 v[88:91], a[228:231], v[124:127], v[88:91]
    s_bcnt1_i32_b64 s51, s[94:95]
    ds_read_b128 v[136:139], v16 offset:10496
    v_mbcnt_lo_u32_b32 v150, s92, 0
    v_mfma_f32_16x16x32_bf16 v[92:95], a[232:235], v[124:127], v[92:95]
    s_lshr_b32 s52, s89, 4
    v_mbcnt_lo_u32_b32 v151, s94, 0
    v_mbcnt_hi_u32_b32 v148, s89, v148
    v_mfma_f32_16x16x32_bf16 v[96:99], a[236:239], v[124:127], v[96:99]
    s_waitcnt vmcnt(10) lgkmcnt(2)
    s_barrier
    v_mfma_f32_16x16x32_bf16 v[64:67], a[132:135], v[128:131], v[64:67]
    s_lshr_b32 s61, s91, 4
    ds_read_b64_tr_b16 a[144:145], v13 offset:12288
    buffer_load_dwordx4 v6, s[16:19], s31 offen offset:1024 lds
    v_mfma_f32_16x16x32_bf16 v[68:71], a[136:139], v[128:131], v[68:71]
    s_bcnt1_i32_b32 s52, s52
    ds_read_b64_tr_b16 a[146:147], v13 offset:13056
    s_bcnt1_i32_b32 s61, s61
    ds_read_b64_tr_b16 a[148:149], v14 offset:12288
    v_mfma_f32_16x16x32_bf16 v[72:75], a[140:143], v[128:131], v[72:75]
    s_waitcnt lgkmcnt(4)
    ds_read_b64_tr_b16 a[150:151], v14 offset:13056
    v_mbcnt_hi_u32_b32 v149, s91, v149
    v_mfma_f32_16x16x32_bf16 v[76:79], a[132:135], v[132:135], v[76:79]
    s_add_u32 s51, s51, s50
    ds_read_b64_tr_b16 a[152:153], v15 offset:12288
    v_mbcnt_hi_u32_b32 v150, s93, v150
    v_mfma_f32_16x16x32_bf16 v[80:83], a[136:139], v[132:135], v[80:83]
    s_add_u32 s43, s48, s49
    ds_read_b64_tr_b16 a[154:155], v15 offset:13056
    buffer_load_dwordx4 v7, s[16:19], s31 offen offset:2048 lds
    v_mbcnt_hi_u32_b32 v151, s95, v151
    v_mfma_f32_16x16x32_bf16 v[84:87], a[140:143], v[132:135], v[84:87]
    s_waitcnt lgkmcnt(6)
    ds_read_b64_tr_b16 a[252:253], v13 offset:18432
    v_mad_i32_i24 v148, 32, v108, v148
    v_mfma_f32_16x16x32_bf16 v[88:91], a[132:135], v[136:139], v[88:91]
    s_add_u32 m0, s24, 0
    ds_read_b64_tr_b16 a[254:255], v13 offset:19200
    v_mbcnt_lo_u32_b32 v144, s80, 0
    s_add_u32 s43, s43, s51
    v_mfma_f32_16x16x32_bf16 v[92:95], a[136:139], v[136:139], v[92:95]
    s_add_u32 s31, s26, 147456
    ds_read_b64_tr_b16 v[188:189], v14 offset:18432
    s_add_u32 s51, s51, s52
    s_add_u32 s51, s51, s61
    v_mfma_f32_16x16x32_bf16 v[96:99], a[140:143], v[136:139], v[96:99]
    s_lshl_b32 s96, s51, 1
    ds_read_b128 v[140:143], v16 offset:13952
    buffer_load_dwordx4 v5, s[16:19], s31 offen lds
    s_lshl_b32 s43, s43, 1
    v_mfma_f32_16x16x32_bf16 v[64:67], a[240:243], v[132:135], v[64:67]
    s_sub_u32 s40, 64, s43
    ds_read_b64_tr_b16 v[190:191], v14 offset:19200
    s_add_u32 s41, s6, s52
    v_mfma_f32_16x16x32_bf16 v[68:71], a[244:247], v[132:135], v[68:71]
    s_sub_u32 s52, 32, s48
    ds_read_b64_tr_b16 v[192:193], v15 offset:18432
    v_mad_i32_i24 v149, s52, v108, v149
    v_mfma_f32_16x16x32_bf16 v[72:75], a[248:251], v[132:135], v[72:75]
    s_sub_u32 s48, s41, s48
    ds_read_b64_tr_b16 v[194:195], v15 offset:19200
    s_add_u32 s41, s41, s61
    v_mfma_f32_16x16x32_bf16 v[76:79], a[240:243], v[136:139], v[76:79]
    s_sub_u32 s49, s41, s49
    ds_read_b128 v[112:115], v17 offset:3456
    buffer_load_dwordx4 v6, s[16:19], s31 offen offset:1024 lds
    v_mfma_f32_16x16x32_bf16 v[80:83], a[244:247], v[136:139], v[80:83]
    s_add_u32 s50, s50, s41
    ds_read_b128 v[116:119], v17 offset:6912
    v_add_lshl_u32 v148, v148, s48, 4
    v_mfma_f32_16x16x32_bf16 v[84:87], a[248:251], v[136:139], v[84:87]
    s_waitcnt lgkmcnt(5)
    ds_read_b128 v[120:123], v17 offset:10368
    v_add_lshl_u32 v149, v149, s49, 4
    v_mfma_f32_16x16x32_bf16 v[88:91], a[240:243], v[140:143], v[88:91]
    s_bcnt1_i32_b64 s7, s[80:81]
    v_add_lshl_u32 v150, v150, s41, 4
    v_add_lshl_u32 v151, v151, s50, 4
    v_mfma_f32_16x16x32_bf16 v[92:95], a[244:247], v[140:143], v[92:95]
    buffer_load_dwordx4 v7, s[16:19], s31 offen offset:2048 lds
    v_mfma_f32_16x16x32_bf16 v[96:99], a[248:251], v[140:143], v[96:99]
    s_waitcnt vmcnt(9) lgkmcnt(2)
    s_barrier
    v_mfma_f32_16x16x32_bf16 v[64:67], a[144:147], v[112:115], v[64:67]
    s_add_u32 m0, s24, 12288
    ds_read_b64_tr_b16 a[48:49], v13 offset:24576
    s_add_u32 s31, s28, 98304
    ds_read_b64_tr_b16 a[50:51], v13 offset:25344
    s_bcnt1_i32_b64 s59, s[82:83]
    v_mfma_f32_16x16x32_bf16 v[68:71], a[148:151], v[112:115], v[68:71]
    s_bcnt1_i32_b64 s79, s[84:85]
    ds_read_b64_tr_b16 a[52:53], v14 offset:24576
    s_bcnt1_i32_b64 s62, s[86:87]
    ds_read_b64_tr_b16 a[54:55], v14 offset:25344
    v_mbcnt_lo_u32_b32 v145, s82, 0
    v_mfma_f32_16x16x32_bf16 v[72:75], a[152:155], v[112:115], v[72:75]
    s_waitcnt lgkmcnt(4)
    ds_read_b64_tr_b16 a[56:57], v15 offset:24576
    buffer_load_dwordx4 v5, s[16:19], s31 offen lds
    v_mbcnt_lo_u32_b32 v146, s84, 0
    v_mfma_f32_16x16x32_bf16 v[76:79], a[144:147], v[116:119], v[76:79]
    s_lshr_b32 s29, s81, 4
    ds_read_b128 v[124:127], v17 offset:13824
    v_mbcnt_lo_u32_b32 v147, s86, 0
    v_mfma_f32_16x16x32_bf16 v[80:83], a[148:151], v[116:119], v[80:83]
    s_lshr_b32 s30, s83, 4
    ds_read_b64_tr_b16 a[58:59], v15 offset:25344
    v_mbcnt_hi_u32_b32 v144, s81, v144
    v_mfma_f32_16x16x32_bf16 v[84:87], a[152:155], v[116:119], v[84:87]
    s_bcnt1_i32_b32 s29, s29
    ds_read_b64_tr_b16 a[156:157], v13 offset:30720
    v_mbcnt_hi_u32_b32 v145, s83, v145
    v_mfma_f32_16x16x32_bf16 v[88:91], a[144:147], v[120:123], v[88:91]
    s_bcnt1_i32_b32 s30, s30
    ds_read_b128 v[128:131], v17 offset:64
    buffer_load_dwordx4 v6, s[16:19], s31 offen offset:1024 lds
    v_mfma_f32_16x16x32_bf16 v[92:95], a[148:151], v[120:123], v[92:95]
    s_add_u32 s62, s62, s79
    ds_read_b64_tr_b16 a[158:159], v13 offset:31488
    v_mbcnt_hi_u32_b32 v146, s85, v146
    v_mfma_f32_16x16x32_bf16 v[96:99], a[152:155], v[120:123], v[96:99]
    s_add_u32 s63, s7, s59
    ds_read_b64_tr_b16 a[160:161], v14 offset:30720
    v_mbcnt_hi_u32_b32 v147, s87, v147
    v_mfma_f32_16x16x32_bf16 v[64:67], a[252:255], v[116:119], v[64:67]
    s_add_u32 s63, s63, s62
    ds_read_b128 v[132:135], v17 offset:3520
    s_add_u32 s62, s62, s29
    v_mfma_f32_16x16x32_bf16 v[68:71], v[188:191], v[116:119], v[68:71]
    s_add_u32 s62, s62, s30
    ds_read_b64_tr_b16 a[162:163], v14 offset:31488
    buffer_load_dwordx4 v7, s[16:19], s31 offen offset:2048 lds
    v_mfma_f32_16x16x32_bf16 v[72:75], v[192:195], v[116:119], v[72:75]
    s_mov_b32 m0, s64
    ds_read_b64_tr_b16 a[164:165], v15 offset:30720
    s_lshl1_add_u32 s6, s6, s96
    v_mfma_f32_16x16x32_bf16 v[76:79], a[252:255], v[120:123], v[76:79]
    s_add_u32 s62, s62, s96
    ds_read_b64_tr_b16 a[166:167], v15 offset:31488
    v_mad_i32_i24 v144, s40, v108, v144
    v_mfma_f32_16x16x32_bf16 v[80:83], v[188:191], v[120:123], v[80:83]
    s_add_u32 s6, s6, s29
    ds_read_b128 v[136:139], v17 offset:6976
    s_sub_u32 s29, s40, s7
    v_mfma_f32_16x16x32_bf16 v[84:87], v[192:195], v[120:123], v[84:87]
    s_waitcnt lgkmcnt(5)
    ds_read_b64_tr_b16 v[196:197], v13 offset:36864
    buffer_load_dwordx4 v9, s[8:11], s65 offen  lds
    v_mfma_f32_16x16x32_bf16 v[88:91], a[252:255], v[124:127], v[88:91]
    s_sub_u32 s7, s6, s7
    ds_read_b64_tr_b16 v[198:199], v13 offset:37632
    v_mad_i32_i24 v145, s29, v108, v145
    v_mfma_f32_16x16x32_bf16 v[92:95], v[188:191], v[124:127], v[92:95]
    s_add_u32 s6, s6, s30
    ds_read_b64_tr_b16 v[200:201], v14 offset:36864
    s_sub_u32 s59, s6, s59
    v_mfma_f32_16x16x32_bf16 v[96:99], v[192:195], v[124:127], v[96:99]
    s_add_u32 s79, s79, s6
    ds_read_b64_tr_b16 v[202:203], v14 offset:37632
    v_add_lshl_u32 v144, v144, s7, 3
    v_mfma_f32_16x16x32_bf16 v[64:67], a[48:51], v[128:131], v[64:67]
    s_sub_u32 s97, s43, s96
    ds_read_b64_tr_b16 v[204:205], v15 offset:36864
    buffer_load_dwordx4 v10, s[8:11], s65 offen offset:1024  lds
    v_mfma_f32_16x16x32_bf16 v[68:71], a[52:55], v[128:131], v[68:71]
    s_sub_u32 s43, 64, s97
    ds_read_b64_tr_b16 v[206:207], v15 offset:37632
    v_add_lshl_u32 v145, v145, s59, 3
    v_mfma_f32_16x16x32_bf16 v[72:75], a[56:59], v[128:131], v[72:75]
    s_waitcnt lgkmcnt(5)
    ds_read_b64_tr_b16 a[60:61], v13 offset:43008
    v_add_lshl_u32 v146, v146, s6, 3
    v_add_lshl_u32 v147, v147, s79, 3
    v_mfma_f32_16x16x32_bf16 v[76:79], a[48:51], v[132:135], v[76:79]
    s_bfm_b64 s[98:99], s96, 0
    ds_read_b64_tr_b16 a[62:63], v13 offset:43776
    s_bfm_b64 vcc, s97, s43
    v_mfma_f32_16x16x32_bf16 v[80:83], a[52:55], v[132:135], v[80:83]
    s_or_b64 s[98:99], s[98:99], vcc
    ds_read_b64_tr_b16 a[64:65], v14 offset:43008
    buffer_load_dwordx4 v11, s[8:11], s65 offen offset:2048  lds
    v_mfma_f32_16x16x32_bf16 v[84:87], a[56:59], v[132:135], v[84:87]
    s_mov_b32 m0, s66
    ds_read_b128 v[140:143], v17 offset:10432
    v_sub_u32 v32, s56, v0
    v_mfma_f32_16x16x32_bf16 v[88:91], a[48:51], v[136:139], v[88:91]
    s_cmp_gt_u32 s62, 32
    s_cselect_b32 s63, 65, s63
    ds_read_b64_tr_b16 a[66:67], v14 offset:43776
    v_mfma_f32_16x16x32_bf16 v[92:95], a[52:55], v[136:139], v[92:95]
    s_cmp_ge_i32 s63, s40
    s_cbranch_scc1 L_bfail1
L_bfail1_back:
    v_cndmask_b32 v144, v111, v144, s[80:81]
    v_mfma_f32_16x16x32_bf16 v[96:99], a[56:59], v[136:139], v[96:99]
    s_mov_b32 s96, 0x7fff7fff
    ds_read_b64_tr_b16 a[68:69], v15 offset:43008
    buffer_load_dwordx4 v9, s[8:11], s67 offen  lds
    v_cndmask_b32 v144, v144, v148, s[88:89]
    v_mfma_f32_16x16x32_bf16 v[64:67], a[156:159], v[132:135], v[64:67]
    s_mov_b32 s88, 0x00040001
    ds_write_b64 v144, v[168:169]
    v_cndmask_b32 v145, v111, v145, s[82:83]
    v_mfma_f32_16x16x32_bf16 v[68:71], a[160:163], v[132:135], v[68:71]
    s_and_b32 s82, s98, 0x55555555
    ds_read_b64_tr_b16 a[70:71], v15 offset:43776
    v_cndmask_b32 v145, v145, v149, s[90:91]
    v_mfma_f32_16x16x32_bf16 v[72:75], a[164:167], v[132:135], v[72:75]
    s_and_b32 s83, s99, 0x55555555
    ds_write_b64 v145, v[170:171]
    v_cndmask_b32 v146, v111, v146, s[84:85]
    v_cndmask_b32 v146, v146, v150, s[92:93]
    v_mfma_f32_16x16x32_bf16 v[76:79], a[156:159], v[136:139], v[76:79]
    s_andn2_b64 s[80:81], s[98:99], s[82:83]
    ds_write_b64 v146, v[172:173]
    v_cndmask_b32 v147, v111, v147, s[86:87]
    v_cndmask_b32 v147, v147, v151, s[94:95]
    v_mfma_f32_16x16x32_bf16 v[80:83], a[160:163], v[136:139], v[80:83]
    s_not_b64 vcc, s[80:81]
    ds_write_b64 v147, v[174:175]
    v_mfma_f32_16x16x32_bf16 v[84:87], a[164:167], v[136:139], v[84:87]
    s_waitcnt lgkmcnt(5)
    ds_read_b64 v[144:145], v110
    v_mfma_f32_16x16x32_bf16 v[88:91], a[156:159], v[140:143], v[88:91]
    buffer_load_dwordx4 v10, s[8:11], s67 offen offset:1024  lds
    v_mfma_f32_16x16x32_bf16 v[92:95], a[160:163], v[140:143], v[92:95]
    s_mov_b32 s89, 0x00400010
    ds_read_b128 v[112:115], v17 offset:13888
    s_lshl_b64 s[90:91], s[88:89], 1
    v_mfma_f32_16x16x32_bf16 v[96:99], a[164:167], v[140:143], v[96:99]
    s_waitcnt vmcnt(11) lgkmcnt(4)
    s_barrier
    v_mfma_f32_16x16x32_bf16 v[64:67], v[196:199], v[136:139], v[64:67]
    s_lshl_b64 s[92:93], s[88:89], 8
    ds_read_b128 v[116:119], v17 offset:128
    s_lshl_b64 s[94:95], s[88:89], 9
    v_mfma_f32_16x16x32_bf16 v[68:71], v[200:203], v[136:139], v[68:71]
    buffer_load_dwordx4 v11, s[8:11], s67 offen offset:2048  lds
    v_mfma_f32_16x16x32_bf16 v[72:75], v[204:207], v[136:139], v[72:75]
    s_waitcnt lgkmcnt(2)
    ds_write_b32 v144, v109
    v_mfma_f32_16x16x32_bf16 v[76:79], v[196:199], v[140:143], v[76:79]
    s_mov_b32 m0, s68
    ds_read_b128 v[120:123], v17 offset:3584
    v_cndmask_b32_dpp v145, v145, v145, vcc quad_perm:[0,0,2,2] row_mask:0xf bank_mask:0xf
    v_mfma_f32_16x16x32_bf16 v[80:83], v[200:203], v[140:143], v[80:83]
    s_mov_b32 s5, 56448
    ds_read_b64_tr_b16 a[168:169], v61 offset:0
    v_add_u32 v31, -252, v32
    v_mfma_f32_16x16x32_bf16 v[84:87], v[204:207], v[140:143], v[84:87]
    s_waitcnt lgkmcnt(4)
    buffer_load_dwordx4 v9, s[8:11], s69 offen  lds
    v_mfma_f32_16x16x32_bf16 v[88:91], v[196:199], v[112:115], v[88:91]
    s_add_u32 s56, s44, 43200
    ds_read_b64_tr_b16 a[170:171], v61 offset:768
    v_and_b32 v31, 2.0, v31
    v_mfma_f32_16x16x32_bf16 v[92:95], v[200:203], v[112:115], v[92:95]
    s_cmp_eq_u32 s46, 0
    s_cselect_b32 s78, s78, s67
    ds_read_b64_tr_b16 a[172:173], v62 offset:0
    v_mfma_f32_16x16x32_bf16 v[96:99], v[204:207], v[112:115], v[96:99]
    s_waitcnt lgkmcnt(4)
    ds_read_b128 v[124:127], v17 offset:7040
    v_add3_u32 v31, v30, v31, s5
    v_mfma_f32_16x16x32_bf16 v[64:67], a[60:63], v[116:119], v[64:67]
    buffer_load_dwordx4 v10, s[8:11], s69 offen offset:1024  lds
    v_mfma_f32_16x16x32_bf16 v[68:71], a[64:67], v[116:119], v[68:71]
    ds_read_b64_tr_b16 a[174:175], v62 offset:768
    v_lshrrev_b32 v40, 3, v1
    v_mfma_f32_16x16x32_bf16 v[72:75], a[68:71], v[116:119], v[72:75]
    s_waitcnt lgkmcnt(4)
    ds_read_b64_tr_b16 a[176:177], v63 offset:0
    v_lshl_add_u32 v40, v40, 4, s4
    v_mfma_f32_16x16x32_bf16 v[76:79], a[60:63], v[120:123], v[76:79]
    ds_read_b64_tr_b16 a[178:179], v63 offset:768
    v_and_or_b32 v24, v1, 4, v40
    v_mfma_f32_16x16x32_bf16 v[80:83], a[64:67], v[120:123], v[80:83]
    buffer_load_dwordx4 v11, s[8:11], s69 offen offset:2048  lds
    v_mfma_f32_16x16x32_bf16 v[84:87], a[68:71], v[120:123], v[84:87]
    s_waitcnt lgkmcnt(3)
    ds_read_b64_tr_b16 v[208:209], v61 offset:9600
    v_lshl_add_u32 v25, v2, 4, s4
    v_mfma_f32_16x16x32_bf16 v[88:91], a[60:63], v[124:127], v[88:91]
    s_lshl_b32 s4, s57, 10
    ds_read_b64_tr_b16 v[210:211], v61 offset:10368
    v_lshrrev_b32 v41, 1, v1
    v_mfma_f32_16x16x32_bf16 v[92:95], a[64:67], v[124:127], v[92:95]
    ds_read_b64_tr_b16 v[212:213], v62 offset:9600
    v_and_or_b32 v41, v41, 8, 32
    v_mfma_f32_16x16x32_bf16 v[96:99], a[68:71], v[124:127], v[96:99]
    s_waitcnt lgkmcnt(3)
    buffer_load_dwordx4 v12, s[8:11], s69 offen offset:2432  lds
    v_mfma_f32_16x16x32_bf16 v[64:67], a[168:171], v[120:123], v[64:67]
    s_add_u32 m0, s24, 24576
    ds_read_b128 v[128:131], v17 offset:10496
    v_bitop3_b32 v26, v7, 48, v41 bitop3:0x6a
    v_mfma_f32_16x16x32_bf16 v[68:71], a[172:175], v[120:123], v[68:71]
    s_add_u32 s31, s28, 49152
    ds_read_b64_tr_b16 v[214:215], v62 offset:10368
    v_xor_b32 v27, 8, v26
    v_mfma_f32_16x16x32_bf16 v[72:75], a[176:179], v[120:123], v[72:75]
    ds_read_b64_tr_b16 v[216:217], v63 offset:9600
    v_lshrrev_b32 v52, 1, v4
    v_mfma_f32_16x16x32_bf16 v[76:79], a[168:171], v[124:127], v[76:79]
    ds_read_b64_tr_b16 v[218:219], v63 offset:10368
    v_lshl_or_b32 v21, v4, 1, v52
    v_mfma_f32_16x16x32_bf16 v[80:83], a[172:175], v[124:127], v[80:83]
    ds_read_b64_tr_b16 a[72:73], v13 offset:49152
    v_and_b32 v21, 48, v21
    v_mfma_f32_16x16x32_bf16 v[84:87], a[176:179], v[124:127], v[84:87]
    s_waitcnt lgkmcnt(4)
    ds_read_b64_tr_b16 a[74:75], v13 offset:49920
    v_lshl_add_u32 v21, s2, 7, v21
    v_mfma_f32_16x16x32_bf16 v[88:91], a[168:171], v[128:131], v[88:91]
    ds_read_b64_tr_b16 a[76:77], v14 offset:49152
    v_mad_u32_u24 v19, v2, s42, v21
    v_mfma_f32_16x16x32_bf16 v[92:95], a[172:175], v[128:131], v[92:95]
    ds_read_b128 v[132:135], v17 offset:13952
    v_lshl_add_u32 v53, s2, 2, v3
    v_mfma_f32_16x16x32_bf16 v[96:99], a[176:179], v[128:131], v[96:99]
    s_waitcnt lgkmcnt(4)
    ds_read_b64_tr_b16 a[78:79], v14 offset:49920
    v_lshrrev_b32 v52, 1, v2
    v_mfma_f32_16x16x32_bf16 v[64:67], v[208:211], v[124:127], v[64:67]
    ds_read_b64_tr_b16 a[80:81], v15 offset:49152
    v_bitop3_b32 v52, v52, 6, v53 bitop3:0x6a
    v_mfma_f32_16x16x32_bf16 v[68:71], v[212:215], v[124:127], v[68:71]
    ds_read_b64_tr_b16 a[82:83], v15 offset:49920
    v_lshl_add_u32 v52, v2, 3, v52
    v_mfma_f32_16x16x32_bf16 v[72:75], v[216:219], v[124:127], v[72:75]
    ds_read_b128 v[136:139], v18 offset:0
    v_lshl_add_u32 v38, v52, 3, s4
    v_mfma_f32_16x16x32_bf16 v[76:79], v[208:211], v[128:131], v[76:79]
    s_mul_i32 s4, s57, 129024
    ds_read_b64_tr_b16 a[180:181], v13 offset:55296
    s_add_u32 s56, s56, s4
    v_mfma_f32_16x16x32_bf16 v[80:83], v[212:215], v[128:131], v[80:83]
    s_add_u32 s4, s56, 43008
    ds_read_b128 v[140:143], v18 offset:3456
    s_add_u32 s5, s56, 86016
    v_mfma_f32_16x16x32_bf16 v[84:87], v[216:219], v[128:131], v[84:87]
    s_waitcnt lgkmcnt(5)
    ds_read_b64_tr_b16 a[182:183], v13 offset:56064
    ds_read_b64_tr_b16 a[184:185], v14 offset:55296
    v_mfma_f32_16x16x32_bf16 v[88:91], v[208:211], v[132:135], v[88:91]
    ds_read_b128 v[112:115], v18 offset:6912
    ds_read_b64_tr_b16 a[186:187], v14 offset:56064
    v_mfma_f32_16x16x32_bf16 v[92:95], v[212:215], v[132:135], v[92:95]
    ds_read_b64_tr_b16 a[188:189], v15 offset:55296
    v_and_or_b32 v30, v32, 2.0, v30
    v_mfma_f32_16x16x32_bf16 v[96:99], v[216:219], v[132:135], v[96:99]
    s_waitcnt vmcnt(10) lgkmcnt(7)
    s_barrier
    v_mfma_f32_16x16x32_bf16 v[64:67], a[72:75], v[136:139], v[64:67]
    ds_read_b64_tr_b16 a[190:191], v15 offset:56064
    v_lshlrev_b32 v146, 16, v145
    v_mfma_f32_16x16x32_bf16 v[68:71], a[76:79], v[136:139], v[68:71]
    ds_read_b64_tr_b16 v[220:221], v13 offset:0
    v_and_b32 v147, 0xffff0000, v145
    v_mfma_f32_16x16x32_bf16 v[72:75], a[80:83], v[136:139], v[72:75]
    s_waitcnt lgkmcnt(5)
    ds_read_b64_tr_b16 v[222:223], v13 offset:768
    v_ceil_f32 v149, v146
    v_mfma_f32_16x16x32_bf16 v[76:79], a[72:75], v[140:143], v[76:79]
    ds_read_b64_tr_b16 v[224:225], v14 offset:0
    v_ceil_f32 v151, v147
    v_mfma_f32_16x16x32_bf16 v[80:83], a[76:79], v[140:143], v[80:83]
    ds_read_b128 v[116:119], v18 offset:10368
    v_cvt_u32_f32 v148, v146
    v_mfma_f32_16x16x32_bf16 v[84:87], a[80:83], v[140:143], v[84:87]
    s_waitcnt lgkmcnt(5)
    ds_read_b64_tr_b16 v[226:227], v14 offset:768
    v_cvt_u32_f32 v150, v147
    v_mfma_f32_16x16x32_bf16 v[88:91], a[72:75], v[112:115], v[88:91]
    ds_read_b64_tr_b16 v[228:229], v15 offset:0
    ds_read_b64_tr_b16 v[230:231], v15 offset:768
    v_mfma_f32_16x16x32_bf16 v[92:95], a[76:79], v[112:115], v[92:95]
    ds_read_b64_tr_b16 a[84:85], v13 offset:6144
    v_cvt_u32_f32 v149, v149
    v_mfma_f32_16x16x32_bf16 v[96:99], a[80:83], v[112:115], v[96:99]
    s_waitcnt lgkmcnt(6)
    ds_read_b64_tr_b16 a[86:87], v13 offset:6912
    v_cvt_u32_f32 v151, v151
    v_mfma_f32_16x16x32_bf16 v[64:67], a[180:183], v[140:143], v[64:67]
    ds_read_b64_tr_b16 a[88:89], v14 offset:6144
    v_cndmask_b32 v164, v148, v149, s[80:81]
    v_mfma_f32_16x16x32_bf16 v[68:71], a[184:187], v[140:143], v[68:71]
    ds_read_b64_tr_b16 a[90:91], v14 offset:6912
    ds_read_b64_tr_b16 a[92:93], v15 offset:6144
    v_mfma_f32_16x16x32_bf16 v[72:75], a[188:191], v[140:143], v[72:75]
    ds_read_b64_tr_b16 a[94:95], v15 offset:6912
    ds_read_b64_tr_b16 a[192:193], v13 offset:12288
    v_mfma_f32_16x16x32_bf16 v[76:79], a[180:183], v[112:115], v[76:79]
    ds_read_b128 v[120:123], v18 offset:13824
    buffer_load_dwordx4 v5, s[16:19], s31 offen lds
    v_mfma_f32_16x16x32_bf16 v[80:83], a[184:187], v[112:115], v[80:83]
    ds_read_b64_tr_b16 a[194:195], v13 offset:13056
    ds_read_b64_tr_b16 a[196:197], v14 offset:12288
    v_mfma_f32_16x16x32_bf16 v[84:87], a[188:191], v[112:115], v[84:87]
    s_waitcnt lgkmcnt(8)
    ds_read_b64_tr_b16 a[198:199], v14 offset:13056
    v_cndmask_b32 v165, v149, v148, s[82:83]
    v_mfma_f32_16x16x32_bf16 v[88:91], a[180:183], v[116:119], v[88:91]
    ds_read_b128 v[124:127], v18 offset:64
    v_and_b32 v160, 4, v150
    v_mfma_f32_16x16x32_bf16 v[92:95], a[184:187], v[116:119], v[92:95]
    ds_read_b64_tr_b16 a[200:201], v15 offset:12288
    buffer_load_dwordx4 v6, s[16:19], s31 offen offset:1024 lds
    v_mfma_f32_16x16x32_bf16 v[96:99], a[188:191], v[116:119], v[96:99]
    ds_read_b64_tr_b16 a[202:203], v15 offset:13056
    v_lshl_add_u32 v160, v160, 3, s35
    v_mfma_f32_16x16x32_bf16 v[64:67], v[220:223], v[112:115], v[64:67]
    ds_read_b128 v[128:131], v18 offset:3520
    v_mad_u32_u24 v160, v150, s42, v160
    v_mfma_f32_16x16x32_bf16 v[68:71], v[224:227], v[112:115], v[68:71]
    ds_read_b64_tr_b16 v[232:233], v13 offset:18432
    v_mad_u32_u24 v164, v164, s34, v160
    v_mfma_f32_16x16x32_bf16 v[72:75], v[228:231], v[112:115], v[72:75]
L_pgY1:
  s_cbranch_execz L_retY
    ds_read_b64_tr_b16 v[234:235], v13 offset:19200
    buffer_load_dwordx4 v7, s[16:19], s31 offen offset:2048 lds
    v_mfma_f32_16x16x32_bf16 v[76:79], v[220:223], v[116:119], v[76:79]
    s_bitcmp1_b32 s73, 30
    s_cbranch_scc1 L_noj3
    s_mov_b32 m0, s72
    s_nop 0
    buffer_load_dwordx4 v50, s[8:11], s73 offen offset:2432  lds
    s_mov_b32 m0, s77
    s_nop 0
    buffer_load_dwordx4 v12, s[8:11], s78 offen offset:2432  lds
    s_mov_b32 m0, s70
    s_bitcmp1_b32 s39, 30
    s_cbranch_scc1 L_noj3
    buffer_load_dwordx4 v9, s[8:11], s71 offen  lds
    buffer_load_dwordx4 v10, s[8:11], s71 offen offset:1024  lds
    buffer_load_dwordx4 v11, s[8:11], s71 offen offset:2048  lds
L_noj3:
    v_mfma_f32_16x16x32_bf16 v[80:83], v[224:227], v[116:119], v[80:83]
    s_lshl_b32 s31, s2, 5
    ds_read_b128 v[132:135], v18 offset:6976
    v_xor_b32 v5, s31, v5
    v_mfma_f32_16x16x32_bf16 v[84:87], v[228:231], v[116:119], v[84:87]
    s_waitcnt lgkmcnt(4)
    ds_read_b64_tr_b16 v[236:237], v14 offset:18432
    v_and_b32 v160, 4, v151
    v_mfma_f32_16x16x32_bf16 v[88:91], v[220:223], v[120:123], v[88:91]
    s_lshr_b32 s31, s24, 1
    ds_read_b64_tr_b16 v[238:239], v14 offset:19200
    v_lshl_add_u32 v160, v160, 3, s35
    v_mfma_f32_16x16x32_bf16 v[92:95], v[224:227], v[120:123], v[92:95]
    s_add_u32 m0, s31, 36864
    ds_read_b64_tr_b16 v[240:241], v15 offset:18432
    v_mad_u32_u24 v160, v151, s42, v160
    v_mfma_f32_16x16x32_bf16 v[96:99], v[228:231], v[120:123], v[96:99]
    s_add_u32 s31, s31, 159744
    ds_read_b64_tr_b16 v[242:243], v15 offset:19200
    v_mad_u32_u24 v165, v165, s34, v160
    v_mfma_f32_16x16x32_bf16 v[64:67], a[84:87], v[124:127], v[64:67]
    ds_read_b128 v[52:55], v23 offset:1536
    buffer_load_dwordx4 v5, s[16:19], s31 offen lds
    v_mfma_f32_16x16x32_bf16 v[68:71], a[88:91], v[124:127], v[68:71]
    ds_read_b128 v[56:59], v23 offset:1552
    v_fract_f32 v152, v146
    v_mfma_f32_16x16x32_bf16 v[72:75], a[92:95], v[124:127], v[72:75]
    s_waitcnt lgkmcnt(5)
    ds_read_b32 v60, v23 offset:1568
    v_fract_f32 v153, v147
    v_mfma_f32_16x16x32_bf16 v[76:79], a[84:87], v[128:131], v[76:79]
    ds_read_b128 v[136:139], v18 offset:10432
    v_mul_f32 v159, v152, v153
    v_mfma_f32_16x16x32_bf16 v[80:83], a[88:91], v[128:131], v[80:83]
    buffer_load_dwordx4 v5, s[16:19], s31 offen offset:512 lds
    v_mfma_f32_16x16x32_bf16 v[84:87], a[92:95], v[128:131], v[84:87]
    v_add_f32 v155, v152, v153
    v_cndmask_b32 v152, 0, v152, s[98:99]
    v_mfma_f32_16x16x32_bf16 v[88:91], a[84:87], v[132:135], v[88:91]
    v_sub_f32 v155, v155, v159
    v_sub_f32 v158, v152, v159
    v_mfma_f32_16x16x32_bf16 v[92:95], a[88:91], v[132:135], v[92:95]
    v_sub_f32 v156, 1.0, v155
    v_sub_f32 v157, v155, v152
    v_mfma_f32_16x16x32_bf16 v[96:99], a[92:95], v[132:135], v[96:99]
    s_waitcnt lgkmcnt(1)
    buffer_load_dwordx4 v[180:183], v30, s[12:15], s55 offen
    v_mfma_f32_16x16x32_bf16 v[64:67], a[192:195], v[128:131], v[64:67]
    v_cvt_pk_bf16_f32 v167, v158, v159
    v_cvt_pk_bf16_f32 v166, v156, v157
    v_mfma_f32_16x16x32_bf16 v[68:71], a[196:199], v[128:131], v[68:71]
    v_cmp_gt_u32 vcc, s32, v148
    v_cmp_le_u32 s[84:85], s33, v149
    v_mfma_f32_16x16x32_bf16 v[72:75], a[200:203], v[128:131], v[72:75]
    v_cmp_le_u32 s[86:87], s36, v151
    v_xor_b32 v40, v52, v4
    v_mfma_f32_16x16x32_bf16 v[76:79], a[192:195], v[132:135], v[76:79]
    ds_read_b128 v[140:143], v18 offset:13888
    buffer_load_dwordx4 v[184:187], v31, s[12:15], s55 offen
    v_mfma_f32_16x16x32_bf16 v[80:83], a[196:199], v[132:135], v[80:83]
    s_or_b64 vcc, vcc, s[84:85]
    v_xor_b32 v41, v53, v4
    v_xor_b32 v42, v54, v4
    v_mfma_f32_16x16x32_bf16 v[84:87], a[200:203], v[132:135], v[84:87]
    s_waitcnt lgkmcnt(1)
    v_xor_b32 v43, v55, v4
    v_xor_b32 v44, v56, v4
    v_mfma_f32_16x16x32_bf16 v[88:91], a[192:195], v[136:139], v[88:91]
    ds_write_b64 v111, v[164:165]
    v_mfma_f32_16x16x32_bf16 v[92:95], a[196:199], v[136:139], v[92:95]
    ds_read2_b32 v[176:177], v24 offset0:0 offset1:32
    ds_read_b128 v[112:115], v18 offset:128
    v_mfma_f32_16x16x32_bf16 v[96:99], a[200:203], v[136:139], v[96:99]
    s_waitcnt vmcnt(4)
    s_barrier
    v_mfma_f32_16x16x32_bf16 v[64:67], v[232:235], v[132:135], v[64:67]
    ds_read_b64_tr_b16 a[96:97], v13 offset:24576
    ds_read_b64_tr_b16 a[98:99], v13 offset:25344
    ds_read_b64_tr_b16 a[100:101], v14 offset:24576
    v_mfma_f32_16x16x32_bf16 v[68:71], v[236:239], v[132:135], v[68:71]
    ds_read_b64_tr_b16 a[102:103], v14 offset:25344
    ds_read_b64_tr_b16 a[104:105], v15 offset:24576
    v_mfma_f32_16x16x32_bf16 v[72:75], v[240:243], v[132:135], v[72:75]
    ds_write_b64 v111, v[166:167] offset:8
    v_mfma_f32_16x16x32_bf16 v[76:79], v[232:235], v[136:139], v[76:79]
    ds_read_b64_tr_b16 a[106:107], v15 offset:25344
    ds_read_b64_tr_b16 a[204:205], v13 offset:30720
    v_mfma_f32_16x16x32_bf16 v[80:83], v[236:239], v[136:139], v[80:83]
    s_or_b64 vcc, vcc, s[86:87]
    s_cbranch_scc1 L_bfail2
L_bfail2_back:
    v_mfma_f32_16x16x32_bf16 v[84:87], v[240:243], v[136:139], v[84:87]
    s_waitcnt lgkmcnt(8)
    ds_read_b128 v[116:119], v18 offset:3584
    ds_read_b64_tr_b16 a[206:207], v13 offset:31488
    v_mfma_f32_16x16x32_bf16 v[88:91], v[232:235], v[140:143], v[88:91]
    ds_read_b64_tr_b16 a[208:209], v14 offset:30720
    ds_read_b128 v[120:123], v18 offset:7040
    v_mfma_f32_16x16x32_bf16 v[92:95], v[236:239], v[140:143], v[92:95]
    ds_read_b64_tr_b16 a[210:211], v14 offset:31488
    ds_read_b64 v[178:179], v25 offset:8
    v_mfma_f32_16x16x32_bf16 v[96:99], v[240:243], v[140:143], v[96:99]
    s_waitcnt vmcnt(2) lgkmcnt(7)
    s_barrier
    v_mfma_f32_16x16x32_bf16 v[64:67], a[96:99], v[112:115], v[64:67]
    ds_read_b64_tr_b16 a[212:213], v15 offset:30720
    ds_read_b64_tr_b16 a[214:215], v15 offset:31488
    v_xor_b32 v172, v176, v26
    v_mfma_f32_16x16x32_bf16 v[68:71], a[100:103], v[112:115], v[68:71]
    ds_read_b64_tr_b16 v[144:145], v172 offset:0
    ds_read_b64_tr_b16 v[244:245], v13 offset:36864
    v_xor_b32 v174, v177, v26
    v_mfma_f32_16x16x32_bf16 v[72:75], a[104:107], v[112:115], v[72:75]
    s_waitcnt lgkmcnt(8)
    ds_read_b64_tr_b16 v[146:147], v174 offset:0
    ds_read_b64_tr_b16 v[246:247], v13 offset:37632
    v_xor_b32 v173, v176, v27
    v_mfma_f32_16x16x32_bf16 v[76:79], a[96:99], v[116:119], v[76:79]
    ds_read_b64_tr_b16 v[148:149], v173 offset:0
    ds_read_b64_tr_b16 v[248:249], v14 offset:36864
    v_xor_b32 v175, v177, v27
    v_mfma_f32_16x16x32_bf16 v[80:83], a[100:103], v[116:119], v[80:83]
    ds_read_b64_tr_b16 v[150:151], v175 offset:0
    v_xor_b32 v45, v57, v4
    v_mfma_f32_16x16x32_bf16 v[84:87], a[104:107], v[116:119], v[84:87]
    s_waitcnt lgkmcnt(9)
    ds_read_b64_tr_b16 v[152:153], v172 offset:64
    v_cndmask_b32 v169, 0, v179, s[88:89]
    v_mfma_f32_16x16x32_bf16 v[88:91], a[96:99], v[120:123], v[88:91]
    ds_read_b64_tr_b16 v[154:155], v174 offset:64
    v_cndmask_b32 v171, 0, v179, s[92:93]
    v_mfma_f32_16x16x32_bf16 v[92:95], a[100:103], v[120:123], v[92:95]
    ds_read_b64_tr_b16 v[156:157], v173 offset:64
    v_cndmask_b32 v168, 0, v178, s[88:89]
    v_mfma_f32_16x16x32_bf16 v[96:99], a[104:107], v[120:123], v[96:99]
    s_waitcnt lgkmcnt(6)
    ds_read_b64_tr_b16 v[158:159], v175 offset:64
    v_cndmask_b32 v170, 0, v178, s[92:93]
    v_mfma_f32_16x16x32_bf16 v[64:67], a[204:207], v[116:119], v[64:67]
    ds_read_b64_tr_b16 v[160:161], v172 offset:128
    v_cndmask_b32 v169, v169, v178, s[90:91]
    v_cndmask_b32 v171, v171, v178, s[94:95]
    v_mfma_f32_16x16x32_bf16 v[68:71], a[208:211], v[116:119], v[68:71]
    ds_read_b64_tr_b16 v[162:163], v174 offset:128
    v_xor_b32 v46, v58, v4
    v_mfma_f32_16x16x32_bf16 v[72:75], a[212:215], v[116:119], v[72:75]
    s_waitcnt lgkmcnt(4)
    ds_read_b64_tr_b16 v[164:165], v173 offset:128
    v_xor_b32 v47, v59, v4
    v_mfma_f32_16x16x32_bf16 v[144:147], v[144:147], v[168:171], 0
    ds_read_b64_tr_b16 v[166:167], v175 offset:128
    v_xor_b32 v48, v60, v4
    v_mfma_f32_16x16x32_bf16 v[148:151], v[148:151], v[168:171], 0
    ds_read_b128 v[124:127], v18 offset:10496
    v_mad_u32_u24 v21, v2, s54, v21
    v_mfma_f32_16x16x32_bf16 v[152:155], v[152:155], v[168:171], 0
    ds_read_b64_tr_b16 v[250:251], v14 offset:37632
    v_lshlrev_b32 v39, 3, v0
    v_mfma_f32_16x16x32_bf16 v[76:79], a[204:207], v[120:123], v[76:79]
    ds_read_b64_tr_b16 v[252:253], v15 offset:36864
    v_cvt_pk_bf16_f32 v144, v144, v145
    v_cvt_pk_bf16_f32 v145, v146, v147
    v_mfma_f32_16x16x32_bf16 v[80:83], a[208:211], v[120:123], v[80:83]
    ds_write_b64 v28, v[144:145] offset:0
    v_mfma_f32_16x16x32_bf16 v[84:87], a[212:215], v[120:123], v[84:87]
    s_waitcnt lgkmcnt(4)
    ds_read_b64_tr_b16 v[254:255], v15 offset:37632
    v_cvt_pk_bf16_f32 v148, v148, v149
    v_cvt_pk_bf16_f32 v149, v150, v151
    v_mfma_f32_16x16x32_bf16 v[156:159], v[156:159], v[168:171], 0
    ds_write_b64 v29, v[148:149] offset:0
    v_mfma_f32_16x16x32_bf16 v[160:163], v[160:163], v[168:171], 0
    ds_read_b128 v[128:131], v18 offset:13952
    v_cvt_pk_bf16_f32 v152, v152, v153
    v_cvt_pk_bf16_f32 v153, v154, v155
    v_mfma_f32_16x16x32_bf16 v[164:167], v[164:167], v[168:171], 0
    s_waitcnt lgkmcnt(5)
    ds_write_b64 v28, v[152:153] offset:64
    v_mfma_f32_16x16x32_bf16 v[88:91], a[204:207], v[124:127], v[88:91]
    v_cvt_pk_bf16_f32 v156, v156, v157
    v_cvt_pk_bf16_f32 v157, v158, v159
    v_mfma_f32_16x16x32_bf16 v[92:95], a[208:211], v[124:127], v[92:95]
    ds_write_b64 v29, v[156:157] offset:64
    v_mfma_f32_16x16x32_bf16 v[96:99], a[212:215], v[124:127], v[96:99]
    s_waitcnt lgkmcnt(4)
    v_cvt_pk_bf16_f32 v160, v160, v161
    v_cvt_pk_bf16_f32 v161, v162, v163
    v_mfma_f32_16x16x32_bf16 v[64:67], v[244:247], v[120:123], v[64:67]
    ds_write_b64 v28, v[160:161] offset:128
    v_mfma_f32_16x16x32_bf16 v[68:71], v[248:251], v[120:123], v[68:71]
    v_cvt_pk_bf16_f32 v164, v164, v165
    v_cvt_pk_bf16_f32 v165, v166, v167
    v_mfma_f32_16x16x32_bf16 v[72:75], v[252:255], v[120:123], v[72:75]
    ds_write_b64 v29, v[164:165] offset:128
    v_mfma_f32_16x16x32_bf16 v[76:79], v[244:247], v[124:127], v[76:79]
    s_cmp_gt_u32 s62, 16
    s_cbranch_scc1 L_more
L_more_back:
    v_mfma_f32_16x16x32_bf16 v[80:83], v[248:251], v[124:127], v[80:83]
    v_lshrrev_b32 v22, 1, v0
    v_bitop3_b32 v22, v22, 48, v39 bitop3:0x6a
    v_mfma_f32_16x16x32_bf16 v[84:87], v[252:255], v[124:127], v[84:87]
    s_waitcnt lgkmcnt(0)
    s_barrier
    ds_read_b128 v[132:135], v40 offset:0
    v_mfma_f32_16x16x32_bf16 v[88:91], v[244:247], v[128:131], v[88:91]
    ds_read_b128 v[136:139], v40 offset:64
    v_bfe_u32 v37, v0, 3, 4
    v_mfma_f32_16x16x32_bf16 v[92:95], v[248:251], v[128:131], v[92:95]
    ds_read_b128 v[140:143], v40 offset:128
    v_and_or_b32 v22, v22, 56, 64
    v_mfma_f32_16x16x32_bf16 v[96:99], v[252:255], v[128:131], v[96:99]
    s_waitcnt lgkmcnt(2)
    ds_read_b128 v[112:115], v41 offset:0
    v_mad_u32_u24 v20, v37, s42, v22
    v_mfma_f32_16x16x32_bf16 v[100:103], a[0:3], v[132:135], 0
    ds_read_b128 v[116:119], v41 offset:64
    v_cvt_pk_bf16_f32 v64, v64, v65
    v_mfma_f32_16x16x32_bf16 v[104:107], a[4:7], v[132:135], 0
    ds_read_b128 v[52:55], v23 offset:768
    v_cvt_pk_bf16_f32 v65, v66, v67
    v_mfma_f32_16x16x32_bf16 v[108:111], a[8:11], v[132:135], 0
    s_waitcnt lgkmcnt(4)
    ds_read_b128 v[56:59], v23 offset:784
    v_cvt_pk_bf16_f32 v66, v68, v69
    v_mfma_f32_16x16x32_bf16 v[100:103], a[12:15], v[136:139], v[100:103]
    ds_read_b128 v[120:123], v41 offset:128
    v_cvt_pk_bf16_f32 v67, v70, v71
    v_mfma_f32_16x16x32_bf16 v[104:107], a[16:19], v[136:139], v[104:107]
    v_permlane16_swap_b32 v64, v66
    v_mfma_f32_16x16x32_bf16 v[108:111], a[20:23], v[136:139], v[108:111]
    s_waitcnt lgkmcnt(4)
    v_permlane16_swap_b32 v65, v67
    v_mfma_f32_16x16x32_bf16 v[100:103], a[24:27], v[140:143], v[100:103]
    ds_read_b128 v[124:127], v42 offset:0
    v_cvt_pk_bf16_f32 v72, v72, v73
    v_mfma_f32_16x16x32_bf16 v[104:107], a[28:31], v[140:143], v[104:107]
    buffer_store_dwordx4 v[64:67], v19, s[20:23], s56 offen sc1
    v_cvt_pk_bf16_f32 v73, v74, v75
    v_mad_u32_u24 v22, v37, s54, v22
    v_cvt_pk_bf16_f32 v84, v84, v85
    v_mfma_f32_16x16x32_bf16 v[108:111], a[32:35], v[140:143], v[108:111]
    s_waitcnt lgkmcnt(2)
    ds_write_b64 v38, v[72:73] offset:49152
    v_mfma_f32_16x16x32_bf16 v[100:103], a[36:39], v[112:115], v[100:103]
    ds_read_b128 v[128:131], v42 offset:64
    v_mfma_f32_16x16x32_bf16 v[104:107], a[40:43], v[112:115], v[104:107]
    ds_read_b32 v60, v23 offset:800
    v_xor_b32 v40, v52, v4
    v_mfma_f32_16x16x32_bf16 v[108:111], a[44:47], v[112:115], v[108:111]
    ds_read2_b32 v[176:177], v24 offset0:64 offset1:96
    v_xor_b32 v41, v53, v4
    v_mfma_f32_16x16x32_bf16 v[100:103], a[48:51], v[116:119], v[100:103]
    ds_read_b128 v[132:135], v42 offset:128
    v_xor_b32 v42, v54, v4
    v_mfma_f32_16x16x32_bf16 v[104:107], a[52:55], v[116:119], v[104:107]
    ds_read_b64 v[178:179], v25 offset:264
    v_cvt_pk_bf16_f32 v85, v86, v87
    v_mfma_f32_16x16x32_bf16 v[108:111], a[56:59], v[116:119], v[108:111]
    s_waitcnt lgkmcnt(5)
    ds_write_b64 v38, v[84:85] offset:51200
    v_mfma_f32_16x16x32_bf16 v[100:103], a[60:63], v[120:123], v[100:103]
    ds_read_b128 v[136:139], v43 offset:0
    v_mfma_f32_16x16x32_bf16 v[104:107], a[64:67], v[120:123], v[104:107]
    v_cvt_pk_bf16_f32 v96, v96, v97
    v_cvt_pk_bf16_f32 v97, v98, v99
    v_mfma_f32_16x16x32_bf16 v[108:111], a[68:71], v[120:123], v[108:111]
    s_waitcnt lgkmcnt(4)
    ds_write_b64 v38, v[96:97] offset:53248
    v_mfma_f32_16x16x32_bf16 v[100:103], a[72:75], v[124:127], v[100:103]
    ds_read_b128 v[140:143], v43 offset:64
    v_mfma_f32_16x16x32_bf16 v[104:107], a[76:79], v[124:127], v[104:107]
    v_xor_b32 v172, v176, v26
    v_xor_b32 v174, v177, v26
    v_mfma_f32_16x16x32_bf16 v[108:111], a[80:83], v[124:127], v[108:111]
    s_waitcnt lgkmcnt(3)
    v_xor_b32 v173, v176, v27
    v_xor_b32 v175, v177, v27
    v_mfma_f32_16x16x32_bf16 v[100:103], a[84:87], v[128:131], v[100:103]
    ds_read_b128 v[112:115], v43 offset:128
    v_cndmask_b32 v169, 0, v179, s[88:89]
    v_mfma_f32_16x16x32_bf16 v[104:107], a[88:91], v[128:131], v[104:107]
    v_cndmask_b32 v171, 0, v179, s[92:93]
    v_cndmask_b32 v168, 0, v178, s[88:89]
    v_mfma_f32_16x16x32_bf16 v[108:111], a[92:95], v[128:131], v[108:111]
    v_cndmask_b32 v170, 0, v178, s[92:93]
    v_cndmask_b32 v169, v169, v178, s[90:91]
    v_mfma_f32_16x16x32_bf16 v[100:103], a[96:99], v[132:135], v[100:103]
    ds_read_b128 v[116:119], v44 offset:0
    v_cndmask_b32 v171, v171, v178, s[94:95]
    v_mfma_f32_16x16x32_bf16 v[104:107], a[100:103], v[132:135], v[104:107]
    v_xor_b32 v43, v55, v4
    v_cvt_pk_bf16_f32 v76, v76, v77
    v_mfma_f32_16x16x32_bf16 v[108:111], a[104:107], v[132:135], v[108:111]
    s_waitcnt lgkmcnt(2)
    v_cvt_pk_bf16_f32 v77, v78, v79
    v_cvt_pk_bf16_f32 v78, v80, v81
    v_mfma_f32_16x16x32_bf16 v[100:103], a[108:111], v[136:139], v[100:103]
    ds_read_b128 v[120:123], v44 offset:64
    v_cvt_pk_bf16_f32 v79, v82, v83
    v_mfma_f32_16x16x32_bf16 v[104:107], a[112:115], v[136:139], v[104:107]
    v_permlane16_swap_b32 v76, v78
    v_mfma_f32_16x16x32_bf16 v[108:111], a[116:119], v[136:139], v[108:111]
    v_permlane16_swap_b32 v77, v79
    v_mfma_f32_16x16x32_bf16 v[100:103], a[120:123], v[140:143], v[100:103]
    ds_read_b128 v[124:127], v44 offset:128
    v_xor_b32 v44, v56, v4
    v_mfma_f32_16x16x32_bf16 v[104:107], a[124:127], v[140:143], v[104:107]
    ds_read_b64_tr_b16 v[144:145], v172 offset:0
    v_cvt_pk_bf16_f32 v88, v88, v89
    v_mfma_f32_16x16x32_bf16 v[108:111], a[128:131], v[140:143], v[108:111]
    s_waitcnt lgkmcnt(3)
    ds_read_b64_tr_b16 v[146:147], v174 offset:0
    v_cvt_pk_bf16_f32 v89, v90, v91
    v_mfma_f32_16x16x32_bf16 v[100:103], a[132:135], v[112:115], v[100:103]
    ds_read_b64_tr_b16 v[148:149], v173 offset:0
    v_cvt_pk_bf16_f32 v90, v92, v93
    v_mfma_f32_16x16x32_bf16 v[104:107], a[136:139], v[112:115], v[104:107]
    ds_read_b128 v[128:131], v45 offset:0
    v_cvt_pk_bf16_f32 v91, v94, v95
    v_mfma_f32_16x16x32_bf16 v[108:111], a[140:143], v[112:115], v[108:111]
    ds_read_b64_tr_b16 v[150:151], v175 offset:0
    v_mfma_f32_16x16x32_bf16 v[100:103], a[144:147], v[116:119], v[100:103]
    ds_read_b64_tr_b16 v[152:153], v172 offset:64
    v_mfma_f32_16x16x32_bf16 v[104:107], a[148:151], v[116:119], v[104:107]
    ds_read_b64_tr_b16 v[154:155], v174 offset:64
    v_mfma_f32_16x16x32_bf16 v[108:111], a[152:155], v[116:119], v[108:111]
    s_waitcnt lgkmcnt(5)
    ds_read_b128 v[132:135], v45 offset:64
    v_mfma_f32_16x16x32_bf16 v[100:103], a[156:159], v[120:123], v[100:103]
    ds_read_b64_tr_b16 v[156:157], v173 offset:64
    v_mfma_f32_16x16x32_bf16 v[104:107], a[160:163], v[120:123], v[104:107]
    ds_read_b64_tr_b16 v[158:159], v175 offset:64
    v_mfma_f32_16x16x32_bf16 v[108:111], a[164:167], v[120:123], v[108:111]
    ds_read_b64_tr_b16 v[160:161], v172 offset:128
    v_mfma_f32_16x16x32_bf16 v[100:103], a[168:171], v[124:127], v[100:103]
    ds_read_b64_tr_b16 v[162:163], v174 offset:128
    v_mfma_f32_16x16x32_bf16 v[104:107], a[172:175], v[124:127], v[104:107]
    ds_read_b64_tr_b16 v[164:165], v173 offset:128
    v_mfma_f32_16x16x32_bf16 v[108:111], a[176:179], v[124:127], v[108:111]
    s_waitcnt lgkmcnt(5)
    ds_read_b64_tr_b16 v[166:167], v175 offset:128
    v_mfma_f32_16x16x32_bf16 v[100:103], a[180:183], v[128:131], v[100:103]
    ds_read_b128 v[136:139], v45 offset:128
    v_xor_b32 v45, v57, v4
    v_mfma_f32_16x16x32_bf16 v[104:107], a[184:187], v[128:131], v[104:107]
    buffer_store_dwordx4 v[76:79], v19, s[20:23], s4 offen sc1
    v_mfma_f32_16x16x32_bf16 v[108:111], a[188:191], v[128:131], v[108:111]
    v_permlane16_swap_b32 v88, v90
    v_mfma_f32_16x16x32_bf16 v[100:103], a[192:195], v[132:135], v[100:103]
    ds_read_b128 v[140:143], v46 offset:0
    v_mfma_f32_16x16x32_bf16 v[104:107], a[196:199], v[132:135], v[104:107]
    v_permlane16_swap_b32 v89, v91
    v_mfma_f32_16x16x32_bf16 v[108:111], a[200:203], v[132:135], v[108:111]
    buffer_store_dwordx4 v[88:91], v19, s[20:23], s5 offen sc1
    v_mfma_f32_16x16x32_bf16 v[144:147], v[144:147], v[168:171], 0
    ds_read_b128 v[112:115], v46 offset:64
    v_mfma_f32_16x16x32_bf16 v[148:151], v[148:151], v[168:171], 0
    v_mfma_f32_16x16x32_bf16 v[152:155], v[152:155], v[168:171], 0
    s_waitcnt lgkmcnt(2)
    v_mfma_f32_16x16x32_bf16 v[156:159], v[156:159], v[168:171], 0
    ds_read_b128 v[116:119], v46 offset:128
    v_xor_b32 v46, v58, v4
    v_mfma_f32_16x16x32_bf16 v[160:163], v[160:163], v[168:171], 0
    v_cvt_pk_bf16_f32 v144, v144, v145
    v_cvt_pk_bf16_f32 v145, v146, v147
    v_mfma_f32_16x16x32_bf16 v[164:167], v[164:167], v[168:171], 0
    ds_write_b64 v28, v[144:145] offset:12288
    v_mfma_f32_16x16x32_bf16 v[100:103], a[204:207], v[136:139], v[100:103]
    ds_read_b128 v[120:123], v47 offset:0
    v_mfma_f32_16x16x32_bf16 v[104:107], a[208:211], v[136:139], v[104:107]
    v_cvt_pk_bf16_f32 v148, v148, v149
    v_cvt_pk_bf16_f32 v149, v150, v151
    v_mfma_f32_16x16x32_bf16 v[108:111], a[212:215], v[136:139], v[108:111]
    s_waitcnt lgkmcnt(3)
    ds_write_b64 v29, v[148:149] offset:12288
    v_mfma_f32_16x16x32_bf16 v[100:103], a[216:219], v[140:143], v[100:103]
    ds_read_b128 v[124:127], v47 offset:64
    v_mfma_f32_16x16x32_bf16 v[104:107], a[220:223], v[140:143], v[104:107]
    v_cvt_pk_bf16_f32 v152, v152, v153
    v_cvt_pk_bf16_f32 v153, v154, v155
    v_mfma_f32_16x16x32_bf16 v[108:111], a[224:227], v[140:143], v[108:111]
    ds_read2_b32 v[176:177], v24 offset0:128 offset1:160
    v_cvt_pk_bf16_f32 v156, v156, v157
    v_mfma_f32_16x16x32_bf16 v[100:103], a[228:231], v[112:115], v[100:103]
    ds_read_b128 v[128:131], v47 offset:128
    v_cvt_pk_bf16_f32 v157, v158, v159
    v_mfma_f32_16x16x32_bf16 v[104:107], a[232:235], v[112:115], v[104:107]
    ds_write_b64 v28, v[152:153] offset:12352
    v_mfma_f32_16x16x32_bf16 v[108:111], a[236:239], v[112:115], v[108:111]
    s_waitcnt lgkmcnt(4)
    ds_read_b64 v[178:179], v25 offset:520
    v_mfma_f32_16x16x32_bf16 v[100:103], a[240:243], v[116:119], v[100:103]
    ds_read_b128 v[132:135], v48 offset:0
    v_cvt_pk_bf16_f32 v160, v160, v161
    v_mfma_f32_16x16x32_bf16 v[104:107], a[244:247], v[116:119], v[104:107]
    ds_write_b64 v29, v[156:157] offset:12352
    v_mfma_f32_16x16x32_bf16 v[108:111], a[248:251], v[116:119], v[108:111]
    s_waitcnt lgkmcnt(5)
    v_xor_b32 v172, v176, v26
    v_xor_b32 v174, v177, v26
    v_mfma_f32_16x16x32_bf16 v[100:103], a[252:255], v[120:123], v[100:103]
    ds_read_b128 v[136:139], v48 offset:64
    v_xor_b32 v173, v176, v27
    v_mfma_f32_16x16x32_bf16 v[104:107], v[188:191], v[120:123], v[104:107]
    v_xor_b32 v175, v177, v27
    v_cvt_pk_bf16_f32 v161, v162, v163
    v_mfma_f32_16x16x32_bf16 v[108:111], v[192:195], v[120:123], v[108:111]
    s_waitcnt lgkmcnt(3)
    ds_write_b64 v28, v[160:161] offset:12416
    v_mfma_f32_16x16x32_bf16 v[100:103], v[196:199], v[124:127], v[100:103]
    ds_read_b128 v[140:143], v48 offset:128
    v_mfma_f32_16x16x32_bf16 v[104:107], v[200:203], v[124:127], v[104:107]
    v_cvt_pk_bf16_f32 v164, v164, v165
    v_cvt_pk_bf16_f32 v165, v166, v167
    v_mfma_f32_16x16x32_bf16 v[108:111], v[204:207], v[124:127], v[108:111]
    ds_write_b64 v29, v[164:165] offset:12416
    v_mfma_f32_16x16x32_bf16 v[100:103], v[208:211], v[128:131], v[100:103]
    ds_read_b128 v[112:115], v40 offset:0
    v_mfma_f32_16x16x32_bf16 v[104:107], v[212:215], v[128:131], v[104:107]
    v_cndmask_b32 v169, 0, v179, s[88:89]
    v_cndmask_b32 v171, 0, v179, s[92:93]
    v_mfma_f32_16x16x32_bf16 v[108:111], v[216:219], v[128:131], v[108:111]
    s_waitcnt lgkmcnt(3)
    v_cndmask_b32 v168, 0, v178, s[88:89]
    v_cndmask_b32 v170, 0, v178, s[92:93]
    v_mfma_f32_16x16x32_bf16 v[100:103], v[220:223], v[132:135], v[100:103]
    ds_read_b128 v[116:119], v40 offset:64
    v_cndmask_b32 v169, v169, v178, s[90:91]
    v_mfma_f32_16x16x32_bf16 v[104:107], v[224:227], v[132:135], v[104:107]
    v_cndmask_b32 v171, v171, v178, s[94:95]
    v_xor_b32 v47, v59, v4
    v_mfma_f32_16x16x32_bf16 v[108:111], v[228:231], v[132:135], v[108:111]
    v_xor_b32 v48, v60, v4
    v_mfma_f32_16x16x32_bf16 v[100:103], v[232:235], v[136:139], v[100:103]
    ds_read_b128 v[120:123], v40 offset:128
    v_mfma_f32_16x16x32_bf16 v[104:107], v[236:239], v[136:139], v[104:107]
    ds_read_b64_tr_b16 v[144:145], v172 offset:0
    v_mfma_f32_16x16x32_bf16 v[108:111], v[240:243], v[136:139], v[108:111]
    s_waitcnt lgkmcnt(3)
    ds_read_b64_tr_b16 v[146:147], v174 offset:0
    v_mfma_f32_16x16x32_bf16 v[100:103], v[244:247], v[140:143], v[100:103]
    ds_read_b64_tr_b16 v[148:149], v173 offset:0
    v_mfma_f32_16x16x32_bf16 v[104:107], v[248:251], v[140:143], v[104:107]
    ds_read_b128 v[124:127], v41 offset:0
    v_mfma_f32_16x16x32_bf16 v[108:111], v[252:255], v[140:143], v[108:111]
    s_waitcnt vmcnt(3) lgkmcnt(5)
    ds_read_b64_tr_b16 v[150:151], v175 offset:0
    v_mfma_f32_16x16x32_bf16 v[64:67], a[0:3], v[112:115], 0
    ds_read_b64_tr_b16 v[152:153], v172 offset:64
    v_and_b32 v180, s96, v180
    v_mfma_f32_16x16x32_bf16 v[68:71], a[4:7], v[112:115], 0
    ds_read_b64_tr_b16 v[154:155], v174 offset:64
    v_and_b32 v181, s96, v181
    v_mfma_f32_16x16x32_bf16 v[72:75], a[8:11], v[112:115], 0
    ds_read_b128 v[128:131], v41 offset:64
    v_cvt_pk_bf16_f32 v108, v108, v109
    v_mfma_f32_16x16x32_bf16 v[64:67], a[12:15], v[116:119], v[64:67]
    ds_read_b64_tr_b16 v[156:157], v173 offset:64
    v_cvt_pk_bf16_f32 v109, v110, v111
    v_mfma_f32_16x16x32_bf16 v[68:71], a[16:19], v[116:119], v[68:71]
    ds_read_b64_tr_b16 v[158:159], v175 offset:64
    v_and_b32 v182, s96, v182
    v_mfma_f32_16x16x32_bf16 v[72:75], a[20:23], v[116:119], v[72:75]
    s_waitcnt lgkmcnt(5)
    ds_read_b64_tr_b16 v[160:161], v172 offset:128
    v_and_b32 v183, s96, v183
    v_mfma_f32_16x16x32_bf16 v[64:67], a[24:27], v[120:123], v[64:67]
    ds_read_b64_tr_b16 v[162:163], v174 offset:128
    v_pk_max_u16 v180, v180, v181
    v_mfma_f32_16x16x32_bf16 v[68:71], a[28:31], v[120:123], v[68:71]
    ds_read_b64_tr_b16 v[164:165], v173 offset:128
    v_pk_max_u16 v182, v182, v183
    v_mfma_f32_16x16x32_bf16 v[72:75], a[32:35], v[120:123], v[72:75]
    ds_read_b64_tr_b16 v[166:167], v175 offset:128
    v_pk_max_u16 v180, v180, s37
    v_mfma_f32_16x16x32_bf16 v[64:67], a[36:39], v[124:127], v[64:67]
    ds_read_b128 v[132:135], v41 offset:128
    v_pk_max_u16 v180, v180, v182
    v_mfma_f32_16x16x32_bf16 v[68:71], a[40:43], v[124:127], v[68:71]
    ds_read_b128 v[52:55], v23 offset:0
    v_cmp_ne_u32 s[80:81], s37, v180
    v_mfma_f32_16x16x32_bf16 v[72:75], a[44:47], v[124:127], v[72:75]
    s_waitcnt lgkmcnt(5)
    ds_read2_b32 v[176:177], v24 offset0:192 offset1:224
    v_and_b32 v184, s96, v184
    v_mfma_f32_16x16x32_bf16 v[64:67], a[48:51], v[128:131], v[64:67]
    ds_read_b128 v[136:139], v42 offset:0
    v_and_b32 v185, s96, v185
    v_mfma_f32_16x16x32_bf16 v[68:71], a[52:55], v[128:131], v[68:71]
    ds_read_b64 v[178:179], v25 offset:776
    v_and_b32 v186, s96, v186
    v_mfma_f32_16x16x32_bf16 v[72:75], a[56:59], v[128:131], v[72:75]
    ds_write_b64 v38, v[108:109] offset:55296
    v_mfma_f32_16x16x32_bf16 v[144:147], v[144:147], v[168:171], 0
    ds_read_b128 v[140:143], v42 offset:64
    v_mfma_f32_16x16x32_bf16 v[148:151], v[148:151], v[168:171], 0
    ds_read_b128 v[56:59], v23 offset:16
    v_and_b32 v187, s96, v187
    v_mfma_f32_16x16x32_bf16 v[152:155], v[152:155], v[168:171], 0
    s_waitcnt lgkmcnt(5)
    ds_read_b32 v60, v23 offset:32
    v_xor_b32 v172, v176, v26
    v_mfma_f32_16x16x32_bf16 v[156:159], v[156:159], v[168:171], 0
    ds_read_b128 v[112:115], v42 offset:128
    v_cvt_pk_bf16_f32 v144, v144, v145
    v_mfma_f32_16x16x32_bf16 v[160:163], v[160:163], v[168:171], 0
    v_cvt_pk_bf16_f32 v145, v146, v147
    v_cvt_pk_bf16_f32 v148, v148, v149
    v_mfma_f32_16x16x32_bf16 v[164:167], v[164:167], v[168:171], 0
    s_waitcnt lgkmcnt(4)
    ds_write_b64 v28, v[144:145] offset:24576
    v_mfma_f32_16x16x32_bf16 v[64:67], a[60:63], v[132:135], v[64:67]
    ds_read_b128 v[116:119], v43 offset:0
    v_mfma_f32_16x16x32_bf16 v[68:71], a[64:67], v[132:135], v[68:71]
    v_cvt_pk_bf16_f32 v149, v150, v151
    v_xor_b32 v174, v177, v26
    v_mfma_f32_16x16x32_bf16 v[72:75], a[68:71], v[132:135], v[72:75]
    s_waitcnt lgkmcnt(3)
    ds_write_b64 v29, v[148:149] offset:24576
    v_mfma_f32_16x16x32_bf16 v[64:67], a[72:75], v[136:139], v[64:67]
    ds_read_b128 v[120:123], v43 offset:64
    v_mfma_f32_16x16x32_bf16 v[68:71], a[76:79], v[136:139], v[68:71]
    v_xor_b32 v173, v176, v27
    v_cvt_pk_bf16_f32 v152, v152, v153
    v_mfma_f32_16x16x32_bf16 v[72:75], a[80:83], v[136:139], v[72:75]
    v_cvt_pk_bf16_f32 v153, v154, v155
    v_xor_b32 v175, v177, v27
    v_mfma_f32_16x16x32_bf16 v[64:67], a[84:87], v[140:143], v[64:67]
    ds_read_b128 v[124:127], v43 offset:128
    v_cvt_pk_bf16_f32 v156, v156, v157
    v_mfma_f32_16x16x32_bf16 v[68:71], a[88:91], v[140:143], v[68:71]
    ds_write_b64 v28, v[152:153] offset:24640
    v_mfma_f32_16x16x32_bf16 v[72:75], a[92:95], v[140:143], v[72:75]
    s_waitcnt lgkmcnt(3)
    v_cvt_pk_bf16_f32 v157, v158, v159
    v_cvt_pk_bf16_f32 v160, v160, v161
    v_mfma_f32_16x16x32_bf16 v[64:67], a[96:99], v[112:115], v[64:67]
    ds_read_b128 v[128:131], v44 offset:0
    v_cvt_pk_bf16_f32 v161, v162, v163
    v_mfma_f32_16x16x32_bf16 v[68:71], a[100:103], v[112:115], v[68:71]
    ds_read_b64_tr_b16 v[144:145], v172 offset:0
    v_cvt_pk_bf16_f32 v164, v164, v165
    v_mfma_f32_16x16x32_bf16 v[72:75], a[104:107], v[112:115], v[72:75]
    ds_read_b64_tr_b16 v[146:147], v174 offset:0
    v_cvt_pk_bf16_f32 v165, v166, v167
    v_mfma_f32_16x16x32_bf16 v[64:67], a[108:111], v[116:119], v[64:67]
    ds_read_b64_tr_b16 v[148:149], v173 offset:0
    v_cndmask_b32 v169, 0, v179, s[88:89]
    v_mfma_f32_16x16x32_bf16 v[68:71], a[112:115], v[116:119], v[68:71]
    ds_read_b128 v[132:135], v44 offset:64
    v_cndmask_b32 v171, 0, v179, s[92:93]
    v_mfma_f32_16x16x32_bf16 v[72:75], a[116:119], v[116:119], v[72:75]
    s_waitcnt lgkmcnt(5)
    ds_read_b64_tr_b16 v[150:151], v175 offset:0
    v_cndmask_b32 v168, 0, v178, s[88:89]
    v_mfma_f32_16x16x32_bf16 v[64:67], a[120:123], v[120:123], v[64:67]
L_pgY2:
  s_cbranch_execz L_retY
    ds_read_b64_tr_b16 v[152:153], v172 offset:64
    v_cndmask_b32 v170, 0, v178, s[92:93]
    v_mfma_f32_16x16x32_bf16 v[68:71], a[124:127], v[120:123], v[68:71]
    ds_read_b64_tr_b16 v[154:155], v174 offset:64
    v_cndmask_b32 v169, v169, v178, s[90:91]
    v_mfma_f32_16x16x32_bf16 v[72:75], a[128:131], v[120:123], v[72:75]
    ds_write_b64 v29, v[156:157] offset:24640
    v_mfma_f32_16x16x32_bf16 v[64:67], a[132:135], v[124:127], v[64:67]
    ds_read_b128 v[136:139], v44 offset:128
    v_mfma_f32_16x16x32_bf16 v[68:71], a[136:139], v[124:127], v[68:71]
    ds_read_b64_tr_b16 v[156:157], v173 offset:64
    v_cndmask_b32 v171, v171, v178, s[94:95]
    v_mfma_f32_16x16x32_bf16 v[72:75], a[140:143], v[124:127], v[72:75]
    s_waitcnt lgkmcnt(5)
    ds_read_b64_tr_b16 v[158:159], v175 offset:64
    v_pk_max_u16 v184, v184, v185
    v_mfma_f32_16x16x32_bf16 v[64:67], a[144:147], v[128:131], v[64:67]
    ds_write_b64 v28, v[160:161] offset:24704
    v_mfma_f32_16x16x32_bf16 v[68:71], a[148:151], v[128:131], v[68:71]
    ds_read_b64_tr_b16 v[160:161], v172 offset:128
    v_mfma_f32_16x16x32_bf16 v[72:75], a[152:155], v[128:131], v[72:75]
    ds_read_b64_tr_b16 v[162:163], v174 offset:128
    v_pk_max_u16 v186, v186, v187
    v_mfma_f32_16x16x32_bf16 v[64:67], a[156:159], v[132:135], v[64:67]
    ds_write_b64 v29, v[164:165] offset:24704
    v_mfma_f32_16x16x32_bf16 v[68:71], a[160:163], v[132:135], v[68:71]
    ds_read_b64_tr_b16 v[164:165], v173 offset:128
    v_mfma_f32_16x16x32_bf16 v[72:75], a[164:167], v[132:135], v[72:75]
    s_waitcnt lgkmcnt(5)
    ds_read_b64_tr_b16 v[166:167], v175 offset:128
    v_pk_max_u16 v184, v184, s37
    v_mfma_f32_16x16x32_bf16 v[64:67], a[168:171], v[136:139], v[64:67]
    ds_read_b128 v[140:143], v45 offset:0
    v_pk_max_u16 v184, v184, v186
    v_mfma_f32_16x16x32_bf16 v[68:71], a[172:175], v[136:139], v[68:71]
    ds_read_b128 v[112:115], v45 offset:64
    v_cmp_ne_u32 s[82:83], s37, v184
    v_mfma_f32_16x16x32_bf16 v[72:75], a[176:179], v[136:139], v[72:75]
    v_xor_b32 v40, v52, v4
    v_xor_b32 v41, v53, v4
    v_mfma_f32_16x16x32_bf16 v[144:147], v[144:147], v[168:171], 0
    ds_read_b128 v[116:119], v45 offset:128
    v_xor_b32 v42, v54, v4
    v_mfma_f32_16x16x32_bf16 v[148:151], v[148:151], v[168:171], 0
    s_or_b64 vcc, s[80:81], s[82:83]
    s_cbranch_scc1 L_afailY
L_afailY_back:
    v_mfma_f32_16x16x32_bf16 v[152:155], v[152:155], v[168:171], 0
    s_waitcnt lgkmcnt(3)
    v_xor_b32 v43, v55, v4
    v_cvt_pk_bf16_f32 v144, v144, v145
    v_mfma_f32_16x16x32_bf16 v[156:159], v[156:159], v[168:171], 0
    ds_read_b128 v[120:123], v46 offset:0
    v_cvt_pk_bf16_f32 v145, v146, v147
    v_mfma_f32_16x16x32_bf16 v[160:163], v[160:163], v[168:171], 0
    ds_write_b64 v28, v[144:145] offset:36864
    v_mfma_f32_16x16x32_bf16 v[164:167], v[164:167], v[168:171], 0
    s_waitcnt lgkmcnt(3)
    v_cvt_pk_bf16_f32 v148, v148, v149
    v_cvt_pk_bf16_f32 v149, v150, v151
    v_mfma_f32_16x16x32_bf16 v[64:67], a[180:183], v[140:143], v[64:67]
    ds_read_b128 v[124:127], v46 offset:64
    v_cvt_pk_bf16_f32 v152, v152, v153
    v_mfma_f32_16x16x32_bf16 v[68:71], a[184:187], v[140:143], v[68:71]
    ds_write_b64 v29, v[148:149] offset:36864
    v_mfma_f32_16x16x32_bf16 v[72:75], a[188:191], v[140:143], v[72:75]
    v_cvt_pk_bf16_f32 v153, v154, v155
    v_cvt_pk_bf16_f32 v156, v156, v157
    v_mfma_f32_16x16x32_bf16 v[64:67], a[192:195], v[112:115], v[64:67]
    ds_read_b128 v[128:131], v46 offset:128
    v_cvt_pk_bf16_f32 v157, v158, v159
    v_mfma_f32_16x16x32_bf16 v[68:71], a[196:199], v[112:115], v[68:71]
    ds_write_b64 v28, v[152:153] offset:36928
    v_mfma_f32_16x16x32_bf16 v[72:75], a[200:203], v[112:115], v[72:75]
    s_waitcnt lgkmcnt(4)
    v_cvt_pk_bf16_f32 v160, v160, v161
    v_cvt_pk_bf16_f32 v161, v162, v163
    v_mfma_f32_16x16x32_bf16 v[64:67], a[204:207], v[116:119], v[64:67]
    ds_read_b128 v[132:135], v47 offset:0
    v_cvt_pk_bf16_f32 v164, v164, v165
    v_mfma_f32_16x16x32_bf16 v[68:71], a[208:211], v[116:119], v[68:71]
    ds_write_b64 v29, v[156:157] offset:36928
    v_mfma_f32_16x16x32_bf16 v[72:75], a[212:215], v[116:119], v[72:75]
    v_cvt_pk_bf16_f32 v165, v166, v167
    v_xor_b32 v44, v56, v4
    v_mfma_f32_16x16x32_bf16 v[64:67], a[216:219], v[120:123], v[64:67]
    ds_read_b128 v[136:139], v47 offset:64
    v_xor_b32 v45, v57, v4
    v_mfma_f32_16x16x32_bf16 v[68:71], a[220:223], v[120:123], v[68:71]
    ds_write_b64 v28, v[160:161] offset:36992
    v_mfma_f32_16x16x32_bf16 v[72:75], a[224:227], v[120:123], v[72:75]
    s_waitcnt lgkmcnt(4)
    v_xor_b32 v46, v58, v4
    v_cvt_pk_bf16_f32 v100, v100, v101
    v_mfma_f32_16x16x32_bf16 v[64:67], a[228:231], v[124:127], v[64:67]
    ds_read_b128 v[140:143], v47 offset:128
    v_xor_b32 v47, v59, v4
    v_mfma_f32_16x16x32_bf16 v[68:71], a[232:235], v[124:127], v[68:71]
    ds_write_b64 v29, v[164:165] offset:36992
    v_mfma_f32_16x16x32_bf16 v[72:75], a[236:239], v[124:127], v[72:75]
    v_cvt_pk_bf16_f32 v101, v102, v103
    v_cvt_pk_bf16_f32 v102, v104, v105
    v_mfma_f32_16x16x32_bf16 v[64:67], a[240:243], v[128:131], v[64:67]
    ds_read_b128 v[112:115], v48 offset:0
    v_cvt_pk_bf16_f32 v103, v106, v107
    v_mfma_f32_16x16x32_bf16 v[68:71], a[244:247], v[128:131], v[68:71]
    v_permlane16_swap_b32 v100, v102
    v_mfma_f32_16x16x32_bf16 v[72:75], a[248:251], v[128:131], v[72:75]
    s_waitcnt lgkmcnt(3)
    v_permlane16_swap_b32 v101, v103
    v_mfma_f32_16x16x32_bf16 v[64:67], a[252:255], v[132:135], v[64:67]
    ds_read_b128 v[116:119], v48 offset:64
    v_mfma_f32_16x16x32_bf16 v[68:71], v[188:191], v[132:135], v[68:71]
    buffer_store_dwordx4 v[100:103], v21, s[20:23], s74 offen sc1
    v_mfma_f32_16x16x32_bf16 v[72:75], v[192:195], v[132:135], v[72:75]
    v_mfma_f32_16x16x32_bf16 v[64:67], v[196:199], v[136:139], v[64:67]
    ds_read_b128 v[120:123], v48 offset:128
    v_xor_b32 v48, v60, v4
    v_mfma_f32_16x16x32_bf16 v[68:71], v[200:203], v[136:139], v[68:71]
    v_mfma_f32_16x16x32_bf16 v[72:75], v[204:207], v[136:139], v[72:75]
    s_waitcnt lgkmcnt(2)
    s_barrier
    v_mfma_f32_16x16x32_bf16 v[64:67], v[208:211], v[140:143], v[64:67]
    ds_read_b128 v[124:127], v40 offset:0
    v_mfma_f32_16x16x32_bf16 v[68:71], v[212:215], v[140:143], v[68:71]
    ds_read_b32 v35, v34
    v_mfma_f32_16x16x32_bf16 v[72:75], v[216:219], v[140:143], v[72:75]
    ds_read_b64 v[6:7], v39 offset:49152
    v_mfma_f32_16x16x32_bf16 v[64:67], v[220:223], v[112:115], v[64:67]
    ds_read_b128 v[128:131], v40 offset:64
    v_mfma_f32_16x16x32_bf16 v[68:71], v[224:227], v[112:115], v[68:71]
    ds_read_b64 v[12:13], v39 offset:55296
    v_mfma_f32_16x16x32_bf16 v[72:75], v[228:231], v[112:115], v[72:75]
    s_waitcnt lgkmcnt(5)
    v_mfma_f32_16x16x32_bf16 v[64:67], v[232:235], v[116:119], v[64:67]
    ds_read_b128 v[132:135], v40 offset:128
    v_mfma_f32_16x16x32_bf16 v[68:71], v[236:239], v[116:119], v[68:71]
    v_mfma_f32_16x16x32_bf16 v[72:75], v[240:243], v[116:119], v[72:75]
    s_waitcnt lgkmcnt(3)
    v_readfirstlane_b32 s63, v35
    v_mfma_f32_16x16x32_bf16 v[64:67], v[244:247], v[120:123], v[64:67]
    ds_read_b128 v[136:139], v41 offset:0
    v_mfma_f32_16x16x32_bf16 v[68:71], v[248:251], v[120:123], v[68:71]
    buffer_store_dwordx2 v[6:7], v20, s[20:23], s56 offen sc1
    v_mfma_f32_16x16x32_bf16 v[72:75], v[252:255], v[120:123], v[72:75]
    s_waitcnt lgkmcnt(2)
    v_mfma_f32_16x16x32_bf16 v[76:79], a[0:3], v[124:127], 0
    ds_read_b128 v[140:143], v41 offset:64
    v_mfma_f32_16x16x32_bf16 v[80:83], a[4:7], v[124:127], 0
    v_cvt_pk_bf16_f32 v64, v64, v65
    v_cvt_pk_bf16_f32 v65, v66, v67
    v_mfma_f32_16x16x32_bf16 v[84:87], a[8:11], v[124:127], 0
    buffer_store_dwordx2 v[12:13], v22, s[20:23], s74 offen sc1
    v_cvt_pk_bf16_f32 v66, v68, v69
    v_mfma_f32_16x16x32_bf16 v[76:79], a[12:15], v[128:131], v[76:79]
    ds_read_b128 v[112:115], v41 offset:128
    v_cvt_pk_bf16_f32 v67, v70, v71
    v_mfma_f32_16x16x32_bf16 v[80:83], a[16:19], v[128:131], v[80:83]
    v_permlane16_swap_b32 v64, v66
    v_mfma_f32_16x16x32_bf16 v[84:87], a[20:23], v[128:131], v[84:87]
    s_waitcnt lgkmcnt(2)
    v_permlane16_swap_b32 v65, v67
    v_mfma_f32_16x16x32_bf16 v[76:79], a[24:27], v[132:135], v[76:79]
    ds_read_b128 v[116:119], v42 offset:0
    v_cvt_pk_bf16_f32 v72, v72, v73
    v_mfma_f32_16x16x32_bf16 v[80:83], a[28:31], v[132:135], v[80:83]
    ds_read_b64 v[8:9], v39 offset:51200
    v_cvt_pk_bf16_f32 v73, v74, v75
    v_mfma_f32_16x16x32_bf16 v[84:87], a[32:35], v[132:135], v[84:87]
    ds_write_b64 v38, v[72:73] offset:57344
    v_mfma_f32_16x16x32_bf16 v[76:79], a[36:39], v[136:139], v[76:79]
    ds_read_b128 v[120:123], v42 offset:64
    v_mfma_f32_16x16x32_bf16 v[80:83], a[40:43], v[136:139], v[80:83]
    buffer_store_dwordx4 v[64:67], v21, s[20:23], s75 offen sc1
    v_mfma_f32_16x16x32_bf16 v[84:87], a[44:47], v[136:139], v[84:87]
    s_waitcnt lgkmcnt(4)
    v_mfma_f32_16x16x32_bf16 v[76:79], a[48:51], v[140:143], v[76:79]
    ds_read_b128 v[124:127], v42 offset:128
    v_mfma_f32_16x16x32_bf16 v[80:83], a[52:55], v[140:143], v[80:83]
    v_mfma_f32_16x16x32_bf16 v[84:87], a[56:59], v[140:143], v[84:87]
    s_waitcnt lgkmcnt(2)
    v_mfma_f32_16x16x32_bf16 v[76:79], a[60:63], v[112:115], v[76:79]
    ds_read_b128 v[128:131], v43 offset:0
    v_mfma_f32_16x16x32_bf16 v[80:83], a[64:67], v[112:115], v[80:83]
    buffer_store_dwordx2 v[8:9], v20, s[20:23], s4 offen sc1
    v_mfma_f32_16x16x32_bf16 v[84:87], a[68:71], v[112:115], v[84:87]
    v_mfma_f32_16x16x32_bf16 v[76:79], a[72:75], v[116:119], v[76:79]
    ds_read_b128 v[132:135], v43 offset:64
    v_mfma_f32_16x16x32_bf16 v[80:83], a[76:79], v[116:119], v[80:83]
    v_mfma_f32_16x16x32_bf16 v[84:87], a[80:83], v[116:119], v[84:87]
    s_waitcnt lgkmcnt(2)
    v_mfma_f32_16x16x32_bf16 v[76:79], a[84:87], v[120:123], v[76:79]
    ds_read_b128 v[136:139], v43 offset:128
    v_mfma_f32_16x16x32_bf16 v[80:83], a[88:91], v[120:123], v[80:83]
    v_mfma_f32_16x16x32_bf16 v[84:87], a[92:95], v[120:123], v[84:87]
    v_mfma_f32_16x16x32_bf16 v[76:79], a[96:99], v[124:127], v[76:79]
    ds_read_b128 v[140:143], v44 offset:0
    v_mfma_f32_16x16x32_bf16 v[80:83], a[100:103], v[124:127], v[80:83]
    ds_read_b64 v[10:11], v39 offset:53248
    v_mfma_f32_16x16x32_bf16 v[84:87], a[104:107], v[124:127], v[84:87]
    s_waitcnt lgkmcnt(3)
    v_mfma_f32_16x16x32_bf16 v[76:79], a[108:111], v[128:131], v[76:79]
    ds_read_b128 v[112:115], v44 offset:64
    v_mfma_f32_16x16x32_bf16 v[80:83], a[112:115], v[128:131], v[80:83]
    v_mfma_f32_16x16x32_bf16 v[84:87], a[116:119], v[128:131], v[84:87]
    v_mfma_f32_16x16x32_bf16 v[76:79], a[120:123], v[132:135], v[76:79]
    ds_read_b128 v[116:119], v44 offset:128
    v_mfma_f32_16x16x32_bf16 v[80:83], a[124:127], v[132:135], v[80:83]
    v_mfma_f32_16x16x32_bf16 v[84:87], a[128:131], v[132:135], v[84:87]
    s_waitcnt lgkmcnt(2)
    v_mfma_f32_16x16x32_bf16 v[76:79], a[132:135], v[136:139], v[76:79]
    ds_read_b128 v[120:123], v45 offset:0
    v_mfma_f32_16x16x32_bf16 v[80:83], a[136:139], v[136:139], v[80:83]
    buffer_store_dwordx2 v[10:11], v20, s[20:23], s5 offen sc1
    v_mfma_f32_16x16x32_bf16 v[84:87], a[140:143], v[136:139], v[84:87]
    v_mfma_f32_16x16x32_bf16 v[76:79], a[144:147], v[140:143], v[76:79]
    ds_read_b128 v[124:127], v45 offset:64
    v_mfma_f32_16x16x32_bf16 v[80:83], a[148:151], v[140:143], v[80:83]
    v_mfma_f32_16x16x32_bf16 v[84:87], a[152:155], v[140:143], v[84:87]
    s_waitcnt lgkmcnt(2)
    v_mfma_f32_16x16x32_bf16 v[76:79], a[156:159], v[112:115], v[76:79]
    ds_read_b128 v[128:131], v45 offset:128
    v_mfma_f32_16x16x32_bf16 v[80:83], a[160:163], v[112:115], v[80:83]
    v_mfma_f32_16x16x32_bf16 v[84:87], a[164:167], v[112:115], v[84:87]
    v_mfma_f32_16x16x32_bf16 v[76:79], a[168:171], v[116:119], v[76:79]
    ds_read_b128 v[132:135], v46 offset:0
    v_mfma_f32_16x16x32_bf16 v[80:83], a[172:175], v[116:119], v[80:83]
    v_mfma_f32_16x16x32_bf16 v[84:87], a[176:179], v[116:119], v[84:87]
    s_waitcnt lgkmcnt(2)
    v_mfma_f32_16x16x32_bf16 v[76:79], a[180:183], v[120:123], v[76:79]
    ds_read_b128 v[136:139], v46 offset:64
    v_mfma_f32_16x16x32_bf16 v[80:83], a[184:187], v[120:123], v[80:83]
    v_mfma_f32_16x16x32_bf16 v[84:87], a[188:191], v[120:123], v[84:87]
    v_mfma_f32_16x16x32_bf16 v[76:79], a[192:195], v[124:127], v[76:79]
    ds_read_b128 v[140:143], v46 offset:128
    v_mfma_f32_16x16x32_bf16 v[80:83], a[196:199], v[124:127], v[80:83]
    v_mfma_f32_16x16x32_bf16 v[84:87], a[200:203], v[124:127], v[84:87]
    s_waitcnt lgkmcnt(2)
    v_mfma_f32_16x16x32_bf16 v[76:79], a[204:207], v[128:131], v[76:79]
    ds_read_b128 v[112:115], v47 offset:0
    v_mfma_f32_16x16x32_bf16 v[80:83], a[208:211], v[128:131], v[80:83]
    ds_read_b128 v[116:119], v47 offset:64
    v_mfma_f32_16x16x32_bf16 v[84:87], a[212:215], v[128:131], v[84:87]
    ds_read_b128 v[120:123], v47 offset:128
    v_mfma_f32_16x16x32_bf16 v[76:79], a[216:219], v[132:135], v[76:79]
    ds_read_b128 v[124:127], v48 offset:0
    v_mfma_f32_16x16x32_bf16 v[80:83], a[220:223], v[132:135], v[80:83]
    ds_read_b128 v[128:131], v48 offset:64
    v_mfma_f32_16x16x32_bf16 v[84:87], a[224:227], v[132:135], v[84:87]
    s_waitcnt lgkmcnt(5)
    ds_read_b128 v[132:135], v48 offset:128
    v_mfma_f32_16x16x32_bf16 v[76:79], a[228:231], v[136:139], v[76:79]
    v_mfma_f32_16x16x32_bf16 v[80:83], a[232:235], v[136:139], v[80:83]
    v_mfma_f32_16x16x32_bf16 v[84:87], a[236:239], v[136:139], v[84:87]
    v_mfma_f32_16x16x32_bf16 v[76:79], a[240:243], v[140:143], v[76:79]
    v_mfma_f32_16x16x32_bf16 v[80:83], a[244:247], v[140:143], v[80:83]
    v_mfma_f32_16x16x32_bf16 v[84:87], a[248:251], v[140:143], v[84:87]
    s_waitcnt lgkmcnt(0)
    v_mfma_f32_16x16x32_bf16 v[84:87], v[192:195], v[112:115], v[84:87]
    v_mfma_f32_16x16x32_bf16 v[84:87], v[204:207], v[116:119], v[84:87]
    v_mfma_f32_16x16x32_bf16 v[84:87], v[216:219], v[120:123], v[84:87]
    v_mfma_f32_16x16x32_bf16 v[84:87], v[228:231], v[124:127], v[84:87]
    v_mfma_f32_16x16x32_bf16 v[84:87], v[240:243], v[128:131], v[84:87]
    v_mfma_f32_16x16x32_bf16 v[84:87], v[252:255], v[132:135], v[84:87]
    s_nop 2
    v_mfma_f32_16x16x32_bf16 v[76:79], a[252:255], v[112:115], v[76:79]
    s_nop 2
    v_mfma_f32_16x16x32_bf16 v[76:79], v[196:199], v[116:119], v[76:79]
    v_cvt_pk_bf16_f32 v84, v84, v85
    v_cvt_pk_bf16_f32 v85, v86, v87
    v_mfma_f32_16x16x32_bf16 v[76:79], v[208:211], v[120:123], v[76:79]
    ds_write_b64 v38, v[84:85] offset:59392
    v_mfma_f32_16x16x32_bf16 v[76:79], v[220:223], v[124:127], v[76:79]
    v_mfma_f32_16x16x32_bf16 v[76:79], v[232:235], v[128:131], v[76:79]
    v_mfma_f32_16x16x32_bf16 v[76:79], v[244:247], v[132:135], v[76:79]
    v_mfma_f32_16x16x32_bf16 v[80:83], v[188:191], v[112:115], v[80:83]
    s_waitcnt lgkmcnt(0)
    s_barrier
    v_mfma_f32_16x16x32_bf16 v[80:83], v[200:203], v[116:119], v[80:83]
    ds_read_b64 v[14:15], v39 offset:57344
    v_mfma_f32_16x16x32_bf16 v[80:83], v[212:215], v[120:123], v[80:83]
    ds_read_b64 v[62:63], v39 offset:59392
    v_mfma_f32_16x16x32_bf16 v[80:83], v[224:227], v[124:127], v[80:83]
    v_mfma_f32_16x16x32_bf16 v[80:83], v[236:239], v[128:131], v[80:83]
    v_cvt_pk_bf16_f32 v76, v76, v77
    v_cvt_pk_bf16_f32 v77, v78, v79
    v_mfma_f32_16x16x32_bf16 v[80:83], v[248:251], v[132:135], v[80:83]
    s_waitcnt lgkmcnt(0)
    buffer_store_dwordx2 v[14:15], v22, s[20:23], s75 offen sc1
    buffer_store_dwordx2 v[62:63], v22, s[20:23], s76 offen sc1
    s_nop 4
    v_cvt_pk_bf16_f32 v78, v80, v81
    v_cvt_pk_bf16_f32 v79, v82, v83
    s_nop 0
    v_permlane16_swap_b32 v76, v78
    v_permlane16_swap_b32 v77, v79
    buffer_store_dwordx4 v[76:79], v21, s[20:23], s76 offen sc1
    s_cmp_lg_u32 s63, 0
    s_cbranch_scc1 L_slow
    s_endpgm
L_y_end:
.p2align 6
L_x:
    v_and_b32 v2, 15, v0
    v_lshrrev_b32 v3, 4, v1
    s_movk_i32 s42, 192
    v_mov_b32 v34, 158976
    v_mov_b32 v147, 0
    ds_write_b32 v34, v147
    v_bfe_u32 v144, v1, 2, 2
    v_lshl_add_u32 v144, v3, 3, v144
    v_lshrrev_b32 v145, 2, v1
    v_mul_u32_u24 v144, 192, v144
    v_bfi_b32 v145, 3, v1, v145
    s_lshl_b32 s40, s2, 5
    v_and_b32 v145, 7, v145
    v_lshl_add_u32 v144, v145, 3, v144
    v_xad_u32 v15, v144, s40, 64
    v_lshl_add_u32 v13, s2, 7, v144
    s_mul_i32 s40, s57, 10368
    v_xor_b32 v14, 32, v13
    s_add_u32 s40, s40, 61440
    s_cmp_eq_u32 s80, 10
    s_cselect_b32 s41, 16, 17
    v_add_u32 v144, 2, v2
    v_add_u32 v147, s40, v4
    v_min_u32 v144, s41, v144
    v_lshl_add_u32 v144, v144, 3, 0
    v_bitop3_b32 v145, v144, 32, v147 bitop3:0x6a
    v_mad_u32_u24 v18, v144, 24, v145
    v_lshl_add_u32 v144, v2, 3, 8
    v_bitop3_b32 v145, v144, 32, v147 bitop3:0x6a
    v_mad_u32_u24 v17, v144, 24, v145
    v_lshl_add_u32 v144, v2, 3, 0
    v_bitop3_b32 v145, v144, 32, v147 bitop3:0x6a
    v_mad_u32_u24 v16, v144, 24, v145
    s_mov_b64 exec, 0
    s_cmp_eq_u32 s3, 0
    s_cbranch_scc1 L_pgX0
    s_cmp_eq_u32 s3, 1
    s_cbranch_scc1 L_pgX1
    s_cmp_eq_u32 s3, 2
    s_cbranch_scc1 L_pgX2
L_retX:
L_pgX2:
    s_mov_b64 exec, -1
    s_add_u32 m0, s25, 6912
    s_add_u32 s31, s44, 86016
    buffer_load_dwordx4 v8, s[8:11], s31 offen  lds
    s_add_u32 m0, s25, 17280
    s_add_u32 s31, s44, 215040
    buffer_load_dwordx4 v8, s[8:11], s31 offen  lds
    s_waitcnt vmcnt(9)
    s_barrier
    s_mul_i32 s31, s57, 3456
    s_add_u32 s31, s31, s24
    s_add_u32 m0, s31, 127488
    s_add_u32 s31, s28, 55296
    buffer_load_dwordx4 v5, s[16:19], s31 offen lds
    ds_read_b64_tr_b16 a[0:1], v13 offset:24576
    buffer_load_dwordx4 v6, s[16:19], s31 offen offset:1024 lds
    ds_read_b64_tr_b16 a[2:3], v13 offset:25344
    buffer_load_dwordx4 v7, s[16:19], s31 offen offset:2048 lds
    ds_read_b64_tr_b16 a[4:5], v14 offset:24576
    s_add_u32 m0, s25, 20736
    s_add_u32 s31, s44, 258048
    buffer_load_dwordx4 v8, s[8:11], s31 offen  lds
    ds_read_b64_tr_b16 a[6:7], v14 offset:25344
    s_add_u32 m0, s25, 24192
    s_add_u32 s31, s44, 301056
    buffer_load_dwordx4 v8, s[8:11], s31 offen  lds
    ds_read_b64_tr_b16 a[8:9], v15 offset:24576
    s_add_u32 m0, s24, 49152
    s_add_u32 s31, s28, 61440
    buffer_load_dwordx4 v5, s[16:19], s31 offen lds
    ds_read_b64_tr_b16 a[10:11], v15 offset:25344
    buffer_load_dwordx4 v6, s[16:19], s31 offen offset:1024 lds
    ds_read_b64_tr_b16 a[12:13], v13 offset:30720
    buffer_load_dwordx4 v7, s[16:19], s31 offen offset:2048 lds
    ds_read_b64_tr_b16 a[14:15], v13 offset:31488
    ds_read_b64_tr_b16 a[16:17], v14 offset:30720
    ds_read_b64_tr_b16 a[18:19], v14 offset:31488
    ds_read_b64_tr_b16 a[20:21], v15 offset:30720
    ds_read_b64_tr_b16 a[22:23], v15 offset:31488
    s_waitcnt lgkmcnt(0)
    s_waitcnt vmcnt(10)
    s_barrier
    ds_read_b128 v[112:115], v16 offset:0
    ds_read_b128 v[116:119], v16 offset:3456
    ds_read_b128 v[120:123], v16 offset:64
    ds_read_b128 v[124:127], v16 offset:3520
    s_waitcnt lgkmcnt(3)
    v_mfma_f32_16x16x32_bf16 v[64:67], a[0:3], v[112:115], 0
    s_add_u32 m0, s24, 0
    ds_read_b64_tr_b16 a[24:25], v13 offset:36864
    s_add_u32 s31, s28, 67584
    ds_read_b64_tr_b16 a[26:27], v13 offset:37632
    v_mfma_f32_16x16x32_bf16 v[68:71], a[4:7], v[112:115], 0
    s_mul_i32 s40, s57, 6912
    ds_read_b64_tr_b16 a[28:29], v14 offset:36864
    buffer_load_dwordx4 v5, s[16:19], s31 offen lds
    v_mfma_f32_16x16x32_bf16 v[72:75], a[8:11], v[112:115], 0
    s_waitcnt lgkmcnt(5)
    ds_read_b64_tr_b16 a[30:31], v14 offset:37632
    v_add_u32 v61, 127488, v13
    v_mfma_f32_16x16x32_bf16 v[76:79], a[0:3], v[116:119], 0
    s_mul_i32 s41, s57, 43008
    ds_read_b64_tr_b16 a[32:33], v15 offset:36864
    v_add_u32 v62, 127488, v14
    v_mfma_f32_16x16x32_bf16 v[80:83], a[4:7], v[116:119], 0
    s_add_u32 s41, s44, s41
    ds_read_b64_tr_b16 a[34:35], v15 offset:37632
    v_add_u32 v63, 127488, v15
    v_mfma_f32_16x16x32_bf16 v[84:87], a[8:11], v[116:119], 0
    s_waitcnt lgkmcnt(6)
    ds_read_b128 v[128:131], v16 offset:128
    buffer_load_dwordx4 v6, s[16:19], s31 offen offset:1024 lds
    v_mfma_f32_16x16x32_bf16 v[64:67], a[12:15], v[120:123], v[64:67]
    s_add_u32 s74, s41, 301248
    ds_read_b64_tr_b16 a[36:37], v13 offset:43008
    v_subrev_u32 v40, s40, v16
    v_mfma_f32_16x16x32_bf16 v[68:71], a[16:19], v[120:123], v[68:71]
    s_add_u32 s75, s41, 387264
    ds_read_b64_tr_b16 a[38:39], v13 offset:43776
    v_subrev_u32 v41, s40, v17
    v_mfma_f32_16x16x32_bf16 v[72:75], a[20:23], v[120:123], v[72:75]
    s_add_u32 s76, s41, 473280
    ds_read_b64_tr_b16 a[40:41], v14 offset:43008
    v_subrev_u32 v42, s40, v18
    v_mfma_f32_16x16x32_bf16 v[76:79], a[12:15], v[124:127], v[76:79]
    s_add_u32 s77, s41, 559296
    ds_read_b128 v[132:135], v16 offset:3584
    buffer_load_dwordx4 v7, s[16:19], s31 offen offset:2048 lds
    v_mfma_f32_16x16x32_bf16 v[80:83], a[16:19], v[124:127], v[80:83]
    s_add_u32 m0, s24, 12288
    ds_read_b64_tr_b16 a[42:43], v14 offset:43776
    v_mul_u32_u24 v30, 1821, v0
    v_mfma_f32_16x16x32_bf16 v[84:87], a[20:23], v[124:127], v[84:87]
    s_waitcnt lgkmcnt(5)
    ds_read_b64_tr_b16 a[44:45], v15 offset:43008
    v_lshlrev_b32 v31, 4, v0
    v_mfma_f32_16x16x32_bf16 v[64:67], a[24:27], v[128:131], v[64:67]
    s_add_u32 s31, s28, 73728
    ds_read_b64_tr_b16 a[46:47], v15 offset:43776
    v_lshrrev_b32 v52, 1, v4
    v_mfma_f32_16x16x32_bf16 v[68:71], a[28:31], v[128:131], v[68:71]
    s_mov_b32 s37, 0x3e803e80
    ds_read_b128 v[136:139], v17 offset:0
    buffer_load_dwordx4 v5, s[16:19], s31 offen lds
    v_mfma_f32_16x16x32_bf16 v[72:75], a[32:35], v[128:131], v[72:75]
    s_waitcnt lgkmcnt(4)
    ds_read_b128 v[140:143], v17 offset:3456
    v_lshl_or_b32 v21, v4, 1, v52
    v_mfma_f32_16x16x32_bf16 v[76:79], a[24:27], v[132:135], v[76:79]
    s_cmp_ge_u32 s45, 47040
    s_cselect_b32 s43, 43008, 0
    v_and_b32 v21, 48, v21
    v_mfma_f32_16x16x32_bf16 v[80:83], a[28:31], v[132:135], v[80:83]
    s_sub_u32 s53, s44, s43
    v_lshl_add_u32 v21, s2, 7, v21
    v_mad_u32_u24 v19, v2, s42, v21
    v_mfma_f32_16x16x32_bf16 v[84:87], a[32:35], v[132:135], v[84:87]
    s_waitcnt vmcnt(12) lgkmcnt(1)
    s_barrier
    v_mfma_f32_16x16x32_bf16 v[64:67], a[36:39], v[136:139], v[64:67]
    s_mov_b32 s96, 0x7fff7fff
    ds_read_b128 v[112:115], v16 offset:6912
    buffer_load_dwordx4 v6, s[16:19], s31 offen offset:1024 lds
    v_mfma_f32_16x16x32_bf16 v[68:71], a[40:43], v[136:139], v[68:71]
    s_mov_b32 s60, 0x435f435f
    ds_read_b128 v[116:119], v16 offset:6976
    s_mul_i32 s56, s46, 36
    ds_read_b128 v[120:123], v16 offset:7040
    v_mfma_f32_16x16x32_bf16 v[72:75], a[44:47], v[136:139], v[72:75]
    s_waitcnt lgkmcnt(3)
    v_lshl_add_u32 v53, s2, 2, v3
    v_lshrrev_b32 v52, 1, v2
    v_mfma_f32_16x16x32_bf16 v[76:79], a[36:39], v[140:143], v[76:79]
    s_movk_i32 s5, 7488
    ds_read_b128 v[124:127], v17 offset:6912
    v_mad_u32_u16 v30, v30, s5, v31 op_sel:[1,0,0,0]
    v_mfma_f32_16x16x32_bf16 v[80:83], a[40:43], v[140:143], v[80:83]
    buffer_load_dwordx4 v7, s[16:19], s31 offen offset:2048 lds
    v_mfma_f32_16x16x32_bf16 v[84:87], a[44:47], v[140:143], v[84:87]
    s_waitcnt lgkmcnt(3)
    v_bitop3_b32 v52, v52, 6, v53 bitop3:0x6a
    v_lshl_add_u32 v52, v2, 3, v52
    v_mfma_f32_16x16x32_bf16 v[88:91], a[0:3], v[112:115], 0
    s_add_u32 m0, s24, 24576
    ds_read_b128 v[128:131], v16 offset:3456
    v_mad_u32_u24 v21, v2, s42, v21
    v_mfma_f32_16x16x32_bf16 v[92:95], a[4:7], v[112:115], 0
    s_add_u32 s31, s28, 24576
    v_lshlrev_b32 v39, 3, v0
    v_lshrrev_b32 v22, 1, v0
    v_mfma_f32_16x16x32_bf16 v[96:99], a[8:11], v[112:115], 0
    s_waitcnt lgkmcnt(2)
    buffer_load_dwordx4 v5, s[16:19], s31 offen lds
    v_mfma_f32_16x16x32_bf16 v[88:91], a[12:15], v[116:119], v[88:91]
    s_addk_i32 s56, 215
    ds_read_b128 v[132:135], v16 offset:6912
    v_sub_u32 v32, s56, v0
    v_mfma_f32_16x16x32_bf16 v[92:95], a[16:19], v[116:119], v[92:95]
    s_mov_b32 s5, 56448
    v_add_u32 v31, -252, v32
    v_and_b32 v31, 2.0, v31
    v_mfma_f32_16x16x32_bf16 v[96:99], a[20:23], v[116:119], v[96:99]
    s_waitcnt vmcnt(11) lgkmcnt(2)
    s_barrier
    v_mfma_f32_16x16x32_bf16 v[88:91], a[24:27], v[120:123], v[88:91]
    s_mul_i32 s55, s45, 36
    ds_read_b64_tr_b16 a[108:109], v61 offset:0
    buffer_load_dwordx4 v6, s[16:19], s31 offen offset:1024 lds
    ds_read_b64_tr_b16 a[110:111], v61 offset:768
    ds_read_b64_tr_b16 a[112:113], v62 offset:0
    ds_read_b64_tr_b16 a[114:115], v62 offset:768
    ds_read_b64_tr_b16 a[116:117], v63 offset:0
    ds_read_b64_tr_b16 a[118:119], v63 offset:768
    v_mfma_f32_16x16x32_bf16 v[92:95], a[28:31], v[120:123], v[92:95]
    s_lshl_b32 s4, s57, 10
    ds_read_b64_tr_b16 a[216:217], v61 offset:9600
    s_add_u32 s56, s44, 43200
    ds_read_b64_tr_b16 a[218:219], v61 offset:10368
    v_mfma_f32_16x16x32_bf16 v[96:99], a[32:35], v[120:123], v[96:99]
    ds_read_b64_tr_b16 a[220:221], v62 offset:9600
    v_add3_u32 v31, v30, v31, s5
    v_mfma_f32_16x16x32_bf16 v[88:91], a[36:39], v[124:127], v[88:91]
    ds_read_b128 v[136:139], v16 offset:10368
    v_and_or_b32 v30, v32, 2.0, v30
    v_mfma_f32_16x16x32_bf16 v[92:95], a[40:43], v[124:127], v[92:95]
    ds_read_b64_tr_b16 a[222:223], v62 offset:10368
    buffer_load_dwordx4 v7, s[16:19], s31 offen offset:2048 lds
    v_mfma_f32_16x16x32_bf16 v[96:99], a[44:47], v[124:127], v[96:99]
    s_waitcnt lgkmcnt(5)
    ds_read_b64_tr_b16 a[224:225], v63 offset:9600
    v_lshl_add_u32 v38, v52, 3, s4
    v_mfma_f32_16x16x32_bf16 v[64:67], a[108:111], v[128:131], v[64:67]
    s_add_u32 m0, s24, 36864
    ds_read_b64_tr_b16 a[226:227], v63 offset:10368
    v_bitop3_b32 v22, v22, 48, v39 bitop3:0x6a
    v_mfma_f32_16x16x32_bf16 v[68:71], a[112:115], v[128:131], v[68:71]
    s_add_u32 s31, s26, 135168
    v_bfe_u32 v37, v0, 3, 4
    v_and_or_b32 v22, v22, 56, 64
    v_mfma_f32_16x16x32_bf16 v[72:75], a[116:119], v[128:131], v[72:75]
    buffer_load_dwordx4 v5, s[16:19], s31 offen lds
    v_mfma_f32_16x16x32_bf16 v[76:79], a[108:111], v[132:135], v[76:79]
    s_mul_i32 s4, s57, 129024
    v_mad_u32_u24 v20, v37, s42, v22
    v_mad_u32_u24 v22, v37, s42, v22
    v_mfma_f32_16x16x32_bf16 v[80:83], a[112:115], v[132:135], v[80:83]
    s_add_u32 s56, s56, s4
    s_add_u32 s4, s56, 43008
    s_add_u32 s5, s56, 86016
    v_mfma_f32_16x16x32_bf16 v[84:87], a[116:119], v[132:135], v[84:87]
    s_waitcnt lgkmcnt(1)
    v_mfma_f32_16x16x32_bf16 v[88:91], a[108:111], v[136:139], v[88:91]
    buffer_load_dwordx4 v6, s[16:19], s31 offen offset:1024 lds
    v_mfma_f32_16x16x32_bf16 v[92:95], a[112:115], v[136:139], v[92:95]
    v_mfma_f32_16x16x32_bf16 v[96:99], a[116:119], v[136:139], v[96:99]
    s_waitcnt vmcnt(8) lgkmcnt(0)
    s_barrier
    v_mfma_f32_16x16x32_bf16 v[64:67], a[216:219], v[132:135], v[64:67]
    ds_read_b64_tr_b16 a[120:121], v13 offset:49152
    ds_read_b64_tr_b16 a[122:123], v13 offset:49920
    ds_read_b64_tr_b16 a[124:125], v14 offset:49152
    v_mfma_f32_16x16x32_bf16 v[68:71], a[220:223], v[132:135], v[68:71]
    ds_read_b128 v[140:143], v16 offset:13824
    buffer_load_dwordx4 v7, s[16:19], s31 offen offset:2048 lds
    ds_read_b64_tr_b16 a[126:127], v14 offset:49920
    v_mfma_f32_16x16x32_bf16 v[72:75], a[224:227], v[132:135], v[72:75]
L_pgX0:
  s_cbranch_execz L_retX
    s_mul_i32 s31, s57, 3456
    ds_read_b64_tr_b16 a[128:129], v15 offset:49152
    s_add_u32 s31, s31, s24
    ds_read_b64_tr_b16 a[130:131], v15 offset:49920
    v_mfma_f32_16x16x32_bf16 v[76:79], a[216:219], v[136:139], v[76:79]
    s_add_u32 m0, s31, 127488
    ds_read_b128 v[112:115], v16 offset:3520
    s_add_u32 s31, s28, 86016
    ds_read_b64_tr_b16 a[228:229], v13 offset:55296
    v_mfma_f32_16x16x32_bf16 v[80:83], a[220:223], v[136:139], v[80:83]
    ds_read_b64_tr_b16 a[230:231], v13 offset:56064
    ds_read_b64_tr_b16 a[232:233], v14 offset:55296
    v_mfma_f32_16x16x32_bf16 v[84:87], a[224:227], v[136:139], v[84:87]
    s_waitcnt lgkmcnt(7)
    ds_read_b128 v[116:119], v16 offset:6976
    buffer_load_dwordx4 v5, s[16:19], s31 offen lds
    v_mfma_f32_16x16x32_bf16 v[88:91], a[216:219], v[140:143], v[88:91]
    ds_read_b64_tr_b16 a[234:235], v14 offset:56064
    ds_read_b64_tr_b16 a[236:237], v15 offset:55296
    v_mfma_f32_16x16x32_bf16 v[92:95], a[220:223], v[140:143], v[92:95]
    ds_read_b64_tr_b16 a[238:239], v15 offset:56064
    v_mfma_f32_16x16x32_bf16 v[96:99], a[224:227], v[140:143], v[96:99]
    s_waitcnt lgkmcnt(7)
    ds_read_b128 v[120:123], v16 offset:10432
    v_mfma_f32_16x16x32_bf16 v[64:67], a[120:123], v[112:115], v[64:67]
    ds_read_b64_tr_b16 a[132:133], v13 offset:0
    buffer_load_dwordx4 v6, s[16:19], s31 offen offset:1024 lds
    v_mfma_f32_16x16x32_bf16 v[68:71], a[124:127], v[112:115], v[68:71]
    ds_read_b64_tr_b16 a[134:135], v13 offset:768
    v_mfma_f32_16x16x32_bf16 v[72:75], a[128:131], v[112:115], v[72:75]
    s_waitcnt lgkmcnt(6)
    ds_read_b64_tr_b16 a[136:137], v14 offset:0
    v_mfma_f32_16x16x32_bf16 v[76:79], a[120:123], v[116:119], v[76:79]
    ds_read_b64_tr_b16 a[138:139], v14 offset:768
    v_mfma_f32_16x16x32_bf16 v[80:83], a[124:127], v[116:119], v[80:83]
    ds_read_b64_tr_b16 a[140:141], v15 offset:0
    buffer_load_dwordx4 v7, s[16:19], s31 offen offset:2048 lds
    v_mfma_f32_16x16x32_bf16 v[84:87], a[128:131], v[116:119], v[84:87]
    s_waitcnt lgkmcnt(5)
    ds_read_b64_tr_b16 a[142:143], v15 offset:768
    s_add_u32 m0, s24, 49152
    v_mfma_f32_16x16x32_bf16 v[88:91], a[120:123], v[120:123], v[88:91]
    s_add_u32 s31, s28, 36864
    ds_read_b64_tr_b16 a[240:241], v13 offset:6144
    v_mfma_f32_16x16x32_bf16 v[92:95], a[124:127], v[120:123], v[92:95]
    ds_read_b64_tr_b16 a[242:243], v13 offset:6912
    v_mfma_f32_16x16x32_bf16 v[96:99], a[128:131], v[120:123], v[96:99]
    ds_read_b64_tr_b16 a[244:245], v14 offset:6144
    v_mfma_f32_16x16x32_bf16 v[64:67], a[228:231], v[116:119], v[64:67]
    ds_read_b128 v[124:127], v16 offset:13888
    v_mfma_f32_16x16x32_bf16 v[68:71], a[232:235], v[116:119], v[68:71]
    ds_read_b64_tr_b16 a[246:247], v14 offset:6912
    v_mfma_f32_16x16x32_bf16 v[72:75], a[236:239], v[116:119], v[72:75]
    ds_read_b64_tr_b16 a[248:249], v15 offset:6144
    v_mfma_f32_16x16x32_bf16 v[76:79], a[228:231], v[120:123], v[76:79]
    ds_read_b64_tr_b16 a[250:251], v15 offset:6912
    v_mfma_f32_16x16x32_bf16 v[80:83], a[232:235], v[120:123], v[80:83]
    ds_read_b128 v[128:131], v16 offset:3584
    v_mfma_f32_16x16x32_bf16 v[84:87], a[236:239], v[120:123], v[84:87]
    s_waitcnt lgkmcnt(4)
    ds_read_b128 v[132:135], v16 offset:7040
    v_mfma_f32_16x16x32_bf16 v[88:91], a[228:231], v[124:127], v[88:91]
    ds_read_b128 v[136:139], v16 offset:10496
    v_mfma_f32_16x16x32_bf16 v[92:95], a[232:235], v[124:127], v[92:95]
    v_mfma_f32_16x16x32_bf16 v[96:99], a[236:239], v[124:127], v[96:99]
    s_waitcnt vmcnt(6) lgkmcnt(2)
    s_barrier
    v_mfma_f32_16x16x32_bf16 v[64:67], a[132:135], v[128:131], v[64:67]
    ds_read_b64_tr_b16 a[144:145], v13 offset:12288
    buffer_load_dwordx4 v5, s[16:19], s31 offen lds
    v_mfma_f32_16x16x32_bf16 v[68:71], a[136:139], v[128:131], v[68:71]
    ds_read_b64_tr_b16 a[146:147], v13 offset:13056
    v_mfma_f32_16x16x32_bf16 v[72:75], a[140:143], v[128:131], v[72:75]
    s_waitcnt lgkmcnt(3)
    ds_read_b64_tr_b16 a[148:149], v14 offset:12288
    v_mfma_f32_16x16x32_bf16 v[76:79], a[132:135], v[132:135], v[76:79]
    ds_read_b128 v[140:143], v16 offset:13952
    v_mfma_f32_16x16x32_bf16 v[80:83], a[136:139], v[132:135], v[80:83]
    ds_read_b64_tr_b16 a[150:151], v14 offset:13056
    buffer_load_dwordx4 v6, s[16:19], s31 offen offset:1024 lds
    v_mfma_f32_16x16x32_bf16 v[84:87], a[140:143], v[132:135], v[84:87]
    s_waitcnt lgkmcnt(5)
    ds_read_b64_tr_b16 a[152:153], v15 offset:12288
    v_mfma_f32_16x16x32_bf16 v[88:91], a[132:135], v[136:139], v[88:91]
    ds_read_b64_tr_b16 a[154:155], v15 offset:13056
    v_mfma_f32_16x16x32_bf16 v[92:95], a[136:139], v[136:139], v[92:95]
    ds_read_b128 v[112:115], v17 offset:3456
    v_mfma_f32_16x16x32_bf16 v[96:99], a[140:143], v[136:139], v[96:99]
    ds_read_b64_tr_b16 a[252:253], v13 offset:18432
    buffer_load_dwordx4 v7, s[16:19], s31 offen offset:2048 lds
    v_mfma_f32_16x16x32_bf16 v[64:67], a[240:243], v[132:135], v[64:67]
    s_add_u32 m0, s24, 0
    ds_read_b64_tr_b16 a[254:255], v13 offset:19200
    s_add_u32 s31, s26, 147456
    v_mfma_f32_16x16x32_bf16 v[68:71], a[244:247], v[132:135], v[68:71]
    ds_read_b64_tr_b16 v[188:189], v14 offset:18432
    v_mfma_f32_16x16x32_bf16 v[72:75], a[248:251], v[132:135], v[72:75]
    ds_read_b128 v[116:119], v17 offset:6912
    v_mfma_f32_16x16x32_bf16 v[76:79], a[240:243], v[136:139], v[76:79]
    ds_read_b64_tr_b16 v[190:191], v14 offset:19200
    buffer_load_dwordx4 v5, s[16:19], s31 offen lds
    v_mfma_f32_16x16x32_bf16 v[80:83], a[244:247], v[136:139], v[80:83]
    ds_read_b64_tr_b16 v[192:193], v15 offset:18432
    v_mfma_f32_16x16x32_bf16 v[84:87], a[248:251], v[136:139], v[84:87]
    s_waitcnt lgkmcnt(5)
    ds_read_b64_tr_b16 v[194:195], v15 offset:19200
    v_mfma_f32_16x16x32_bf16 v[88:91], a[240:243], v[140:143], v[88:91]
    ds_read_b128 v[120:123], v17 offset:10368
    v_mfma_f32_16x16x32_bf16 v[92:95], a[244:247], v[140:143], v[92:95]
    buffer_load_dwordx4 v6, s[16:19], s31 offen offset:1024 lds
    v_mfma_f32_16x16x32_bf16 v[96:99], a[248:251], v[140:143], v[96:99]
    ds_read_b64_tr_b16 a[48:49], v13 offset:24576
    v_mfma_f32_16x16x32_bf16 v[64:67], a[144:147], v[112:115], v[64:67]
    ds_read_b64_tr_b16 a[50:51], v13 offset:25344
    v_mfma_f32_16x16x32_bf16 v[68:71], a[148:151], v[112:115], v[68:71]
    ds_read_b64_tr_b16 a[52:53], v14 offset:24576
    v_mfma_f32_16x16x32_bf16 v[72:75], a[152:155], v[112:115], v[72:75]
    s_waitcnt lgkmcnt(4)
    buffer_load_dwordx4 v7, s[16:19], s31 offen offset:2048 lds
    v_mfma_f32_16x16x32_bf16 v[76:79], a[144:147], v[116:119], v[76:79]
    s_add_u32 m0, s24, 12288
    ds_read_b64_tr_b16 a[54:55], v14 offset:25344
    s_add_u32 s31, s28, 98304
    v_mfma_f32_16x16x32_bf16 v[80:83], a[148:151], v[116:119], v[80:83]
    ds_read_b64_tr_b16 a[56:57], v15 offset:24576
    v_mfma_f32_16x16x32_bf16 v[84:87], a[152:155], v[116:119], v[84:87]
    s_waitcnt lgkmcnt(4)
    ds_read_b64_tr_b16 a[58:59], v15 offset:25344
    v_mfma_f32_16x16x32_bf16 v[88:91], a[144:147], v[120:123], v[88:91]
    ds_read_b64_tr_b16 a[156:157], v13 offset:30720
    v_mfma_f32_16x16x32_bf16 v[92:95], a[148:151], v[120:123], v[92:95]
    ds_read_b64_tr_b16 a[158:159], v13 offset:31488
    v_mfma_f32_16x16x32_bf16 v[96:99], a[152:155], v[120:123], v[96:99]
    ds_read_b64_tr_b16 a[160:161], v14 offset:30720
    v_mfma_f32_16x16x32_bf16 v[64:67], a[252:255], v[116:119], v[64:67]
    ds_read_b128 v[124:127], v17 offset:13824
    v_mfma_f32_16x16x32_bf16 v[68:71], v[188:191], v[116:119], v[68:71]
    ds_read_b64_tr_b16 a[162:163], v14 offset:31488
    v_mfma_f32_16x16x32_bf16 v[72:75], v[192:195], v[116:119], v[72:75]
    ds_read_b64_tr_b16 a[164:165], v15 offset:30720
    v_mfma_f32_16x16x32_bf16 v[76:79], a[252:255], v[120:123], v[76:79]
    ds_read_b64_tr_b16 a[166:167], v15 offset:31488
    v_mfma_f32_16x16x32_bf16 v[80:83], v[188:191], v[120:123], v[80:83]
    ds_read_b128 v[128:131], v17 offset:64
    v_mfma_f32_16x16x32_bf16 v[84:87], v[192:195], v[120:123], v[84:87]
    s_waitcnt lgkmcnt(4)
    ds_read_b128 v[132:135], v17 offset:3520
    v_mfma_f32_16x16x32_bf16 v[88:91], a[252:255], v[124:127], v[88:91]
    ds_read_b128 v[136:139], v17 offset:6976
    v_mfma_f32_16x16x32_bf16 v[92:95], v[188:191], v[124:127], v[92:95]
    v_mfma_f32_16x16x32_bf16 v[96:99], v[192:195], v[124:127], v[96:99]
    s_waitcnt vmcnt(6) lgkmcnt(2)
    s_barrier
    v_mfma_f32_16x16x32_bf16 v[64:67], a[48:51], v[128:131], v[64:67]
    buffer_load_dwordx4 v5, s[16:19], s31 offen lds
    v_mfma_f32_16x16x32_bf16 v[68:71], a[52:55], v[128:131], v[68:71]
    ds_read_b64_tr_b16 v[196:197], v13 offset:36864
    v_mfma_f32_16x16x32_bf16 v[72:75], a[56:59], v[128:131], v[72:75]
    s_waitcnt lgkmcnt(2)
    ds_read_b64_tr_b16 v[198:199], v13 offset:37632
    v_mfma_f32_16x16x32_bf16 v[76:79], a[48:51], v[132:135], v[76:79]
    ds_read_b64_tr_b16 v[200:201], v14 offset:36864
    v_mfma_f32_16x16x32_bf16 v[80:83], a[52:55], v[132:135], v[80:83]
    buffer_load_dwordx4 v6, s[16:19], s31 offen offset:1024 lds
    v_mfma_f32_16x16x32_bf16 v[84:87], a[56:59], v[132:135], v[84:87]
    s_waitcnt lgkmcnt(3)
    ds_read_b128 v[140:143], v17 offset:10432
    v_mfma_f32_16x16x32_bf16 v[88:91], a[48:51], v[136:139], v[88:91]
    ds_read_b64_tr_b16 v[202:203], v14 offset:37632
    v_mfma_f32_16x16x32_bf16 v[92:95], a[52:55], v[136:139], v[92:95]
    ds_read_b64_tr_b16 v[204:205], v15 offset:36864
    v_mfma_f32_16x16x32_bf16 v[96:99], a[56:59], v[136:139], v[96:99]
    ds_read_b64_tr_b16 v[206:207], v15 offset:37632
    buffer_load_dwordx4 v7, s[16:19], s31 offen offset:2048 lds
    v_mfma_f32_16x16x32_bf16 v[64:67], a[156:159], v[132:135], v[64:67]
    s_add_u32 m0, s24, 24576
    ds_read_b64_tr_b16 a[60:61], v13 offset:43008
    s_add_u32 s31, s28, 49152
    v_mfma_f32_16x16x32_bf16 v[68:71], a[160:163], v[132:135], v[68:71]
    ds_read_b64_tr_b16 a[62:63], v13 offset:43776
    v_mfma_f32_16x16x32_bf16 v[72:75], a[164:167], v[132:135], v[72:75]
    ds_read_b64_tr_b16 a[64:65], v14 offset:43008
    v_mfma_f32_16x16x32_bf16 v[76:79], a[156:159], v[136:139], v[76:79]
    buffer_load_dwordx4 v5, s[16:19], s31 offen lds
    v_mfma_f32_16x16x32_bf16 v[80:83], a[160:163], v[136:139], v[80:83]
    ds_read_b128 v[112:115], v17 offset:13888
    v_mfma_f32_16x16x32_bf16 v[84:87], a[164:167], v[136:139], v[84:87]
    s_waitcnt lgkmcnt(4)
    ds_read_b64_tr_b16 a[66:67], v14 offset:43776
    v_mfma_f32_16x16x32_bf16 v[88:91], a[156:159], v[140:143], v[88:91]
    ds_read_b64_tr_b16 a[68:69], v15 offset:43008
    v_mfma_f32_16x16x32_bf16 v[92:95], a[160:163], v[140:143], v[92:95]
    ds_read_b64_tr_b16 a[70:71], v15 offset:43776
    buffer_load_dwordx4 v6, s[16:19], s31 offen offset:1024 lds
    v_mfma_f32_16x16x32_bf16 v[96:99], a[164:167], v[140:143], v[96:99]
    ds_read_b128 v[116:119], v17 offset:128
    v_mfma_f32_16x16x32_bf16 v[64:67], v[196:199], v[136:139], v[64:67]
    ds_read_b128 v[120:123], v17 offset:3584
    v_mfma_f32_16x16x32_bf16 v[68:71], v[200:203], v[136:139], v[68:71]
    ds_read_b64_tr_b16 a[168:169], v61 offset:0
    v_mfma_f32_16x16x32_bf16 v[72:75], v[204:207], v[136:139], v[72:75]
    buffer_load_dwordx4 v7, s[16:19], s31 offen offset:2048 lds
    v_mfma_f32_16x16x32_bf16 v[76:79], v[196:199], v[140:143], v[76:79]
    s_lshl_b32 s31, s2, 5
    ds_read_b64_tr_b16 a[170:171], v61 offset:768
    v_xor_b32 v5, s31, v5
    v_mfma_f32_16x16x32_bf16 v[80:83], v[200:203], v[140:143], v[80:83]
    s_lshr_b32 s31, s24, 1
    ds_read_b64_tr_b16 a[172:173], v62 offset:0
    s_add_u32 m0, s31, 36864
    v_mfma_f32_16x16x32_bf16 v[84:87], v[204:207], v[140:143], v[84:87]
    s_waitcnt lgkmcnt(4)
    ds_read_b128 v[124:127], v17 offset:7040
    s_add_u32 s31, s31, 159744
    v_mfma_f32_16x16x32_bf16 v[88:91], v[196:199], v[112:115], v[88:91]
    ds_read_b64_tr_b16 a[174:175], v62 offset:768
    v_mfma_f32_16x16x32_bf16 v[92:95], v[200:203], v[112:115], v[92:95]
    ds_read_b64_tr_b16 a[176:177], v63 offset:0
    v_mfma_f32_16x16x32_bf16 v[96:99], v[204:207], v[112:115], v[96:99]
    ds_read_b64_tr_b16 a[178:179], v63 offset:768
    v_mfma_f32_16x16x32_bf16 v[64:67], a[60:63], v[116:119], v[64:67]
    ds_read_b64_tr_b16 v[208:209], v61 offset:9600
    v_mfma_f32_16x16x32_bf16 v[68:71], a[64:67], v[116:119], v[68:71]
    ds_read_b64_tr_b16 v[210:211], v61 offset:10368
    v_mfma_f32_16x16x32_bf16 v[72:75], a[68:71], v[116:119], v[72:75]
    s_waitcnt lgkmcnt(5)
    ds_read_b64_tr_b16 v[212:213], v62 offset:9600
    v_mfma_f32_16x16x32_bf16 v[76:79], a[60:63], v[120:123], v[76:79]
    ds_read_b128 v[128:131], v17 offset:10496
    v_mfma_f32_16x16x32_bf16 v[80:83], a[64:67], v[120:123], v[80:83]
    ds_read_b64_tr_b16 v[214:215], v62 offset:10368
    v_mfma_f32_16x16x32_bf16 v[84:87], a[68:71], v[120:123], v[84:87]
    ds_read_b64_tr_b16 v[216:217], v63 offset:9600
    v_mfma_f32_16x16x32_bf16 v[88:91], a[60:63], v[124:127], v[88:91]
    ds_read_b64_tr_b16 v[218:219], v63 offset:10368
    v_mfma_f32_16x16x32_bf16 v[92:95], a[64:67], v[124:127], v[92:95]
    v_mfma_f32_16x16x32_bf16 v[96:99], a[68:71], v[124:127], v[96:99]
    s_waitcnt vmcnt(6) lgkmcnt(4)
    s_barrier
    v_mfma_f32_16x16x32_bf16 v[64:67], a[168:171], v[120:123], v[64:67]
    ds_read_b64_tr_b16 a[72:73], v13 offset:49152
    buffer_load_dwordx4 v5, s[16:19], s31 offen lds
    v_mfma_f32_16x16x32_bf16 v[68:71], a[172:175], v[120:123], v[68:71]
    ds_read_b64_tr_b16 a[74:75], v13 offset:49920
    v_mfma_f32_16x16x32_bf16 v[72:75], a[176:179], v[120:123], v[72:75]
    ds_read_b64_tr_b16 a[76:77], v14 offset:49152
    v_mfma_f32_16x16x32_bf16 v[76:79], a[168:171], v[124:127], v[76:79]
    ds_read_b128 v[132:135], v17 offset:13952
    v_mfma_f32_16x16x32_bf16 v[80:83], a[172:175], v[124:127], v[80:83]
    buffer_load_dwordx4 v5, s[16:19], s31 offen offset:512 lds
    v_mfma_f32_16x16x32_bf16 v[84:87], a[176:179], v[124:127], v[84:87]
    s_waitcnt lgkmcnt(4)
    ds_read_b64_tr_b16 a[78:79], v14 offset:49920
    s_add_u32 m0, s25, 27648
    v_mfma_f32_16x16x32_bf16 v[88:91], a[168:171], v[128:131], v[88:91]
    s_add_u32 s31, s44, 344064
    ds_read_b64_tr_b16 a[80:81], v15 offset:49152
    v_mfma_f32_16x16x32_bf16 v[92:95], a[172:175], v[128:131], v[92:95]
    ds_read_b64_tr_b16 a[82:83], v15 offset:49920
    v_mfma_f32_16x16x32_bf16 v[96:99], a[176:179], v[128:131], v[96:99]
    buffer_load_dwordx4 v8, s[8:11], s31 offen  lds
    v_mfma_f32_16x16x32_bf16 v[64:67], v[208:211], v[124:127], v[64:67]
    s_add_u32 m0, s25, 31104
    ds_read_b128 v[136:139], v18 offset:0
    s_add_u32 s31, s44, 387072
    v_mfma_f32_16x16x32_bf16 v[68:71], v[212:215], v[124:127], v[68:71]
    ds_read_b128 v[140:143], v18 offset:3456
    v_mfma_f32_16x16x32_bf16 v[72:75], v[216:219], v[124:127], v[72:75]
    ds_read_b64_tr_b16 a[180:181], v13 offset:55296
    v_mfma_f32_16x16x32_bf16 v[76:79], v[208:211], v[128:131], v[76:79]
    buffer_load_dwordx4 v8, s[8:11], s31 offen  lds
    v_mfma_f32_16x16x32_bf16 v[80:83], v[212:215], v[128:131], v[80:83]
    ds_read_b64_tr_b16 a[182:183], v13 offset:56064
    v_mfma_f32_16x16x32_bf16 v[84:87], v[216:219], v[128:131], v[84:87]
    s_waitcnt lgkmcnt(4)
    ds_read_b64_tr_b16 a[184:185], v14 offset:55296
    v_mfma_f32_16x16x32_bf16 v[88:91], v[208:211], v[132:135], v[88:91]
    ds_read_b128 v[112:115], v18 offset:6912
    v_mfma_f32_16x16x32_bf16 v[92:95], v[212:215], v[132:135], v[92:95]
    ds_read_b64_tr_b16 a[186:187], v14 offset:56064
    v_mfma_f32_16x16x32_bf16 v[96:99], v[216:219], v[132:135], v[96:99]
    s_waitcnt lgkmcnt(4)
    ds_read_b64_tr_b16 a[188:189], v15 offset:55296
    v_mfma_f32_16x16x32_bf16 v[64:67], a[72:75], v[136:139], v[64:67]
    buffer_load_dwordx4 v[180:183], v30, s[12:15], s55 offen
    v_mfma_f32_16x16x32_bf16 v[68:71], a[76:79], v[136:139], v[68:71]
    ds_read_b64_tr_b16 a[190:191], v15 offset:56064
    v_mfma_f32_16x16x32_bf16 v[72:75], a[80:83], v[136:139], v[72:75]
    ds_read_b64_tr_b16 v[220:221], v13 offset:0
    v_mfma_f32_16x16x32_bf16 v[76:79], a[72:75], v[140:143], v[76:79]
    ds_read_b64_tr_b16 v[222:223], v13 offset:768
    v_mfma_f32_16x16x32_bf16 v[80:83], a[76:79], v[140:143], v[80:83]
    buffer_load_dwordx4 v[184:187], v31, s[12:15], s55 offen
    v_mfma_f32_16x16x32_bf16 v[84:87], a[80:83], v[140:143], v[84:87]
    s_waitcnt lgkmcnt(3)
    ds_read_b64_tr_b16 v[224:225], v14 offset:0
    s_add_u32 m0, s25, 34560
    v_mfma_f32_16x16x32_bf16 v[88:91], a[72:75], v[112:115], v[88:91]
    s_add_u32 s31, s44, 430080
    ds_read_b128 v[116:119], v18 offset:10368
    v_mfma_f32_16x16x32_bf16 v[92:95], a[76:79], v[112:115], v[92:95]
    ds_read_b64_tr_b16 v[226:227], v14 offset:768
    v_mfma_f32_16x16x32_bf16 v[96:99], a[80:83], v[112:115], v[96:99]
    s_waitcnt lgkmcnt(4)
    buffer_load_dwordx4 v8, s[8:11], s31 offen  lds
    v_mfma_f32_16x16x32_bf16 v[64:67], a[180:183], v[140:143], v[64:67]
    s_add_u32 m0, s25, 38016
    ds_read_b64_tr_b16 v[228:229], v15 offset:0
    s_add_u32 s31, s44, 473088
    v_mfma_f32_16x16x32_bf16 v[68:71], a[184:187], v[140:143], v[68:71]
    ds_read_b64_tr_b16 v[230:231], v15 offset:768
    v_mfma_f32_16x16x32_bf16 v[72:75], a[188:191], v[140:143], v[72:75]
    ds_read_b64_tr_b16 a[84:85], v13 offset:6144
    v_mfma_f32_16x16x32_bf16 v[76:79], a[180:183], v[112:115], v[76:79]
    buffer_load_dwordx4 v8, s[8:11], s31 offen  lds
    v_mfma_f32_16x16x32_bf16 v[80:83], a[184:187], v[112:115], v[80:83]
    s_add_u32 m0, s25, 41472
    ds_read_b64_tr_b16 a[86:87], v13 offset:6912
    s_add_u32 s31, s44, 516096
    v_mfma_f32_16x16x32_bf16 v[84:87], a[188:191], v[112:115], v[84:87]
    s_waitcnt lgkmcnt(4)
    ds_read_b64_tr_b16 a[88:89], v14 offset:6144
    v_mfma_f32_16x16x32_bf16 v[88:91], a[180:183], v[116:119], v[88:91]
    ds_read_b128 v[120:123], v18 offset:13824
    v_mfma_f32_16x16x32_bf16 v[92:95], a[184:187], v[116:119], v[92:95]
    ds_read_b64_tr_b16 a[90:91], v14 offset:6912
    v_mfma_f32_16x16x32_bf16 v[96:99], a[188:191], v[116:119], v[96:99]
    s_waitcnt vmcnt(8) lgkmcnt(4)
    s_barrier
    v_mfma_f32_16x16x32_bf16 v[64:67], v[220:223], v[112:115], v[64:67]
    buffer_load_dwordx4 v8, s[8:11], s31 offen  lds
    v_mfma_f32_16x16x32_bf16 v[68:71], v[224:227], v[112:115], v[68:71]
    s_add_u32 m0, s25, 44928
    ds_read_b64_tr_b16 a[92:93], v15 offset:6144
    s_add_u32 s31, s44, 559104
    v_mfma_f32_16x16x32_bf16 v[72:75], v[228:231], v[112:115], v[72:75]
    ds_read_b64_tr_b16 a[94:95], v15 offset:6912
    v_mfma_f32_16x16x32_bf16 v[76:79], v[220:223], v[116:119], v[76:79]
    ds_read_b128 v[124:127], v18 offset:64
    v_mfma_f32_16x16x32_bf16 v[80:83], v[224:227], v[116:119], v[80:83]
    buffer_load_dwordx4 v8, s[8:11], s31 offen  lds
    v_mfma_f32_16x16x32_bf16 v[84:87], v[228:231], v[116:119], v[84:87]
    s_waitcnt lgkmcnt(3)
    ds_read_b128 v[128:131], v18 offset:3520
    s_add_u32 m0, s25, 48384
    v_mfma_f32_16x16x32_bf16 v[88:91], v[220:223], v[120:123], v[88:91]
    s_add_u32 s31, s44, 602112
    ds_read_b64_tr_b16 a[192:193], v13 offset:12288
    v_mfma_f32_16x16x32_bf16 v[92:95], v[224:227], v[120:123], v[92:95]
    ds_read_b64_tr_b16 a[194:195], v13 offset:13056
    v_mfma_f32_16x16x32_bf16 v[96:99], v[228:231], v[120:123], v[96:99]
    s_waitcnt lgkmcnt(3)
    ds_read_b64_tr_b16 a[196:197], v14 offset:12288
    v_mfma_f32_16x16x32_bf16 v[64:67], a[84:87], v[124:127], v[64:67]
    ds_read_b128 v[132:135], v18 offset:6976
    v_mfma_f32_16x16x32_bf16 v[68:71], a[88:91], v[124:127], v[68:71]
    ds_read_b64_tr_b16 a[198:199], v14 offset:13056
    v_mfma_f32_16x16x32_bf16 v[72:75], a[92:95], v[124:127], v[72:75]
    s_waitcnt lgkmcnt(5)
    ds_read_b64_tr_b16 a[200:201], v15 offset:12288
    v_mfma_f32_16x16x32_bf16 v[76:79], a[84:87], v[128:131], v[76:79]
    ds_read_b64_tr_b16 a[202:203], v15 offset:13056
    v_mfma_f32_16x16x32_bf16 v[80:83], a[88:91], v[128:131], v[80:83]
    ds_read_b64_tr_b16 v[232:233], v13 offset:18432
    v_mfma_f32_16x16x32_bf16 v[84:87], a[92:95], v[128:131], v[84:87]
    s_waitcnt lgkmcnt(4)
    ds_read_b64_tr_b16 v[234:235], v13 offset:19200
    v_mfma_f32_16x16x32_bf16 v[88:91], a[84:87], v[132:135], v[88:91]
    ds_read_b64_tr_b16 v[236:237], v14 offset:18432
    v_mfma_f32_16x16x32_bf16 v[92:95], a[88:91], v[132:135], v[92:95]
    ds_read_b128 v[136:139], v18 offset:10432
    v_mfma_f32_16x16x32_bf16 v[96:99], a[92:95], v[132:135], v[96:99]
    s_waitcnt lgkmcnt(4)
    ds_read_b64_tr_b16 v[238:239], v14 offset:19200
    v_mfma_f32_16x16x32_bf16 v[64:67], a[192:195], v[128:131], v[64:67]
    buffer_load_dwordx4 v8, s[8:11], s31 offen  lds
    v_mfma_f32_16x16x32_bf16 v[68:71], a[196:199], v[128:131], v[68:71]
    s_add_u32 m0, s25, 51840
    ds_read_b64_tr_b16 v[240:241], v15 offset:18432
    s_add_u32 s31, s53, 645120
    v_mfma_f32_16x16x32_bf16 v[72:75], a[200:203], v[128:131], v[72:75]
    ds_read_b64_tr_b16 v[242:243], v15 offset:19200
    v_mfma_f32_16x16x32_bf16 v[76:79], a[192:195], v[132:135], v[76:79]
    ds_read_b64_tr_b16 a[96:97], v13 offset:24576
    v_mfma_f32_16x16x32_bf16 v[80:83], a[196:199], v[132:135], v[80:83]
    buffer_load_dwordx4 v8, s[8:11], s31 offen  lds
    v_mfma_f32_16x16x32_bf16 v[84:87], a[200:203], v[132:135], v[84:87]
    s_waitcnt lgkmcnt(3)
    ds_read_b64_tr_b16 a[98:99], v13 offset:25344
    v_mfma_f32_16x16x32_bf16 v[88:91], a[192:195], v[136:139], v[88:91]
    ds_read_b64_tr_b16 a[100:101], v14 offset:24576
    v_mfma_f32_16x16x32_bf16 v[92:95], a[196:199], v[136:139], v[92:95]
    ds_read_b128 v[140:143], v18 offset:13888
    v_mfma_f32_16x16x32_bf16 v[96:99], a[200:203], v[136:139], v[96:99]
    s_waitcnt lgkmcnt(4)
    ds_read_b64_tr_b16 a[102:103], v14 offset:25344
    v_mfma_f32_16x16x32_bf16 v[64:67], v[232:235], v[132:135], v[64:67]
    ds_read_b64_tr_b16 a[104:105], v15 offset:24576
    v_mfma_f32_16x16x32_bf16 v[68:71], v[236:239], v[132:135], v[68:71]
    ds_read_b64_tr_b16 a[106:107], v15 offset:25344
    v_mfma_f32_16x16x32_bf16 v[72:75], v[240:243], v[132:135], v[72:75]
    ds_read_b128 v[112:115], v18 offset:128
    v_mfma_f32_16x16x32_bf16 v[76:79], v[232:235], v[136:139], v[76:79]
    ds_read_b64_tr_b16 a[204:205], v13 offset:30720
    v_mfma_f32_16x16x32_bf16 v[80:83], v[236:239], v[136:139], v[80:83]
    ds_read_b128 v[116:119], v18 offset:3584
    v_mfma_f32_16x16x32_bf16 v[84:87], v[240:243], v[136:139], v[84:87]
    s_waitcnt lgkmcnt(5)
    ds_read_b64_tr_b16 a[206:207], v13 offset:31488
    v_mfma_f32_16x16x32_bf16 v[88:91], v[232:235], v[140:143], v[88:91]
    ds_read_b64_tr_b16 a[208:209], v14 offset:30720
    v_mfma_f32_16x16x32_bf16 v[92:95], v[236:239], v[140:143], v[92:95]
    ds_read_b128 v[120:123], v18 offset:7040
    v_mfma_f32_16x16x32_bf16 v[96:99], v[240:243], v[140:143], v[96:99]
    s_waitcnt vmcnt(9) lgkmcnt(5)
    s_barrier
    v_mfma_f32_16x16x32_bf16 v[64:67], a[96:99], v[112:115], v[64:67]
    ds_read_b64_tr_b16 a[210:211], v14 offset:31488
    v_mfma_f32_16x16x32_bf16 v[68:71], a[100:103], v[112:115], v[68:71]
    ds_read_b64_tr_b16 a[212:213], v15 offset:30720
    v_mfma_f32_16x16x32_bf16 v[72:75], a[104:107], v[112:115], v[72:75]
    s_waitcnt lgkmcnt(4)
    ds_read_b64_tr_b16 a[214:215], v15 offset:31488
    v_mfma_f32_16x16x32_bf16 v[76:79], a[96:99], v[116:119], v[76:79]
    ds_read_b64_tr_b16 v[244:245], v13 offset:36864
    v_mfma_f32_16x16x32_bf16 v[80:83], a[100:103], v[116:119], v[80:83]
    ds_read_b64_tr_b16 v[246:247], v13 offset:37632
    v_mfma_f32_16x16x32_bf16 v[84:87], a[104:107], v[116:119], v[84:87]
    s_waitcnt lgkmcnt(5)
    ds_read_b64_tr_b16 v[248:249], v14 offset:36864
    v_mfma_f32_16x16x32_bf16 v[88:91], a[96:99], v[120:123], v[88:91]
    ds_read_b128 v[124:127], v18 offset:10496
    v_mfma_f32_16x16x32_bf16 v[92:95], a[100:103], v[120:123], v[92:95]
    ds_read_b64_tr_b16 v[250:251], v14 offset:37632
    v_mfma_f32_16x16x32_bf16 v[96:99], a[104:107], v[120:123], v[96:99]
    s_waitcnt lgkmcnt(5)
    ds_read_b64_tr_b16 v[252:253], v15 offset:36864
    v_mfma_f32_16x16x32_bf16 v[64:67], a[204:207], v[116:119], v[64:67]
    ds_read_b64_tr_b16 v[254:255], v15 offset:37632
    v_mfma_f32_16x16x32_bf16 v[68:71], a[208:211], v[116:119], v[68:71]
    v_mfma_f32_16x16x32_bf16 v[72:75], a[212:215], v[116:119], v[72:75]
    v_mfma_f32_16x16x32_bf16 v[76:79], a[204:207], v[120:123], v[76:79]
    ds_read_b128 v[128:131], v18 offset:13952
    v_mfma_f32_16x16x32_bf16 v[80:83], a[208:211], v[120:123], v[80:83]
    v_mfma_f32_16x16x32_bf16 v[84:87], a[212:215], v[120:123], v[84:87]
    s_waitcnt lgkmcnt(2)
    v_mfma_f32_16x16x32_bf16 v[88:91], a[204:207], v[124:127], v[88:91]
    ds_read_b128 v[132:135], v40 offset:20736
    v_mfma_f32_16x16x32_bf16 v[92:95], a[208:211], v[124:127], v[92:95]
    v_mfma_f32_16x16x32_bf16 v[96:99], a[212:215], v[124:127], v[96:99]
    s_waitcnt lgkmcnt(2)
    v_mfma_f32_16x16x32_bf16 v[64:67], v[244:247], v[120:123], v[64:67]
    ds_read_b128 v[136:139], v40 offset:20800
    v_mfma_f32_16x16x32_bf16 v[68:71], v[248:251], v[120:123], v[68:71]
    v_mfma_f32_16x16x32_bf16 v[72:75], v[252:255], v[120:123], v[72:75]
    v_mfma_f32_16x16x32_bf16 v[76:79], v[244:247], v[124:127], v[76:79]
    ds_read_b128 v[140:143], v40 offset:20864
    v_mfma_f32_16x16x32_bf16 v[80:83], v[248:251], v[124:127], v[80:83]
    v_mfma_f32_16x16x32_bf16 v[84:87], v[252:255], v[124:127], v[84:87]
    s_waitcnt lgkmcnt(2)
    v_mfma_f32_16x16x32_bf16 v[88:91], v[244:247], v[128:131], v[88:91]
    ds_read_b128 v[112:115], v41 offset:20736
    v_mfma_f32_16x16x32_bf16 v[92:95], v[248:251], v[128:131], v[92:95]
    v_mfma_f32_16x16x32_bf16 v[96:99], v[252:255], v[128:131], v[96:99]
    v_mfma_f32_16x16x32_bf16 v[100:103], a[0:3], v[132:135], 0
    ds_read_b128 v[116:119], v41 offset:20800
    v_cvt_pk_bf16_f32 v72, v72, v73
    v_mfma_f32_16x16x32_bf16 v[104:107], a[4:7], v[132:135], 0
    v_cvt_pk_bf16_f32 v73, v74, v75
    v_cvt_pk_bf16_f32 v84, v84, v85
    v_mfma_f32_16x16x32_bf16 v[108:111], a[8:11], v[132:135], 0
    s_waitcnt lgkmcnt(2)
    ds_write_b64 v38, v[72:73] offset:0
    v_mfma_f32_16x16x32_bf16 v[100:103], a[12:15], v[136:139], v[100:103]
    ds_read_b128 v[120:123], v41 offset:20864
    v_mfma_f32_16x16x32_bf16 v[104:107], a[16:19], v[136:139], v[104:107]
    v_cvt_pk_bf16_f32 v85, v86, v87
    v_cvt_pk_bf16_f32 v96, v96, v97
    v_mfma_f32_16x16x32_bf16 v[108:111], a[20:23], v[136:139], v[108:111]
    ds_write_b64 v38, v[84:85] offset:2048
    v_mfma_f32_16x16x32_bf16 v[100:103], a[24:27], v[140:143], v[100:103]
    ds_read_b128 v[124:127], v42 offset:20736
    v_mfma_f32_16x16x32_bf16 v[104:107], a[28:31], v[140:143], v[104:107]
    v_cvt_pk_bf16_f32 v97, v98, v99
    v_cvt_pk_bf16_f32 v64, v64, v65
    v_mfma_f32_16x16x32_bf16 v[108:111], a[32:35], v[140:143], v[108:111]
    s_waitcnt lgkmcnt(3)
    ds_write_b64 v38, v[96:97] offset:4096
    v_mfma_f32_16x16x32_bf16 v[100:103], a[36:39], v[112:115], v[100:103]
    ds_read_b128 v[128:131], v42 offset:20800
    v_mfma_f32_16x16x32_bf16 v[104:107], a[40:43], v[112:115], v[104:107]
    v_cvt_pk_bf16_f32 v65, v66, v67
    v_cvt_pk_bf16_f32 v66, v68, v69
    v_mfma_f32_16x16x32_bf16 v[108:111], a[44:47], v[112:115], v[108:111]
    v_cvt_pk_bf16_f32 v67, v70, v71
    v_cvt_pk_bf16_f32 v76, v76, v77
    v_mfma_f32_16x16x32_bf16 v[100:103], a[48:51], v[116:119], v[100:103]
    ds_read_b128 v[132:135], v42 offset:20864
    v_cvt_pk_bf16_f32 v77, v78, v79
    v_mfma_f32_16x16x32_bf16 v[104:107], a[52:55], v[116:119], v[104:107]
    v_permlane16_swap_b32 v64, v66
    v_mfma_f32_16x16x32_bf16 v[108:111], a[56:59], v[116:119], v[108:111]
    s_waitcnt lgkmcnt(2)
    v_permlane16_swap_b32 v65, v67
    v_mfma_f32_16x16x32_bf16 v[100:103], a[60:63], v[120:123], v[100:103]
    ds_read_b128 v[136:139], v40 offset:24192
    v_cvt_pk_bf16_f32 v78, v80, v81
    v_mfma_f32_16x16x32_bf16 v[104:107], a[64:67], v[120:123], v[104:107]
    buffer_store_dwordx4 v[64:67], v19, s[20:23], s56 offen sc1
    v_cvt_pk_bf16_f32 v79, v82, v83
    v_cvt_pk_bf16_f32 v88, v88, v89
    v_cvt_pk_bf16_f32 v89, v90, v91
    v_mfma_f32_16x16x32_bf16 v[108:111], a[68:71], v[120:123], v[108:111]
    v_permlane16_swap_b32 v76, v78
    v_mfma_f32_16x16x32_bf16 v[100:103], a[72:75], v[124:127], v[100:103]
    ds_read_b128 v[140:143], v40 offset:24256
    v_cvt_pk_bf16_f32 v90, v92, v93
    v_mfma_f32_16x16x32_bf16 v[104:107], a[76:79], v[124:127], v[104:107]
    v_permlane16_swap_b32 v77, v79
    v_mfma_f32_16x16x32_bf16 v[108:111], a[80:83], v[124:127], v[108:111]
    s_waitcnt lgkmcnt(2)
    v_permlane16_swap_b32 v88, v90
    v_mfma_f32_16x16x32_bf16 v[100:103], a[84:87], v[128:131], v[100:103]
    ds_read_b128 v[112:115], v40 offset:24320
    v_cvt_pk_bf16_f32 v91, v94, v95
    v_mfma_f32_16x16x32_bf16 v[104:107], a[88:91], v[128:131], v[104:107]
    buffer_store_dwordx4 v[76:79], v19, s[20:23], s4 offen sc1
    v_mfma_f32_16x16x32_bf16 v[108:111], a[92:95], v[128:131], v[108:111]
    v_permlane16_swap_b32 v89, v91
    v_mfma_f32_16x16x32_bf16 v[100:103], a[96:99], v[132:135], v[100:103]
    ds_read_b128 v[116:119], v41 offset:24192
    v_mfma_f32_16x16x32_bf16 v[104:107], a[100:103], v[132:135], v[104:107]
    v_mfma_f32_16x16x32_bf16 v[108:111], a[104:107], v[132:135], v[108:111]
    s_waitcnt lgkmcnt(2)
    v_mfma_f32_16x16x32_bf16 v[100:103], a[108:111], v[136:139], v[100:103]
    ds_read_b128 v[120:123], v41 offset:24256
    v_mfma_f32_16x16x32_bf16 v[104:107], a[112:115], v[136:139], v[104:107]
    v_mfma_f32_16x16x32_bf16 v[108:111], a[116:119], v[136:139], v[108:111]
    s_waitcnt vmcnt(5) lgkmcnt(2)
    s_barrier
    v_mfma_f32_16x16x32_bf16 v[100:103], a[120:123], v[140:143], v[100:103]
L_pgX1:
  s_cbranch_execz L_retX
    ds_read_b128 v[124:127], v41 offset:24320
    v_mfma_f32_16x16x32_bf16 v[104:107], a[124:127], v[140:143], v[104:107]
    ds_read_b64 v[6:7], v39 offset:0
    v_mfma_f32_16x16x32_bf16 v[108:111], a[128:131], v[140:143], v[108:111]
    v_mfma_f32_16x16x32_bf16 v[100:103], a[132:135], v[112:115], v[100:103]
    ds_read_b128 v[128:131], v42 offset:24192
    v_mfma_f32_16x16x32_bf16 v[104:107], a[136:139], v[112:115], v[104:107]
    v_mfma_f32_16x16x32_bf16 v[108:111], a[140:143], v[112:115], v[108:111]
    s_waitcnt lgkmcnt(3)
    v_mfma_f32_16x16x32_bf16 v[100:103], a[144:147], v[116:119], v[100:103]
    ds_read_b128 v[132:135], v42 offset:24256
    v_mfma_f32_16x16x32_bf16 v[104:107], a[148:151], v[116:119], v[104:107]
    buffer_store_dwordx4 v[88:91], v19, s[20:23], s5 offen sc1
    v_mfma_f32_16x16x32_bf16 v[108:111], a[152:155], v[116:119], v[108:111]
    s_waitcnt lgkmcnt(2)
    v_mfma_f32_16x16x32_bf16 v[100:103], a[156:159], v[120:123], v[100:103]
    ds_read_b128 v[136:139], v42 offset:24320
    v_mfma_f32_16x16x32_bf16 v[104:107], a[160:163], v[120:123], v[104:107]
    v_mfma_f32_16x16x32_bf16 v[108:111], a[164:167], v[120:123], v[108:111]
    buffer_store_dwordx2 v[6:7], v20, s[20:23], s56 offen sc1
    v_mfma_f32_16x16x32_bf16 v[100:103], a[168:171], v[124:127], v[100:103]
    ds_read_b128 v[140:143], v40 offset:27648
    v_mfma_f32_16x16x32_bf16 v[104:107], a[172:175], v[124:127], v[104:107]
    v_mfma_f32_16x16x32_bf16 v[108:111], a[176:179], v[124:127], v[108:111]
    s_waitcnt lgkmcnt(2)
    v_mfma_f32_16x16x32_bf16 v[100:103], a[180:183], v[128:131], v[100:103]
    ds_read_b128 v[112:115], v40 offset:27712
    v_mfma_f32_16x16x32_bf16 v[104:107], a[184:187], v[128:131], v[104:107]
    v_mfma_f32_16x16x32_bf16 v[108:111], a[188:191], v[128:131], v[108:111]
    v_mfma_f32_16x16x32_bf16 v[100:103], a[192:195], v[132:135], v[100:103]
    ds_read_b128 v[116:119], v40 offset:27776
    v_mfma_f32_16x16x32_bf16 v[104:107], a[196:199], v[132:135], v[104:107]
    ds_read_b64 v[8:9], v39 offset:2048
    v_mfma_f32_16x16x32_bf16 v[108:111], a[200:203], v[132:135], v[108:111]
    s_waitcnt lgkmcnt(3)
    v_mfma_f32_16x16x32_bf16 v[100:103], a[204:207], v[136:139], v[100:103]
    ds_read_b128 v[120:123], v41 offset:27648
    v_mfma_f32_16x16x32_bf16 v[104:107], a[208:211], v[136:139], v[104:107]
    v_mfma_f32_16x16x32_bf16 v[108:111], a[212:215], v[136:139], v[108:111]
    v_mfma_f32_16x16x32_bf16 v[100:103], a[216:219], v[140:143], v[100:103]
    ds_read_b128 v[124:127], v41 offset:27712
    v_mfma_f32_16x16x32_bf16 v[104:107], a[220:223], v[140:143], v[104:107]
    v_mfma_f32_16x16x32_bf16 v[108:111], a[224:227], v[140:143], v[108:111]
    s_waitcnt lgkmcnt(2)
    v_mfma_f32_16x16x32_bf16 v[100:103], a[228:231], v[112:115], v[100:103]
    ds_read_b128 v[128:131], v41 offset:27776
    v_mfma_f32_16x16x32_bf16 v[104:107], a[232:235], v[112:115], v[104:107]
    buffer_store_dwordx2 v[8:9], v20, s[20:23], s4 offen sc1
    v_mfma_f32_16x16x32_bf16 v[108:111], a[236:239], v[112:115], v[108:111]
    v_mfma_f32_16x16x32_bf16 v[100:103], a[240:243], v[116:119], v[100:103]
    ds_read_b128 v[132:135], v42 offset:27648
    v_mfma_f32_16x16x32_bf16 v[104:107], a[244:247], v[116:119], v[104:107]
    v_mfma_f32_16x16x32_bf16 v[108:111], a[248:251], v[116:119], v[108:111]
    s_waitcnt lgkmcnt(2)
    v_mfma_f32_16x16x32_bf16 v[100:103], a[252:255], v[120:123], v[100:103]
    ds_read_b128 v[136:139], v42 offset:27712
    v_mfma_f32_16x16x32_bf16 v[104:107], v[188:191], v[120:123], v[104:107]
    v_mfma_f32_16x16x32_bf16 v[108:111], v[192:195], v[120:123], v[108:111]
    v_mfma_f32_16x16x32_bf16 v[100:103], v[196:199], v[124:127], v[100:103]
    ds_read_b128 v[140:143], v42 offset:27776
    v_mfma_f32_16x16x32_bf16 v[104:107], v[200:203], v[124:127], v[104:107]
    ds_read_b64 v[10:11], v39 offset:4096
    v_mfma_f32_16x16x32_bf16 v[108:111], v[204:207], v[124:127], v[108:111]
    s_waitcnt lgkmcnt(3)
    v_mfma_f32_16x16x32_bf16 v[100:103], v[208:211], v[128:131], v[100:103]
    ds_read_b128 v[112:115], v40 offset:27648
    v_mfma_f32_16x16x32_bf16 v[104:107], v[212:215], v[128:131], v[104:107]
    v_mfma_f32_16x16x32_bf16 v[108:111], v[216:219], v[128:131], v[108:111]
    v_mfma_f32_16x16x32_bf16 v[100:103], v[220:223], v[132:135], v[100:103]
    ds_read_b128 v[116:119], v40 offset:27712
    v_mfma_f32_16x16x32_bf16 v[104:107], v[224:227], v[132:135], v[104:107]
    v_mfma_f32_16x16x32_bf16 v[108:111], v[228:231], v[132:135], v[108:111]
    s_waitcnt lgkmcnt(2)
    v_mfma_f32_16x16x32_bf16 v[100:103], v[232:235], v[136:139], v[100:103]
    ds_read_b128 v[120:123], v40 offset:27776
    v_mfma_f32_16x16x32_bf16 v[104:107], v[236:239], v[136:139], v[104:107]
    buffer_store_dwordx2 v[10:11], v20, s[20:23], s5 offen sc1
    v_mfma_f32_16x16x32_bf16 v[108:111], v[240:243], v[136:139], v[108:111]
    v_mfma_f32_16x16x32_bf16 v[100:103], v[244:247], v[140:143], v[100:103]
    ds_read_b128 v[124:127], v41 offset:27648
    v_mfma_f32_16x16x32_bf16 v[104:107], v[248:251], v[140:143], v[104:107]
    v_mfma_f32_16x16x32_bf16 v[108:111], v[252:255], v[140:143], v[108:111]
    s_waitcnt lgkmcnt(2)
    v_mfma_f32_16x16x32_bf16 v[64:67], a[0:3], v[112:115], 0
    ds_read_b128 v[128:131], v41 offset:27712
    v_mfma_f32_16x16x32_bf16 v[68:71], a[4:7], v[112:115], 0
    v_mfma_f32_16x16x32_bf16 v[72:75], a[8:11], v[112:115], 0
    v_cvt_pk_bf16_f32 v100, v100, v101
    v_cvt_pk_bf16_f32 v101, v102, v103
    v_mfma_f32_16x16x32_bf16 v[64:67], a[12:15], v[116:119], v[64:67]
    ds_read_b128 v[132:135], v41 offset:27776
    v_cvt_pk_bf16_f32 v108, v108, v109
    v_mfma_f32_16x16x32_bf16 v[68:71], a[16:19], v[116:119], v[68:71]
    v_cvt_pk_bf16_f32 v109, v110, v111
    v_cvt_pk_bf16_f32 v102, v104, v105
    v_mfma_f32_16x16x32_bf16 v[72:75], a[20:23], v[116:119], v[72:75]
    s_waitcnt lgkmcnt(2)
    ds_write_b64 v38, v[108:109] offset:6144
    v_mfma_f32_16x16x32_bf16 v[64:67], a[24:27], v[120:123], v[64:67]
    ds_read_b128 v[136:139], v42 offset:27648
    v_mfma_f32_16x16x32_bf16 v[68:71], a[28:31], v[120:123], v[68:71]
    v_permlane16_swap_b32 v100, v102
    v_mfma_f32_16x16x32_bf16 v[72:75], a[32:35], v[120:123], v[72:75]
    v_cvt_pk_bf16_f32 v103, v106, v107
    v_mfma_f32_16x16x32_bf16 v[64:67], a[36:39], v[124:127], v[64:67]
    ds_read_b128 v[140:143], v42 offset:27712
    v_mfma_f32_16x16x32_bf16 v[68:71], a[40:43], v[124:127], v[68:71]
    v_permlane16_swap_b32 v101, v103
    v_mfma_f32_16x16x32_bf16 v[72:75], a[44:47], v[124:127], v[72:75]
    s_waitcnt lgkmcnt(2)
    v_mfma_f32_16x16x32_bf16 v[64:67], a[48:51], v[128:131], v[64:67]
    ds_read_b128 v[112:115], v42 offset:27776
    v_mfma_f32_16x16x32_bf16 v[68:71], a[52:55], v[128:131], v[68:71]
    buffer_store_dwordx4 v[100:103], v21, s[20:23], s74 offen sc1
    v_mfma_f32_16x16x32_bf16 v[72:75], a[56:59], v[128:131], v[72:75]
    v_mfma_f32_16x16x32_bf16 v[64:67], a[60:63], v[132:135], v[64:67]
    ds_read_b128 v[116:119], v40 offset:31104
    v_mfma_f32_16x16x32_bf16 v[68:71], a[64:67], v[132:135], v[68:71]
    v_mfma_f32_16x16x32_bf16 v[72:75], a[68:71], v[132:135], v[72:75]
    s_waitcnt lgkmcnt(2)
    v_mfma_f32_16x16x32_bf16 v[64:67], a[72:75], v[136:139], v[64:67]
    ds_read_b128 v[120:123], v40 offset:31168
    v_mfma_f32_16x16x32_bf16 v[68:71], a[76:79], v[136:139], v[68:71]
    v_mfma_f32_16x16x32_bf16 v[72:75], a[80:83], v[136:139], v[72:75]
    v_mfma_f32_16x16x32_bf16 v[64:67], a[84:87], v[140:143], v[64:67]
    ds_read_b128 v[124:127], v40 offset:31232
    v_mfma_f32_16x16x32_bf16 v[68:71], a[88:91], v[140:143], v[68:71]
    v_mfma_f32_16x16x32_bf16 v[72:75], a[92:95], v[140:143], v[72:75]
    s_waitcnt vmcnt(13) lgkmcnt(2)
    v_mfma_f32_16x16x32_bf16 v[64:67], a[96:99], v[112:115], v[64:67]
    ds_read_b128 v[128:131], v41 offset:31104
    v_and_b32 v180, s96, v180
    v_mfma_f32_16x16x32_bf16 v[68:71], a[100:103], v[112:115], v[68:71]
    v_and_b32 v181, s96, v181
    v_and_b32 v182, s96, v182
    v_mfma_f32_16x16x32_bf16 v[72:75], a[104:107], v[112:115], v[72:75]
    v_and_b32 v183, s96, v183
    v_pk_max_u16 v180, v180, v181
    v_mfma_f32_16x16x32_bf16 v[64:67], a[108:111], v[116:119], v[64:67]
    ds_read_b128 v[132:135], v41 offset:31168
    v_pk_max_u16 v182, v182, v183
    v_mfma_f32_16x16x32_bf16 v[68:71], a[112:115], v[116:119], v[68:71]
    v_pk_max_u16 v180, v180, s37
    v_pk_max_u16 v180, v180, v182
    v_mfma_f32_16x16x32_bf16 v[72:75], a[116:119], v[116:119], v[72:75]
    s_waitcnt lgkmcnt(2)
    v_cmp_ne_u32 s[80:81], s37, v180
    v_and_b32 v184, s96, v184
    v_mfma_f32_16x16x32_bf16 v[64:67], a[120:123], v[120:123], v[64:67]
    ds_read_b128 v[136:139], v41 offset:31232
    v_and_b32 v185, s96, v185
    v_mfma_f32_16x16x32_bf16 v[68:71], a[124:127], v[120:123], v[68:71]
    v_and_b32 v186, s96, v186
    v_and_b32 v187, s96, v187
    v_mfma_f32_16x16x32_bf16 v[72:75], a[128:131], v[120:123], v[72:75]
    v_pk_max_u16 v184, v184, v185
    v_pk_max_u16 v186, v186, v187
    v_mfma_f32_16x16x32_bf16 v[64:67], a[132:135], v[124:127], v[64:67]
    ds_read_b128 v[140:143], v42 offset:31104
    v_pk_max_u16 v184, v184, s37
    v_mfma_f32_16x16x32_bf16 v[68:71], a[136:139], v[124:127], v[68:71]
    v_pk_max_u16 v184, v184, v186
    v_cmp_ne_u32 s[82:83], s37, v184
    v_mfma_f32_16x16x32_bf16 v[72:75], a[140:143], v[124:127], v[72:75]
    s_waitcnt lgkmcnt(2)
    v_mfma_f32_16x16x32_bf16 v[64:67], a[144:147], v[128:131], v[64:67]
    ds_read_b128 v[112:115], v42 offset:31168
    v_mfma_f32_16x16x32_bf16 v[68:71], a[148:151], v[128:131], v[68:71]
    s_or_b64 vcc, s[80:81], s[82:83]
    s_cbranch_scc1 L_afailX
L_afailX_back:
    v_mfma_f32_16x16x32_bf16 v[72:75], a[152:155], v[128:131], v[72:75]
    v_mfma_f32_16x16x32_bf16 v[64:67], a[156:159], v[132:135], v[64:67]
    ds_read_b128 v[116:119], v42 offset:31232
    v_mfma_f32_16x16x32_bf16 v[68:71], a[160:163], v[132:135], v[68:71]
    v_mfma_f32_16x16x32_bf16 v[72:75], a[164:167], v[132:135], v[72:75]
    s_waitcnt lgkmcnt(2)
    v_mfma_f32_16x16x32_bf16 v[64:67], a[168:171], v[136:139], v[64:67]
    ds_read_b128 v[120:123], v40 offset:34560
    v_mfma_f32_16x16x32_bf16 v[68:71], a[172:175], v[136:139], v[68:71]
    v_mfma_f32_16x16x32_bf16 v[72:75], a[176:179], v[136:139], v[72:75]
    v_mfma_f32_16x16x32_bf16 v[64:67], a[180:183], v[140:143], v[64:67]
    ds_read_b128 v[124:127], v40 offset:34624
    v_mfma_f32_16x16x32_bf16 v[68:71], a[184:187], v[140:143], v[68:71]
    v_mfma_f32_16x16x32_bf16 v[72:75], a[188:191], v[140:143], v[72:75]
    s_waitcnt lgkmcnt(2)
    v_mfma_f32_16x16x32_bf16 v[64:67], a[192:195], v[112:115], v[64:67]
    ds_read_b128 v[128:131], v40 offset:34688
    v_mfma_f32_16x16x32_bf16 v[68:71], a[196:199], v[112:115], v[68:71]
    v_mfma_f32_16x16x32_bf16 v[72:75], a[200:203], v[112:115], v[72:75]
    v_mfma_f32_16x16x32_bf16 v[64:67], a[204:207], v[116:119], v[64:67]
    ds_read_b128 v[132:135], v41 offset:34560
    v_mfma_f32_16x16x32_bf16 v[68:71], a[208:211], v[116:119], v[68:71]
    v_mfma_f32_16x16x32_bf16 v[72:75], a[212:215], v[116:119], v[72:75]
    s_waitcnt lgkmcnt(2)
    v_mfma_f32_16x16x32_bf16 v[64:67], a[216:219], v[120:123], v[64:67]
    ds_read_b128 v[136:139], v41 offset:34624
    v_mfma_f32_16x16x32_bf16 v[68:71], a[220:223], v[120:123], v[68:71]
    v_mfma_f32_16x16x32_bf16 v[72:75], a[224:227], v[120:123], v[72:75]
    v_mfma_f32_16x16x32_bf16 v[64:67], a[228:231], v[124:127], v[64:67]
    ds_read_b128 v[140:143], v41 offset:34688
    v_mfma_f32_16x16x32_bf16 v[68:71], a[232:235], v[124:127], v[68:71]
    v_mfma_f32_16x16x32_bf16 v[72:75], a[236:239], v[124:127], v[72:75]
    s_waitcnt lgkmcnt(2)
    v_mfma_f32_16x16x32_bf16 v[64:67], a[240:243], v[128:131], v[64:67]
    ds_read_b128 v[112:115], v42 offset:34560
    v_mfma_f32_16x16x32_bf16 v[68:71], a[244:247], v[128:131], v[68:71]
    v_mfma_f32_16x16x32_bf16 v[72:75], a[248:251], v[128:131], v[72:75]
    v_mfma_f32_16x16x32_bf16 v[64:67], a[252:255], v[132:135], v[64:67]
    ds_read_b128 v[116:119], v42 offset:34624
    v_mfma_f32_16x16x32_bf16 v[68:71], v[188:191], v[132:135], v[68:71]
    v_mfma_f32_16x16x32_bf16 v[72:75], v[192:195], v[132:135], v[72:75]
    s_waitcnt lgkmcnt(2)
    v_mfma_f32_16x16x32_bf16 v[64:67], v[196:199], v[136:139], v[64:67]
    ds_read_b128 v[120:123], v42 offset:34688
    v_mfma_f32_16x16x32_bf16 v[68:71], v[200:203], v[136:139], v[68:71]
    v_mfma_f32_16x16x32_bf16 v[72:75], v[204:207], v[136:139], v[72:75]
    v_mfma_f32_16x16x32_bf16 v[64:67], v[208:211], v[140:143], v[64:67]
    ds_read_b128 v[124:127], v40 offset:34560
    v_mfma_f32_16x16x32_bf16 v[68:71], v[212:215], v[140:143], v[68:71]
    v_mfma_f32_16x16x32_bf16 v[72:75], v[216:219], v[140:143], v[72:75]
    s_waitcnt lgkmcnt(2)
    v_mfma_f32_16x16x32_bf16 v[64:67], v[220:223], v[112:115], v[64:67]
    ds_read_b128 v[128:131], v40 offset:34624
    v_mfma_f32_16x16x32_bf16 v[68:71], v[224:227], v[112:115], v[68:71]
    v_mfma_f32_16x16x32_bf16 v[72:75], v[228:231], v[112:115], v[72:75]
    v_mfma_f32_16x16x32_bf16 v[64:67], v[232:235], v[116:119], v[64:67]
    ds_read_b128 v[132:135], v40 offset:34688
    v_mfma_f32_16x16x32_bf16 v[68:71], v[236:239], v[116:119], v[68:71]
    v_mfma_f32_16x16x32_bf16 v[72:75], v[240:243], v[116:119], v[72:75]
    s_waitcnt lgkmcnt(2)
    v_mfma_f32_16x16x32_bf16 v[64:67], v[244:247], v[120:123], v[64:67]
    ds_read_b128 v[136:139], v41 offset:34560
    v_mfma_f32_16x16x32_bf16 v[68:71], v[248:251], v[120:123], v[68:71]
    v_mfma_f32_16x16x32_bf16 v[72:75], v[252:255], v[120:123], v[72:75]
    v_mfma_f32_16x16x32_bf16 v[76:79], a[0:3], v[124:127], 0
    ds_read_b128 v[140:143], v41 offset:34624
    v_mfma_f32_16x16x32_bf16 v[80:83], a[4:7], v[124:127], 0
    v_mfma_f32_16x16x32_bf16 v[84:87], a[8:11], v[124:127], 0
    s_waitcnt lgkmcnt(2)
    v_cvt_pk_bf16_f32 v64, v64, v65
    v_cvt_pk_bf16_f32 v65, v66, v67
    v_mfma_f32_16x16x32_bf16 v[76:79], a[12:15], v[128:131], v[76:79]
    ds_read_b128 v[112:115], v41 offset:34688
    v_cvt_pk_bf16_f32 v72, v72, v73
    v_mfma_f32_16x16x32_bf16 v[80:83], a[16:19], v[128:131], v[80:83]
    v_cvt_pk_bf16_f32 v73, v74, v75
    v_cvt_pk_bf16_f32 v66, v68, v69
    v_mfma_f32_16x16x32_bf16 v[84:87], a[20:23], v[128:131], v[84:87]
    ds_write_b64 v38, v[72:73] offset:8192
    v_mfma_f32_16x16x32_bf16 v[76:79], a[24:27], v[132:135], v[76:79]
    ds_read_b128 v[116:119], v42 offset:34560
    v_mfma_f32_16x16x32_bf16 v[80:83], a[28:31], v[132:135], v[80:83]
    v_permlane16_swap_b32 v64, v66
    v_mfma_f32_16x16x32_bf16 v[84:87], a[32:35], v[132:135], v[84:87]
    s_waitcnt lgkmcnt(3)
    v_cvt_pk_bf16_f32 v67, v70, v71
    v_mfma_f32_16x16x32_bf16 v[76:79], a[36:39], v[136:139], v[76:79]
    ds_read_b128 v[120:123], v42 offset:34624
    v_mfma_f32_16x16x32_bf16 v[80:83], a[40:43], v[136:139], v[80:83]
    v_permlane16_swap_b32 v65, v67
    v_mfma_f32_16x16x32_bf16 v[84:87], a[44:47], v[136:139], v[84:87]
    buffer_store_dwordx4 v[64:67], v21, s[20:23], s75 offen sc1
    v_mfma_f32_16x16x32_bf16 v[76:79], a[48:51], v[140:143], v[76:79]
    ds_read_b128 v[124:127], v42 offset:34688
    v_mfma_f32_16x16x32_bf16 v[80:83], a[52:55], v[140:143], v[80:83]
    v_mfma_f32_16x16x32_bf16 v[84:87], a[56:59], v[140:143], v[84:87]
    s_waitcnt lgkmcnt(2)
    v_mfma_f32_16x16x32_bf16 v[76:79], a[60:63], v[112:115], v[76:79]
    ds_read_b128 v[128:131], v40 offset:38016
    v_mfma_f32_16x16x32_bf16 v[80:83], a[64:67], v[112:115], v[80:83]
    v_mfma_f32_16x16x32_bf16 v[84:87], a[68:71], v[112:115], v[84:87]
    v_mfma_f32_16x16x32_bf16 v[76:79], a[72:75], v[116:119], v[76:79]
    ds_read_b128 v[132:135], v40 offset:38080
    v_mfma_f32_16x16x32_bf16 v[80:83], a[76:79], v[116:119], v[80:83]
    v_mfma_f32_16x16x32_bf16 v[84:87], a[80:83], v[116:119], v[84:87]
    s_waitcnt lgkmcnt(2)
    v_mfma_f32_16x16x32_bf16 v[76:79], a[84:87], v[120:123], v[76:79]
    ds_read_b128 v[136:139], v40 offset:38144
    v_mfma_f32_16x16x32_bf16 v[80:83], a[88:91], v[120:123], v[80:83]
    v_mfma_f32_16x16x32_bf16 v[84:87], a[92:95], v[120:123], v[84:87]
    s_waitcnt vmcnt(8) lgkmcnt(2)
    s_barrier
    v_mfma_f32_16x16x32_bf16 v[76:79], a[96:99], v[124:127], v[76:79]
    ds_read_b128 v[140:143], v41 offset:38016
    v_mfma_f32_16x16x32_bf16 v[80:83], a[100:103], v[124:127], v[80:83]
    ds_read_b32 v35, v34
    v_mfma_f32_16x16x32_bf16 v[84:87], a[104:107], v[124:127], v[84:87]
    ds_read_b64 v[12:13], v39 offset:6144
    v_mfma_f32_16x16x32_bf16 v[76:79], a[108:111], v[128:131], v[76:79]
    ds_read_b128 v[112:115], v41 offset:38080
    v_mfma_f32_16x16x32_bf16 v[80:83], a[112:115], v[128:131], v[80:83]
    ds_read_b64 v[14:15], v39 offset:8192
    v_mfma_f32_16x16x32_bf16 v[84:87], a[116:119], v[128:131], v[84:87]
    s_waitcnt lgkmcnt(5)
    v_mfma_f32_16x16x32_bf16 v[76:79], a[120:123], v[132:135], v[76:79]
    ds_read_b128 v[116:119], v41 offset:38144
    v_mfma_f32_16x16x32_bf16 v[80:83], a[124:127], v[132:135], v[80:83]
    v_mfma_f32_16x16x32_bf16 v[84:87], a[128:131], v[132:135], v[84:87]
    s_waitcnt lgkmcnt(3)
    v_readfirstlane_b32 s63, v35
    v_mfma_f32_16x16x32_bf16 v[76:79], a[132:135], v[136:139], v[76:79]
    ds_read_b128 v[120:123], v42 offset:38016
    v_mfma_f32_16x16x32_bf16 v[80:83], a[136:139], v[136:139], v[80:83]
    buffer_store_dwordx2 v[12:13], v22, s[20:23], s74 offen sc1
    v_mfma_f32_16x16x32_bf16 v[84:87], a[140:143], v[136:139], v[84:87]
    s_waitcnt lgkmcnt(2)
    v_mfma_f32_16x16x32_bf16 v[76:79], a[144:147], v[140:143], v[76:79]
    ds_read_b128 v[124:127], v42 offset:38080
    v_mfma_f32_16x16x32_bf16 v[80:83], a[148:151], v[140:143], v[80:83]
    v_mfma_f32_16x16x32_bf16 v[84:87], a[152:155], v[140:143], v[84:87]
    buffer_store_dwordx2 v[14:15], v22, s[20:23], s75 offen sc1
    v_mfma_f32_16x16x32_bf16 v[76:79], a[156:159], v[112:115], v[76:79]
    ds_read_b128 v[128:131], v42 offset:38144
    v_mfma_f32_16x16x32_bf16 v[80:83], a[160:163], v[112:115], v[80:83]
    v_mfma_f32_16x16x32_bf16 v[84:87], a[164:167], v[112:115], v[84:87]
    s_waitcnt lgkmcnt(2)
    v_mfma_f32_16x16x32_bf16 v[76:79], a[168:171], v[116:119], v[76:79]
    ds_read_b128 v[132:135], v40 offset:41472
    v_mfma_f32_16x16x32_bf16 v[80:83], a[172:175], v[116:119], v[80:83]
    v_mfma_f32_16x16x32_bf16 v[84:87], a[176:179], v[116:119], v[84:87]
    v_mfma_f32_16x16x32_bf16 v[76:79], a[180:183], v[120:123], v[76:79]
    ds_read_b128 v[136:139], v40 offset:41536
    v_mfma_f32_16x16x32_bf16 v[80:83], a[184:187], v[120:123], v[80:83]
    v_mfma_f32_16x16x32_bf16 v[84:87], a[188:191], v[120:123], v[84:87]
    s_waitcnt lgkmcnt(2)
    v_mfma_f32_16x16x32_bf16 v[76:79], a[192:195], v[124:127], v[76:79]
    ds_read_b128 v[140:143], v40 offset:41600
    v_mfma_f32_16x16x32_bf16 v[80:83], a[196:199], v[124:127], v[80:83]
    v_mfma_f32_16x16x32_bf16 v[84:87], a[200:203], v[124:127], v[84:87]
    v_mfma_f32_16x16x32_bf16 v[76:79], a[204:207], v[128:131], v[76:79]
    ds_read_b128 v[112:115], v41 offset:41472
    v_mfma_f32_16x16x32_bf16 v[80:83], a[208:211], v[128:131], v[80:83]
    v_mfma_f32_16x16x32_bf16 v[84:87], a[212:215], v[128:131], v[84:87]
    s_waitcnt lgkmcnt(2)
    v_mfma_f32_16x16x32_bf16 v[76:79], a[216:219], v[132:135], v[76:79]
    ds_read_b128 v[116:119], v41 offset:41536
    v_mfma_f32_16x16x32_bf16 v[80:83], a[220:223], v[132:135], v[80:83]
    v_mfma_f32_16x16x32_bf16 v[84:87], a[224:227], v[132:135], v[84:87]
    v_mfma_f32_16x16x32_bf16 v[76:79], a[228:231], v[136:139], v[76:79]
    ds_read_b128 v[120:123], v41 offset:41600
    v_mfma_f32_16x16x32_bf16 v[80:83], a[232:235], v[136:139], v[80:83]
    v_mfma_f32_16x16x32_bf16 v[84:87], a[236:239], v[136:139], v[84:87]
    s_waitcnt lgkmcnt(2)
    v_mfma_f32_16x16x32_bf16 v[76:79], a[240:243], v[140:143], v[76:79]
    ds_read_b128 v[124:127], v42 offset:41472
    v_mfma_f32_16x16x32_bf16 v[80:83], a[244:247], v[140:143], v[80:83]
    v_mfma_f32_16x16x32_bf16 v[84:87], a[248:251], v[140:143], v[84:87]
    v_mfma_f32_16x16x32_bf16 v[76:79], a[252:255], v[112:115], v[76:79]
    ds_read_b128 v[128:131], v42 offset:41536
    v_mfma_f32_16x16x32_bf16 v[80:83], v[188:191], v[112:115], v[80:83]
    v_mfma_f32_16x16x32_bf16 v[84:87], v[192:195], v[112:115], v[84:87]
    s_waitcnt lgkmcnt(2)
    v_mfma_f32_16x16x32_bf16 v[76:79], v[196:199], v[116:119], v[76:79]
    ds_read_b128 v[132:135], v42 offset:41600
    v_mfma_f32_16x16x32_bf16 v[80:83], v[200:203], v[116:119], v[80:83]
    v_mfma_f32_16x16x32_bf16 v[84:87], v[204:207], v[116:119], v[84:87]
    v_mfma_f32_16x16x32_bf16 v[76:79], v[208:211], v[120:123], v[76:79]
    ds_read_b128 v[136:139], v40 offset:41472
    v_mfma_f32_16x16x32_bf16 v[80:83], v[212:215], v[120:123], v[80:83]
    v_mfma_f32_16x16x32_bf16 v[84:87], v[216:219], v[120:123], v[84:87]
    s_waitcnt lgkmcnt(2)
    v_mfma_f32_16x16x32_bf16 v[76:79], v[220:223], v[124:127], v[76:79]
    ds_read_b128 v[140:143], v40 offset:41536
    v_mfma_f32_16x16x32_bf16 v[80:83], v[224:227], v[124:127], v[80:83]
    v_mfma_f32_16x16x32_bf16 v[84:87], v[228:231], v[124:127], v[84:87]
    v_mfma_f32_16x16x32_bf16 v[76:79], v[232:235], v[128:131], v[76:79]
    ds_read_b128 v[112:115], v40 offset:41600
    v_mfma_f32_16x16x32_bf16 v[80:83], v[236:239], v[128:131], v[80:83]
    v_mfma_f32_16x16x32_bf16 v[84:87], v[240:243], v[128:131], v[84:87]
    s_waitcnt lgkmcnt(2)
    v_mfma_f32_16x16x32_bf16 v[76:79], v[244:247], v[132:135], v[76:79]
    ds_read_b128 v[116:119], v41 offset:41472
    v_mfma_f32_16x16x32_bf16 v[80:83], v[248:251], v[132:135], v[80:83]
    v_mfma_f32_16x16x32_bf16 v[84:87], v[252:255], v[132:135], v[84:87]
    v_mfma_f32_16x16x32_bf16 v[88:91], a[0:3], v[136:139], 0
    ds_read_b128 v[120:123], v41 offset:41536
    v_mfma_f32_16x16x32_bf16 v[92:95], a[4:7], v[136:139], 0
    v_mfma_f32_16x16x32_bf16 v[96:99], a[8:11], v[136:139], 0
    s_waitcnt lgkmcnt(2)
    v_cvt_pk_bf16_f32 v76, v76, v77
    v_cvt_pk_bf16_f32 v77, v78, v79
    v_mfma_f32_16x16x32_bf16 v[88:91], a[12:15], v[140:143], v[88:91]
    ds_read_b128 v[124:127], v41 offset:41600
    v_cvt_pk_bf16_f32 v78, v80, v81
    v_mfma_f32_16x16x32_bf16 v[92:95], a[16:19], v[140:143], v[92:95]
    v_cvt_pk_bf16_f32 v79, v82, v83
    v_cvt_pk_bf16_f32 v84, v84, v85
    v_mfma_f32_16x16x32_bf16 v[96:99], a[20:23], v[140:143], v[96:99]
    v_permlane16_swap_b32 v76, v78
    v_mfma_f32_16x16x32_bf16 v[88:91], a[24:27], v[112:115], v[88:91]
    ds_read_b128 v[128:131], v42 offset:41472
    v_cvt_pk_bf16_f32 v85, v86, v87
    v_mfma_f32_16x16x32_bf16 v[92:95], a[28:31], v[112:115], v[92:95]
    v_permlane16_swap_b32 v77, v79
    v_mfma_f32_16x16x32_bf16 v[96:99], a[32:35], v[112:115], v[96:99]
    s_waitcnt lgkmcnt(2)
    ds_write_b64 v38, v[84:85] offset:10240
    v_mfma_f32_16x16x32_bf16 v[88:91], a[36:39], v[116:119], v[88:91]
    ds_read_b128 v[132:135], v42 offset:41536
    v_mfma_f32_16x16x32_bf16 v[92:95], a[40:43], v[116:119], v[92:95]
    buffer_store_dwordx4 v[76:79], v21, s[20:23], s76 offen sc1
    v_mfma_f32_16x16x32_bf16 v[96:99], a[44:47], v[116:119], v[96:99]
    v_mfma_f32_16x16x32_bf16 v[88:91], a[48:51], v[120:123], v[88:91]
    ds_read_b128 v[136:139], v42 offset:41600
    v_mfma_f32_16x16x32_bf16 v[92:95], a[52:55], v[120:123], v[92:95]
    v_mfma_f32_16x16x32_bf16 v[96:99], a[56:59], v[120:123], v[96:99]
    s_waitcnt lgkmcnt(2)
    v_mfma_f32_16x16x32_bf16 v[88:91], a[60:63], v[124:127], v[88:91]
    ds_read_b128 v[140:143], v40 offset:44928
    v_mfma_f32_16x16x32_bf16 v[92:95], a[64:67], v[124:127], v[92:95]
    v_mfma_f32_16x16x32_bf16 v[96:99], a[68:71], v[124:127], v[96:99]
    v_mfma_f32_16x16x32_bf16 v[88:91], a[72:75], v[128:131], v[88:91]
    ds_read_b128 v[112:115], v40 offset:44992
    v_mfma_f32_16x16x32_bf16 v[92:95], a[76:79], v[128:131], v[92:95]
    v_mfma_f32_16x16x32_bf16 v[96:99], a[80:83], v[128:131], v[96:99]
    s_waitcnt lgkmcnt(2)
    v_mfma_f32_16x16x32_bf16 v[88:91], a[84:87], v[132:135], v[88:91]
    ds_read_b128 v[116:119], v40 offset:45056
    v_mfma_f32_16x16x32_bf16 v[92:95], a[88:91], v[132:135], v[92:95]
    v_mfma_f32_16x16x32_bf16 v[96:99], a[92:95], v[132:135], v[96:99]
    v_mfma_f32_16x16x32_bf16 v[88:91], a[96:99], v[136:139], v[88:91]
    ds_read_b128 v[120:123], v41 offset:44928
    v_mfma_f32_16x16x32_bf16 v[92:95], a[100:103], v[136:139], v[92:95]
    v_mfma_f32_16x16x32_bf16 v[96:99], a[104:107], v[136:139], v[96:99]
    s_waitcnt lgkmcnt(2)
    v_mfma_f32_16x16x32_bf16 v[88:91], a[108:111], v[140:143], v[88:91]
    ds_read_b128 v[124:127], v41 offset:44992
    v_mfma_f32_16x16x32_bf16 v[92:95], a[112:115], v[140:143], v[92:95]
    v_mfma_f32_16x16x32_bf16 v[96:99], a[116:119], v[140:143], v[96:99]
    v_mfma_f32_16x16x32_bf16 v[88:91], a[120:123], v[112:115], v[88:91]
    ds_read_b128 v[128:131], v41 offset:45056
    v_mfma_f32_16x16x32_bf16 v[92:95], a[124:127], v[112:115], v[92:95]
    v_mfma_f32_16x16x32_bf16 v[96:99], a[128:131], v[112:115], v[96:99]
    s_waitcnt lgkmcnt(2)
    v_mfma_f32_16x16x32_bf16 v[88:91], a[132:135], v[116:119], v[88:91]
    ds_read_b128 v[132:135], v42 offset:44928
    v_mfma_f32_16x16x32_bf16 v[92:95], a[136:139], v[116:119], v[92:95]
    v_mfma_f32_16x16x32_bf16 v[96:99], a[140:143], v[116:119], v[96:99]
    v_mfma_f32_16x16x32_bf16 v[88:91], a[144:147], v[120:123], v[88:91]
    ds_read_b128 v[136:139], v42 offset:44992
    v_mfma_f32_16x16x32_bf16 v[92:95], a[148:151], v[120:123], v[92:95]
    v_mfma_f32_16x16x32_bf16 v[96:99], a[152:155], v[120:123], v[96:99]
    s_waitcnt lgkmcnt(2)
    v_mfma_f32_16x16x32_bf16 v[88:91], a[156:159], v[124:127], v[88:91]
    ds_read_b128 v[140:143], v42 offset:45056
    v_mfma_f32_16x16x32_bf16 v[92:95], a[160:163], v[124:127], v[92:95]
    v_mfma_f32_16x16x32_bf16 v[96:99], a[164:167], v[124:127], v[96:99]
    v_mfma_f32_16x16x32_bf16 v[88:91], a[168:171], v[128:131], v[88:91]
    ds_read_b128 v[112:115], v40 offset:48384
    v_mfma_f32_16x16x32_bf16 v[92:95], a[172:175], v[128:131], v[92:95]
    v_mfma_f32_16x16x32_bf16 v[96:99], a[176:179], v[128:131], v[96:99]
    s_waitcnt lgkmcnt(2)
    v_mfma_f32_16x16x32_bf16 v[88:91], a[180:183], v[132:135], v[88:91]
    ds_read_b128 v[116:119], v40 offset:48448
    v_mfma_f32_16x16x32_bf16 v[92:95], a[184:187], v[132:135], v[92:95]
    v_mfma_f32_16x16x32_bf16 v[96:99], a[188:191], v[132:135], v[96:99]
    v_mfma_f32_16x16x32_bf16 v[88:91], a[192:195], v[136:139], v[88:91]
    ds_read_b128 v[120:123], v40 offset:48512
    v_mfma_f32_16x16x32_bf16 v[92:95], a[196:199], v[136:139], v[92:95]
    v_mfma_f32_16x16x32_bf16 v[96:99], a[200:203], v[136:139], v[96:99]
    s_waitcnt lgkmcnt(2)
    v_mfma_f32_16x16x32_bf16 v[88:91], a[204:207], v[140:143], v[88:91]
    ds_read_b128 v[124:127], v41 offset:48384
    v_mfma_f32_16x16x32_bf16 v[92:95], a[208:211], v[140:143], v[92:95]
    ds_read_b128 v[128:131], v41 offset:48448
    v_mfma_f32_16x16x32_bf16 v[96:99], a[212:215], v[140:143], v[96:99]
    ds_read_b128 v[132:135], v41 offset:48512
    v_mfma_f32_16x16x32_bf16 v[88:91], a[216:219], v[112:115], v[88:91]
    ds_read_b128 v[136:139], v42 offset:48384
    v_mfma_f32_16x16x32_bf16 v[92:95], a[220:223], v[112:115], v[92:95]
    ds_read_b128 v[140:143], v42 offset:48448
    v_mfma_f32_16x16x32_bf16 v[96:99], a[224:227], v[112:115], v[96:99]
    s_waitcnt lgkmcnt(5)
    ds_read_b128 v[112:115], v42 offset:48512
    v_mfma_f32_16x16x32_bf16 v[88:91], a[228:231], v[116:119], v[88:91]
    v_mfma_f32_16x16x32_bf16 v[92:95], a[232:235], v[116:119], v[92:95]
    v_mfma_f32_16x16x32_bf16 v[96:99], a[236:239], v[116:119], v[96:99]
    v_mfma_f32_16x16x32_bf16 v[88:91], a[240:243], v[120:123], v[88:91]
    v_mfma_f32_16x16x32_bf16 v[92:95], a[244:247], v[120:123], v[92:95]
    v_mfma_f32_16x16x32_bf16 v[96:99], a[248:251], v[120:123], v[96:99]
    s_waitcnt lgkmcnt(0)
    v_mfma_f32_16x16x32_bf16 v[96:99], v[192:195], v[124:127], v[96:99]
    v_mfma_f32_16x16x32_bf16 v[96:99], v[204:207], v[128:131], v[96:99]
    v_mfma_f32_16x16x32_bf16 v[96:99], v[216:219], v[132:135], v[96:99]
    v_mfma_f32_16x16x32_bf16 v[96:99], v[228:231], v[136:139], v[96:99]
    v_mfma_f32_16x16x32_bf16 v[96:99], v[240:243], v[140:143], v[96:99]
    v_mfma_f32_16x16x32_bf16 v[96:99], v[252:255], v[112:115], v[96:99]
    s_nop 2
    v_mfma_f32_16x16x32_bf16 v[88:91], a[252:255], v[124:127], v[88:91]
    s_nop 2
    v_mfma_f32_16x16x32_bf16 v[88:91], v[196:199], v[128:131], v[88:91]
    v_cvt_pk_bf16_f32 v96, v96, v97
    v_cvt_pk_bf16_f32 v97, v98, v99
    v_mfma_f32_16x16x32_bf16 v[88:91], v[208:211], v[132:135], v[88:91]
    ds_write_b64 v38, v[96:97] offset:12288
    v_mfma_f32_16x16x32_bf16 v[88:91], v[220:223], v[136:139], v[88:91]
    v_mfma_f32_16x16x32_bf16 v[88:91], v[232:235], v[140:143], v[88:91]
    v_mfma_f32_16x16x32_bf16 v[88:91], v[244:247], v[112:115], v[88:91]
    v_mfma_f32_16x16x32_bf16 v[92:95], v[188:191], v[124:127], v[92:95]
    s_waitcnt lgkmcnt(0)
    s_barrier
    v_mfma_f32_16x16x32_bf16 v[92:95], v[200:203], v[128:131], v[92:95]
    ds_read_b64 v[62:63], v39 offset:10240
    v_mfma_f32_16x16x32_bf16 v[92:95], v[212:215], v[132:135], v[92:95]
    ds_read_b64 v[50:51], v39 offset:12288
    v_mfma_f32_16x16x32_bf16 v[92:95], v[224:227], v[136:139], v[92:95]
    v_mfma_f32_16x16x32_bf16 v[92:95], v[236:239], v[140:143], v[92:95]
    v_cvt_pk_bf16_f32 v88, v88, v89
    v_cvt_pk_bf16_f32 v89, v90, v91
    v_mfma_f32_16x16x32_bf16 v[92:95], v[248:251], v[112:115], v[92:95]
    s_waitcnt lgkmcnt(0)
    buffer_store_dwordx2 v[62:63], v22, s[20:23], s76 offen sc1
    buffer_store_dwordx2 v[50:51], v22, s[20:23], s77 offen sc1
    s_nop 4
    v_cvt_pk_bf16_f32 v90, v92, v93
    v_cvt_pk_bf16_f32 v91, v94, v95
    s_nop 0
    v_permlane16_swap_b32 v88, v90
    v_permlane16_swap_b32 v89, v91
    buffer_store_dwordx4 v[88:91], v21, s[20:23], s77 offen sc1
L_check:
    s_cmp_lg_u32 s63, 0
    s_cbranch_scc1 L_slow
    s_endpgm
L_x_end:
L_more:
    ds_read2_b32 v[176:177], v24 offset0:64 offset1:96
    ds_read_b64 v[178:179], v25 offset:264
    s_waitcnt lgkmcnt(0)
    v_xor_b32 v172, v176, v26
    v_xor_b32 v174, v177, v26
    v_xor_b32 v173, v176, v27
    v_xor_b32 v175, v177, v27
    ds_read_b64_tr_b16 v[144:145], v172 offset:0
    ds_read_b64_tr_b16 v[146:147], v174 offset:0
    ds_read_b64_tr_b16 v[148:149], v173 offset:0
    ds_read_b64_tr_b16 v[150:151], v175 offset:0
    ds_read_b64_tr_b16 v[152:153], v172 offset:64
    ds_read_b64_tr_b16 v[154:155], v174 offset:64
    v_cndmask_b32 v169, 0, v179, s[88:89]
    v_cndmask_b32 v171, 0, v179, s[92:93]
    v_cndmask_b32 v168, 0, v178, s[88:89]
    v_cndmask_b32 v170, 0, v178, s[92:93]
    v_cndmask_b32 v169, v169, v178, s[90:91]
    v_cndmask_b32 v171, v171, v178, s[94:95]
    ds_read_b64_tr_b16 v[156:157], v173 offset:64
    ds_read_b64_tr_b16 v[158:159], v175 offset:64
    ds_read_b64_tr_b16 v[160:161], v172 offset:128
    ds_read_b64_tr_b16 v[162:163], v174 offset:128
    ds_read_b64_tr_b16 v[164:165], v173 offset:128
    ds_read_b64_tr_b16 v[166:167], v175 offset:128
    s_waitcnt lgkmcnt(0)
    v_mfma_f32_16x16x32_bf16 v[144:147], v[144:147], v[168:171], 0
    v_mfma_f32_16x16x32_bf16 v[148:151], v[148:151], v[168:171], 0
    v_mfma_f32_16x16x32_bf16 v[152:155], v[152:155], v[168:171], 0
    v_mfma_f32_16x16x32_bf16 v[156:159], v[156:159], v[168:171], 0
    v_mfma_f32_16x16x32_bf16 v[160:163], v[160:163], v[168:171], 0
    v_mfma_f32_16x16x32_bf16 v[164:167], v[164:167], v[168:171], 0
    s_nop 3
    v_cvt_pk_bf16_f32 v144, v144, v145
    v_cvt_pk_bf16_f32 v145, v146, v147
    ds_write_b64 v28, v[144:145] offset:12288
    v_cvt_pk_bf16_f32 v148, v148, v149
    v_cvt_pk_bf16_f32 v149, v150, v151
    ds_write_b64 v29, v[148:149] offset:12288
    v_cvt_pk_bf16_f32 v152, v152, v153
    v_cvt_pk_bf16_f32 v153, v154, v155
    ds_write_b64 v28, v[152:153] offset:12352
    v_cvt_pk_bf16_f32 v156, v156, v157
    v_cvt_pk_bf16_f32 v157, v158, v159
    ds_write_b64 v29, v[156:157] offset:12352
    v_cvt_pk_bf16_f32 v160, v160, v161
    v_cvt_pk_bf16_f32 v161, v162, v163
    ds_write_b64 v28, v[160:161] offset:12416
    v_cvt_pk_bf16_f32 v164, v164, v165
    v_cvt_pk_bf16_f32 v165, v166, v167
    ds_write_b64 v29, v[164:165] offset:12416
    s_waitcnt lgkmcnt(0)
    s_branch L_more_back
L_hot_end:
L_bfail1:
    v_mov_b32 v163, s60
    ds_write_b32 v110, v163 offset:4
    s_mov_b64 s[80:81], 0
    s_mov_b64 s[88:89], 0
    s_mov_b64 s[82:83], 0
    s_mov_b64 s[90:91], 0
    s_mov_b64 s[84:85], 0
    s_mov_b64 s[92:93], 0
    s_mov_b64 s[86:87], 0
    s_mov_b64 s[94:95], 0
    s_mov_b64 s[98:99], 0
    s_mov_b32 s62, 0
    s_branch L_bfail1_back
L_bfail2:
    v_mov_b32 v144, s38
    ds_or_b32 v34, v144
    s_branch L_bfail2_back
L_afailX:
    v_mul_u32_u24 v32, 1821, v0
    v_lshrrev_b32 v32, 16, v32
    v_lshlrev_b32 v32, v32, 1
    v_lshlrev_b32 v33, 7, v32
    s_mov_b64 exec, s[80:81]
    ds_or_b32 v34, v32
    s_mov_b64 exec, s[82:83]
    ds_or_b32 v34, v33
    s_mov_b64 exec, -1
    s_waitcnt lgkmcnt(0)
    s_branch L_afailX_back
L_afailY:
    v_mul_u32_u24 v32, 1821, v0
    v_lshrrev_b32 v32, 16, v32
    v_lshlrev_b32 v32, v32, 1
    v_lshlrev_b32 v33, 7, v32
    s_mov_b64 exec, s[80:81]
    ds_or_b32 v34, v32
    s_mov_b64 exec, s[82:83]
    ds_or_b32 v34, v33
    s_mov_b64 exec, -1
    s_waitcnt lgkmcnt(0)
    s_branch L_afailY_back
L_slow:
    s_waitcnt vmcnt(0) lgkmcnt(0)
    s_barrier
    s_ff1_i32_b32 s80, s63
    s_bitset0_b32 s63, s80
    s_mul_i32 s81, s80, 224
    s_add_u32 s81, s81, s45
    s_mov_b32 s82, 1
    s_cmp_lt_u32 s80, 16
    s_cbranch_scc1 L_s1
    s_bfe_u32 s40, s80, 0x10002
    s_add_u32 s40, s40, s53
    s_and_b32 s41, s80, 3
    s_lshl_b32 s41, s41, 4
    s_cmp_eq_u32 s47, 0
    s_cselect_b32 s82, 1, 224
    s_cselect_b32 s81, 224, 1
    s_mul_i32 s81, s81, s40
    s_mul_i32 s41, s41, s82
    s_add_u32 s81, s81, s41
L_s1:
    s_movk_i32 s43, 224
    v_mul_u32_u24 v79, s82, v2
    v_lshl_add_u32 v49, s2, 2, v3
    v_lshl_add_u32 v49, v49, 3, 64
    v_mad_u32_u24 v49, v79, s42, v49
    v_add_u32 v79, s81, v79
    v_lshrrev_b32 v80, 4, v0
    v_min_u32 v80, 8, v80
    v_mul_u32_u24 v85, 36, v79
    v_lshl_add_u32 v85, v80, 2, v85
    buffer_load_dword v85, v85, s[12:15], 0 offen
    v_mul_u32_u24 v81, 74899, v79
    v_lshrrev_b32 v81, 24, v81
    v_mul_u32_u24 v82, 224, v81
    v_sub_u32 v82, v79, v82
    v_mul_u32_u24 v83, 11, v80
    v_lshrrev_b32 v83, 5, v83
    v_mad_i32_i24 v84, v83, -3, v80
    v_add3_u32 v81, v81, v83, -1
    v_add3_u32 v82, v82, v84, -1
    v_cvt_f32_i32 v81, v81
    v_cvt_f32_i32 v82, v82
    s_waitcnt vmcnt(0)
    v_lshlrev_b32 v65, 16, v85
    v_and_b32 v66, 0xffff0000, v85
    v_add_f32 v65, v81, v65
    v_add_f32 v66, v82, v66
    v_cvt_pk_bf16_f32 v64, v65, v66
    v_pk_max_i16 v64, v64, 0
    v_pk_min_i16 v64, v64, s60
    v_lshlrev_b32 v65, 16, v64
    v_and_b32 v66, 0xffff0000, v64
    v_fract_f32 v71, v65
    v_fract_f32 v72, v66
    v_ceil_f32 v68, v65
    v_ceil_f32 v70, v66
    v_sub_f32 v73, 1.0, v71
    v_sub_f32 v74, 1.0, v72
    v_cvt_u32_f32 v67, v65
    v_cvt_u32_f32 v69, v66
    v_cvt_pk_bf16_f32 v74, v73, v74
    v_cvt_u32_f32 v68, v68
    v_cvt_u32_f32 v70, v70
    v_lshlrev_b32 v73, 16, v74
    v_and_b32 v74, 0xffff0000, v74
    v_mul_f32 v78, v71, v72
    v_mul_f32 v76, v73, v72
    v_mul_f32 v77, v71, v74
    v_mul_f32 v75, v73, v74
    v_mad_u32_u24 v88, v67, s43, v69
    v_mul_u32_u24 v88, 192, v88
    v_mad_u32_u24 v89, v67, s43, v70
    v_mul_u32_u24 v89, 192, v89
    v_mad_u32_u24 v90, v68, s43, v69
    v_mul_u32_u24 v90, 192, v90
    v_mad_u32_u24 v91, v68, s43, v70
    v_mul_u32_u24 v91, 192, v91
    v_cvt_pk_bf16_f32 v92, v75, v76
    v_cvt_pk_bf16_f32 v93, v77, v78
    v_lshlrev_b32 v79, 5, v0
    v_add_u32 v79, 61440, v79
    ds_write_b128 v79, v[88:91]
    ds_write_b64 v79, v[92:93] offset:16
    s_mov_b32 s83, 0
    s_waitcnt lgkmcnt(0)
    s_barrier
L_s2:
    s_add_u32 s40, s83, 0
    v_add_u32 v96, s40, v0
    v_mul_u32_u24 v70, 5462, v96
    v_lshrrev_b32 v70, 16, v70
    v_mad_i32_i24 v71, v70, -12, v96
    v_lshlrev_b32 v70, 5, v70
    v_add_u32 v70, 61440, v70
    ds_read_b128 v[64:67], v70
    ds_read_b64 v[68:69], v70 offset:16
    v_lshlrev_b32 v96, 4, v96
    s_add_u32 s40, s83, 256
    v_add_u32 v97, s40, v0
    v_mul_u32_u24 v78, 5462, v97
    v_lshrrev_b32 v78, 16, v78
    v_mad_i32_i24 v79, v78, -12, v97
    v_lshlrev_b32 v78, 5, v78
    v_add_u32 v78, 61440, v78
    ds_read_b128 v[72:75], v78
    ds_read_b64 v[76:77], v78 offset:16
    v_lshlrev_b32 v97, 4, v97
    s_add_u32 s40, s83, 512
    v_add_u32 v98, s40, v0
    v_mul_u32_u24 v86, 5462, v98
    v_lshrrev_b32 v86, 16, v86
    v_mad_i32_i24 v87, v86, -12, v98
    v_lshlrev_b32 v86, 5, v86
    v_add_u32 v86, 61440, v86
    ds_read_b128 v[80:83], v86
    ds_read_b64 v[84:85], v86 offset:16
    v_lshlrev_b32 v98, 4, v98
    s_add_u32 s40, s83, 768
    v_add_u32 v99, s40, v0
    v_mul_u32_u24 v94, 5462, v99
    v_lshrrev_b32 v94, 16, v94
    v_mad_i32_i24 v95, v94, -12, v99
    v_lshlrev_b32 v94, 5, v94
    v_add_u32 v94, 61440, v94
    ds_read_b128 v[88:91], v94
    ds_read_b64 v[92:93], v94 offset:16
    v_lshlrev_b32 v99, 4, v99
    s_waitcnt lgkmcnt(0)
    v_lshl_add_u32 v64, v71, 4, v64
    buffer_load_dwordx4 v[100:103], v64, s[8:11], 0 offen
    v_lshl_add_u32 v65, v71, 4, v65
    buffer_load_dwordx4 v[104:107], v65, s[8:11], 0 offen
    v_lshl_add_u32 v66, v71, 4, v66
    buffer_load_dwordx4 v[108:111], v66, s[8:11], 0 offen
    v_lshl_add_u32 v67, v71, 4, v67
    buffer_load_dwordx4 v[112:115], v67, s[8:11], 0 offen
    v_lshl_add_u32 v72, v79, 4, v72
    buffer_load_dwordx4 v[116:119], v72, s[8:11], 0 offen
    v_lshl_add_u32 v73, v79, 4, v73
    buffer_load_dwordx4 v[120:123], v73, s[8:11], 0 offen
    v_lshl_add_u32 v74, v79, 4, v74
    buffer_load_dwordx4 v[124:127], v74, s[8:11], 0 offen
    v_lshl_add_u32 v75, v79, 4, v75
    buffer_load_dwordx4 v[128:131], v75, s[8:11], 0 offen
    v_lshl_add_u32 v80, v87, 4, v80
    buffer_load_dwordx4 v[132:135], v80, s[8:11], 0 offen
    v_lshl_add_u32 v81, v87, 4, v81
    buffer_load_dwordx4 v[136:139], v81, s[8:11], 0 offen
    v_lshl_add_u32 v82, v87, 4, v82
    buffer_load_dwordx4 v[140:143], v82, s[8:11], 0 offen
    v_lshl_add_u32 v83, v87, 4, v83
    buffer_load_dwordx4 v[144:147], v83, s[8:11], 0 offen
    v_lshl_add_u32 v88, v95, 4, v88
    buffer_load_dwordx4 v[148:151], v88, s[8:11], 0 offen
    v_lshl_add_u32 v89, v95, 4, v89
    buffer_load_dwordx4 v[152:155], v89, s[8:11], 0 offen
    v_lshl_add_u32 v90, v95, 4, v90
    buffer_load_dwordx4 v[156:159], v90, s[8:11], 0 offen
    v_lshl_add_u32 v91, v95, 4, v91
    buffer_load_dwordx4 v[160:163], v91, s[8:11], 0 offen
    s_waitcnt vmcnt(12)
    v_lshlrev_b32 v172, 16, v68
    v_lshlrev_b32 v173, 16, v100
    v_and_b32 v174, 0xffff0000, v100
    v_mul_f32 v164, v172, v173
    v_mul_f32 v165, v172, v174
    v_lshlrev_b32 v173, 16, v101
    v_and_b32 v174, 0xffff0000, v101
    v_mul_f32 v166, v172, v173
    v_mul_f32 v167, v172, v174
    v_lshlrev_b32 v173, 16, v102
    v_and_b32 v174, 0xffff0000, v102
    v_mul_f32 v168, v172, v173
    v_mul_f32 v169, v172, v174
    v_lshlrev_b32 v173, 16, v103
    v_and_b32 v174, 0xffff0000, v103
    v_mul_f32 v170, v172, v173
    v_mul_f32 v171, v172, v174
    v_and_b32 v172, 0xffff0000, v68
    v_lshlrev_b32 v173, 16, v104
    v_and_b32 v174, 0xffff0000, v104
    v_fmac_f32 v164, v172, v173
    v_fmac_f32 v165, v172, v174
    v_lshlrev_b32 v173, 16, v105
    v_and_b32 v174, 0xffff0000, v105
    v_fmac_f32 v166, v172, v173
    v_fmac_f32 v167, v172, v174
    v_lshlrev_b32 v173, 16, v106
    v_and_b32 v174, 0xffff0000, v106
    v_fmac_f32 v168, v172, v173
    v_fmac_f32 v169, v172, v174
    v_lshlrev_b32 v173, 16, v107
    v_and_b32 v174, 0xffff0000, v107
    v_fmac_f32 v170, v172, v173
    v_fmac_f32 v171, v172, v174
    v_lshlrev_b32 v172, 16, v69
    v_lshlrev_b32 v173, 16, v108
    v_and_b32 v174, 0xffff0000, v108
    v_fmac_f32 v164, v172, v173
    v_fmac_f32 v165, v172, v174
    v_lshlrev_b32 v173, 16, v109
    v_and_b32 v174, 0xffff0000, v109
    v_fmac_f32 v166, v172, v173
    v_fmac_f32 v167, v172, v174
    v_lshlrev_b32 v173, 16, v110
    v_and_b32 v174, 0xffff0000, v110
    v_fmac_f32 v168, v172, v173
    v_fmac_f32 v169, v172, v174
    v_lshlrev_b32 v173, 16, v111
    v_and_b32 v174, 0xffff0000, v111
    v_fmac_f32 v170, v172, v173
    v_fmac_f32 v171, v172, v174
    v_and_b32 v172, 0xffff0000, v69
    v_lshlrev_b32 v173, 16, v112
    v_and_b32 v174, 0xffff0000, v112
    v_fmac_f32 v164, v172, v173
    v_fmac_f32 v165, v172, v174
    v_lshlrev_b32 v173, 16, v113
    v_and_b32 v174, 0xffff0000, v113
    v_fmac_f32 v166, v172, v173
    v_fmac_f32 v167, v172, v174
    v_lshlrev_b32 v173, 16, v114
    v_and_b32 v174, 0xffff0000, v114
    v_fmac_f32 v168, v172, v173
    v_fmac_f32 v169, v172, v174
    v_lshlrev_b32 v173, 16, v115
    v_and_b32 v174, 0xffff0000, v115
    v_fmac_f32 v170, v172, v173
    v_fmac_f32 v171, v172, v174
    v_cvt_pk_bf16_f32 v176, v164, v165
    v_cvt_pk_bf16_f32 v177, v166, v167
    v_cvt_pk_bf16_f32 v178, v168, v169
    v_cvt_pk_bf16_f32 v179, v170, v171
    ds_write_b128 v96, v[176:179]
    s_waitcnt vmcnt(8)
    v_lshlrev_b32 v172, 16, v76
    v_lshlrev_b32 v173, 16, v116
    v_and_b32 v174, 0xffff0000, v116
    v_mul_f32 v164, v172, v173
    v_mul_f32 v165, v172, v174
    v_lshlrev_b32 v173, 16, v117
    v_and_b32 v174, 0xffff0000, v117
    v_mul_f32 v166, v172, v173
    v_mul_f32 v167, v172, v174
    v_lshlrev_b32 v173, 16, v118
    v_and_b32 v174, 0xffff0000, v118
    v_mul_f32 v168, v172, v173
    v_mul_f32 v169, v172, v174
    v_lshlrev_b32 v173, 16, v119
    v_and_b32 v174, 0xffff0000, v119
    v_mul_f32 v170, v172, v173
    v_mul_f32 v171, v172, v174
    v_and_b32 v172, 0xffff0000, v76
    v_lshlrev_b32 v173, 16, v120
    v_and_b32 v174, 0xffff0000, v120
    v_fmac_f32 v164, v172, v173
    v_fmac_f32 v165, v172, v174
    v_lshlrev_b32 v173, 16, v121
    v_and_b32 v174, 0xffff0000, v121
    v_fmac_f32 v166, v172, v173
    v_fmac_f32 v167, v172, v174
    v_lshlrev_b32 v173, 16, v122
    v_and_b32 v174, 0xffff0000, v122
    v_fmac_f32 v168, v172, v173
    v_fmac_f32 v169, v172, v174
    v_lshlrev_b32 v173, 16, v123
    v_and_b32 v174, 0xffff0000, v123
    v_fmac_f32 v170, v172, v173
    v_fmac_f32 v171, v172, v174
    v_lshlrev_b32 v172, 16, v77
    v_lshlrev_b32 v173, 16, v124
    v_and_b32 v174, 0xffff0000, v124
    v_fmac_f32 v164, v172, v173
    v_fmac_f32 v165, v172, v174
    v_lshlrev_b32 v173, 16, v125
    v_and_b32 v174, 0xffff0000, v125
    v_fmac_f32 v166, v172, v173
    v_fmac_f32 v167, v172, v174
    v_lshlrev_b32 v173, 16, v126
    v_and_b32 v174, 0xffff0000, v126
    v_fmac_f32 v168, v172, v173
    v_fmac_f32 v169, v172, v174
    v_lshlrev_b32 v173, 16, v127
    v_and_b32 v174, 0xffff0000, v127
    v_fmac_f32 v170, v172, v173
    v_fmac_f32 v171, v172, v174
    v_and_b32 v172, 0xffff0000, v77
    v_lshlrev_b32 v173, 16, v128
    v_and_b32 v174, 0xffff0000, v128
    v_fmac_f32 v164, v172, v173
    v_fmac_f32 v165, v172, v174
    v_lshlrev_b32 v173, 16, v129
    v_and_b32 v174, 0xffff0000, v129
    v_fmac_f32 v166, v172, v173
    v_fmac_f32 v167, v172, v174
    v_lshlrev_b32 v173, 16, v130
    v_and_b32 v174, 0xffff0000, v130
    v_fmac_f32 v168, v172, v173
    v_fmac_f32 v169, v172, v174
    v_lshlrev_b32 v173, 16, v131
    v_and_b32 v174, 0xffff0000, v131
    v_fmac_f32 v170, v172, v173
    v_fmac_f32 v171, v172, v174
    v_cvt_pk_bf16_f32 v176, v164, v165
    v_cvt_pk_bf16_f32 v177, v166, v167
    v_cvt_pk_bf16_f32 v178, v168, v169
    v_cvt_pk_bf16_f32 v179, v170, v171
    ds_write_b128 v97, v[176:179]
    s_waitcnt vmcnt(4)
    v_lshlrev_b32 v172, 16, v84
    v_lshlrev_b32 v173, 16, v132
    v_and_b32 v174, 0xffff0000, v132
    v_mul_f32 v164, v172, v173
    v_mul_f32 v165, v172, v174
    v_lshlrev_b32 v173, 16, v133
    v_and_b32 v174, 0xffff0000, v133
    v_mul_f32 v166, v172, v173
    v_mul_f32 v167, v172, v174
    v_lshlrev_b32 v173, 16, v134
    v_and_b32 v174, 0xffff0000, v134
    v_mul_f32 v168, v172, v173
    v_mul_f32 v169, v172, v174
    v_lshlrev_b32 v173, 16, v135
    v_and_b32 v174, 0xffff0000, v135
    v_mul_f32 v170, v172, v173
    v_mul_f32 v171, v172, v174
    v_and_b32 v172, 0xffff0000, v84
    v_lshlrev_b32 v173, 16, v136
    v_and_b32 v174, 0xffff0000, v136
    v_fmac_f32 v164, v172, v173
    v_fmac_f32 v165, v172, v174
    v_lshlrev_b32 v173, 16, v137
    v_and_b32 v174, 0xffff0000, v137
    v_fmac_f32 v166, v172, v173
    v_fmac_f32 v167, v172, v174
    v_lshlrev_b32 v173, 16, v138
    v_and_b32 v174, 0xffff0000, v138
    v_fmac_f32 v168, v172, v173
    v_fmac_f32 v169, v172, v174
    v_lshlrev_b32 v173, 16, v139
    v_and_b32 v174, 0xffff0000, v139
    v_fmac_f32 v170, v172, v173
    v_fmac_f32 v171, v172, v174
    v_lshlrev_b32 v172, 16, v85
    v_lshlrev_b32 v173, 16, v140
    v_and_b32 v174, 0xffff0000, v140
    v_fmac_f32 v164, v172, v173
    v_fmac_f32 v165, v172, v174
    v_lshlrev_b32 v173, 16, v141
    v_and_b32 v174, 0xffff0000, v141
    v_fmac_f32 v166, v172, v173
    v_fmac_f32 v167, v172, v174
    v_lshlrev_b32 v173, 16, v142
    v_and_b32 v174, 0xffff0000, v142
    v_fmac_f32 v168, v172, v173
    v_fmac_f32 v169, v172, v174
    v_lshlrev_b32 v173, 16, v143
    v_and_b32 v174, 0xffff0000, v143
    v_fmac_f32 v170, v172, v173
    v_fmac_f32 v171, v172, v174
    v_and_b32 v172, 0xffff0000, v85
    v_lshlrev_b32 v173, 16, v144
    v_and_b32 v174, 0xffff0000, v144
    v_fmac_f32 v164, v172, v173
    v_fmac_f32 v165, v172, v174
    v_lshlrev_b32 v173, 16, v145
    v_and_b32 v174, 0xffff0000, v145
    v_fmac_f32 v166, v172, v173
    v_fmac_f32 v167, v172, v174
    v_lshlrev_b32 v173, 16, v146
    v_and_b32 v174, 0xffff0000, v146
    v_fmac_f32 v168, v172, v173
    v_fmac_f32 v169, v172, v174
    v_lshlrev_b32 v173, 16, v147
    v_and_b32 v174, 0xffff0000, v147
    v_fmac_f32 v170, v172, v173
    v_fmac_f32 v171, v172, v174
    v_cvt_pk_bf16_f32 v176, v164, v165
    v_cvt_pk_bf16_f32 v177, v166, v167
    v_cvt_pk_bf16_f32 v178, v168, v169
    v_cvt_pk_bf16_f32 v179, v170, v171
    ds_write_b128 v98, v[176:179]
    s_waitcnt vmcnt(0)
    v_lshlrev_b32 v172, 16, v92
    v_lshlrev_b32 v173, 16, v148
    v_and_b32 v174, 0xffff0000, v148
    v_mul_f32 v164, v172, v173
    v_mul_f32 v165, v172, v174
    v_lshlrev_b32 v173, 16, v149
    v_and_b32 v174, 0xffff0000, v149
    v_mul_f32 v166, v172, v173
    v_mul_f32 v167, v172, v174
    v_lshlrev_b32 v173, 16, v150
    v_and_b32 v174, 0xffff0000, v150
    v_mul_f32 v168, v172, v173
    v_mul_f32 v169, v172, v174
    v_lshlrev_b32 v173, 16, v151
    v_and_b32 v174, 0xffff0000, v151
    v_mul_f32 v170, v172, v173
    v_mul_f32 v171, v172, v174
    v_and_b32 v172, 0xffff0000, v92
    v_lshlrev_b32 v173, 16, v152
    v_and_b32 v174, 0xffff0000, v152
    v_fmac_f32 v164, v172, v173
    v_fmac_f32 v165, v172, v174
    v_lshlrev_b32 v173, 16, v153
    v_and_b32 v174, 0xffff0000, v153
    v_fmac_f32 v166, v172, v173
    v_fmac_f32 v167, v172, v174
    v_lshlrev_b32 v173, 16, v154
    v_and_b32 v174, 0xffff0000, v154
    v_fmac_f32 v168, v172, v173
    v_fmac_f32 v169, v172, v174
    v_lshlrev_b32 v173, 16, v155
    v_and_b32 v174, 0xffff0000, v155
    v_fmac_f32 v170, v172, v173
    v_fmac_f32 v171, v172, v174
    v_lshlrev_b32 v172, 16, v93
    v_lshlrev_b32 v173, 16, v156
    v_and_b32 v174, 0xffff0000, v156
    v_fmac_f32 v164, v172, v173
    v_fmac_f32 v165, v172, v174
    v_lshlrev_b32 v173, 16, v157
    v_and_b32 v174, 0xffff0000, v157
    v_fmac_f32 v166, v172, v173
    v_fmac_f32 v167, v172, v174
    v_lshlrev_b32 v173, 16, v158
    v_and_b32 v174, 0xffff0000, v158
    v_fmac_f32 v168, v172, v173
    v_fmac_f32 v169, v172, v174
    v_lshlrev_b32 v173, 16, v159
    v_and_b32 v174, 0xffff0000, v159
    v_fmac_f32 v170, v172, v173
    v_fmac_f32 v171, v172, v174
    v_and_b32 v172, 0xffff0000, v93
    v_lshlrev_b32 v173, 16, v160
    v_and_b32 v174, 0xffff0000, v160
    v_fmac_f32 v164, v172, v173
    v_fmac_f32 v165, v172, v174
    v_lshlrev_b32 v173, 16, v161
    v_and_b32 v174, 0xffff0000, v161
    v_fmac_f32 v166, v172, v173
    v_fmac_f32 v167, v172, v174
    v_lshlrev_b32 v173, 16, v162
    v_and_b32 v174, 0xffff0000, v162
    v_fmac_f32 v168, v172, v173
    v_fmac_f32 v169, v172, v174
    v_lshlrev_b32 v173, 16, v163
    v_and_b32 v174, 0xffff0000, v163
    v_fmac_f32 v170, v172, v173
    v_fmac_f32 v171, v172, v174
    v_cvt_pk_bf16_f32 v176, v164, v165
    v_cvt_pk_bf16_f32 v177, v166, v167
    v_cvt_pk_bf16_f32 v178, v168, v169
    v_cvt_pk_bf16_f32 v179, v170, v171
    ds_write_b128 v99, v[176:179]
    s_add_u32 s83, s83, 1024
    s_cmp_lt_u32 s83, 1728
    s_cbranch_scc1 L_s2
    s_waitcnt lgkmcnt(0)
    s_barrier
    s_cmp_ge_u32 s3, 2
    s_cbranch_scc1 L_s3
    v_mad_u32_u24 v40, v2, s42, v4
    ds_read_b128 v[112:115], v40 offset:0
    ds_read_b128 v[116:119], v40 offset:64
    ds_read_b128 v[120:123], v40 offset:128
    s_waitcnt lgkmcnt(0)
    v_mfma_f32_16x16x32_bf16 v[64:67], a[0:3], v[112:115], 0
    v_mfma_f32_16x16x32_bf16 v[68:71], a[4:7], v[112:115], 0
    v_mfma_f32_16x16x32_bf16 v[72:75], a[8:11], v[112:115], 0
    v_mfma_f32_16x16x32_bf16 v[64:67], a[12:15], v[116:119], v[64:67]
    v_mfma_f32_16x16x32_bf16 v[68:71], a[16:19], v[116:119], v[68:71]
    v_mfma_f32_16x16x32_bf16 v[72:75], a[20:23], v[116:119], v[72:75]
    v_mfma_f32_16x16x32_bf16 v[64:67], a[24:27], v[120:123], v[64:67]
    v_mfma_f32_16x16x32_bf16 v[68:71], a[28:31], v[120:123], v[68:71]
    v_mfma_f32_16x16x32_bf16 v[72:75], a[32:35], v[120:123], v[72:75]
    s_nop 1
    ds_read_b128 v[112:115], v40 offset:3072
    ds_read_b128 v[116:119], v40 offset:3136
    ds_read_b128 v[120:123], v40 offset:3200
    s_waitcnt lgkmcnt(0)
    v_mfma_f32_16x16x32_bf16 v[64:67], a[36:39], v[112:115], v[64:67]
    v_mfma_f32_16x16x32_bf16 v[68:71], a[40:43], v[112:115], v[68:71]
    v_mfma_f32_16x16x32_bf16 v[72:75], a[44:47], v[112:115], v[72:75]
    v_mfma_f32_16x16x32_bf16 v[64:67], a[48:51], v[116:119], v[64:67]
    v_mfma_f32_16x16x32_bf16 v[68:71], a[52:55], v[116:119], v[68:71]
    v_mfma_f32_16x16x32_bf16 v[72:75], a[56:59], v[116:119], v[72:75]
    v_mfma_f32_16x16x32_bf16 v[64:67], a[60:63], v[120:123], v[64:67]
    v_mfma_f32_16x16x32_bf16 v[68:71], a[64:67], v[120:123], v[68:71]
    v_mfma_f32_16x16x32_bf16 v[72:75], a[68:71], v[120:123], v[72:75]
    s_nop 1
    ds_read_b128 v[112:115], v40 offset:6144
    ds_read_b128 v[116:119], v40 offset:6208
    ds_read_b128 v[120:123], v40 offset:6272
    s_waitcnt lgkmcnt(0)
    v_mfma_f32_16x16x32_bf16 v[64:67], a[72:75], v[112:115], v[64:67]
    v_mfma_f32_16x16x32_bf16 v[68:71], a[76:79], v[112:115], v[68:71]
    v_mfma_f32_16x16x32_bf16 v[72:75], a[80:83], v[112:115], v[72:75]
    v_mfma_f32_16x16x32_bf16 v[64:67], a[84:87], v[116:119], v[64:67]
    v_mfma_f32_16x16x32_bf16 v[68:71], a[88:91], v[116:119], v[68:71]
    v_mfma_f32_16x16x32_bf16 v[72:75], a[92:95], v[116:119], v[72:75]
    v_mfma_f32_16x16x32_bf16 v[64:67], a[96:99], v[120:123], v[64:67]
    v_mfma_f32_16x16x32_bf16 v[68:71], a[100:103], v[120:123], v[68:71]
    v_mfma_f32_16x16x32_bf16 v[72:75], a[104:107], v[120:123], v[72:75]
    s_nop 1
    ds_read_b128 v[112:115], v40 offset:9216
    ds_read_b128 v[116:119], v40 offset:9280
    ds_read_b128 v[120:123], v40 offset:9344
    s_waitcnt lgkmcnt(0)
    v_mfma_f32_16x16x32_bf16 v[64:67], a[108:111], v[112:115], v[64:67]
    v_mfma_f32_16x16x32_bf16 v[68:71], a[112:115], v[112:115], v[68:71]
    v_mfma_f32_16x16x32_bf16 v[72:75], a[116:119], v[112:115], v[72:75]
    v_mfma_f32_16x16x32_bf16 v[64:67], a[120:123], v[116:119], v[64:67]
    v_mfma_f32_16x16x32_bf16 v[68:71], a[124:127], v[116:119], v[68:71]
    v_mfma_f32_16x16x32_bf16 v[72:75], a[128:131], v[116:119], v[72:75]
    v_mfma_f32_16x16x32_bf16 v[64:67], a[132:135], v[120:123], v[64:67]
    v_mfma_f32_16x16x32_bf16 v[68:71], a[136:139], v[120:123], v[68:71]
    v_mfma_f32_16x16x32_bf16 v[72:75], a[140:143], v[120:123], v[72:75]
    s_nop 1
    ds_read_b128 v[112:115], v40 offset:12288
    ds_read_b128 v[116:119], v40 offset:12352
    ds_read_b128 v[120:123], v40 offset:12416
    s_waitcnt lgkmcnt(0)
    v_mfma_f32_16x16x32_bf16 v[64:67], a[144:147], v[112:115], v[64:67]
    v_mfma_f32_16x16x32_bf16 v[68:71], a[148:151], v[112:115], v[68:71]
    v_mfma_f32_16x16x32_bf16 v[72:75], a[152:155], v[112:115], v[72:75]
    v_mfma_f32_16x16x32_bf16 v[64:67], a[156:159], v[116:119], v[64:67]
    v_mfma_f32_16x16x32_bf16 v[68:71], a[160:163], v[116:119], v[68:71]
    v_mfma_f32_16x16x32_bf16 v[72:75], a[164:167], v[116:119], v[72:75]
    v_mfma_f32_16x16x32_bf16 v[64:67], a[168:171], v[120:123], v[64:67]
    v_mfma_f32_16x16x32_bf16 v[68:71], a[172:175], v[120:123], v[68:71]
    v_mfma_f32_16x16x32_bf16 v[72:75], a[176:179], v[120:123], v[72:75]
    s_nop 1
    ds_read_b128 v[112:115], v40 offset:15360
    ds_read_b128 v[116:119], v40 offset:15424
    ds_read_b128 v[120:123], v40 offset:15488
    s_waitcnt lgkmcnt(0)
    v_mfma_f32_16x16x32_bf16 v[64:67], a[180:183], v[112:115], v[64:67]
    v_mfma_f32_16x16x32_bf16 v[68:71], a[184:187], v[112:115], v[68:71]
    v_mfma_f32_16x16x32_bf16 v[72:75], a[188:191], v[112:115], v[72:75]
    v_mfma_f32_16x16x32_bf16 v[64:67], a[192:195], v[116:119], v[64:67]
    v_mfma_f32_16x16x32_bf16 v[68:71], a[196:199], v[116:119], v[68:71]
    v_mfma_f32_16x16x32_bf16 v[72:75], a[200:203], v[116:119], v[72:75]
    v_mfma_f32_16x16x32_bf16 v[64:67], a[204:207], v[120:123], v[64:67]
    v_mfma_f32_16x16x32_bf16 v[68:71], a[208:211], v[120:123], v[68:71]
    v_mfma_f32_16x16x32_bf16 v[72:75], a[212:215], v[120:123], v[72:75]
    s_nop 1
    ds_read_b128 v[112:115], v40 offset:18432
    ds_read_b128 v[116:119], v40 offset:18496
    ds_read_b128 v[120:123], v40 offset:18560
    s_waitcnt lgkmcnt(0)
    v_mfma_f32_16x16x32_bf16 v[64:67], a[216:219], v[112:115], v[64:67]
    v_mfma_f32_16x16x32_bf16 v[68:71], a[220:223], v[112:115], v[68:71]
    v_mfma_f32_16x16x32_bf16 v[72:75], a[224:227], v[112:115], v[72:75]
    v_mfma_f32_16x16x32_bf16 v[64:67], a[228:231], v[116:119], v[64:67]
    v_mfma_f32_16x16x32_bf16 v[68:71], a[232:235], v[116:119], v[68:71]
    v_mfma_f32_16x16x32_bf16 v[72:75], a[236:239], v[116:119], v[72:75]
    v_mfma_f32_16x16x32_bf16 v[64:67], a[240:243], v[120:123], v[64:67]
    v_mfma_f32_16x16x32_bf16 v[68:71], a[244:247], v[120:123], v[68:71]
    v_mfma_f32_16x16x32_bf16 v[72:75], a[248:251], v[120:123], v[72:75]
    s_nop 1
    ds_read_b128 v[112:115], v40 offset:21504
    ds_read_b128 v[116:119], v40 offset:21568
    ds_read_b128 v[120:123], v40 offset:21632
    s_waitcnt lgkmcnt(0)
    v_mfma_f32_16x16x32_bf16 v[64:67], a[252:255], v[112:115], v[64:67]
    v_mfma_f32_16x16x32_bf16 v[68:71], v[188:191], v[112:115], v[68:71]
    v_mfma_f32_16x16x32_bf16 v[72:75], v[192:195], v[112:115], v[72:75]
    v_mfma_f32_16x16x32_bf16 v[64:67], v[196:199], v[116:119], v[64:67]
    v_mfma_f32_16x16x32_bf16 v[68:71], v[200:203], v[116:119], v[68:71]
    v_mfma_f32_16x16x32_bf16 v[72:75], v[204:207], v[116:119], v[72:75]
    v_mfma_f32_16x16x32_bf16 v[64:67], v[208:211], v[120:123], v[64:67]
    v_mfma_f32_16x16x32_bf16 v[68:71], v[212:215], v[120:123], v[68:71]
    v_mfma_f32_16x16x32_bf16 v[72:75], v[216:219], v[120:123], v[72:75]
    s_nop 1
    ds_read_b128 v[112:115], v40 offset:24576
    ds_read_b128 v[116:119], v40 offset:24640
    ds_read_b128 v[120:123], v40 offset:24704
    s_waitcnt lgkmcnt(0)
    v_mfma_f32_16x16x32_bf16 v[64:67], v[220:223], v[112:115], v[64:67]
    v_mfma_f32_16x16x32_bf16 v[68:71], v[224:227], v[112:115], v[68:71]
    v_mfma_f32_16x16x32_bf16 v[72:75], v[228:231], v[112:115], v[72:75]
    v_mfma_f32_16x16x32_bf16 v[64:67], v[232:235], v[116:119], v[64:67]
    v_mfma_f32_16x16x32_bf16 v[68:71], v[236:239], v[116:119], v[68:71]
    v_mfma_f32_16x16x32_bf16 v[72:75], v[240:243], v[116:119], v[72:75]
    v_mfma_f32_16x16x32_bf16 v[64:67], v[244:247], v[120:123], v[64:67]
    v_mfma_f32_16x16x32_bf16 v[68:71], v[248:251], v[120:123], v[68:71]
    v_mfma_f32_16x16x32_bf16 v[72:75], v[252:255], v[120:123], v[72:75]
    s_nop 1
    s_mul_i32 s81, s81, 192
    s_cmp_lt_u32 s80, 16
    s_cselect_b64 vcc, -1, 0
    v_cndmask_b32 v40, v21, v19, vcc
    s_nop 5
    v_cvt_pk_bf16_f32 v64, v64, v65
    v_cvt_pk_bf16_f32 v65, v66, v67
    v_cvt_pk_bf16_f32 v66, v68, v69
    v_cvt_pk_bf16_f32 v67, v70, v71
    v_cvt_pk_bf16_f32 v72, v72, v73
    v_cvt_pk_bf16_f32 v73, v74, v75
    v_permlane16_swap_b32 v64, v66
    v_permlane16_swap_b32 v65, v67
    buffer_store_dwordx4 v[64:67], v40, s[20:23], s81 offen sc1
    buffer_store_dwordx2 v[72:73], v49, s[20:23], s81 offen sc1
L_s3:
    s_branch L_check
L_code_end:
L_end:
    s_endpgm
.section .rodata,"a"
.p2align 6
.amdhsa_kernel standalone__deformable_dcnv1__vision_kernel
  .amdhsa_next_free_vgpr 512
  .amdhsa_next_free_sgpr 102
  .amdhsa_accum_offset 256
  .amdhsa_group_segment_fixed_size 0
  .amdhsa_kernarg_size 48
  .amdhsa_user_sgpr_count 2
  .amdhsa_user_sgpr_kernarg_segment_ptr 1
  .amdhsa_system_sgpr_workgroup_id_x 1
  .amdhsa_float_denorm_mode_32 3
.end_amdhsa_kernel
```

```asm
; @launch grid=(256,1,1) block=(256,1,1) lds=159040

.amdgcn_target "amdgcn-amd-amdhsa--gfx950"
.text
.globl standalone__deformable_dcnv1__vision_kernel
.p2align 12
.type standalone__deformable_dcnv1__vision_kernel,@function
standalone__deformable_dcnv1__vision_kernel:
    s_cmpk_ge_u32 s2, 256
    s_cbranch_scc1 L_end
    s_load_dwordx2 s[8:9], s[0:1], 0
    s_load_dwordx2 s[16:17], s[0:1], 16
    s_load_dwordx2 s[12:13], s[0:1], 8
    s_load_dwordx2 s[20:21], s[0:1], 24
    s_getpc_b64 s[6:7]
L_pc:
    s_lshr_b32 s41, s2, 3
    v_lshrrev_b32 v144, 6, v0
    s_mul_i32 s40, s41, 768
    v_lshl_add_u32 v145, v0, 2, s40
    v_readfirstlane_b32 s3, v144
    global_load_dword v37, v145, s[6:7]
    s_and_b32 s85, s2, 7
    s_lshl_b32 s85, s85, 5
    s_add_u32 s85, s85, s41
    s_add_u32 s81, s85, 8
    s_mul_i32 s80, s81, 2731
    s_lshr_b32 s80, s80, 16
    s_mul_i32 s86, s80, 24
    s_sub_u32 s81, s81, s86
    s_cmp_lt_u32 s80, 3
    s_cselect_b32 s82, 16, 20
    s_cselect_b32 s83, 4, 8
    s_cmp_eq_u32 s80, 0
    s_cselect_b32 s82, 8, s82
    s_cselect_b32 s83, 5, s83
    s_cselect_b32 s86, -1, 47
    s_sub_u32 s84, s81, s82
    s_cselect_b32 s46, 0, s83
    s_mul_i32 s44, s81, 6
    s_mul_i32 s40, s84, s46
    s_add_u32 s86, s86, s44
    s_add_u32 s86, s86, s40
    s_mul_i32 s86, s86, 14
    s_add_u32 s44, s86, s80
    s_mulk_i32 s44, 3072
    s_addk_i32 s44, 9024
    v_and_b32 v1, 63, v0
    s_lshl2_add_u32 s41, s41, s3

    s_mulk_i32 s41, 1296
    v_min_u32 v70, 10, v1
    s_lshl_b32 s40, s3, 6
    v_lshl_add_u32 v70, v70, 7, s41
    s_min_u32 s40, s40, 152
    v_add_u32 v144, s40, v1
    s_lshl4_add_u32 s25, s40, 61440
    v_mul_u32_u24 v64, 5462, v144
    v_lshlrev_b32 v144, 4, v144
    v_lshrrev_b32 v64, 13, v64
    v_bitop3_b32 v8, v64, 32, v144 bitop3:0x6a
    v_lshlrev_b32 v5, 4, v1
    v_and_b32 v144, 32, v1
    v_xor_b32 v7, 32, v5
    v_xor_b32 v6, v144, v5
    s_mul_i32 s24, s3, 3072
    s_mov_b32 s41, 43008
    s_mov_b32 s10, 9633792
    s_mov_b32 s11, 0x20000
    s_mov_b32 s18, 165888
    s_mov_b32 s19, s11
    s_add_u32 m0, s24, 24576
    s_waitcnt lgkmcnt(0)
    buffer_load_dword v37, v70, s[16:19], 0 offen
    buffer_load_dwordx4 v5, s[16:19], s24 offen lds
    buffer_load_dwordx4 v6, s[16:19], s24 offen offset:1024 lds
    buffer_load_dwordx4 v7, s[16:19], s24 offen offset:2048 lds
    s_mov_b32 m0, s25
    s_lshr_b32 s57, s3, 1
    buffer_load_dwordx4 v8, s[8:11], s44 offen  lds
    s_addk_i32 m0, 10368
    s_add_u32 s31, s44, 129024
    buffer_load_dwordx4 v8, s[8:11], s31 offen  lds
    s_add_u32 m0, s24, 36864
    s_add_u32 s31, s24, 12288
    buffer_load_dwordx4 v5, s[16:19], s31 offen lds
    buffer_load_dwordx4 v6, s[16:19], s31 offen offset:1024 lds
    buffer_load_dwordx4 v7, s[16:19], s31 offen offset:2048 lds
    s_add_u32 m0, s25, 3456
    s_add_u32 s31, s44, 43008
    buffer_load_dwordx4 v8, s[8:11], s31 offen  lds
    s_addk_i32 m0, 10368
    s_add_u32 s31, s44, 172032
    buffer_load_dwordx4 v8, s[8:11], s31 offen  lds
L_issued:
    v_and_b32 v4, 48, v0
    s_add_u32 s86, s86, s80
    s_and_b32 s2, s3, 1
    s_lshl4_add_u32 s45, s86, 272
    s_mov_b32 s14, 1806336
    s_mov_b32 s15, 0x20000
    s_mov_b32 s22, 9633792
    s_mov_b32 s23, 0x20000
    s_mul_i32 s40, s2, 3072
    s_mul_i32 s26, s57, -104448
    s_add_u32 s26, s26, s40
    s_mul_i32 s27, s57, 6144
    s_add_u32 s27, s27, s40
    s_mul_i32 s28, s57, 55296
    s_add_u32 s28, s28, s40
    s_cmp_eq_u32 s46, 8
    s_cbranch_scc1 L_x
    v_mul_u32_u24 v65, 7282, v1
    s_mul_i32 s85, s82, s80
    s_mul_i32 s86, s83, 3
    v_lshrrev_b32 v65, 16, v65
    s_add_u32 s85, s85, s81
    s_sub_u32 s85, s85, s86
    v_mad_i32_i24 v66, v65, -9, v1
    s_cmp_ge_i32 s85, 92
    s_cselect_b32 s86, -168, 40
    s_cselect_b32 s47, 1, 0
    s_cselect_b32 s52, 8064, 36
    s_cselect_b32 s41, 36, 8064
    v_lshl_add_u32 v67, v65, 2, s3
    s_lshl1_add_u32 s53, s85, s86
    s_lshl3_add_u32 s86, s80, s84
    s_lshl_b32 s86, s86, 1
    v_lshlrev_b32 v71, 2, v66
    s_cmp_eq_u32 s46, 4
    s_cselect_b32 s53, s86, s53
    s_sub_u32 s86, s84, 1
    v_mad_u32_u24 v71, v67, s52, v71
    s_cmp_eq_u32 s46, 5
    s_cselect_b32 s53, s86, s53
    s_cselect_b32 s86, 0x7f000000, 0
    s_mul_i32 s40, s52, 24
    s_cmp_eq_u32 s46, 0
    s_cselect_b32 s40, s40, 0x7f000000
    s_cselect_b32 s85, 54, 36
    v_cmp_gt_u32 vcc, s85, v1
    v_mov_b32 v146, 0x7f000000
    s_mul_i32 s48, s53, s41
    s_add_u32 s49, s48, s41
    v_cndmask_b32 v71, v146, v71, vcc
    s_add_u32 s50, s48, s40
    s_add_u32 s51, s49, s40
    s_add_u32 s48, s48, s86
    buffer_load_dword v176, v71, s[12:15], s48 offen
    buffer_load_dword v177, v71, s[12:15], s49 offen
    buffer_load_dword v178, v71, s[12:15], s50 offen
    buffer_load_dword v179, v71, s[12:15], s51 offen
    v_and_b32 v2, 15, v0
    s_mul_i32 s54, s47, 42816
    s_addk_i32 s54, 192
    v_mul_u32_u24 v68, 11, v66
    v_lshrrev_b32 v68, 5, v68
    v_mad_i32_i24 v69, v68, -3, v66
    s_mov_b32 s60, 0x435f435f
    s_mov_b32 s59, 0x03020c0c
    s_cmp_eq_u32 s47, 0
    s_cselect_b32 s58, 0x01000c0c, s59
    s_cselect_b32 s59, s59, 0x01000c0c
    s_cselect_b64 vcc, -1, 0
    v_cndmask_b32 v144, v69, v68, vcc
    v_cndmask_b32 v145, v68, v69, vcc
    v_add3_u32 v144, s53, v144, -1
    v_add3_u32 v145, v67, v145, -1
    v_cvt_f32_i32 v100, v144
    v_cvt_f32_i32 v102, v145
    v_add_f32 v101, 1.0, v100
    v_add_f32 v103, 0x41c00000, v102
    s_mov_b32 s40, 0x435f0000
    v_med3_f32 v144, v100, 0, s40
    v_med3_f32 v145, v101, 0, s40
    v_med3_f32 v146, v102, 0, s40
    v_med3_f32 v147, v103, 0, s40
    v_cvt_pk_bf16_f32 v105, v145, v146
    v_cvt_pk_bf16_f32 v104, v144, v146
    v_cvt_pk_bf16_f32 v106, v144, v147
    v_cvt_pk_bf16_f32 v107, v145, v147
    v_mul_u32_u24 v168, 12, v67
    v_readfirstlane_b32 s41, v105
    v_add_lshl_u32 v168, v168, v66, 2
    v_lshlrev_b32 v110, 3, v0
    v_lshlrev_b32 v162, 2, v1
    v_mov_b32 v163, s41
    v_add_u32 v110, 156928, v110
    s_mov_b64 exec, 0
    s_cmp_eq_u32 s3, 0
    s_cbranch_scc1 L_pgY0
    s_cmp_eq_u32 s3, 1
    s_cbranch_scc1 L_pgY1
    s_cmp_eq_u32 s3, 2
    s_cbranch_scc1 L_pgY2
L_retY:
    s_mov_b64 exec, -1
    v_add_u32 v162, 148992, v162
    ds_write_b64 v110, v[162:163]
    s_mul_i32 s40, s57, 3072
    s_add_u32 s40, s40, 146688
    v_mad_u32_u24 v23, v2, 48, s40
    s_sub_u32 s61, 43200, s54
    s_cmp_lt_u32 s45, 14784
    s_cselect_b32 s37, 0, 0x80
    s_cmp_lt_u32 s80, 2
    s_cselect_b32 s40, 0, 0x800000
    s_or_b32 s37, s37, s40
    s_or_b32 s37, s37, 0x3e003e00
    s_mul_i32 s35, s46, 3456
    s_add_u32 s35, s35, 89088
    s_add_u32 s43, s53, s57
    s_mul_i32 s76, s43, s61
    s_cmp_lg_u32 s46, 0
    s_cbranch_scc1 L_mc
    s_mov_b32 s41, 0x7f000000
    s_cmp_lt_u32 s53, 34
    s_cselect_b32 s39, 768, s41
    s_cselect_b32 s33, 6, 4
    s_subb_u32 s32, s53, 1
    s_movk_i32 s34, 9600
    s_movk_i32 s36, 50
    s_mov_b32 s38, 0x770000
    s_lshl_b32 s40, s54, 4
    s_add_u32 s75, s76, s40
    s_add_u32 s74, s75, s40
    s_add_u32 s65, s32, s3
    s_min_u32 s65, s65, 223
    s_mul_i32 s65, s65, s61
    s_add_u32 s67, s65, s40
    s_add_u32 s69, s67, s40
    s_mul_i32 s64, s3, s34
    s_add_u32 s64, s64, s35
    s_add_u32 s66, s64, 3072
    s_add_u32 s68, s64, 6144
    s_sub_u32 s43, s43, s32
    s_mul_i32 s43, s43, s34
    s_add_u32 s77, s43, 0x80015c00
    s_add_u32 s78, s77, 0x400000
    s_add_u32 s79, s77, 0x800000
    s_branch L_mc_back
L_mc:
    s_mov_b32 s39, 0x7f000000
    s_sub_u32 s33, 10, s46
    s_add_u32 s32, s53, s46
    s_sub_u32 s32, s32, 6
    s_max_i32 s32, s32, 0
    s_movk_i32 s34, 3456
    s_movk_i32 s36, 18
    s_mul_i32 s64, s3, 3456
    s_add_u32 s64, s64, 89088
    s_add_u32 s66, s64, 13824
    s_add_u32 s68, s64, 27648
    s_min_u32 s68, s68, 123648
    s_mul_i32 s40, s80, 3072
    s_add_u32 s40, s40, 9599808
    s_add_u32 s69, s3, 8
    s_mul_i32 s65, s69, s61
    s_add_u32 s65, s65, s44
    s_min_u32 s65, s65, s40
    s_add_u32 s41, s44, 516096
    s_min_u32 s41, s41, s40
    s_sub_u32 s40, s69, s46
    s_add_u32 s69, s40, s32
    s_mul_i32 s69, s69, s61
    s_sub_u32 s67, s69, 172032
    s_cmp_lt_u32 s40, 4
    s_cselect_b32 s67, s41, s67
    s_mul_i32 s40, s57, 43008
    s_add_u32 s40, s44, s40
    s_add_u32 s74, s40, 301248
    s_add_u32 s75, s40, 387264
    s_add_u32 s40, s40, 473280
    s_mul_i32 s79, s57, 3456
    s_add_u32 s79, s79, 0x80054e80
    s_add_u32 s78, s79, 6912
    s_add_u32 s41, s79, 13824
    s_sub_u32 s77, s43, s32
    s_mul_i32 s77, s77, 3456
    s_add_u32 s77, s77, s35
    s_cmp_eq_u32 s43, 0
    s_cselect_b32 s43, 0, 0x80000000
    s_or_b32 s77, s77, s43
    s_sub_u32 s38, 21, s46
    s_lshl_b32 s38, s38, 16
    s_sub_u32 s43, s46, s57
    s_cmp_eq_u32 s43, 5
    s_cselect_b32 s76, s40, s76
    s_cselect_b32 s77, s41, s77
L_mc_back:
    v_mov_b32 v84, s79
    s_mov_b32 exec_hi, 0
    v_mov_b32 v84, s78
    s_mov_b32 exec_lo, 0xffff
    v_mov_b32 v84, s77
    s_mov_b64 exec, -1
    v_bfe_u32 v155, v84, 18, 6
    v_and_b32 v148, 0x3ffff, v84
    v_ashrrev_i32 v147, 31, v84
    v_add_lshl_u32 v155, v155, v2, 3
    v_add_u32 v149, s34, v148
    v_mad_i32_i24 v147, v147, s34, v148
    v_add_u32 v154, -8, v155
    v_add_u32 v156, 8, v155
    v_max_i32 v154, 0, v154
    v_and_b32 v144, 32, v154
    v_mad_u32_u24 v144, v154, 24, v144
    v_and_b32 v145, 32, v155
    v_mad_u32_u24 v145, v155, 24, v145
    v_and_b32 v146, 32, v156
    v_mad_u32_u24 v146, v156, 24, v146
    s_cmp_eq_u32 s47, 0
    s_cbranch_scc1 L_notr
    v_swap_b32 v144, v147
    v_swap_b32 v145, v148
    v_swap_b32 v146, v149
L_notr:
    v_add_u32 v88, v147, v144
    v_add_u32 v89, v147, v145
    v_add_u32 v90, v147, v146
    v_add_u32 v91, v148, v144
    v_add_u32 v92, v148, v145
    v_add_u32 v93, v148, v146
    v_add_u32 v94, v149, v144
    v_add_u32 v95, v149, v145
    v_add_u32 v96, v149, v146
    v_mad_u32_u24 v144, v4, 48, v23
    ds_write_b128 v144, v[88:91]
    ds_write_b128 v144, v[92:95] offset:16
    s_add_u32 m0, s25, 6912
    s_add_u32 s31, s44, 86016
    buffer_load_dwordx4 v8, s[8:11], s31 offen  lds
    ds_write_b32 v144, v96 offset:32
    v_lshrrev_b32 v3, 4, v1
    s_movk_i32 s42, 192
    v_mov_b32 v34, 158976
    v_mov_b32 v147, 0
    ds_write_b32 v34, v147
    v_bfe_u32 v144, v1, 2, 2
    s_add_u32 m0, s25, 17280
    s_add_u32 s31, s44, 215040
    buffer_load_dwordx4 v8, s[8:11], s31 offen  lds
    v_lshl_add_u32 v144, v3, 3, v144
    v_lshrrev_b32 v145, 2, v1
    v_mul_u32_u24 v144, 192, v144
    v_bfi_b32 v145, 3, v1, v145
    s_lshl_b32 s40, s2, 5
    v_and_b32 v145, 7, v145
    v_lshl_add_u32 v144, v145, 3, v144
    s_mul_i32 s31, s57, 3456
    s_add_u32 s31, s31, s24
    s_add_u32 m0, s31, 127488
    s_add_u32 s31, s28, 55296
    buffer_load_dwordx4 v5, s[16:19], s31 offen lds
    v_xad_u32 v15, v144, s40, 64
    v_lshl_add_u32 v13, s2, 7, v144
    s_mul_i32 s40, s57, 10368
    v_xor_b32 v14, 32, v13
    s_add_u32 s40, s40, 61440
    s_cmp_eq_u32 s80, 10
    s_cselect_b32 s41, 16, 17
    buffer_load_dwordx4 v6, s[16:19], s31 offen offset:1024 lds
    v_add_u32 v144, 2, v2
    v_add_u32 v147, s40, v4
    v_min_u32 v144, s41, v144
    v_lshl_add_u32 v144, v144, 3, 0
    v_bitop3_b32 v145, v144, 32, v147 bitop3:0x6a
    v_mad_u32_u24 v18, v144, 24, v145
    v_lshl_add_u32 v144, v2, 3, 8
    buffer_load_dwordx4 v7, s[16:19], s31 offen offset:2048 lds
    v_bitop3_b32 v145, v144, 32, v147 bitop3:0x6a
    v_mad_u32_u24 v17, v144, 24, v145
    v_lshl_add_u32 v144, v2, 3, 0
    v_bitop3_b32 v145, v144, 32, v147 bitop3:0x6a
    v_mad_u32_u24 v16, v144, 24, v145
    v_mul_u32_u24 v144, 5462, v1
    s_sub_u32 s40, s54, 192
    s_waitcnt vmcnt(16)
    s_barrier
    s_add_u32 m0, s25, 20736
    s_add_u32 s31, s44, 258048
    buffer_load_dwordx4 v8, s[8:11], s31 offen  lds
    ds_read_b64_tr_b16 a[0:1], v13 offset:24576
    ds_read_b64_tr_b16 a[2:3], v13 offset:25344
    ds_read_b64_tr_b16 a[4:5], v14 offset:24576
    ds_read_b64_tr_b16 a[6:7], v14 offset:25344
    ds_read_b64_tr_b16 a[8:9], v15 offset:24576
    ds_read_b64_tr_b16 a[10:11], v15 offset:25344
    ds_read_b64_tr_b16 a[12:13], v13 offset:30720
    v_lshrrev_b32 v145, 13, v144
    v_bitop3_b32 v145, v145, 32, v5 bitop3:0x6a
    v_mad_u32_u16 v9, v144, s40, v145 op_sel:[1,0,0,0]
    v_add_u32 v146, 349568, v144
    v_lshrrev_b32 v145, 13, v146
    v_bitop3_b32 v145, v145, 32, v5 bitop3:0x6a
    v_mad_u32_u16 v10, v146, s40, v145 op_sel:[1,0,0,0]
    s_add_u32 m0, s25, 24192
    s_add_u32 s31, s44, 301056
    buffer_load_dwordx4 v8, s[8:11], s31 offen  lds
    ds_read_b64_tr_b16 a[14:15], v13 offset:31488
    v_add_u32 v146, 699136, v144
    ds_read_b64_tr_b16 a[16:17], v14 offset:30720
    ds_read_b64_tr_b16 a[18:19], v14 offset:31488
    ds_read_b64_tr_b16 a[20:21], v15 offset:30720
    ds_read_b64_tr_b16 a[22:23], v15 offset:31488
    v_lshrrev_b32 v145, 13, v146
    v_bitop3_b32 v145, v145, 32, v5 bitop3:0x6a
    v_mad_u32_u16 v11, v146, s40, v145 op_sel:[1,0,0,0]
    v_add_u32 v146, 830224, v144
    v_lshrrev_b32 v145, 13, v146
    v_bitop3_b32 v145, v145, 32, v5 bitop3:0x6a
    s_add_u32 m0, s24, 49152
    s_add_u32 s31, s28, 61440
    buffer_load_dwordx4 v5, s[16:19], s31 offen lds
    v_mad_u32_u16 v12, v146, s40, v145 op_sel:[1,0,0,0]
    s_cmp_eq_u32 s46, 0
    s_cselect_b64 vcc, -1, 0
    v_cndmask_b32 v50, v12, v9, vcc
    v_add_u32 v61, 127488, v13
    v_add_u32 v62, 127488, v14
    v_add_u32 v63, 127488, v15
    buffer_load_dwordx4 v6, s[16:19], s31 offen offset:1024 lds
    v_add_u32 v174, 150912, v168
    v_add_u32 v172, 147840, v168
    v_add_u32 v170, 149760, v168
    v_add_u32 v168, 146688, v168
    v_subrev_u32 v108, 36, v1
    v_lshrrev_b32 v108, 31, v108
    v_lshlrev_b32 v111, 4, v0
    buffer_load_dwordx4 v7, s[16:19], s31 offen offset:2048 lds
    v_add_u32 v111, 152832, v111
    v_mul_u32_u24 v41, 192, v2
    v_lshlrev_b32 v40, 2, v2
    v_add_u32 v41, s24, v41
    v_and_or_b32 v109, v40, 48, v41
    v_and_or_b32 v40, v40, 56, v41
    v_mul_u32_u24 v42, 768, v4
    v_xor_b32 v28, v40, v4
    v_add_u32 v109, v109, v42
    v_xor_b32 v29, 8, v28
    s_waitcnt lgkmcnt(0)
    s_waitcnt vmcnt(14)
    s_barrier
    ds_read_b128 v[112:115], v16 offset:0
    ds_read_b128 v[116:119], v16 offset:3456
    ds_read_b128 v[120:123], v16 offset:64
    ds_read_b128 v[124:127], v16 offset:3520
    s_waitcnt lgkmcnt(3)
    v_mfma_f32_16x16x32_bf16 v[64:67], a[0:3], v[112:115], 0
    s_add_u32 m0, s24, 0
    ds_read_b64_tr_b16 a[24:25], v13 offset:36864
    s_add_u32 s31, s28, 67584
    ds_read_b64_tr_b16 a[26:27], v13 offset:37632
    v_mfma_f32_16x16x32_bf16 v[68:71], a[4:7], v[112:115], 0
    s_mul_i32 s56, s46, 36
    ds_read_b64_tr_b16 a[28:29], v14 offset:36864
    buffer_load_dwordx4 v5, s[16:19], s31 offen lds
    v_mfma_f32_16x16x32_bf16 v[72:75], a[8:11], v[112:115], 0
    s_waitcnt lgkmcnt(5)
    ds_read_b64_tr_b16 a[30:31], v14 offset:37632
    s_movk_i32 s5, 7488
    ds_read_b64_tr_b16 a[32:33], v15 offset:36864
    v_mfma_f32_16x16x32_bf16 v[76:79], a[0:3], v[116:119], 0
    s_addk_i32 s56, 215
    ds_read_b64_tr_b16 a[34:35], v15 offset:37632
    v_mul_u32_u24 v30, 1821, v0
    v_mfma_f32_16x16x32_bf16 v[80:83], a[4:7], v[116:119], 0
    s_mul_i32 s55, s45, 36
    ds_read_b128 v[128:131], v16 offset:128
    v_lshlrev_b32 v31, 4, v0
    v_mfma_f32_16x16x32_bf16 v[84:87], a[8:11], v[116:119], 0
    s_waitcnt vmcnt(11) lgkmcnt(7)
    ds_read_b64_tr_b16 a[36:37], v13 offset:43008
    buffer_load_dwordx4 v6, s[16:19], s31 offen offset:1024 lds
    v_mfma_f32_16x16x32_bf16 v[64:67], a[12:15], v[120:123], v[64:67]
    s_lshl_b32 s6, s3, 5
    ds_read_b64_tr_b16 a[38:39], v13 offset:43776
    v_perm_b32 v144, v176, v176, s58
    v_mfma_f32_16x16x32_bf16 v[68:71], a[16:19], v[120:123], v[68:71]
    s_add_u32 s6, s6, 9808
    ds_read_b64_tr_b16 a[40:41], v14 offset:43008
    v_perm_b32 v145, v176, v176, s59
    v_mfma_f32_16x16x32_bf16 v[72:75], a[20:23], v[120:123], v[72:75]
    s_add_u32 s33, s33, s32
    ds_read_b128 v[132:135], v16 offset:3584
    v_perm_b32 v146, v177, v177, s58
    v_mfma_f32_16x16x32_bf16 v[76:79], a[12:15], v[124:127], v[76:79]
    s_mul_i32 s40, s32, s34
    ds_read_b64_tr_b16 a[42:43], v14 offset:43776
    buffer_load_dwordx4 v7, s[16:19], s31 offen offset:2048 lds
    v_mfma_f32_16x16x32_bf16 v[80:83], a[16:19], v[124:127], v[80:83]
    s_add_u32 m0, s24, 12288
    ds_read_b64_tr_b16 a[44:45], v15 offset:43008
    v_perm_b32 v147, v177, v177, s59
    v_mfma_f32_16x16x32_bf16 v[84:87], a[20:23], v[124:127], v[84:87]
    s_waitcnt lgkmcnt(5)
    ds_read_b64_tr_b16 a[46:47], v15 offset:43776
    v_perm_b32 v148, v178, v178, s58
    v_mfma_f32_16x16x32_bf16 v[64:67], a[24:27], v[128:131], v[64:67]
    s_add_u32 s31, s28, 73728
    ds_read_b128 v[136:139], v17 offset:0
    v_perm_b32 v149, v178, v178, s59
    v_mfma_f32_16x16x32_bf16 v[68:71], a[28:31], v[128:131], v[68:71]
    s_sub_u32 s35, s35, s40
    ds_read_b128 v[140:143], v17 offset:3456
    buffer_load_dwordx4 v5, s[16:19], s31 offen lds
    v_mfma_f32_16x16x32_bf16 v[72:75], a[32:35], v[128:131], v[72:75]
    s_waitcnt lgkmcnt(5)
    v_perm_b32 v150, v179, v179, s58
    v_perm_b32 v151, v179, v179, s59
    v_mfma_f32_16x16x32_bf16 v[76:79], a[24:27], v[132:135], v[76:79]
    s_lshl_b32 s4, s3, 10
    v_add_f32 v144, v100, v144
    v_add_f32 v145, v102, v145
    v_mfma_f32_16x16x32_bf16 v[80:83], a[28:31], v[132:135], v[80:83]
    s_add_u32 s4, s4, 152832
    v_add_f32 v146, v101, v146
    v_add_f32 v147, v102, v147
    v_mfma_f32_16x16x32_bf16 v[84:87], a[32:35], v[132:135], v[84:87]
    s_waitcnt vmcnt(9) lgkmcnt(1)
    s_barrier
    v_mfma_f32_16x16x32_bf16 v[64:67], a[36:39], v[136:139], v[64:67]
    s_mul_i32 s72, s2, 9600
    ds_read_b128 v[112:115], v16 offset:6912
    buffer_load_dwordx4 v6, s[16:19], s31 offen offset:1024 lds
    v_mfma_f32_16x16x32_bf16 v[68:71], a[40:43], v[136:139], v[68:71]
    s_add_u32 s72, s72, 127488
    ds_read_b64_tr_b16 a[108:109], v61 offset:0
    s_mul_i32 s77, s57, 1536
    ds_read_b64_tr_b16 a[110:111], v61 offset:768
    v_mfma_f32_16x16x32_bf16 v[72:75], a[44:47], v[136:139], v[72:75]
    s_waitcnt lgkmcnt(3)
    ds_read_b64_tr_b16 a[112:113], v62 offset:0
    s_lshl1_add_u32 s70, s77, s72
    ds_read_b128 v[116:119], v16 offset:6976
    v_mfma_f32_16x16x32_bf16 v[76:79], a[36:39], v[140:143], v[76:79]
    s_add_u32 s77, s77, s72
    ds_read_b64_tr_b16 a[114:115], v62 offset:768
    s_addk_i32 s77, 4608
    ds_read_b64_tr_b16 a[116:117], v63 offset:0
    v_mfma_f32_16x16x32_bf16 v[80:83], a[40:43], v[140:143], v[80:83]
    s_add_u32 s73, s32, s2
    ds_read_b64_tr_b16 a[118:119], v63 offset:768
    buffer_load_dwordx4 v7, s[16:19], s31 offen offset:2048 lds
    v_mfma_f32_16x16x32_bf16 v[84:87], a[44:47], v[140:143], v[84:87]
    s_waitcnt lgkmcnt(7)
    ds_read_b128 v[120:123], v16 offset:7040
    v_add_f32 v148, v100, v148
    v_mfma_f32_16x16x32_bf16 v[88:91], a[0:3], v[112:115], 0
    s_add_u32 m0, s24, 24576
    ds_read_b64_tr_b16 a[216:217], v61 offset:9600
    v_add_f32 v149, v103, v149
    v_mfma_f32_16x16x32_bf16 v[92:95], a[4:7], v[112:115], 0
    s_add_u32 s31, s28, 24576
    ds_read_b64_tr_b16 a[218:219], v61 offset:10368
    v_add_f32 v150, v101, v150
    v_mfma_f32_16x16x32_bf16 v[96:99], a[8:11], v[112:115], 0
L_pgY0:
  s_cbranch_execz L_retY
    s_waitcnt lgkmcnt(6)
    ds_read_b64_tr_b16 a[220:221], v62 offset:9600
    buffer_load_dwordx4 v5, s[16:19], s31 offen lds
    v_mfma_f32_16x16x32_bf16 v[88:91], a[12:15], v[116:119], v[88:91]
    s_mulk_i32 s73, 192
    ds_read_b128 v[124:127], v17 offset:6912
    v_add_f32 v151, v103, v151
    v_mfma_f32_16x16x32_bf16 v[92:95], a[16:19], v[116:119], v[92:95]
    s_add_u32 s73, s73, s39
    ds_read_b64_tr_b16 a[222:223], v62 offset:10368
    v_cvt_pk_bf16_f32 v169, v144, v145
    v_mfma_f32_16x16x32_bf16 v[96:99], a[20:23], v[116:119], v[96:99]
    s_waitcnt lgkmcnt(5)
    ds_read_b64_tr_b16 a[224:225], v63 offset:9600
    v_cvt_pk_bf16_f32 v171, v146, v147
    v_mfma_f32_16x16x32_bf16 v[88:91], a[24:27], v[120:123], v[88:91]
    s_mul_i32 s78, s57, 344064
    ds_read_b64_tr_b16 a[226:227], v63 offset:10368
    buffer_load_dwordx4 v6, s[16:19], s31 offen offset:1024 lds
    v_mfma_f32_16x16x32_bf16 v[92:95], a[28:31], v[120:123], v[92:95]
    s_lshl1_add_u32 s71, s78, s73
    ds_read_b128 v[128:131], v16 offset:3456
    v_cvt_pk_bf16_f32 v173, v148, v149
    v_mfma_f32_16x16x32_bf16 v[96:99], a[32:35], v[120:123], v[96:99]
    s_waitcnt lgkmcnt(4)
    ds_read_b128 v[132:135], v16 offset:6912
    v_cvt_pk_bf16_f32 v175, v150, v151
    v_mfma_f32_16x16x32_bf16 v[88:91], a[36:39], v[124:127], v[88:91]
    s_add_u32 s78, s78, s73
    v_pk_max_i16 v169, v169, 0
    v_pk_max_i16 v171, v171, 0
    v_mfma_f32_16x16x32_bf16 v[92:95], a[40:43], v[124:127], v[92:95]
    buffer_load_dwordx4 v7, s[16:19], s31 offen offset:2048 lds
    v_mfma_f32_16x16x32_bf16 v[96:99], a[44:47], v[124:127], v[96:99]
    s_waitcnt vmcnt(6) lgkmcnt(1)
    s_barrier
    v_mfma_f32_16x16x32_bf16 v[64:67], a[108:111], v[128:131], v[64:67]
    s_add_u32 m0, s24, 36864
    ds_read_b128 v[136:139], v16 offset:10368
    v_pk_max_i16 v173, v173, 0
    v_mfma_f32_16x16x32_bf16 v[68:71], a[112:115], v[128:131], v[68:71]
    s_add_u32 s31, s26, 135168
    ds_read_b64_tr_b16 a[120:121], v13 offset:49152
    v_pk_max_i16 v175, v175, 0
    v_mfma_f32_16x16x32_bf16 v[72:75], a[116:119], v[128:131], v[72:75]
    s_waitcnt lgkmcnt(2)
    ds_read_b64_tr_b16 a[122:123], v13 offset:49920
    buffer_load_dwordx4 v5, s[16:19], s31 offen lds
    v_mfma_f32_16x16x32_bf16 v[76:79], a[108:111], v[132:135], v[76:79]
    s_add_u32 s73, s78, 1373824
    ds_read_b64_tr_b16 a[124:125], v14 offset:49152
    v_pk_min_i16 v169, v169, s60
    v_mfma_f32_16x16x32_bf16 v[80:83], a[112:115], v[132:135], v[80:83]
    s_add_u32 s78, s78, 1032192
    ds_read_b128 v[140:143], v16 offset:13824
    v_pk_min_i16 v171, v171, s60
    v_mfma_f32_16x16x32_bf16 v[84:87], a[116:119], v[132:135], v[84:87]
    s_waitcnt lgkmcnt(4)
    ds_read_b64_tr_b16 a[126:127], v14 offset:49920
    v_pk_min_i16 v173, v173, s60
    v_mfma_f32_16x16x32_bf16 v[88:91], a[108:111], v[136:139], v[88:91]
    s_sub_u32 s72, s77, 896
    ds_read_b64_tr_b16 a[128:129], v15 offset:49152
    buffer_load_dwordx4 v6, s[16:19], s31 offen offset:1024 lds
    v_mfma_f32_16x16x32_bf16 v[92:95], a[112:115], v[136:139], v[92:95]
    s_cmp_eq_u32 s46, 0
    s_cselect_b32 s72, s72, s64
    ds_read_b64_tr_b16 a[130:131], v15 offset:49920
    v_mfma_f32_16x16x32_bf16 v[96:99], a[116:119], v[136:139], v[96:99]
    s_cmp_eq_u32 s46, 0
    s_cselect_b32 s73, s73, s65
    ds_read_b128 v[112:115], v16 offset:3520
    v_mfma_f32_16x16x32_bf16 v[64:67], a[216:219], v[132:135], v[64:67]
    s_cmp_eq_u32 s46, 0
    s_cselect_b32 s77, s77, s66
    ds_read_b64_tr_b16 a[228:229], v13 offset:55296
    v_mfma_f32_16x16x32_bf16 v[68:71], a[220:223], v[132:135], v[68:71]
    ds_read_b64_tr_b16 a[230:231], v13 offset:56064
    buffer_load_dwordx4 v7, s[16:19], s31 offen offset:2048 lds
    v_mfma_f32_16x16x32_bf16 v[72:75], a[224:227], v[132:135], v[72:75]
    s_mul_i32 s31, s57, 3456
    ds_read_b64_tr_b16 a[232:233], v14 offset:55296
    v_pk_min_i16 v175, v175, s60
    v_mfma_f32_16x16x32_bf16 v[76:79], a[216:219], v[136:139], v[76:79]
    s_add_u32 s31, s31, s24
    ds_read_b128 v[116:119], v16 offset:6976
    v_cmp_ne_u16_e64 s[80:81], v169, v104
    v_mfma_f32_16x16x32_bf16 v[80:83], a[220:223], v[136:139], v[80:83]
    ds_read_b64_tr_b16 a[234:235], v14 offset:56064
    v_cmp_ne_u16_sdwa s[88:89], v169, v104 src0_sel:WORD_1 src1_sel:WORD_1
    v_mfma_f32_16x16x32_bf16 v[84:87], a[224:227], v[136:139], v[84:87]
    s_waitcnt lgkmcnt(5)
    ds_read_b64_tr_b16 a[236:237], v15 offset:55296
    v_cmp_ne_u16_e64 s[82:83], v171, v105
    v_mfma_f32_16x16x32_bf16 v[88:91], a[216:219], v[140:143], v[88:91]
    ds_read_b64_tr_b16 a[238:239], v15 offset:56064
    v_cmp_ne_u16_sdwa s[90:91], v171, v105 src0_sel:WORD_1 src1_sel:WORD_1
    v_mfma_f32_16x16x32_bf16 v[92:95], a[220:223], v[140:143], v[92:95]
    ds_read_b128 v[120:123], v16 offset:10432
    v_cmp_ne_u16_e64 s[84:85], v173, v106
    v_mfma_f32_16x16x32_bf16 v[96:99], a[224:227], v[140:143], v[96:99]
    ds_read_b64_tr_b16 a[132:133], v13 offset:0
    v_cmp_ne_u16_sdwa s[92:93], v173, v106 src0_sel:WORD_1 src1_sel:WORD_1
    v_mfma_f32_16x16x32_bf16 v[64:67], a[120:123], v[112:115], v[64:67]
    ds_read_b64_tr_b16 a[134:135], v13 offset:768
    v_cmp_ne_u16_e64 s[86:87], v175, v107
    v_mfma_f32_16x16x32_bf16 v[68:71], a[124:127], v[112:115], v[68:71]
    ds_read_b64_tr_b16 a[136:137], v14 offset:0
    v_cmp_ne_u16_sdwa s[94:95], v175, v107 src0_sel:WORD_1 src1_sel:WORD_1
    v_mfma_f32_16x16x32_bf16 v[72:75], a[128:131], v[112:115], v[72:75]
    s_waitcnt lgkmcnt(5)
    ds_read_b64_tr_b16 a[138:139], v14 offset:768
    v_mad_u32_u16 v30, v30, s5, v31 op_sel:[1,0,0,0]
    v_mfma_f32_16x16x32_bf16 v[76:79], a[120:123], v[116:119], v[76:79]
    s_add_u32 m0, s31, 127488
    ds_read_b64_tr_b16 a[140:141], v15 offset:0
    v_sub_u32 v32, s56, v0
    v_mfma_f32_16x16x32_bf16 v[80:83], a[124:127], v[116:119], v[80:83]
    s_add_u32 s31, s28, 86016
    ds_read_b64_tr_b16 a[142:143], v15 offset:768
    v_add_u32 v31, -252, v32
    v_mfma_f32_16x16x32_bf16 v[84:87], a[128:131], v[116:119], v[84:87]
    s_waitcnt lgkmcnt(5)
    ds_read_b64_tr_b16 a[240:241], v13 offset:6144
    buffer_load_dwordx4 v5, s[16:19], s31 offen lds
    v_mfma_f32_16x16x32_bf16 v[88:91], a[120:123], v[120:123], v[88:91]
    s_xor_b64 s[80:81], s[80:81], s[88:89]
    ds_read_b64_tr_b16 a[242:243], v13 offset:6912
    v_mbcnt_lo_u32_b32 v144, s80, 0
    v_mfma_f32_16x16x32_bf16 v[92:95], a[124:127], v[120:123], v[92:95]
    s_andn2_b64 s[88:89], s[88:89], s[80:81]
    ds_read_b64_tr_b16 a[244:245], v14 offset:6144
    v_mbcnt_lo_u32_b32 v148, s88, 0
    v_mfma_f32_16x16x32_bf16 v[96:99], a[128:131], v[120:123], v[96:99]
    s_xor_b64 s[82:83], s[82:83], s[90:91]
    ds_read_b128 v[124:127], v16 offset:13888
    v_mbcnt_hi_u32_b32 v148, s89, v148
    v_mfma_f32_16x16x32_bf16 v[64:67], a[228:231], v[116:119], v[64:67]
    s_andn2_b64 s[90:91], s[90:91], s[82:83]
    ds_read_b64_tr_b16 a[246:247], v14 offset:6912
    buffer_load_dwordx4 v6, s[16:19], s31 offen offset:1024 lds
    v_mfma_f32_16x16x32_bf16 v[68:71], a[232:235], v[116:119], v[68:71]
    s_xor_b64 s[84:85], s[84:85], s[92:93]
    ds_read_b64_tr_b16 a[248:249], v15 offset:6144
    v_mbcnt_lo_u32_b32 v149, s90, 0
    v_mfma_f32_16x16x32_bf16 v[72:75], a[236:239], v[116:119], v[72:75]
    s_andn2_b64 s[92:93], s[92:93], s[84:85]
    ds_read_b64_tr_b16 a[250:251], v15 offset:6912
    v_mbcnt_lo_u32_b32 v150, s92, 0
    v_mfma_f32_16x16x32_bf16 v[76:79], a[228:231], v[120:123], v[76:79]
    s_xor_b64 s[86:87], s[86:87], s[94:95]
    ds_read_b128 v[128:131], v16 offset:3584
    v_mbcnt_hi_u32_b32 v149, s91, v149
    v_mfma_f32_16x16x32_bf16 v[80:83], a[232:235], v[120:123], v[80:83]
    s_andn2_b64 s[94:95], s[94:95], s[86:87]
    ds_read_b128 v[132:135], v16 offset:7040
    buffer_load_dwordx4 v7, s[16:19], s31 offen offset:2048 lds
    v_mfma_f32_16x16x32_bf16 v[84:87], a[236:239], v[120:123], v[84:87]
    s_waitcnt lgkmcnt(5)
    ds_read_b128 v[136:139], v16 offset:10496
    v_mbcnt_lo_u32_b32 v151, s94, 0
    v_mfma_f32_16x16x32_bf16 v[88:91], a[228:231], v[124:127], v[88:91]
    s_add_u32 m0, s24, 49152
    v_mbcnt_hi_u32_b32 v150, s93, v150
    v_mbcnt_hi_u32_b32 v151, s95, v151
    v_mfma_f32_16x16x32_bf16 v[92:95], a[232:235], v[124:127], v[92:95]
    s_add_u32 s31, s28, 36864
    s_bcnt1_i32_b64 s48, s[88:89]
    v_mad_i32_i24 v148, 32, v108, v148
    v_mfma_f32_16x16x32_bf16 v[96:99], a[236:239], v[124:127], v[96:99]
    s_waitcnt vmcnt(9) lgkmcnt(2)
    s_barrier
    v_mfma_f32_16x16x32_bf16 v[64:67], a[132:135], v[128:131], v[64:67]
    s_bcnt1_i32_b64 s49, s[90:91]
    ds_read_b64_tr_b16 a[144:145], v13 offset:12288
    buffer_load_dwordx4 v5, s[16:19], s31 offen lds
    v_mfma_f32_16x16x32_bf16 v[68:71], a[136:139], v[128:131], v[68:71]
    s_bcnt1_i32_b64 s50, s[92:93]
    ds_read_b64_tr_b16 a[146:147], v13 offset:13056
    v_mbcnt_lo_u32_b32 v145, s82, 0
    v_mfma_f32_16x16x32_bf16 v[72:75], a[140:143], v[128:131], v[72:75]
    s_waitcnt lgkmcnt(2)
    ds_read_b64_tr_b16 a[148:149], v14 offset:12288
    s_bcnt1_i32_b64 s51, s[94:95]
    v_mfma_f32_16x16x32_bf16 v[76:79], a[132:135], v[132:135], v[76:79]
    s_lshr_b32 s52, s89, 4
    ds_read_b64_tr_b16 a[150:151], v14 offset:13056
    v_mbcnt_lo_u32_b32 v146, s84, 0
    v_mfma_f32_16x16x32_bf16 v[80:83], a[136:139], v[132:135], v[80:83]
    s_lshr_b32 s61, s91, 4
    ds_read_b64_tr_b16 a[152:153], v15 offset:12288
    buffer_load_dwordx4 v6, s[16:19], s31 offen offset:1024 lds
    v_mfma_f32_16x16x32_bf16 v[84:87], a[140:143], v[132:135], v[84:87]
    s_bcnt1_i32_b32 s52, s52
    ds_read_b64_tr_b16 a[154:155], v15 offset:13056
    v_mbcnt_lo_u32_b32 v147, s86, 0
    v_mfma_f32_16x16x32_bf16 v[88:91], a[132:135], v[136:139], v[88:91]
    s_bcnt1_i32_b32 s61, s61
    ds_read_b64_tr_b16 a[252:253], v13 offset:18432
    v_mbcnt_hi_u32_b32 v144, s81, v144
    v_mfma_f32_16x16x32_bf16 v[92:95], a[136:139], v[136:139], v[92:95]
    s_add_u32 s51, s51, s50
    ds_read_b64_tr_b16 a[254:255], v13 offset:19200
    v_mbcnt_hi_u32_b32 v145, s83, v145
    v_mfma_f32_16x16x32_bf16 v[96:99], a[140:143], v[136:139], v[96:99]
    s_add_u32 s43, s48, s49
    ds_read_b64_tr_b16 v[188:189], v14 offset:18432
    buffer_load_dwordx4 v7, s[16:19], s31 offen offset:2048 lds
    v_mfma_f32_16x16x32_bf16 v[64:67], a[240:243], v[132:135], v[64:67]
    s_add_u32 m0, s24, 0
    ds_read_b128 v[140:143], v16 offset:13952
    v_mbcnt_hi_u32_b32 v146, s85, v146
    v_mfma_f32_16x16x32_bf16 v[68:71], a[244:247], v[132:135], v[68:71]
    s_add_u32 s31, s26, 147456
    ds_read_b64_tr_b16 v[190:191], v14 offset:19200
    s_add_u32 s43, s43, s51
    v_mfma_f32_16x16x32_bf16 v[72:75], a[248:251], v[132:135], v[72:75]
    s_add_u32 s51, s51, s52
    ds_read_b64_tr_b16 v[192:193], v15 offset:18432
    v_mbcnt_hi_u32_b32 v147, s87, v147
    v_mfma_f32_16x16x32_bf16 v[76:79], a[240:243], v[136:139], v[76:79]
    s_add_u32 s51, s51, s61
    ds_read_b64_tr_b16 v[194:195], v15 offset:19200
    buffer_load_dwordx4 v5, s[16:19], s31 offen lds
    v_mfma_f32_16x16x32_bf16 v[80:83], a[244:247], v[136:139], v[80:83]
    s_lshl_b32 s96, s51, 1
    ds_read_b128 v[112:115], v17 offset:3456
    s_lshl_b32 s43, s43, 1
    v_mfma_f32_16x16x32_bf16 v[84:87], a[248:251], v[136:139], v[84:87]
    s_waitcnt lgkmcnt(4)
    ds_read_b128 v[116:119], v17 offset:6912
    s_sub_u32 s40, 64, s43
    v_mfma_f32_16x16x32_bf16 v[88:91], a[240:243], v[140:143], v[88:91]
    s_add_u32 s41, s6, s52
    ds_read_b128 v[120:123], v17 offset:10368
    v_mad_i32_i24 v144, s40, v108, v144
    v_mfma_f32_16x16x32_bf16 v[92:95], a[244:247], v[140:143], v[92:95]
    buffer_load_dwordx4 v6, s[16:19], s31 offen offset:1024 lds
    v_mfma_f32_16x16x32_bf16 v[96:99], a[248:251], v[140:143], v[96:99]
    s_waitcnt vmcnt(11) lgkmcnt(2)
    s_barrier
    v_mfma_f32_16x16x32_bf16 v[64:67], a[144:147], v[112:115], v[64:67]
    s_sub_u32 s52, 32, s48
    ds_read_b64_tr_b16 a[48:49], v13 offset:24576
    v_mad_i32_i24 v149, s52, v108, v149
    v_mfma_f32_16x16x32_bf16 v[68:71], a[148:151], v[112:115], v[68:71]
    s_sub_u32 s48, s41, s48
    ds_read_b64_tr_b16 a[50:51], v13 offset:25344
    s_add_u32 s41, s41, s61
    v_mfma_f32_16x16x32_bf16 v[72:75], a[152:155], v[112:115], v[72:75]
    s_waitcnt lgkmcnt(3)
    ds_read_b64_tr_b16 a[52:53], v14 offset:24576
    buffer_load_dwordx4 v7, s[16:19], s31 offen offset:2048 lds
    v_mfma_f32_16x16x32_bf16 v[76:79], a[144:147], v[116:119], v[76:79]
    s_add_u32 m0, s24, 12288
    ds_read_b64_tr_b16 a[54:55], v14 offset:25344
    v_add_lshl_u32 v148, v148, s48, 4
    v_mfma_f32_16x16x32_bf16 v[80:83], a[148:151], v[116:119], v[80:83]
    s_add_u32 s31, s28, 98304
    ds_read_b64_tr_b16 a[56:57], v15 offset:24576
    s_sub_u32 s49, s41, s49
    v_mfma_f32_16x16x32_bf16 v[84:87], a[152:155], v[116:119], v[84:87]
    s_waitcnt lgkmcnt(5)
    ds_read_b64_tr_b16 a[58:59], v15 offset:25344
    s_add_u32 s50, s50, s41
    v_mfma_f32_16x16x32_bf16 v[88:91], a[144:147], v[120:123], v[88:91]
    s_bcnt1_i32_b64 s7, s[80:81]
    ds_read_b64_tr_b16 a[156:157], v13 offset:30720
    buffer_load_dwordx4 v5, s[16:19], s31 offen lds
    v_mfma_f32_16x16x32_bf16 v[92:95], a[148:151], v[120:123], v[92:95]
    s_bcnt1_i32_b64 s59, s[82:83]
    ds_read_b64_tr_b16 a[158:159], v13 offset:31488
    v_add_lshl_u32 v149, v149, s49, 4
    v_mfma_f32_16x16x32_bf16 v[96:99], a[152:155], v[120:123], v[96:99]
    s_bcnt1_i32_b64 s79, s[84:85]
    ds_read_b64_tr_b16 a[160:161], v14 offset:30720
    v_add_lshl_u32 v150, v150, s41, 4
    v_mfma_f32_16x16x32_bf16 v[64:67], a[252:255], v[116:119], v[64:67]
    s_bcnt1_i32_b64 s62, s[86:87]
    ds_read_b128 v[124:127], v17 offset:13824
    v_add_lshl_u32 v151, v151, s50, 4
    v_mfma_f32_16x16x32_bf16 v[68:71], v[188:191], v[116:119], v[68:71]
    s_lshr_b32 s29, s81, 4
    ds_read_b64_tr_b16 a[162:163], v14 offset:31488
    buffer_load_dwordx4 v6, s[16:19], s31 offen offset:1024 lds
    v_mfma_f32_16x16x32_bf16 v[72:75], v[192:195], v[116:119], v[72:75]
    s_lshr_b32 s30, s83, 4
    ds_read_b64_tr_b16 a[164:165], v15 offset:30720
    v_and_b32 v31, 2.0, v31
    v_mfma_f32_16x16x32_bf16 v[76:79], a[252:255], v[120:123], v[76:79]
    s_bcnt1_i32_b32 s29, s29
    ds_read_b64_tr_b16 a[166:167], v15 offset:31488
    v_lshrrev_b32 v40, 3, v1
    v_mfma_f32_16x16x32_bf16 v[80:83], v[188:191], v[120:123], v[80:83]
    s_bcnt1_i32_b32 s30, s30
    ds_read_b128 v[128:131], v17 offset:64
    v_lshl_add_u32 v40, v40, 4, s4
    v_mfma_f32_16x16x32_bf16 v[84:87], v[192:195], v[120:123], v[84:87]
    s_waitcnt lgkmcnt(4)
    ds_read_b128 v[132:135], v17 offset:3520
    buffer_load_dwordx4 v7, s[16:19], s31 offen offset:2048 lds
    v_mfma_f32_16x16x32_bf16 v[88:91], a[252:255], v[124:127], v[88:91]
    s_add_u32 m0, s24, 24576
    ds_read_b128 v[136:139], v17 offset:6976
    v_and_or_b32 v24, v1, 4, v40
    v_mfma_f32_16x16x32_bf16 v[92:95], v[188:191], v[124:127], v[92:95]
    s_add_u32 s31, s28, 49152
    v_lshl_add_u32 v25, v2, 4, s4
    v_lshrrev_b32 v41, 1, v1
    v_mfma_f32_16x16x32_bf16 v[96:99], v[192:195], v[124:127], v[96:99]
    s_waitcnt vmcnt(9) lgkmcnt(2)
    s_barrier
    v_mfma_f32_16x16x32_bf16 v[64:67], a[48:51], v[128:131], v[64:67]
    s_add_u32 s62, s62, s79
    ds_read_b64_tr_b16 v[196:197], v13 offset:36864
    buffer_load_dwordx4 v5, s[16:19], s31 offen lds
    v_mfma_f32_16x16x32_bf16 v[68:71], a[52:55], v[128:131], v[68:71]
    s_add_u32 s63, s7, s59
    ds_read_b64_tr_b16 v[198:199], v13 offset:37632
    s_add_u32 s63, s63, s62
    ds_read_b64_tr_b16 v[200:201], v14 offset:36864
    v_mfma_f32_16x16x32_bf16 v[72:75], a[56:59], v[128:131], v[72:75]
    s_waitcnt lgkmcnt(4)
    ds_read_b64_tr_b16 v[202:203], v14 offset:37632
    s_add_u32 s62, s62, s29
    v_mfma_f32_16x16x32_bf16 v[76:79], a[48:51], v[132:135], v[76:79]
    s_add_u32 s62, s62, s30
    ds_read_b128 v[140:143], v17 offset:10432
    s_lshl1_add_u32 s6, s6, s96
    v_mfma_f32_16x16x32_bf16 v[80:83], a[52:55], v[132:135], v[80:83]
    s_add_u32 s62, s62, s96
    ds_read_b64_tr_b16 v[204:205], v15 offset:36864
    buffer_load_dwordx4 v6, s[16:19], s31 offen offset:1024 lds
    v_mfma_f32_16x16x32_bf16 v[84:87], a[56:59], v[132:135], v[84:87]
    s_waitcnt lgkmcnt(6)
    ds_read_b64_tr_b16 v[206:207], v15 offset:37632
    s_add_u32 s6, s6, s29
    v_mfma_f32_16x16x32_bf16 v[88:91], a[48:51], v[136:139], v[88:91]
    s_sub_u32 s29, s40, s7
    ds_read_b64_tr_b16 a[60:61], v13 offset:43008
    v_mad_i32_i24 v145, s29, v108, v145
    v_mfma_f32_16x16x32_bf16 v[92:95], a[52:55], v[136:139], v[92:95]
    s_sub_u32 s7, s6, s7
    ds_read_b64_tr_b16 a[62:63], v13 offset:43776
    s_add_u32 s6, s6, s30
    v_mfma_f32_16x16x32_bf16 v[96:99], a[56:59], v[136:139], v[96:99]
    s_sub_u32 s59, s6, s59
    ds_read_b64_tr_b16 a[64:65], v14 offset:43008
    buffer_load_dwordx4 v7, s[16:19], s31 offen offset:2048 lds
    v_mfma_f32_16x16x32_bf16 v[64:67], a[156:159], v[132:135], v[64:67]
    s_mov_b32 m0, s64
    ds_read_b64_tr_b16 a[66:67], v14 offset:43776
    s_add_u32 s79, s79, s6
    v_mfma_f32_16x16x32_bf16 v[68:71], a[160:163], v[132:135], v[68:71]
    s_sub_u32 s97, s43, s96
    ds_read_b64_tr_b16 a[68:69], v15 offset:43008
    v_add_lshl_u32 v144, v144, s7, 3
    v_mfma_f32_16x16x32_bf16 v[72:75], a[164:167], v[132:135], v[72:75]
    s_sub_u32 s43, 64, s97
    ds_read_b64_tr_b16 a[70:71], v15 offset:43776
    v_add_lshl_u32 v145, v145, s59, 3
    v_mfma_f32_16x16x32_bf16 v[76:79], a[156:159], v[136:139], v[76:79]
    s_bfm_b64 s[98:99], s96, 0
    ds_read_b128 v[112:115], v17 offset:13888
    buffer_load_dwordx4 v9, s[8:11], s65 offen  lds
    v_mfma_f32_16x16x32_bf16 v[80:83], a[160:163], v[136:139], v[80:83]
    s_bfm_b64 vcc, s97, s43
    ds_read_b64_tr_b16 a[168:169], v61 offset:0
    v_add_lshl_u32 v146, v146, s6, 3
    v_mfma_f32_16x16x32_bf16 v[84:87], a[164:167], v[136:139], v[84:87]
    s_waitcnt lgkmcnt(5)
    ds_read_b64_tr_b16 a[170:171], v61 offset:768
    v_add_lshl_u32 v147, v147, s79, 3
    v_mfma_f32_16x16x32_bf16 v[88:91], a[156:159], v[140:143], v[88:91]
    s_or_b64 s[98:99], s[98:99], vcc
    ds_read_b64_tr_b16 a[172:173], v62 offset:0
    v_and_or_b32 v41, v41, 8, 32
    v_mfma_f32_16x16x32_bf16 v[92:95], a[160:163], v[140:143], v[92:95]
    s_mov_b32 s5, 56448
    ds_read_b128 v[116:119], v17 offset:128
    buffer_load_dwordx4 v10, s[8:11], s65 offen offset:1024  lds
    v_mfma_f32_16x16x32_bf16 v[96:99], a[164:167], v[140:143], v[96:99]
    s_cmp_gt_u32 s62, 32
    s_cselect_b32 s63, 65, s63
    ds_read_b64_tr_b16 a[174:175], v62 offset:768
    v_mfma_f32_16x16x32_bf16 v[64:67], v[196:199], v[136:139], v[64:67]
    s_cmp_ge_i32 s63, s40
    s_cbranch_scc1 L_bfail1
L_bfail1_back:
    v_mfma_f32_16x16x32_bf16 v[68:71], v[200:203], v[136:139], v[68:71]
    s_mov_b32 s96, 0x7fff7fff
    ds_read_b64_tr_b16 a[176:177], v63 offset:0
    v_cndmask_b32 v144, v111, v144, s[80:81]
    v_mfma_f32_16x16x32_bf16 v[72:75], v[204:207], v[136:139], v[72:75]
    s_lshl_b32 s4, s57, 10
    ds_read_b64_tr_b16 a[178:179], v63 offset:768
    buffer_load_dwordx4 v11, s[8:11], s65 offen offset:2048  lds
    v_mfma_f32_16x16x32_bf16 v[76:79], v[196:199], v[140:143], v[76:79]
    s_mov_b32 m0, s66
    ds_read_b128 v[120:123], v17 offset:3584
    v_cndmask_b32 v144, v144, v148, s[88:89]
    v_mfma_f32_16x16x32_bf16 v[80:83], v[200:203], v[140:143], v[80:83]
    s_mov_b32 s88, 0x00040001
    ds_read_b64_tr_b16 v[208:209], v61 offset:9600
    v_cndmask_b32 v145, v111, v145, s[82:83]
    v_mfma_f32_16x16x32_bf16 v[84:87], v[204:207], v[140:143], v[84:87]
    s_waitcnt lgkmcnt(4)
    ds_read_b64_tr_b16 v[210:211], v61 offset:10368
    v_cndmask_b32 v145, v145, v149, s[90:91]
    v_mfma_f32_16x16x32_bf16 v[88:91], v[196:199], v[112:115], v[88:91]
    s_and_b32 s82, s98, 0x55555555
    ds_read_b64_tr_b16 v[212:213], v62 offset:9600
    buffer_load_dwordx4 v9, s[8:11], s67 offen  lds
    v_mfma_f32_16x16x32_bf16 v[92:95], v[200:203], v[112:115], v[92:95]
    s_and_b32 s83, s99, 0x55555555
    ds_read_b128 v[124:127], v17 offset:7040
    v_cndmask_b32 v146, v111, v146, s[84:85]
    v_mfma_f32_16x16x32_bf16 v[96:99], v[204:207], v[112:115], v[96:99]
    s_andn2_b64 s[80:81], s[98:99], s[82:83]
    ds_read_b64_tr_b16 v[214:215], v62 offset:10368
    v_cndmask_b32 v146, v146, v150, s[92:93]
    v_mfma_f32_16x16x32_bf16 v[64:67], a[60:63], v[116:119], v[64:67]
    s_not_b64 vcc, s[80:81]
    ds_write_b64 v144, v[168:169]
    v_mfma_f32_16x16x32_bf16 v[68:71], a[64:67], v[116:119], v[68:71]
    s_mov_b32 s89, 0x00400010
    ds_read_b64_tr_b16 v[216:217], v63 offset:9600
    buffer_load_dwordx4 v10, s[8:11], s67 offen offset:1024  lds
    v_mfma_f32_16x16x32_bf16 v[72:75], a[68:71], v[116:119], v[72:75]
    s_waitcnt lgkmcnt(5)
    ds_write_b64 v145, v[170:171]
    v_mfma_f32_16x16x32_bf16 v[76:79], a[60:63], v[120:123], v[76:79]
    s_lshl_b64 s[90:91], s[88:89], 1
    ds_read_b64_tr_b16 v[218:219], v63 offset:10368
    v_mfma_f32_16x16x32_bf16 v[80:83], a[64:67], v[120:123], v[80:83]
    s_lshl_b64 s[92:93], s[88:89], 8
    ds_write_b64 v146, v[172:173]
    v_mfma_f32_16x16x32_bf16 v[84:87], a[68:71], v[120:123], v[84:87]
    s_waitcnt lgkmcnt(5)
    ds_read_b128 v[128:131], v17 offset:10496
    buffer_load_dwordx4 v11, s[8:11], s67 offen offset:2048  lds
    v_cndmask_b32 v147, v111, v147, s[86:87]
    v_cndmask_b32 v147, v147, v151, s[94:95]
    v_mfma_f32_16x16x32_bf16 v[88:91], a[60:63], v[124:127], v[88:91]
    s_mov_b32 m0, s68
    ds_write_b64 v147, v[174:175]
    v_mfma_f32_16x16x32_bf16 v[92:95], a[64:67], v[124:127], v[92:95]
    s_lshl_b64 s[94:95], s[88:89], 9
    ds_read_b64 v[144:145], v110
    v_add3_u32 v31, v30, v31, s5
    v_and_or_b32 v30, v32, 2.0, v30
    v_mfma_f32_16x16x32_bf16 v[96:99], a[68:71], v[124:127], v[96:99]
    s_waitcnt vmcnt(12) lgkmcnt(4)
    s_barrier
    v_mfma_f32_16x16x32_bf16 v[64:67], a[168:171], v[120:123], v[64:67]
    s_add_u32 s56, s44, 43200
    ds_read_b64_tr_b16 a[72:73], v13 offset:49152
    buffer_load_dwordx4 v9, s[8:11], s69 offen  lds
    v_mfma_f32_16x16x32_bf16 v[68:71], a[172:175], v[120:123], v[68:71]
    s_cmp_eq_u32 s46, 0
    s_cselect_b32 s78, s78, s67
    ds_read_b64_tr_b16 a[74:75], v13 offset:49920
    v_mfma_f32_16x16x32_bf16 v[72:75], a[176:179], v[120:123], v[72:75]
    ds_read_b64_tr_b16 a[76:77], v14 offset:49152
    v_bitop3_b32 v26, v7, 48, v41 bitop3:0x6a
    v_mfma_f32_16x16x32_bf16 v[76:79], a[168:171], v[124:127], v[76:79]
    ds_read_b128 v[132:135], v17 offset:13952
    v_xor_b32 v27, 8, v26
    v_mfma_f32_16x16x32_bf16 v[80:83], a[172:175], v[124:127], v[80:83]
    buffer_load_dwordx4 v10, s[8:11], s69 offen offset:1024  lds
    v_mfma_f32_16x16x32_bf16 v[84:87], a[176:179], v[124:127], v[84:87]
    s_waitcnt lgkmcnt(4)
    ds_write_b32 v144, v109
    v_mfma_f32_16x16x32_bf16 v[88:91], a[168:171], v[128:131], v[88:91]
    ds_read_b64_tr_b16 a[78:79], v14 offset:49920
    v_cndmask_b32_dpp v145, v145, v145, vcc quad_perm:[0,0,2,2] row_mask:0xf bank_mask:0xf
    v_mfma_f32_16x16x32_bf16 v[92:95], a[172:175], v[128:131], v[92:95]
    ds_read_b64_tr_b16 a[80:81], v15 offset:49152
    v_lshrrev_b32 v52, 1, v4
    v_mfma_f32_16x16x32_bf16 v[96:99], a[176:179], v[128:131], v[96:99]
    buffer_load_dwordx4 v11, s[8:11], s69 offen offset:2048  lds
    v_mfma_f32_16x16x32_bf16 v[64:67], v[208:211], v[124:127], v[64:67]
    ds_read_b64_tr_b16 a[82:83], v15 offset:49920
    v_lshl_or_b32 v21, v4, 1, v52
    v_mfma_f32_16x16x32_bf16 v[68:71], v[212:215], v[124:127], v[68:71]
    ds_read_b128 v[136:139], v18 offset:0
    v_and_b32 v21, 48, v21
    v_mfma_f32_16x16x32_bf16 v[72:75], v[216:219], v[124:127], v[72:75]
    ds_read_b128 v[140:143], v18 offset:3456
    v_lshl_add_u32 v21, s2, 7, v21
    v_mfma_f32_16x16x32_bf16 v[76:79], v[208:211], v[128:131], v[76:79]
    buffer_load_dwordx4 v12, s[8:11], s69 offen offset:2432  lds
    v_mfma_f32_16x16x32_bf16 v[80:83], v[212:215], v[128:131], v[80:83]
    s_bitcmp1_b32 s73, 30
    s_cbranch_scc1 L_noj3
    s_mov_b32 m0, s72
    s_nop 0
    buffer_load_dwordx4 v50, s[8:11], s73 offen offset:2432  lds
    s_mov_b32 m0, s77
    s_nop 0
    buffer_load_dwordx4 v12, s[8:11], s78 offen offset:2432  lds
    s_mov_b32 m0, s70
    s_bitcmp1_b32 s39, 30
    s_cbranch_scc1 L_noj3
    buffer_load_dwordx4 v9, s[8:11], s71 offen  lds
    buffer_load_dwordx4 v10, s[8:11], s71 offen offset:1024  lds
    buffer_load_dwordx4 v11, s[8:11], s71 offen offset:2048  lds
L_noj3:
    v_mfma_f32_16x16x32_bf16 v[84:87], v[216:219], v[128:131], v[84:87]
    s_waitcnt lgkmcnt(3)
    ds_read_b64_tr_b16 a[180:181], v13 offset:55296
    v_mad_u32_u24 v19, v2, s42, v21
    v_mfma_f32_16x16x32_bf16 v[88:91], v[208:211], v[132:135], v[88:91]
    s_lshl_b32 s31, s2, 5
    ds_read_b64_tr_b16 a[182:183], v13 offset:56064
    ds_read_b64_tr_b16 a[184:185], v14 offset:55296
    v_mfma_f32_16x16x32_bf16 v[92:95], v[212:215], v[132:135], v[92:95]
    ds_read_b128 v[112:115], v18 offset:6912
    v_xor_b32 v5, s31, v5
    v_mfma_f32_16x16x32_bf16 v[96:99], v[216:219], v[132:135], v[96:99]
    s_waitcnt lgkmcnt(4)
    ds_read_b64_tr_b16 a[186:187], v14 offset:56064
    v_lshl_add_u32 v53, s2, 2, v3
    v_mfma_f32_16x16x32_bf16 v[64:67], a[72:75], v[136:139], v[64:67]
    s_lshr_b32 s31, s24, 1
    ds_read_b64_tr_b16 a[188:189], v15 offset:55296
    v_lshrrev_b32 v52, 1, v2
    v_mfma_f32_16x16x32_bf16 v[68:71], a[76:79], v[136:139], v[68:71]
    s_add_u32 m0, s31, 36864
    ds_read_b64_tr_b16 a[190:191], v15 offset:56064
    v_bitop3_b32 v52, v52, 6, v53 bitop3:0x6a
    v_mfma_f32_16x16x32_bf16 v[72:75], a[80:83], v[136:139], v[72:75]
    s_add_u32 s31, s31, 159744
    ds_read_b64_tr_b16 v[220:221], v13 offset:0
    v_lshl_add_u32 v52, v2, 3, v52
    v_mfma_f32_16x16x32_bf16 v[76:79], a[72:75], v[140:143], v[76:79]
    ds_read_b64_tr_b16 v[222:223], v13 offset:768
    buffer_load_dwordx4 v5, s[16:19], s31 offen lds
    v_mfma_f32_16x16x32_bf16 v[80:83], a[76:79], v[140:143], v[80:83]
    ds_read_b64_tr_b16 v[224:225], v14 offset:0
    v_lshl_add_u32 v38, v52, 3, s4
    v_mfma_f32_16x16x32_bf16 v[84:87], a[80:83], v[140:143], v[84:87]
    s_waitcnt lgkmcnt(5)
    ds_read_b128 v[116:119], v18 offset:10368
    v_lshlrev_b32 v146, 16, v145
    v_mfma_f32_16x16x32_bf16 v[88:91], a[72:75], v[112:115], v[88:91]
    s_mul_i32 s4, s57, 129024
    ds_read_b64_tr_b16 v[226:227], v14 offset:768
    s_add_u32 s56, s56, s4
    ds_read_b64_tr_b16 v[228:229], v15 offset:0
    v_mfma_f32_16x16x32_bf16 v[92:95], a[76:79], v[112:115], v[92:95]
    s_add_u32 s4, s56, 43008
    ds_read_b64_tr_b16 v[230:231], v15 offset:768
    buffer_load_dwordx4 v5, s[16:19], s31 offen offset:512 lds
    v_mfma_f32_16x16x32_bf16 v[96:99], a[80:83], v[112:115], v[96:99]
    s_waitcnt lgkmcnt(6)
    ds_read_b64_tr_b16 a[84:85], v13 offset:6144
    s_add_u32 s5, s56, 86016
    v_mfma_f32_16x16x32_bf16 v[64:67], a[180:183], v[140:143], v[64:67]
    ds_read_b64_tr_b16 a[86:87], v13 offset:6912
    v_and_b32 v147, 0xffff0000, v145
    v_mfma_f32_16x16x32_bf16 v[68:71], a[184:187], v[140:143], v[68:71]
    ds_read_b64_tr_b16 a[88:89], v14 offset:6144
    ds_read_b64_tr_b16 a[90:91], v14 offset:6912
    v_mfma_f32_16x16x32_bf16 v[72:75], a[188:191], v[140:143], v[72:75]
    ds_read_b64_tr_b16 a[92:93], v15 offset:6144
    buffer_load_dwordx4 v[180:183], v30, s[12:15], s55 offen
    v_mfma_f32_16x16x32_bf16 v[76:79], a[180:183], v[112:115], v[76:79]
    ds_read_b128 v[120:123], v18 offset:13824
    ds_read_b64_tr_b16 a[94:95], v15 offset:6912
    v_mfma_f32_16x16x32_bf16 v[80:83], a[184:187], v[112:115], v[80:83]
    v_ceil_f32 v149, v146
    v_ceil_f32 v151, v147
    v_mfma_f32_16x16x32_bf16 v[84:87], a[188:191], v[112:115], v[84:87]
    s_waitcnt lgkmcnt(6)
    v_cvt_u32_f32 v148, v146
    v_cvt_u32_f32 v150, v147
    v_mfma_f32_16x16x32_bf16 v[88:91], a[180:183], v[116:119], v[88:91]
    ds_read_b128 v[124:127], v18 offset:64
    buffer_load_dwordx4 v[184:187], v31, s[12:15], s55 offen
    v_mfma_f32_16x16x32_bf16 v[92:95], a[184:187], v[116:119], v[92:95]
    v_cvt_u32_f32 v149, v149
    v_cvt_u32_f32 v151, v151
    v_mfma_f32_16x16x32_bf16 v[96:99], a[188:191], v[116:119], v[96:99]
L_pgY1:
  s_cbranch_execz L_retY
    s_waitcnt vmcnt(14) lgkmcnt(3)
    s_barrier
    v_mfma_f32_16x16x32_bf16 v[64:67], v[220:223], v[112:115], v[64:67]
    ds_read_b128 v[128:131], v18 offset:3520
    ds_read_b64_tr_b16 a[192:193], v13 offset:12288
    v_mfma_f32_16x16x32_bf16 v[68:71], v[224:227], v[112:115], v[68:71]
    ds_read_b64_tr_b16 a[194:195], v13 offset:13056
    ds_read_b64_tr_b16 a[196:197], v14 offset:12288
    v_mfma_f32_16x16x32_bf16 v[72:75], v[228:231], v[112:115], v[72:75]
    ds_read_b64_tr_b16 a[198:199], v14 offset:13056
    ds_read_b64_tr_b16 a[200:201], v15 offset:12288
    v_mfma_f32_16x16x32_bf16 v[76:79], v[220:223], v[116:119], v[76:79]
    ds_read_b128 v[132:135], v18 offset:6976
    ds_read_b64_tr_b16 a[202:203], v15 offset:13056
    v_mfma_f32_16x16x32_bf16 v[80:83], v[224:227], v[116:119], v[80:83]
    ds_read_b64_tr_b16 v[232:233], v13 offset:18432
    v_cndmask_b32 v164, v148, v149, s[80:81]
    v_mfma_f32_16x16x32_bf16 v[84:87], v[228:231], v[116:119], v[84:87]
    s_waitcnt lgkmcnt(9)
    ds_read_b64_tr_b16 v[234:235], v13 offset:19200
    v_cndmask_b32 v165, v149, v148, s[82:83]
    v_mfma_f32_16x16x32_bf16 v[88:91], v[220:223], v[120:123], v[88:91]
    ds_read_b64_tr_b16 v[236:237], v14 offset:18432
    v_and_b32 v160, 4, v150
    v_mfma_f32_16x16x32_bf16 v[92:95], v[224:227], v[120:123], v[92:95]
    ds_read_b64_tr_b16 v[238:239], v14 offset:19200
    v_lshl_add_u32 v160, v160, 3, s35
    v_mfma_f32_16x16x32_bf16 v[96:99], v[228:231], v[120:123], v[96:99]
    ds_read_b64_tr_b16 v[240:241], v15 offset:18432
    v_mad_u32_u24 v160, v150, s42, v160
    v_mfma_f32_16x16x32_bf16 v[64:67], a[84:87], v[124:127], v[64:67]
    ds_read_b64_tr_b16 v[242:243], v15 offset:19200
    v_mad_u32_u24 v164, v164, s34, v160
    v_mfma_f32_16x16x32_bf16 v[68:71], a[88:91], v[124:127], v[68:71]
    ds_read_b64_tr_b16 a[96:97], v13 offset:24576
    v_and_b32 v160, 4, v151
    v_mfma_f32_16x16x32_bf16 v[72:75], a[92:95], v[124:127], v[72:75]
    s_waitcnt lgkmcnt(5)
    ds_read_b64_tr_b16 a[98:99], v13 offset:25344
    v_lshl_add_u32 v160, v160, 3, s35
    v_mfma_f32_16x16x32_bf16 v[76:79], a[84:87], v[128:131], v[76:79]
    ds_read_b128 v[136:139], v18 offset:10432
    v_mad_u32_u24 v160, v151, s42, v160
    v_mfma_f32_16x16x32_bf16 v[80:83], a[88:91], v[128:131], v[80:83]
    ds_read_b64_tr_b16 a[100:101], v14 offset:24576
    v_mad_u32_u24 v165, v165, s34, v160
    v_mfma_f32_16x16x32_bf16 v[84:87], a[92:95], v[128:131], v[84:87]
    ds_read_b64_tr_b16 a[102:103], v14 offset:25344
    v_fract_f32 v152, v146
    v_mfma_f32_16x16x32_bf16 v[88:91], a[84:87], v[132:135], v[88:91]
    ds_read_b64_tr_b16 a[104:105], v15 offset:24576
    v_fract_f32 v153, v147
    v_mfma_f32_16x16x32_bf16 v[92:95], a[88:91], v[132:135], v[92:95]
    ds_read_b64_tr_b16 a[106:107], v15 offset:25344
    v_mul_f32 v159, v152, v153
    v_mfma_f32_16x16x32_bf16 v[96:99], a[92:95], v[132:135], v[96:99]
    ds_read_b64_tr_b16 a[204:205], v13 offset:30720
    v_add_f32 v155, v152, v153
    v_mfma_f32_16x16x32_bf16 v[64:67], a[192:195], v[128:131], v[64:67]
    ds_read_b64_tr_b16 a[206:207], v13 offset:31488
    v_cndmask_b32 v152, 0, v152, s[98:99]
    v_mfma_f32_16x16x32_bf16 v[68:71], a[196:199], v[128:131], v[68:71]
    ds_read_b64_tr_b16 a[208:209], v14 offset:30720
    v_sub_f32 v155, v155, v159
    v_mfma_f32_16x16x32_bf16 v[72:75], a[200:203], v[128:131], v[72:75]
    ds_write_b64 v111, v[164:165]
    v_mfma_f32_16x16x32_bf16 v[76:79], a[192:195], v[132:135], v[76:79]
    ds_read_b128 v[140:143], v18 offset:13888
    v_mfma_f32_16x16x32_bf16 v[80:83], a[196:199], v[132:135], v[80:83]
    ds_read2_b32 v[176:177], v24 offset0:0 offset1:32
    v_sub_f32 v158, v152, v159
    v_mfma_f32_16x16x32_bf16 v[84:87], a[200:203], v[132:135], v[84:87]
    s_waitcnt lgkmcnt(5)
    ds_read_b64_tr_b16 a[210:211], v14 offset:31488
    v_sub_f32 v156, 1.0, v155
    v_mfma_f32_16x16x32_bf16 v[88:91], a[192:195], v[136:139], v[88:91]
    ds_read_b128 v[112:115], v18 offset:128
    v_sub_f32 v157, v155, v152
    v_mfma_f32_16x16x32_bf16 v[92:95], a[196:199], v[136:139], v[92:95]
    ds_read_b64_tr_b16 a[212:213], v15 offset:30720
    v_cvt_pk_bf16_f32 v167, v158, v159
    v_mfma_f32_16x16x32_bf16 v[96:99], a[200:203], v[136:139], v[96:99]
    ds_read_b64_tr_b16 a[214:215], v15 offset:31488
    v_cvt_pk_bf16_f32 v166, v156, v157
    v_mfma_f32_16x16x32_bf16 v[64:67], v[232:235], v[132:135], v[64:67]
    ds_write_b64 v111, v[166:167] offset:8
    v_mfma_f32_16x16x32_bf16 v[68:71], v[236:239], v[132:135], v[68:71]
    ds_read_b128 v[116:119], v18 offset:3584
    v_mfma_f32_16x16x32_bf16 v[72:75], v[240:243], v[132:135], v[72:75]
    s_waitcnt lgkmcnt(5)
    ds_read_b64 v[178:179], v25 offset:8
    v_cmp_gt_u32 vcc, s32, v148
    v_mfma_f32_16x16x32_bf16 v[76:79], v[232:235], v[136:139], v[76:79]
    ds_read_b128 v[120:123], v18 offset:7040
    v_cmp_le_u32 s[84:85], s33, v149
    v_mfma_f32_16x16x32_bf16 v[80:83], v[236:239], v[136:139], v[80:83]
    ds_read_b128 v[52:55], v23 offset:1536
    v_cmp_le_u32 s[86:87], s36, v151
    v_mfma_f32_16x16x32_bf16 v[84:87], v[240:243], v[136:139], v[84:87]
    ds_read_b128 v[56:59], v23 offset:1552
    v_xor_b32 v172, v176, v26
    v_mfma_f32_16x16x32_bf16 v[88:91], v[232:235], v[140:143], v[88:91]
    s_or_b64 vcc, vcc, s[84:85]
    ds_read_b32 v60, v23 offset:1568
    s_or_b64 vcc, vcc, s[86:87]
    s_cbranch_scc1 L_bfail2
L_bfail2_back:
    v_mfma_f32_16x16x32_bf16 v[92:95], v[236:239], v[140:143], v[92:95]
    v_xor_b32 v174, v177, v26
    v_xor_b32 v173, v176, v27
    v_mfma_f32_16x16x32_bf16 v[96:99], v[240:243], v[140:143], v[96:99]
    s_waitcnt vmcnt(2) lgkmcnt(4)
    s_barrier
    v_mfma_f32_16x16x32_bf16 v[64:67], a[96:99], v[112:115], v[64:67]
    ds_read_b64_tr_b16 v[144:145], v172 offset:0
    ds_read_b64_tr_b16 v[146:147], v174 offset:0
    v_mfma_f32_16x16x32_bf16 v[68:71], a[100:103], v[112:115], v[68:71]
    ds_read_b64_tr_b16 v[148:149], v173 offset:0
    ds_read_b64_tr_b16 v[244:245], v13 offset:36864
    v_mfma_f32_16x16x32_bf16 v[72:75], a[104:107], v[112:115], v[72:75]
    s_waitcnt lgkmcnt(5)
    ds_read_b64_tr_b16 v[246:247], v13 offset:37632
    v_xor_b32 v175, v177, v27
    v_mfma_f32_16x16x32_bf16 v[76:79], a[96:99], v[116:119], v[76:79]
    ds_read_b64_tr_b16 v[150:151], v175 offset:0
    v_cndmask_b32 v169, 0, v179, s[88:89]
    v_mfma_f32_16x16x32_bf16 v[80:83], a[100:103], v[116:119], v[80:83]
    ds_read_b64_tr_b16 v[152:153], v172 offset:64
    v_cndmask_b32 v171, 0, v179, s[92:93]
    v_mfma_f32_16x16x32_bf16 v[84:87], a[104:107], v[116:119], v[84:87]
    s_waitcnt lgkmcnt(7)
    ds_read_b64_tr_b16 v[154:155], v174 offset:64
    v_cndmask_b32 v168, 0, v178, s[88:89]
    v_mfma_f32_16x16x32_bf16 v[88:91], a[96:99], v[120:123], v[88:91]
    ds_read_b64_tr_b16 v[156:157], v173 offset:64
    v_cndmask_b32 v170, 0, v178, s[92:93]
    v_mfma_f32_16x16x32_bf16 v[92:95], a[100:103], v[120:123], v[92:95]
    ds_read_b64_tr_b16 v[158:159], v175 offset:64
    v_cndmask_b32 v169, v169, v178, s[90:91]
    v_mfma_f32_16x16x32_bf16 v[96:99], a[104:107], v[120:123], v[96:99]
    ds_read_b64_tr_b16 v[160:161], v172 offset:128
    v_cndmask_b32 v171, v171, v178, s[94:95]
    v_mfma_f32_16x16x32_bf16 v[64:67], a[204:207], v[116:119], v[64:67]
    ds_read_b64_tr_b16 v[162:163], v174 offset:128
    v_xor_b32 v40, v52, v4
    v_mfma_f32_16x16x32_bf16 v[68:71], a[208:211], v[116:119], v[68:71]
    ds_read_b64_tr_b16 v[164:165], v173 offset:128
    v_xor_b32 v41, v53, v4
    v_mfma_f32_16x16x32_bf16 v[72:75], a[212:215], v[116:119], v[72:75]
    s_waitcnt lgkmcnt(5)
    ds_read_b64_tr_b16 v[166:167], v175 offset:128
    v_xor_b32 v42, v54, v4
    v_mfma_f32_16x16x32_bf16 v[144:147], v[144:147], v[168:171], 0
    ds_read_b64_tr_b16 v[248:249], v14 offset:36864
    v_xor_b32 v43, v55, v4
    v_mfma_f32_16x16x32_bf16 v[148:151], v[148:151], v[168:171], 0
    ds_read_b128 v[124:127], v18 offset:10496
    v_xor_b32 v44, v56, v4
    v_mfma_f32_16x16x32_bf16 v[152:155], v[152:155], v[168:171], 0
    ds_read_b64_tr_b16 v[250:251], v14 offset:37632
    v_xor_b32 v45, v57, v4
    v_mfma_f32_16x16x32_bf16 v[76:79], a[204:207], v[120:123], v[76:79]
    ds_read_b64_tr_b16 v[252:253], v15 offset:36864
    v_cvt_pk_bf16_f32 v144, v144, v145
    v_cvt_pk_bf16_f32 v145, v146, v147
    v_mfma_f32_16x16x32_bf16 v[80:83], a[208:211], v[120:123], v[80:83]
    ds_write_b64 v28, v[144:145] offset:0
    v_mfma_f32_16x16x32_bf16 v[84:87], a[212:215], v[120:123], v[84:87]
    s_waitcnt lgkmcnt(5)
    ds_read_b64_tr_b16 v[254:255], v15 offset:37632
    v_cvt_pk_bf16_f32 v148, v148, v149
    v_cvt_pk_bf16_f32 v149, v150, v151
    v_mfma_f32_16x16x32_bf16 v[156:159], v[156:159], v[168:171], 0
    ds_write_b64 v29, v[148:149] offset:0
    v_mfma_f32_16x16x32_bf16 v[160:163], v[160:163], v[168:171], 0
    ds_read_b128 v[128:131], v18 offset:13952
    v_cvt_pk_bf16_f32 v152, v152, v153
    v_cvt_pk_bf16_f32 v153, v154, v155
    v_mfma_f32_16x16x32_bf16 v[164:167], v[164:167], v[168:171], 0
    s_waitcnt lgkmcnt(5)
    ds_write_b64 v28, v[152:153] offset:64
    v_mfma_f32_16x16x32_bf16 v[88:91], a[204:207], v[124:127], v[88:91]
    v_cvt_pk_bf16_f32 v156, v156, v157
    v_cvt_pk_bf16_f32 v157, v158, v159
    v_mfma_f32_16x16x32_bf16 v[92:95], a[208:211], v[124:127], v[92:95]
    ds_write_b64 v29, v[156:157] offset:64
    v_mfma_f32_16x16x32_bf16 v[96:99], a[212:215], v[124:127], v[96:99]
    s_waitcnt lgkmcnt(4)
    v_cvt_pk_bf16_f32 v160, v160, v161
    v_cvt_pk_bf16_f32 v161, v162, v163
    v_mfma_f32_16x16x32_bf16 v[64:67], v[244:247], v[120:123], v[64:67]
    ds_write_b64 v28, v[160:161] offset:128
    v_mfma_f32_16x16x32_bf16 v[68:71], v[248:251], v[120:123], v[68:71]
    v_cvt_pk_bf16_f32 v164, v164, v165
    v_cvt_pk_bf16_f32 v165, v166, v167
    v_mfma_f32_16x16x32_bf16 v[72:75], v[252:255], v[120:123], v[72:75]
    ds_write_b64 v29, v[164:165] offset:128
    v_mfma_f32_16x16x32_bf16 v[76:79], v[244:247], v[124:127], v[76:79]
    s_cmp_gt_u32 s62, 16
    s_cbranch_scc1 L_more
L_more_back:
    v_mfma_f32_16x16x32_bf16 v[80:83], v[248:251], v[124:127], v[80:83]
    v_xor_b32 v46, v58, v4
    v_xor_b32 v47, v59, v4
    v_mfma_f32_16x16x32_bf16 v[84:87], v[252:255], v[124:127], v[84:87]
    s_waitcnt lgkmcnt(0)
    s_barrier
    ds_read_b128 v[132:135], v40 offset:0
    v_mfma_f32_16x16x32_bf16 v[88:91], v[244:247], v[128:131], v[88:91]
    ds_read_b128 v[136:139], v40 offset:64
    v_xor_b32 v48, v60, v4
    v_mfma_f32_16x16x32_bf16 v[92:95], v[248:251], v[128:131], v[92:95]
    ds_read_b128 v[140:143], v40 offset:128
    v_mad_u32_u24 v21, v2, s54, v21
    v_mfma_f32_16x16x32_bf16 v[96:99], v[252:255], v[128:131], v[96:99]
    s_waitcnt lgkmcnt(2)
    ds_read_b128 v[112:115], v41 offset:0
    v_lshlrev_b32 v39, 3, v0
    v_mfma_f32_16x16x32_bf16 v[100:103], a[0:3], v[132:135], 0
    ds_read_b128 v[116:119], v41 offset:64
    v_cvt_pk_bf16_f32 v64, v64, v65
    v_mfma_f32_16x16x32_bf16 v[104:107], a[4:7], v[132:135], 0
    ds_read_b128 v[52:55], v23 offset:768
    v_cvt_pk_bf16_f32 v65, v66, v67
    v_mfma_f32_16x16x32_bf16 v[108:111], a[8:11], v[132:135], 0
    s_waitcnt lgkmcnt(4)
    ds_read_b128 v[56:59], v23 offset:784
    v_cvt_pk_bf16_f32 v66, v68, v69
    v_mfma_f32_16x16x32_bf16 v[100:103], a[12:15], v[136:139], v[100:103]
    ds_read_b128 v[120:123], v41 offset:128
    v_cvt_pk_bf16_f32 v67, v70, v71
    v_mfma_f32_16x16x32_bf16 v[104:107], a[16:19], v[136:139], v[104:107]
    v_permlane16_swap_b32 v64, v66
    v_mfma_f32_16x16x32_bf16 v[108:111], a[20:23], v[136:139], v[108:111]
    s_waitcnt lgkmcnt(4)
    v_permlane16_swap_b32 v65, v67
    v_mfma_f32_16x16x32_bf16 v[100:103], a[24:27], v[140:143], v[100:103]
    ds_read_b128 v[124:127], v42 offset:0
    v_cvt_pk_bf16_f32 v72, v72, v73
    v_mfma_f32_16x16x32_bf16 v[104:107], a[28:31], v[140:143], v[104:107]
    buffer_store_dwordx4 v[64:67], v19, s[20:23], s56 offen sc1
    v_cvt_pk_bf16_f32 v73, v74, v75
    v_lshrrev_b32 v22, 1, v0
    v_bitop3_b32 v22, v22, 48, v39 bitop3:0x6a
    v_mfma_f32_16x16x32_bf16 v[108:111], a[32:35], v[140:143], v[108:111]
    s_waitcnt lgkmcnt(2)
    ds_write_b64 v38, v[72:73] offset:49152
    v_mfma_f32_16x16x32_bf16 v[100:103], a[36:39], v[112:115], v[100:103]
    ds_read_b128 v[128:131], v42 offset:64
    v_mfma_f32_16x16x32_bf16 v[104:107], a[40:43], v[112:115], v[104:107]
    ds_read_b32 v60, v23 offset:800
    v_xor_b32 v40, v52, v4
    v_mfma_f32_16x16x32_bf16 v[108:111], a[44:47], v[112:115], v[108:111]
    ds_read2_b32 v[176:177], v24 offset0:64 offset1:96
    v_xor_b32 v41, v53, v4
    v_mfma_f32_16x16x32_bf16 v[100:103], a[48:51], v[116:119], v[100:103]
    ds_read_b128 v[132:135], v42 offset:128
    v_bfe_u32 v37, v0, 3, 4
    v_mfma_f32_16x16x32_bf16 v[104:107], a[52:55], v[116:119], v[104:107]
    ds_read_b64 v[178:179], v25 offset:264
    v_and_or_b32 v22, v22, 56, 64
    v_mfma_f32_16x16x32_bf16 v[108:111], a[56:59], v[116:119], v[108:111]
    s_waitcnt lgkmcnt(5)
    v_mad_u32_u24 v20, v37, s42, v22
    v_mad_u32_u24 v22, v37, s54, v22
    v_mfma_f32_16x16x32_bf16 v[100:103], a[60:63], v[120:123], v[100:103]
    ds_read_b128 v[136:139], v43 offset:0
    v_xor_b32 v42, v54, v4
    v_mfma_f32_16x16x32_bf16 v[104:107], a[64:67], v[120:123], v[104:107]
    v_cvt_pk_bf16_f32 v84, v84, v85
    v_cvt_pk_bf16_f32 v85, v86, v87
    v_mfma_f32_16x16x32_bf16 v[108:111], a[68:71], v[120:123], v[108:111]
    s_waitcnt lgkmcnt(3)
    ds_write_b64 v38, v[84:85] offset:51200
    v_mfma_f32_16x16x32_bf16 v[100:103], a[72:75], v[124:127], v[100:103]
    ds_read_b128 v[140:143], v43 offset:64
    v_mfma_f32_16x16x32_bf16 v[104:107], a[76:79], v[124:127], v[104:107]
    v_xor_b32 v172, v176, v26
    v_xor_b32 v174, v177, v26
    v_mfma_f32_16x16x32_bf16 v[108:111], a[80:83], v[124:127], v[108:111]
    s_waitcnt lgkmcnt(3)
    v_xor_b32 v173, v176, v27
    v_xor_b32 v175, v177, v27
    v_mfma_f32_16x16x32_bf16 v[100:103], a[84:87], v[128:131], v[100:103]
    ds_read_b128 v[112:115], v43 offset:128
    v_cndmask_b32 v169, 0, v179, s[88:89]
    v_mfma_f32_16x16x32_bf16 v[104:107], a[88:91], v[128:131], v[104:107]
    v_cndmask_b32 v171, 0, v179, s[92:93]
    v_cndmask_b32 v168, 0, v178, s[88:89]
    v_mfma_f32_16x16x32_bf16 v[108:111], a[92:95], v[128:131], v[108:111]
    v_cndmask_b32 v170, 0, v178, s[92:93]
    v_cndmask_b32 v169, v169, v178, s[90:91]
    v_mfma_f32_16x16x32_bf16 v[100:103], a[96:99], v[132:135], v[100:103]
    ds_read_b128 v[116:119], v44 offset:0
    v_cndmask_b32 v171, v171, v178, s[94:95]
    v_mfma_f32_16x16x32_bf16 v[104:107], a[100:103], v[132:135], v[104:107]
    v_xor_b32 v43, v55, v4
    v_cvt_pk_bf16_f32 v96, v96, v97
    v_mfma_f32_16x16x32_bf16 v[108:111], a[104:107], v[132:135], v[108:111]
    s_waitcnt lgkmcnt(2)
    v_cvt_pk_bf16_f32 v97, v98, v99
    v_cvt_pk_bf16_f32 v76, v76, v77
    v_mfma_f32_16x16x32_bf16 v[100:103], a[108:111], v[136:139], v[100:103]
    ds_read_b128 v[120:123], v44 offset:64
    v_cvt_pk_bf16_f32 v77, v78, v79
    v_mfma_f32_16x16x32_bf16 v[104:107], a[112:115], v[136:139], v[104:107]
    ds_write_b64 v38, v[96:97] offset:53248
    v_mfma_f32_16x16x32_bf16 v[108:111], a[116:119], v[136:139], v[108:111]
    v_cvt_pk_bf16_f32 v78, v80, v81
    v_cvt_pk_bf16_f32 v79, v82, v83
    v_mfma_f32_16x16x32_bf16 v[100:103], a[120:123], v[140:143], v[100:103]
    ds_read_b128 v[124:127], v44 offset:128
    v_xor_b32 v44, v56, v4
    v_mfma_f32_16x16x32_bf16 v[104:107], a[124:127], v[140:143], v[104:107]
    ds_read_b64_tr_b16 v[144:145], v172 offset:0
    v_cvt_pk_bf16_f32 v88, v88, v89
    v_mfma_f32_16x16x32_bf16 v[108:111], a[128:131], v[140:143], v[108:111]
    s_waitcnt lgkmcnt(4)
    ds_read_b64_tr_b16 v[146:147], v174 offset:0
    v_cvt_pk_bf16_f32 v89, v90, v91
    v_mfma_f32_16x16x32_bf16 v[100:103], a[132:135], v[112:115], v[100:103]
    ds_read_b64_tr_b16 v[148:149], v173 offset:0
    v_cvt_pk_bf16_f32 v90, v92, v93
    v_mfma_f32_16x16x32_bf16 v[104:107], a[136:139], v[112:115], v[104:107]
    ds_read_b128 v[128:131], v45 offset:0
    v_cvt_pk_bf16_f32 v91, v94, v95
    v_mfma_f32_16x16x32_bf16 v[108:111], a[140:143], v[112:115], v[108:111]
    ds_read_b64_tr_b16 v[150:151], v175 offset:0
    v_mfma_f32_16x16x32_bf16 v[100:103], a[144:147], v[116:119], v[100:103]
    ds_read_b64_tr_b16 v[152:153], v172 offset:64
    v_mfma_f32_16x16x32_bf16 v[104:107], a[148:151], v[116:119], v[104:107]
    ds_read_b64_tr_b16 v[154:155], v174 offset:64
    v_mfma_f32_16x16x32_bf16 v[108:111], a[152:155], v[116:119], v[108:111]
    s_waitcnt lgkmcnt(5)
    ds_read_b128 v[132:135], v45 offset:64
    v_mfma_f32_16x16x32_bf16 v[100:103], a[156:159], v[120:123], v[100:103]
    ds_read_b64_tr_b16 v[156:157], v173 offset:64
    v_mfma_f32_16x16x32_bf16 v[104:107], a[160:163], v[120:123], v[104:107]
    ds_read_b64_tr_b16 v[158:159], v175 offset:64
    v_mfma_f32_16x16x32_bf16 v[108:111], a[164:167], v[120:123], v[108:111]
    ds_read_b64_tr_b16 v[160:161], v172 offset:128
    v_mfma_f32_16x16x32_bf16 v[100:103], a[168:171], v[124:127], v[100:103]
    ds_read_b64_tr_b16 v[162:163], v174 offset:128
    v_mfma_f32_16x16x32_bf16 v[104:107], a[172:175], v[124:127], v[104:107]
    ds_read_b64_tr_b16 v[164:165], v173 offset:128
    v_mfma_f32_16x16x32_bf16 v[108:111], a[176:179], v[124:127], v[108:111]
    s_waitcnt lgkmcnt(5)
    ds_read_b64_tr_b16 v[166:167], v175 offset:128
    v_mfma_f32_16x16x32_bf16 v[100:103], a[180:183], v[128:131], v[100:103]
    ds_read_b128 v[136:139], v45 offset:128
    v_xor_b32 v45, v57, v4
    v_mfma_f32_16x16x32_bf16 v[104:107], a[184:187], v[128:131], v[104:107]
    v_permlane16_swap_b32 v76, v78
    v_mfma_f32_16x16x32_bf16 v[108:111], a[188:191], v[128:131], v[108:111]
    v_permlane16_swap_b32 v77, v79
    v_mfma_f32_16x16x32_bf16 v[100:103], a[192:195], v[132:135], v[100:103]
    ds_read_b128 v[140:143], v46 offset:0
    v_mfma_f32_16x16x32_bf16 v[104:107], a[196:199], v[132:135], v[104:107]
    buffer_store_dwordx4 v[76:79], v19, s[20:23], s4 offen sc1
    v_mfma_f32_16x16x32_bf16 v[108:111], a[200:203], v[132:135], v[108:111]
    v_permlane16_swap_b32 v88, v90
    v_mfma_f32_16x16x32_bf16 v[144:147], v[144:147], v[168:171], 0
    ds_read_b128 v[112:115], v46 offset:64
    v_mfma_f32_16x16x32_bf16 v[148:151], v[148:151], v[168:171], 0
    v_permlane16_swap_b32 v89, v91
    v_mfma_f32_16x16x32_bf16 v[152:155], v[152:155], v[168:171], 0
    s_waitcnt lgkmcnt(2)
    v_mfma_f32_16x16x32_bf16 v[156:159], v[156:159], v[168:171], 0
    ds_read_b128 v[116:119], v46 offset:128
    v_xor_b32 v46, v58, v4
    v_mfma_f32_16x16x32_bf16 v[160:163], v[160:163], v[168:171], 0
    buffer_store_dwordx4 v[88:91], v19, s[20:23], s5 offen sc1
    v_cvt_pk_bf16_f32 v144, v144, v145
    v_cvt_pk_bf16_f32 v145, v146, v147
    v_cvt_pk_bf16_f32 v148, v148, v149
    v_mfma_f32_16x16x32_bf16 v[164:167], v[164:167], v[168:171], 0
    ds_write_b64 v28, v[144:145] offset:12288
    v_mfma_f32_16x16x32_bf16 v[100:103], a[204:207], v[136:139], v[100:103]
    ds_read_b128 v[120:123], v47 offset:0
    v_mfma_f32_16x16x32_bf16 v[104:107], a[208:211], v[136:139], v[104:107]
    v_cvt_pk_bf16_f32 v149, v150, v151
    v_cvt_pk_bf16_f32 v152, v152, v153
    v_mfma_f32_16x16x32_bf16 v[108:111], a[212:215], v[136:139], v[108:111]
    s_waitcnt lgkmcnt(3)
    ds_write_b64 v29, v[148:149] offset:12288
    v_mfma_f32_16x16x32_bf16 v[100:103], a[216:219], v[140:143], v[100:103]
    ds_read_b128 v[124:127], v47 offset:64
    v_mfma_f32_16x16x32_bf16 v[104:107], a[220:223], v[140:143], v[104:107]
    v_cvt_pk_bf16_f32 v153, v154, v155
    v_cvt_pk_bf16_f32 v156, v156, v157
    v_mfma_f32_16x16x32_bf16 v[108:111], a[224:227], v[140:143], v[108:111]
    ds_read2_b32 v[176:177], v24 offset0:128 offset1:160
    v_cvt_pk_bf16_f32 v157, v158, v159
    v_mfma_f32_16x16x32_bf16 v[100:103], a[228:231], v[112:115], v[100:103]
    ds_read_b128 v[128:131], v47 offset:128
    v_cvt_pk_bf16_f32 v160, v160, v161
    v_mfma_f32_16x16x32_bf16 v[104:107], a[232:235], v[112:115], v[104:107]
    ds_write_b64 v28, v[152:153] offset:12352
    v_mfma_f32_16x16x32_bf16 v[108:111], a[236:239], v[112:115], v[108:111]
    s_waitcnt lgkmcnt(4)
    ds_read_b64 v[178:179], v25 offset:520
    v_mfma_f32_16x16x32_bf16 v[100:103], a[240:243], v[116:119], v[100:103]
    ds_read_b128 v[132:135], v48 offset:0
    v_cvt_pk_bf16_f32 v161, v162, v163
    v_mfma_f32_16x16x32_bf16 v[104:107], a[244:247], v[116:119], v[104:107]
    ds_write_b64 v29, v[156:157] offset:12352
    v_mfma_f32_16x16x32_bf16 v[108:111], a[248:251], v[116:119], v[108:111]
    s_waitcnt lgkmcnt(5)
    v_xor_b32 v172, v176, v26
    v_xor_b32 v174, v177, v26
    v_mfma_f32_16x16x32_bf16 v[100:103], a[252:255], v[120:123], v[100:103]
    ds_read_b128 v[136:139], v48 offset:64
    v_xor_b32 v173, v176, v27
    v_mfma_f32_16x16x32_bf16 v[104:107], v[188:191], v[120:123], v[104:107]
    ds_write_b64 v28, v[160:161] offset:12416
    v_mfma_f32_16x16x32_bf16 v[108:111], v[192:195], v[120:123], v[108:111]
    s_waitcnt lgkmcnt(4)
    v_xor_b32 v175, v177, v27
    v_cvt_pk_bf16_f32 v164, v164, v165
    v_mfma_f32_16x16x32_bf16 v[100:103], v[196:199], v[124:127], v[100:103]
    ds_read_b128 v[140:143], v48 offset:128
    v_cvt_pk_bf16_f32 v165, v166, v167
    v_mfma_f32_16x16x32_bf16 v[104:107], v[200:203], v[124:127], v[104:107]
    ds_write_b64 v29, v[164:165] offset:12416
    v_mfma_f32_16x16x32_bf16 v[108:111], v[204:207], v[124:127], v[108:111]
    v_cndmask_b32 v169, 0, v179, s[88:89]
    v_cndmask_b32 v171, 0, v179, s[92:93]
    v_mfma_f32_16x16x32_bf16 v[100:103], v[208:211], v[128:131], v[100:103]
    ds_read_b128 v[112:115], v40 offset:0
    v_cndmask_b32 v168, 0, v178, s[88:89]
    v_mfma_f32_16x16x32_bf16 v[104:107], v[212:215], v[128:131], v[104:107]
    v_cndmask_b32 v170, 0, v178, s[92:93]
    v_cndmask_b32 v169, v169, v178, s[90:91]
    v_mfma_f32_16x16x32_bf16 v[108:111], v[216:219], v[128:131], v[108:111]
    s_waitcnt lgkmcnt(3)
    v_cndmask_b32 v171, v171, v178, s[94:95]
    v_xor_b32 v47, v59, v4
    v_mfma_f32_16x16x32_bf16 v[100:103], v[220:223], v[132:135], v[100:103]
    ds_read_b128 v[116:119], v40 offset:64
    v_xor_b32 v48, v60, v4
    v_mfma_f32_16x16x32_bf16 v[104:107], v[224:227], v[132:135], v[104:107]
    v_mfma_f32_16x16x32_bf16 v[108:111], v[228:231], v[132:135], v[108:111]
    v_mfma_f32_16x16x32_bf16 v[100:103], v[232:235], v[136:139], v[100:103]
    ds_read_b128 v[120:123], v40 offset:128
    v_mfma_f32_16x16x32_bf16 v[104:107], v[236:239], v[136:139], v[104:107]
    ds_read_b64_tr_b16 v[144:145], v172 offset:0
    v_mfma_f32_16x16x32_bf16 v[108:111], v[240:243], v[136:139], v[108:111]
    s_waitcnt lgkmcnt(3)
    ds_read_b64_tr_b16 v[146:147], v174 offset:0
    v_mfma_f32_16x16x32_bf16 v[100:103], v[244:247], v[140:143], v[100:103]
    ds_read_b64_tr_b16 v[148:149], v173 offset:0
    v_mfma_f32_16x16x32_bf16 v[104:107], v[248:251], v[140:143], v[104:107]
    ds_read_b128 v[124:127], v41 offset:0
    v_mfma_f32_16x16x32_bf16 v[108:111], v[252:255], v[140:143], v[108:111]
    s_waitcnt vmcnt(3) lgkmcnt(5)
    ds_read_b64_tr_b16 v[150:151], v175 offset:0
    v_mfma_f32_16x16x32_bf16 v[64:67], a[0:3], v[112:115], 0
    ds_read_b64_tr_b16 v[152:153], v172 offset:64
    v_and_b32 v180, s96, v180
    v_mfma_f32_16x16x32_bf16 v[68:71], a[4:7], v[112:115], 0
    ds_read_b64_tr_b16 v[154:155], v174 offset:64
    v_and_b32 v181, s96, v181
    v_mfma_f32_16x16x32_bf16 v[72:75], a[8:11], v[112:115], 0
    ds_read_b128 v[128:131], v41 offset:64
    v_cvt_pk_bf16_f32 v108, v108, v109
    v_mfma_f32_16x16x32_bf16 v[64:67], a[12:15], v[116:119], v[64:67]
    ds_read_b64_tr_b16 v[156:157], v173 offset:64
    v_cvt_pk_bf16_f32 v109, v110, v111
    v_mfma_f32_16x16x32_bf16 v[68:71], a[16:19], v[116:119], v[68:71]
    ds_read_b64_tr_b16 v[158:159], v175 offset:64
    v_and_b32 v182, s96, v182
    v_mfma_f32_16x16x32_bf16 v[72:75], a[20:23], v[116:119], v[72:75]
    s_waitcnt lgkmcnt(5)
    ds_read_b64_tr_b16 v[160:161], v172 offset:128
    v_and_b32 v183, s96, v183
    v_mfma_f32_16x16x32_bf16 v[64:67], a[24:27], v[120:123], v[64:67]
    ds_read_b64_tr_b16 v[162:163], v174 offset:128
    v_pk_max_u16 v180, v180, v181
    v_mfma_f32_16x16x32_bf16 v[68:71], a[28:31], v[120:123], v[68:71]
    ds_read_b64_tr_b16 v[164:165], v173 offset:128
    v_pk_max_u16 v182, v182, v183
    v_mfma_f32_16x16x32_bf16 v[72:75], a[32:35], v[120:123], v[72:75]
    ds_read_b64_tr_b16 v[166:167], v175 offset:128
    v_pk_max_u16 v180, v180, s37
    v_mfma_f32_16x16x32_bf16 v[64:67], a[36:39], v[124:127], v[64:67]
    ds_read_b128 v[132:135], v41 offset:128
    v_pk_max_u16 v180, v180, v182
    v_mfma_f32_16x16x32_bf16 v[68:71], a[40:43], v[124:127], v[68:71]
    ds_read_b128 v[52:55], v23 offset:0
    v_cmp_ne_u32 s[80:81], s37, v180
    v_mfma_f32_16x16x32_bf16 v[72:75], a[44:47], v[124:127], v[72:75]
    s_waitcnt lgkmcnt(5)
    ds_read2_b32 v[176:177], v24 offset0:192 offset1:224
    v_and_b32 v184, s96, v184
    v_mfma_f32_16x16x32_bf16 v[64:67], a[48:51], v[128:131], v[64:67]
    ds_read_b128 v[136:139], v42 offset:0
    v_and_b32 v185, s96, v185
    v_mfma_f32_16x16x32_bf16 v[68:71], a[52:55], v[128:131], v[68:71]
    ds_read_b64 v[178:179], v25 offset:776
    v_and_b32 v186, s96, v186
    v_mfma_f32_16x16x32_bf16 v[72:75], a[56:59], v[128:131], v[72:75]
    ds_write_b64 v38, v[108:109] offset:55296
    v_mfma_f32_16x16x32_bf16 v[144:147], v[144:147], v[168:171], 0
    ds_read_b128 v[140:143], v42 offset:64
    v_mfma_f32_16x16x32_bf16 v[148:151], v[148:151], v[168:171], 0
    ds_read_b128 v[56:59], v23 offset:16
    v_and_b32 v187, s96, v187
    v_mfma_f32_16x16x32_bf16 v[152:155], v[152:155], v[168:171], 0
    s_waitcnt lgkmcnt(5)
    ds_read_b32 v60, v23 offset:32
    v_xor_b32 v172, v176, v26
    v_mfma_f32_16x16x32_bf16 v[156:159], v[156:159], v[168:171], 0
    ds_read_b128 v[112:115], v42 offset:128
    v_cvt_pk_bf16_f32 v144, v144, v145
    v_mfma_f32_16x16x32_bf16 v[160:163], v[160:163], v[168:171], 0
    v_cvt_pk_bf16_f32 v145, v146, v147
    v_cvt_pk_bf16_f32 v148, v148, v149
    v_mfma_f32_16x16x32_bf16 v[164:167], v[164:167], v[168:171], 0
    s_waitcnt lgkmcnt(4)
    ds_write_b64 v28, v[144:145] offset:24576
    v_mfma_f32_16x16x32_bf16 v[64:67], a[60:63], v[132:135], v[64:67]
    ds_read_b128 v[116:119], v43 offset:0
    v_mfma_f32_16x16x32_bf16 v[68:71], a[64:67], v[132:135], v[68:71]
    v_cvt_pk_bf16_f32 v149, v150, v151
    v_xor_b32 v174, v177, v26
    v_mfma_f32_16x16x32_bf16 v[72:75], a[68:71], v[132:135], v[72:75]
    s_waitcnt lgkmcnt(3)
    ds_write_b64 v29, v[148:149] offset:24576
    v_mfma_f32_16x16x32_bf16 v[64:67], a[72:75], v[136:139], v[64:67]
    ds_read_b128 v[120:123], v43 offset:64
    v_mfma_f32_16x16x32_bf16 v[68:71], a[76:79], v[136:139], v[68:71]
    v_xor_b32 v173, v176, v27
    v_cvt_pk_bf16_f32 v152, v152, v153
    v_mfma_f32_16x16x32_bf16 v[72:75], a[80:83], v[136:139], v[72:75]
    v_cvt_pk_bf16_f32 v153, v154, v155
    v_xor_b32 v175, v177, v27
    v_mfma_f32_16x16x32_bf16 v[64:67], a[84:87], v[140:143], v[64:67]
    ds_read_b128 v[124:127], v43 offset:128
    v_cvt_pk_bf16_f32 v156, v156, v157
    v_mfma_f32_16x16x32_bf16 v[68:71], a[88:91], v[140:143], v[68:71]
    ds_write_b64 v28, v[152:153] offset:24640
    v_mfma_f32_16x16x32_bf16 v[72:75], a[92:95], v[140:143], v[72:75]
    s_waitcnt lgkmcnt(3)
    v_cvt_pk_bf16_f32 v157, v158, v159
    v_cvt_pk_bf16_f32 v160, v160, v161
    v_mfma_f32_16x16x32_bf16 v[64:67], a[96:99], v[112:115], v[64:67]
    ds_read_b128 v[128:131], v44 offset:0
    v_cvt_pk_bf16_f32 v161, v162, v163
    v_mfma_f32_16x16x32_bf16 v[68:71], a[100:103], v[112:115], v[68:71]
    ds_read_b64_tr_b16 v[144:145], v172 offset:0
    v_cvt_pk_bf16_f32 v164, v164, v165
    v_mfma_f32_16x16x32_bf16 v[72:75], a[104:107], v[112:115], v[72:75]
    ds_read_b64_tr_b16 v[146:147], v174 offset:0
    v_cvt_pk_bf16_f32 v165, v166, v167
    v_mfma_f32_16x16x32_bf16 v[64:67], a[108:111], v[116:119], v[64:67]
    ds_read_b64_tr_b16 v[148:149], v173 offset:0
    v_cndmask_b32 v169, 0, v179, s[88:89]
    v_mfma_f32_16x16x32_bf16 v[68:71], a[112:115], v[116:119], v[68:71]
    ds_read_b128 v[132:135], v44 offset:64
    v_cndmask_b32 v171, 0, v179, s[92:93]
    v_mfma_f32_16x16x32_bf16 v[72:75], a[116:119], v[116:119], v[72:75]
    s_waitcnt lgkmcnt(5)
    ds_read_b64_tr_b16 v[150:151], v175 offset:0
    v_cndmask_b32 v168, 0, v178, s[88:89]
    v_mfma_f32_16x16x32_bf16 v[64:67], a[120:123], v[120:123], v[64:67]
    ds_read_b64_tr_b16 v[152:153], v172 offset:64
    v_cndmask_b32 v170, 0, v178, s[92:93]
    v_mfma_f32_16x16x32_bf16 v[68:71], a[124:127], v[120:123], v[68:71]
L_pgY2:
  s_cbranch_execz L_retY
    ds_read_b64_tr_b16 v[154:155], v174 offset:64
    v_cndmask_b32 v169, v169, v178, s[90:91]
    v_mfma_f32_16x16x32_bf16 v[72:75], a[128:131], v[120:123], v[72:75]
    ds_write_b64 v29, v[156:157] offset:24640
    v_mfma_f32_16x16x32_bf16 v[64:67], a[132:135], v[124:127], v[64:67]
    ds_read_b128 v[136:139], v44 offset:128
    v_mfma_f32_16x16x32_bf16 v[68:71], a[136:139], v[124:127], v[68:71]
    ds_read_b64_tr_b16 v[156:157], v173 offset:64
    v_cndmask_b32 v171, v171, v178, s[94:95]
    v_mfma_f32_16x16x32_bf16 v[72:75], a[140:143], v[124:127], v[72:75]
    s_waitcnt lgkmcnt(5)
    ds_read_b64_tr_b16 v[158:159], v175 offset:64
    v_pk_max_u16 v184, v184, v185
    v_mfma_f32_16x16x32_bf16 v[64:67], a[144:147], v[128:131], v[64:67]
    ds_write_b64 v28, v[160:161] offset:24704
    v_mfma_f32_16x16x32_bf16 v[68:71], a[148:151], v[128:131], v[68:71]
    ds_read_b64_tr_b16 v[160:161], v172 offset:128
    v_mfma_f32_16x16x32_bf16 v[72:75], a[152:155], v[128:131], v[72:75]
    ds_read_b64_tr_b16 v[162:163], v174 offset:128
    v_pk_max_u16 v186, v186, v187
    v_mfma_f32_16x16x32_bf16 v[64:67], a[156:159], v[132:135], v[64:67]
    ds_write_b64 v29, v[164:165] offset:24704
    v_mfma_f32_16x16x32_bf16 v[68:71], a[160:163], v[132:135], v[68:71]
    ds_read_b64_tr_b16 v[164:165], v173 offset:128
    v_mfma_f32_16x16x32_bf16 v[72:75], a[164:167], v[132:135], v[72:75]
    s_waitcnt lgkmcnt(5)
    ds_read_b64_tr_b16 v[166:167], v175 offset:128
    v_pk_max_u16 v184, v184, s37
    v_mfma_f32_16x16x32_bf16 v[64:67], a[168:171], v[136:139], v[64:67]
    ds_read_b128 v[140:143], v45 offset:0
    v_pk_max_u16 v184, v184, v186
    v_mfma_f32_16x16x32_bf16 v[68:71], a[172:175], v[136:139], v[68:71]
    ds_read_b128 v[112:115], v45 offset:64
    v_cmp_ne_u32 s[82:83], s37, v184
    v_mfma_f32_16x16x32_bf16 v[72:75], a[176:179], v[136:139], v[72:75]
    v_xor_b32 v40, v52, v4
    v_xor_b32 v41, v53, v4
    v_mfma_f32_16x16x32_bf16 v[144:147], v[144:147], v[168:171], 0
    ds_read_b128 v[116:119], v45 offset:128
    v_xor_b32 v42, v54, v4
    v_mfma_f32_16x16x32_bf16 v[148:151], v[148:151], v[168:171], 0
    s_or_b64 vcc, s[80:81], s[82:83]
    s_cbranch_scc1 L_afailY
L_afailY_back:
    v_mfma_f32_16x16x32_bf16 v[152:155], v[152:155], v[168:171], 0
    s_waitcnt lgkmcnt(3)
    v_xor_b32 v43, v55, v4
    v_cvt_pk_bf16_f32 v144, v144, v145
    v_mfma_f32_16x16x32_bf16 v[156:159], v[156:159], v[168:171], 0
    ds_read_b128 v[120:123], v46 offset:0
    v_cvt_pk_bf16_f32 v145, v146, v147
    v_mfma_f32_16x16x32_bf16 v[160:163], v[160:163], v[168:171], 0
    ds_write_b64 v28, v[144:145] offset:36864
    v_mfma_f32_16x16x32_bf16 v[164:167], v[164:167], v[168:171], 0
    s_waitcnt lgkmcnt(3)
    v_cvt_pk_bf16_f32 v148, v148, v149
    v_cvt_pk_bf16_f32 v149, v150, v151
    v_mfma_f32_16x16x32_bf16 v[64:67], a[180:183], v[140:143], v[64:67]
    ds_read_b128 v[124:127], v46 offset:64
    v_cvt_pk_bf16_f32 v152, v152, v153
    v_mfma_f32_16x16x32_bf16 v[68:71], a[184:187], v[140:143], v[68:71]
    ds_write_b64 v29, v[148:149] offset:36864
    v_mfma_f32_16x16x32_bf16 v[72:75], a[188:191], v[140:143], v[72:75]
    v_cvt_pk_bf16_f32 v153, v154, v155
    v_cvt_pk_bf16_f32 v156, v156, v157
    v_mfma_f32_16x16x32_bf16 v[64:67], a[192:195], v[112:115], v[64:67]
    ds_read_b128 v[128:131], v46 offset:128
    v_cvt_pk_bf16_f32 v157, v158, v159
    v_mfma_f32_16x16x32_bf16 v[68:71], a[196:199], v[112:115], v[68:71]
    ds_write_b64 v28, v[152:153] offset:36928
    v_mfma_f32_16x16x32_bf16 v[72:75], a[200:203], v[112:115], v[72:75]
    s_waitcnt lgkmcnt(4)
    v_cvt_pk_bf16_f32 v160, v160, v161
    v_cvt_pk_bf16_f32 v161, v162, v163
    v_mfma_f32_16x16x32_bf16 v[64:67], a[204:207], v[116:119], v[64:67]
    ds_read_b128 v[132:135], v47 offset:0
    v_cvt_pk_bf16_f32 v164, v164, v165
    v_mfma_f32_16x16x32_bf16 v[68:71], a[208:211], v[116:119], v[68:71]
    ds_write_b64 v29, v[156:157] offset:36928
    v_mfma_f32_16x16x32_bf16 v[72:75], a[212:215], v[116:119], v[72:75]
    v_cvt_pk_bf16_f32 v165, v166, v167
    v_xor_b32 v44, v56, v4
    v_mfma_f32_16x16x32_bf16 v[64:67], a[216:219], v[120:123], v[64:67]
    ds_read_b128 v[136:139], v47 offset:64
    v_xor_b32 v45, v57, v4
    v_mfma_f32_16x16x32_bf16 v[68:71], a[220:223], v[120:123], v[68:71]
    ds_write_b64 v28, v[160:161] offset:36992
    v_mfma_f32_16x16x32_bf16 v[72:75], a[224:227], v[120:123], v[72:75]
    s_waitcnt lgkmcnt(4)
    v_xor_b32 v46, v58, v4
    v_cvt_pk_bf16_f32 v100, v100, v101
    v_mfma_f32_16x16x32_bf16 v[64:67], a[228:231], v[124:127], v[64:67]
    ds_read_b128 v[140:143], v47 offset:128
    v_xor_b32 v47, v59, v4
    v_mfma_f32_16x16x32_bf16 v[68:71], a[232:235], v[124:127], v[68:71]
    ds_write_b64 v29, v[164:165] offset:36992
    v_mfma_f32_16x16x32_bf16 v[72:75], a[236:239], v[124:127], v[72:75]
    v_cvt_pk_bf16_f32 v101, v102, v103
    v_cvt_pk_bf16_f32 v102, v104, v105
    v_mfma_f32_16x16x32_bf16 v[64:67], a[240:243], v[128:131], v[64:67]
    ds_read_b128 v[112:115], v48 offset:0
    v_cvt_pk_bf16_f32 v103, v106, v107
    v_mfma_f32_16x16x32_bf16 v[68:71], a[244:247], v[128:131], v[68:71]
    v_permlane16_swap_b32 v100, v102
    v_mfma_f32_16x16x32_bf16 v[72:75], a[248:251], v[128:131], v[72:75]
    s_waitcnt lgkmcnt(3)
    v_permlane16_swap_b32 v101, v103
    v_mfma_f32_16x16x32_bf16 v[64:67], a[252:255], v[132:135], v[64:67]
    ds_read_b128 v[116:119], v48 offset:64
    v_mfma_f32_16x16x32_bf16 v[68:71], v[188:191], v[132:135], v[68:71]
    buffer_store_dwordx4 v[100:103], v21, s[20:23], s74 offen sc1
    v_mfma_f32_16x16x32_bf16 v[72:75], v[192:195], v[132:135], v[72:75]
    v_mfma_f32_16x16x32_bf16 v[64:67], v[196:199], v[136:139], v[64:67]
    ds_read_b128 v[120:123], v48 offset:128
    v_xor_b32 v48, v60, v4
    v_mfma_f32_16x16x32_bf16 v[68:71], v[200:203], v[136:139], v[68:71]
    v_mfma_f32_16x16x32_bf16 v[72:75], v[204:207], v[136:139], v[72:75]
    s_waitcnt lgkmcnt(2)
    s_barrier
    v_mfma_f32_16x16x32_bf16 v[64:67], v[208:211], v[140:143], v[64:67]
    ds_read_b128 v[124:127], v40 offset:0
    v_mfma_f32_16x16x32_bf16 v[68:71], v[212:215], v[140:143], v[68:71]
    ds_read_b32 v35, v34
    v_mfma_f32_16x16x32_bf16 v[72:75], v[216:219], v[140:143], v[72:75]
    ds_read_b64 v[6:7], v39 offset:49152
    v_mfma_f32_16x16x32_bf16 v[64:67], v[220:223], v[112:115], v[64:67]
    ds_read_b128 v[128:131], v40 offset:64
    v_mfma_f32_16x16x32_bf16 v[68:71], v[224:227], v[112:115], v[68:71]
    ds_read_b64 v[12:13], v39 offset:55296
    v_mfma_f32_16x16x32_bf16 v[72:75], v[228:231], v[112:115], v[72:75]
    s_waitcnt lgkmcnt(5)
    v_mfma_f32_16x16x32_bf16 v[64:67], v[232:235], v[116:119], v[64:67]
    ds_read_b128 v[132:135], v40 offset:128
    v_mfma_f32_16x16x32_bf16 v[68:71], v[236:239], v[116:119], v[68:71]
    v_mfma_f32_16x16x32_bf16 v[72:75], v[240:243], v[116:119], v[72:75]
    s_waitcnt lgkmcnt(3)
    v_readfirstlane_b32 s63, v35
    v_mfma_f32_16x16x32_bf16 v[64:67], v[244:247], v[120:123], v[64:67]
    ds_read_b128 v[136:139], v41 offset:0
    v_mfma_f32_16x16x32_bf16 v[68:71], v[248:251], v[120:123], v[68:71]
    buffer_store_dwordx2 v[6:7], v20, s[20:23], s56 offen sc1
    v_mfma_f32_16x16x32_bf16 v[72:75], v[252:255], v[120:123], v[72:75]
    s_waitcnt lgkmcnt(2)
    v_mfma_f32_16x16x32_bf16 v[76:79], a[0:3], v[124:127], 0
    ds_read_b128 v[140:143], v41 offset:64
    v_mfma_f32_16x16x32_bf16 v[80:83], a[4:7], v[124:127], 0
    v_cvt_pk_bf16_f32 v64, v64, v65
    v_cvt_pk_bf16_f32 v65, v66, v67
    v_mfma_f32_16x16x32_bf16 v[84:87], a[8:11], v[124:127], 0
    buffer_store_dwordx2 v[12:13], v22, s[20:23], s74 offen sc1
    v_cvt_pk_bf16_f32 v72, v72, v73
    v_mfma_f32_16x16x32_bf16 v[76:79], a[12:15], v[128:131], v[76:79]
    ds_read_b128 v[112:115], v41 offset:128
    v_cvt_pk_bf16_f32 v73, v74, v75
    v_mfma_f32_16x16x32_bf16 v[80:83], a[16:19], v[128:131], v[80:83]
    ds_write_b64 v38, v[72:73] offset:57344
    v_mfma_f32_16x16x32_bf16 v[84:87], a[20:23], v[128:131], v[84:87]
    s_waitcnt lgkmcnt(3)
    v_cvt_pk_bf16_f32 v66, v68, v69
    v_cvt_pk_bf16_f32 v67, v70, v71
    v_mfma_f32_16x16x32_bf16 v[76:79], a[24:27], v[132:135], v[76:79]
    ds_read_b128 v[116:119], v42 offset:0
    v_mfma_f32_16x16x32_bf16 v[80:83], a[28:31], v[132:135], v[80:83]
    v_permlane16_swap_b32 v64, v66
    v_mfma_f32_16x16x32_bf16 v[84:87], a[32:35], v[132:135], v[84:87]
    v_permlane16_swap_b32 v65, v67
    v_mfma_f32_16x16x32_bf16 v[76:79], a[36:39], v[136:139], v[76:79]
    ds_read_b128 v[120:123], v42 offset:64
    v_mfma_f32_16x16x32_bf16 v[80:83], a[40:43], v[136:139], v[80:83]
    buffer_store_dwordx4 v[64:67], v21, s[20:23], s75 offen sc1
    v_mfma_f32_16x16x32_bf16 v[84:87], a[44:47], v[136:139], v[84:87]
    s_waitcnt lgkmcnt(2)
    v_mfma_f32_16x16x32_bf16 v[76:79], a[48:51], v[140:143], v[76:79]
    ds_read_b128 v[124:127], v42 offset:128
    v_mfma_f32_16x16x32_bf16 v[80:83], a[52:55], v[140:143], v[80:83]
    ds_read_b64 v[8:9], v39 offset:51200
    v_mfma_f32_16x16x32_bf16 v[84:87], a[56:59], v[140:143], v[84:87]
    v_mfma_f32_16x16x32_bf16 v[76:79], a[60:63], v[112:115], v[76:79]
    ds_read_b128 v[128:131], v43 offset:0
    v_mfma_f32_16x16x32_bf16 v[80:83], a[64:67], v[112:115], v[80:83]
    v_mfma_f32_16x16x32_bf16 v[84:87], a[68:71], v[112:115], v[84:87]
    s_waitcnt lgkmcnt(3)
    v_mfma_f32_16x16x32_bf16 v[76:79], a[72:75], v[116:119], v[76:79]
    ds_read_b128 v[132:135], v43 offset:64
    v_mfma_f32_16x16x32_bf16 v[80:83], a[76:79], v[116:119], v[80:83]
    v_mfma_f32_16x16x32_bf16 v[84:87], a[80:83], v[116:119], v[84:87]
    s_waitcnt lgkmcnt(2)
    v_mfma_f32_16x16x32_bf16 v[76:79], a[84:87], v[120:123], v[76:79]
    ds_read_b128 v[136:139], v43 offset:128
    v_mfma_f32_16x16x32_bf16 v[80:83], a[88:91], v[120:123], v[80:83]
    buffer_store_dwordx2 v[8:9], v20, s[20:23], s4 offen sc1
    v_mfma_f32_16x16x32_bf16 v[84:87], a[92:95], v[120:123], v[84:87]
    s_barrier
    v_mfma_f32_16x16x32_bf16 v[76:79], a[96:99], v[124:127], v[76:79]
    ds_read_b128 v[140:143], v44 offset:0
    v_mfma_f32_16x16x32_bf16 v[80:83], a[100:103], v[124:127], v[80:83]
    ds_read_b64 v[14:15], v39 offset:57344
    v_mfma_f32_16x16x32_bf16 v[84:87], a[104:107], v[124:127], v[84:87]
    s_waitcnt lgkmcnt(3)
    v_mfma_f32_16x16x32_bf16 v[76:79], a[108:111], v[128:131], v[76:79]
    ds_read_b128 v[112:115], v44 offset:64
    v_mfma_f32_16x16x32_bf16 v[80:83], a[112:115], v[128:131], v[80:83]
    v_mfma_f32_16x16x32_bf16 v[84:87], a[116:119], v[128:131], v[84:87]
    v_mfma_f32_16x16x32_bf16 v[76:79], a[120:123], v[132:135], v[76:79]
    ds_read_b128 v[116:119], v44 offset:128
    v_mfma_f32_16x16x32_bf16 v[80:83], a[124:127], v[132:135], v[80:83]
    v_mfma_f32_16x16x32_bf16 v[84:87], a[128:131], v[132:135], v[84:87]
    s_waitcnt lgkmcnt(2)
    v_mfma_f32_16x16x32_bf16 v[76:79], a[132:135], v[136:139], v[76:79]
    ds_read_b128 v[120:123], v45 offset:0
    v_mfma_f32_16x16x32_bf16 v[80:83], a[136:139], v[136:139], v[80:83]
    buffer_store_dwordx2 v[14:15], v22, s[20:23], s75 offen sc1
    v_mfma_f32_16x16x32_bf16 v[84:87], a[140:143], v[136:139], v[84:87]
    v_mfma_f32_16x16x32_bf16 v[76:79], a[144:147], v[140:143], v[76:79]
    ds_read_b128 v[124:127], v45 offset:64
    v_mfma_f32_16x16x32_bf16 v[80:83], a[148:151], v[140:143], v[80:83]
    ds_read_b64 v[10:11], v39 offset:53248
    v_mfma_f32_16x16x32_bf16 v[84:87], a[152:155], v[140:143], v[84:87]
    s_waitcnt lgkmcnt(3)
    v_mfma_f32_16x16x32_bf16 v[76:79], a[156:159], v[112:115], v[76:79]
    ds_read_b128 v[128:131], v45 offset:128
    v_mfma_f32_16x16x32_bf16 v[80:83], a[160:163], v[112:115], v[80:83]
    v_mfma_f32_16x16x32_bf16 v[84:87], a[164:167], v[112:115], v[84:87]
    v_mfma_f32_16x16x32_bf16 v[76:79], a[168:171], v[116:119], v[76:79]
    ds_read_b128 v[132:135], v46 offset:0
    v_mfma_f32_16x16x32_bf16 v[80:83], a[172:175], v[116:119], v[80:83]
    v_mfma_f32_16x16x32_bf16 v[84:87], a[176:179], v[116:119], v[84:87]
    s_waitcnt lgkmcnt(2)
    v_mfma_f32_16x16x32_bf16 v[76:79], a[180:183], v[120:123], v[76:79]
    ds_read_b128 v[136:139], v46 offset:64
    v_mfma_f32_16x16x32_bf16 v[80:83], a[184:187], v[120:123], v[80:83]
    buffer_store_dwordx2 v[10:11], v20, s[20:23], s5 offen sc1
    v_mfma_f32_16x16x32_bf16 v[84:87], a[188:191], v[120:123], v[84:87]
    v_mfma_f32_16x16x32_bf16 v[76:79], a[192:195], v[124:127], v[76:79]
    ds_read_b128 v[140:143], v46 offset:128
    v_mfma_f32_16x16x32_bf16 v[80:83], a[196:199], v[124:127], v[80:83]
    v_mfma_f32_16x16x32_bf16 v[84:87], a[200:203], v[124:127], v[84:87]
    s_waitcnt lgkmcnt(2)
    v_mfma_f32_16x16x32_bf16 v[76:79], a[204:207], v[128:131], v[76:79]
    ds_read_b128 v[112:115], v47 offset:0
    v_mfma_f32_16x16x32_bf16 v[80:83], a[208:211], v[128:131], v[80:83]
    ds_read_b128 v[116:119], v47 offset:64
    v_mfma_f32_16x16x32_bf16 v[84:87], a[212:215], v[128:131], v[84:87]
    ds_read_b128 v[120:123], v47 offset:128
    v_mfma_f32_16x16x32_bf16 v[76:79], a[216:219], v[132:135], v[76:79]
    ds_read_b128 v[124:127], v48 offset:0
    v_mfma_f32_16x16x32_bf16 v[80:83], a[220:223], v[132:135], v[80:83]
    ds_read_b128 v[128:131], v48 offset:64
    v_mfma_f32_16x16x32_bf16 v[84:87], a[224:227], v[132:135], v[84:87]
    s_waitcnt lgkmcnt(5)
    ds_read_b128 v[132:135], v48 offset:128
    v_mfma_f32_16x16x32_bf16 v[76:79], a[228:231], v[136:139], v[76:79]
    v_mfma_f32_16x16x32_bf16 v[80:83], a[232:235], v[136:139], v[80:83]
    v_mfma_f32_16x16x32_bf16 v[84:87], a[236:239], v[136:139], v[84:87]
    v_mfma_f32_16x16x32_bf16 v[76:79], a[240:243], v[140:143], v[76:79]
    v_mfma_f32_16x16x32_bf16 v[80:83], a[244:247], v[140:143], v[80:83]
    v_mfma_f32_16x16x32_bf16 v[84:87], a[248:251], v[140:143], v[84:87]
    s_waitcnt lgkmcnt(0)
    v_mfma_f32_16x16x32_bf16 v[84:87], v[192:195], v[112:115], v[84:87]
    v_mfma_f32_16x16x32_bf16 v[84:87], v[204:207], v[116:119], v[84:87]
    v_mfma_f32_16x16x32_bf16 v[84:87], v[216:219], v[120:123], v[84:87]
    v_mfma_f32_16x16x32_bf16 v[84:87], v[228:231], v[124:127], v[84:87]
    v_mfma_f32_16x16x32_bf16 v[84:87], v[240:243], v[128:131], v[84:87]
    v_mfma_f32_16x16x32_bf16 v[84:87], v[252:255], v[132:135], v[84:87]
    s_nop 2
    v_mfma_f32_16x16x32_bf16 v[76:79], a[252:255], v[112:115], v[76:79]
    s_nop 2
    v_mfma_f32_16x16x32_bf16 v[76:79], v[196:199], v[116:119], v[76:79]
    v_cvt_pk_bf16_f32 v84, v84, v85
    v_cvt_pk_bf16_f32 v85, v86, v87
    v_mfma_f32_16x16x32_bf16 v[76:79], v[208:211], v[120:123], v[76:79]
    ds_write_b64 v38, v[84:85] offset:59392
    v_mfma_f32_16x16x32_bf16 v[76:79], v[220:223], v[124:127], v[76:79]
    v_mfma_f32_16x16x32_bf16 v[76:79], v[232:235], v[128:131], v[76:79]
    v_mfma_f32_16x16x32_bf16 v[76:79], v[244:247], v[132:135], v[76:79]
    v_mfma_f32_16x16x32_bf16 v[80:83], v[188:191], v[112:115], v[80:83]
    s_waitcnt lgkmcnt(0)
    s_barrier
    v_mfma_f32_16x16x32_bf16 v[80:83], v[200:203], v[116:119], v[80:83]
    ds_read_b64 v[62:63], v39 offset:59392
    v_mfma_f32_16x16x32_bf16 v[80:83], v[212:215], v[120:123], v[80:83]
    s_nop 0
    v_mfma_f32_16x16x32_bf16 v[80:83], v[224:227], v[124:127], v[80:83]
    v_mfma_f32_16x16x32_bf16 v[80:83], v[236:239], v[128:131], v[80:83]
    v_cvt_pk_bf16_f32 v76, v76, v77
    v_cvt_pk_bf16_f32 v77, v78, v79
    v_mfma_f32_16x16x32_bf16 v[80:83], v[248:251], v[132:135], v[80:83]
    s_waitcnt lgkmcnt(0)
    buffer_store_dwordx2 v[62:63], v22, s[20:23], s76 offen sc1
    s_nop 5
    v_cvt_pk_bf16_f32 v78, v80, v81
    v_cvt_pk_bf16_f32 v79, v82, v83
    s_nop 0
    v_permlane16_swap_b32 v76, v78
    v_permlane16_swap_b32 v77, v79
    buffer_store_dwordx4 v[76:79], v21, s[20:23], s76 offen sc1
    s_cmp_lg_u32 s63, 0
    s_cbranch_scc1 L_slow
    s_endpgm
L_y_end:
.p2align 6
L_x:
    v_and_b32 v2, 15, v0
    v_lshrrev_b32 v3, 4, v1
    s_movk_i32 s42, 192
    v_mov_b32 v34, 158976
    v_mov_b32 v147, 0
    ds_write_b32 v34, v147
    v_bfe_u32 v144, v1, 2, 2
    v_lshl_add_u32 v144, v3, 3, v144
    v_lshrrev_b32 v145, 2, v1
    v_mul_u32_u24 v144, 192, v144
    v_bfi_b32 v145, 3, v1, v145
    s_lshl_b32 s40, s2, 5
    v_and_b32 v145, 7, v145
    v_lshl_add_u32 v144, v145, 3, v144
    v_xad_u32 v15, v144, s40, 64
    v_lshl_add_u32 v13, s2, 7, v144
    s_mul_i32 s40, s57, 10368
    v_xor_b32 v14, 32, v13
    s_add_u32 s40, s40, 61440
    s_cmp_eq_u32 s80, 10
    s_cselect_b32 s41, 16, 17
    v_add_u32 v144, 2, v2
    v_add_u32 v147, s40, v4
    v_min_u32 v144, s41, v144
    v_lshl_add_u32 v144, v144, 3, 0
    v_bitop3_b32 v145, v144, 32, v147 bitop3:0x6a
    v_mad_u32_u24 v18, v144, 24, v145
    v_lshl_add_u32 v144, v2, 3, 8
    v_bitop3_b32 v145, v144, 32, v147 bitop3:0x6a
    v_mad_u32_u24 v17, v144, 24, v145
    v_lshl_add_u32 v144, v2, 3, 0
    v_bitop3_b32 v145, v144, 32, v147 bitop3:0x6a
    v_mad_u32_u24 v16, v144, 24, v145
    s_mov_b64 exec, 0
    s_cmp_eq_u32 s3, 0
    s_cbranch_scc1 L_pgX0
    s_cmp_eq_u32 s3, 1
    s_cbranch_scc1 L_pgX1
    s_cmp_eq_u32 s3, 2
    s_cbranch_scc1 L_pgX2
L_retX:
L_pgX2:
    s_mov_b64 exec, -1
    s_add_u32 m0, s25, 6912
    s_add_u32 s31, s44, 86016
    buffer_load_dwordx4 v8, s[8:11], s31 offen  lds
    s_add_u32 m0, s25, 17280
    s_add_u32 s31, s44, 215040
    buffer_load_dwordx4 v8, s[8:11], s31 offen  lds
    s_waitcnt vmcnt(9)
    s_barrier
    s_mul_i32 s31, s57, 3456
    s_add_u32 s31, s31, s24
    s_add_u32 m0, s31, 127488
    s_add_u32 s31, s28, 55296
    buffer_load_dwordx4 v5, s[16:19], s31 offen lds
    ds_read_b64_tr_b16 a[0:1], v13 offset:24576
    buffer_load_dwordx4 v6, s[16:19], s31 offen offset:1024 lds
    ds_read_b64_tr_b16 a[2:3], v13 offset:25344
    buffer_load_dwordx4 v7, s[16:19], s31 offen offset:2048 lds
    ds_read_b64_tr_b16 a[4:5], v14 offset:24576
    s_add_u32 m0, s25, 20736
    s_add_u32 s31, s44, 258048
    buffer_load_dwordx4 v8, s[8:11], s31 offen  lds
    ds_read_b64_tr_b16 a[6:7], v14 offset:25344
    s_add_u32 m0, s25, 24192
    s_add_u32 s31, s44, 301056
    buffer_load_dwordx4 v8, s[8:11], s31 offen  lds
    ds_read_b64_tr_b16 a[8:9], v15 offset:24576
    s_add_u32 m0, s24, 49152
    s_add_u32 s31, s28, 61440
    buffer_load_dwordx4 v5, s[16:19], s31 offen lds
    ds_read_b64_tr_b16 a[10:11], v15 offset:25344
    buffer_load_dwordx4 v6, s[16:19], s31 offen offset:1024 lds
    ds_read_b64_tr_b16 a[12:13], v13 offset:30720
    buffer_load_dwordx4 v7, s[16:19], s31 offen offset:2048 lds
    ds_read_b64_tr_b16 a[14:15], v13 offset:31488
    ds_read_b64_tr_b16 a[16:17], v14 offset:30720
    ds_read_b64_tr_b16 a[18:19], v14 offset:31488
    ds_read_b64_tr_b16 a[20:21], v15 offset:30720
    ds_read_b64_tr_b16 a[22:23], v15 offset:31488
    s_waitcnt lgkmcnt(0)
    s_waitcnt vmcnt(10)
    s_barrier
    ds_read_b128 v[112:115], v16 offset:0
    ds_read_b128 v[116:119], v16 offset:3456
    ds_read_b128 v[120:123], v16 offset:64
    ds_read_b128 v[124:127], v16 offset:3520
    s_waitcnt lgkmcnt(3)
    v_mfma_f32_16x16x32_bf16 v[64:67], a[0:3], v[112:115], 0
    s_add_u32 m0, s24, 0
    ds_read_b64_tr_b16 a[24:25], v13 offset:36864
    s_add_u32 s31, s28, 67584
    ds_read_b64_tr_b16 a[26:27], v13 offset:37632
    v_mfma_f32_16x16x32_bf16 v[68:71], a[4:7], v[112:115], 0
    s_mul_i32 s56, s46, 36
    ds_read_b64_tr_b16 a[28:29], v14 offset:36864
    buffer_load_dwordx4 v5, s[16:19], s31 offen lds
    v_mfma_f32_16x16x32_bf16 v[72:75], a[8:11], v[112:115], 0
    s_waitcnt lgkmcnt(5)
    ds_read_b64_tr_b16 a[30:31], v14 offset:37632
    v_add_u32 v61, 127488, v13
    v_mfma_f32_16x16x32_bf16 v[76:79], a[0:3], v[116:119], 0
    s_movk_i32 s5, 7488
    ds_read_b64_tr_b16 a[32:33], v15 offset:36864
    v_add_u32 v62, 127488, v14
    v_mfma_f32_16x16x32_bf16 v[80:83], a[4:7], v[116:119], 0
    s_addk_i32 s56, 215
    ds_read_b64_tr_b16 a[34:35], v15 offset:37632
    v_add_u32 v63, 127488, v15
    v_mfma_f32_16x16x32_bf16 v[84:87], a[8:11], v[116:119], 0
    s_waitcnt lgkmcnt(6)
    ds_read_b128 v[128:131], v16 offset:128
    buffer_load_dwordx4 v6, s[16:19], s31 offen offset:1024 lds
    v_mfma_f32_16x16x32_bf16 v[64:67], a[12:15], v[120:123], v[64:67]
    s_mul_i32 s55, s45, 36
    ds_read_b64_tr_b16 a[36:37], v13 offset:43008
    v_mul_u32_u24 v30, 1821, v0
    v_mfma_f32_16x16x32_bf16 v[68:71], a[16:19], v[120:123], v[68:71]
    s_mul_i32 s40, s57, 6912
    ds_read_b64_tr_b16 a[38:39], v13 offset:43776
    v_lshlrev_b32 v31, 4, v0
    v_mfma_f32_16x16x32_bf16 v[72:75], a[20:23], v[120:123], v[72:75]
    s_mul_i32 s41, s57, 43008
    ds_read_b64_tr_b16 a[40:41], v14 offset:43008
    v_mad_u32_u16 v30, v30, s5, v31 op_sel:[1,0,0,0]
    v_mfma_f32_16x16x32_bf16 v[76:79], a[12:15], v[124:127], v[76:79]
    s_mov_b32 s5, 56448
    ds_read_b128 v[132:135], v16 offset:3584
    buffer_load_dwordx4 v7, s[16:19], s31 offen offset:2048 lds
    v_mfma_f32_16x16x32_bf16 v[80:83], a[16:19], v[124:127], v[80:83]
    s_add_u32 m0, s24, 12288
    ds_read_b64_tr_b16 a[42:43], v14 offset:43776
    v_sub_u32 v32, s56, v0
    v_mfma_f32_16x16x32_bf16 v[84:87], a[20:23], v[124:127], v[84:87]
    s_waitcnt lgkmcnt(5)
    ds_read_b64_tr_b16 a[44:45], v15 offset:43008
    v_add_u32 v31, -252, v32
    v_mfma_f32_16x16x32_bf16 v[64:67], a[24:27], v[128:131], v[64:67]
    s_add_u32 s31, s28, 73728
    ds_read_b64_tr_b16 a[46:47], v15 offset:43776
    v_and_b32 v31, 2.0, v31
    v_mfma_f32_16x16x32_bf16 v[68:71], a[28:31], v[128:131], v[68:71]
    s_add_u32 s41, s44, s41
    ds_read_b128 v[136:139], v17 offset:0
    buffer_load_dwordx4 v5, s[16:19], s31 offen lds
    v_mfma_f32_16x16x32_bf16 v[72:75], a[32:35], v[128:131], v[72:75]
    s_waitcnt lgkmcnt(4)
    ds_read_b128 v[140:143], v17 offset:3456
    v_add3_u32 v31, v30, v31, s5
    v_mfma_f32_16x16x32_bf16 v[76:79], a[24:27], v[132:135], v[76:79]
    s_add_u32 s74, s41, 301248
    v_and_or_b32 v30, v32, 2.0, v30
    v_subrev_u32 v40, s40, v16
    v_mfma_f32_16x16x32_bf16 v[80:83], a[28:31], v[132:135], v[80:83]
    s_add_u32 s75, s41, 387264
    v_subrev_u32 v41, s40, v17
    v_subrev_u32 v42, s40, v18
    v_mfma_f32_16x16x32_bf16 v[84:87], a[32:35], v[132:135], v[84:87]
    s_waitcnt vmcnt(12) lgkmcnt(1)
    s_barrier
    v_mfma_f32_16x16x32_bf16 v[64:67], a[36:39], v[136:139], v[64:67]
    s_add_u32 s76, s41, 473280
    ds_read_b128 v[112:115], v16 offset:6912
    buffer_load_dwordx4 v6, s[16:19], s31 offen offset:1024 lds
    v_mfma_f32_16x16x32_bf16 v[68:71], a[40:43], v[136:139], v[68:71]
    s_add_u32 s77, s41, 559296
    ds_read_b128 v[116:119], v16 offset:6976
    s_mov_b32 s37, 0x3e803e80
    ds_read_b128 v[120:123], v16 offset:7040
    v_mfma_f32_16x16x32_bf16 v[72:75], a[44:47], v[136:139], v[72:75]
    s_waitcnt lgkmcnt(3)
    v_lshrrev_b32 v52, 1, v4
    v_lshl_or_b32 v21, v4, 1, v52
    v_mfma_f32_16x16x32_bf16 v[76:79], a[36:39], v[140:143], v[76:79]
    s_cmp_ge_u32 s45, 47040
    s_cselect_b32 s43, 43008, 0
    ds_read_b128 v[124:127], v17 offset:6912
    v_mfma_f32_16x16x32_bf16 v[80:83], a[40:43], v[140:143], v[80:83]
    buffer_load_dwordx4 v7, s[16:19], s31 offen offset:2048 lds
    v_mfma_f32_16x16x32_bf16 v[84:87], a[44:47], v[140:143], v[84:87]
    s_waitcnt lgkmcnt(3)
    v_and_b32 v21, 48, v21
    v_lshl_add_u32 v21, s2, 7, v21
    v_mfma_f32_16x16x32_bf16 v[88:91], a[0:3], v[112:115], 0
    s_add_u32 m0, s24, 24576
    ds_read_b128 v[128:131], v16 offset:3456
    v_mad_u32_u24 v19, v2, s42, v21
    v_mfma_f32_16x16x32_bf16 v[92:95], a[4:7], v[112:115], 0
    s_add_u32 s31, s28, 24576
    v_lshl_add_u32 v53, s2, 2, v3
    v_lshrrev_b32 v52, 1, v2
    v_mfma_f32_16x16x32_bf16 v[96:99], a[8:11], v[112:115], 0
    s_waitcnt lgkmcnt(2)
    buffer_load_dwordx4 v5, s[16:19], s31 offen lds
    v_mfma_f32_16x16x32_bf16 v[88:91], a[12:15], v[116:119], v[88:91]
    s_sub_u32 s53, s44, s43
    ds_read_b128 v[132:135], v16 offset:6912
    v_bitop3_b32 v52, v52, 6, v53 bitop3:0x6a
    v_mfma_f32_16x16x32_bf16 v[92:95], a[16:19], v[116:119], v[92:95]
    s_mov_b32 s96, 0x7fff7fff
    v_lshl_add_u32 v52, v2, 3, v52
    v_mad_u32_u24 v21, v2, s42, v21
    v_mfma_f32_16x16x32_bf16 v[96:99], a[20:23], v[116:119], v[96:99]
    s_waitcnt vmcnt(11) lgkmcnt(2)
    s_barrier
    v_mfma_f32_16x16x32_bf16 v[88:91], a[24:27], v[120:123], v[88:91]
    s_mov_b32 s60, 0x435f435f
    ds_read_b64_tr_b16 a[108:109], v61 offset:0
    buffer_load_dwordx4 v6, s[16:19], s31 offen offset:1024 lds
    ds_read_b64_tr_b16 a[110:111], v61 offset:768
    ds_read_b64_tr_b16 a[112:113], v62 offset:0
    ds_read_b64_tr_b16 a[114:115], v62 offset:768
    ds_read_b64_tr_b16 a[116:117], v63 offset:0
    ds_read_b64_tr_b16 a[118:119], v63 offset:768
    v_mfma_f32_16x16x32_bf16 v[92:95], a[28:31], v[120:123], v[92:95]
    s_lshl_b32 s4, s57, 10
    ds_read_b64_tr_b16 a[216:217], v61 offset:9600
    s_add_u32 s56, s44, 43200
    ds_read_b64_tr_b16 a[218:219], v61 offset:10368
    v_mfma_f32_16x16x32_bf16 v[96:99], a[32:35], v[120:123], v[96:99]
    ds_read_b64_tr_b16 a[220:221], v62 offset:9600
    v_lshl_add_u32 v38, v52, 3, s4
    v_mfma_f32_16x16x32_bf16 v[88:91], a[36:39], v[124:127], v[88:91]
    s_mul_i32 s4, s57, 129024
    ds_read_b128 v[136:139], v16 offset:10368
    v_lshlrev_b32 v39, 3, v0
    v_mfma_f32_16x16x32_bf16 v[92:95], a[40:43], v[124:127], v[92:95]
    s_add_u32 s56, s56, s4
    ds_read_b64_tr_b16 a[222:223], v62 offset:10368
    buffer_load_dwordx4 v7, s[16:19], s31 offen offset:2048 lds
    v_mfma_f32_16x16x32_bf16 v[96:99], a[44:47], v[124:127], v[96:99]
    s_waitcnt lgkmcnt(5)
    ds_read_b64_tr_b16 a[224:225], v63 offset:9600
    v_lshrrev_b32 v22, 1, v0
    v_mfma_f32_16x16x32_bf16 v[64:67], a[108:111], v[128:131], v[64:67]
    s_add_u32 m0, s24, 36864
    ds_read_b64_tr_b16 a[226:227], v63 offset:10368
    v_bitop3_b32 v22, v22, 48, v39 bitop3:0x6a
    v_mfma_f32_16x16x32_bf16 v[68:71], a[112:115], v[128:131], v[68:71]
    s_add_u32 s31, s26, 135168
    v_bfe_u32 v37, v0, 3, 4
    v_and_or_b32 v22, v22, 56, 64
    v_mfma_f32_16x16x32_bf16 v[72:75], a[116:119], v[128:131], v[72:75]
    buffer_load_dwordx4 v5, s[16:19], s31 offen lds
    v_mfma_f32_16x16x32_bf16 v[76:79], a[108:111], v[132:135], v[76:79]
    s_add_u32 s4, s56, 43008
    v_mad_u32_u24 v20, v37, s42, v22
    v_mad_u32_u24 v22, v37, s42, v22
    v_mfma_f32_16x16x32_bf16 v[80:83], a[112:115], v[132:135], v[80:83]
    s_add_u32 s5, s56, 86016
    v_mfma_f32_16x16x32_bf16 v[84:87], a[116:119], v[132:135], v[84:87]
    s_waitcnt lgkmcnt(1)
    v_mfma_f32_16x16x32_bf16 v[88:91], a[108:111], v[136:139], v[88:91]
    buffer_load_dwordx4 v6, s[16:19], s31 offen offset:1024 lds
    v_mfma_f32_16x16x32_bf16 v[92:95], a[112:115], v[136:139], v[92:95]
    v_mfma_f32_16x16x32_bf16 v[96:99], a[116:119], v[136:139], v[96:99]
    s_waitcnt vmcnt(8) lgkmcnt(0)
    s_barrier
    v_mfma_f32_16x16x32_bf16 v[64:67], a[216:219], v[132:135], v[64:67]
    ds_read_b64_tr_b16 a[120:121], v13 offset:49152
    ds_read_b64_tr_b16 a[122:123], v13 offset:49920
    ds_read_b64_tr_b16 a[124:125], v14 offset:49152
    v_mfma_f32_16x16x32_bf16 v[68:71], a[220:223], v[132:135], v[68:71]
    ds_read_b128 v[140:143], v16 offset:13824
    buffer_load_dwordx4 v7, s[16:19], s31 offen offset:2048 lds
    ds_read_b64_tr_b16 a[126:127], v14 offset:49920
    v_mfma_f32_16x16x32_bf16 v[72:75], a[224:227], v[132:135], v[72:75]
L_pgX0:
  s_cbranch_execz L_retX
    s_mul_i32 s31, s57, 3456
    ds_read_b64_tr_b16 a[128:129], v15 offset:49152
    s_add_u32 s31, s31, s24
    ds_read_b64_tr_b16 a[130:131], v15 offset:49920
    v_mfma_f32_16x16x32_bf16 v[76:79], a[216:219], v[136:139], v[76:79]
    s_add_u32 m0, s31, 127488
    ds_read_b128 v[112:115], v16 offset:3520
    s_add_u32 s31, s28, 86016
    ds_read_b64_tr_b16 a[228:229], v13 offset:55296
    v_mfma_f32_16x16x32_bf16 v[80:83], a[220:223], v[136:139], v[80:83]
    ds_read_b64_tr_b16 a[230:231], v13 offset:56064
    ds_read_b64_tr_b16 a[232:233], v14 offset:55296
    v_mfma_f32_16x16x32_bf16 v[84:87], a[224:227], v[136:139], v[84:87]
    s_waitcnt lgkmcnt(7)
    ds_read_b128 v[116:119], v16 offset:6976
    buffer_load_dwordx4 v5, s[16:19], s31 offen lds
    v_mfma_f32_16x16x32_bf16 v[88:91], a[216:219], v[140:143], v[88:91]
    ds_read_b64_tr_b16 a[234:235], v14 offset:56064
    ds_read_b64_tr_b16 a[236:237], v15 offset:55296
    v_mfma_f32_16x16x32_bf16 v[92:95], a[220:223], v[140:143], v[92:95]
    ds_read_b64_tr_b16 a[238:239], v15 offset:56064
    v_mfma_f32_16x16x32_bf16 v[96:99], a[224:227], v[140:143], v[96:99]
    s_waitcnt lgkmcnt(7)
    ds_read_b128 v[120:123], v16 offset:10432
    v_mfma_f32_16x16x32_bf16 v[64:67], a[120:123], v[112:115], v[64:67]
    ds_read_b64_tr_b16 a[132:133], v13 offset:0
    buffer_load_dwordx4 v6, s[16:19], s31 offen offset:1024 lds
    v_mfma_f32_16x16x32_bf16 v[68:71], a[124:127], v[112:115], v[68:71]
    ds_read_b64_tr_b16 a[134:135], v13 offset:768
    v_mfma_f32_16x16x32_bf16 v[72:75], a[128:131], v[112:115], v[72:75]
    s_waitcnt lgkmcnt(6)
    ds_read_b64_tr_b16 a[136:137], v14 offset:0
    v_mfma_f32_16x16x32_bf16 v[76:79], a[120:123], v[116:119], v[76:79]
    ds_read_b64_tr_b16 a[138:139], v14 offset:768
    v_mfma_f32_16x16x32_bf16 v[80:83], a[124:127], v[116:119], v[80:83]
    ds_read_b64_tr_b16 a[140:141], v15 offset:0
    buffer_load_dwordx4 v7, s[16:19], s31 offen offset:2048 lds
    v_mfma_f32_16x16x32_bf16 v[84:87], a[128:131], v[116:119], v[84:87]
    s_waitcnt lgkmcnt(5)
    ds_read_b64_tr_b16 a[142:143], v15 offset:768
    s_add_u32 m0, s24, 49152
    v_mfma_f32_16x16x32_bf16 v[88:91], a[120:123], v[120:123], v[88:91]
    s_add_u32 s31, s28, 36864
    ds_read_b64_tr_b16 a[240:241], v13 offset:6144
    v_mfma_f32_16x16x32_bf16 v[92:95], a[124:127], v[120:123], v[92:95]
    ds_read_b64_tr_b16 a[242:243], v13 offset:6912
    v_mfma_f32_16x16x32_bf16 v[96:99], a[128:131], v[120:123], v[96:99]
    ds_read_b64_tr_b16 a[244:245], v14 offset:6144
    v_mfma_f32_16x16x32_bf16 v[64:67], a[228:231], v[116:119], v[64:67]
    ds_read_b128 v[124:127], v16 offset:13888
    v_mfma_f32_16x16x32_bf16 v[68:71], a[232:235], v[116:119], v[68:71]
    ds_read_b64_tr_b16 a[246:247], v14 offset:6912
    v_mfma_f32_16x16x32_bf16 v[72:75], a[236:239], v[116:119], v[72:75]
    ds_read_b64_tr_b16 a[248:249], v15 offset:6144
    v_mfma_f32_16x16x32_bf16 v[76:79], a[228:231], v[120:123], v[76:79]
    ds_read_b64_tr_b16 a[250:251], v15 offset:6912
    v_mfma_f32_16x16x32_bf16 v[80:83], a[232:235], v[120:123], v[80:83]
    ds_read_b128 v[128:131], v16 offset:3584
    v_mfma_f32_16x16x32_bf16 v[84:87], a[236:239], v[120:123], v[84:87]
    s_waitcnt lgkmcnt(4)
    ds_read_b128 v[132:135], v16 offset:7040
    v_mfma_f32_16x16x32_bf16 v[88:91], a[228:231], v[124:127], v[88:91]
    ds_read_b128 v[136:139], v16 offset:10496
    v_mfma_f32_16x16x32_bf16 v[92:95], a[232:235], v[124:127], v[92:95]
    v_mfma_f32_16x16x32_bf16 v[96:99], a[236:239], v[124:127], v[96:99]
    s_waitcnt vmcnt(6) lgkmcnt(2)
    s_barrier
    v_mfma_f32_16x16x32_bf16 v[64:67], a[132:135], v[128:131], v[64:67]
    ds_read_b64_tr_b16 a[144:145], v13 offset:12288
    buffer_load_dwordx4 v5, s[16:19], s31 offen lds
    v_mfma_f32_16x16x32_bf16 v[68:71], a[136:139], v[128:131], v[68:71]
    ds_read_b64_tr_b16 a[146:147], v13 offset:13056
    v_mfma_f32_16x16x32_bf16 v[72:75], a[140:143], v[128:131], v[72:75]
    s_waitcnt lgkmcnt(3)
    ds_read_b64_tr_b16 a[148:149], v14 offset:12288
    v_mfma_f32_16x16x32_bf16 v[76:79], a[132:135], v[132:135], v[76:79]
    ds_read_b128 v[140:143], v16 offset:13952
    v_mfma_f32_16x16x32_bf16 v[80:83], a[136:139], v[132:135], v[80:83]
    ds_read_b64_tr_b16 a[150:151], v14 offset:13056
    buffer_load_dwordx4 v6, s[16:19], s31 offen offset:1024 lds
    v_mfma_f32_16x16x32_bf16 v[84:87], a[140:143], v[132:135], v[84:87]
    s_waitcnt lgkmcnt(5)
    ds_read_b64_tr_b16 a[152:153], v15 offset:12288
    v_mfma_f32_16x16x32_bf16 v[88:91], a[132:135], v[136:139], v[88:91]
    ds_read_b64_tr_b16 a[154:155], v15 offset:13056
    v_mfma_f32_16x16x32_bf16 v[92:95], a[136:139], v[136:139], v[92:95]
    ds_read_b128 v[112:115], v17 offset:3456
    v_mfma_f32_16x16x32_bf16 v[96:99], a[140:143], v[136:139], v[96:99]
    ds_read_b64_tr_b16 a[252:253], v13 offset:18432
    buffer_load_dwordx4 v7, s[16:19], s31 offen offset:2048 lds
    v_mfma_f32_16x16x32_bf16 v[64:67], a[240:243], v[132:135], v[64:67]
    s_add_u32 m0, s24, 0
    ds_read_b64_tr_b16 a[254:255], v13 offset:19200
    s_add_u32 s31, s26, 147456
    v_mfma_f32_16x16x32_bf16 v[68:71], a[244:247], v[132:135], v[68:71]
    ds_read_b64_tr_b16 v[188:189], v14 offset:18432
    v_mfma_f32_16x16x32_bf16 v[72:75], a[248:251], v[132:135], v[72:75]
    ds_read_b128 v[116:119], v17 offset:6912
    v_mfma_f32_16x16x32_bf16 v[76:79], a[240:243], v[136:139], v[76:79]
    ds_read_b64_tr_b16 v[190:191], v14 offset:19200
    buffer_load_dwordx4 v5, s[16:19], s31 offen lds
    v_mfma_f32_16x16x32_bf16 v[80:83], a[244:247], v[136:139], v[80:83]
    ds_read_b64_tr_b16 v[192:193], v15 offset:18432
    v_mfma_f32_16x16x32_bf16 v[84:87], a[248:251], v[136:139], v[84:87]
    s_waitcnt lgkmcnt(5)
    ds_read_b64_tr_b16 v[194:195], v15 offset:19200
    v_mfma_f32_16x16x32_bf16 v[88:91], a[240:243], v[140:143], v[88:91]
    ds_read_b128 v[120:123], v17 offset:10368
    v_mfma_f32_16x16x32_bf16 v[92:95], a[244:247], v[140:143], v[92:95]
    buffer_load_dwordx4 v6, s[16:19], s31 offen offset:1024 lds
    v_mfma_f32_16x16x32_bf16 v[96:99], a[248:251], v[140:143], v[96:99]
    ds_read_b64_tr_b16 a[48:49], v13 offset:24576
    v_mfma_f32_16x16x32_bf16 v[64:67], a[144:147], v[112:115], v[64:67]
    ds_read_b64_tr_b16 a[50:51], v13 offset:25344
    v_mfma_f32_16x16x32_bf16 v[68:71], a[148:151], v[112:115], v[68:71]
    ds_read_b64_tr_b16 a[52:53], v14 offset:24576
    v_mfma_f32_16x16x32_bf16 v[72:75], a[152:155], v[112:115], v[72:75]
    s_waitcnt lgkmcnt(4)
    buffer_load_dwordx4 v7, s[16:19], s31 offen offset:2048 lds
    v_mfma_f32_16x16x32_bf16 v[76:79], a[144:147], v[116:119], v[76:79]
    s_add_u32 m0, s24, 12288
    ds_read_b64_tr_b16 a[54:55], v14 offset:25344
    s_add_u32 s31, s28, 98304
    v_mfma_f32_16x16x32_bf16 v[80:83], a[148:151], v[116:119], v[80:83]
    ds_read_b64_tr_b16 a[56:57], v15 offset:24576
    v_mfma_f32_16x16x32_bf16 v[84:87], a[152:155], v[116:119], v[84:87]
    s_waitcnt lgkmcnt(4)
    ds_read_b64_tr_b16 a[58:59], v15 offset:25344
    v_mfma_f32_16x16x32_bf16 v[88:91], a[144:147], v[120:123], v[88:91]
    ds_read_b64_tr_b16 a[156:157], v13 offset:30720
    v_mfma_f32_16x16x32_bf16 v[92:95], a[148:151], v[120:123], v[92:95]
    ds_read_b64_tr_b16 a[158:159], v13 offset:31488
    v_mfma_f32_16x16x32_bf16 v[96:99], a[152:155], v[120:123], v[96:99]
    ds_read_b64_tr_b16 a[160:161], v14 offset:30720
    v_mfma_f32_16x16x32_bf16 v[64:67], a[252:255], v[116:119], v[64:67]
    ds_read_b128 v[124:127], v17 offset:13824
    v_mfma_f32_16x16x32_bf16 v[68:71], v[188:191], v[116:119], v[68:71]
    ds_read_b64_tr_b16 a[162:163], v14 offset:31488
    v_mfma_f32_16x16x32_bf16 v[72:75], v[192:195], v[116:119], v[72:75]
    ds_read_b64_tr_b16 a[164:165], v15 offset:30720
    v_mfma_f32_16x16x32_bf16 v[76:79], a[252:255], v[120:123], v[76:79]
    ds_read_b64_tr_b16 a[166:167], v15 offset:31488
    v_mfma_f32_16x16x32_bf16 v[80:83], v[188:191], v[120:123], v[80:83]
    ds_read_b128 v[128:131], v17 offset:64
    v_mfma_f32_16x16x32_bf16 v[84:87], v[192:195], v[120:123], v[84:87]
    s_waitcnt lgkmcnt(4)
    ds_read_b128 v[132:135], v17 offset:3520
    v_mfma_f32_16x16x32_bf16 v[88:91], a[252:255], v[124:127], v[88:91]
    ds_read_b128 v[136:139], v17 offset:6976
    v_mfma_f32_16x16x32_bf16 v[92:95], v[188:191], v[124:127], v[92:95]
    v_mfma_f32_16x16x32_bf16 v[96:99], v[192:195], v[124:127], v[96:99]
    s_waitcnt vmcnt(6) lgkmcnt(2)
    s_barrier
    v_mfma_f32_16x16x32_bf16 v[64:67], a[48:51], v[128:131], v[64:67]
    buffer_load_dwordx4 v5, s[16:19], s31 offen lds
    v_mfma_f32_16x16x32_bf16 v[68:71], a[52:55], v[128:131], v[68:71]
    ds_read_b64_tr_b16 v[196:197], v13 offset:36864
    v_mfma_f32_16x16x32_bf16 v[72:75], a[56:59], v[128:131], v[72:75]
    s_waitcnt lgkmcnt(2)
    ds_read_b64_tr_b16 v[198:199], v13 offset:37632
    v_mfma_f32_16x16x32_bf16 v[76:79], a[48:51], v[132:135], v[76:79]
    ds_read_b64_tr_b16 v[200:201], v14 offset:36864
    v_mfma_f32_16x16x32_bf16 v[80:83], a[52:55], v[132:135], v[80:83]
    buffer_load_dwordx4 v6, s[16:19], s31 offen offset:1024 lds
    v_mfma_f32_16x16x32_bf16 v[84:87], a[56:59], v[132:135], v[84:87]
    s_waitcnt lgkmcnt(3)
    ds_read_b128 v[140:143], v17 offset:10432
    v_mfma_f32_16x16x32_bf16 v[88:91], a[48:51], v[136:139], v[88:91]
    ds_read_b64_tr_b16 v[202:203], v14 offset:37632
    v_mfma_f32_16x16x32_bf16 v[92:95], a[52:55], v[136:139], v[92:95]
    ds_read_b64_tr_b16 v[204:205], v15 offset:36864
    v_mfma_f32_16x16x32_bf16 v[96:99], a[56:59], v[136:139], v[96:99]
    ds_read_b64_tr_b16 v[206:207], v15 offset:37632
    buffer_load_dwordx4 v7, s[16:19], s31 offen offset:2048 lds
    v_mfma_f32_16x16x32_bf16 v[64:67], a[156:159], v[132:135], v[64:67]
    s_add_u32 m0, s24, 24576
    ds_read_b64_tr_b16 a[60:61], v13 offset:43008
    s_add_u32 s31, s28, 49152
    v_mfma_f32_16x16x32_bf16 v[68:71], a[160:163], v[132:135], v[68:71]
    ds_read_b64_tr_b16 a[62:63], v13 offset:43776
    v_mfma_f32_16x16x32_bf16 v[72:75], a[164:167], v[132:135], v[72:75]
    ds_read_b64_tr_b16 a[64:65], v14 offset:43008
    v_mfma_f32_16x16x32_bf16 v[76:79], a[156:159], v[136:139], v[76:79]
    buffer_load_dwordx4 v5, s[16:19], s31 offen lds
    v_mfma_f32_16x16x32_bf16 v[80:83], a[160:163], v[136:139], v[80:83]
    ds_read_b128 v[112:115], v17 offset:13888
    v_mfma_f32_16x16x32_bf16 v[84:87], a[164:167], v[136:139], v[84:87]
    s_waitcnt lgkmcnt(4)
    ds_read_b64_tr_b16 a[66:67], v14 offset:43776
    v_mfma_f32_16x16x32_bf16 v[88:91], a[156:159], v[140:143], v[88:91]
    ds_read_b64_tr_b16 a[68:69], v15 offset:43008
    v_mfma_f32_16x16x32_bf16 v[92:95], a[160:163], v[140:143], v[92:95]
    ds_read_b64_tr_b16 a[70:71], v15 offset:43776
    buffer_load_dwordx4 v6, s[16:19], s31 offen offset:1024 lds
    v_mfma_f32_16x16x32_bf16 v[96:99], a[164:167], v[140:143], v[96:99]
    ds_read_b128 v[116:119], v17 offset:128
    v_mfma_f32_16x16x32_bf16 v[64:67], v[196:199], v[136:139], v[64:67]
    ds_read_b128 v[120:123], v17 offset:3584
    v_mfma_f32_16x16x32_bf16 v[68:71], v[200:203], v[136:139], v[68:71]
    ds_read_b64_tr_b16 a[168:169], v61 offset:0
    v_mfma_f32_16x16x32_bf16 v[72:75], v[204:207], v[136:139], v[72:75]
    buffer_load_dwordx4 v7, s[16:19], s31 offen offset:2048 lds
    v_mfma_f32_16x16x32_bf16 v[76:79], v[196:199], v[140:143], v[76:79]
    s_lshl_b32 s31, s2, 5
    ds_read_b64_tr_b16 a[170:171], v61 offset:768
    v_xor_b32 v5, s31, v5
    v_mfma_f32_16x16x32_bf16 v[80:83], v[200:203], v[140:143], v[80:83]
    s_lshr_b32 s31, s24, 1
    ds_read_b64_tr_b16 a[172:173], v62 offset:0
    s_add_u32 m0, s31, 36864
    v_mfma_f32_16x16x32_bf16 v[84:87], v[204:207], v[140:143], v[84:87]
    s_waitcnt lgkmcnt(4)
    ds_read_b128 v[124:127], v17 offset:7040
    s_add_u32 s31, s31, 159744
    v_mfma_f32_16x16x32_bf16 v[88:91], v[196:199], v[112:115], v[88:91]
    ds_read_b64_tr_b16 a[174:175], v62 offset:768
    v_mfma_f32_16x16x32_bf16 v[92:95], v[200:203], v[112:115], v[92:95]
    ds_read_b64_tr_b16 a[176:177], v63 offset:0
    v_mfma_f32_16x16x32_bf16 v[96:99], v[204:207], v[112:115], v[96:99]
    ds_read_b64_tr_b16 a[178:179], v63 offset:768
    v_mfma_f32_16x16x32_bf16 v[64:67], a[60:63], v[116:119], v[64:67]
    ds_read_b64_tr_b16 v[208:209], v61 offset:9600
    v_mfma_f32_16x16x32_bf16 v[68:71], a[64:67], v[116:119], v[68:71]
    ds_read_b64_tr_b16 v[210:211], v61 offset:10368
    v_mfma_f32_16x16x32_bf16 v[72:75], a[68:71], v[116:119], v[72:75]
    s_waitcnt lgkmcnt(5)
    ds_read_b64_tr_b16 v[212:213], v62 offset:9600
    v_mfma_f32_16x16x32_bf16 v[76:79], a[60:63], v[120:123], v[76:79]
    ds_read_b128 v[128:131], v17 offset:10496
    v_mfma_f32_16x16x32_bf16 v[80:83], a[64:67], v[120:123], v[80:83]
    ds_read_b64_tr_b16 v[214:215], v62 offset:10368
    v_mfma_f32_16x16x32_bf16 v[84:87], a[68:71], v[120:123], v[84:87]
    ds_read_b64_tr_b16 v[216:217], v63 offset:9600
    v_mfma_f32_16x16x32_bf16 v[88:91], a[60:63], v[124:127], v[88:91]
    ds_read_b64_tr_b16 v[218:219], v63 offset:10368
    v_mfma_f32_16x16x32_bf16 v[92:95], a[64:67], v[124:127], v[92:95]
    v_mfma_f32_16x16x32_bf16 v[96:99], a[68:71], v[124:127], v[96:99]
    s_waitcnt vmcnt(6) lgkmcnt(4)
    s_barrier
    v_mfma_f32_16x16x32_bf16 v[64:67], a[168:171], v[120:123], v[64:67]
    ds_read_b64_tr_b16 a[72:73], v13 offset:49152
    buffer_load_dwordx4 v5, s[16:19], s31 offen lds
    v_mfma_f32_16x16x32_bf16 v[68:71], a[172:175], v[120:123], v[68:71]
    ds_read_b64_tr_b16 a[74:75], v13 offset:49920
    v_mfma_f32_16x16x32_bf16 v[72:75], a[176:179], v[120:123], v[72:75]
    ds_read_b64_tr_b16 a[76:77], v14 offset:49152
    v_mfma_f32_16x16x32_bf16 v[76:79], a[168:171], v[124:127], v[76:79]
    ds_read_b128 v[132:135], v17 offset:13952
    v_mfma_f32_16x16x32_bf16 v[80:83], a[172:175], v[124:127], v[80:83]
    buffer_load_dwordx4 v5, s[16:19], s31 offen offset:512 lds
    v_mfma_f32_16x16x32_bf16 v[84:87], a[176:179], v[124:127], v[84:87]
    s_waitcnt lgkmcnt(4)
    ds_read_b64_tr_b16 a[78:79], v14 offset:49920
    s_add_u32 m0, s25, 27648
    v_mfma_f32_16x16x32_bf16 v[88:91], a[168:171], v[128:131], v[88:91]
    s_add_u32 s31, s44, 344064
    ds_read_b64_tr_b16 a[80:81], v15 offset:49152
    v_mfma_f32_16x16x32_bf16 v[92:95], a[172:175], v[128:131], v[92:95]
    ds_read_b64_tr_b16 a[82:83], v15 offset:49920
    v_mfma_f32_16x16x32_bf16 v[96:99], a[176:179], v[128:131], v[96:99]
    buffer_load_dwordx4 v8, s[8:11], s31 offen  lds
    v_mfma_f32_16x16x32_bf16 v[64:67], v[208:211], v[124:127], v[64:67]
    s_add_u32 m0, s25, 31104
    ds_read_b128 v[136:139], v18 offset:0
    s_add_u32 s31, s44, 387072
    v_mfma_f32_16x16x32_bf16 v[68:71], v[212:215], v[124:127], v[68:71]
    ds_read_b128 v[140:143], v18 offset:3456
    v_mfma_f32_16x16x32_bf16 v[72:75], v[216:219], v[124:127], v[72:75]
    ds_read_b64_tr_b16 a[180:181], v13 offset:55296
    v_mfma_f32_16x16x32_bf16 v[76:79], v[208:211], v[128:131], v[76:79]
    buffer_load_dwordx4 v8, s[8:11], s31 offen  lds
    v_mfma_f32_16x16x32_bf16 v[80:83], v[212:215], v[128:131], v[80:83]
    ds_read_b64_tr_b16 a[182:183], v13 offset:56064
    v_mfma_f32_16x16x32_bf16 v[84:87], v[216:219], v[128:131], v[84:87]
    s_waitcnt lgkmcnt(4)
    ds_read_b64_tr_b16 a[184:185], v14 offset:55296
    v_mfma_f32_16x16x32_bf16 v[88:91], v[208:211], v[132:135], v[88:91]
    ds_read_b128 v[112:115], v18 offset:6912
    v_mfma_f32_16x16x32_bf16 v[92:95], v[212:215], v[132:135], v[92:95]
    ds_read_b64_tr_b16 a[186:187], v14 offset:56064
    v_mfma_f32_16x16x32_bf16 v[96:99], v[216:219], v[132:135], v[96:99]
    s_waitcnt lgkmcnt(4)
    ds_read_b64_tr_b16 a[188:189], v15 offset:55296
    v_mfma_f32_16x16x32_bf16 v[64:67], a[72:75], v[136:139], v[64:67]
    buffer_load_dwordx4 v[180:183], v30, s[12:15], s55 offen
    v_mfma_f32_16x16x32_bf16 v[68:71], a[76:79], v[136:139], v[68:71]
    ds_read_b64_tr_b16 a[190:191], v15 offset:56064
    v_mfma_f32_16x16x32_bf16 v[72:75], a[80:83], v[136:139], v[72:75]
    ds_read_b64_tr_b16 v[220:221], v13 offset:0
    v_mfma_f32_16x16x32_bf16 v[76:79], a[72:75], v[140:143], v[76:79]
    ds_read_b64_tr_b16 v[222:223], v13 offset:768
    v_mfma_f32_16x16x32_bf16 v[80:83], a[76:79], v[140:143], v[80:83]
    buffer_load_dwordx4 v[184:187], v31, s[12:15], s55 offen
    v_mfma_f32_16x16x32_bf16 v[84:87], a[80:83], v[140:143], v[84:87]
    s_waitcnt lgkmcnt(3)
    ds_read_b64_tr_b16 v[224:225], v14 offset:0
    s_add_u32 m0, s25, 34560
    v_mfma_f32_16x16x32_bf16 v[88:91], a[72:75], v[112:115], v[88:91]
    s_add_u32 s31, s44, 430080
    ds_read_b128 v[116:119], v18 offset:10368
    v_mfma_f32_16x16x32_bf16 v[92:95], a[76:79], v[112:115], v[92:95]
    ds_read_b64_tr_b16 v[226:227], v14 offset:768
    v_mfma_f32_16x16x32_bf16 v[96:99], a[80:83], v[112:115], v[96:99]
    s_waitcnt lgkmcnt(4)
    buffer_load_dwordx4 v8, s[8:11], s31 offen  lds
    v_mfma_f32_16x16x32_bf16 v[64:67], a[180:183], v[140:143], v[64:67]
    s_add_u32 m0, s25, 38016
    ds_read_b64_tr_b16 v[228:229], v15 offset:0
    s_add_u32 s31, s44, 473088
    v_mfma_f32_16x16x32_bf16 v[68:71], a[184:187], v[140:143], v[68:71]
    ds_read_b64_tr_b16 v[230:231], v15 offset:768
    v_mfma_f32_16x16x32_bf16 v[72:75], a[188:191], v[140:143], v[72:75]
    ds_read_b64_tr_b16 a[84:85], v13 offset:6144
    v_mfma_f32_16x16x32_bf16 v[76:79], a[180:183], v[112:115], v[76:79]
    buffer_load_dwordx4 v8, s[8:11], s31 offen  lds
    v_mfma_f32_16x16x32_bf16 v[80:83], a[184:187], v[112:115], v[80:83]
    s_add_u32 m0, s25, 41472
    ds_read_b64_tr_b16 a[86:87], v13 offset:6912
    s_add_u32 s31, s44, 516096
    v_mfma_f32_16x16x32_bf16 v[84:87], a[188:191], v[112:115], v[84:87]
    s_waitcnt lgkmcnt(4)
    ds_read_b64_tr_b16 a[88:89], v14 offset:6144
    v_mfma_f32_16x16x32_bf16 v[88:91], a[180:183], v[116:119], v[88:91]
    ds_read_b128 v[120:123], v18 offset:13824
    v_mfma_f32_16x16x32_bf16 v[92:95], a[184:187], v[116:119], v[92:95]
    ds_read_b64_tr_b16 a[90:91], v14 offset:6912
    v_mfma_f32_16x16x32_bf16 v[96:99], a[188:191], v[116:119], v[96:99]
    s_waitcnt vmcnt(8) lgkmcnt(4)
    s_barrier
    v_mfma_f32_16x16x32_bf16 v[64:67], v[220:223], v[112:115], v[64:67]
    buffer_load_dwordx4 v8, s[8:11], s31 offen  lds
    v_mfma_f32_16x16x32_bf16 v[68:71], v[224:227], v[112:115], v[68:71]
    s_add_u32 m0, s25, 44928
    ds_read_b64_tr_b16 a[92:93], v15 offset:6144
    s_add_u32 s31, s44, 559104
    v_mfma_f32_16x16x32_bf16 v[72:75], v[228:231], v[112:115], v[72:75]
    ds_read_b64_tr_b16 a[94:95], v15 offset:6912
    v_mfma_f32_16x16x32_bf16 v[76:79], v[220:223], v[116:119], v[76:79]
    ds_read_b128 v[124:127], v18 offset:64
    v_mfma_f32_16x16x32_bf16 v[80:83], v[224:227], v[116:119], v[80:83]
    buffer_load_dwordx4 v8, s[8:11], s31 offen  lds
    v_mfma_f32_16x16x32_bf16 v[84:87], v[228:231], v[116:119], v[84:87]
    s_waitcnt lgkmcnt(3)
    ds_read_b128 v[128:131], v18 offset:3520
    s_add_u32 m0, s25, 48384
    v_mfma_f32_16x16x32_bf16 v[88:91], v[220:223], v[120:123], v[88:91]
    s_add_u32 s31, s44, 602112
    ds_read_b64_tr_b16 a[192:193], v13 offset:12288
    v_mfma_f32_16x16x32_bf16 v[92:95], v[224:227], v[120:123], v[92:95]
    ds_read_b64_tr_b16 a[194:195], v13 offset:13056
    v_mfma_f32_16x16x32_bf16 v[96:99], v[228:231], v[120:123], v[96:99]
    s_waitcnt lgkmcnt(3)
    ds_read_b64_tr_b16 a[196:197], v14 offset:12288
    v_mfma_f32_16x16x32_bf16 v[64:67], a[84:87], v[124:127], v[64:67]
    ds_read_b128 v[132:135], v18 offset:6976
    v_mfma_f32_16x16x32_bf16 v[68:71], a[88:91], v[124:127], v[68:71]
    ds_read_b64_tr_b16 a[198:199], v14 offset:13056
    v_mfma_f32_16x16x32_bf16 v[72:75], a[92:95], v[124:127], v[72:75]
    s_waitcnt lgkmcnt(5)
    ds_read_b64_tr_b16 a[200:201], v15 offset:12288
    v_mfma_f32_16x16x32_bf16 v[76:79], a[84:87], v[128:131], v[76:79]
    ds_read_b64_tr_b16 a[202:203], v15 offset:13056
    v_mfma_f32_16x16x32_bf16 v[80:83], a[88:91], v[128:131], v[80:83]
    ds_read_b64_tr_b16 v[232:233], v13 offset:18432
    v_mfma_f32_16x16x32_bf16 v[84:87], a[92:95], v[128:131], v[84:87]
    s_waitcnt lgkmcnt(4)
    ds_read_b64_tr_b16 v[234:235], v13 offset:19200
    v_mfma_f32_16x16x32_bf16 v[88:91], a[84:87], v[132:135], v[88:91]
    ds_read_b64_tr_b16 v[236:237], v14 offset:18432
    v_mfma_f32_16x16x32_bf16 v[92:95], a[88:91], v[132:135], v[92:95]
    ds_read_b128 v[136:139], v18 offset:10432
    v_mfma_f32_16x16x32_bf16 v[96:99], a[92:95], v[132:135], v[96:99]
    s_waitcnt lgkmcnt(4)
    ds_read_b64_tr_b16 v[238:239], v14 offset:19200
    v_mfma_f32_16x16x32_bf16 v[64:67], a[192:195], v[128:131], v[64:67]
    buffer_load_dwordx4 v8, s[8:11], s31 offen  lds
    v_mfma_f32_16x16x32_bf16 v[68:71], a[196:199], v[128:131], v[68:71]
    s_add_u32 m0, s25, 51840
    ds_read_b64_tr_b16 v[240:241], v15 offset:18432
    s_add_u32 s31, s53, 645120
    v_mfma_f32_16x16x32_bf16 v[72:75], a[200:203], v[128:131], v[72:75]
    ds_read_b64_tr_b16 v[242:243], v15 offset:19200
    v_mfma_f32_16x16x32_bf16 v[76:79], a[192:195], v[132:135], v[76:79]
    ds_read_b64_tr_b16 a[96:97], v13 offset:24576
    v_mfma_f32_16x16x32_bf16 v[80:83], a[196:199], v[132:135], v[80:83]
    buffer_load_dwordx4 v8, s[8:11], s31 offen  lds
    v_mfma_f32_16x16x32_bf16 v[84:87], a[200:203], v[132:135], v[84:87]
    s_waitcnt lgkmcnt(3)
    ds_read_b64_tr_b16 a[98:99], v13 offset:25344
    v_mfma_f32_16x16x32_bf16 v[88:91], a[192:195], v[136:139], v[88:91]
    ds_read_b64_tr_b16 a[100:101], v14 offset:24576
    v_mfma_f32_16x16x32_bf16 v[92:95], a[196:199], v[136:139], v[92:95]
    ds_read_b128 v[140:143], v18 offset:13888
    v_mfma_f32_16x16x32_bf16 v[96:99], a[200:203], v[136:139], v[96:99]
    s_waitcnt lgkmcnt(4)
    ds_read_b64_tr_b16 a[102:103], v14 offset:25344
    v_mfma_f32_16x16x32_bf16 v[64:67], v[232:235], v[132:135], v[64:67]
    ds_read_b64_tr_b16 a[104:105], v15 offset:24576
    v_mfma_f32_16x16x32_bf16 v[68:71], v[236:239], v[132:135], v[68:71]
    ds_read_b64_tr_b16 a[106:107], v15 offset:25344
    v_mfma_f32_16x16x32_bf16 v[72:75], v[240:243], v[132:135], v[72:75]
    ds_read_b128 v[112:115], v18 offset:128
    v_mfma_f32_16x16x32_bf16 v[76:79], v[232:235], v[136:139], v[76:79]
    ds_read_b64_tr_b16 a[204:205], v13 offset:30720
    v_mfma_f32_16x16x32_bf16 v[80:83], v[236:239], v[136:139], v[80:83]
    ds_read_b128 v[116:119], v18 offset:3584
    v_mfma_f32_16x16x32_bf16 v[84:87], v[240:243], v[136:139], v[84:87]
    s_waitcnt lgkmcnt(5)
    ds_read_b64_tr_b16 a[206:207], v13 offset:31488
    v_mfma_f32_16x16x32_bf16 v[88:91], v[232:235], v[140:143], v[88:91]
    ds_read_b64_tr_b16 a[208:209], v14 offset:30720
    v_mfma_f32_16x16x32_bf16 v[92:95], v[236:239], v[140:143], v[92:95]
    ds_read_b128 v[120:123], v18 offset:7040
    v_mfma_f32_16x16x32_bf16 v[96:99], v[240:243], v[140:143], v[96:99]
    s_waitcnt vmcnt(9) lgkmcnt(5)
    s_barrier
    v_mfma_f32_16x16x32_bf16 v[64:67], a[96:99], v[112:115], v[64:67]
    ds_read_b64_tr_b16 a[210:211], v14 offset:31488
    v_mfma_f32_16x16x32_bf16 v[68:71], a[100:103], v[112:115], v[68:71]
    ds_read_b64_tr_b16 a[212:213], v15 offset:30720
    v_mfma_f32_16x16x32_bf16 v[72:75], a[104:107], v[112:115], v[72:75]
    s_waitcnt lgkmcnt(4)
    ds_read_b64_tr_b16 a[214:215], v15 offset:31488
    v_mfma_f32_16x16x32_bf16 v[76:79], a[96:99], v[116:119], v[76:79]
    ds_read_b64_tr_b16 v[244:245], v13 offset:36864
    v_mfma_f32_16x16x32_bf16 v[80:83], a[100:103], v[116:119], v[80:83]
    ds_read_b64_tr_b16 v[246:247], v13 offset:37632
    v_mfma_f32_16x16x32_bf16 v[84:87], a[104:107], v[116:119], v[84:87]
    s_waitcnt lgkmcnt(5)
    ds_read_b64_tr_b16 v[248:249], v14 offset:36864
    v_mfma_f32_16x16x32_bf16 v[88:91], a[96:99], v[120:123], v[88:91]
    ds_read_b128 v[124:127], v18 offset:10496
    v_mfma_f32_16x16x32_bf16 v[92:95], a[100:103], v[120:123], v[92:95]
    ds_read_b64_tr_b16 v[250:251], v14 offset:37632
    v_mfma_f32_16x16x32_bf16 v[96:99], a[104:107], v[120:123], v[96:99]
    s_waitcnt lgkmcnt(5)
    ds_read_b64_tr_b16 v[252:253], v15 offset:36864
    v_mfma_f32_16x16x32_bf16 v[64:67], a[204:207], v[116:119], v[64:67]
    ds_read_b64_tr_b16 v[254:255], v15 offset:37632
    v_mfma_f32_16x16x32_bf16 v[68:71], a[208:211], v[116:119], v[68:71]
    v_mfma_f32_16x16x32_bf16 v[72:75], a[212:215], v[116:119], v[72:75]
    v_mfma_f32_16x16x32_bf16 v[76:79], a[204:207], v[120:123], v[76:79]
    ds_read_b128 v[128:131], v18 offset:13952
    v_mfma_f32_16x16x32_bf16 v[80:83], a[208:211], v[120:123], v[80:83]
    v_mfma_f32_16x16x32_bf16 v[84:87], a[212:215], v[120:123], v[84:87]
    s_waitcnt lgkmcnt(2)
    v_mfma_f32_16x16x32_bf16 v[88:91], a[204:207], v[124:127], v[88:91]
    ds_read_b128 v[132:135], v40 offset:20736
    v_mfma_f32_16x16x32_bf16 v[92:95], a[208:211], v[124:127], v[92:95]
    v_mfma_f32_16x16x32_bf16 v[96:99], a[212:215], v[124:127], v[96:99]
    s_waitcnt lgkmcnt(2)
    v_mfma_f32_16x16x32_bf16 v[64:67], v[244:247], v[120:123], v[64:67]
    ds_read_b128 v[136:139], v40 offset:20800
    v_mfma_f32_16x16x32_bf16 v[68:71], v[248:251], v[120:123], v[68:71]
    v_mfma_f32_16x16x32_bf16 v[72:75], v[252:255], v[120:123], v[72:75]
    v_mfma_f32_16x16x32_bf16 v[76:79], v[244:247], v[124:127], v[76:79]
    ds_read_b128 v[140:143], v40 offset:20864
    v_mfma_f32_16x16x32_bf16 v[80:83], v[248:251], v[124:127], v[80:83]
    v_mfma_f32_16x16x32_bf16 v[84:87], v[252:255], v[124:127], v[84:87]
    s_waitcnt lgkmcnt(2)
    v_mfma_f32_16x16x32_bf16 v[88:91], v[244:247], v[128:131], v[88:91]
    ds_read_b128 v[112:115], v41 offset:20736
    v_mfma_f32_16x16x32_bf16 v[92:95], v[248:251], v[128:131], v[92:95]
    v_mfma_f32_16x16x32_bf16 v[96:99], v[252:255], v[128:131], v[96:99]
    v_mfma_f32_16x16x32_bf16 v[100:103], a[0:3], v[132:135], 0
    ds_read_b128 v[116:119], v41 offset:20800
    v_cvt_pk_bf16_f32 v72, v72, v73
    v_mfma_f32_16x16x32_bf16 v[104:107], a[4:7], v[132:135], 0
    v_cvt_pk_bf16_f32 v73, v74, v75
    v_cvt_pk_bf16_f32 v84, v84, v85
    v_mfma_f32_16x16x32_bf16 v[108:111], a[8:11], v[132:135], 0
    s_waitcnt lgkmcnt(2)
    ds_write_b64 v38, v[72:73] offset:0
    v_mfma_f32_16x16x32_bf16 v[100:103], a[12:15], v[136:139], v[100:103]
    ds_read_b128 v[120:123], v41 offset:20864
    v_mfma_f32_16x16x32_bf16 v[104:107], a[16:19], v[136:139], v[104:107]
    v_cvt_pk_bf16_f32 v85, v86, v87
    v_cvt_pk_bf16_f32 v96, v96, v97
    v_mfma_f32_16x16x32_bf16 v[108:111], a[20:23], v[136:139], v[108:111]
    ds_write_b64 v38, v[84:85] offset:2048
    v_mfma_f32_16x16x32_bf16 v[100:103], a[24:27], v[140:143], v[100:103]
    ds_read_b128 v[124:127], v42 offset:20736
    v_mfma_f32_16x16x32_bf16 v[104:107], a[28:31], v[140:143], v[104:107]
    v_cvt_pk_bf16_f32 v97, v98, v99
    v_cvt_pk_bf16_f32 v64, v64, v65
    v_mfma_f32_16x16x32_bf16 v[108:111], a[32:35], v[140:143], v[108:111]
    s_waitcnt lgkmcnt(3)
    ds_write_b64 v38, v[96:97] offset:4096
    v_mfma_f32_16x16x32_bf16 v[100:103], a[36:39], v[112:115], v[100:103]
    ds_read_b128 v[128:131], v42 offset:20800
    v_mfma_f32_16x16x32_bf16 v[104:107], a[40:43], v[112:115], v[104:107]
    v_cvt_pk_bf16_f32 v65, v66, v67
    v_cvt_pk_bf16_f32 v66, v68, v69
    v_mfma_f32_16x16x32_bf16 v[108:111], a[44:47], v[112:115], v[108:111]
    v_cvt_pk_bf16_f32 v67, v70, v71
    v_cvt_pk_bf16_f32 v76, v76, v77
    v_mfma_f32_16x16x32_bf16 v[100:103], a[48:51], v[116:119], v[100:103]
    ds_read_b128 v[132:135], v42 offset:20864
    v_cvt_pk_bf16_f32 v77, v78, v79
    v_mfma_f32_16x16x32_bf16 v[104:107], a[52:55], v[116:119], v[104:107]
    v_permlane16_swap_b32 v64, v66
    v_mfma_f32_16x16x32_bf16 v[108:111], a[56:59], v[116:119], v[108:111]
    s_waitcnt lgkmcnt(2)
    v_permlane16_swap_b32 v65, v67
    v_mfma_f32_16x16x32_bf16 v[100:103], a[60:63], v[120:123], v[100:103]
    ds_read_b128 v[136:139], v40 offset:24192
    v_cvt_pk_bf16_f32 v78, v80, v81
    v_mfma_f32_16x16x32_bf16 v[104:107], a[64:67], v[120:123], v[104:107]
    buffer_store_dwordx4 v[64:67], v19, s[20:23], s56 offen sc1
    v_cvt_pk_bf16_f32 v79, v82, v83
    v_cvt_pk_bf16_f32 v88, v88, v89
    v_cvt_pk_bf16_f32 v89, v90, v91
    v_mfma_f32_16x16x32_bf16 v[108:111], a[68:71], v[120:123], v[108:111]
    v_permlane16_swap_b32 v76, v78
    v_mfma_f32_16x16x32_bf16 v[100:103], a[72:75], v[124:127], v[100:103]
    ds_read_b128 v[140:143], v40 offset:24256
    v_cvt_pk_bf16_f32 v90, v92, v93
    v_mfma_f32_16x16x32_bf16 v[104:107], a[76:79], v[124:127], v[104:107]
    v_permlane16_swap_b32 v77, v79
    v_mfma_f32_16x16x32_bf16 v[108:111], a[80:83], v[124:127], v[108:111]
    s_waitcnt lgkmcnt(2)
    v_permlane16_swap_b32 v88, v90
    v_mfma_f32_16x16x32_bf16 v[100:103], a[84:87], v[128:131], v[100:103]
    ds_read_b128 v[112:115], v40 offset:24320
    v_cvt_pk_bf16_f32 v91, v94, v95
    v_mfma_f32_16x16x32_bf16 v[104:107], a[88:91], v[128:131], v[104:107]
    v_mfma_f32_16x16x32_bf16 v[108:111], a[92:95], v[128:131], v[108:111]
    v_permlane16_swap_b32 v89, v91
    v_mfma_f32_16x16x32_bf16 v[100:103], a[96:99], v[132:135], v[100:103]
    ds_read_b128 v[116:119], v41 offset:24192
    v_mfma_f32_16x16x32_bf16 v[104:107], a[100:103], v[132:135], v[104:107]
    buffer_store_dwordx4 v[76:79], v19, s[20:23], s4 offen sc1
    v_mfma_f32_16x16x32_bf16 v[108:111], a[104:107], v[132:135], v[108:111]
    s_waitcnt lgkmcnt(2)
    v_mfma_f32_16x16x32_bf16 v[100:103], a[108:111], v[136:139], v[100:103]
    ds_read_b128 v[120:123], v41 offset:24256
    v_mfma_f32_16x16x32_bf16 v[104:107], a[112:115], v[136:139], v[104:107]
    v_mfma_f32_16x16x32_bf16 v[108:111], a[116:119], v[136:139], v[108:111]
    s_waitcnt vmcnt(5) lgkmcnt(2)
    s_barrier
    v_mfma_f32_16x16x32_bf16 v[100:103], a[120:123], v[140:143], v[100:103]
L_pgX1:
  s_cbranch_execz L_retX
    ds_read_b128 v[124:127], v41 offset:24320
    v_mfma_f32_16x16x32_bf16 v[104:107], a[124:127], v[140:143], v[104:107]
    ds_read_b64 v[6:7], v39 offset:0
    v_mfma_f32_16x16x32_bf16 v[108:111], a[128:131], v[140:143], v[108:111]
    v_mfma_f32_16x16x32_bf16 v[100:103], a[132:135], v[112:115], v[100:103]
    ds_read_b128 v[128:131], v42 offset:24192
    v_mfma_f32_16x16x32_bf16 v[104:107], a[136:139], v[112:115], v[104:107]
    v_mfma_f32_16x16x32_bf16 v[108:111], a[140:143], v[112:115], v[108:111]
    s_waitcnt lgkmcnt(3)
    v_mfma_f32_16x16x32_bf16 v[100:103], a[144:147], v[116:119], v[100:103]
    ds_read_b128 v[132:135], v42 offset:24256
    v_mfma_f32_16x16x32_bf16 v[104:107], a[148:151], v[116:119], v[104:107]
    v_mfma_f32_16x16x32_bf16 v[108:111], a[152:155], v[116:119], v[108:111]
    s_waitcnt lgkmcnt(2)
    v_mfma_f32_16x16x32_bf16 v[100:103], a[156:159], v[120:123], v[100:103]
    ds_read_b128 v[136:139], v42 offset:24320
    v_mfma_f32_16x16x32_bf16 v[104:107], a[160:163], v[120:123], v[104:107]
    buffer_store_dwordx2 v[6:7], v20, s[20:23], s56 offen sc1
    v_mfma_f32_16x16x32_bf16 v[108:111], a[164:167], v[120:123], v[108:111]
    v_mfma_f32_16x16x32_bf16 v[100:103], a[168:171], v[124:127], v[100:103]
    ds_read_b128 v[140:143], v40 offset:27648
    v_mfma_f32_16x16x32_bf16 v[104:107], a[172:175], v[124:127], v[104:107]
    v_mfma_f32_16x16x32_bf16 v[108:111], a[176:179], v[124:127], v[108:111]
    s_waitcnt lgkmcnt(2)
    v_mfma_f32_16x16x32_bf16 v[100:103], a[180:183], v[128:131], v[100:103]
    ds_read_b128 v[112:115], v40 offset:27712
    v_mfma_f32_16x16x32_bf16 v[104:107], a[184:187], v[128:131], v[104:107]
    v_mfma_f32_16x16x32_bf16 v[108:111], a[188:191], v[128:131], v[108:111]
    v_mfma_f32_16x16x32_bf16 v[100:103], a[192:195], v[132:135], v[100:103]
    ds_read_b128 v[116:119], v40 offset:27776
    v_mfma_f32_16x16x32_bf16 v[104:107], a[196:199], v[132:135], v[104:107]
    buffer_store_dwordx4 v[88:91], v19, s[20:23], s5 offen sc1
    v_mfma_f32_16x16x32_bf16 v[108:111], a[200:203], v[132:135], v[108:111]
    s_waitcnt lgkmcnt(2)
    v_mfma_f32_16x16x32_bf16 v[100:103], a[204:207], v[136:139], v[100:103]
    ds_read_b128 v[120:123], v41 offset:27648
    v_mfma_f32_16x16x32_bf16 v[104:107], a[208:211], v[136:139], v[104:107]
    v_mfma_f32_16x16x32_bf16 v[108:111], a[212:215], v[136:139], v[108:111]
    v_mfma_f32_16x16x32_bf16 v[100:103], a[216:219], v[140:143], v[100:103]
    ds_read_b128 v[124:127], v41 offset:27712
    v_mfma_f32_16x16x32_bf16 v[104:107], a[220:223], v[140:143], v[104:107]
    ds_read_b64 v[8:9], v39 offset:2048
    v_mfma_f32_16x16x32_bf16 v[108:111], a[224:227], v[140:143], v[108:111]
    s_waitcnt lgkmcnt(3)
    v_mfma_f32_16x16x32_bf16 v[100:103], a[228:231], v[112:115], v[100:103]
    ds_read_b128 v[128:131], v41 offset:27776
    v_mfma_f32_16x16x32_bf16 v[104:107], a[232:235], v[112:115], v[104:107]
    v_mfma_f32_16x16x32_bf16 v[108:111], a[236:239], v[112:115], v[108:111]
    v_mfma_f32_16x16x32_bf16 v[100:103], a[240:243], v[116:119], v[100:103]
    ds_read_b128 v[132:135], v42 offset:27648
    v_mfma_f32_16x16x32_bf16 v[104:107], a[244:247], v[116:119], v[104:107]
    v_mfma_f32_16x16x32_bf16 v[108:111], a[248:251], v[116:119], v[108:111]
    s_waitcnt lgkmcnt(2)
    v_mfma_f32_16x16x32_bf16 v[100:103], a[252:255], v[120:123], v[100:103]
    ds_read_b128 v[136:139], v42 offset:27712
    v_mfma_f32_16x16x32_bf16 v[104:107], v[188:191], v[120:123], v[104:107]
    buffer_store_dwordx2 v[8:9], v20, s[20:23], s4 offen sc1
    v_mfma_f32_16x16x32_bf16 v[108:111], v[192:195], v[120:123], v[108:111]
    v_mfma_f32_16x16x32_bf16 v[100:103], v[196:199], v[124:127], v[100:103]
    ds_read_b128 v[140:143], v42 offset:27776
    v_mfma_f32_16x16x32_bf16 v[104:107], v[200:203], v[124:127], v[104:107]
    v_mfma_f32_16x16x32_bf16 v[108:111], v[204:207], v[124:127], v[108:111]
    s_waitcnt lgkmcnt(2)
    v_mfma_f32_16x16x32_bf16 v[100:103], v[208:211], v[128:131], v[100:103]
    ds_read_b128 v[112:115], v40 offset:27648
    v_mfma_f32_16x16x32_bf16 v[104:107], v[212:215], v[128:131], v[104:107]
    v_mfma_f32_16x16x32_bf16 v[108:111], v[216:219], v[128:131], v[108:111]
    v_mfma_f32_16x16x32_bf16 v[100:103], v[220:223], v[132:135], v[100:103]
    ds_read_b128 v[116:119], v40 offset:27712
    v_mfma_f32_16x16x32_bf16 v[104:107], v[224:227], v[132:135], v[104:107]
    v_mfma_f32_16x16x32_bf16 v[108:111], v[228:231], v[132:135], v[108:111]
    s_waitcnt lgkmcnt(2)
    v_mfma_f32_16x16x32_bf16 v[100:103], v[232:235], v[136:139], v[100:103]
    ds_read_b128 v[120:123], v40 offset:27776
    v_mfma_f32_16x16x32_bf16 v[104:107], v[236:239], v[136:139], v[104:107]
    v_mfma_f32_16x16x32_bf16 v[108:111], v[240:243], v[136:139], v[108:111]
    v_mfma_f32_16x16x32_bf16 v[100:103], v[244:247], v[140:143], v[100:103]
    ds_read_b128 v[124:127], v41 offset:27648
    v_mfma_f32_16x16x32_bf16 v[104:107], v[248:251], v[140:143], v[104:107]
    ds_read_b64 v[10:11], v39 offset:4096
    v_mfma_f32_16x16x32_bf16 v[108:111], v[252:255], v[140:143], v[108:111]
    s_waitcnt lgkmcnt(3)
    v_mfma_f32_16x16x32_bf16 v[64:67], a[0:3], v[112:115], 0
    ds_read_b128 v[128:131], v41 offset:27712
    v_mfma_f32_16x16x32_bf16 v[68:71], a[4:7], v[112:115], 0
    v_cvt_pk_bf16_f32 v100, v100, v101
    v_cvt_pk_bf16_f32 v101, v102, v103
    v_mfma_f32_16x16x32_bf16 v[72:75], a[8:11], v[112:115], 0
    v_cvt_pk_bf16_f32 v102, v104, v105
    v_cvt_pk_bf16_f32 v108, v108, v109
    v_mfma_f32_16x16x32_bf16 v[64:67], a[12:15], v[116:119], v[64:67]
    ds_read_b128 v[132:135], v41 offset:27776
    v_cvt_pk_bf16_f32 v109, v110, v111
    v_mfma_f32_16x16x32_bf16 v[68:71], a[16:19], v[116:119], v[68:71]
    ds_write_b64 v38, v[108:109] offset:6144
    v_mfma_f32_16x16x32_bf16 v[72:75], a[20:23], v[116:119], v[72:75]
    s_waitcnt lgkmcnt(3)
    v_permlane16_swap_b32 v100, v102
    v_mfma_f32_16x16x32_bf16 v[64:67], a[24:27], v[120:123], v[64:67]
    ds_read_b128 v[136:139], v42 offset:27648
    v_cvt_pk_bf16_f32 v103, v106, v107
    v_mfma_f32_16x16x32_bf16 v[68:71], a[28:31], v[120:123], v[68:71]
    buffer_store_dwordx2 v[10:11], v20, s[20:23], s5 offen sc1
    v_mfma_f32_16x16x32_bf16 v[72:75], a[32:35], v[120:123], v[72:75]
    v_permlane16_swap_b32 v101, v103
    v_mfma_f32_16x16x32_bf16 v[64:67], a[36:39], v[124:127], v[64:67]
    ds_read_b128 v[140:143], v42 offset:27712
    v_mfma_f32_16x16x32_bf16 v[68:71], a[40:43], v[124:127], v[68:71]
    v_mfma_f32_16x16x32_bf16 v[72:75], a[44:47], v[124:127], v[72:75]
    s_waitcnt lgkmcnt(2)
    v_mfma_f32_16x16x32_bf16 v[64:67], a[48:51], v[128:131], v[64:67]
    ds_read_b128 v[112:115], v42 offset:27776
    v_mfma_f32_16x16x32_bf16 v[68:71], a[52:55], v[128:131], v[68:71]
    buffer_store_dwordx4 v[100:103], v21, s[20:23], s74 offen sc1
    v_mfma_f32_16x16x32_bf16 v[72:75], a[56:59], v[128:131], v[72:75]
    v_mfma_f32_16x16x32_bf16 v[64:67], a[60:63], v[132:135], v[64:67]
    ds_read_b128 v[116:119], v40 offset:31104
    v_mfma_f32_16x16x32_bf16 v[68:71], a[64:67], v[132:135], v[68:71]
    v_mfma_f32_16x16x32_bf16 v[72:75], a[68:71], v[132:135], v[72:75]
    s_waitcnt lgkmcnt(2)
    v_mfma_f32_16x16x32_bf16 v[64:67], a[72:75], v[136:139], v[64:67]
    ds_read_b128 v[120:123], v40 offset:31168
    v_mfma_f32_16x16x32_bf16 v[68:71], a[76:79], v[136:139], v[68:71]
    v_mfma_f32_16x16x32_bf16 v[72:75], a[80:83], v[136:139], v[72:75]
    v_mfma_f32_16x16x32_bf16 v[64:67], a[84:87], v[140:143], v[64:67]
    ds_read_b128 v[124:127], v40 offset:31232
    v_mfma_f32_16x16x32_bf16 v[68:71], a[88:91], v[140:143], v[68:71]
    v_mfma_f32_16x16x32_bf16 v[72:75], a[92:95], v[140:143], v[72:75]
    s_waitcnt vmcnt(13) lgkmcnt(2)
    v_mfma_f32_16x16x32_bf16 v[64:67], a[96:99], v[112:115], v[64:67]
    ds_read_b128 v[128:131], v41 offset:31104
    v_and_b32 v180, s96, v180
    v_mfma_f32_16x16x32_bf16 v[68:71], a[100:103], v[112:115], v[68:71]
    v_and_b32 v181, s96, v181
    v_and_b32 v182, s96, v182
    v_mfma_f32_16x16x32_bf16 v[72:75], a[104:107], v[112:115], v[72:75]
    v_and_b32 v183, s96, v183
    v_pk_max_u16 v180, v180, v181
    v_mfma_f32_16x16x32_bf16 v[64:67], a[108:111], v[116:119], v[64:67]
    ds_read_b128 v[132:135], v41 offset:31168
    v_pk_max_u16 v182, v182, v183
    v_mfma_f32_16x16x32_bf16 v[68:71], a[112:115], v[116:119], v[68:71]
    v_pk_max_u16 v180, v180, s37
    v_pk_max_u16 v180, v180, v182
    v_mfma_f32_16x16x32_bf16 v[72:75], a[116:119], v[116:119], v[72:75]
    s_waitcnt lgkmcnt(2)
    v_cmp_ne_u32 s[80:81], s37, v180
    v_and_b32 v184, s96, v184
    v_mfma_f32_16x16x32_bf16 v[64:67], a[120:123], v[120:123], v[64:67]
    ds_read_b128 v[136:139], v41 offset:31232
    v_and_b32 v185, s96, v185
    v_mfma_f32_16x16x32_bf16 v[68:71], a[124:127], v[120:123], v[68:71]
    v_and_b32 v186, s96, v186
    v_and_b32 v187, s96, v187
    v_mfma_f32_16x16x32_bf16 v[72:75], a[128:131], v[120:123], v[72:75]
    v_pk_max_u16 v184, v184, v185
    v_pk_max_u16 v186, v186, v187
    v_mfma_f32_16x16x32_bf16 v[64:67], a[132:135], v[124:127], v[64:67]
    ds_read_b128 v[140:143], v42 offset:31104
    v_pk_max_u16 v184, v184, s37
    v_mfma_f32_16x16x32_bf16 v[68:71], a[136:139], v[124:127], v[68:71]
    v_pk_max_u16 v184, v184, v186
    v_cmp_ne_u32 s[82:83], s37, v184
    v_mfma_f32_16x16x32_bf16 v[72:75], a[140:143], v[124:127], v[72:75]
    s_waitcnt lgkmcnt(2)
    v_mfma_f32_16x16x32_bf16 v[64:67], a[144:147], v[128:131], v[64:67]
    ds_read_b128 v[112:115], v42 offset:31168
    v_mfma_f32_16x16x32_bf16 v[68:71], a[148:151], v[128:131], v[68:71]
    s_or_b64 vcc, s[80:81], s[82:83]
    s_cbranch_scc1 L_afailX
L_afailX_back:
    v_mfma_f32_16x16x32_bf16 v[72:75], a[152:155], v[128:131], v[72:75]
    v_mfma_f32_16x16x32_bf16 v[64:67], a[156:159], v[132:135], v[64:67]
    ds_read_b128 v[116:119], v42 offset:31232
    v_mfma_f32_16x16x32_bf16 v[68:71], a[160:163], v[132:135], v[68:71]
    v_mfma_f32_16x16x32_bf16 v[72:75], a[164:167], v[132:135], v[72:75]
    s_waitcnt lgkmcnt(2)
    v_mfma_f32_16x16x32_bf16 v[64:67], a[168:171], v[136:139], v[64:67]
    ds_read_b128 v[120:123], v40 offset:34560
    v_mfma_f32_16x16x32_bf16 v[68:71], a[172:175], v[136:139], v[68:71]
    v_mfma_f32_16x16x32_bf16 v[72:75], a[176:179], v[136:139], v[72:75]
    v_mfma_f32_16x16x32_bf16 v[64:67], a[180:183], v[140:143], v[64:67]
    ds_read_b128 v[124:127], v40 offset:34624
    v_mfma_f32_16x16x32_bf16 v[68:71], a[184:187], v[140:143], v[68:71]
    v_mfma_f32_16x16x32_bf16 v[72:75], a[188:191], v[140:143], v[72:75]
    s_waitcnt lgkmcnt(2)
    v_mfma_f32_16x16x32_bf16 v[64:67], a[192:195], v[112:115], v[64:67]
    ds_read_b128 v[128:131], v40 offset:34688
    v_mfma_f32_16x16x32_bf16 v[68:71], a[196:199], v[112:115], v[68:71]
    v_mfma_f32_16x16x32_bf16 v[72:75], a[200:203], v[112:115], v[72:75]
    v_mfma_f32_16x16x32_bf16 v[64:67], a[204:207], v[116:119], v[64:67]
    ds_read_b128 v[132:135], v41 offset:34560
    v_mfma_f32_16x16x32_bf16 v[68:71], a[208:211], v[116:119], v[68:71]
    v_mfma_f32_16x16x32_bf16 v[72:75], a[212:215], v[116:119], v[72:75]
    s_waitcnt lgkmcnt(2)
    v_mfma_f32_16x16x32_bf16 v[64:67], a[216:219], v[120:123], v[64:67]
    ds_read_b128 v[136:139], v41 offset:34624
    v_mfma_f32_16x16x32_bf16 v[68:71], a[220:223], v[120:123], v[68:71]
    v_mfma_f32_16x16x32_bf16 v[72:75], a[224:227], v[120:123], v[72:75]
    v_mfma_f32_16x16x32_bf16 v[64:67], a[228:231], v[124:127], v[64:67]
    ds_read_b128 v[140:143], v41 offset:34688
    v_mfma_f32_16x16x32_bf16 v[68:71], a[232:235], v[124:127], v[68:71]
    v_mfma_f32_16x16x32_bf16 v[72:75], a[236:239], v[124:127], v[72:75]
    s_waitcnt lgkmcnt(2)
    v_mfma_f32_16x16x32_bf16 v[64:67], a[240:243], v[128:131], v[64:67]
    ds_read_b128 v[112:115], v42 offset:34560
    v_mfma_f32_16x16x32_bf16 v[68:71], a[244:247], v[128:131], v[68:71]
    v_mfma_f32_16x16x32_bf16 v[72:75], a[248:251], v[128:131], v[72:75]
    v_mfma_f32_16x16x32_bf16 v[64:67], a[252:255], v[132:135], v[64:67]
    ds_read_b128 v[116:119], v42 offset:34624
    v_mfma_f32_16x16x32_bf16 v[68:71], v[188:191], v[132:135], v[68:71]
    v_mfma_f32_16x16x32_bf16 v[72:75], v[192:195], v[132:135], v[72:75]
    s_waitcnt lgkmcnt(2)
    v_mfma_f32_16x16x32_bf16 v[64:67], v[196:199], v[136:139], v[64:67]
    ds_read_b128 v[120:123], v42 offset:34688
    v_mfma_f32_16x16x32_bf16 v[68:71], v[200:203], v[136:139], v[68:71]
    v_mfma_f32_16x16x32_bf16 v[72:75], v[204:207], v[136:139], v[72:75]
    v_mfma_f32_16x16x32_bf16 v[64:67], v[208:211], v[140:143], v[64:67]
    ds_read_b128 v[124:127], v40 offset:34560
    v_mfma_f32_16x16x32_bf16 v[68:71], v[212:215], v[140:143], v[68:71]
    v_mfma_f32_16x16x32_bf16 v[72:75], v[216:219], v[140:143], v[72:75]
    s_waitcnt lgkmcnt(2)
    v_mfma_f32_16x16x32_bf16 v[64:67], v[220:223], v[112:115], v[64:67]
    ds_read_b128 v[128:131], v40 offset:34624
    v_mfma_f32_16x16x32_bf16 v[68:71], v[224:227], v[112:115], v[68:71]
    v_mfma_f32_16x16x32_bf16 v[72:75], v[228:231], v[112:115], v[72:75]
    v_mfma_f32_16x16x32_bf16 v[64:67], v[232:235], v[116:119], v[64:67]
    ds_read_b128 v[132:135], v40 offset:34688
    v_mfma_f32_16x16x32_bf16 v[68:71], v[236:239], v[116:119], v[68:71]
    v_mfma_f32_16x16x32_bf16 v[72:75], v[240:243], v[116:119], v[72:75]
    s_waitcnt lgkmcnt(2)
    v_mfma_f32_16x16x32_bf16 v[64:67], v[244:247], v[120:123], v[64:67]
    ds_read_b128 v[136:139], v41 offset:34560
    v_mfma_f32_16x16x32_bf16 v[68:71], v[248:251], v[120:123], v[68:71]
    v_mfma_f32_16x16x32_bf16 v[72:75], v[252:255], v[120:123], v[72:75]
    v_mfma_f32_16x16x32_bf16 v[76:79], a[0:3], v[124:127], 0
    ds_read_b128 v[140:143], v41 offset:34624
    v_mfma_f32_16x16x32_bf16 v[80:83], a[4:7], v[124:127], 0
    v_mfma_f32_16x16x32_bf16 v[84:87], a[8:11], v[124:127], 0
    s_waitcnt lgkmcnt(2)
    v_cvt_pk_bf16_f32 v64, v64, v65
    v_cvt_pk_bf16_f32 v65, v66, v67
    v_mfma_f32_16x16x32_bf16 v[76:79], a[12:15], v[128:131], v[76:79]
    ds_read_b128 v[112:115], v41 offset:34688
    v_cvt_pk_bf16_f32 v72, v72, v73
    v_mfma_f32_16x16x32_bf16 v[80:83], a[16:19], v[128:131], v[80:83]
    v_cvt_pk_bf16_f32 v73, v74, v75
    v_cvt_pk_bf16_f32 v66, v68, v69
    v_mfma_f32_16x16x32_bf16 v[84:87], a[20:23], v[128:131], v[84:87]
    ds_write_b64 v38, v[72:73] offset:8192
    v_mfma_f32_16x16x32_bf16 v[76:79], a[24:27], v[132:135], v[76:79]
    ds_read_b128 v[116:119], v42 offset:34560
    v_mfma_f32_16x16x32_bf16 v[80:83], a[28:31], v[132:135], v[80:83]
    v_permlane16_swap_b32 v64, v66
    v_mfma_f32_16x16x32_bf16 v[84:87], a[32:35], v[132:135], v[84:87]
    s_waitcnt lgkmcnt(3)
    v_cvt_pk_bf16_f32 v67, v70, v71
    v_mfma_f32_16x16x32_bf16 v[76:79], a[36:39], v[136:139], v[76:79]
    ds_read_b128 v[120:123], v42 offset:34624
    v_mfma_f32_16x16x32_bf16 v[80:83], a[40:43], v[136:139], v[80:83]
    v_permlane16_swap_b32 v65, v67
    v_mfma_f32_16x16x32_bf16 v[84:87], a[44:47], v[136:139], v[84:87]
    buffer_store_dwordx4 v[64:67], v21, s[20:23], s75 offen sc1
    v_mfma_f32_16x16x32_bf16 v[76:79], a[48:51], v[140:143], v[76:79]
    ds_read_b128 v[124:127], v42 offset:34688
    v_mfma_f32_16x16x32_bf16 v[80:83], a[52:55], v[140:143], v[80:83]
    v_mfma_f32_16x16x32_bf16 v[84:87], a[56:59], v[140:143], v[84:87]
    s_waitcnt lgkmcnt(2)
    v_mfma_f32_16x16x32_bf16 v[76:79], a[60:63], v[112:115], v[76:79]
    ds_read_b128 v[128:131], v40 offset:38016
    v_mfma_f32_16x16x32_bf16 v[80:83], a[64:67], v[112:115], v[80:83]
    v_mfma_f32_16x16x32_bf16 v[84:87], a[68:71], v[112:115], v[84:87]
    v_mfma_f32_16x16x32_bf16 v[76:79], a[72:75], v[116:119], v[76:79]
    ds_read_b128 v[132:135], v40 offset:38080
    v_mfma_f32_16x16x32_bf16 v[80:83], a[76:79], v[116:119], v[80:83]
    v_mfma_f32_16x16x32_bf16 v[84:87], a[80:83], v[116:119], v[84:87]
    s_waitcnt lgkmcnt(2)
    v_mfma_f32_16x16x32_bf16 v[76:79], a[84:87], v[120:123], v[76:79]
    ds_read_b128 v[136:139], v40 offset:38144
    v_mfma_f32_16x16x32_bf16 v[80:83], a[88:91], v[120:123], v[80:83]
    v_mfma_f32_16x16x32_bf16 v[84:87], a[92:95], v[120:123], v[84:87]
    s_waitcnt vmcnt(9) lgkmcnt(2)
    s_barrier
    v_mfma_f32_16x16x32_bf16 v[76:79], a[96:99], v[124:127], v[76:79]
    ds_read_b128 v[140:143], v41 offset:38016
    v_mfma_f32_16x16x32_bf16 v[80:83], a[100:103], v[124:127], v[80:83]
    ds_read_b32 v35, v34
    v_mfma_f32_16x16x32_bf16 v[84:87], a[104:107], v[124:127], v[84:87]
    ds_read_b64 v[12:13], v39 offset:6144
    v_mfma_f32_16x16x32_bf16 v[76:79], a[108:111], v[128:131], v[76:79]
    ds_read_b128 v[112:115], v41 offset:38080
    v_mfma_f32_16x16x32_bf16 v[80:83], a[112:115], v[128:131], v[80:83]
    ds_read_b64 v[14:15], v39 offset:8192
    v_mfma_f32_16x16x32_bf16 v[84:87], a[116:119], v[128:131], v[84:87]
    s_waitcnt lgkmcnt(5)
    v_mfma_f32_16x16x32_bf16 v[76:79], a[120:123], v[132:135], v[76:79]
    ds_read_b128 v[116:119], v41 offset:38144
    v_mfma_f32_16x16x32_bf16 v[80:83], a[124:127], v[132:135], v[80:83]
    v_mfma_f32_16x16x32_bf16 v[84:87], a[128:131], v[132:135], v[84:87]
    s_waitcnt lgkmcnt(3)
    v_readfirstlane_b32 s63, v35
    v_mfma_f32_16x16x32_bf16 v[76:79], a[132:135], v[136:139], v[76:79]
    ds_read_b128 v[120:123], v42 offset:38016
    v_mfma_f32_16x16x32_bf16 v[80:83], a[136:139], v[136:139], v[80:83]
    buffer_store_dwordx2 v[12:13], v22, s[20:23], s74 offen sc1
    v_mfma_f32_16x16x32_bf16 v[84:87], a[140:143], v[136:139], v[84:87]
    s_waitcnt lgkmcnt(2)
    v_mfma_f32_16x16x32_bf16 v[76:79], a[144:147], v[140:143], v[76:79]
    ds_read_b128 v[124:127], v42 offset:38080
    v_mfma_f32_16x16x32_bf16 v[80:83], a[148:151], v[140:143], v[80:83]
    v_mfma_f32_16x16x32_bf16 v[84:87], a[152:155], v[140:143], v[84:87]
    buffer_store_dwordx2 v[14:15], v22, s[20:23], s75 offen sc1
    v_mfma_f32_16x16x32_bf16 v[76:79], a[156:159], v[112:115], v[76:79]
    ds_read_b128 v[128:131], v42 offset:38144
    v_mfma_f32_16x16x32_bf16 v[80:83], a[160:163], v[112:115], v[80:83]
    v_mfma_f32_16x16x32_bf16 v[84:87], a[164:167], v[112:115], v[84:87]
    s_waitcnt lgkmcnt(2)
    v_mfma_f32_16x16x32_bf16 v[76:79], a[168:171], v[116:119], v[76:79]
    ds_read_b128 v[132:135], v40 offset:41472
    v_mfma_f32_16x16x32_bf16 v[80:83], a[172:175], v[116:119], v[80:83]
    v_mfma_f32_16x16x32_bf16 v[84:87], a[176:179], v[116:119], v[84:87]
    v_mfma_f32_16x16x32_bf16 v[76:79], a[180:183], v[120:123], v[76:79]
    ds_read_b128 v[136:139], v40 offset:41536
    v_mfma_f32_16x16x32_bf16 v[80:83], a[184:187], v[120:123], v[80:83]
    v_mfma_f32_16x16x32_bf16 v[84:87], a[188:191], v[120:123], v[84:87]
    s_waitcnt lgkmcnt(2)
    v_mfma_f32_16x16x32_bf16 v[76:79], a[192:195], v[124:127], v[76:79]
    ds_read_b128 v[140:143], v40 offset:41600
    v_mfma_f32_16x16x32_bf16 v[80:83], a[196:199], v[124:127], v[80:83]
    v_mfma_f32_16x16x32_bf16 v[84:87], a[200:203], v[124:127], v[84:87]
    v_mfma_f32_16x16x32_bf16 v[76:79], a[204:207], v[128:131], v[76:79]
    ds_read_b128 v[112:115], v41 offset:41472
    v_mfma_f32_16x16x32_bf16 v[80:83], a[208:211], v[128:131], v[80:83]
    v_mfma_f32_16x16x32_bf16 v[84:87], a[212:215], v[128:131], v[84:87]
    s_waitcnt lgkmcnt(2)
    v_mfma_f32_16x16x32_bf16 v[76:79], a[216:219], v[132:135], v[76:79]
    ds_read_b128 v[116:119], v41 offset:41536
    v_mfma_f32_16x16x32_bf16 v[80:83], a[220:223], v[132:135], v[80:83]
    v_mfma_f32_16x16x32_bf16 v[84:87], a[224:227], v[132:135], v[84:87]
    v_mfma_f32_16x16x32_bf16 v[76:79], a[228:231], v[136:139], v[76:79]
    ds_read_b128 v[120:123], v41 offset:41600
    v_mfma_f32_16x16x32_bf16 v[80:83], a[232:235], v[136:139], v[80:83]
    v_mfma_f32_16x16x32_bf16 v[84:87], a[236:239], v[136:139], v[84:87]
    s_waitcnt lgkmcnt(2)
    v_mfma_f32_16x16x32_bf16 v[76:79], a[240:243], v[140:143], v[76:79]
    ds_read_b128 v[124:127], v42 offset:41472
    v_mfma_f32_16x16x32_bf16 v[80:83], a[244:247], v[140:143], v[80:83]
    v_mfma_f32_16x16x32_bf16 v[84:87], a[248:251], v[140:143], v[84:87]
    v_mfma_f32_16x16x32_bf16 v[76:79], a[252:255], v[112:115], v[76:79]
    ds_read_b128 v[128:131], v42 offset:41536
    v_mfma_f32_16x16x32_bf16 v[80:83], v[188:191], v[112:115], v[80:83]
    v_mfma_f32_16x16x32_bf16 v[84:87], v[192:195], v[112:115], v[84:87]
    s_waitcnt lgkmcnt(2)
    v_mfma_f32_16x16x32_bf16 v[76:79], v[196:199], v[116:119], v[76:79]
    ds_read_b128 v[132:135], v42 offset:41600
    v_mfma_f32_16x16x32_bf16 v[80:83], v[200:203], v[116:119], v[80:83]
    v_mfma_f32_16x16x32_bf16 v[84:87], v[204:207], v[116:119], v[84:87]
    v_mfma_f32_16x16x32_bf16 v[76:79], v[208:211], v[120:123], v[76:79]
    ds_read_b128 v[136:139], v40 offset:41472
    v_mfma_f32_16x16x32_bf16 v[80:83], v[212:215], v[120:123], v[80:83]
    v_mfma_f32_16x16x32_bf16 v[84:87], v[216:219], v[120:123], v[84:87]
    s_waitcnt lgkmcnt(2)
    v_mfma_f32_16x16x32_bf16 v[76:79], v[220:223], v[124:127], v[76:79]
    ds_read_b128 v[140:143], v40 offset:41536
    v_mfma_f32_16x16x32_bf16 v[80:83], v[224:227], v[124:127], v[80:83]
    v_mfma_f32_16x16x32_bf16 v[84:87], v[228:231], v[124:127], v[84:87]
    v_mfma_f32_16x16x32_bf16 v[76:79], v[232:235], v[128:131], v[76:79]
    ds_read_b128 v[112:115], v40 offset:41600
    v_mfma_f32_16x16x32_bf16 v[80:83], v[236:239], v[128:131], v[80:83]
    v_mfma_f32_16x16x32_bf16 v[84:87], v[240:243], v[128:131], v[84:87]
    s_waitcnt lgkmcnt(2)
    v_mfma_f32_16x16x32_bf16 v[76:79], v[244:247], v[132:135], v[76:79]
    ds_read_b128 v[116:119], v41 offset:41472
    v_mfma_f32_16x16x32_bf16 v[80:83], v[248:251], v[132:135], v[80:83]
    v_mfma_f32_16x16x32_bf16 v[84:87], v[252:255], v[132:135], v[84:87]
    v_mfma_f32_16x16x32_bf16 v[88:91], a[0:3], v[136:139], 0
    ds_read_b128 v[120:123], v41 offset:41536
    v_mfma_f32_16x16x32_bf16 v[92:95], a[4:7], v[136:139], 0
    v_mfma_f32_16x16x32_bf16 v[96:99], a[8:11], v[136:139], 0
    s_waitcnt lgkmcnt(2)
    v_cvt_pk_bf16_f32 v76, v76, v77
    v_cvt_pk_bf16_f32 v77, v78, v79
    v_mfma_f32_16x16x32_bf16 v[88:91], a[12:15], v[140:143], v[88:91]
    ds_read_b128 v[124:127], v41 offset:41600
    v_cvt_pk_bf16_f32 v84, v84, v85
    v_mfma_f32_16x16x32_bf16 v[92:95], a[16:19], v[140:143], v[92:95]
    v_cvt_pk_bf16_f32 v85, v86, v87
    v_cvt_pk_bf16_f32 v78, v80, v81
    v_mfma_f32_16x16x32_bf16 v[96:99], a[20:23], v[140:143], v[96:99]
    ds_write_b64 v38, v[84:85] offset:10240
    v_mfma_f32_16x16x32_bf16 v[88:91], a[24:27], v[112:115], v[88:91]
    ds_read_b128 v[128:131], v42 offset:41472
    v_mfma_f32_16x16x32_bf16 v[92:95], a[28:31], v[112:115], v[92:95]
    v_permlane16_swap_b32 v76, v78
    v_mfma_f32_16x16x32_bf16 v[96:99], a[32:35], v[112:115], v[96:99]
    s_waitcnt lgkmcnt(3)
    v_cvt_pk_bf16_f32 v79, v82, v83
    v_mfma_f32_16x16x32_bf16 v[88:91], a[36:39], v[116:119], v[88:91]
    ds_read_b128 v[132:135], v42 offset:41536
    v_mfma_f32_16x16x32_bf16 v[92:95], a[40:43], v[116:119], v[92:95]
    v_permlane16_swap_b32 v77, v79
    v_mfma_f32_16x16x32_bf16 v[96:99], a[44:47], v[116:119], v[96:99]
    buffer_store_dwordx4 v[76:79], v21, s[20:23], s76 offen sc1
    v_mfma_f32_16x16x32_bf16 v[88:91], a[48:51], v[120:123], v[88:91]
    ds_read_b128 v[136:139], v42 offset:41600
    v_mfma_f32_16x16x32_bf16 v[92:95], a[52:55], v[120:123], v[92:95]
    v_mfma_f32_16x16x32_bf16 v[96:99], a[56:59], v[120:123], v[96:99]
    s_waitcnt lgkmcnt(2)
    v_mfma_f32_16x16x32_bf16 v[88:91], a[60:63], v[124:127], v[88:91]
    ds_read_b128 v[140:143], v40 offset:44928
    v_mfma_f32_16x16x32_bf16 v[92:95], a[64:67], v[124:127], v[92:95]
    v_mfma_f32_16x16x32_bf16 v[96:99], a[68:71], v[124:127], v[96:99]
    v_mfma_f32_16x16x32_bf16 v[88:91], a[72:75], v[128:131], v[88:91]
    ds_read_b128 v[112:115], v40 offset:44992
    v_mfma_f32_16x16x32_bf16 v[92:95], a[76:79], v[128:131], v[92:95]
    v_mfma_f32_16x16x32_bf16 v[96:99], a[80:83], v[128:131], v[96:99]
    s_waitcnt lgkmcnt(2)
    v_mfma_f32_16x16x32_bf16 v[88:91], a[84:87], v[132:135], v[88:91]
    ds_read_b128 v[116:119], v40 offset:45056
    v_mfma_f32_16x16x32_bf16 v[92:95], a[88:91], v[132:135], v[92:95]
    v_mfma_f32_16x16x32_bf16 v[96:99], a[92:95], v[132:135], v[96:99]
    s_waitcnt vmcnt(11) lgkmcnt(2)
    s_barrier
    v_mfma_f32_16x16x32_bf16 v[88:91], a[96:99], v[136:139], v[88:91]
    ds_read_b128 v[120:123], v41 offset:44928
    v_mfma_f32_16x16x32_bf16 v[92:95], a[100:103], v[136:139], v[92:95]
    ds_read_b64 v[62:63], v39 offset:10240
    v_mfma_f32_16x16x32_bf16 v[96:99], a[104:107], v[136:139], v[96:99]
    v_mfma_f32_16x16x32_bf16 v[88:91], a[108:111], v[140:143], v[88:91]
    ds_read_b128 v[124:127], v41 offset:44992
    v_mfma_f32_16x16x32_bf16 v[92:95], a[112:115], v[140:143], v[92:95]
    v_mfma_f32_16x16x32_bf16 v[96:99], a[116:119], v[140:143], v[96:99]
    s_waitcnt lgkmcnt(3)
    v_mfma_f32_16x16x32_bf16 v[88:91], a[120:123], v[112:115], v[88:91]
    ds_read_b128 v[128:131], v41 offset:45056
    v_mfma_f32_16x16x32_bf16 v[92:95], a[124:127], v[112:115], v[92:95]
    v_mfma_f32_16x16x32_bf16 v[96:99], a[128:131], v[112:115], v[96:99]
    s_waitcnt lgkmcnt(2)
    v_mfma_f32_16x16x32_bf16 v[88:91], a[132:135], v[116:119], v[88:91]
    ds_read_b128 v[132:135], v42 offset:44928
    v_mfma_f32_16x16x32_bf16 v[92:95], a[136:139], v[116:119], v[92:95]
    buffer_store_dwordx2 v[62:63], v22, s[20:23], s76 offen sc1
    v_mfma_f32_16x16x32_bf16 v[96:99], a[140:143], v[116:119], v[96:99]
    v_mfma_f32_16x16x32_bf16 v[88:91], a[144:147], v[120:123], v[88:91]
    ds_read_b128 v[136:139], v42 offset:44992
    v_mfma_f32_16x16x32_bf16 v[92:95], a[148:151], v[120:123], v[92:95]
    v_mfma_f32_16x16x32_bf16 v[96:99], a[152:155], v[120:123], v[96:99]
    s_waitcnt lgkmcnt(2)
    v_mfma_f32_16x16x32_bf16 v[88:91], a[156:159], v[124:127], v[88:91]
    ds_read_b128 v[140:143], v42 offset:45056
    v_mfma_f32_16x16x32_bf16 v[92:95], a[160:163], v[124:127], v[92:95]
    v_mfma_f32_16x16x32_bf16 v[96:99], a[164:167], v[124:127], v[96:99]
    v_mfma_f32_16x16x32_bf16 v[88:91], a[168:171], v[128:131], v[88:91]
    ds_read_b128 v[112:115], v40 offset:48384
    v_mfma_f32_16x16x32_bf16 v[92:95], a[172:175], v[128:131], v[92:95]
    v_mfma_f32_16x16x32_bf16 v[96:99], a[176:179], v[128:131], v[96:99]
    s_waitcnt lgkmcnt(2)
    v_mfma_f32_16x16x32_bf16 v[88:91], a[180:183], v[132:135], v[88:91]
    ds_read_b128 v[116:119], v40 offset:48448
    v_mfma_f32_16x16x32_bf16 v[92:95], a[184:187], v[132:135], v[92:95]
    v_mfma_f32_16x16x32_bf16 v[96:99], a[188:191], v[132:135], v[96:99]
    v_mfma_f32_16x16x32_bf16 v[88:91], a[192:195], v[136:139], v[88:91]
    ds_read_b128 v[120:123], v40 offset:48512
    v_mfma_f32_16x16x32_bf16 v[92:95], a[196:199], v[136:139], v[92:95]
    v_mfma_f32_16x16x32_bf16 v[96:99], a[200:203], v[136:139], v[96:99]
    s_waitcnt lgkmcnt(2)
    v_mfma_f32_16x16x32_bf16 v[88:91], a[204:207], v[140:143], v[88:91]
    ds_read_b128 v[124:127], v41 offset:48384
    v_mfma_f32_16x16x32_bf16 v[92:95], a[208:211], v[140:143], v[92:95]
    ds_read_b128 v[128:131], v41 offset:48448
    v_mfma_f32_16x16x32_bf16 v[96:99], a[212:215], v[140:143], v[96:99]
    ds_read_b128 v[132:135], v41 offset:48512
    v_mfma_f32_16x16x32_bf16 v[88:91], a[216:219], v[112:115], v[88:91]
    ds_read_b128 v[136:139], v42 offset:48384
    v_mfma_f32_16x16x32_bf16 v[92:95], a[220:223], v[112:115], v[92:95]
    ds_read_b128 v[140:143], v42 offset:48448
    v_mfma_f32_16x16x32_bf16 v[96:99], a[224:227], v[112:115], v[96:99]
    s_waitcnt lgkmcnt(5)
    ds_read_b128 v[112:115], v42 offset:48512
    v_mfma_f32_16x16x32_bf16 v[88:91], a[228:231], v[116:119], v[88:91]
    v_mfma_f32_16x16x32_bf16 v[92:95], a[232:235], v[116:119], v[92:95]
    v_mfma_f32_16x16x32_bf16 v[96:99], a[236:239], v[116:119], v[96:99]
    v_mfma_f32_16x16x32_bf16 v[88:91], a[240:243], v[120:123], v[88:91]
    v_mfma_f32_16x16x32_bf16 v[92:95], a[244:247], v[120:123], v[92:95]
    v_mfma_f32_16x16x32_bf16 v[96:99], a[248:251], v[120:123], v[96:99]
    s_waitcnt lgkmcnt(0)
    v_mfma_f32_16x16x32_bf16 v[96:99], v[192:195], v[124:127], v[96:99]
    v_mfma_f32_16x16x32_bf16 v[96:99], v[204:207], v[128:131], v[96:99]
    v_mfma_f32_16x16x32_bf16 v[96:99], v[216:219], v[132:135], v[96:99]
    v_mfma_f32_16x16x32_bf16 v[96:99], v[228:231], v[136:139], v[96:99]
    v_mfma_f32_16x16x32_bf16 v[96:99], v[240:243], v[140:143], v[96:99]
    v_mfma_f32_16x16x32_bf16 v[96:99], v[252:255], v[112:115], v[96:99]
    s_nop 2
    v_mfma_f32_16x16x32_bf16 v[88:91], a[252:255], v[124:127], v[88:91]
    s_nop 2
    v_mfma_f32_16x16x32_bf16 v[88:91], v[196:199], v[128:131], v[88:91]
    v_cvt_pk_bf16_f32 v96, v96, v97
    v_cvt_pk_bf16_f32 v97, v98, v99
    v_mfma_f32_16x16x32_bf16 v[88:91], v[208:211], v[132:135], v[88:91]
    ds_write_b64 v38, v[96:97] offset:12288
    v_mfma_f32_16x16x32_bf16 v[88:91], v[220:223], v[136:139], v[88:91]
    v_mfma_f32_16x16x32_bf16 v[88:91], v[232:235], v[140:143], v[88:91]
    v_mfma_f32_16x16x32_bf16 v[88:91], v[244:247], v[112:115], v[88:91]
    v_mfma_f32_16x16x32_bf16 v[92:95], v[188:191], v[124:127], v[92:95]
    s_waitcnt lgkmcnt(0)
    s_barrier
    v_mfma_f32_16x16x32_bf16 v[92:95], v[200:203], v[128:131], v[92:95]
    ds_read_b64 v[50:51], v39 offset:12288
    v_mfma_f32_16x16x32_bf16 v[92:95], v[212:215], v[132:135], v[92:95]
    s_nop 0
    v_mfma_f32_16x16x32_bf16 v[92:95], v[224:227], v[136:139], v[92:95]
    v_mfma_f32_16x16x32_bf16 v[92:95], v[236:239], v[140:143], v[92:95]
    v_cvt_pk_bf16_f32 v88, v88, v89
    v_cvt_pk_bf16_f32 v89, v90, v91
    v_mfma_f32_16x16x32_bf16 v[92:95], v[248:251], v[112:115], v[92:95]
    s_waitcnt lgkmcnt(0)
    buffer_store_dwordx2 v[50:51], v22, s[20:23], s77 offen sc1
    s_nop 5
    v_cvt_pk_bf16_f32 v90, v92, v93
    v_cvt_pk_bf16_f32 v91, v94, v95
    s_nop 0
    v_permlane16_swap_b32 v88, v90
    v_permlane16_swap_b32 v89, v91
    buffer_store_dwordx4 v[88:91], v21, s[20:23], s77 offen sc1
L_check:
    s_cmp_lg_u32 s63, 0
    s_cbranch_scc1 L_slow
    s_endpgm
L_x_end:
L_more:
    ds_read2_b32 v[176:177], v24 offset0:64 offset1:96
    ds_read_b64 v[178:179], v25 offset:264
    s_waitcnt lgkmcnt(0)
    v_xor_b32 v172, v176, v26
    v_xor_b32 v174, v177, v26
    v_xor_b32 v173, v176, v27
    v_xor_b32 v175, v177, v27
    ds_read_b64_tr_b16 v[144:145], v172 offset:0
    ds_read_b64_tr_b16 v[146:147], v174 offset:0
    ds_read_b64_tr_b16 v[148:149], v173 offset:0
    ds_read_b64_tr_b16 v[150:151], v175 offset:0
    ds_read_b64_tr_b16 v[152:153], v172 offset:64
    ds_read_b64_tr_b16 v[154:155], v174 offset:64
    v_cndmask_b32 v169, 0, v179, s[88:89]
    v_cndmask_b32 v171, 0, v179, s[92:93]
    v_cndmask_b32 v168, 0, v178, s[88:89]
    v_cndmask_b32 v170, 0, v178, s[92:93]
    v_cndmask_b32 v169, v169, v178, s[90:91]
    v_cndmask_b32 v171, v171, v178, s[94:95]
    ds_read_b64_tr_b16 v[156:157], v173 offset:64
    ds_read_b64_tr_b16 v[158:159], v175 offset:64
    ds_read_b64_tr_b16 v[160:161], v172 offset:128
    ds_read_b64_tr_b16 v[162:163], v174 offset:128
    ds_read_b64_tr_b16 v[164:165], v173 offset:128
    ds_read_b64_tr_b16 v[166:167], v175 offset:128
    s_waitcnt lgkmcnt(0)
    v_mfma_f32_16x16x32_bf16 v[144:147], v[144:147], v[168:171], 0
    v_mfma_f32_16x16x32_bf16 v[148:151], v[148:151], v[168:171], 0
    v_mfma_f32_16x16x32_bf16 v[152:155], v[152:155], v[168:171], 0
    v_mfma_f32_16x16x32_bf16 v[156:159], v[156:159], v[168:171], 0
    v_mfma_f32_16x16x32_bf16 v[160:163], v[160:163], v[168:171], 0
    v_mfma_f32_16x16x32_bf16 v[164:167], v[164:167], v[168:171], 0
    s_nop 3
    v_cvt_pk_bf16_f32 v144, v144, v145
    v_cvt_pk_bf16_f32 v145, v146, v147
    ds_write_b64 v28, v[144:145] offset:12288
    v_cvt_pk_bf16_f32 v148, v148, v149
    v_cvt_pk_bf16_f32 v149, v150, v151
    ds_write_b64 v29, v[148:149] offset:12288
    v_cvt_pk_bf16_f32 v152, v152, v153
    v_cvt_pk_bf16_f32 v153, v154, v155
    ds_write_b64 v28, v[152:153] offset:12352
    v_cvt_pk_bf16_f32 v156, v156, v157
    v_cvt_pk_bf16_f32 v157, v158, v159
    ds_write_b64 v29, v[156:157] offset:12352
    v_cvt_pk_bf16_f32 v160, v160, v161
    v_cvt_pk_bf16_f32 v161, v162, v163
    ds_write_b64 v28, v[160:161] offset:12416
    v_cvt_pk_bf16_f32 v164, v164, v165
    v_cvt_pk_bf16_f32 v165, v166, v167
    ds_write_b64 v29, v[164:165] offset:12416
    s_waitcnt lgkmcnt(0)
    s_branch L_more_back
L_hot_end:
L_bfail1:
    v_mov_b32 v163, s60
    ds_write_b32 v110, v163 offset:4
    s_mov_b64 s[80:81], 0
    s_mov_b64 s[88:89], 0
    s_mov_b64 s[82:83], 0
    s_mov_b64 s[90:91], 0
    s_mov_b64 s[84:85], 0
    s_mov_b64 s[92:93], 0
    s_mov_b64 s[86:87], 0
    s_mov_b64 s[94:95], 0
    s_mov_b64 s[98:99], 0
    s_mov_b32 s62, 0
    s_branch L_bfail1_back
L_bfail2:
    v_mov_b32 v144, s38
    ds_or_b32 v34, v144
    s_branch L_bfail2_back
L_afailX:
    v_mul_u32_u24 v32, 1821, v0
    v_lshrrev_b32 v32, 16, v32
    v_lshlrev_b32 v32, v32, 1
    v_lshlrev_b32 v33, 7, v32
    s_mov_b64 exec, s[80:81]
    ds_or_b32 v34, v32
    s_mov_b64 exec, s[82:83]
    ds_or_b32 v34, v33
    s_mov_b64 exec, -1
    s_waitcnt lgkmcnt(0)
    s_branch L_afailX_back
L_afailY:
    v_mul_u32_u24 v32, 1821, v0
    v_lshrrev_b32 v32, 16, v32
    v_lshlrev_b32 v32, v32, 1
    v_lshlrev_b32 v33, 7, v32
    s_mov_b64 exec, s[80:81]
    ds_or_b32 v34, v32
    s_mov_b64 exec, s[82:83]
    ds_or_b32 v34, v33
    s_mov_b64 exec, -1
    s_waitcnt lgkmcnt(0)
    s_branch L_afailY_back
L_slow:
    s_waitcnt vmcnt(0) lgkmcnt(0)
    s_barrier
    s_ff1_i32_b32 s80, s63
    s_bitset0_b32 s63, s80
    s_mul_i32 s81, s80, 224
    s_add_u32 s81, s81, s45
    s_mov_b32 s82, 1
    s_cmp_lt_u32 s80, 16
    s_cbranch_scc1 L_s1
    s_bfe_u32 s40, s80, 0x10002
    s_add_u32 s40, s40, s53
    s_and_b32 s41, s80, 3
    s_lshl_b32 s41, s41, 4
    s_cmp_eq_u32 s47, 0
    s_cselect_b32 s82, 1, 224
    s_cselect_b32 s81, 224, 1
    s_mul_i32 s81, s81, s40
    s_mul_i32 s41, s41, s82
    s_add_u32 s81, s81, s41
L_s1:
    s_movk_i32 s43, 224
    v_mul_u32_u24 v79, s82, v2
    v_lshl_add_u32 v49, s2, 2, v3
    v_lshl_add_u32 v49, v49, 3, 64
    v_mad_u32_u24 v49, v79, s42, v49
    v_add_u32 v79, s81, v79
    v_lshrrev_b32 v80, 4, v0
    v_min_u32 v80, 8, v80
    v_mul_u32_u24 v85, 36, v79
    v_lshl_add_u32 v85, v80, 2, v85
    buffer_load_dword v85, v85, s[12:15], 0 offen
    v_mul_u32_u24 v81, 74899, v79
    v_lshrrev_b32 v81, 24, v81
    v_mul_u32_u24 v82, 224, v81
    v_sub_u32 v82, v79, v82
    v_mul_u32_u24 v83, 11, v80
    v_lshrrev_b32 v83, 5, v83
    v_mad_i32_i24 v84, v83, -3, v80
    v_add3_u32 v81, v81, v83, -1
    v_add3_u32 v82, v82, v84, -1
    v_cvt_f32_i32 v81, v81
    v_cvt_f32_i32 v82, v82
    s_waitcnt vmcnt(0)
    v_lshlrev_b32 v65, 16, v85
    v_and_b32 v66, 0xffff0000, v85
    v_add_f32 v65, v81, v65
    v_add_f32 v66, v82, v66
    v_cvt_pk_bf16_f32 v64, v65, v66
    v_pk_max_i16 v64, v64, 0
    v_pk_min_i16 v64, v64, s60
    v_lshlrev_b32 v65, 16, v64
    v_and_b32 v66, 0xffff0000, v64
    v_fract_f32 v71, v65
    v_fract_f32 v72, v66
    v_ceil_f32 v68, v65
    v_ceil_f32 v70, v66
    v_sub_f32 v73, 1.0, v71
    v_sub_f32 v74, 1.0, v72
    v_cvt_u32_f32 v67, v65
    v_cvt_u32_f32 v69, v66
    v_cvt_pk_bf16_f32 v74, v73, v74
    v_cvt_u32_f32 v68, v68
    v_cvt_u32_f32 v70, v70
    v_lshlrev_b32 v73, 16, v74
    v_and_b32 v74, 0xffff0000, v74
    v_mul_f32 v78, v71, v72
    v_mul_f32 v76, v73, v72
    v_mul_f32 v77, v71, v74
    v_mul_f32 v75, v73, v74
    v_mad_u32_u24 v88, v67, s43, v69
    v_mul_u32_u24 v88, 192, v88
    v_mad_u32_u24 v89, v67, s43, v70
    v_mul_u32_u24 v89, 192, v89
    v_mad_u32_u24 v90, v68, s43, v69
    v_mul_u32_u24 v90, 192, v90
    v_mad_u32_u24 v91, v68, s43, v70
    v_mul_u32_u24 v91, 192, v91
    v_cvt_pk_bf16_f32 v92, v75, v76
    v_cvt_pk_bf16_f32 v93, v77, v78
    v_lshlrev_b32 v79, 5, v0
    v_add_u32 v79, 61440, v79
    ds_write_b128 v79, v[88:91]
    ds_write_b64 v79, v[92:93] offset:16
    s_mov_b32 s83, 0
    s_waitcnt lgkmcnt(0)
    s_barrier
L_s2:
    s_add_u32 s40, s83, 0
    v_add_u32 v96, s40, v0
    v_mul_u32_u24 v70, 5462, v96
    v_lshrrev_b32 v70, 16, v70
    v_mad_i32_i24 v71, v70, -12, v96
    v_lshlrev_b32 v70, 5, v70
    v_add_u32 v70, 61440, v70
    ds_read_b128 v[64:67], v70
    ds_read_b64 v[68:69], v70 offset:16
    v_lshlrev_b32 v96, 4, v96
    s_add_u32 s40, s83, 256
    v_add_u32 v97, s40, v0
    v_mul_u32_u24 v78, 5462, v97
    v_lshrrev_b32 v78, 16, v78
    v_mad_i32_i24 v79, v78, -12, v97
    v_lshlrev_b32 v78, 5, v78
    v_add_u32 v78, 61440, v78
    ds_read_b128 v[72:75], v78
    ds_read_b64 v[76:77], v78 offset:16
    v_lshlrev_b32 v97, 4, v97
    s_add_u32 s40, s83, 512
    v_add_u32 v98, s40, v0
    v_mul_u32_u24 v86, 5462, v98
    v_lshrrev_b32 v86, 16, v86
    v_mad_i32_i24 v87, v86, -12, v98
    v_lshlrev_b32 v86, 5, v86
    v_add_u32 v86, 61440, v86
    ds_read_b128 v[80:83], v86
    ds_read_b64 v[84:85], v86 offset:16
    v_lshlrev_b32 v98, 4, v98
    s_add_u32 s40, s83, 768
    v_add_u32 v99, s40, v0
    v_mul_u32_u24 v94, 5462, v99
    v_lshrrev_b32 v94, 16, v94
    v_mad_i32_i24 v95, v94, -12, v99
    v_lshlrev_b32 v94, 5, v94
    v_add_u32 v94, 61440, v94
    ds_read_b128 v[88:91], v94
    ds_read_b64 v[92:93], v94 offset:16
    v_lshlrev_b32 v99, 4, v99
    s_waitcnt lgkmcnt(0)
    v_lshl_add_u32 v64, v71, 4, v64
    buffer_load_dwordx4 v[100:103], v64, s[8:11], 0 offen
    v_lshl_add_u32 v65, v71, 4, v65
    buffer_load_dwordx4 v[104:107], v65, s[8:11], 0 offen
    v_lshl_add_u32 v66, v71, 4, v66
    buffer_load_dwordx4 v[108:111], v66, s[8:11], 0 offen
    v_lshl_add_u32 v67, v71, 4, v67
    buffer_load_dwordx4 v[112:115], v67, s[8:11], 0 offen
    v_lshl_add_u32 v72, v79, 4, v72
    buffer_load_dwordx4 v[116:119], v72, s[8:11], 0 offen
    v_lshl_add_u32 v73, v79, 4, v73
    buffer_load_dwordx4 v[120:123], v73, s[8:11], 0 offen
    v_lshl_add_u32 v74, v79, 4, v74
    buffer_load_dwordx4 v[124:127], v74, s[8:11], 0 offen
    v_lshl_add_u32 v75, v79, 4, v75
    buffer_load_dwordx4 v[128:131], v75, s[8:11], 0 offen
    v_lshl_add_u32 v80, v87, 4, v80
    buffer_load_dwordx4 v[132:135], v80, s[8:11], 0 offen
    v_lshl_add_u32 v81, v87, 4, v81
    buffer_load_dwordx4 v[136:139], v81, s[8:11], 0 offen
    v_lshl_add_u32 v82, v87, 4, v82
    buffer_load_dwordx4 v[140:143], v82, s[8:11], 0 offen
    v_lshl_add_u32 v83, v87, 4, v83
    buffer_load_dwordx4 v[144:147], v83, s[8:11], 0 offen
    v_lshl_add_u32 v88, v95, 4, v88
    buffer_load_dwordx4 v[148:151], v88, s[8:11], 0 offen
    v_lshl_add_u32 v89, v95, 4, v89
    buffer_load_dwordx4 v[152:155], v89, s[8:11], 0 offen
    v_lshl_add_u32 v90, v95, 4, v90
    buffer_load_dwordx4 v[156:159], v90, s[8:11], 0 offen
    v_lshl_add_u32 v91, v95, 4, v91
    buffer_load_dwordx4 v[160:163], v91, s[8:11], 0 offen
    s_waitcnt vmcnt(12)
    v_lshlrev_b32 v172, 16, v68
    v_lshlrev_b32 v173, 16, v100
    v_and_b32 v174, 0xffff0000, v100
    v_mul_f32 v164, v172, v173
    v_mul_f32 v165, v172, v174
    v_lshlrev_b32 v173, 16, v101
    v_and_b32 v174, 0xffff0000, v101
    v_mul_f32 v166, v172, v173
    v_mul_f32 v167, v172, v174
    v_lshlrev_b32 v173, 16, v102
    v_and_b32 v174, 0xffff0000, v102
    v_mul_f32 v168, v172, v173
    v_mul_f32 v169, v172, v174
    v_lshlrev_b32 v173, 16, v103
    v_and_b32 v174, 0xffff0000, v103
    v_mul_f32 v170, v172, v173
    v_mul_f32 v171, v172, v174
    v_and_b32 v172, 0xffff0000, v68
    v_lshlrev_b32 v173, 16, v104
    v_and_b32 v174, 0xffff0000, v104
    v_fmac_f32 v164, v172, v173
    v_fmac_f32 v165, v172, v174
    v_lshlrev_b32 v173, 16, v105
    v_and_b32 v174, 0xffff0000, v105
    v_fmac_f32 v166, v172, v173
    v_fmac_f32 v167, v172, v174
    v_lshlrev_b32 v173, 16, v106
    v_and_b32 v174, 0xffff0000, v106
    v_fmac_f32 v168, v172, v173
    v_fmac_f32 v169, v172, v174
    v_lshlrev_b32 v173, 16, v107
    v_and_b32 v174, 0xffff0000, v107
    v_fmac_f32 v170, v172, v173
    v_fmac_f32 v171, v172, v174
    v_lshlrev_b32 v172, 16, v69
    v_lshlrev_b32 v173, 16, v108
    v_and_b32 v174, 0xffff0000, v108
    v_fmac_f32 v164, v172, v173
    v_fmac_f32 v165, v172, v174
    v_lshlrev_b32 v173, 16, v109
    v_and_b32 v174, 0xffff0000, v109
    v_fmac_f32 v166, v172, v173
    v_fmac_f32 v167, v172, v174
    v_lshlrev_b32 v173, 16, v110
    v_and_b32 v174, 0xffff0000, v110
    v_fmac_f32 v168, v172, v173
    v_fmac_f32 v169, v172, v174
    v_lshlrev_b32 v173, 16, v111
    v_and_b32 v174, 0xffff0000, v111
    v_fmac_f32 v170, v172, v173
    v_fmac_f32 v171, v172, v174
    v_and_b32 v172, 0xffff0000, v69
    v_lshlrev_b32 v173, 16, v112
    v_and_b32 v174, 0xffff0000, v112
    v_fmac_f32 v164, v172, v173
    v_fmac_f32 v165, v172, v174
    v_lshlrev_b32 v173, 16, v113
    v_and_b32 v174, 0xffff0000, v113
    v_fmac_f32 v166, v172, v173
    v_fmac_f32 v167, v172, v174
    v_lshlrev_b32 v173, 16, v114
    v_and_b32 v174, 0xffff0000, v114
    v_fmac_f32 v168, v172, v173
    v_fmac_f32 v169, v172, v174
    v_lshlrev_b32 v173, 16, v115
    v_and_b32 v174, 0xffff0000, v115
    v_fmac_f32 v170, v172, v173
    v_fmac_f32 v171, v172, v174
    v_cvt_pk_bf16_f32 v176, v164, v165
    v_cvt_pk_bf16_f32 v177, v166, v167
    v_cvt_pk_bf16_f32 v178, v168, v169
    v_cvt_pk_bf16_f32 v179, v170, v171
    ds_write_b128 v96, v[176:179]
    s_waitcnt vmcnt(8)
    v_lshlrev_b32 v172, 16, v76
    v_lshlrev_b32 v173, 16, v116
    v_and_b32 v174, 0xffff0000, v116
    v_mul_f32 v164, v172, v173
    v_mul_f32 v165, v172, v174
    v_lshlrev_b32 v173, 16, v117
    v_and_b32 v174, 0xffff0000, v117
    v_mul_f32 v166, v172, v173
    v_mul_f32 v167, v172, v174
    v_lshlrev_b32 v173, 16, v118
    v_and_b32 v174, 0xffff0000, v118
    v_mul_f32 v168, v172, v173
    v_mul_f32 v169, v172, v174
    v_lshlrev_b32 v173, 16, v119
    v_and_b32 v174, 0xffff0000, v119
    v_mul_f32 v170, v172, v173
    v_mul_f32 v171, v172, v174
    v_and_b32 v172, 0xffff0000, v76
    v_lshlrev_b32 v173, 16, v120
    v_and_b32 v174, 0xffff0000, v120
    v_fmac_f32 v164, v172, v173
    v_fmac_f32 v165, v172, v174
    v_lshlrev_b32 v173, 16, v121
    v_and_b32 v174, 0xffff0000, v121
    v_fmac_f32 v166, v172, v173
    v_fmac_f32 v167, v172, v174
    v_lshlrev_b32 v173, 16, v122
    v_and_b32 v174, 0xffff0000, v122
    v_fmac_f32 v168, v172, v173
    v_fmac_f32 v169, v172, v174
    v_lshlrev_b32 v173, 16, v123
    v_and_b32 v174, 0xffff0000, v123
    v_fmac_f32 v170, v172, v173
    v_fmac_f32 v171, v172, v174
    v_lshlrev_b32 v172, 16, v77
    v_lshlrev_b32 v173, 16, v124
    v_and_b32 v174, 0xffff0000, v124
    v_fmac_f32 v164, v172, v173
    v_fmac_f32 v165, v172, v174
    v_lshlrev_b32 v173, 16, v125
    v_and_b32 v174, 0xffff0000, v125
    v_fmac_f32 v166, v172, v173
    v_fmac_f32 v167, v172, v174
    v_lshlrev_b32 v173, 16, v126
    v_and_b32 v174, 0xffff0000, v126
    v_fmac_f32 v168, v172, v173
    v_fmac_f32 v169, v172, v174
    v_lshlrev_b32 v173, 16, v127
    v_and_b32 v174, 0xffff0000, v127
    v_fmac_f32 v170, v172, v173
    v_fmac_f32 v171, v172, v174
    v_and_b32 v172, 0xffff0000, v77
    v_lshlrev_b32 v173, 16, v128
    v_and_b32 v174, 0xffff0000, v128
    v_fmac_f32 v164, v172, v173
    v_fmac_f32 v165, v172, v174
    v_lshlrev_b32 v173, 16, v129
    v_and_b32 v174, 0xffff0000, v129
    v_fmac_f32 v166, v172, v173
    v_fmac_f32 v167, v172, v174
    v_lshlrev_b32 v173, 16, v130
    v_and_b32 v174, 0xffff0000, v130
    v_fmac_f32 v168, v172, v173
    v_fmac_f32 v169, v172, v174
    v_lshlrev_b32 v173, 16, v131
    v_and_b32 v174, 0xffff0000, v131
    v_fmac_f32 v170, v172, v173
    v_fmac_f32 v171, v172, v174
    v_cvt_pk_bf16_f32 v176, v164, v165
    v_cvt_pk_bf16_f32 v177, v166, v167
    v_cvt_pk_bf16_f32 v178, v168, v169
    v_cvt_pk_bf16_f32 v179, v170, v171
    ds_write_b128 v97, v[176:179]
    s_waitcnt vmcnt(4)
    v_lshlrev_b32 v172, 16, v84
    v_lshlrev_b32 v173, 16, v132
    v_and_b32 v174, 0xffff0000, v132
    v_mul_f32 v164, v172, v173
    v_mul_f32 v165, v172, v174
    v_lshlrev_b32 v173, 16, v133
    v_and_b32 v174, 0xffff0000, v133
    v_mul_f32 v166, v172, v173
    v_mul_f32 v167, v172, v174
    v_lshlrev_b32 v173, 16, v134
    v_and_b32 v174, 0xffff0000, v134
    v_mul_f32 v168, v172, v173
    v_mul_f32 v169, v172, v174
    v_lshlrev_b32 v173, 16, v135
    v_and_b32 v174, 0xffff0000, v135
    v_mul_f32 v170, v172, v173
    v_mul_f32 v171, v172, v174
    v_and_b32 v172, 0xffff0000, v84
    v_lshlrev_b32 v173, 16, v136
    v_and_b32 v174, 0xffff0000, v136
    v_fmac_f32 v164, v172, v173
    v_fmac_f32 v165, v172, v174
    v_lshlrev_b32 v173, 16, v137
    v_and_b32 v174, 0xffff0000, v137
    v_fmac_f32 v166, v172, v173
    v_fmac_f32 v167, v172, v174
    v_lshlrev_b32 v173, 16, v138
    v_and_b32 v174, 0xffff0000, v138
    v_fmac_f32 v168, v172, v173
    v_fmac_f32 v169, v172, v174
    v_lshlrev_b32 v173, 16, v139
    v_and_b32 v174, 0xffff0000, v139
    v_fmac_f32 v170, v172, v173
    v_fmac_f32 v171, v172, v174
    v_lshlrev_b32 v172, 16, v85
    v_lshlrev_b32 v173, 16, v140
    v_and_b32 v174, 0xffff0000, v140
    v_fmac_f32 v164, v172, v173
    v_fmac_f32 v165, v172, v174
    v_lshlrev_b32 v173, 16, v141
    v_and_b32 v174, 0xffff0000, v141
    v_fmac_f32 v166, v172, v173
    v_fmac_f32 v167, v172, v174
    v_lshlrev_b32 v173, 16, v142
    v_and_b32 v174, 0xffff0000, v142
    v_fmac_f32 v168, v172, v173
    v_fmac_f32 v169, v172, v174
    v_lshlrev_b32 v173, 16, v143
    v_and_b32 v174, 0xffff0000, v143
    v_fmac_f32 v170, v172, v173
    v_fmac_f32 v171, v172, v174
    v_and_b32 v172, 0xffff0000, v85
    v_lshlrev_b32 v173, 16, v144
    v_and_b32 v174, 0xffff0000, v144
    v_fmac_f32 v164, v172, v173
    v_fmac_f32 v165, v172, v174
    v_lshlrev_b32 v173, 16, v145
    v_and_b32 v174, 0xffff0000, v145
    v_fmac_f32 v166, v172, v173
    v_fmac_f32 v167, v172, v174
    v_lshlrev_b32 v173, 16, v146
    v_and_b32 v174, 0xffff0000, v146
    v_fmac_f32 v168, v172, v173
    v_fmac_f32 v169, v172, v174
    v_lshlrev_b32 v173, 16, v147
    v_and_b32 v174, 0xffff0000, v147
    v_fmac_f32 v170, v172, v173
    v_fmac_f32 v171, v172, v174
    v_cvt_pk_bf16_f32 v176, v164, v165
    v_cvt_pk_bf16_f32 v177, v166, v167
    v_cvt_pk_bf16_f32 v178, v168, v169
    v_cvt_pk_bf16_f32 v179, v170, v171
    ds_write_b128 v98, v[176:179]
    s_waitcnt vmcnt(0)
    v_lshlrev_b32 v172, 16, v92
    v_lshlrev_b32 v173, 16, v148
    v_and_b32 v174, 0xffff0000, v148
    v_mul_f32 v164, v172, v173
    v_mul_f32 v165, v172, v174
    v_lshlrev_b32 v173, 16, v149
    v_and_b32 v174, 0xffff0000, v149
    v_mul_f32 v166, v172, v173
    v_mul_f32 v167, v172, v174
    v_lshlrev_b32 v173, 16, v150
    v_and_b32 v174, 0xffff0000, v150
    v_mul_f32 v168, v172, v173
    v_mul_f32 v169, v172, v174
    v_lshlrev_b32 v173, 16, v151
    v_and_b32 v174, 0xffff0000, v151
    v_mul_f32 v170, v172, v173
    v_mul_f32 v171, v172, v174
    v_and_b32 v172, 0xffff0000, v92
    v_lshlrev_b32 v173, 16, v152
    v_and_b32 v174, 0xffff0000, v152
    v_fmac_f32 v164, v172, v173
    v_fmac_f32 v165, v172, v174
    v_lshlrev_b32 v173, 16, v153
    v_and_b32 v174, 0xffff0000, v153
    v_fmac_f32 v166, v172, v173
    v_fmac_f32 v167, v172, v174
    v_lshlrev_b32 v173, 16, v154
    v_and_b32 v174, 0xffff0000, v154
    v_fmac_f32 v168, v172, v173
    v_fmac_f32 v169, v172, v174
    v_lshlrev_b32 v173, 16, v155
    v_and_b32 v174, 0xffff0000, v155
    v_fmac_f32 v170, v172, v173
    v_fmac_f32 v171, v172, v174
    v_lshlrev_b32 v172, 16, v93
    v_lshlrev_b32 v173, 16, v156
    v_and_b32 v174, 0xffff0000, v156
    v_fmac_f32 v164, v172, v173
    v_fmac_f32 v165, v172, v174
    v_lshlrev_b32 v173, 16, v157
    v_and_b32 v174, 0xffff0000, v157
    v_fmac_f32 v166, v172, v173
    v_fmac_f32 v167, v172, v174
    v_lshlrev_b32 v173, 16, v158
    v_and_b32 v174, 0xffff0000, v158
    v_fmac_f32 v168, v172, v173
    v_fmac_f32 v169, v172, v174
    v_lshlrev_b32 v173, 16, v159
    v_and_b32 v174, 0xffff0000, v159
    v_fmac_f32 v170, v172, v173
    v_fmac_f32 v171, v172, v174
    v_and_b32 v172, 0xffff0000, v93
    v_lshlrev_b32 v173, 16, v160
    v_and_b32 v174, 0xffff0000, v160
    v_fmac_f32 v164, v172, v173
    v_fmac_f32 v165, v172, v174
    v_lshlrev_b32 v173, 16, v161
    v_and_b32 v174, 0xffff0000, v161
    v_fmac_f32 v166, v172, v173
    v_fmac_f32 v167, v172, v174
    v_lshlrev_b32 v173, 16, v162
    v_and_b32 v174, 0xffff0000, v162
    v_fmac_f32 v168, v172, v173
    v_fmac_f32 v169, v172, v174
    v_lshlrev_b32 v173, 16, v163
    v_and_b32 v174, 0xffff0000, v163
    v_fmac_f32 v170, v172, v173
    v_fmac_f32 v171, v172, v174
    v_cvt_pk_bf16_f32 v176, v164, v165
    v_cvt_pk_bf16_f32 v177, v166, v167
    v_cvt_pk_bf16_f32 v178, v168, v169
    v_cvt_pk_bf16_f32 v179, v170, v171
    ds_write_b128 v99, v[176:179]
    s_add_u32 s83, s83, 1024
    s_cmp_lt_u32 s83, 1728
    s_cbranch_scc1 L_s2
    s_waitcnt lgkmcnt(0)
    s_barrier
    s_cmp_ge_u32 s3, 2
    s_cbranch_scc1 L_s3
    v_mad_u32_u24 v40, v2, s42, v4
    ds_read_b128 v[112:115], v40 offset:0
    ds_read_b128 v[116:119], v40 offset:64
    ds_read_b128 v[120:123], v40 offset:128
    s_waitcnt lgkmcnt(0)
    v_mfma_f32_16x16x32_bf16 v[64:67], a[0:3], v[112:115], 0
    v_mfma_f32_16x16x32_bf16 v[68:71], a[4:7], v[112:115], 0
    v_mfma_f32_16x16x32_bf16 v[72:75], a[8:11], v[112:115], 0
    v_mfma_f32_16x16x32_bf16 v[64:67], a[12:15], v[116:119], v[64:67]
    v_mfma_f32_16x16x32_bf16 v[68:71], a[16:19], v[116:119], v[68:71]
    v_mfma_f32_16x16x32_bf16 v[72:75], a[20:23], v[116:119], v[72:75]
    v_mfma_f32_16x16x32_bf16 v[64:67], a[24:27], v[120:123], v[64:67]
    v_mfma_f32_16x16x32_bf16 v[68:71], a[28:31], v[120:123], v[68:71]
    v_mfma_f32_16x16x32_bf16 v[72:75], a[32:35], v[120:123], v[72:75]
    s_nop 1
    ds_read_b128 v[112:115], v40 offset:3072
    ds_read_b128 v[116:119], v40 offset:3136
    ds_read_b128 v[120:123], v40 offset:3200
    s_waitcnt lgkmcnt(0)
    v_mfma_f32_16x16x32_bf16 v[64:67], a[36:39], v[112:115], v[64:67]
    v_mfma_f32_16x16x32_bf16 v[68:71], a[40:43], v[112:115], v[68:71]
    v_mfma_f32_16x16x32_bf16 v[72:75], a[44:47], v[112:115], v[72:75]
    v_mfma_f32_16x16x32_bf16 v[64:67], a[48:51], v[116:119], v[64:67]
    v_mfma_f32_16x16x32_bf16 v[68:71], a[52:55], v[116:119], v[68:71]
    v_mfma_f32_16x16x32_bf16 v[72:75], a[56:59], v[116:119], v[72:75]
    v_mfma_f32_16x16x32_bf16 v[64:67], a[60:63], v[120:123], v[64:67]
    v_mfma_f32_16x16x32_bf16 v[68:71], a[64:67], v[120:123], v[68:71]
    v_mfma_f32_16x16x32_bf16 v[72:75], a[68:71], v[120:123], v[72:75]
    s_nop 1
    ds_read_b128 v[112:115], v40 offset:6144
    ds_read_b128 v[116:119], v40 offset:6208
    ds_read_b128 v[120:123], v40 offset:6272
    s_waitcnt lgkmcnt(0)
    v_mfma_f32_16x16x32_bf16 v[64:67], a[72:75], v[112:115], v[64:67]
    v_mfma_f32_16x16x32_bf16 v[68:71], a[76:79], v[112:115], v[68:71]
    v_mfma_f32_16x16x32_bf16 v[72:75], a[80:83], v[112:115], v[72:75]
    v_mfma_f32_16x16x32_bf16 v[64:67], a[84:87], v[116:119], v[64:67]
    v_mfma_f32_16x16x32_bf16 v[68:71], a[88:91], v[116:119], v[68:71]
    v_mfma_f32_16x16x32_bf16 v[72:75], a[92:95], v[116:119], v[72:75]
    v_mfma_f32_16x16x32_bf16 v[64:67], a[96:99], v[120:123], v[64:67]
    v_mfma_f32_16x16x32_bf16 v[68:71], a[100:103], v[120:123], v[68:71]
    v_mfma_f32_16x16x32_bf16 v[72:75], a[104:107], v[120:123], v[72:75]
    s_nop 1
    ds_read_b128 v[112:115], v40 offset:9216
    ds_read_b128 v[116:119], v40 offset:9280
    ds_read_b128 v[120:123], v40 offset:9344
    s_waitcnt lgkmcnt(0)
    v_mfma_f32_16x16x32_bf16 v[64:67], a[108:111], v[112:115], v[64:67]
    v_mfma_f32_16x16x32_bf16 v[68:71], a[112:115], v[112:115], v[68:71]
    v_mfma_f32_16x16x32_bf16 v[72:75], a[116:119], v[112:115], v[72:75]
    v_mfma_f32_16x16x32_bf16 v[64:67], a[120:123], v[116:119], v[64:67]
    v_mfma_f32_16x16x32_bf16 v[68:71], a[124:127], v[116:119], v[68:71]
    v_mfma_f32_16x16x32_bf16 v[72:75], a[128:131], v[116:119], v[72:75]
    v_mfma_f32_16x16x32_bf16 v[64:67], a[132:135], v[120:123], v[64:67]
    v_mfma_f32_16x16x32_bf16 v[68:71], a[136:139], v[120:123], v[68:71]
    v_mfma_f32_16x16x32_bf16 v[72:75], a[140:143], v[120:123], v[72:75]
    s_nop 1
    ds_read_b128 v[112:115], v40 offset:12288
    ds_read_b128 v[116:119], v40 offset:12352
    ds_read_b128 v[120:123], v40 offset:12416
    s_waitcnt lgkmcnt(0)
    v_mfma_f32_16x16x32_bf16 v[64:67], a[144:147], v[112:115], v[64:67]
    v_mfma_f32_16x16x32_bf16 v[68:71], a[148:151], v[112:115], v[68:71]
    v_mfma_f32_16x16x32_bf16 v[72:75], a[152:155], v[112:115], v[72:75]
    v_mfma_f32_16x16x32_bf16 v[64:67], a[156:159], v[116:119], v[64:67]
    v_mfma_f32_16x16x32_bf16 v[68:71], a[160:163], v[116:119], v[68:71]
    v_mfma_f32_16x16x32_bf16 v[72:75], a[164:167], v[116:119], v[72:75]
    v_mfma_f32_16x16x32_bf16 v[64:67], a[168:171], v[120:123], v[64:67]
    v_mfma_f32_16x16x32_bf16 v[68:71], a[172:175], v[120:123], v[68:71]
    v_mfma_f32_16x16x32_bf16 v[72:75], a[176:179], v[120:123], v[72:75]
    s_nop 1
    ds_read_b128 v[112:115], v40 offset:15360
    ds_read_b128 v[116:119], v40 offset:15424
    ds_read_b128 v[120:123], v40 offset:15488
    s_waitcnt lgkmcnt(0)
    v_mfma_f32_16x16x32_bf16 v[64:67], a[180:183], v[112:115], v[64:67]
    v_mfma_f32_16x16x32_bf16 v[68:71], a[184:187], v[112:115], v[68:71]
    v_mfma_f32_16x16x32_bf16 v[72:75], a[188:191], v[112:115], v[72:75]
    v_mfma_f32_16x16x32_bf16 v[64:67], a[192:195], v[116:119], v[64:67]
    v_mfma_f32_16x16x32_bf16 v[68:71], a[196:199], v[116:119], v[68:71]
    v_mfma_f32_16x16x32_bf16 v[72:75], a[200:203], v[116:119], v[72:75]
    v_mfma_f32_16x16x32_bf16 v[64:67], a[204:207], v[120:123], v[64:67]
    v_mfma_f32_16x16x32_bf16 v[68:71], a[208:211], v[120:123], v[68:71]
    v_mfma_f32_16x16x32_bf16 v[72:75], a[212:215], v[120:123], v[72:75]
    s_nop 1
    ds_read_b128 v[112:115], v40 offset:18432
    ds_read_b128 v[116:119], v40 offset:18496
    ds_read_b128 v[120:123], v40 offset:18560
    s_waitcnt lgkmcnt(0)
    v_mfma_f32_16x16x32_bf16 v[64:67], a[216:219], v[112:115], v[64:67]
    v_mfma_f32_16x16x32_bf16 v[68:71], a[220:223], v[112:115], v[68:71]
    v_mfma_f32_16x16x32_bf16 v[72:75], a[224:227], v[112:115], v[72:75]
    v_mfma_f32_16x16x32_bf16 v[64:67], a[228:231], v[116:119], v[64:67]
    v_mfma_f32_16x16x32_bf16 v[68:71], a[232:235], v[116:119], v[68:71]
    v_mfma_f32_16x16x32_bf16 v[72:75], a[236:239], v[116:119], v[72:75]
    v_mfma_f32_16x16x32_bf16 v[64:67], a[240:243], v[120:123], v[64:67]
    v_mfma_f32_16x16x32_bf16 v[68:71], a[244:247], v[120:123], v[68:71]
    v_mfma_f32_16x16x32_bf16 v[72:75], a[248:251], v[120:123], v[72:75]
    s_nop 1
    ds_read_b128 v[112:115], v40 offset:21504
    ds_read_b128 v[116:119], v40 offset:21568
    ds_read_b128 v[120:123], v40 offset:21632
    s_waitcnt lgkmcnt(0)
    v_mfma_f32_16x16x32_bf16 v[64:67], a[252:255], v[112:115], v[64:67]
    v_mfma_f32_16x16x32_bf16 v[68:71], v[188:191], v[112:115], v[68:71]
    v_mfma_f32_16x16x32_bf16 v[72:75], v[192:195], v[112:115], v[72:75]
    v_mfma_f32_16x16x32_bf16 v[64:67], v[196:199], v[116:119], v[64:67]
    v_mfma_f32_16x16x32_bf16 v[68:71], v[200:203], v[116:119], v[68:71]
    v_mfma_f32_16x16x32_bf16 v[72:75], v[204:207], v[116:119], v[72:75]
    v_mfma_f32_16x16x32_bf16 v[64:67], v[208:211], v[120:123], v[64:67]
    v_mfma_f32_16x16x32_bf16 v[68:71], v[212:215], v[120:123], v[68:71]
    v_mfma_f32_16x16x32_bf16 v[72:75], v[216:219], v[120:123], v[72:75]
    s_nop 1
    ds_read_b128 v[112:115], v40 offset:24576
    ds_read_b128 v[116:119], v40 offset:24640
    ds_read_b128 v[120:123], v40 offset:24704
    s_waitcnt lgkmcnt(0)
    v_mfma_f32_16x16x32_bf16 v[64:67], v[220:223], v[112:115], v[64:67]
    v_mfma_f32_16x16x32_bf16 v[68:71], v[224:227], v[112:115], v[68:71]
    v_mfma_f32_16x16x32_bf16 v[72:75], v[228:231], v[112:115], v[72:75]
    v_mfma_f32_16x16x32_bf16 v[64:67], v[232:235], v[116:119], v[64:67]
    v_mfma_f32_16x16x32_bf16 v[68:71], v[236:239], v[116:119], v[68:71]
    v_mfma_f32_16x16x32_bf16 v[72:75], v[240:243], v[116:119], v[72:75]
    v_mfma_f32_16x16x32_bf16 v[64:67], v[244:247], v[120:123], v[64:67]
    v_mfma_f32_16x16x32_bf16 v[68:71], v[248:251], v[120:123], v[68:71]
    v_mfma_f32_16x16x32_bf16 v[72:75], v[252:255], v[120:123], v[72:75]
    s_nop 1
    s_mul_i32 s81, s81, 192
    s_cmp_lt_u32 s80, 16
    s_cselect_b64 vcc, -1, 0
    v_cndmask_b32 v40, v21, v19, vcc
    s_nop 5
    v_cvt_pk_bf16_f32 v64, v64, v65
    v_cvt_pk_bf16_f32 v65, v66, v67
    v_cvt_pk_bf16_f32 v66, v68, v69
    v_cvt_pk_bf16_f32 v67, v70, v71
    v_cvt_pk_bf16_f32 v72, v72, v73
    v_cvt_pk_bf16_f32 v73, v74, v75
    v_permlane16_swap_b32 v64, v66
    v_permlane16_swap_b32 v65, v67
    buffer_store_dwordx4 v[64:67], v40, s[20:23], s81 offen sc1
    buffer_store_dwordx2 v[72:73], v49, s[20:23], s81 offen sc1
L_s3:
    s_branch L_check
L_code_end:
L_end:
    s_endpgm
.section .rodata,"a"
.p2align 6
.amdhsa_kernel standalone__deformable_dcnv1__vision_kernel
  .amdhsa_next_free_vgpr 512
  .amdhsa_next_free_sgpr 102
  .amdhsa_accum_offset 256
  .amdhsa_group_segment_fixed_size 0
  .amdhsa_kernarg_size 48
  .amdhsa_user_sgpr_count 2
  .amdhsa_user_sgpr_kernarg_segment_ptr 1
  .amdhsa_system_sgpr_workgroup_id_x 1
  .amdhsa_float_denorm_mode_32 3
.end_amdhsa_kernel
```

```asm
; @launch grid=(256,1,1) block=(256,1,1) lds=159040

.amdgcn_target "amdgcn-amd-amdhsa--gfx950"
.text
.globl standalone__deformable_dcnv1__vision_kernel
.p2align 12
.type standalone__deformable_dcnv1__vision_kernel,@function
standalone__deformable_dcnv1__vision_kernel:
    s_cmpk_ge_u32 s2, 256
    s_cbranch_scc1 L_end
    s_load_dwordx2 s[8:9], s[0:1], 0
    s_load_dwordx2 s[16:17], s[0:1], 16
    s_load_dwordx2 s[12:13], s[0:1], 8
    s_load_dwordx2 s[20:21], s[0:1], 24
    s_getpc_b64 s[6:7]
L_pc:
    s_lshr_b32 s41, s2, 3
    v_lshrrev_b32 v144, 6, v0
    s_mul_i32 s40, s41, 768
    v_lshl_add_u32 v145, v0, 2, s40
    v_readfirstlane_b32 s3, v144
    global_load_dword v37, v145, s[6:7]
    s_and_b32 s85, s2, 7
    s_lshl_b32 s85, s85, 5
    s_add_u32 s85, s85, s41
    s_add_u32 s81, s85, 8
    s_mul_i32 s80, s81, 2731
    s_lshr_b32 s80, s80, 16
    s_mul_i32 s86, s80, 24
    s_sub_u32 s81, s81, s86
    s_cmp_lt_u32 s80, 3
    s_cselect_b32 s82, 16, 20
    s_cselect_b32 s83, 4, 8
    s_cmp_eq_u32 s80, 0
    s_cselect_b32 s82, 8, s82
    s_cselect_b32 s83, 5, s83
    s_cselect_b32 s86, -1, 47
    s_sub_u32 s84, s81, s82
    s_cselect_b32 s46, 0, s83
    s_mul_i32 s44, s81, 6
    s_mul_i32 s40, s84, s46
    s_add_u32 s86, s86, s44
    s_add_u32 s86, s86, s40
    s_mul_i32 s86, s86, 14
    s_add_u32 s44, s86, s80
    s_mulk_i32 s44, 3072
    s_addk_i32 s44, 9024
    v_and_b32 v1, 63, v0
    s_lshl2_add_u32 s41, s41, s3

    s_mulk_i32 s41, 1296
    v_min_u32 v70, 10, v1
    s_lshl_b32 s40, s3, 6
    v_lshl_add_u32 v70, v70, 7, s41
    s_min_u32 s40, s40, 152
    v_add_u32 v144, s40, v1
    s_lshl4_add_u32 s25, s40, 61440
    v_mul_u32_u24 v64, 5462, v144
    v_lshlrev_b32 v144, 4, v144
    v_lshrrev_b32 v64, 13, v64
    v_bitop3_b32 v8, v64, 32, v144 bitop3:0x6a
    v_lshlrev_b32 v5, 4, v1
    v_and_b32 v144, 32, v1
    v_xor_b32 v7, 32, v5
    v_xor_b32 v6, v144, v5
    s_mul_i32 s24, s3, 3072
    s_mov_b32 s41, 43008
    s_mov_b32 s10, 9633792
    s_mov_b32 s11, 0x20000
    s_mov_b32 s18, 165888
    s_mov_b32 s19, s11
    s_add_u32 m0, s24, 24576
    s_waitcnt lgkmcnt(0)
    buffer_load_dword v37, v70, s[16:19], 0 offen
    buffer_load_dwordx4 v5, s[16:19], s24 offen lds
    buffer_load_dwordx4 v6, s[16:19], s24 offen offset:1024 lds
    buffer_load_dwordx4 v7, s[16:19], s24 offen offset:2048 lds
    s_mov_b32 m0, s25
    s_lshr_b32 s57, s3, 1
    buffer_load_dwordx4 v8, s[8:11], s44 offen  lds
    s_addk_i32 m0, 10368
    s_add_u32 s31, s44, 129024
    buffer_load_dwordx4 v8, s[8:11], s31 offen  lds
    s_add_u32 m0, s24, 36864
    s_add_u32 s31, s24, 12288
    buffer_load_dwordx4 v5, s[16:19], s31 offen lds
    buffer_load_dwordx4 v6, s[16:19], s31 offen offset:1024 lds
    buffer_load_dwordx4 v7, s[16:19], s31 offen offset:2048 lds
    s_add_u32 m0, s25, 3456
    s_add_u32 s31, s44, 43008
    buffer_load_dwordx4 v8, s[8:11], s31 offen  lds
    s_addk_i32 m0, 10368
    s_add_u32 s31, s44, 172032
    buffer_load_dwordx4 v8, s[8:11], s31 offen  lds
L_issued:
    v_and_b32 v4, 48, v0
    s_add_u32 s86, s86, s80
    s_and_b32 s2, s3, 1
    s_lshl4_add_u32 s45, s86, 272
    s_mov_b32 s14, 1806336
    s_mov_b32 s15, 0x20000
    s_mov_b32 s22, 9633792
    s_mov_b32 s23, 0x20000
    s_mul_i32 s40, s2, 3072
    s_mul_i32 s26, s57, -104448
    s_add_u32 s26, s26, s40
    s_mul_i32 s27, s57, 6144
    s_add_u32 s27, s27, s40
    s_mul_i32 s28, s57, 55296
    s_add_u32 s28, s28, s40
    s_cmp_eq_u32 s46, 8
    s_cbranch_scc1 L_x
    v_mul_u32_u24 v65, 7282, v1
    s_mul_i32 s85, s82, s80
    s_mul_i32 s86, s83, 3
    v_lshrrev_b32 v65, 16, v65
    s_add_u32 s85, s85, s81
    s_sub_u32 s85, s85, s86
    v_mad_i32_i24 v66, v65, -9, v1
    s_cmp_ge_i32 s85, 92
    s_cselect_b32 s86, -168, 40
    s_cselect_b32 s47, 1, 0
    s_cselect_b32 s52, 8064, 36
    s_cselect_b32 s41, 36, 8064
    v_lshl_add_u32 v67, v65, 2, s3
    s_lshl1_add_u32 s53, s85, s86
    s_lshl3_add_u32 s86, s80, s84
    s_lshl_b32 s86, s86, 1
    v_lshlrev_b32 v71, 2, v66
    s_cmp_eq_u32 s46, 4
    s_cselect_b32 s53, s86, s53
    s_sub_u32 s86, s84, 1
    v_mad_u32_u24 v71, v67, s52, v71
    s_cmp_eq_u32 s46, 5
    s_cselect_b32 s53, s86, s53
    s_cselect_b32 s86, 0x7f000000, 0
    s_mul_i32 s40, s52, 24
    s_cmp_eq_u32 s46, 0
    s_cselect_b32 s40, s40, 0x7f000000
    s_cselect_b32 s85, 54, 36
    v_cmp_gt_u32 vcc, s85, v1
    v_mov_b32 v146, 0x7f000000
    s_mul_i32 s48, s53, s41
    s_add_u32 s49, s48, s41
    v_cndmask_b32 v71, v146, v71, vcc
    s_add_u32 s50, s48, s40
    s_add_u32 s51, s49, s40
    s_add_u32 s48, s48, s86
    buffer_load_dword v176, v71, s[12:15], s48 offen
    buffer_load_dword v177, v71, s[12:15], s49 offen
    buffer_load_dword v178, v71, s[12:15], s50 offen
    buffer_load_dword v179, v71, s[12:15], s51 offen
    v_and_b32 v2, 15, v0
    s_mul_i32 s54, s47, 42816
    s_addk_i32 s54, 192
    v_mul_u32_u24 v68, 11, v66
    v_lshrrev_b32 v68, 5, v68
    v_mad_i32_i24 v69, v68, -3, v66
    s_mov_b32 s60, 0x435f435f
    s_mov_b32 s59, 0x03020c0c
    s_cmp_eq_u32 s47, 0
    s_cselect_b32 s58, 0x01000c0c, s59
    s_cselect_b32 s59, s59, 0x01000c0c
    s_cselect_b64 vcc, -1, 0
    v_cndmask_b32 v144, v69, v68, vcc
    v_cndmask_b32 v145, v68, v69, vcc
    v_add3_u32 v144, s53, v144, -1
    v_add3_u32 v145, v67, v145, -1
    v_cvt_f32_i32 v100, v144
    v_cvt_f32_i32 v102, v145
    v_add_f32 v101, 1.0, v100
    v_add_f32 v103, 0x41c00000, v102
    s_mov_b32 s40, 0x435f0000
    v_med3_f32 v144, v100, 0, s40
    v_med3_f32 v145, v101, 0, s40
    v_med3_f32 v146, v102, 0, s40
    v_med3_f32 v147, v103, 0, s40
    v_cvt_pk_bf16_f32 v105, v145, v146
    v_cvt_pk_bf16_f32 v104, v144, v146
    v_cvt_pk_bf16_f32 v106, v144, v147
    v_cvt_pk_bf16_f32 v107, v145, v147
    v_mul_u32_u24 v168, 12, v67
    v_readfirstlane_b32 s41, v105
    v_add_lshl_u32 v168, v168, v66, 2
    v_lshlrev_b32 v110, 3, v0
    v_lshlrev_b32 v162, 2, v1
    v_mov_b32 v163, s41
    v_add_u32 v110, 156928, v110
    s_mov_b64 exec, 0
    s_cmp_eq_u32 s3, 0
    s_cbranch_scc1 L_pgY0
    s_cmp_eq_u32 s3, 1
    s_cbranch_scc1 L_pgY1
    s_cmp_eq_u32 s3, 2
    s_cbranch_scc1 L_pgY2
L_retY:
    s_mov_b64 exec, -1
    v_add_u32 v162, 148992, v162
    ds_write_b64 v110, v[162:163]
    s_mul_i32 s40, s57, 3072
    s_add_u32 s40, s40, 146688
    v_mad_u32_u24 v23, v2, 48, s40
    s_sub_u32 s61, 43200, s54
    s_cmp_lt_u32 s45, 14784
    s_cselect_b32 s37, 0, 0x80
    s_cmp_lt_u32 s80, 2
    s_cselect_b32 s40, 0, 0x800000
    s_or_b32 s37, s37, s40
    s_or_b32 s37, s37, 0x3e003e00
    s_mul_i32 s35, s46, 3456
    s_add_u32 s35, s35, 89088
    s_add_u32 s43, s53, s57
    s_mul_i32 s76, s43, s61
    s_cmp_lg_u32 s46, 0
    s_cbranch_scc1 L_mc
    s_mov_b32 s41, 0x7f000000
    s_cmp_lt_u32 s53, 34
    s_cselect_b32 s39, 768, s41
    s_cselect_b32 s33, 6, 4
    s_subb_u32 s32, s53, 1
    s_movk_i32 s34, 9600
    s_movk_i32 s36, 50
    s_mov_b32 s38, 0x770000
    s_lshl_b32 s40, s54, 4
    s_add_u32 s75, s76, s40
    s_add_u32 s74, s75, s40
    s_add_u32 s65, s32, s3
    s_min_u32 s65, s65, 223
    s_mul_i32 s65, s65, s61
    s_add_u32 s67, s65, s40
    s_add_u32 s69, s67, s40
    s_mul_i32 s64, s3, s34
    s_add_u32 s64, s64, s35
    s_add_u32 s66, s64, 3072
    s_add_u32 s68, s64, 6144
    s_sub_u32 s43, s43, s32
    s_mul_i32 s43, s43, s34
    s_add_u32 s77, s43, 0x80015c00
    s_add_u32 s78, s77, 0x400000
    s_add_u32 s79, s77, 0x800000
    s_branch L_mc_back
L_mc:
    s_mov_b32 s39, 0x7f000000
    s_sub_u32 s33, 10, s46
    s_add_u32 s32, s53, s46
    s_sub_u32 s32, s32, 6
    s_max_i32 s32, s32, 0
    s_movk_i32 s34, 3456
    s_movk_i32 s36, 18
    s_mul_i32 s64, s3, 3456
    s_add_u32 s64, s64, 89088
    s_add_u32 s66, s64, 13824
    s_add_u32 s68, s64, 27648
    s_min_u32 s68, s68, 123648
    s_mul_i32 s40, s80, 3072
    s_add_u32 s40, s40, 9599808
    s_add_u32 s69, s3, 8
    s_mul_i32 s65, s69, s61
    s_add_u32 s65, s65, s44
    s_min_u32 s65, s65, s40
    s_add_u32 s41, s44, 516096
    s_min_u32 s41, s41, s40
    s_sub_u32 s40, s69, s46
    s_add_u32 s69, s40, s32
    s_mul_i32 s69, s69, s61
    s_sub_u32 s67, s69, 172032
    s_cmp_lt_u32 s40, 4
    s_cselect_b32 s67, s41, s67
    s_mul_i32 s40, s57, 43008
    s_add_u32 s40, s44, s40
    s_add_u32 s74, s40, 301248
    s_add_u32 s75, s40, 387264
    s_add_u32 s40, s40, 473280
    s_mul_i32 s79, s57, 3456
    s_add_u32 s79, s79, 0x80054e80
    s_add_u32 s78, s79, 6912
    s_add_u32 s41, s79, 13824
    s_sub_u32 s77, s43, s32
    s_mul_i32 s77, s77, 3456
    s_add_u32 s77, s77, s35
    s_cmp_eq_u32 s43, 0
    s_cselect_b32 s43, 0, 0x80000000
    s_or_b32 s77, s77, s43
    s_sub_u32 s38, 21, s46
    s_lshl_b32 s38, s38, 16
    s_sub_u32 s43, s46, s57
    s_cmp_eq_u32 s43, 5
    s_cselect_b32 s76, s40, s76
    s_cselect_b32 s77, s41, s77
L_mc_back:
    v_mov_b32 v84, s79
    s_mov_b32 exec_hi, 0
    v_mov_b32 v84, s78
    s_mov_b32 exec_lo, 0xffff
    v_mov_b32 v84, s77
    s_mov_b64 exec, -1
    v_bfe_u32 v155, v84, 18, 6
    v_and_b32 v148, 0x3ffff, v84
    v_ashrrev_i32 v147, 31, v84
    v_add_lshl_u32 v155, v155, v2, 3
    v_add_u32 v149, s34, v148
    v_mad_i32_i24 v147, v147, s34, v148
    v_add_u32 v154, -8, v155
    v_add_u32 v156, 8, v155
    v_max_i32 v154, 0, v154
    v_and_b32 v144, 32, v154
    v_mad_u32_u24 v144, v154, 24, v144
    v_and_b32 v145, 32, v155
    v_mad_u32_u24 v145, v155, 24, v145
    v_and_b32 v146, 32, v156
    v_mad_u32_u24 v146, v156, 24, v146
    s_cmp_eq_u32 s47, 0
    s_cbranch_scc1 L_notr
    v_swap_b32 v144, v147
    v_swap_b32 v145, v148
    v_swap_b32 v146, v149
L_notr:
    v_add_u32 v88, v147, v144
    v_add_u32 v89, v147, v145
    v_add_u32 v90, v147, v146
    v_add_u32 v91, v148, v144
    v_add_u32 v92, v148, v145
    v_add_u32 v93, v148, v146
    v_add_u32 v94, v149, v144
    v_add_u32 v95, v149, v145
    v_add_u32 v96, v149, v146
    v_mad_u32_u24 v144, v4, 48, v23
    ds_write_b128 v144, v[88:91]
    ds_write_b128 v144, v[92:95] offset:16
    s_add_u32 m0, s25, 6912
    s_add_u32 s31, s44, 86016
    buffer_load_dwordx4 v8, s[8:11], s31 offen  lds
    ds_write_b32 v144, v96 offset:32
    v_lshrrev_b32 v3, 4, v1
    s_movk_i32 s42, 192
    v_mov_b32 v34, 158976
    v_mov_b32 v147, 0
    ds_write_b32 v34, v147
    v_bfe_u32 v144, v1, 2, 2
    s_add_u32 m0, s25, 17280
    s_add_u32 s31, s44, 215040
    buffer_load_dwordx4 v8, s[8:11], s31 offen  lds
    v_lshl_add_u32 v144, v3, 3, v144
    v_lshrrev_b32 v145, 2, v1
    v_mul_u32_u24 v144, 192, v144
    v_bfi_b32 v145, 3, v1, v145
    s_lshl_b32 s40, s2, 5
    v_and_b32 v145, 7, v145
    v_lshl_add_u32 v144, v145, 3, v144
    s_mul_i32 s31, s57, 3456
    s_add_u32 s31, s31, s24
    s_add_u32 m0, s31, 127488
    s_add_u32 s31, s28, 55296
    buffer_load_dwordx4 v5, s[16:19], s31 offen lds
    v_xad_u32 v15, v144, s40, 64
    v_lshl_add_u32 v13, s2, 7, v144
    s_mul_i32 s40, s57, 10368
    v_xor_b32 v14, 32, v13
    s_add_u32 s40, s40, 61440
    s_cmp_eq_u32 s80, 10
    s_cselect_b32 s41, 16, 17
    buffer_load_dwordx4 v6, s[16:19], s31 offen offset:1024 lds
    v_add_u32 v144, 2, v2
    v_add_u32 v147, s40, v4
    v_min_u32 v144, s41, v144
    v_lshl_add_u32 v144, v144, 3, 0
    v_bitop3_b32 v145, v144, 32, v147 bitop3:0x6a
    v_mad_u32_u24 v18, v144, 24, v145
    v_lshl_add_u32 v144, v2, 3, 8
    buffer_load_dwordx4 v7, s[16:19], s31 offen offset:2048 lds
    v_bitop3_b32 v145, v144, 32, v147 bitop3:0x6a
    v_mad_u32_u24 v17, v144, 24, v145
    v_lshl_add_u32 v144, v2, 3, 0
    v_bitop3_b32 v145, v144, 32, v147 bitop3:0x6a
    v_mad_u32_u24 v16, v144, 24, v145
    v_mul_u32_u24 v144, 5462, v1
    s_sub_u32 s40, s54, 192
    s_waitcnt vmcnt(16)
    s_barrier
    s_add_u32 m0, s25, 20736
    s_add_u32 s31, s44, 258048
    buffer_load_dwordx4 v8, s[8:11], s31 offen  lds
    ds_read_b64_tr_b16 a[0:1], v13 offset:24576
    ds_read_b64_tr_b16 a[2:3], v13 offset:25344
    ds_read_b64_tr_b16 a[4:5], v14 offset:24576
    ds_read_b64_tr_b16 a[6:7], v14 offset:25344
    ds_read_b64_tr_b16 a[8:9], v15 offset:24576
    ds_read_b64_tr_b16 a[10:11], v15 offset:25344
    ds_read_b64_tr_b16 a[12:13], v13 offset:30720
    v_lshrrev_b32 v145, 13, v144
    v_bitop3_b32 v145, v145, 32, v5 bitop3:0x6a
    v_mad_u32_u16 v9, v144, s40, v145 op_sel:[1,0,0,0]
    v_add_u32 v146, 349568, v144
    v_lshrrev_b32 v145, 13, v146
    v_bitop3_b32 v145, v145, 32, v5 bitop3:0x6a
    v_mad_u32_u16 v10, v146, s40, v145 op_sel:[1,0,0,0]
    s_add_u32 m0, s25, 24192
    s_add_u32 s31, s44, 301056
    buffer_load_dwordx4 v8, s[8:11], s31 offen  lds
    ds_read_b64_tr_b16 a[14:15], v13 offset:31488
    v_add_u32 v146, 699136, v144
    ds_read_b64_tr_b16 a[16:17], v14 offset:30720
    ds_read_b64_tr_b16 a[18:19], v14 offset:31488
    ds_read_b64_tr_b16 a[20:21], v15 offset:30720
    ds_read_b64_tr_b16 a[22:23], v15 offset:31488
    v_lshrrev_b32 v145, 13, v146
    v_bitop3_b32 v145, v145, 32, v5 bitop3:0x6a
    v_mad_u32_u16 v11, v146, s40, v145 op_sel:[1,0,0,0]
    v_add_u32 v146, 830224, v144
    v_lshrrev_b32 v145, 13, v146
    v_bitop3_b32 v145, v145, 32, v5 bitop3:0x6a
    s_add_u32 m0, s24, 49152
    s_add_u32 s31, s28, 61440
    buffer_load_dwordx4 v5, s[16:19], s31 offen lds
    v_mad_u32_u16 v12, v146, s40, v145 op_sel:[1,0,0,0]
    s_cmp_eq_u32 s46, 0
    s_cselect_b64 vcc, -1, 0
    v_cndmask_b32 v50, v12, v9, vcc
    v_add_u32 v61, 127488, v13
    v_add_u32 v62, 127488, v14
    v_add_u32 v63, 127488, v15
    buffer_load_dwordx4 v6, s[16:19], s31 offen offset:1024 lds
    v_add_u32 v174, 150912, v168
    v_add_u32 v172, 147840, v168
    v_add_u32 v170, 149760, v168
    v_add_u32 v168, 146688, v168
    v_subrev_u32 v108, 36, v1
    v_lshrrev_b32 v108, 31, v108
    v_lshlrev_b32 v111, 4, v0
    buffer_load_dwordx4 v7, s[16:19], s31 offen offset:2048 lds
    v_add_u32 v111, 152832, v111
    v_mul_u32_u24 v41, 192, v2
    v_lshlrev_b32 v40, 2, v2
    v_add_u32 v41, s24, v41
    v_and_or_b32 v109, v40, 48, v41
    v_and_or_b32 v40, v40, 56, v41
    v_mul_u32_u24 v42, 768, v4
    v_xor_b32 v28, v40, v4
    v_add_u32 v109, v109, v42
    v_xor_b32 v29, 8, v28
    s_waitcnt lgkmcnt(0)
    s_waitcnt vmcnt(14)
    s_barrier
    ds_read_b128 v[112:115], v16 offset:0
    ds_read_b128 v[116:119], v16 offset:3456
    ds_read_b128 v[120:123], v16 offset:64
    ds_read_b128 v[124:127], v16 offset:3520
    s_waitcnt lgkmcnt(3)
    v_mfma_f32_16x16x32_bf16 v[64:67], a[0:3], v[112:115], 0
    s_add_u32 m0, s24, 0
    ds_read_b64_tr_b16 a[24:25], v13 offset:36864
    s_add_u32 s31, s28, 67584
    ds_read_b64_tr_b16 a[26:27], v13 offset:37632
    v_mfma_f32_16x16x32_bf16 v[68:71], a[4:7], v[112:115], 0
    s_mul_i32 s56, s46, 36
    ds_read_b64_tr_b16 a[28:29], v14 offset:36864
    buffer_load_dwordx4 v5, s[16:19], s31 offen lds
    v_mfma_f32_16x16x32_bf16 v[72:75], a[8:11], v[112:115], 0
    s_waitcnt lgkmcnt(5)
    ds_read_b64_tr_b16 a[30:31], v14 offset:37632
    s_movk_i32 s5, 7488
    ds_read_b64_tr_b16 a[32:33], v15 offset:36864
    v_mfma_f32_16x16x32_bf16 v[76:79], a[0:3], v[116:119], 0
    s_addk_i32 s56, 215
    ds_read_b64_tr_b16 a[34:35], v15 offset:37632
    v_mul_u32_u24 v30, 1821, v0
    v_mfma_f32_16x16x32_bf16 v[80:83], a[4:7], v[116:119], 0
    s_lshl_b32 s4, s3, 10
    ds_read_b128 v[128:131], v16 offset:128
    v_lshlrev_b32 v31, 4, v0
    v_mfma_f32_16x16x32_bf16 v[84:87], a[8:11], v[116:119], 0
    s_waitcnt vmcnt(11) lgkmcnt(7)
    ds_read_b64_tr_b16 a[36:37], v13 offset:43008
    buffer_load_dwordx4 v6, s[16:19], s31 offen offset:1024 lds
    v_mfma_f32_16x16x32_bf16 v[64:67], a[12:15], v[120:123], v[64:67]
    s_lshl_b32 s6, s3, 5
    ds_read_b64_tr_b16 a[38:39], v13 offset:43776
    v_perm_b32 v144, v176, v176, s58
    v_mfma_f32_16x16x32_bf16 v[68:71], a[16:19], v[120:123], v[68:71]
    s_add_u32 s6, s6, 9808
    ds_read_b64_tr_b16 a[40:41], v14 offset:43008
    v_perm_b32 v145, v176, v176, s59
    v_mfma_f32_16x16x32_bf16 v[72:75], a[20:23], v[120:123], v[72:75]
    s_add_u32 s33, s33, s32
    ds_read_b128 v[132:135], v16 offset:3584
    v_perm_b32 v146, v177, v177, s58
    v_mfma_f32_16x16x32_bf16 v[76:79], a[12:15], v[124:127], v[76:79]
    s_mul_i32 s40, s32, s34
    ds_read_b64_tr_b16 a[42:43], v14 offset:43776
    buffer_load_dwordx4 v7, s[16:19], s31 offen offset:2048 lds
    v_mfma_f32_16x16x32_bf16 v[80:83], a[16:19], v[124:127], v[80:83]
    s_add_u32 m0, s24, 12288
    ds_read_b64_tr_b16 a[44:45], v15 offset:43008
    v_perm_b32 v147, v177, v177, s59
    v_mfma_f32_16x16x32_bf16 v[84:87], a[20:23], v[124:127], v[84:87]
    s_waitcnt lgkmcnt(5)
    ds_read_b64_tr_b16 a[46:47], v15 offset:43776
    v_perm_b32 v148, v178, v178, s58
    v_mfma_f32_16x16x32_bf16 v[64:67], a[24:27], v[128:131], v[64:67]
    s_add_u32 s31, s28, 73728
    ds_read_b128 v[136:139], v17 offset:0
    v_perm_b32 v149, v178, v178, s59
    v_mfma_f32_16x16x32_bf16 v[68:71], a[28:31], v[128:131], v[68:71]
    s_sub_u32 s35, s35, s40
    ds_read_b128 v[140:143], v17 offset:3456
    buffer_load_dwordx4 v5, s[16:19], s31 offen lds
    v_mfma_f32_16x16x32_bf16 v[72:75], a[32:35], v[128:131], v[72:75]
    s_waitcnt lgkmcnt(5)
    v_perm_b32 v150, v179, v179, s58
    v_perm_b32 v151, v179, v179, s59
    v_mfma_f32_16x16x32_bf16 v[76:79], a[24:27], v[132:135], v[76:79]
    s_add_u32 s4, s4, 152832
    v_add_f32 v144, v100, v144
    v_add_f32 v145, v102, v145
    v_mfma_f32_16x16x32_bf16 v[80:83], a[28:31], v[132:135], v[80:83]
    s_mul_i32 s55, s45, 36
    v_add_f32 v146, v101, v146
    v_add_f32 v147, v102, v147
    v_mfma_f32_16x16x32_bf16 v[84:87], a[32:35], v[132:135], v[84:87]
    s_waitcnt vmcnt(9) lgkmcnt(1)
    s_barrier
    v_mfma_f32_16x16x32_bf16 v[64:67], a[36:39], v[136:139], v[64:67]
    s_mul_i32 s72, s2, 9600
    ds_read_b128 v[112:115], v16 offset:6912
    buffer_load_dwordx4 v6, s[16:19], s31 offen offset:1024 lds
    v_mfma_f32_16x16x32_bf16 v[68:71], a[40:43], v[136:139], v[68:71]
    s_add_u32 s72, s72, 127488
    ds_read_b64_tr_b16 a[108:109], v61 offset:0
    s_mul_i32 s77, s57, 1536
    ds_read_b64_tr_b16 a[110:111], v61 offset:768
    v_mfma_f32_16x16x32_bf16 v[72:75], a[44:47], v[136:139], v[72:75]
    s_waitcnt lgkmcnt(3)
    ds_read_b64_tr_b16 a[112:113], v62 offset:0
    s_lshl1_add_u32 s70, s77, s72
    ds_read_b128 v[116:119], v16 offset:6976
    v_mfma_f32_16x16x32_bf16 v[76:79], a[36:39], v[140:143], v[76:79]
    s_add_u32 s77, s77, s72
    ds_read_b64_tr_b16 a[114:115], v62 offset:768
    s_addk_i32 s77, 4608
    ds_read_b64_tr_b16 a[116:117], v63 offset:0
    v_mfma_f32_16x16x32_bf16 v[80:83], a[40:43], v[140:143], v[80:83]
    s_add_u32 s73, s32, s2
    ds_read_b64_tr_b16 a[118:119], v63 offset:768
    buffer_load_dwordx4 v7, s[16:19], s31 offen offset:2048 lds
    v_mfma_f32_16x16x32_bf16 v[84:87], a[44:47], v[140:143], v[84:87]
    s_waitcnt lgkmcnt(7)
    ds_read_b128 v[120:123], v16 offset:7040
    v_add_f32 v148, v100, v148
    v_mfma_f32_16x16x32_bf16 v[88:91], a[0:3], v[112:115], 0
    s_add_u32 m0, s24, 24576
    ds_read_b64_tr_b16 a[216:217], v61 offset:9600
    v_add_f32 v149, v103, v149
    v_mfma_f32_16x16x32_bf16 v[92:95], a[4:7], v[112:115], 0
    s_add_u32 s31, s28, 24576
    ds_read_b64_tr_b16 a[218:219], v61 offset:10368
    v_add_f32 v150, v101, v150
    v_mfma_f32_16x16x32_bf16 v[96:99], a[8:11], v[112:115], 0
L_pgY0:
  s_cbranch_execz L_retY
    s_waitcnt lgkmcnt(6)
    ds_read_b64_tr_b16 a[220:221], v62 offset:9600
    buffer_load_dwordx4 v5, s[16:19], s31 offen lds
    v_mfma_f32_16x16x32_bf16 v[88:91], a[12:15], v[116:119], v[88:91]
    s_mulk_i32 s73, 192
    ds_read_b128 v[124:127], v17 offset:6912
    v_add_f32 v151, v103, v151
    v_mfma_f32_16x16x32_bf16 v[92:95], a[16:19], v[116:119], v[92:95]
    s_add_u32 s73, s73, s39
    ds_read_b64_tr_b16 a[222:223], v62 offset:10368
    v_cvt_pk_bf16_f32 v169, v144, v145
    v_mfma_f32_16x16x32_bf16 v[96:99], a[20:23], v[116:119], v[96:99]
    s_waitcnt lgkmcnt(5)
    ds_read_b64_tr_b16 a[224:225], v63 offset:9600
    v_cvt_pk_bf16_f32 v171, v146, v147
    v_mfma_f32_16x16x32_bf16 v[88:91], a[24:27], v[120:123], v[88:91]
    s_mul_i32 s78, s57, 344064
    ds_read_b64_tr_b16 a[226:227], v63 offset:10368
    buffer_load_dwordx4 v6, s[16:19], s31 offen offset:1024 lds
    v_mfma_f32_16x16x32_bf16 v[92:95], a[28:31], v[120:123], v[92:95]
    s_lshl1_add_u32 s71, s78, s73
    ds_read_b128 v[128:131], v16 offset:3456
    v_cvt_pk_bf16_f32 v173, v148, v149
    v_mfma_f32_16x16x32_bf16 v[96:99], a[32:35], v[120:123], v[96:99]
    s_waitcnt lgkmcnt(4)
    ds_read_b128 v[132:135], v16 offset:6912
    v_cvt_pk_bf16_f32 v175, v150, v151
    v_mfma_f32_16x16x32_bf16 v[88:91], a[36:39], v[124:127], v[88:91]
    s_add_u32 s78, s78, s73
    v_pk_max_i16 v169, v169, 0
    v_pk_max_i16 v171, v171, 0
    v_mfma_f32_16x16x32_bf16 v[92:95], a[40:43], v[124:127], v[92:95]
    buffer_load_dwordx4 v7, s[16:19], s31 offen offset:2048 lds
    v_mfma_f32_16x16x32_bf16 v[96:99], a[44:47], v[124:127], v[96:99]
    s_waitcnt vmcnt(9) lgkmcnt(1)
    s_barrier
    v_mfma_f32_16x16x32_bf16 v[64:67], a[108:111], v[128:131], v[64:67]
    s_add_u32 m0, s24, 36864
    ds_read_b128 v[136:139], v16 offset:10368
    s_add_u32 s31, s26, 135168
    ds_read_b64_tr_b16 a[120:121], v13 offset:49152
    v_mfma_f32_16x16x32_bf16 v[68:71], a[112:115], v[128:131], v[68:71]
    s_add_u32 s73, s78, 1373824
    ds_read_b64_tr_b16 a[122:123], v13 offset:49920
    v_pk_max_i16 v173, v173, 0
    v_mfma_f32_16x16x32_bf16 v[72:75], a[116:119], v[128:131], v[72:75]
    s_waitcnt lgkmcnt(3)
    ds_read_b64_tr_b16 a[124:125], v14 offset:49152
    buffer_load_dwordx4 v5, s[16:19], s31 offen lds
    v_mfma_f32_16x16x32_bf16 v[76:79], a[108:111], v[132:135], v[76:79]
    s_add_u32 s78, s78, 1032192
    ds_read_b64_tr_b16 a[126:127], v14 offset:49920
    v_pk_max_i16 v175, v175, 0
    v_mfma_f32_16x16x32_bf16 v[80:83], a[112:115], v[132:135], v[80:83]
    s_sub_u32 s72, s77, 896
    ds_read_b64_tr_b16 a[128:129], v15 offset:49152
    v_pk_min_i16 v169, v169, s60
    v_mfma_f32_16x16x32_bf16 v[84:87], a[116:119], v[132:135], v[84:87]
    s_waitcnt lgkmcnt(5)
    ds_read_b64_tr_b16 a[130:131], v15 offset:49920
    v_pk_min_i16 v171, v171, s60
    v_mfma_f32_16x16x32_bf16 v[88:91], a[108:111], v[136:139], v[88:91]
    ds_read_b64_tr_b16 a[228:229], v13 offset:55296
    buffer_load_dwordx4 v6, s[16:19], s31 offen offset:1024 lds
    v_mfma_f32_16x16x32_bf16 v[92:95], a[112:115], v[136:139], v[92:95]
    s_cmp_eq_u32 s46, 0
    s_cselect_b32 s72, s72, s64
    ds_read_b64_tr_b16 a[230:231], v13 offset:56064
    v_mfma_f32_16x16x32_bf16 v[96:99], a[116:119], v[136:139], v[96:99]
    s_cmp_eq_u32 s46, 0
    s_cselect_b32 s73, s73, s65
    ds_read_b64_tr_b16 a[232:233], v14 offset:55296
    v_mfma_f32_16x16x32_bf16 v[64:67], a[216:219], v[132:135], v[64:67]
    s_cmp_eq_u32 s46, 0
    s_cselect_b32 s77, s77, s66
    ds_read_b128 v[140:143], v16 offset:13824
    v_mfma_f32_16x16x32_bf16 v[68:71], a[220:223], v[132:135], v[68:71]
    ds_read_b64_tr_b16 a[234:235], v14 offset:56064
    buffer_load_dwordx4 v7, s[16:19], s31 offen offset:2048 lds
    v_mfma_f32_16x16x32_bf16 v[72:75], a[224:227], v[132:135], v[72:75]
    s_mul_i32 s31, s57, 3456
    ds_read_b64_tr_b16 a[236:237], v15 offset:55296
    v_pk_min_i16 v173, v173, s60
    v_mfma_f32_16x16x32_bf16 v[76:79], a[216:219], v[136:139], v[76:79]
    s_add_u32 s31, s31, s24
    ds_read_b64_tr_b16 a[238:239], v15 offset:56064
    v_pk_min_i16 v175, v175, s60
    v_mfma_f32_16x16x32_bf16 v[80:83], a[220:223], v[136:139], v[80:83]
    s_add_u32 m0, s31, 127488
    ds_read_b128 v[112:115], v16 offset:3520
    v_cmp_ne_u16_e64 s[80:81], v169, v104
    v_mfma_f32_16x16x32_bf16 v[84:87], a[224:227], v[136:139], v[84:87]
    s_waitcnt lgkmcnt(4)
    ds_read_b128 v[116:119], v16 offset:6976
    v_cmp_ne_u16_sdwa s[88:89], v169, v104 src0_sel:WORD_1 src1_sel:WORD_1
    v_mfma_f32_16x16x32_bf16 v[88:91], a[216:219], v[140:143], v[88:91]
    ds_read_b128 v[120:123], v16 offset:10432
    v_cmp_ne_u16_e64 s[82:83], v171, v105
    v_mfma_f32_16x16x32_bf16 v[92:95], a[220:223], v[140:143], v[92:95]
    v_cmp_ne_u16_sdwa s[90:91], v171, v105 src0_sel:WORD_1 src1_sel:WORD_1
    v_cmp_ne_u16_e64 s[84:85], v173, v106
    v_mfma_f32_16x16x32_bf16 v[96:99], a[224:227], v[140:143], v[96:99]
    s_waitcnt vmcnt(9) lgkmcnt(2)
    s_barrier
    v_mfma_f32_16x16x32_bf16 v[64:67], a[120:123], v[112:115], v[64:67]
    s_add_u32 s31, s28, 86016
    ds_read_b64_tr_b16 a[132:133], v13 offset:0
    v_cmp_ne_u16_sdwa s[92:93], v173, v106 src0_sel:WORD_1 src1_sel:WORD_1
    v_mfma_f32_16x16x32_bf16 v[68:71], a[124:127], v[112:115], v[68:71]
    ds_read_b64_tr_b16 a[134:135], v13 offset:768
    buffer_load_dwordx4 v5, s[16:19], s31 offen lds
    v_mfma_f32_16x16x32_bf16 v[72:75], a[128:131], v[112:115], v[72:75]
    s_waitcnt lgkmcnt(3)
    ds_read_b64_tr_b16 a[136:137], v14 offset:0
    v_cmp_ne_u16_e64 s[86:87], v175, v107
    v_mfma_f32_16x16x32_bf16 v[76:79], a[120:123], v[116:119], v[76:79]
    ds_read_b64_tr_b16 a[138:139], v14 offset:768
    v_cmp_ne_u16_sdwa s[94:95], v175, v107 src0_sel:WORD_1 src1_sel:WORD_1
    v_mfma_f32_16x16x32_bf16 v[80:83], a[124:127], v[116:119], v[80:83]
    ds_read_b64_tr_b16 a[140:141], v15 offset:0
    v_mad_u32_u16 v30, v30, s5, v31 op_sel:[1,0,0,0]
    v_mfma_f32_16x16x32_bf16 v[84:87], a[128:131], v[116:119], v[84:87]
    s_waitcnt lgkmcnt(5)
    ds_read_b64_tr_b16 a[142:143], v15 offset:768
    buffer_load_dwordx4 v6, s[16:19], s31 offen offset:1024 lds
    v_mfma_f32_16x16x32_bf16 v[88:91], a[120:123], v[120:123], v[88:91]
    s_xor_b64 s[80:81], s[80:81], s[88:89]
    ds_read_b64_tr_b16 a[240:241], v13 offset:6144
    s_andn2_b64 s[88:89], s[88:89], s[80:81]
    v_mfma_f32_16x16x32_bf16 v[92:95], a[124:127], v[120:123], v[92:95]
    s_xor_b64 s[82:83], s[82:83], s[90:91]
    ds_read_b64_tr_b16 a[242:243], v13 offset:6912
    s_andn2_b64 s[90:91], s[90:91], s[82:83]
    v_mfma_f32_16x16x32_bf16 v[96:99], a[128:131], v[120:123], v[96:99]
    s_xor_b64 s[84:85], s[84:85], s[92:93]
    ds_read_b64_tr_b16 a[244:245], v14 offset:6144
    s_andn2_b64 s[92:93], s[92:93], s[84:85]
    v_mfma_f32_16x16x32_bf16 v[64:67], a[228:231], v[116:119], v[64:67]
    s_xor_b64 s[86:87], s[86:87], s[94:95]
    ds_read_b128 v[124:127], v16 offset:13888
    buffer_load_dwordx4 v7, s[16:19], s31 offen offset:2048 lds
    v_mfma_f32_16x16x32_bf16 v[68:71], a[232:235], v[116:119], v[68:71]
    s_add_u32 m0, s24, 49152
    ds_read_b64_tr_b16 a[246:247], v14 offset:6912
    v_mbcnt_lo_u32_b32 v148, s88, 0
    v_mfma_f32_16x16x32_bf16 v[72:75], a[236:239], v[116:119], v[72:75]
    s_add_u32 s31, s28, 36864
    ds_read_b64_tr_b16 a[248:249], v15 offset:6144
    s_andn2_b64 s[94:95], s[94:95], s[86:87]
    v_mfma_f32_16x16x32_bf16 v[76:79], a[228:231], v[120:123], v[76:79]
    s_bcnt1_i32_b64 s48, s[88:89]
    ds_read_b64_tr_b16 a[250:251], v15 offset:6912
    s_bcnt1_i32_b64 s49, s[90:91]
    v_mfma_f32_16x16x32_bf16 v[80:83], a[232:235], v[120:123], v[80:83]
    s_bcnt1_i32_b64 s50, s[92:93]
    ds_read_b128 v[128:131], v16 offset:3584
    buffer_load_dwordx4 v5, s[16:19], s31 offen lds
    v_mfma_f32_16x16x32_bf16 v[84:87], a[236:239], v[120:123], v[84:87]
    s_waitcnt lgkmcnt(4)
    ds_read_b128 v[132:135], v16 offset:7040
    v_mbcnt_lo_u32_b32 v149, s90, 0
    v_mfma_f32_16x16x32_bf16 v[88:91], a[228:231], v[124:127], v[88:91]
    s_bcnt1_i32_b64 s51, s[94:95]
    ds_read_b128 v[136:139], v16 offset:10496
    v_mbcnt_lo_u32_b32 v150, s92, 0
    v_mfma_f32_16x16x32_bf16 v[92:95], a[232:235], v[124:127], v[92:95]
    s_lshr_b32 s52, s89, 4
    v_mbcnt_lo_u32_b32 v151, s94, 0
    v_mbcnt_hi_u32_b32 v148, s89, v148
    v_mfma_f32_16x16x32_bf16 v[96:99], a[236:239], v[124:127], v[96:99]
    s_waitcnt vmcnt(10) lgkmcnt(2)
    s_barrier
    v_mfma_f32_16x16x32_bf16 v[64:67], a[132:135], v[128:131], v[64:67]
    s_lshr_b32 s61, s91, 4
    ds_read_b64_tr_b16 a[144:145], v13 offset:12288
    buffer_load_dwordx4 v6, s[16:19], s31 offen offset:1024 lds
    v_mfma_f32_16x16x32_bf16 v[68:71], a[136:139], v[128:131], v[68:71]
    s_bcnt1_i32_b32 s52, s52
    ds_read_b64_tr_b16 a[146:147], v13 offset:13056
    s_bcnt1_i32_b32 s61, s61
    ds_read_b64_tr_b16 a[148:149], v14 offset:12288
    v_mfma_f32_16x16x32_bf16 v[72:75], a[140:143], v[128:131], v[72:75]
    s_waitcnt lgkmcnt(4)
    ds_read_b64_tr_b16 a[150:151], v14 offset:13056
    v_mbcnt_hi_u32_b32 v149, s91, v149
    v_mfma_f32_16x16x32_bf16 v[76:79], a[132:135], v[132:135], v[76:79]
    s_add_u32 s51, s51, s50
    ds_read_b64_tr_b16 a[152:153], v15 offset:12288
    v_mbcnt_hi_u32_b32 v150, s93, v150
    v_mfma_f32_16x16x32_bf16 v[80:83], a[136:139], v[132:135], v[80:83]
    s_add_u32 s43, s48, s49
    ds_read_b64_tr_b16 a[154:155], v15 offset:13056
    buffer_load_dwordx4 v7, s[16:19], s31 offen offset:2048 lds
    v_mbcnt_hi_u32_b32 v151, s95, v151
    v_mfma_f32_16x16x32_bf16 v[84:87], a[140:143], v[132:135], v[84:87]
    s_waitcnt lgkmcnt(6)
    ds_read_b64_tr_b16 a[252:253], v13 offset:18432
    v_mad_i32_i24 v148, 32, v108, v148
    v_mfma_f32_16x16x32_bf16 v[88:91], a[132:135], v[136:139], v[88:91]
    s_add_u32 m0, s24, 0
    ds_read_b64_tr_b16 a[254:255], v13 offset:19200
    v_mbcnt_lo_u32_b32 v144, s80, 0
    s_add_u32 s43, s43, s51
    v_mfma_f32_16x16x32_bf16 v[92:95], a[136:139], v[136:139], v[92:95]
    s_add_u32 s31, s26, 147456
    ds_read_b64_tr_b16 v[188:189], v14 offset:18432
    s_add_u32 s51, s51, s52
    s_add_u32 s51, s51, s61
    v_mfma_f32_16x16x32_bf16 v[96:99], a[140:143], v[136:139], v[96:99]
    s_lshl_b32 s96, s51, 1
    ds_read_b128 v[140:143], v16 offset:13952
    buffer_load_dwordx4 v5, s[16:19], s31 offen lds
    s_lshl_b32 s43, s43, 1
    v_mfma_f32_16x16x32_bf16 v[64:67], a[240:243], v[132:135], v[64:67]
    s_sub_u32 s40, 64, s43
    ds_read_b64_tr_b16 v[190:191], v14 offset:19200
    s_add_u32 s41, s6, s52
    v_mfma_f32_16x16x32_bf16 v[68:71], a[244:247], v[132:135], v[68:71]
    s_sub_u32 s52, 32, s48
    ds_read_b64_tr_b16 v[192:193], v15 offset:18432
    v_mad_i32_i24 v149, s52, v108, v149
    v_mfma_f32_16x16x32_bf16 v[72:75], a[248:251], v[132:135], v[72:75]
    s_sub_u32 s48, s41, s48
    ds_read_b64_tr_b16 v[194:195], v15 offset:19200
    s_add_u32 s41, s41, s61
    v_mfma_f32_16x16x32_bf16 v[76:79], a[240:243], v[136:139], v[76:79]
    s_sub_u32 s49, s41, s49
    ds_read_b128 v[112:115], v17 offset:3456
    buffer_load_dwordx4 v6, s[16:19], s31 offen offset:1024 lds
    v_mfma_f32_16x16x32_bf16 v[80:83], a[244:247], v[136:139], v[80:83]
    s_add_u32 s50, s50, s41
    ds_read_b128 v[116:119], v17 offset:6912
    v_add_lshl_u32 v148, v148, s48, 4
    v_mfma_f32_16x16x32_bf16 v[84:87], a[248:251], v[136:139], v[84:87]
    s_waitcnt lgkmcnt(5)
    ds_read_b128 v[120:123], v17 offset:10368
    v_add_lshl_u32 v149, v149, s49, 4
    v_mfma_f32_16x16x32_bf16 v[88:91], a[240:243], v[140:143], v[88:91]
    s_bcnt1_i32_b64 s7, s[80:81]
    v_add_lshl_u32 v150, v150, s41, 4
    v_add_lshl_u32 v151, v151, s50, 4
    v_mfma_f32_16x16x32_bf16 v[92:95], a[244:247], v[140:143], v[92:95]
    buffer_load_dwordx4 v7, s[16:19], s31 offen offset:2048 lds
    v_mfma_f32_16x16x32_bf16 v[96:99], a[248:251], v[140:143], v[96:99]
    s_waitcnt vmcnt(9) lgkmcnt(2)
    s_barrier
    v_mfma_f32_16x16x32_bf16 v[64:67], a[144:147], v[112:115], v[64:67]
    s_add_u32 m0, s24, 12288
    ds_read_b64_tr_b16 a[48:49], v13 offset:24576
    s_add_u32 s31, s28, 98304
    ds_read_b64_tr_b16 a[50:51], v13 offset:25344
    s_bcnt1_i32_b64 s59, s[82:83]
    v_mfma_f32_16x16x32_bf16 v[68:71], a[148:151], v[112:115], v[68:71]
    s_bcnt1_i32_b64 s79, s[84:85]
    ds_read_b64_tr_b16 a[52:53], v14 offset:24576
    s_bcnt1_i32_b64 s62, s[86:87]
    ds_read_b64_tr_b16 a[54:55], v14 offset:25344
    v_mbcnt_lo_u32_b32 v145, s82, 0
    v_mfma_f32_16x16x32_bf16 v[72:75], a[152:155], v[112:115], v[72:75]
    s_waitcnt lgkmcnt(4)
    ds_read_b64_tr_b16 a[56:57], v15 offset:24576
    buffer_load_dwordx4 v5, s[16:19], s31 offen lds
    v_mbcnt_lo_u32_b32 v146, s84, 0
    v_mfma_f32_16x16x32_bf16 v[76:79], a[144:147], v[116:119], v[76:79]
    s_lshr_b32 s29, s81, 4
    ds_read_b128 v[124:127], v17 offset:13824
    v_mbcnt_lo_u32_b32 v147, s86, 0
    v_mfma_f32_16x16x32_bf16 v[80:83], a[148:151], v[116:119], v[80:83]
    s_lshr_b32 s30, s83, 4
    ds_read_b64_tr_b16 a[58:59], v15 offset:25344
    v_mbcnt_hi_u32_b32 v144, s81, v144
    v_mfma_f32_16x16x32_bf16 v[84:87], a[152:155], v[116:119], v[84:87]
    s_bcnt1_i32_b32 s29, s29
    ds_read_b64_tr_b16 a[156:157], v13 offset:30720
    v_mbcnt_hi_u32_b32 v145, s83, v145
    v_mfma_f32_16x16x32_bf16 v[88:91], a[144:147], v[120:123], v[88:91]
    s_bcnt1_i32_b32 s30, s30
    ds_read_b128 v[128:131], v17 offset:64
    buffer_load_dwordx4 v6, s[16:19], s31 offen offset:1024 lds
    v_mfma_f32_16x16x32_bf16 v[92:95], a[148:151], v[120:123], v[92:95]
    s_add_u32 s62, s62, s79
    ds_read_b64_tr_b16 a[158:159], v13 offset:31488
    v_mbcnt_hi_u32_b32 v146, s85, v146
    v_mfma_f32_16x16x32_bf16 v[96:99], a[152:155], v[120:123], v[96:99]
    s_add_u32 s63, s7, s59
    ds_read_b64_tr_b16 a[160:161], v14 offset:30720
    v_mbcnt_hi_u32_b32 v147, s87, v147
    v_mfma_f32_16x16x32_bf16 v[64:67], a[252:255], v[116:119], v[64:67]
    s_add_u32 s63, s63, s62
    ds_read_b128 v[132:135], v17 offset:3520
    s_add_u32 s62, s62, s29
    v_mfma_f32_16x16x32_bf16 v[68:71], v[188:191], v[116:119], v[68:71]
    s_add_u32 s62, s62, s30
    ds_read_b64_tr_b16 a[162:163], v14 offset:31488
    buffer_load_dwordx4 v7, s[16:19], s31 offen offset:2048 lds
    v_mfma_f32_16x16x32_bf16 v[72:75], v[192:195], v[116:119], v[72:75]
    s_mov_b32 m0, s64
    ds_read_b64_tr_b16 a[164:165], v15 offset:30720
    s_lshl1_add_u32 s6, s6, s96
    v_mfma_f32_16x16x32_bf16 v[76:79], a[252:255], v[120:123], v[76:79]
    s_add_u32 s62, s62, s96
    ds_read_b64_tr_b16 a[166:167], v15 offset:31488
    v_mad_i32_i24 v144, s40, v108, v144
    v_mfma_f32_16x16x32_bf16 v[80:83], v[188:191], v[120:123], v[80:83]
    s_add_u32 s6, s6, s29
    ds_read_b128 v[136:139], v17 offset:6976
    s_sub_u32 s29, s40, s7
    v_mfma_f32_16x16x32_bf16 v[84:87], v[192:195], v[120:123], v[84:87]
    s_waitcnt lgkmcnt(5)
    ds_read_b64_tr_b16 v[196:197], v13 offset:36864
    buffer_load_dwordx4 v9, s[8:11], s65 offen  lds
    v_mfma_f32_16x16x32_bf16 v[88:91], a[252:255], v[124:127], v[88:91]
    s_sub_u32 s7, s6, s7
    ds_read_b64_tr_b16 v[198:199], v13 offset:37632
    v_mad_i32_i24 v145, s29, v108, v145
    v_mfma_f32_16x16x32_bf16 v[92:95], v[188:191], v[124:127], v[92:95]
    s_add_u32 s6, s6, s30
    ds_read_b64_tr_b16 v[200:201], v14 offset:36864
    s_sub_u32 s59, s6, s59
    v_mfma_f32_16x16x32_bf16 v[96:99], v[192:195], v[124:127], v[96:99]
    s_add_u32 s79, s79, s6
    ds_read_b64_tr_b16 v[202:203], v14 offset:37632
    v_add_lshl_u32 v144, v144, s7, 3
    v_mfma_f32_16x16x32_bf16 v[64:67], a[48:51], v[128:131], v[64:67]
    s_sub_u32 s97, s43, s96
    ds_read_b64_tr_b16 v[204:205], v15 offset:36864
    buffer_load_dwordx4 v10, s[8:11], s65 offen offset:1024  lds
    v_mfma_f32_16x16x32_bf16 v[68:71], a[52:55], v[128:131], v[68:71]
    s_sub_u32 s43, 64, s97
    ds_read_b64_tr_b16 v[206:207], v15 offset:37632
    v_add_lshl_u32 v145, v145, s59, 3
    v_mfma_f32_16x16x32_bf16 v[72:75], a[56:59], v[128:131], v[72:75]
    s_waitcnt lgkmcnt(5)
    ds_read_b64_tr_b16 a[60:61], v13 offset:43008
    v_add_lshl_u32 v146, v146, s6, 3
    v_add_lshl_u32 v147, v147, s79, 3
    v_mfma_f32_16x16x32_bf16 v[76:79], a[48:51], v[132:135], v[76:79]
    s_bfm_b64 s[98:99], s96, 0
    ds_read_b64_tr_b16 a[62:63], v13 offset:43776
    s_bfm_b64 vcc, s97, s43
    v_mfma_f32_16x16x32_bf16 v[80:83], a[52:55], v[132:135], v[80:83]
    s_or_b64 s[98:99], s[98:99], vcc
    ds_read_b64_tr_b16 a[64:65], v14 offset:43008
    buffer_load_dwordx4 v11, s[8:11], s65 offen offset:2048  lds
    v_mfma_f32_16x16x32_bf16 v[84:87], a[56:59], v[132:135], v[84:87]
    s_mov_b32 m0, s66
    ds_read_b128 v[140:143], v17 offset:10432
    v_sub_u32 v32, s56, v0
    v_mfma_f32_16x16x32_bf16 v[88:91], a[48:51], v[136:139], v[88:91]
    s_cmp_gt_u32 s62, 32
    s_cselect_b32 s63, 65, s63
    ds_read_b64_tr_b16 a[66:67], v14 offset:43776
    v_mfma_f32_16x16x32_bf16 v[92:95], a[52:55], v[136:139], v[92:95]
    s_cmp_ge_i32 s63, s40
    s_cbranch_scc1 L_bfail1
L_bfail1_back:
    v_cndmask_b32 v144, v111, v144, s[80:81]
    v_mfma_f32_16x16x32_bf16 v[96:99], a[56:59], v[136:139], v[96:99]
    s_mov_b32 s96, 0x7fff7fff
    ds_read_b64_tr_b16 a[68:69], v15 offset:43008
    buffer_load_dwordx4 v9, s[8:11], s67 offen  lds
    v_cndmask_b32 v144, v144, v148, s[88:89]
    v_mfma_f32_16x16x32_bf16 v[64:67], a[156:159], v[132:135], v[64:67]
    s_mov_b32 s88, 0x00040001
    ds_write_b64 v144, v[168:169]
    v_cndmask_b32 v145, v111, v145, s[82:83]
    v_mfma_f32_16x16x32_bf16 v[68:71], a[160:163], v[132:135], v[68:71]
    s_and_b32 s82, s98, 0x55555555
    ds_read_b64_tr_b16 a[70:71], v15 offset:43776
    v_cndmask_b32 v145, v145, v149, s[90:91]
    v_mfma_f32_16x16x32_bf16 v[72:75], a[164:167], v[132:135], v[72:75]
    s_and_b32 s83, s99, 0x55555555
    ds_write_b64 v145, v[170:171]
    v_cndmask_b32 v146, v111, v146, s[84:85]
    v_cndmask_b32 v146, v146, v150, s[92:93]
    v_mfma_f32_16x16x32_bf16 v[76:79], a[156:159], v[136:139], v[76:79]
    s_andn2_b64 s[80:81], s[98:99], s[82:83]
    ds_write_b64 v146, v[172:173]
    v_cndmask_b32 v147, v111, v147, s[86:87]
    v_cndmask_b32 v147, v147, v151, s[94:95]
    v_mfma_f32_16x16x32_bf16 v[80:83], a[160:163], v[136:139], v[80:83]
    s_not_b64 vcc, s[80:81]
    ds_write_b64 v147, v[174:175]
    v_mfma_f32_16x16x32_bf16 v[84:87], a[164:167], v[136:139], v[84:87]
    s_waitcnt lgkmcnt(5)
    ds_read_b64 v[144:145], v110
    v_mfma_f32_16x16x32_bf16 v[88:91], a[156:159], v[140:143], v[88:91]
    buffer_load_dwordx4 v10, s[8:11], s67 offen offset:1024  lds
    v_mfma_f32_16x16x32_bf16 v[92:95], a[160:163], v[140:143], v[92:95]
    s_mov_b32 s89, 0x00400010
    ds_read_b128 v[112:115], v17 offset:13888
    s_lshl_b64 s[90:91], s[88:89], 1
    v_mfma_f32_16x16x32_bf16 v[96:99], a[164:167], v[140:143], v[96:99]
    s_waitcnt vmcnt(11) lgkmcnt(4)
    s_barrier
    v_mfma_f32_16x16x32_bf16 v[64:67], v[196:199], v[136:139], v[64:67]
    s_lshl_b64 s[92:93], s[88:89], 8
    ds_read_b128 v[116:119], v17 offset:128
    s_lshl_b64 s[94:95], s[88:89], 9
    v_mfma_f32_16x16x32_bf16 v[68:71], v[200:203], v[136:139], v[68:71]
    buffer_load_dwordx4 v11, s[8:11], s67 offen offset:2048  lds
    v_mfma_f32_16x16x32_bf16 v[72:75], v[204:207], v[136:139], v[72:75]
    s_waitcnt lgkmcnt(2)
    ds_write_b32 v144, v109
    v_mfma_f32_16x16x32_bf16 v[76:79], v[196:199], v[140:143], v[76:79]
    s_mov_b32 m0, s68
    ds_read_b128 v[120:123], v17 offset:3584
    v_cndmask_b32_dpp v145, v145, v145, vcc quad_perm:[0,0,2,2] row_mask:0xf bank_mask:0xf
    v_mfma_f32_16x16x32_bf16 v[80:83], v[200:203], v[140:143], v[80:83]
    s_mov_b32 s5, 56448
    ds_read_b64_tr_b16 a[168:169], v61 offset:0
    v_add_u32 v31, -252, v32
    v_mfma_f32_16x16x32_bf16 v[84:87], v[204:207], v[140:143], v[84:87]
    s_waitcnt lgkmcnt(4)
    buffer_load_dwordx4 v9, s[8:11], s69 offen  lds
    v_mfma_f32_16x16x32_bf16 v[88:91], v[196:199], v[112:115], v[88:91]
    s_add_u32 s56, s44, 43200
    ds_read_b64_tr_b16 a[170:171], v61 offset:768
    v_and_b32 v31, 2.0, v31
    v_mfma_f32_16x16x32_bf16 v[92:95], v[200:203], v[112:115], v[92:95]
    s_cmp_eq_u32 s46, 0
    s_cselect_b32 s78, s78, s67
    ds_read_b64_tr_b16 a[172:173], v62 offset:0
    v_mfma_f32_16x16x32_bf16 v[96:99], v[204:207], v[112:115], v[96:99]
    s_waitcnt lgkmcnt(4)
    ds_read_b128 v[124:127], v17 offset:7040
    v_add3_u32 v31, v30, v31, s5
    v_mfma_f32_16x16x32_bf16 v[64:67], a[60:63], v[116:119], v[64:67]
    buffer_load_dwordx4 v10, s[8:11], s69 offen offset:1024  lds
    v_mfma_f32_16x16x32_bf16 v[68:71], a[64:67], v[116:119], v[68:71]
    ds_read_b64_tr_b16 a[174:175], v62 offset:768
    v_lshrrev_b32 v40, 3, v1
    v_mfma_f32_16x16x32_bf16 v[72:75], a[68:71], v[116:119], v[72:75]
    s_waitcnt lgkmcnt(4)
    ds_read_b64_tr_b16 a[176:177], v63 offset:0
    v_lshl_add_u32 v40, v40, 4, s4
    v_mfma_f32_16x16x32_bf16 v[76:79], a[60:63], v[120:123], v[76:79]
    ds_read_b64_tr_b16 a[178:179], v63 offset:768
    v_and_or_b32 v24, v1, 4, v40
    v_mfma_f32_16x16x32_bf16 v[80:83], a[64:67], v[120:123], v[80:83]
    buffer_load_dwordx4 v11, s[8:11], s69 offen offset:2048  lds
    v_mfma_f32_16x16x32_bf16 v[84:87], a[68:71], v[120:123], v[84:87]
    s_waitcnt lgkmcnt(3)
    ds_read_b64_tr_b16 v[208:209], v61 offset:9600
    v_lshl_add_u32 v25, v2, 4, s4
    v_mfma_f32_16x16x32_bf16 v[88:91], a[60:63], v[124:127], v[88:91]
    s_lshl_b32 s4, s57, 10
    ds_read_b64_tr_b16 v[210:211], v61 offset:10368
    v_lshrrev_b32 v41, 1, v1
    v_mfma_f32_16x16x32_bf16 v[92:95], a[64:67], v[124:127], v[92:95]
    ds_read_b64_tr_b16 v[212:213], v62 offset:9600
    v_and_or_b32 v41, v41, 8, 32
    v_mfma_f32_16x16x32_bf16 v[96:99], a[68:71], v[124:127], v[96:99]
    s_waitcnt lgkmcnt(3)
    buffer_load_dwordx4 v12, s[8:11], s69 offen offset:2432  lds
    v_mfma_f32_16x16x32_bf16 v[64:67], a[168:171], v[120:123], v[64:67]
    s_add_u32 m0, s24, 24576
    ds_read_b128 v[128:131], v17 offset:10496
    v_bitop3_b32 v26, v7, 48, v41 bitop3:0x6a
    v_mfma_f32_16x16x32_bf16 v[68:71], a[172:175], v[120:123], v[68:71]
    s_add_u32 s31, s28, 49152
    ds_read_b64_tr_b16 v[214:215], v62 offset:10368
    v_xor_b32 v27, 8, v26
    v_mfma_f32_16x16x32_bf16 v[72:75], a[176:179], v[120:123], v[72:75]
    ds_read_b64_tr_b16 v[216:217], v63 offset:9600
    v_lshrrev_b32 v52, 1, v4
    v_mfma_f32_16x16x32_bf16 v[76:79], a[168:171], v[124:127], v[76:79]
    ds_read_b64_tr_b16 v[218:219], v63 offset:10368
    v_lshl_or_b32 v21, v4, 1, v52
    v_mfma_f32_16x16x32_bf16 v[80:83], a[172:175], v[124:127], v[80:83]
    ds_read_b64_tr_b16 a[72:73], v13 offset:49152
    v_and_b32 v21, 48, v21
    v_mfma_f32_16x16x32_bf16 v[84:87], a[176:179], v[124:127], v[84:87]
    s_waitcnt lgkmcnt(4)
    ds_read_b64_tr_b16 a[74:75], v13 offset:49920
    v_lshl_add_u32 v21, s2, 7, v21
    v_mfma_f32_16x16x32_bf16 v[88:91], a[168:171], v[128:131], v[88:91]
    ds_read_b64_tr_b16 a[76:77], v14 offset:49152
    v_mad_u32_u24 v19, v2, s42, v21
    v_mfma_f32_16x16x32_bf16 v[92:95], a[172:175], v[128:131], v[92:95]
    ds_read_b128 v[132:135], v17 offset:13952
    v_lshl_add_u32 v53, s2, 2, v3
    v_mfma_f32_16x16x32_bf16 v[96:99], a[176:179], v[128:131], v[96:99]
    s_waitcnt lgkmcnt(4)
    ds_read_b64_tr_b16 a[78:79], v14 offset:49920
    v_lshrrev_b32 v52, 1, v2
    v_mfma_f32_16x16x32_bf16 v[64:67], v[208:211], v[124:127], v[64:67]
    ds_read_b64_tr_b16 a[80:81], v15 offset:49152
    v_bitop3_b32 v52, v52, 6, v53 bitop3:0x6a
    v_mfma_f32_16x16x32_bf16 v[68:71], v[212:215], v[124:127], v[68:71]
    ds_read_b64_tr_b16 a[82:83], v15 offset:49920
    v_lshl_add_u32 v52, v2, 3, v52
    v_mfma_f32_16x16x32_bf16 v[72:75], v[216:219], v[124:127], v[72:75]
    ds_read_b128 v[136:139], v18 offset:0
    v_lshl_add_u32 v38, v52, 3, s4
    v_mfma_f32_16x16x32_bf16 v[76:79], v[208:211], v[128:131], v[76:79]
    s_mul_i32 s4, s57, 129024
    ds_read_b64_tr_b16 a[180:181], v13 offset:55296
    s_add_u32 s56, s56, s4
    v_mfma_f32_16x16x32_bf16 v[80:83], v[212:215], v[128:131], v[80:83]
    s_add_u32 s4, s56, 43008
    ds_read_b128 v[140:143], v18 offset:3456
    s_add_u32 s5, s56, 86016
    v_mfma_f32_16x16x32_bf16 v[84:87], v[216:219], v[128:131], v[84:87]
    s_waitcnt lgkmcnt(5)
    ds_read_b64_tr_b16 a[182:183], v13 offset:56064
    ds_read_b64_tr_b16 a[184:185], v14 offset:55296
    v_mfma_f32_16x16x32_bf16 v[88:91], v[208:211], v[132:135], v[88:91]
    ds_read_b128 v[112:115], v18 offset:6912
    ds_read_b64_tr_b16 a[186:187], v14 offset:56064
    v_mfma_f32_16x16x32_bf16 v[92:95], v[212:215], v[132:135], v[92:95]
    ds_read_b64_tr_b16 a[188:189], v15 offset:55296
    v_and_or_b32 v30, v32, 2.0, v30
    v_mfma_f32_16x16x32_bf16 v[96:99], v[216:219], v[132:135], v[96:99]
    s_waitcnt vmcnt(10) lgkmcnt(7)
    s_barrier
    v_mfma_f32_16x16x32_bf16 v[64:67], a[72:75], v[136:139], v[64:67]
    ds_read_b64_tr_b16 a[190:191], v15 offset:56064
    v_lshlrev_b32 v146, 16, v145
    v_mfma_f32_16x16x32_bf16 v[68:71], a[76:79], v[136:139], v[68:71]
    ds_read_b64_tr_b16 v[220:221], v13 offset:0
    v_and_b32 v147, 0xffff0000, v145
    v_mfma_f32_16x16x32_bf16 v[72:75], a[80:83], v[136:139], v[72:75]
    s_waitcnt lgkmcnt(5)
    ds_read_b64_tr_b16 v[222:223], v13 offset:768
    v_ceil_f32 v149, v146
    v_mfma_f32_16x16x32_bf16 v[76:79], a[72:75], v[140:143], v[76:79]
    ds_read_b64_tr_b16 v[224:225], v14 offset:0
    v_ceil_f32 v151, v147
    v_mfma_f32_16x16x32_bf16 v[80:83], a[76:79], v[140:143], v[80:83]
    ds_read_b128 v[116:119], v18 offset:10368
    v_cvt_u32_f32 v148, v146
    v_mfma_f32_16x16x32_bf16 v[84:87], a[80:83], v[140:143], v[84:87]
    s_waitcnt lgkmcnt(5)
    ds_read_b64_tr_b16 v[226:227], v14 offset:768
    v_cvt_u32_f32 v150, v147
    v_mfma_f32_16x16x32_bf16 v[88:91], a[72:75], v[112:115], v[88:91]
    ds_read_b64_tr_b16 v[228:229], v15 offset:0
    ds_read_b64_tr_b16 v[230:231], v15 offset:768
    v_mfma_f32_16x16x32_bf16 v[92:95], a[76:79], v[112:115], v[92:95]
    ds_read_b64_tr_b16 a[84:85], v13 offset:6144
    v_cvt_u32_f32 v149, v149
    v_mfma_f32_16x16x32_bf16 v[96:99], a[80:83], v[112:115], v[96:99]
    s_waitcnt lgkmcnt(6)
    ds_read_b64_tr_b16 a[86:87], v13 offset:6912
    v_cvt_u32_f32 v151, v151
    v_mfma_f32_16x16x32_bf16 v[64:67], a[180:183], v[140:143], v[64:67]
    ds_read_b64_tr_b16 a[88:89], v14 offset:6144
    v_cndmask_b32 v164, v148, v149, s[80:81]
    v_mfma_f32_16x16x32_bf16 v[68:71], a[184:187], v[140:143], v[68:71]
    ds_read_b64_tr_b16 a[90:91], v14 offset:6912
    ds_read_b64_tr_b16 a[92:93], v15 offset:6144
    v_mfma_f32_16x16x32_bf16 v[72:75], a[188:191], v[140:143], v[72:75]
    ds_read_b64_tr_b16 a[94:95], v15 offset:6912
    ds_read_b64_tr_b16 a[192:193], v13 offset:12288
    v_mfma_f32_16x16x32_bf16 v[76:79], a[180:183], v[112:115], v[76:79]
    ds_read_b128 v[120:123], v18 offset:13824
    buffer_load_dwordx4 v5, s[16:19], s31 offen lds
    v_mfma_f32_16x16x32_bf16 v[80:83], a[184:187], v[112:115], v[80:83]
    ds_read_b64_tr_b16 a[194:195], v13 offset:13056
    ds_read_b64_tr_b16 a[196:197], v14 offset:12288
    v_mfma_f32_16x16x32_bf16 v[84:87], a[188:191], v[112:115], v[84:87]
    s_waitcnt lgkmcnt(8)
    ds_read_b64_tr_b16 a[198:199], v14 offset:13056
    v_cndmask_b32 v165, v149, v148, s[82:83]
    v_mfma_f32_16x16x32_bf16 v[88:91], a[180:183], v[116:119], v[88:91]
    ds_read_b128 v[124:127], v18 offset:64
    v_and_b32 v160, 4, v150
    v_mfma_f32_16x16x32_bf16 v[92:95], a[184:187], v[116:119], v[92:95]
    ds_read_b64_tr_b16 a[200:201], v15 offset:12288
    buffer_load_dwordx4 v6, s[16:19], s31 offen offset:1024 lds
    v_mfma_f32_16x16x32_bf16 v[96:99], a[188:191], v[116:119], v[96:99]
    ds_read_b64_tr_b16 a[202:203], v15 offset:13056
    v_lshl_add_u32 v160, v160, 3, s35
    v_mfma_f32_16x16x32_bf16 v[64:67], v[220:223], v[112:115], v[64:67]
    ds_read_b128 v[128:131], v18 offset:3520
    v_mad_u32_u24 v160, v150, s42, v160
    v_mfma_f32_16x16x32_bf16 v[68:71], v[224:227], v[112:115], v[68:71]
    ds_read_b64_tr_b16 v[232:233], v13 offset:18432
    v_mad_u32_u24 v164, v164, s34, v160
    v_mfma_f32_16x16x32_bf16 v[72:75], v[228:231], v[112:115], v[72:75]
L_pgY1:
  s_cbranch_execz L_retY
    ds_read_b64_tr_b16 v[234:235], v13 offset:19200
    buffer_load_dwordx4 v7, s[16:19], s31 offen offset:2048 lds
    v_mfma_f32_16x16x32_bf16 v[76:79], v[220:223], v[116:119], v[76:79]
    s_bitcmp1_b32 s73, 30
    s_cbranch_scc1 L_noj3
    s_mov_b32 m0, s72
    s_nop 0
    buffer_load_dwordx4 v50, s[8:11], s73 offen offset:2432  lds
    s_mov_b32 m0, s77
    s_nop 0
    buffer_load_dwordx4 v12, s[8:11], s78 offen offset:2432  lds
    s_mov_b32 m0, s70
    s_bitcmp1_b32 s39, 30
    s_cbranch_scc1 L_noj3
    buffer_load_dwordx4 v9, s[8:11], s71 offen  lds
    buffer_load_dwordx4 v10, s[8:11], s71 offen offset:1024  lds
    buffer_load_dwordx4 v11, s[8:11], s71 offen offset:2048  lds
L_noj3:
    v_mfma_f32_16x16x32_bf16 v[80:83], v[224:227], v[116:119], v[80:83]
    s_lshl_b32 s31, s2, 5
    ds_read_b128 v[132:135], v18 offset:6976
    v_xor_b32 v5, s31, v5
    v_mfma_f32_16x16x32_bf16 v[84:87], v[228:231], v[116:119], v[84:87]
    s_waitcnt lgkmcnt(4)
    ds_read_b64_tr_b16 v[236:237], v14 offset:18432
    v_and_b32 v160, 4, v151
    v_mfma_f32_16x16x32_bf16 v[88:91], v[220:223], v[120:123], v[88:91]
    s_lshr_b32 s31, s24, 1
    ds_read_b64_tr_b16 v[238:239], v14 offset:19200
    v_lshl_add_u32 v160, v160, 3, s35
    v_mfma_f32_16x16x32_bf16 v[92:95], v[224:227], v[120:123], v[92:95]
    s_add_u32 m0, s31, 36864
    ds_read_b64_tr_b16 v[240:241], v15 offset:18432
    v_mad_u32_u24 v160, v151, s42, v160
    v_mfma_f32_16x16x32_bf16 v[96:99], v[228:231], v[120:123], v[96:99]
    s_add_u32 s31, s31, 159744
    ds_read_b64_tr_b16 v[242:243], v15 offset:19200
    v_mad_u32_u24 v165, v165, s34, v160
    v_mfma_f32_16x16x32_bf16 v[64:67], a[84:87], v[124:127], v[64:67]
    ds_read_b128 v[52:55], v23 offset:1536
    buffer_load_dwordx4 v5, s[16:19], s31 offen lds
    v_mfma_f32_16x16x32_bf16 v[68:71], a[88:91], v[124:127], v[68:71]
    ds_read_b128 v[56:59], v23 offset:1552
    v_fract_f32 v152, v146
    v_mfma_f32_16x16x32_bf16 v[72:75], a[92:95], v[124:127], v[72:75]
    s_waitcnt lgkmcnt(5)
    ds_read_b32 v60, v23 offset:1568
    v_fract_f32 v153, v147
    v_mfma_f32_16x16x32_bf16 v[76:79], a[84:87], v[128:131], v[76:79]
    ds_read_b128 v[136:139], v18 offset:10432
    v_mul_f32 v159, v152, v153
    v_mfma_f32_16x16x32_bf16 v[80:83], a[88:91], v[128:131], v[80:83]
    buffer_load_dwordx4 v5, s[16:19], s31 offen offset:512 lds
    v_mfma_f32_16x16x32_bf16 v[84:87], a[92:95], v[128:131], v[84:87]
    v_add_f32 v155, v152, v153
    v_cndmask_b32 v152, 0, v152, s[98:99]
    v_mfma_f32_16x16x32_bf16 v[88:91], a[84:87], v[132:135], v[88:91]
    v_sub_f32 v155, v155, v159
    v_sub_f32 v158, v152, v159
    v_mfma_f32_16x16x32_bf16 v[92:95], a[88:91], v[132:135], v[92:95]
    v_sub_f32 v156, 1.0, v155
    v_sub_f32 v157, v155, v152
    v_mfma_f32_16x16x32_bf16 v[96:99], a[92:95], v[132:135], v[96:99]
    s_waitcnt lgkmcnt(1)
    buffer_load_dwordx4 v[180:183], v30, s[12:15], s55 offen
    v_mfma_f32_16x16x32_bf16 v[64:67], a[192:195], v[128:131], v[64:67]
    v_cvt_pk_bf16_f32 v167, v158, v159
    v_cvt_pk_bf16_f32 v166, v156, v157
    v_mfma_f32_16x16x32_bf16 v[68:71], a[196:199], v[128:131], v[68:71]
    v_cmp_gt_u32 vcc, s32, v148
    v_cmp_le_u32 s[84:85], s33, v149
    v_mfma_f32_16x16x32_bf16 v[72:75], a[200:203], v[128:131], v[72:75]
    v_cmp_le_u32 s[86:87], s36, v151
    v_xor_b32 v40, v52, v4
    v_mfma_f32_16x16x32_bf16 v[76:79], a[192:195], v[132:135], v[76:79]
    ds_read_b128 v[140:143], v18 offset:13888
    buffer_load_dwordx4 v[184:187], v31, s[12:15], s55 offen
    v_mfma_f32_16x16x32_bf16 v[80:83], a[196:199], v[132:135], v[80:83]
    s_or_b64 vcc, vcc, s[84:85]
    v_xor_b32 v41, v53, v4
    v_xor_b32 v42, v54, v4
    v_mfma_f32_16x16x32_bf16 v[84:87], a[200:203], v[132:135], v[84:87]
    s_waitcnt lgkmcnt(1)
    v_xor_b32 v43, v55, v4
    v_xor_b32 v44, v56, v4
    v_mfma_f32_16x16x32_bf16 v[88:91], a[192:195], v[136:139], v[88:91]
    ds_write_b64 v111, v[164:165]
    v_mfma_f32_16x16x32_bf16 v[92:95], a[196:199], v[136:139], v[92:95]
    ds_read2_b32 v[176:177], v24 offset0:0 offset1:32
    ds_read_b128 v[112:115], v18 offset:128
    v_mfma_f32_16x16x32_bf16 v[96:99], a[200:203], v[136:139], v[96:99]
    s_waitcnt vmcnt(4)
    s_barrier
    v_mfma_f32_16x16x32_bf16 v[64:67], v[232:235], v[132:135], v[64:67]
    ds_read_b64_tr_b16 a[96:97], v13 offset:24576
    ds_read_b64_tr_b16 a[98:99], v13 offset:25344
    ds_read_b64_tr_b16 a[100:101], v14 offset:24576
    v_mfma_f32_16x16x32_bf16 v[68:71], v[236:239], v[132:135], v[68:71]
    ds_read_b64_tr_b16 a[102:103], v14 offset:25344
    ds_read_b64_tr_b16 a[104:105], v15 offset:24576
    v_mfma_f32_16x16x32_bf16 v[72:75], v[240:243], v[132:135], v[72:75]
    ds_write_b64 v111, v[166:167] offset:8
    v_mfma_f32_16x16x32_bf16 v[76:79], v[232:235], v[136:139], v[76:79]
    ds_read_b64_tr_b16 a[106:107], v15 offset:25344
    ds_read_b64_tr_b16 a[204:205], v13 offset:30720
    v_mfma_f32_16x16x32_bf16 v[80:83], v[236:239], v[136:139], v[80:83]
    s_or_b64 vcc, vcc, s[86:87]
    s_cbranch_scc1 L_bfail2
L_bfail2_back:
    v_mfma_f32_16x16x32_bf16 v[84:87], v[240:243], v[136:139], v[84:87]
    s_waitcnt lgkmcnt(8)
    ds_read_b128 v[116:119], v18 offset:3584
    ds_read_b64_tr_b16 a[206:207], v13 offset:31488
    v_mfma_f32_16x16x32_bf16 v[88:91], v[232:235], v[140:143], v[88:91]
    ds_read_b64_tr_b16 a[208:209], v14 offset:30720
    ds_read_b128 v[120:123], v18 offset:7040
    v_mfma_f32_16x16x32_bf16 v[92:95], v[236:239], v[140:143], v[92:95]
    ds_read_b64_tr_b16 a[210:211], v14 offset:31488
    ds_read_b64 v[178:179], v25 offset:8
    v_mfma_f32_16x16x32_bf16 v[96:99], v[240:243], v[140:143], v[96:99]
    s_waitcnt vmcnt(2) lgkmcnt(7)
    s_barrier
    v_mfma_f32_16x16x32_bf16 v[64:67], a[96:99], v[112:115], v[64:67]
    ds_read_b64_tr_b16 a[212:213], v15 offset:30720
    ds_read_b64_tr_b16 a[214:215], v15 offset:31488
    v_xor_b32 v172, v176, v26
    v_mfma_f32_16x16x32_bf16 v[68:71], a[100:103], v[112:115], v[68:71]
    ds_read_b64_tr_b16 v[144:145], v172 offset:0
    ds_read_b64_tr_b16 v[244:245], v13 offset:36864
    v_xor_b32 v174, v177, v26
    v_mfma_f32_16x16x32_bf16 v[72:75], a[104:107], v[112:115], v[72:75]
    s_waitcnt lgkmcnt(8)
    ds_read_b64_tr_b16 v[146:147], v174 offset:0
    ds_read_b64_tr_b16 v[246:247], v13 offset:37632
    v_xor_b32 v173, v176, v27
    v_mfma_f32_16x16x32_bf16 v[76:79], a[96:99], v[116:119], v[76:79]
    ds_read_b64_tr_b16 v[148:149], v173 offset:0
    ds_read_b64_tr_b16 v[248:249], v14 offset:36864
    v_xor_b32 v175, v177, v27
    v_mfma_f32_16x16x32_bf16 v[80:83], a[100:103], v[116:119], v[80:83]
    ds_read_b64_tr_b16 v[150:151], v175 offset:0
    v_xor_b32 v45, v57, v4
    v_mfma_f32_16x16x32_bf16 v[84:87], a[104:107], v[116:119], v[84:87]
    s_waitcnt lgkmcnt(9)
    ds_read_b64_tr_b16 v[152:153], v172 offset:64
    v_cndmask_b32 v169, 0, v179, s[88:89]
    v_mfma_f32_16x16x32_bf16 v[88:91], a[96:99], v[120:123], v[88:91]
    ds_read_b64_tr_b16 v[154:155], v174 offset:64
    v_cndmask_b32 v171, 0, v179, s[92:93]
    v_mfma_f32_16x16x32_bf16 v[92:95], a[100:103], v[120:123], v[92:95]
    ds_read_b64_tr_b16 v[156:157], v173 offset:64
    v_cndmask_b32 v168, 0, v178, s[88:89]
    v_mfma_f32_16x16x32_bf16 v[96:99], a[104:107], v[120:123], v[96:99]
    s_waitcnt lgkmcnt(6)
    ds_read_b64_tr_b16 v[158:159], v175 offset:64
    v_cndmask_b32 v170, 0, v178, s[92:93]
    v_mfma_f32_16x16x32_bf16 v[64:67], a[204:207], v[116:119], v[64:67]
    ds_read_b64_tr_b16 v[160:161], v172 offset:128
    v_cndmask_b32 v169, v169, v178, s[90:91]
    v_cndmask_b32 v171, v171, v178, s[94:95]
    v_mfma_f32_16x16x32_bf16 v[68:71], a[208:211], v[116:119], v[68:71]
    ds_read_b64_tr_b16 v[162:163], v174 offset:128
    v_xor_b32 v46, v58, v4
    v_mfma_f32_16x16x32_bf16 v[72:75], a[212:215], v[116:119], v[72:75]
    s_waitcnt lgkmcnt(4)
    ds_read_b64_tr_b16 v[164:165], v173 offset:128
    v_xor_b32 v47, v59, v4
    v_mfma_f32_16x16x32_bf16 v[144:147], v[144:147], v[168:171], 0
    ds_read_b64_tr_b16 v[166:167], v175 offset:128
    v_xor_b32 v48, v60, v4
    v_mfma_f32_16x16x32_bf16 v[148:151], v[148:151], v[168:171], 0
    ds_read_b128 v[124:127], v18 offset:10496
    v_mad_u32_u24 v21, v2, s54, v21
    v_mfma_f32_16x16x32_bf16 v[152:155], v[152:155], v[168:171], 0
    ds_read_b64_tr_b16 v[250:251], v14 offset:37632
    v_lshlrev_b32 v39, 3, v0
    v_mfma_f32_16x16x32_bf16 v[76:79], a[204:207], v[120:123], v[76:79]
    ds_read_b64_tr_b16 v[252:253], v15 offset:36864
    v_cvt_pk_bf16_f32 v144, v144, v145
    v_cvt_pk_bf16_f32 v145, v146, v147
    v_mfma_f32_16x16x32_bf16 v[80:83], a[208:211], v[120:123], v[80:83]
    ds_write_b64 v28, v[144:145] offset:0
    v_mfma_f32_16x16x32_bf16 v[84:87], a[212:215], v[120:123], v[84:87]
    s_waitcnt lgkmcnt(4)
    ds_read_b64_tr_b16 v[254:255], v15 offset:37632
    v_cvt_pk_bf16_f32 v148, v148, v149
    v_cvt_pk_bf16_f32 v149, v150, v151
    v_mfma_f32_16x16x32_bf16 v[156:159], v[156:159], v[168:171], 0
    ds_write_b64 v29, v[148:149] offset:0
    v_mfma_f32_16x16x32_bf16 v[160:163], v[160:163], v[168:171], 0
    ds_read_b128 v[128:131], v18 offset:13952
    v_cvt_pk_bf16_f32 v152, v152, v153
    v_cvt_pk_bf16_f32 v153, v154, v155
    v_mfma_f32_16x16x32_bf16 v[164:167], v[164:167], v[168:171], 0
    s_waitcnt lgkmcnt(5)
    ds_write_b64 v28, v[152:153] offset:64
    v_mfma_f32_16x16x32_bf16 v[88:91], a[204:207], v[124:127], v[88:91]
    v_cvt_pk_bf16_f32 v156, v156, v157
    v_cvt_pk_bf16_f32 v157, v158, v159
    v_mfma_f32_16x16x32_bf16 v[92:95], a[208:211], v[124:127], v[92:95]
    ds_write_b64 v29, v[156:157] offset:64
    v_mfma_f32_16x16x32_bf16 v[96:99], a[212:215], v[124:127], v[96:99]
    s_waitcnt lgkmcnt(4)
    v_cvt_pk_bf16_f32 v160, v160, v161
    v_cvt_pk_bf16_f32 v161, v162, v163
    v_mfma_f32_16x16x32_bf16 v[64:67], v[244:247], v[120:123], v[64:67]
    ds_write_b64 v28, v[160:161] offset:128
    v_mfma_f32_16x16x32_bf16 v[68:71], v[248:251], v[120:123], v[68:71]
    v_cvt_pk_bf16_f32 v164, v164, v165
    v_cvt_pk_bf16_f32 v165, v166, v167
    v_mfma_f32_16x16x32_bf16 v[72:75], v[252:255], v[120:123], v[72:75]
    ds_write_b64 v29, v[164:165] offset:128
    v_mfma_f32_16x16x32_bf16 v[76:79], v[244:247], v[124:127], v[76:79]
    s_cmp_gt_u32 s62, 16
    s_cbranch_scc1 L_more
L_more_back:
    v_mfma_f32_16x16x32_bf16 v[80:83], v[248:251], v[124:127], v[80:83]
    v_lshrrev_b32 v22, 1, v0
    v_bitop3_b32 v22, v22, 48, v39 bitop3:0x6a
    v_mfma_f32_16x16x32_bf16 v[84:87], v[252:255], v[124:127], v[84:87]
    s_waitcnt lgkmcnt(0)
    s_barrier
    ds_read_b128 v[132:135], v40 offset:0
    v_mfma_f32_16x16x32_bf16 v[88:91], v[244:247], v[128:131], v[88:91]
    ds_read_b128 v[136:139], v40 offset:64
    v_bfe_u32 v37, v0, 3, 4
    v_mfma_f32_16x16x32_bf16 v[92:95], v[248:251], v[128:131], v[92:95]
    ds_read_b128 v[140:143], v40 offset:128
    v_and_or_b32 v22, v22, 56, 64
    v_mfma_f32_16x16x32_bf16 v[96:99], v[252:255], v[128:131], v[96:99]
    s_waitcnt lgkmcnt(2)
    ds_read_b128 v[112:115], v41 offset:0
    v_mad_u32_u24 v20, v37, s42, v22
    v_mfma_f32_16x16x32_bf16 v[100:103], a[0:3], v[132:135], 0
    ds_read_b128 v[116:119], v41 offset:64
    v_cvt_pk_bf16_f32 v64, v64, v65
    v_mfma_f32_16x16x32_bf16 v[104:107], a[4:7], v[132:135], 0
    ds_read_b128 v[52:55], v23 offset:768
    v_cvt_pk_bf16_f32 v65, v66, v67
    v_mfma_f32_16x16x32_bf16 v[108:111], a[8:11], v[132:135], 0
    s_waitcnt lgkmcnt(4)
    ds_read_b128 v[56:59], v23 offset:784
    v_cvt_pk_bf16_f32 v66, v68, v69
    v_mfma_f32_16x16x32_bf16 v[100:103], a[12:15], v[136:139], v[100:103]
    ds_read_b128 v[120:123], v41 offset:128
    v_cvt_pk_bf16_f32 v67, v70, v71
    v_mfma_f32_16x16x32_bf16 v[104:107], a[16:19], v[136:139], v[104:107]
    v_permlane16_swap_b32 v64, v66
    v_mfma_f32_16x16x32_bf16 v[108:111], a[20:23], v[136:139], v[108:111]
    s_waitcnt lgkmcnt(4)
    v_permlane16_swap_b32 v65, v67
    v_mfma_f32_16x16x32_bf16 v[100:103], a[24:27], v[140:143], v[100:103]
    ds_read_b128 v[124:127], v42 offset:0
    v_cvt_pk_bf16_f32 v72, v72, v73
    v_mfma_f32_16x16x32_bf16 v[104:107], a[28:31], v[140:143], v[104:107]
    buffer_store_dwordx4 v[64:67], v19, s[20:23], s56 offen sc1
    v_cvt_pk_bf16_f32 v73, v74, v75
    v_mad_u32_u24 v22, v37, s54, v22
    v_cvt_pk_bf16_f32 v84, v84, v85
    v_mfma_f32_16x16x32_bf16 v[108:111], a[32:35], v[140:143], v[108:111]
    s_waitcnt lgkmcnt(2)
    ds_write_b64 v38, v[72:73] offset:49152
    v_mfma_f32_16x16x32_bf16 v[100:103], a[36:39], v[112:115], v[100:103]
    ds_read_b128 v[128:131], v42 offset:64
    v_mfma_f32_16x16x32_bf16 v[104:107], a[40:43], v[112:115], v[104:107]
    ds_read_b32 v60, v23 offset:800
    v_xor_b32 v40, v52, v4
    v_mfma_f32_16x16x32_bf16 v[108:111], a[44:47], v[112:115], v[108:111]
    ds_read2_b32 v[176:177], v24 offset0:64 offset1:96
    v_xor_b32 v41, v53, v4
    v_mfma_f32_16x16x32_bf16 v[100:103], a[48:51], v[116:119], v[100:103]
    ds_read_b128 v[132:135], v42 offset:128
    v_xor_b32 v42, v54, v4
    v_mfma_f32_16x16x32_bf16 v[104:107], a[52:55], v[116:119], v[104:107]
    ds_read_b64 v[178:179], v25 offset:264
    v_cvt_pk_bf16_f32 v85, v86, v87
    v_mfma_f32_16x16x32_bf16 v[108:111], a[56:59], v[116:119], v[108:111]
    s_waitcnt lgkmcnt(5)
    ds_write_b64 v38, v[84:85] offset:51200
    v_mfma_f32_16x16x32_bf16 v[100:103], a[60:63], v[120:123], v[100:103]
    ds_read_b128 v[136:139], v43 offset:0
    v_mfma_f32_16x16x32_bf16 v[104:107], a[64:67], v[120:123], v[104:107]
    v_cvt_pk_bf16_f32 v96, v96, v97
    v_cvt_pk_bf16_f32 v97, v98, v99
    v_mfma_f32_16x16x32_bf16 v[108:111], a[68:71], v[120:123], v[108:111]
    s_waitcnt lgkmcnt(4)
    ds_write_b64 v38, v[96:97] offset:53248
    v_mfma_f32_16x16x32_bf16 v[100:103], a[72:75], v[124:127], v[100:103]
    ds_read_b128 v[140:143], v43 offset:64
    v_mfma_f32_16x16x32_bf16 v[104:107], a[76:79], v[124:127], v[104:107]
    v_xor_b32 v172, v176, v26
    v_xor_b32 v174, v177, v26
    v_mfma_f32_16x16x32_bf16 v[108:111], a[80:83], v[124:127], v[108:111]
    s_waitcnt lgkmcnt(3)
    v_xor_b32 v173, v176, v27
    v_xor_b32 v175, v177, v27
    v_mfma_f32_16x16x32_bf16 v[100:103], a[84:87], v[128:131], v[100:103]
    ds_read_b128 v[112:115], v43 offset:128
    v_cndmask_b32 v169, 0, v179, s[88:89]
    v_mfma_f32_16x16x32_bf16 v[104:107], a[88:91], v[128:131], v[104:107]
    v_cndmask_b32 v171, 0, v179, s[92:93]
    v_cndmask_b32 v168, 0, v178, s[88:89]
    v_mfma_f32_16x16x32_bf16 v[108:111], a[92:95], v[128:131], v[108:111]
    v_cndmask_b32 v170, 0, v178, s[92:93]
    v_cndmask_b32 v169, v169, v178, s[90:91]
    v_mfma_f32_16x16x32_bf16 v[100:103], a[96:99], v[132:135], v[100:103]
    ds_read_b128 v[116:119], v44 offset:0
    v_cndmask_b32 v171, v171, v178, s[94:95]
    v_mfma_f32_16x16x32_bf16 v[104:107], a[100:103], v[132:135], v[104:107]
    v_xor_b32 v43, v55, v4
    v_cvt_pk_bf16_f32 v76, v76, v77
    v_mfma_f32_16x16x32_bf16 v[108:111], a[104:107], v[132:135], v[108:111]
    s_waitcnt lgkmcnt(2)
    v_cvt_pk_bf16_f32 v77, v78, v79
    v_cvt_pk_bf16_f32 v78, v80, v81
    v_mfma_f32_16x16x32_bf16 v[100:103], a[108:111], v[136:139], v[100:103]
    ds_read_b128 v[120:123], v44 offset:64
    v_cvt_pk_bf16_f32 v79, v82, v83
    v_mfma_f32_16x16x32_bf16 v[104:107], a[112:115], v[136:139], v[104:107]
    v_permlane16_swap_b32 v76, v78
    v_mfma_f32_16x16x32_bf16 v[108:111], a[116:119], v[136:139], v[108:111]
    v_permlane16_swap_b32 v77, v79
    v_mfma_f32_16x16x32_bf16 v[100:103], a[120:123], v[140:143], v[100:103]
    ds_read_b128 v[124:127], v44 offset:128
    v_xor_b32 v44, v56, v4
    v_mfma_f32_16x16x32_bf16 v[104:107], a[124:127], v[140:143], v[104:107]
    ds_read_b64_tr_b16 v[144:145], v172 offset:0
    v_cvt_pk_bf16_f32 v88, v88, v89
    v_mfma_f32_16x16x32_bf16 v[108:111], a[128:131], v[140:143], v[108:111]
    s_waitcnt lgkmcnt(3)
    ds_read_b64_tr_b16 v[146:147], v174 offset:0
    v_cvt_pk_bf16_f32 v89, v90, v91
    v_mfma_f32_16x16x32_bf16 v[100:103], a[132:135], v[112:115], v[100:103]
    ds_read_b64_tr_b16 v[148:149], v173 offset:0
    v_cvt_pk_bf16_f32 v90, v92, v93
    v_mfma_f32_16x16x32_bf16 v[104:107], a[136:139], v[112:115], v[104:107]
    ds_read_b128 v[128:131], v45 offset:0
    v_cvt_pk_bf16_f32 v91, v94, v95
    v_mfma_f32_16x16x32_bf16 v[108:111], a[140:143], v[112:115], v[108:111]
    ds_read_b64_tr_b16 v[150:151], v175 offset:0
    v_mfma_f32_16x16x32_bf16 v[100:103], a[144:147], v[116:119], v[100:103]
    ds_read_b64_tr_b16 v[152:153], v172 offset:64
    v_mfma_f32_16x16x32_bf16 v[104:107], a[148:151], v[116:119], v[104:107]
    ds_read_b64_tr_b16 v[154:155], v174 offset:64
    v_mfma_f32_16x16x32_bf16 v[108:111], a[152:155], v[116:119], v[108:111]
    s_waitcnt lgkmcnt(5)
    ds_read_b128 v[132:135], v45 offset:64
    v_mfma_f32_16x16x32_bf16 v[100:103], a[156:159], v[120:123], v[100:103]
    ds_read_b64_tr_b16 v[156:157], v173 offset:64
    v_mfma_f32_16x16x32_bf16 v[104:107], a[160:163], v[120:123], v[104:107]
    ds_read_b64_tr_b16 v[158:159], v175 offset:64
    v_mfma_f32_16x16x32_bf16 v[108:111], a[164:167], v[120:123], v[108:111]
    ds_read_b64_tr_b16 v[160:161], v172 offset:128
    v_mfma_f32_16x16x32_bf16 v[100:103], a[168:171], v[124:127], v[100:103]
    ds_read_b64_tr_b16 v[162:163], v174 offset:128
    v_mfma_f32_16x16x32_bf16 v[104:107], a[172:175], v[124:127], v[104:107]
    ds_read_b64_tr_b16 v[164:165], v173 offset:128
    v_mfma_f32_16x16x32_bf16 v[108:111], a[176:179], v[124:127], v[108:111]
    s_waitcnt lgkmcnt(5)
    ds_read_b64_tr_b16 v[166:167], v175 offset:128
    v_mfma_f32_16x16x32_bf16 v[100:103], a[180:183], v[128:131], v[100:103]
    ds_read_b128 v[136:139], v45 offset:128
    v_xor_b32 v45, v57, v4
    v_mfma_f32_16x16x32_bf16 v[104:107], a[184:187], v[128:131], v[104:107]
    buffer_store_dwordx4 v[76:79], v19, s[20:23], s4 offen sc1
    v_mfma_f32_16x16x32_bf16 v[108:111], a[188:191], v[128:131], v[108:111]
    v_permlane16_swap_b32 v88, v90
    v_mfma_f32_16x16x32_bf16 v[100:103], a[192:195], v[132:135], v[100:103]
    ds_read_b128 v[140:143], v46 offset:0
    v_mfma_f32_16x16x32_bf16 v[104:107], a[196:199], v[132:135], v[104:107]
    v_permlane16_swap_b32 v89, v91
    v_mfma_f32_16x16x32_bf16 v[108:111], a[200:203], v[132:135], v[108:111]
    buffer_store_dwordx4 v[88:91], v19, s[20:23], s5 offen sc1
    v_mfma_f32_16x16x32_bf16 v[144:147], v[144:147], v[168:171], 0
    ds_read_b128 v[112:115], v46 offset:64
    v_mfma_f32_16x16x32_bf16 v[148:151], v[148:151], v[168:171], 0
    v_mfma_f32_16x16x32_bf16 v[152:155], v[152:155], v[168:171], 0
    s_waitcnt lgkmcnt(2)
    v_mfma_f32_16x16x32_bf16 v[156:159], v[156:159], v[168:171], 0
    ds_read_b128 v[116:119], v46 offset:128
    v_xor_b32 v46, v58, v4
    v_mfma_f32_16x16x32_bf16 v[160:163], v[160:163], v[168:171], 0
    v_cvt_pk_bf16_f32 v144, v144, v145
    v_cvt_pk_bf16_f32 v145, v146, v147
    v_mfma_f32_16x16x32_bf16 v[164:167], v[164:167], v[168:171], 0
    ds_write_b64 v28, v[144:145] offset:12288
    v_mfma_f32_16x16x32_bf16 v[100:103], a[204:207], v[136:139], v[100:103]
    ds_read_b128 v[120:123], v47 offset:0
    v_mfma_f32_16x16x32_bf16 v[104:107], a[208:211], v[136:139], v[104:107]
    v_cvt_pk_bf16_f32 v148, v148, v149
    v_cvt_pk_bf16_f32 v149, v150, v151
    v_mfma_f32_16x16x32_bf16 v[108:111], a[212:215], v[136:139], v[108:111]
    s_waitcnt lgkmcnt(3)
    ds_write_b64 v29, v[148:149] offset:12288
    v_mfma_f32_16x16x32_bf16 v[100:103], a[216:219], v[140:143], v[100:103]
    ds_read_b128 v[124:127], v47 offset:64
    v_mfma_f32_16x16x32_bf16 v[104:107], a[220:223], v[140:143], v[104:107]
    v_cvt_pk_bf16_f32 v152, v152, v153
    v_cvt_pk_bf16_f32 v153, v154, v155
    v_mfma_f32_16x16x32_bf16 v[108:111], a[224:227], v[140:143], v[108:111]
    ds_read2_b32 v[176:177], v24 offset0:128 offset1:160
    v_cvt_pk_bf16_f32 v156, v156, v157
    v_mfma_f32_16x16x32_bf16 v[100:103], a[228:231], v[112:115], v[100:103]
    ds_read_b128 v[128:131], v47 offset:128
    v_cvt_pk_bf16_f32 v157, v158, v159
    v_mfma_f32_16x16x32_bf16 v[104:107], a[232:235], v[112:115], v[104:107]
    ds_write_b64 v28, v[152:153] offset:12352
    v_mfma_f32_16x16x32_bf16 v[108:111], a[236:239], v[112:115], v[108:111]
    s_waitcnt lgkmcnt(4)
    ds_read_b64 v[178:179], v25 offset:520
    v_mfma_f32_16x16x32_bf16 v[100:103], a[240:243], v[116:119], v[100:103]
    ds_read_b128 v[132:135], v48 offset:0
    v_cvt_pk_bf16_f32 v160, v160, v161
    v_mfma_f32_16x16x32_bf16 v[104:107], a[244:247], v[116:119], v[104:107]
    ds_write_b64 v29, v[156:157] offset:12352
    v_mfma_f32_16x16x32_bf16 v[108:111], a[248:251], v[116:119], v[108:111]
    s_waitcnt lgkmcnt(5)
    v_xor_b32 v172, v176, v26
    v_xor_b32 v174, v177, v26
    v_mfma_f32_16x16x32_bf16 v[100:103], a[252:255], v[120:123], v[100:103]
    ds_read_b128 v[136:139], v48 offset:64
    v_xor_b32 v173, v176, v27
    v_mfma_f32_16x16x32_bf16 v[104:107], v[188:191], v[120:123], v[104:107]
    v_xor_b32 v175, v177, v27
    v_cvt_pk_bf16_f32 v161, v162, v163
    v_mfma_f32_16x16x32_bf16 v[108:111], v[192:195], v[120:123], v[108:111]
    s_waitcnt lgkmcnt(3)
    ds_write_b64 v28, v[160:161] offset:12416
    v_mfma_f32_16x16x32_bf16 v[100:103], v[196:199], v[124:127], v[100:103]
    ds_read_b128 v[140:143], v48 offset:128
    v_mfma_f32_16x16x32_bf16 v[104:107], v[200:203], v[124:127], v[104:107]
    v_cvt_pk_bf16_f32 v164, v164, v165
    v_cvt_pk_bf16_f32 v165, v166, v167
    v_mfma_f32_16x16x32_bf16 v[108:111], v[204:207], v[124:127], v[108:111]
    ds_write_b64 v29, v[164:165] offset:12416
    v_mfma_f32_16x16x32_bf16 v[100:103], v[208:211], v[128:131], v[100:103]
    ds_read_b128 v[112:115], v40 offset:0
    v_mfma_f32_16x16x32_bf16 v[104:107], v[212:215], v[128:131], v[104:107]
    v_cndmask_b32 v169, 0, v179, s[88:89]
    v_cndmask_b32 v171, 0, v179, s[92:93]
    v_mfma_f32_16x16x32_bf16 v[108:111], v[216:219], v[128:131], v[108:111]
    s_waitcnt lgkmcnt(3)
    v_cndmask_b32 v168, 0, v178, s[88:89]
    v_cndmask_b32 v170, 0, v178, s[92:93]
    v_mfma_f32_16x16x32_bf16 v[100:103], v[220:223], v[132:135], v[100:103]
    ds_read_b128 v[116:119], v40 offset:64
    v_cndmask_b32 v169, v169, v178, s[90:91]
    v_mfma_f32_16x16x32_bf16 v[104:107], v[224:227], v[132:135], v[104:107]
    v_cndmask_b32 v171, v171, v178, s[94:95]
    v_xor_b32 v47, v59, v4
    v_mfma_f32_16x16x32_bf16 v[108:111], v[228:231], v[132:135], v[108:111]
    v_xor_b32 v48, v60, v4
    v_mfma_f32_16x16x32_bf16 v[100:103], v[232:235], v[136:139], v[100:103]
    ds_read_b128 v[120:123], v40 offset:128
    v_mfma_f32_16x16x32_bf16 v[104:107], v[236:239], v[136:139], v[104:107]
    ds_read_b64_tr_b16 v[144:145], v172 offset:0
    v_mfma_f32_16x16x32_bf16 v[108:111], v[240:243], v[136:139], v[108:111]
    s_waitcnt lgkmcnt(3)
    ds_read_b64_tr_b16 v[146:147], v174 offset:0
    v_mfma_f32_16x16x32_bf16 v[100:103], v[244:247], v[140:143], v[100:103]
    ds_read_b64_tr_b16 v[148:149], v173 offset:0
    v_mfma_f32_16x16x32_bf16 v[104:107], v[248:251], v[140:143], v[104:107]
    ds_read_b128 v[124:127], v41 offset:0
    v_mfma_f32_16x16x32_bf16 v[108:111], v[252:255], v[140:143], v[108:111]
    s_waitcnt vmcnt(3) lgkmcnt(5)
    ds_read_b64_tr_b16 v[150:151], v175 offset:0
    v_mfma_f32_16x16x32_bf16 v[64:67], a[0:3], v[112:115], 0
    ds_read_b64_tr_b16 v[152:153], v172 offset:64
    v_and_b32 v180, s96, v180
    v_mfma_f32_16x16x32_bf16 v[68:71], a[4:7], v[112:115], 0
    ds_read_b64_tr_b16 v[154:155], v174 offset:64
    v_and_b32 v181, s96, v181
    v_mfma_f32_16x16x32_bf16 v[72:75], a[8:11], v[112:115], 0
    ds_read_b128 v[128:131], v41 offset:64
    v_cvt_pk_bf16_f32 v108, v108, v109
    v_mfma_f32_16x16x32_bf16 v[64:67], a[12:15], v[116:119], v[64:67]
    ds_read_b64_tr_b16 v[156:157], v173 offset:64
    v_cvt_pk_bf16_f32 v109, v110, v111
    v_mfma_f32_16x16x32_bf16 v[68:71], a[16:19], v[116:119], v[68:71]
    ds_read_b64_tr_b16 v[158:159], v175 offset:64
    v_and_b32 v182, s96, v182
    v_mfma_f32_16x16x32_bf16 v[72:75], a[20:23], v[116:119], v[72:75]
    s_waitcnt lgkmcnt(5)
    ds_read_b64_tr_b16 v[160:161], v172 offset:128
    v_and_b32 v183, s96, v183
    v_mfma_f32_16x16x32_bf16 v[64:67], a[24:27], v[120:123], v[64:67]
    ds_read_b64_tr_b16 v[162:163], v174 offset:128
    v_pk_max_u16 v180, v180, v181
    v_mfma_f32_16x16x32_bf16 v[68:71], a[28:31], v[120:123], v[68:71]
    ds_read_b64_tr_b16 v[164:165], v173 offset:128
    v_pk_max_u16 v182, v182, v183
    v_mfma_f32_16x16x32_bf16 v[72:75], a[32:35], v[120:123], v[72:75]
    ds_read_b64_tr_b16 v[166:167], v175 offset:128
    v_pk_max_u16 v180, v180, s37
    v_mfma_f32_16x16x32_bf16 v[64:67], a[36:39], v[124:127], v[64:67]
    ds_read_b128 v[132:135], v41 offset:128
    v_pk_max_u16 v180, v180, v182
    v_mfma_f32_16x16x32_bf16 v[68:71], a[40:43], v[124:127], v[68:71]
    ds_read_b128 v[52:55], v23 offset:0
    v_cmp_ne_u32 s[80:81], s37, v180
    v_mfma_f32_16x16x32_bf16 v[72:75], a[44:47], v[124:127], v[72:75]
    s_waitcnt lgkmcnt(5)
    ds_read2_b32 v[176:177], v24 offset0:192 offset1:224
    v_and_b32 v184, s96, v184
    v_mfma_f32_16x16x32_bf16 v[64:67], a[48:51], v[128:131], v[64:67]
    ds_read_b128 v[136:139], v42 offset:0
    v_and_b32 v185, s96, v185
    v_mfma_f32_16x16x32_bf16 v[68:71], a[52:55], v[128:131], v[68:71]
    ds_read_b64 v[178:179], v25 offset:776
    v_and_b32 v186, s96, v186
    v_mfma_f32_16x16x32_bf16 v[72:75], a[56:59], v[128:131], v[72:75]
    ds_write_b64 v38, v[108:109] offset:55296
    v_mfma_f32_16x16x32_bf16 v[144:147], v[144:147], v[168:171], 0
    ds_read_b128 v[140:143], v42 offset:64
    v_mfma_f32_16x16x32_bf16 v[148:151], v[148:151], v[168:171], 0
    ds_read_b128 v[56:59], v23 offset:16
    v_and_b32 v187, s96, v187
    v_mfma_f32_16x16x32_bf16 v[152:155], v[152:155], v[168:171], 0
    s_waitcnt lgkmcnt(5)
    ds_read_b32 v60, v23 offset:32
    v_xor_b32 v172, v176, v26
    v_mfma_f32_16x16x32_bf16 v[156:159], v[156:159], v[168:171], 0
    ds_read_b128 v[112:115], v42 offset:128
    v_cvt_pk_bf16_f32 v144, v144, v145
    v_mfma_f32_16x16x32_bf16 v[160:163], v[160:163], v[168:171], 0
    v_cvt_pk_bf16_f32 v145, v146, v147
    v_cvt_pk_bf16_f32 v148, v148, v149
    v_mfma_f32_16x16x32_bf16 v[164:167], v[164:167], v[168:171], 0
    s_waitcnt lgkmcnt(4)
    ds_write_b64 v28, v[144:145] offset:24576
    v_mfma_f32_16x16x32_bf16 v[64:67], a[60:63], v[132:135], v[64:67]
    ds_read_b128 v[116:119], v43 offset:0
    v_mfma_f32_16x16x32_bf16 v[68:71], a[64:67], v[132:135], v[68:71]
    v_cvt_pk_bf16_f32 v149, v150, v151
    v_xor_b32 v174, v177, v26
    v_mfma_f32_16x16x32_bf16 v[72:75], a[68:71], v[132:135], v[72:75]
    s_waitcnt lgkmcnt(3)
    ds_write_b64 v29, v[148:149] offset:24576
    v_mfma_f32_16x16x32_bf16 v[64:67], a[72:75], v[136:139], v[64:67]
    ds_read_b128 v[120:123], v43 offset:64
    v_mfma_f32_16x16x32_bf16 v[68:71], a[76:79], v[136:139], v[68:71]
    v_xor_b32 v173, v176, v27
    v_cvt_pk_bf16_f32 v152, v152, v153
    v_mfma_f32_16x16x32_bf16 v[72:75], a[80:83], v[136:139], v[72:75]
    v_cvt_pk_bf16_f32 v153, v154, v155
    v_xor_b32 v175, v177, v27
    v_mfma_f32_16x16x32_bf16 v[64:67], a[84:87], v[140:143], v[64:67]
    ds_read_b128 v[124:127], v43 offset:128
    v_cvt_pk_bf16_f32 v156, v156, v157
    v_mfma_f32_16x16x32_bf16 v[68:71], a[88:91], v[140:143], v[68:71]
    ds_write_b64 v28, v[152:153] offset:24640
    v_mfma_f32_16x16x32_bf16 v[72:75], a[92:95], v[140:143], v[72:75]
    s_waitcnt lgkmcnt(3)
    v_cvt_pk_bf16_f32 v157, v158, v159
    v_cvt_pk_bf16_f32 v160, v160, v161
    v_mfma_f32_16x16x32_bf16 v[64:67], a[96:99], v[112:115], v[64:67]
    ds_read_b128 v[128:131], v44 offset:0
    v_cvt_pk_bf16_f32 v161, v162, v163
    v_mfma_f32_16x16x32_bf16 v[68:71], a[100:103], v[112:115], v[68:71]
    ds_read_b64_tr_b16 v[144:145], v172 offset:0
    v_cvt_pk_bf16_f32 v164, v164, v165
    v_mfma_f32_16x16x32_bf16 v[72:75], a[104:107], v[112:115], v[72:75]
    ds_read_b64_tr_b16 v[146:147], v174 offset:0
    v_cvt_pk_bf16_f32 v165, v166, v167
    v_mfma_f32_16x16x32_bf16 v[64:67], a[108:111], v[116:119], v[64:67]
    ds_read_b64_tr_b16 v[148:149], v173 offset:0
    v_cndmask_b32 v169, 0, v179, s[88:89]
    v_mfma_f32_16x16x32_bf16 v[68:71], a[112:115], v[116:119], v[68:71]
    ds_read_b128 v[132:135], v44 offset:64
    v_cndmask_b32 v171, 0, v179, s[92:93]
    v_mfma_f32_16x16x32_bf16 v[72:75], a[116:119], v[116:119], v[72:75]
    s_waitcnt lgkmcnt(5)
    ds_read_b64_tr_b16 v[150:151], v175 offset:0
    v_cndmask_b32 v168, 0, v178, s[88:89]
    v_mfma_f32_16x16x32_bf16 v[64:67], a[120:123], v[120:123], v[64:67]
L_pgY2:
  s_cbranch_execz L_retY
    ds_read_b64_tr_b16 v[152:153], v172 offset:64
    v_cndmask_b32 v170, 0, v178, s[92:93]
    v_mfma_f32_16x16x32_bf16 v[68:71], a[124:127], v[120:123], v[68:71]
    ds_read_b64_tr_b16 v[154:155], v174 offset:64
    v_cndmask_b32 v169, v169, v178, s[90:91]
    v_mfma_f32_16x16x32_bf16 v[72:75], a[128:131], v[120:123], v[72:75]
    ds_write_b64 v29, v[156:157] offset:24640
    v_mfma_f32_16x16x32_bf16 v[64:67], a[132:135], v[124:127], v[64:67]
    ds_read_b128 v[136:139], v44 offset:128
    v_mfma_f32_16x16x32_bf16 v[68:71], a[136:139], v[124:127], v[68:71]
    ds_read_b64_tr_b16 v[156:157], v173 offset:64
    v_cndmask_b32 v171, v171, v178, s[94:95]
    v_mfma_f32_16x16x32_bf16 v[72:75], a[140:143], v[124:127], v[72:75]
    s_waitcnt lgkmcnt(5)
    ds_read_b64_tr_b16 v[158:159], v175 offset:64
    v_pk_max_u16 v184, v184, v185
    v_mfma_f32_16x16x32_bf16 v[64:67], a[144:147], v[128:131], v[64:67]
    ds_write_b64 v28, v[160:161] offset:24704
    v_mfma_f32_16x16x32_bf16 v[68:71], a[148:151], v[128:131], v[68:71]
    ds_read_b64_tr_b16 v[160:161], v172 offset:128
    v_mfma_f32_16x16x32_bf16 v[72:75], a[152:155], v[128:131], v[72:75]
    ds_read_b64_tr_b16 v[162:163], v174 offset:128
    v_pk_max_u16 v186, v186, v187
    v_mfma_f32_16x16x32_bf16 v[64:67], a[156:159], v[132:135], v[64:67]
    ds_write_b64 v29, v[164:165] offset:24704
    v_mfma_f32_16x16x32_bf16 v[68:71], a[160:163], v[132:135], v[68:71]
    ds_read_b64_tr_b16 v[164:165], v173 offset:128
    v_mfma_f32_16x16x32_bf16 v[72:75], a[164:167], v[132:135], v[72:75]
    s_waitcnt lgkmcnt(5)
    ds_read_b64_tr_b16 v[166:167], v175 offset:128
    v_pk_max_u16 v184, v184, s37
    v_mfma_f32_16x16x32_bf16 v[64:67], a[168:171], v[136:139], v[64:67]
    ds_read_b128 v[140:143], v45 offset:0
    v_pk_max_u16 v184, v184, v186
    v_mfma_f32_16x16x32_bf16 v[68:71], a[172:175], v[136:139], v[68:71]
    ds_read_b128 v[112:115], v45 offset:64
    v_cmp_ne_u32 s[82:83], s37, v184
    v_mfma_f32_16x16x32_bf16 v[72:75], a[176:179], v[136:139], v[72:75]
    v_xor_b32 v40, v52, v4
    v_xor_b32 v41, v53, v4
    v_mfma_f32_16x16x32_bf16 v[144:147], v[144:147], v[168:171], 0
    ds_read_b128 v[116:119], v45 offset:128
    v_xor_b32 v42, v54, v4
    v_mfma_f32_16x16x32_bf16 v[148:151], v[148:151], v[168:171], 0
    s_or_b64 vcc, s[80:81], s[82:83]
    s_cbranch_scc1 L_afailY
L_afailY_back:
    v_mfma_f32_16x16x32_bf16 v[152:155], v[152:155], v[168:171], 0
    s_waitcnt lgkmcnt(3)
    v_xor_b32 v43, v55, v4
    v_cvt_pk_bf16_f32 v144, v144, v145
    v_mfma_f32_16x16x32_bf16 v[156:159], v[156:159], v[168:171], 0
    ds_read_b128 v[120:123], v46 offset:0
    v_cvt_pk_bf16_f32 v145, v146, v147
    v_mfma_f32_16x16x32_bf16 v[160:163], v[160:163], v[168:171], 0
    ds_write_b64 v28, v[144:145] offset:36864
    v_mfma_f32_16x16x32_bf16 v[164:167], v[164:167], v[168:171], 0
    s_waitcnt lgkmcnt(3)
    v_cvt_pk_bf16_f32 v148, v148, v149
    v_cvt_pk_bf16_f32 v149, v150, v151
    v_mfma_f32_16x16x32_bf16 v[64:67], a[180:183], v[140:143], v[64:67]
    ds_read_b128 v[124:127], v46 offset:64
    v_cvt_pk_bf16_f32 v152, v152, v153
    v_mfma_f32_16x16x32_bf16 v[68:71], a[184:187], v[140:143], v[68:71]
    ds_write_b64 v29, v[148:149] offset:36864
    v_mfma_f32_16x16x32_bf16 v[72:75], a[188:191], v[140:143], v[72:75]
    v_cvt_pk_bf16_f32 v153, v154, v155
    v_cvt_pk_bf16_f32 v156, v156, v157
    v_mfma_f32_16x16x32_bf16 v[64:67], a[192:195], v[112:115], v[64:67]
    ds_read_b128 v[128:131], v46 offset:128
    v_cvt_pk_bf16_f32 v157, v158, v159
    v_mfma_f32_16x16x32_bf16 v[68:71], a[196:199], v[112:115], v[68:71]
    ds_write_b64 v28, v[152:153] offset:36928
    v_mfma_f32_16x16x32_bf16 v[72:75], a[200:203], v[112:115], v[72:75]
    s_waitcnt lgkmcnt(4)
    v_cvt_pk_bf16_f32 v160, v160, v161
    v_cvt_pk_bf16_f32 v161, v162, v163
    v_mfma_f32_16x16x32_bf16 v[64:67], a[204:207], v[116:119], v[64:67]
    ds_read_b128 v[132:135], v47 offset:0
    v_cvt_pk_bf16_f32 v164, v164, v165
    v_mfma_f32_16x16x32_bf16 v[68:71], a[208:211], v[116:119], v[68:71]
    ds_write_b64 v29, v[156:157] offset:36928
    v_mfma_f32_16x16x32_bf16 v[72:75], a[212:215], v[116:119], v[72:75]
    v_cvt_pk_bf16_f32 v165, v166, v167
    v_xor_b32 v44, v56, v4
    v_mfma_f32_16x16x32_bf16 v[64:67], a[216:219], v[120:123], v[64:67]
    ds_read_b128 v[136:139], v47 offset:64
    v_xor_b32 v45, v57, v4
    v_mfma_f32_16x16x32_bf16 v[68:71], a[220:223], v[120:123], v[68:71]
    ds_write_b64 v28, v[160:161] offset:36992
    v_mfma_f32_16x16x32_bf16 v[72:75], a[224:227], v[120:123], v[72:75]
    s_waitcnt lgkmcnt(4)
    v_xor_b32 v46, v58, v4
    v_cvt_pk_bf16_f32 v100, v100, v101
    v_mfma_f32_16x16x32_bf16 v[64:67], a[228:231], v[124:127], v[64:67]
    ds_read_b128 v[140:143], v47 offset:128
    v_xor_b32 v47, v59, v4
    v_mfma_f32_16x16x32_bf16 v[68:71], a[232:235], v[124:127], v[68:71]
    ds_write_b64 v29, v[164:165] offset:36992
    v_mfma_f32_16x16x32_bf16 v[72:75], a[236:239], v[124:127], v[72:75]
    v_cvt_pk_bf16_f32 v101, v102, v103
    v_cvt_pk_bf16_f32 v102, v104, v105
    v_mfma_f32_16x16x32_bf16 v[64:67], a[240:243], v[128:131], v[64:67]
    ds_read_b128 v[112:115], v48 offset:0
    v_cvt_pk_bf16_f32 v103, v106, v107
    v_mfma_f32_16x16x32_bf16 v[68:71], a[244:247], v[128:131], v[68:71]
    v_permlane16_swap_b32 v100, v102
    v_mfma_f32_16x16x32_bf16 v[72:75], a[248:251], v[128:131], v[72:75]
    s_waitcnt lgkmcnt(3)
    v_permlane16_swap_b32 v101, v103
    v_mfma_f32_16x16x32_bf16 v[64:67], a[252:255], v[132:135], v[64:67]
    ds_read_b128 v[116:119], v48 offset:64
    v_mfma_f32_16x16x32_bf16 v[68:71], v[188:191], v[132:135], v[68:71]
    buffer_store_dwordx4 v[100:103], v21, s[20:23], s74 offen sc1
    v_mfma_f32_16x16x32_bf16 v[72:75], v[192:195], v[132:135], v[72:75]
    v_mfma_f32_16x16x32_bf16 v[64:67], v[196:199], v[136:139], v[64:67]
    ds_read_b128 v[120:123], v48 offset:128
    v_xor_b32 v48, v60, v4
    v_mfma_f32_16x16x32_bf16 v[68:71], v[200:203], v[136:139], v[68:71]
    v_mfma_f32_16x16x32_bf16 v[72:75], v[204:207], v[136:139], v[72:75]
    s_waitcnt lgkmcnt(2)
    s_barrier
    v_mfma_f32_16x16x32_bf16 v[64:67], v[208:211], v[140:143], v[64:67]
    ds_read_b128 v[124:127], v40 offset:0
    v_mfma_f32_16x16x32_bf16 v[68:71], v[212:215], v[140:143], v[68:71]
    ds_read_b32 v35, v34
    v_mfma_f32_16x16x32_bf16 v[72:75], v[216:219], v[140:143], v[72:75]
    ds_read_b64 v[6:7], v39 offset:49152
    v_mfma_f32_16x16x32_bf16 v[64:67], v[220:223], v[112:115], v[64:67]
    ds_read_b128 v[128:131], v40 offset:64
    v_mfma_f32_16x16x32_bf16 v[68:71], v[224:227], v[112:115], v[68:71]
    ds_read_b64 v[12:13], v39 offset:55296
    v_mfma_f32_16x16x32_bf16 v[72:75], v[228:231], v[112:115], v[72:75]
    s_waitcnt lgkmcnt(5)
    v_mfma_f32_16x16x32_bf16 v[64:67], v[232:235], v[116:119], v[64:67]
    ds_read_b128 v[132:135], v40 offset:128
    v_mfma_f32_16x16x32_bf16 v[68:71], v[236:239], v[116:119], v[68:71]
    v_mfma_f32_16x16x32_bf16 v[72:75], v[240:243], v[116:119], v[72:75]
    s_waitcnt lgkmcnt(3)
    v_readfirstlane_b32 s63, v35
    v_mfma_f32_16x16x32_bf16 v[64:67], v[244:247], v[120:123], v[64:67]
    ds_read_b128 v[136:139], v41 offset:0
    v_mfma_f32_16x16x32_bf16 v[68:71], v[248:251], v[120:123], v[68:71]
    buffer_store_dwordx2 v[6:7], v20, s[20:23], s56 offen sc1
    v_mfma_f32_16x16x32_bf16 v[72:75], v[252:255], v[120:123], v[72:75]
    s_waitcnt lgkmcnt(2)
    v_mfma_f32_16x16x32_bf16 v[76:79], a[0:3], v[124:127], 0
    ds_read_b128 v[140:143], v41 offset:64
    v_mfma_f32_16x16x32_bf16 v[80:83], a[4:7], v[124:127], 0
    v_cvt_pk_bf16_f32 v64, v64, v65
    v_cvt_pk_bf16_f32 v65, v66, v67
    v_mfma_f32_16x16x32_bf16 v[84:87], a[8:11], v[124:127], 0
    buffer_store_dwordx2 v[12:13], v22, s[20:23], s74 offen sc1
    v_cvt_pk_bf16_f32 v72, v72, v73
    v_mfma_f32_16x16x32_bf16 v[76:79], a[12:15], v[128:131], v[76:79]
    ds_read_b128 v[112:115], v41 offset:128
    v_cvt_pk_bf16_f32 v73, v74, v75
    v_mfma_f32_16x16x32_bf16 v[80:83], a[16:19], v[128:131], v[80:83]
    ds_write_b64 v38, v[72:73] offset:57344
    v_mfma_f32_16x16x32_bf16 v[84:87], a[20:23], v[128:131], v[84:87]
    s_waitcnt lgkmcnt(3)
    v_cvt_pk_bf16_f32 v66, v68, v69
    v_cvt_pk_bf16_f32 v67, v70, v71
    v_mfma_f32_16x16x32_bf16 v[76:79], a[24:27], v[132:135], v[76:79]
    ds_read_b128 v[116:119], v42 offset:0
    v_mfma_f32_16x16x32_bf16 v[80:83], a[28:31], v[132:135], v[80:83]
    v_permlane16_swap_b32 v64, v66
    v_mfma_f32_16x16x32_bf16 v[84:87], a[32:35], v[132:135], v[84:87]
    v_permlane16_swap_b32 v65, v67
    v_mfma_f32_16x16x32_bf16 v[76:79], a[36:39], v[136:139], v[76:79]
    ds_read_b128 v[120:123], v42 offset:64
    v_mfma_f32_16x16x32_bf16 v[80:83], a[40:43], v[136:139], v[80:83]
    buffer_store_dwordx4 v[64:67], v21, s[20:23], s75 offen sc1
    v_mfma_f32_16x16x32_bf16 v[84:87], a[44:47], v[136:139], v[84:87]
    s_waitcnt lgkmcnt(2)
    v_mfma_f32_16x16x32_bf16 v[76:79], a[48:51], v[140:143], v[76:79]
    ds_read_b128 v[124:127], v42 offset:128
    v_mfma_f32_16x16x32_bf16 v[80:83], a[52:55], v[140:143], v[80:83]
    ds_read_b64 v[8:9], v39 offset:51200
    v_mfma_f32_16x16x32_bf16 v[84:87], a[56:59], v[140:143], v[84:87]
    v_mfma_f32_16x16x32_bf16 v[76:79], a[60:63], v[112:115], v[76:79]
    ds_read_b128 v[128:131], v43 offset:0
    v_mfma_f32_16x16x32_bf16 v[80:83], a[64:67], v[112:115], v[80:83]
    v_mfma_f32_16x16x32_bf16 v[84:87], a[68:71], v[112:115], v[84:87]
    s_waitcnt lgkmcnt(3)
    v_mfma_f32_16x16x32_bf16 v[76:79], a[72:75], v[116:119], v[76:79]
    ds_read_b128 v[132:135], v43 offset:64
    v_mfma_f32_16x16x32_bf16 v[80:83], a[76:79], v[116:119], v[80:83]
    v_mfma_f32_16x16x32_bf16 v[84:87], a[80:83], v[116:119], v[84:87]
    s_waitcnt lgkmcnt(2)
    v_mfma_f32_16x16x32_bf16 v[76:79], a[84:87], v[120:123], v[76:79]
    ds_read_b128 v[136:139], v43 offset:128
    v_mfma_f32_16x16x32_bf16 v[80:83], a[88:91], v[120:123], v[80:83]
    buffer_store_dwordx2 v[8:9], v20, s[20:23], s4 offen sc1
    v_mfma_f32_16x16x32_bf16 v[84:87], a[92:95], v[120:123], v[84:87]
    s_barrier
    v_mfma_f32_16x16x32_bf16 v[76:79], a[96:99], v[124:127], v[76:79]
    ds_read_b128 v[140:143], v44 offset:0
    v_mfma_f32_16x16x32_bf16 v[80:83], a[100:103], v[124:127], v[80:83]
    ds_read_b64 v[14:15], v39 offset:57344
    v_mfma_f32_16x16x32_bf16 v[84:87], a[104:107], v[124:127], v[84:87]
    s_waitcnt lgkmcnt(3)
    v_mfma_f32_16x16x32_bf16 v[76:79], a[108:111], v[128:131], v[76:79]
    ds_read_b128 v[112:115], v44 offset:64
    v_mfma_f32_16x16x32_bf16 v[80:83], a[112:115], v[128:131], v[80:83]
    v_mfma_f32_16x16x32_bf16 v[84:87], a[116:119], v[128:131], v[84:87]
    v_mfma_f32_16x16x32_bf16 v[76:79], a[120:123], v[132:135], v[76:79]
    ds_read_b128 v[116:119], v44 offset:128
    v_mfma_f32_16x16x32_bf16 v[80:83], a[124:127], v[132:135], v[80:83]
    v_mfma_f32_16x16x32_bf16 v[84:87], a[128:131], v[132:135], v[84:87]
    s_waitcnt lgkmcnt(2)
    v_mfma_f32_16x16x32_bf16 v[76:79], a[132:135], v[136:139], v[76:79]
    ds_read_b128 v[120:123], v45 offset:0
    v_mfma_f32_16x16x32_bf16 v[80:83], a[136:139], v[136:139], v[80:83]
    buffer_store_dwordx2 v[14:15], v22, s[20:23], s75 offen sc1
    v_mfma_f32_16x16x32_bf16 v[84:87], a[140:143], v[136:139], v[84:87]
    v_mfma_f32_16x16x32_bf16 v[76:79], a[144:147], v[140:143], v[76:79]
    ds_read_b128 v[124:127], v45 offset:64
    v_mfma_f32_16x16x32_bf16 v[80:83], a[148:151], v[140:143], v[80:83]
    ds_read_b64 v[10:11], v39 offset:53248
    v_mfma_f32_16x16x32_bf16 v[84:87], a[152:155], v[140:143], v[84:87]
    s_waitcnt lgkmcnt(3)
    v_mfma_f32_16x16x32_bf16 v[76:79], a[156:159], v[112:115], v[76:79]
    ds_read_b128 v[128:131], v45 offset:128
    v_mfma_f32_16x16x32_bf16 v[80:83], a[160:163], v[112:115], v[80:83]
    v_mfma_f32_16x16x32_bf16 v[84:87], a[164:167], v[112:115], v[84:87]
    v_mfma_f32_16x16x32_bf16 v[76:79], a[168:171], v[116:119], v[76:79]
    ds_read_b128 v[132:135], v46 offset:0
    v_mfma_f32_16x16x32_bf16 v[80:83], a[172:175], v[116:119], v[80:83]
    v_mfma_f32_16x16x32_bf16 v[84:87], a[176:179], v[116:119], v[84:87]
    s_waitcnt lgkmcnt(2)
    v_mfma_f32_16x16x32_bf16 v[76:79], a[180:183], v[120:123], v[76:79]
    ds_read_b128 v[136:139], v46 offset:64
    v_mfma_f32_16x16x32_bf16 v[80:83], a[184:187], v[120:123], v[80:83]
    buffer_store_dwordx2 v[10:11], v20, s[20:23], s5 offen sc1
    v_mfma_f32_16x16x32_bf16 v[84:87], a[188:191], v[120:123], v[84:87]
    v_mfma_f32_16x16x32_bf16 v[76:79], a[192:195], v[124:127], v[76:79]
    ds_read_b128 v[140:143], v46 offset:128
    v_mfma_f32_16x16x32_bf16 v[80:83], a[196:199], v[124:127], v[80:83]
    v_mfma_f32_16x16x32_bf16 v[84:87], a[200:203], v[124:127], v[84:87]
    s_waitcnt lgkmcnt(2)
    v_mfma_f32_16x16x32_bf16 v[76:79], a[204:207], v[128:131], v[76:79]
    ds_read_b128 v[112:115], v47 offset:0
    v_mfma_f32_16x16x32_bf16 v[80:83], a[208:211], v[128:131], v[80:83]
    ds_read_b128 v[116:119], v47 offset:64
    v_mfma_f32_16x16x32_bf16 v[84:87], a[212:215], v[128:131], v[84:87]
    ds_read_b128 v[120:123], v47 offset:128
    v_mfma_f32_16x16x32_bf16 v[76:79], a[216:219], v[132:135], v[76:79]
    ds_read_b128 v[124:127], v48 offset:0
    v_mfma_f32_16x16x32_bf16 v[80:83], a[220:223], v[132:135], v[80:83]
    ds_read_b128 v[128:131], v48 offset:64
    v_mfma_f32_16x16x32_bf16 v[84:87], a[224:227], v[132:135], v[84:87]
    s_waitcnt lgkmcnt(5)
    ds_read_b128 v[132:135], v48 offset:128
    v_mfma_f32_16x16x32_bf16 v[76:79], a[228:231], v[136:139], v[76:79]
    v_mfma_f32_16x16x32_bf16 v[80:83], a[232:235], v[136:139], v[80:83]
    v_mfma_f32_16x16x32_bf16 v[84:87], a[236:239], v[136:139], v[84:87]
    v_mfma_f32_16x16x32_bf16 v[76:79], a[240:243], v[140:143], v[76:79]
    v_mfma_f32_16x16x32_bf16 v[80:83], a[244:247], v[140:143], v[80:83]
    v_mfma_f32_16x16x32_bf16 v[84:87], a[248:251], v[140:143], v[84:87]
    s_waitcnt lgkmcnt(0)
    v_mfma_f32_16x16x32_bf16 v[84:87], v[192:195], v[112:115], v[84:87]
    v_mfma_f32_16x16x32_bf16 v[84:87], v[204:207], v[116:119], v[84:87]
    v_mfma_f32_16x16x32_bf16 v[84:87], v[216:219], v[120:123], v[84:87]
    v_mfma_f32_16x16x32_bf16 v[84:87], v[228:231], v[124:127], v[84:87]
    v_mfma_f32_16x16x32_bf16 v[84:87], v[240:243], v[128:131], v[84:87]
    v_mfma_f32_16x16x32_bf16 v[84:87], v[252:255], v[132:135], v[84:87]
    s_nop 2
    v_mfma_f32_16x16x32_bf16 v[76:79], a[252:255], v[112:115], v[76:79]
    s_nop 2
    v_mfma_f32_16x16x32_bf16 v[76:79], v[196:199], v[116:119], v[76:79]
    v_cvt_pk_bf16_f32 v84, v84, v85
    v_cvt_pk_bf16_f32 v85, v86, v87
    v_mfma_f32_16x16x32_bf16 v[76:79], v[208:211], v[120:123], v[76:79]
    ds_write_b64 v38, v[84:85] offset:59392
    v_mfma_f32_16x16x32_bf16 v[76:79], v[220:223], v[124:127], v[76:79]
    v_mfma_f32_16x16x32_bf16 v[76:79], v[232:235], v[128:131], v[76:79]
    v_mfma_f32_16x16x32_bf16 v[76:79], v[244:247], v[132:135], v[76:79]
    v_mfma_f32_16x16x32_bf16 v[80:83], v[188:191], v[112:115], v[80:83]
    s_waitcnt lgkmcnt(0)
    s_barrier
    v_mfma_f32_16x16x32_bf16 v[80:83], v[200:203], v[116:119], v[80:83]
    ds_read_b64 v[62:63], v39 offset:59392
    v_mfma_f32_16x16x32_bf16 v[80:83], v[212:215], v[120:123], v[80:83]
    s_nop 0
    v_mfma_f32_16x16x32_bf16 v[80:83], v[224:227], v[124:127], v[80:83]
    v_mfma_f32_16x16x32_bf16 v[80:83], v[236:239], v[128:131], v[80:83]
    v_cvt_pk_bf16_f32 v76, v76, v77
    v_cvt_pk_bf16_f32 v77, v78, v79
    v_mfma_f32_16x16x32_bf16 v[80:83], v[248:251], v[132:135], v[80:83]
    s_waitcnt lgkmcnt(0)
    buffer_store_dwordx2 v[62:63], v22, s[20:23], s76 offen sc1
    s_nop 5
    v_cvt_pk_bf16_f32 v78, v80, v81
    v_cvt_pk_bf16_f32 v79, v82, v83
    s_nop 0
    v_permlane16_swap_b32 v76, v78
    v_permlane16_swap_b32 v77, v79
    buffer_store_dwordx4 v[76:79], v21, s[20:23], s76 offen sc1
    s_cmp_lg_u32 s63, 0
    s_cbranch_scc1 L_slow
    s_endpgm
L_y_end:
.p2align 6
L_x:
    v_and_b32 v2, 15, v0
    v_lshrrev_b32 v3, 4, v1
    s_movk_i32 s42, 192
    v_mov_b32 v34, 158976
    v_mov_b32 v147, 0
    ds_write_b32 v34, v147
    v_bfe_u32 v144, v1, 2, 2
    v_lshl_add_u32 v144, v3, 3, v144
    v_lshrrev_b32 v145, 2, v1
    v_mul_u32_u24 v144, 192, v144
    v_bfi_b32 v145, 3, v1, v145
    s_lshl_b32 s40, s2, 5
    v_and_b32 v145, 7, v145
    v_lshl_add_u32 v144, v145, 3, v144
    v_xad_u32 v15, v144, s40, 64
    v_lshl_add_u32 v13, s2, 7, v144
    s_mul_i32 s40, s57, 10368
    v_xor_b32 v14, 32, v13
    s_add_u32 s40, s40, 61440
    s_cmp_eq_u32 s80, 10
    s_cselect_b32 s41, 16, 17
    v_add_u32 v144, 2, v2
    v_add_u32 v147, s40, v4
    v_min_u32 v144, s41, v144
    v_lshl_add_u32 v144, v144, 3, 0
    v_bitop3_b32 v145, v144, 32, v147 bitop3:0x6a
    v_mad_u32_u24 v18, v144, 24, v145
    v_lshl_add_u32 v144, v2, 3, 8
    v_bitop3_b32 v145, v144, 32, v147 bitop3:0x6a
    v_mad_u32_u24 v17, v144, 24, v145
    v_lshl_add_u32 v144, v2, 3, 0
    v_bitop3_b32 v145, v144, 32, v147 bitop3:0x6a
    v_mad_u32_u24 v16, v144, 24, v145
    s_mov_b64 exec, 0
    s_cmp_eq_u32 s3, 0
    s_cbranch_scc1 L_pgX0
    s_cmp_eq_u32 s3, 1
    s_cbranch_scc1 L_pgX1
    s_cmp_eq_u32 s3, 2
    s_cbranch_scc1 L_pgX2
L_retX:
L_pgX2:
    s_mov_b64 exec, -1
    s_add_u32 m0, s25, 6912
    s_add_u32 s31, s44, 86016
    buffer_load_dwordx4 v8, s[8:11], s31 offen  lds
    s_add_u32 m0, s25, 17280
    s_add_u32 s31, s44, 215040
    buffer_load_dwordx4 v8, s[8:11], s31 offen  lds
    s_waitcnt vmcnt(9)
    s_barrier
    s_mul_i32 s31, s57, 3456
    s_add_u32 s31, s31, s24
    s_add_u32 m0, s31, 127488
    s_add_u32 s31, s28, 55296
    buffer_load_dwordx4 v5, s[16:19], s31 offen lds
    ds_read_b64_tr_b16 a[0:1], v13 offset:24576
    buffer_load_dwordx4 v6, s[16:19], s31 offen offset:1024 lds
    ds_read_b64_tr_b16 a[2:3], v13 offset:25344
    buffer_load_dwordx4 v7, s[16:19], s31 offen offset:2048 lds
    ds_read_b64_tr_b16 a[4:5], v14 offset:24576
    s_add_u32 m0, s25, 20736
    s_add_u32 s31, s44, 258048
    buffer_load_dwordx4 v8, s[8:11], s31 offen  lds
    ds_read_b64_tr_b16 a[6:7], v14 offset:25344
    s_add_u32 m0, s25, 24192
    s_add_u32 s31, s44, 301056
    buffer_load_dwordx4 v8, s[8:11], s31 offen  lds
    ds_read_b64_tr_b16 a[8:9], v15 offset:24576
    s_add_u32 m0, s24, 49152
    s_add_u32 s31, s28, 61440
    buffer_load_dwordx4 v5, s[16:19], s31 offen lds
    ds_read_b64_tr_b16 a[10:11], v15 offset:25344
    buffer_load_dwordx4 v6, s[16:19], s31 offen offset:1024 lds
    ds_read_b64_tr_b16 a[12:13], v13 offset:30720
    buffer_load_dwordx4 v7, s[16:19], s31 offen offset:2048 lds
    ds_read_b64_tr_b16 a[14:15], v13 offset:31488
    ds_read_b64_tr_b16 a[16:17], v14 offset:30720
    ds_read_b64_tr_b16 a[18:19], v14 offset:31488
    ds_read_b64_tr_b16 a[20:21], v15 offset:30720
    ds_read_b64_tr_b16 a[22:23], v15 offset:31488
    s_waitcnt lgkmcnt(0)
    s_waitcnt vmcnt(10)
    s_barrier
    ds_read_b128 v[112:115], v16 offset:0
    ds_read_b128 v[116:119], v16 offset:3456
    ds_read_b128 v[120:123], v16 offset:64
    ds_read_b128 v[124:127], v16 offset:3520
    s_waitcnt lgkmcnt(3)
    v_mfma_f32_16x16x32_bf16 v[64:67], a[0:3], v[112:115], 0
    s_add_u32 m0, s24, 0
    ds_read_b64_tr_b16 a[24:25], v13 offset:36864
    s_add_u32 s31, s28, 67584
    ds_read_b64_tr_b16 a[26:27], v13 offset:37632
    v_mfma_f32_16x16x32_bf16 v[68:71], a[4:7], v[112:115], 0
    s_mul_i32 s40, s57, 6912
    ds_read_b64_tr_b16 a[28:29], v14 offset:36864
    buffer_load_dwordx4 v5, s[16:19], s31 offen lds
    v_mfma_f32_16x16x32_bf16 v[72:75], a[8:11], v[112:115], 0
    s_waitcnt lgkmcnt(5)
    ds_read_b64_tr_b16 a[30:31], v14 offset:37632
    v_add_u32 v61, 127488, v13
    v_mfma_f32_16x16x32_bf16 v[76:79], a[0:3], v[116:119], 0
    s_mul_i32 s41, s57, 43008
    ds_read_b64_tr_b16 a[32:33], v15 offset:36864
    v_add_u32 v62, 127488, v14
    v_mfma_f32_16x16x32_bf16 v[80:83], a[4:7], v[116:119], 0
    s_add_u32 s41, s44, s41
    ds_read_b64_tr_b16 a[34:35], v15 offset:37632
    v_add_u32 v63, 127488, v15
    v_mfma_f32_16x16x32_bf16 v[84:87], a[8:11], v[116:119], 0
    s_waitcnt lgkmcnt(6)
    ds_read_b128 v[128:131], v16 offset:128
    buffer_load_dwordx4 v6, s[16:19], s31 offen offset:1024 lds
    v_mfma_f32_16x16x32_bf16 v[64:67], a[12:15], v[120:123], v[64:67]
    s_add_u32 s74, s41, 301248
    ds_read_b64_tr_b16 a[36:37], v13 offset:43008
    v_subrev_u32 v40, s40, v16
    v_mfma_f32_16x16x32_bf16 v[68:71], a[16:19], v[120:123], v[68:71]
    s_add_u32 s75, s41, 387264
    ds_read_b64_tr_b16 a[38:39], v13 offset:43776
    v_subrev_u32 v41, s40, v17
    v_mfma_f32_16x16x32_bf16 v[72:75], a[20:23], v[120:123], v[72:75]
    s_add_u32 s76, s41, 473280
    ds_read_b64_tr_b16 a[40:41], v14 offset:43008
    v_subrev_u32 v42, s40, v18
    v_mfma_f32_16x16x32_bf16 v[76:79], a[12:15], v[124:127], v[76:79]
    s_add_u32 s77, s41, 559296
    ds_read_b128 v[132:135], v16 offset:3584
    buffer_load_dwordx4 v7, s[16:19], s31 offen offset:2048 lds
    v_mfma_f32_16x16x32_bf16 v[80:83], a[16:19], v[124:127], v[80:83]
    s_add_u32 m0, s24, 12288
    ds_read_b64_tr_b16 a[42:43], v14 offset:43776
    v_mul_u32_u24 v30, 1821, v0
    v_mfma_f32_16x16x32_bf16 v[84:87], a[20:23], v[124:127], v[84:87]
    s_waitcnt lgkmcnt(5)
    ds_read_b64_tr_b16 a[44:45], v15 offset:43008
    v_lshlrev_b32 v31, 4, v0
    v_mfma_f32_16x16x32_bf16 v[64:67], a[24:27], v[128:131], v[64:67]
    s_add_u32 s31, s28, 73728
    ds_read_b64_tr_b16 a[46:47], v15 offset:43776
    v_lshrrev_b32 v52, 1, v4
    v_mfma_f32_16x16x32_bf16 v[68:71], a[28:31], v[128:131], v[68:71]
    s_mov_b32 s37, 0x3e803e80
    ds_read_b128 v[136:139], v17 offset:0
    buffer_load_dwordx4 v5, s[16:19], s31 offen lds
    v_mfma_f32_16x16x32_bf16 v[72:75], a[32:35], v[128:131], v[72:75]
    s_waitcnt lgkmcnt(4)
    ds_read_b128 v[140:143], v17 offset:3456
    v_lshl_or_b32 v21, v4, 1, v52
    v_mfma_f32_16x16x32_bf16 v[76:79], a[24:27], v[132:135], v[76:79]
    s_cmp_ge_u32 s45, 47040
    s_cselect_b32 s43, 43008, 0
    v_and_b32 v21, 48, v21
    v_mfma_f32_16x16x32_bf16 v[80:83], a[28:31], v[132:135], v[80:83]
    s_sub_u32 s53, s44, s43
    v_lshl_add_u32 v21, s2, 7, v21
    v_mad_u32_u24 v19, v2, s42, v21
    v_mfma_f32_16x16x32_bf16 v[84:87], a[32:35], v[132:135], v[84:87]
    s_waitcnt vmcnt(12) lgkmcnt(1)
    s_barrier
    v_mfma_f32_16x16x32_bf16 v[64:67], a[36:39], v[136:139], v[64:67]
    s_mov_b32 s96, 0x7fff7fff
    ds_read_b128 v[112:115], v16 offset:6912
    buffer_load_dwordx4 v6, s[16:19], s31 offen offset:1024 lds
    v_mfma_f32_16x16x32_bf16 v[68:71], a[40:43], v[136:139], v[68:71]
    s_mov_b32 s60, 0x435f435f
    ds_read_b128 v[116:119], v16 offset:6976
    s_mul_i32 s56, s46, 36
    ds_read_b128 v[120:123], v16 offset:7040
    v_mfma_f32_16x16x32_bf16 v[72:75], a[44:47], v[136:139], v[72:75]
    s_waitcnt lgkmcnt(3)
    v_lshl_add_u32 v53, s2, 2, v3
    v_lshrrev_b32 v52, 1, v2
    v_mfma_f32_16x16x32_bf16 v[76:79], a[36:39], v[140:143], v[76:79]
    s_movk_i32 s5, 7488
    ds_read_b128 v[124:127], v17 offset:6912
    v_mad_u32_u16 v30, v30, s5, v31 op_sel:[1,0,0,0]
    v_mfma_f32_16x16x32_bf16 v[80:83], a[40:43], v[140:143], v[80:83]
    buffer_load_dwordx4 v7, s[16:19], s31 offen offset:2048 lds
    v_mfma_f32_16x16x32_bf16 v[84:87], a[44:47], v[140:143], v[84:87]
    s_waitcnt lgkmcnt(3)
    v_bitop3_b32 v52, v52, 6, v53 bitop3:0x6a
    v_lshl_add_u32 v52, v2, 3, v52
    v_mfma_f32_16x16x32_bf16 v[88:91], a[0:3], v[112:115], 0
    s_add_u32 m0, s24, 24576
    ds_read_b128 v[128:131], v16 offset:3456
    v_mad_u32_u24 v21, v2, s42, v21
    v_mfma_f32_16x16x32_bf16 v[92:95], a[4:7], v[112:115], 0
    s_add_u32 s31, s28, 24576
    v_lshlrev_b32 v39, 3, v0
    v_lshrrev_b32 v22, 1, v0
    v_mfma_f32_16x16x32_bf16 v[96:99], a[8:11], v[112:115], 0
    s_waitcnt lgkmcnt(2)
    buffer_load_dwordx4 v5, s[16:19], s31 offen lds
    v_mfma_f32_16x16x32_bf16 v[88:91], a[12:15], v[116:119], v[88:91]
    s_addk_i32 s56, 215
    ds_read_b128 v[132:135], v16 offset:6912
    v_sub_u32 v32, s56, v0
    v_mfma_f32_16x16x32_bf16 v[92:95], a[16:19], v[116:119], v[92:95]
    s_mov_b32 s5, 56448
    v_add_u32 v31, -252, v32
    v_and_b32 v31, 2.0, v31
    v_mfma_f32_16x16x32_bf16 v[96:99], a[20:23], v[116:119], v[96:99]
    s_waitcnt vmcnt(11) lgkmcnt(2)
    s_barrier
    v_mfma_f32_16x16x32_bf16 v[88:91], a[24:27], v[120:123], v[88:91]
    s_mul_i32 s55, s45, 36
    ds_read_b64_tr_b16 a[108:109], v61 offset:0
    buffer_load_dwordx4 v6, s[16:19], s31 offen offset:1024 lds
    ds_read_b64_tr_b16 a[110:111], v61 offset:768
    ds_read_b64_tr_b16 a[112:113], v62 offset:0
    ds_read_b64_tr_b16 a[114:115], v62 offset:768
    ds_read_b64_tr_b16 a[116:117], v63 offset:0
    ds_read_b64_tr_b16 a[118:119], v63 offset:768
    v_mfma_f32_16x16x32_bf16 v[92:95], a[28:31], v[120:123], v[92:95]
    s_lshl_b32 s4, s57, 10
    ds_read_b64_tr_b16 a[216:217], v61 offset:9600
    s_add_u32 s56, s44, 43200
    ds_read_b64_tr_b16 a[218:219], v61 offset:10368
    v_mfma_f32_16x16x32_bf16 v[96:99], a[32:35], v[120:123], v[96:99]
    ds_read_b64_tr_b16 a[220:221], v62 offset:9600
    v_add3_u32 v31, v30, v31, s5
    v_mfma_f32_16x16x32_bf16 v[88:91], a[36:39], v[124:127], v[88:91]
    ds_read_b128 v[136:139], v16 offset:10368
    v_and_or_b32 v30, v32, 2.0, v30
    v_mfma_f32_16x16x32_bf16 v[92:95], a[40:43], v[124:127], v[92:95]
    ds_read_b64_tr_b16 a[222:223], v62 offset:10368
    buffer_load_dwordx4 v7, s[16:19], s31 offen offset:2048 lds
    v_mfma_f32_16x16x32_bf16 v[96:99], a[44:47], v[124:127], v[96:99]
    s_waitcnt lgkmcnt(5)
    ds_read_b64_tr_b16 a[224:225], v63 offset:9600
    v_lshl_add_u32 v38, v52, 3, s4
    v_mfma_f32_16x16x32_bf16 v[64:67], a[108:111], v[128:131], v[64:67]
    s_add_u32 m0, s24, 36864
    ds_read_b64_tr_b16 a[226:227], v63 offset:10368
    v_bitop3_b32 v22, v22, 48, v39 bitop3:0x6a
    v_mfma_f32_16x16x32_bf16 v[68:71], a[112:115], v[128:131], v[68:71]
    s_add_u32 s31, s26, 135168
    v_bfe_u32 v37, v0, 3, 4
    v_and_or_b32 v22, v22, 56, 64
    v_mfma_f32_16x16x32_bf16 v[72:75], a[116:119], v[128:131], v[72:75]
    buffer_load_dwordx4 v5, s[16:19], s31 offen lds
    v_mfma_f32_16x16x32_bf16 v[76:79], a[108:111], v[132:135], v[76:79]
    s_mul_i32 s4, s57, 129024
    v_mad_u32_u24 v20, v37, s42, v22
    v_mad_u32_u24 v22, v37, s42, v22
    v_mfma_f32_16x16x32_bf16 v[80:83], a[112:115], v[132:135], v[80:83]
    s_add_u32 s56, s56, s4
    s_add_u32 s4, s56, 43008
    s_add_u32 s5, s56, 86016
    v_mfma_f32_16x16x32_bf16 v[84:87], a[116:119], v[132:135], v[84:87]
    s_waitcnt lgkmcnt(1)
    v_mfma_f32_16x16x32_bf16 v[88:91], a[108:111], v[136:139], v[88:91]
    buffer_load_dwordx4 v6, s[16:19], s31 offen offset:1024 lds
    v_mfma_f32_16x16x32_bf16 v[92:95], a[112:115], v[136:139], v[92:95]
    v_mfma_f32_16x16x32_bf16 v[96:99], a[116:119], v[136:139], v[96:99]
    s_waitcnt vmcnt(8) lgkmcnt(0)
    s_barrier
    v_mfma_f32_16x16x32_bf16 v[64:67], a[216:219], v[132:135], v[64:67]
    ds_read_b64_tr_b16 a[120:121], v13 offset:49152
    ds_read_b64_tr_b16 a[122:123], v13 offset:49920
    ds_read_b64_tr_b16 a[124:125], v14 offset:49152
    v_mfma_f32_16x16x32_bf16 v[68:71], a[220:223], v[132:135], v[68:71]
    ds_read_b128 v[140:143], v16 offset:13824
    buffer_load_dwordx4 v7, s[16:19], s31 offen offset:2048 lds
    ds_read_b64_tr_b16 a[126:127], v14 offset:49920
    v_mfma_f32_16x16x32_bf16 v[72:75], a[224:227], v[132:135], v[72:75]
L_pgX0:
  s_cbranch_execz L_retX
    s_mul_i32 s31, s57, 3456
    ds_read_b64_tr_b16 a[128:129], v15 offset:49152
    s_add_u32 s31, s31, s24
    ds_read_b64_tr_b16 a[130:131], v15 offset:49920
    v_mfma_f32_16x16x32_bf16 v[76:79], a[216:219], v[136:139], v[76:79]
    s_add_u32 m0, s31, 127488
    ds_read_b128 v[112:115], v16 offset:3520
    s_add_u32 s31, s28, 86016
    ds_read_b64_tr_b16 a[228:229], v13 offset:55296
    v_mfma_f32_16x16x32_bf16 v[80:83], a[220:223], v[136:139], v[80:83]
    ds_read_b64_tr_b16 a[230:231], v13 offset:56064
    ds_read_b64_tr_b16 a[232:233], v14 offset:55296
    v_mfma_f32_16x16x32_bf16 v[84:87], a[224:227], v[136:139], v[84:87]
    s_waitcnt lgkmcnt(7)
    ds_read_b128 v[116:119], v16 offset:6976
    buffer_load_dwordx4 v5, s[16:19], s31 offen lds
    v_mfma_f32_16x16x32_bf16 v[88:91], a[216:219], v[140:143], v[88:91]
    ds_read_b64_tr_b16 a[234:235], v14 offset:56064
    ds_read_b64_tr_b16 a[236:237], v15 offset:55296
    v_mfma_f32_16x16x32_bf16 v[92:95], a[220:223], v[140:143], v[92:95]
    ds_read_b64_tr_b16 a[238:239], v15 offset:56064
    v_mfma_f32_16x16x32_bf16 v[96:99], a[224:227], v[140:143], v[96:99]
    s_waitcnt lgkmcnt(7)
    ds_read_b128 v[120:123], v16 offset:10432
    v_mfma_f32_16x16x32_bf16 v[64:67], a[120:123], v[112:115], v[64:67]
    ds_read_b64_tr_b16 a[132:133], v13 offset:0
    buffer_load_dwordx4 v6, s[16:19], s31 offen offset:1024 lds
    v_mfma_f32_16x16x32_bf16 v[68:71], a[124:127], v[112:115], v[68:71]
    ds_read_b64_tr_b16 a[134:135], v13 offset:768
    v_mfma_f32_16x16x32_bf16 v[72:75], a[128:131], v[112:115], v[72:75]
    s_waitcnt lgkmcnt(6)
    ds_read_b64_tr_b16 a[136:137], v14 offset:0
    v_mfma_f32_16x16x32_bf16 v[76:79], a[120:123], v[116:119], v[76:79]
    ds_read_b64_tr_b16 a[138:139], v14 offset:768
    v_mfma_f32_16x16x32_bf16 v[80:83], a[124:127], v[116:119], v[80:83]
    ds_read_b64_tr_b16 a[140:141], v15 offset:0
    buffer_load_dwordx4 v7, s[16:19], s31 offen offset:2048 lds
    v_mfma_f32_16x16x32_bf16 v[84:87], a[128:131], v[116:119], v[84:87]
    s_waitcnt lgkmcnt(5)
    ds_read_b64_tr_b16 a[142:143], v15 offset:768
    s_add_u32 m0, s24, 49152
    v_mfma_f32_16x16x32_bf16 v[88:91], a[120:123], v[120:123], v[88:91]
    s_add_u32 s31, s28, 36864
    ds_read_b64_tr_b16 a[240:241], v13 offset:6144
    v_mfma_f32_16x16x32_bf16 v[92:95], a[124:127], v[120:123], v[92:95]
    ds_read_b64_tr_b16 a[242:243], v13 offset:6912
    v_mfma_f32_16x16x32_bf16 v[96:99], a[128:131], v[120:123], v[96:99]
    ds_read_b64_tr_b16 a[244:245], v14 offset:6144
    v_mfma_f32_16x16x32_bf16 v[64:67], a[228:231], v[116:119], v[64:67]
    ds_read_b128 v[124:127], v16 offset:13888
    v_mfma_f32_16x16x32_bf16 v[68:71], a[232:235], v[116:119], v[68:71]
    ds_read_b64_tr_b16 a[246:247], v14 offset:6912
    v_mfma_f32_16x16x32_bf16 v[72:75], a[236:239], v[116:119], v[72:75]
    ds_read_b64_tr_b16 a[248:249], v15 offset:6144
    v_mfma_f32_16x16x32_bf16 v[76:79], a[228:231], v[120:123], v[76:79]
    ds_read_b64_tr_b16 a[250:251], v15 offset:6912
    v_mfma_f32_16x16x32_bf16 v[80:83], a[232:235], v[120:123], v[80:83]
    ds_read_b128 v[128:131], v16 offset:3584
    v_mfma_f32_16x16x32_bf16 v[84:87], a[236:239], v[120:123], v[84:87]
    s_waitcnt lgkmcnt(4)
    ds_read_b128 v[132:135], v16 offset:7040
    v_mfma_f32_16x16x32_bf16 v[88:91], a[228:231], v[124:127], v[88:91]
    ds_read_b128 v[136:139], v16 offset:10496
    v_mfma_f32_16x16x32_bf16 v[92:95], a[232:235], v[124:127], v[92:95]
    v_mfma_f32_16x16x32_bf16 v[96:99], a[236:239], v[124:127], v[96:99]
    s_waitcnt vmcnt(6) lgkmcnt(2)
    s_barrier
    v_mfma_f32_16x16x32_bf16 v[64:67], a[132:135], v[128:131], v[64:67]
    ds_read_b64_tr_b16 a[144:145], v13 offset:12288
    buffer_load_dwordx4 v5, s[16:19], s31 offen lds
    v_mfma_f32_16x16x32_bf16 v[68:71], a[136:139], v[128:131], v[68:71]
    ds_read_b64_tr_b16 a[146:147], v13 offset:13056
    v_mfma_f32_16x16x32_bf16 v[72:75], a[140:143], v[128:131], v[72:75]
    s_waitcnt lgkmcnt(3)
    ds_read_b64_tr_b16 a[148:149], v14 offset:12288
    v_mfma_f32_16x16x32_bf16 v[76:79], a[132:135], v[132:135], v[76:79]
    ds_read_b128 v[140:143], v16 offset:13952
    v_mfma_f32_16x16x32_bf16 v[80:83], a[136:139], v[132:135], v[80:83]
    ds_read_b64_tr_b16 a[150:151], v14 offset:13056
    buffer_load_dwordx4 v6, s[16:19], s31 offen offset:1024 lds
    v_mfma_f32_16x16x32_bf16 v[84:87], a[140:143], v[132:135], v[84:87]
    s_waitcnt lgkmcnt(5)
    ds_read_b64_tr_b16 a[152:153], v15 offset:12288
    v_mfma_f32_16x16x32_bf16 v[88:91], a[132:135], v[136:139], v[88:91]
    ds_read_b64_tr_b16 a[154:155], v15 offset:13056
    v_mfma_f32_16x16x32_bf16 v[92:95], a[136:139], v[136:139], v[92:95]
    ds_read_b128 v[112:115], v17 offset:3456
    v_mfma_f32_16x16x32_bf16 v[96:99], a[140:143], v[136:139], v[96:99]
    ds_read_b64_tr_b16 a[252:253], v13 offset:18432
    buffer_load_dwordx4 v7, s[16:19], s31 offen offset:2048 lds
    v_mfma_f32_16x16x32_bf16 v[64:67], a[240:243], v[132:135], v[64:67]
    s_add_u32 m0, s24, 0
    ds_read_b64_tr_b16 a[254:255], v13 offset:19200
    s_add_u32 s31, s26, 147456
    v_mfma_f32_16x16x32_bf16 v[68:71], a[244:247], v[132:135], v[68:71]
    ds_read_b64_tr_b16 v[188:189], v14 offset:18432
    v_mfma_f32_16x16x32_bf16 v[72:75], a[248:251], v[132:135], v[72:75]
    ds_read_b128 v[116:119], v17 offset:6912
    v_mfma_f32_16x16x32_bf16 v[76:79], a[240:243], v[136:139], v[76:79]
    ds_read_b64_tr_b16 v[190:191], v14 offset:19200
    buffer_load_dwordx4 v5, s[16:19], s31 offen lds
    v_mfma_f32_16x16x32_bf16 v[80:83], a[244:247], v[136:139], v[80:83]
    ds_read_b64_tr_b16 v[192:193], v15 offset:18432
    v_mfma_f32_16x16x32_bf16 v[84:87], a[248:251], v[136:139], v[84:87]
    s_waitcnt lgkmcnt(5)
    ds_read_b64_tr_b16 v[194:195], v15 offset:19200
    v_mfma_f32_16x16x32_bf16 v[88:91], a[240:243], v[140:143], v[88:91]
    ds_read_b128 v[120:123], v17 offset:10368
    v_mfma_f32_16x16x32_bf16 v[92:95], a[244:247], v[140:143], v[92:95]
    buffer_load_dwordx4 v6, s[16:19], s31 offen offset:1024 lds
    v_mfma_f32_16x16x32_bf16 v[96:99], a[248:251], v[140:143], v[96:99]
    ds_read_b64_tr_b16 a[48:49], v13 offset:24576
    v_mfma_f32_16x16x32_bf16 v[64:67], a[144:147], v[112:115], v[64:67]
    ds_read_b64_tr_b16 a[50:51], v13 offset:25344
    v_mfma_f32_16x16x32_bf16 v[68:71], a[148:151], v[112:115], v[68:71]
    ds_read_b64_tr_b16 a[52:53], v14 offset:24576
    v_mfma_f32_16x16x32_bf16 v[72:75], a[152:155], v[112:115], v[72:75]
    s_waitcnt lgkmcnt(4)
    buffer_load_dwordx4 v7, s[16:19], s31 offen offset:2048 lds
    v_mfma_f32_16x16x32_bf16 v[76:79], a[144:147], v[116:119], v[76:79]
    s_add_u32 m0, s24, 12288
    ds_read_b64_tr_b16 a[54:55], v14 offset:25344
    s_add_u32 s31, s28, 98304
    v_mfma_f32_16x16x32_bf16 v[80:83], a[148:151], v[116:119], v[80:83]
    ds_read_b64_tr_b16 a[56:57], v15 offset:24576
    v_mfma_f32_16x16x32_bf16 v[84:87], a[152:155], v[116:119], v[84:87]
    s_waitcnt lgkmcnt(4)
    ds_read_b64_tr_b16 a[58:59], v15 offset:25344
    v_mfma_f32_16x16x32_bf16 v[88:91], a[144:147], v[120:123], v[88:91]
    ds_read_b64_tr_b16 a[156:157], v13 offset:30720
    v_mfma_f32_16x16x32_bf16 v[92:95], a[148:151], v[120:123], v[92:95]
    ds_read_b64_tr_b16 a[158:159], v13 offset:31488
    v_mfma_f32_16x16x32_bf16 v[96:99], a[152:155], v[120:123], v[96:99]
    ds_read_b64_tr_b16 a[160:161], v14 offset:30720
    v_mfma_f32_16x16x32_bf16 v[64:67], a[252:255], v[116:119], v[64:67]
    ds_read_b128 v[124:127], v17 offset:13824
    v_mfma_f32_16x16x32_bf16 v[68:71], v[188:191], v[116:119], v[68:71]
    ds_read_b64_tr_b16 a[162:163], v14 offset:31488
    v_mfma_f32_16x16x32_bf16 v[72:75], v[192:195], v[116:119], v[72:75]
    ds_read_b64_tr_b16 a[164:165], v15 offset:30720
    v_mfma_f32_16x16x32_bf16 v[76:79], a[252:255], v[120:123], v[76:79]
    ds_read_b64_tr_b16 a[166:167], v15 offset:31488
    v_mfma_f32_16x16x32_bf16 v[80:83], v[188:191], v[120:123], v[80:83]
    ds_read_b128 v[128:131], v17 offset:64
    v_mfma_f32_16x16x32_bf16 v[84:87], v[192:195], v[120:123], v[84:87]
    s_waitcnt lgkmcnt(4)
    ds_read_b128 v[132:135], v17 offset:3520
    v_mfma_f32_16x16x32_bf16 v[88:91], a[252:255], v[124:127], v[88:91]
    ds_read_b128 v[136:139], v17 offset:6976
    v_mfma_f32_16x16x32_bf16 v[92:95], v[188:191], v[124:127], v[92:95]
    v_mfma_f32_16x16x32_bf16 v[96:99], v[192:195], v[124:127], v[96:99]
    s_waitcnt vmcnt(6) lgkmcnt(2)
    s_barrier
    v_mfma_f32_16x16x32_bf16 v[64:67], a[48:51], v[128:131], v[64:67]
    buffer_load_dwordx4 v5, s[16:19], s31 offen lds
    v_mfma_f32_16x16x32_bf16 v[68:71], a[52:55], v[128:131], v[68:71]
    ds_read_b64_tr_b16 v[196:197], v13 offset:36864
    v_mfma_f32_16x16x32_bf16 v[72:75], a[56:59], v[128:131], v[72:75]
    s_waitcnt lgkmcnt(2)
    ds_read_b64_tr_b16 v[198:199], v13 offset:37632
    v_mfma_f32_16x16x32_bf16 v[76:79], a[48:51], v[132:135], v[76:79]
    ds_read_b64_tr_b16 v[200:201], v14 offset:36864
    v_mfma_f32_16x16x32_bf16 v[80:83], a[52:55], v[132:135], v[80:83]
    buffer_load_dwordx4 v6, s[16:19], s31 offen offset:1024 lds
    v_mfma_f32_16x16x32_bf16 v[84:87], a[56:59], v[132:135], v[84:87]
    s_waitcnt lgkmcnt(3)
    ds_read_b128 v[140:143], v17 offset:10432
    v_mfma_f32_16x16x32_bf16 v[88:91], a[48:51], v[136:139], v[88:91]
    ds_read_b64_tr_b16 v[202:203], v14 offset:37632
    v_mfma_f32_16x16x32_bf16 v[92:95], a[52:55], v[136:139], v[92:95]
    ds_read_b64_tr_b16 v[204:205], v15 offset:36864
    v_mfma_f32_16x16x32_bf16 v[96:99], a[56:59], v[136:139], v[96:99]
    ds_read_b64_tr_b16 v[206:207], v15 offset:37632
    buffer_load_dwordx4 v7, s[16:19], s31 offen offset:2048 lds
    v_mfma_f32_16x16x32_bf16 v[64:67], a[156:159], v[132:135], v[64:67]
    s_add_u32 m0, s24, 24576
    ds_read_b64_tr_b16 a[60:61], v13 offset:43008
    s_add_u32 s31, s28, 49152
    v_mfma_f32_16x16x32_bf16 v[68:71], a[160:163], v[132:135], v[68:71]
    ds_read_b64_tr_b16 a[62:63], v13 offset:43776
    v_mfma_f32_16x16x32_bf16 v[72:75], a[164:167], v[132:135], v[72:75]
    ds_read_b64_tr_b16 a[64:65], v14 offset:43008
    v_mfma_f32_16x16x32_bf16 v[76:79], a[156:159], v[136:139], v[76:79]
    buffer_load_dwordx4 v5, s[16:19], s31 offen lds
    v_mfma_f32_16x16x32_bf16 v[80:83], a[160:163], v[136:139], v[80:83]
    ds_read_b128 v[112:115], v17 offset:13888
    v_mfma_f32_16x16x32_bf16 v[84:87], a[164:167], v[136:139], v[84:87]
    s_waitcnt lgkmcnt(4)
    ds_read_b64_tr_b16 a[66:67], v14 offset:43776
    v_mfma_f32_16x16x32_bf16 v[88:91], a[156:159], v[140:143], v[88:91]
    ds_read_b64_tr_b16 a[68:69], v15 offset:43008
    v_mfma_f32_16x16x32_bf16 v[92:95], a[160:163], v[140:143], v[92:95]
    ds_read_b64_tr_b16 a[70:71], v15 offset:43776
    buffer_load_dwordx4 v6, s[16:19], s31 offen offset:1024 lds
    v_mfma_f32_16x16x32_bf16 v[96:99], a[164:167], v[140:143], v[96:99]
    ds_read_b128 v[116:119], v17 offset:128
    v_mfma_f32_16x16x32_bf16 v[64:67], v[196:199], v[136:139], v[64:67]
    ds_read_b128 v[120:123], v17 offset:3584
    v_mfma_f32_16x16x32_bf16 v[68:71], v[200:203], v[136:139], v[68:71]
    ds_read_b64_tr_b16 a[168:169], v61 offset:0
    v_mfma_f32_16x16x32_bf16 v[72:75], v[204:207], v[136:139], v[72:75]
    buffer_load_dwordx4 v7, s[16:19], s31 offen offset:2048 lds
    v_mfma_f32_16x16x32_bf16 v[76:79], v[196:199], v[140:143], v[76:79]
    s_lshl_b32 s31, s2, 5
    ds_read_b64_tr_b16 a[170:171], v61 offset:768
    v_xor_b32 v5, s31, v5
    v_mfma_f32_16x16x32_bf16 v[80:83], v[200:203], v[140:143], v[80:83]
    s_lshr_b32 s31, s24, 1
    ds_read_b64_tr_b16 a[172:173], v62 offset:0
    s_add_u32 m0, s31, 36864
    v_mfma_f32_16x16x32_bf16 v[84:87], v[204:207], v[140:143], v[84:87]
    s_waitcnt lgkmcnt(4)
    ds_read_b128 v[124:127], v17 offset:7040
    s_add_u32 s31, s31, 159744
    v_mfma_f32_16x16x32_bf16 v[88:91], v[196:199], v[112:115], v[88:91]
    ds_read_b64_tr_b16 a[174:175], v62 offset:768
    v_mfma_f32_16x16x32_bf16 v[92:95], v[200:203], v[112:115], v[92:95]
    ds_read_b64_tr_b16 a[176:177], v63 offset:0
    v_mfma_f32_16x16x32_bf16 v[96:99], v[204:207], v[112:115], v[96:99]
    ds_read_b64_tr_b16 a[178:179], v63 offset:768
    v_mfma_f32_16x16x32_bf16 v[64:67], a[60:63], v[116:119], v[64:67]
    ds_read_b64_tr_b16 v[208:209], v61 offset:9600
    v_mfma_f32_16x16x32_bf16 v[68:71], a[64:67], v[116:119], v[68:71]
    ds_read_b64_tr_b16 v[210:211], v61 offset:10368
    v_mfma_f32_16x16x32_bf16 v[72:75], a[68:71], v[116:119], v[72:75]
    s_waitcnt lgkmcnt(5)
    ds_read_b64_tr_b16 v[212:213], v62 offset:9600
    v_mfma_f32_16x16x32_bf16 v[76:79], a[60:63], v[120:123], v[76:79]
    ds_read_b128 v[128:131], v17 offset:10496
    v_mfma_f32_16x16x32_bf16 v[80:83], a[64:67], v[120:123], v[80:83]
    ds_read_b64_tr_b16 v[214:215], v62 offset:10368
    v_mfma_f32_16x16x32_bf16 v[84:87], a[68:71], v[120:123], v[84:87]
    ds_read_b64_tr_b16 v[216:217], v63 offset:9600
    v_mfma_f32_16x16x32_bf16 v[88:91], a[60:63], v[124:127], v[88:91]
    ds_read_b64_tr_b16 v[218:219], v63 offset:10368
    v_mfma_f32_16x16x32_bf16 v[92:95], a[64:67], v[124:127], v[92:95]
    v_mfma_f32_16x16x32_bf16 v[96:99], a[68:71], v[124:127], v[96:99]
    s_waitcnt vmcnt(6) lgkmcnt(4)
    s_barrier
    v_mfma_f32_16x16x32_bf16 v[64:67], a[168:171], v[120:123], v[64:67]
    ds_read_b64_tr_b16 a[72:73], v13 offset:49152
    buffer_load_dwordx4 v5, s[16:19], s31 offen lds
    v_mfma_f32_16x16x32_bf16 v[68:71], a[172:175], v[120:123], v[68:71]
    ds_read_b64_tr_b16 a[74:75], v13 offset:49920
    v_mfma_f32_16x16x32_bf16 v[72:75], a[176:179], v[120:123], v[72:75]
    ds_read_b64_tr_b16 a[76:77], v14 offset:49152
    v_mfma_f32_16x16x32_bf16 v[76:79], a[168:171], v[124:127], v[76:79]
    ds_read_b128 v[132:135], v17 offset:13952
    v_mfma_f32_16x16x32_bf16 v[80:83], a[172:175], v[124:127], v[80:83]
    buffer_load_dwordx4 v5, s[16:19], s31 offen offset:512 lds
    v_mfma_f32_16x16x32_bf16 v[84:87], a[176:179], v[124:127], v[84:87]
    s_waitcnt lgkmcnt(4)
    ds_read_b64_tr_b16 a[78:79], v14 offset:49920
    s_add_u32 m0, s25, 27648
    v_mfma_f32_16x16x32_bf16 v[88:91], a[168:171], v[128:131], v[88:91]
    s_add_u32 s31, s44, 344064
    ds_read_b64_tr_b16 a[80:81], v15 offset:49152
    v_mfma_f32_16x16x32_bf16 v[92:95], a[172:175], v[128:131], v[92:95]
    ds_read_b64_tr_b16 a[82:83], v15 offset:49920
    v_mfma_f32_16x16x32_bf16 v[96:99], a[176:179], v[128:131], v[96:99]
    buffer_load_dwordx4 v8, s[8:11], s31 offen  lds
    v_mfma_f32_16x16x32_bf16 v[64:67], v[208:211], v[124:127], v[64:67]
    s_add_u32 m0, s25, 31104
    ds_read_b128 v[136:139], v18 offset:0
    s_add_u32 s31, s44, 387072
    v_mfma_f32_16x16x32_bf16 v[68:71], v[212:215], v[124:127], v[68:71]
    ds_read_b128 v[140:143], v18 offset:3456
    v_mfma_f32_16x16x32_bf16 v[72:75], v[216:219], v[124:127], v[72:75]
    ds_read_b64_tr_b16 a[180:181], v13 offset:55296
    v_mfma_f32_16x16x32_bf16 v[76:79], v[208:211], v[128:131], v[76:79]
    buffer_load_dwordx4 v8, s[8:11], s31 offen  lds
    v_mfma_f32_16x16x32_bf16 v[80:83], v[212:215], v[128:131], v[80:83]
    ds_read_b64_tr_b16 a[182:183], v13 offset:56064
    v_mfma_f32_16x16x32_bf16 v[84:87], v[216:219], v[128:131], v[84:87]
    s_waitcnt lgkmcnt(4)
    ds_read_b64_tr_b16 a[184:185], v14 offset:55296
    v_mfma_f32_16x16x32_bf16 v[88:91], v[208:211], v[132:135], v[88:91]
    ds_read_b128 v[112:115], v18 offset:6912
    v_mfma_f32_16x16x32_bf16 v[92:95], v[212:215], v[132:135], v[92:95]
    ds_read_b64_tr_b16 a[186:187], v14 offset:56064
    v_mfma_f32_16x16x32_bf16 v[96:99], v[216:219], v[132:135], v[96:99]
    s_waitcnt lgkmcnt(4)
    ds_read_b64_tr_b16 a[188:189], v15 offset:55296
    v_mfma_f32_16x16x32_bf16 v[64:67], a[72:75], v[136:139], v[64:67]
    buffer_load_dwordx4 v[180:183], v30, s[12:15], s55 offen
    v_mfma_f32_16x16x32_bf16 v[68:71], a[76:79], v[136:139], v[68:71]
    ds_read_b64_tr_b16 a[190:191], v15 offset:56064
    v_mfma_f32_16x16x32_bf16 v[72:75], a[80:83], v[136:139], v[72:75]
    ds_read_b64_tr_b16 v[220:221], v13 offset:0
    v_mfma_f32_16x16x32_bf16 v[76:79], a[72:75], v[140:143], v[76:79]
    ds_read_b64_tr_b16 v[222:223], v13 offset:768
    v_mfma_f32_16x16x32_bf16 v[80:83], a[76:79], v[140:143], v[80:83]
    buffer_load_dwordx4 v[184:187], v31, s[12:15], s55 offen
    v_mfma_f32_16x16x32_bf16 v[84:87], a[80:83], v[140:143], v[84:87]
    s_waitcnt lgkmcnt(3)
    ds_read_b64_tr_b16 v[224:225], v14 offset:0
    s_add_u32 m0, s25, 34560
    v_mfma_f32_16x16x32_bf16 v[88:91], a[72:75], v[112:115], v[88:91]
    s_add_u32 s31, s44, 430080
    ds_read_b128 v[116:119], v18 offset:10368
    v_mfma_f32_16x16x32_bf16 v[92:95], a[76:79], v[112:115], v[92:95]
    ds_read_b64_tr_b16 v[226:227], v14 offset:768
    v_mfma_f32_16x16x32_bf16 v[96:99], a[80:83], v[112:115], v[96:99]
    s_waitcnt lgkmcnt(4)
    buffer_load_dwordx4 v8, s[8:11], s31 offen  lds
    v_mfma_f32_16x16x32_bf16 v[64:67], a[180:183], v[140:143], v[64:67]
    s_add_u32 m0, s25, 38016
    ds_read_b64_tr_b16 v[228:229], v15 offset:0
    s_add_u32 s31, s44, 473088
    v_mfma_f32_16x16x32_bf16 v[68:71], a[184:187], v[140:143], v[68:71]
    ds_read_b64_tr_b16 v[230:231], v15 offset:768
    v_mfma_f32_16x16x32_bf16 v[72:75], a[188:191], v[140:143], v[72:75]
    ds_read_b64_tr_b16 a[84:85], v13 offset:6144
    v_mfma_f32_16x16x32_bf16 v[76:79], a[180:183], v[112:115], v[76:79]
    buffer_load_dwordx4 v8, s[8:11], s31 offen  lds
    v_mfma_f32_16x16x32_bf16 v[80:83], a[184:187], v[112:115], v[80:83]
    s_add_u32 m0, s25, 41472
    ds_read_b64_tr_b16 a[86:87], v13 offset:6912
    s_add_u32 s31, s44, 516096
    v_mfma_f32_16x16x32_bf16 v[84:87], a[188:191], v[112:115], v[84:87]
    s_waitcnt lgkmcnt(4)
    ds_read_b64_tr_b16 a[88:89], v14 offset:6144
    v_mfma_f32_16x16x32_bf16 v[88:91], a[180:183], v[116:119], v[88:91]
    ds_read_b128 v[120:123], v18 offset:13824
    v_mfma_f32_16x16x32_bf16 v[92:95], a[184:187], v[116:119], v[92:95]
    ds_read_b64_tr_b16 a[90:91], v14 offset:6912
    v_mfma_f32_16x16x32_bf16 v[96:99], a[188:191], v[116:119], v[96:99]
    s_waitcnt vmcnt(8) lgkmcnt(4)
    s_barrier
    v_mfma_f32_16x16x32_bf16 v[64:67], v[220:223], v[112:115], v[64:67]
    buffer_load_dwordx4 v8, s[8:11], s31 offen  lds
    v_mfma_f32_16x16x32_bf16 v[68:71], v[224:227], v[112:115], v[68:71]
    s_add_u32 m0, s25, 44928
    ds_read_b64_tr_b16 a[92:93], v15 offset:6144
    s_add_u32 s31, s44, 559104
    v_mfma_f32_16x16x32_bf16 v[72:75], v[228:231], v[112:115], v[72:75]
    ds_read_b64_tr_b16 a[94:95], v15 offset:6912
    v_mfma_f32_16x16x32_bf16 v[76:79], v[220:223], v[116:119], v[76:79]
    ds_read_b128 v[124:127], v18 offset:64
    v_mfma_f32_16x16x32_bf16 v[80:83], v[224:227], v[116:119], v[80:83]
    buffer_load_dwordx4 v8, s[8:11], s31 offen  lds
    v_mfma_f32_16x16x32_bf16 v[84:87], v[228:231], v[116:119], v[84:87]
    s_waitcnt lgkmcnt(3)
    ds_read_b128 v[128:131], v18 offset:3520
    s_add_u32 m0, s25, 48384
    v_mfma_f32_16x16x32_bf16 v[88:91], v[220:223], v[120:123], v[88:91]
    s_add_u32 s31, s44, 602112
    ds_read_b64_tr_b16 a[192:193], v13 offset:12288
    v_mfma_f32_16x16x32_bf16 v[92:95], v[224:227], v[120:123], v[92:95]
    ds_read_b64_tr_b16 a[194:195], v13 offset:13056
    v_mfma_f32_16x16x32_bf16 v[96:99], v[228:231], v[120:123], v[96:99]
    s_waitcnt lgkmcnt(3)
    ds_read_b64_tr_b16 a[196:197], v14 offset:12288
    v_mfma_f32_16x16x32_bf16 v[64:67], a[84:87], v[124:127], v[64:67]
    ds_read_b128 v[132:135], v18 offset:6976
    v_mfma_f32_16x16x32_bf16 v[68:71], a[88:91], v[124:127], v[68:71]
    ds_read_b64_tr_b16 a[198:199], v14 offset:13056
    v_mfma_f32_16x16x32_bf16 v[72:75], a[92:95], v[124:127], v[72:75]
    s_waitcnt lgkmcnt(5)
    ds_read_b64_tr_b16 a[200:201], v15 offset:12288
    v_mfma_f32_16x16x32_bf16 v[76:79], a[84:87], v[128:131], v[76:79]
    ds_read_b64_tr_b16 a[202:203], v15 offset:13056
    v_mfma_f32_16x16x32_bf16 v[80:83], a[88:91], v[128:131], v[80:83]
    ds_read_b64_tr_b16 v[232:233], v13 offset:18432
    v_mfma_f32_16x16x32_bf16 v[84:87], a[92:95], v[128:131], v[84:87]
    s_waitcnt lgkmcnt(4)
    ds_read_b64_tr_b16 v[234:235], v13 offset:19200
    v_mfma_f32_16x16x32_bf16 v[88:91], a[84:87], v[132:135], v[88:91]
    ds_read_b64_tr_b16 v[236:237], v14 offset:18432
    v_mfma_f32_16x16x32_bf16 v[92:95], a[88:91], v[132:135], v[92:95]
    ds_read_b128 v[136:139], v18 offset:10432
    v_mfma_f32_16x16x32_bf16 v[96:99], a[92:95], v[132:135], v[96:99]
    s_waitcnt lgkmcnt(4)
    ds_read_b64_tr_b16 v[238:239], v14 offset:19200
    v_mfma_f32_16x16x32_bf16 v[64:67], a[192:195], v[128:131], v[64:67]
    buffer_load_dwordx4 v8, s[8:11], s31 offen  lds
    v_mfma_f32_16x16x32_bf16 v[68:71], a[196:199], v[128:131], v[68:71]
    s_add_u32 m0, s25, 51840
    ds_read_b64_tr_b16 v[240:241], v15 offset:18432
    s_add_u32 s31, s53, 645120
    v_mfma_f32_16x16x32_bf16 v[72:75], a[200:203], v[128:131], v[72:75]
    ds_read_b64_tr_b16 v[242:243], v15 offset:19200
    v_mfma_f32_16x16x32_bf16 v[76:79], a[192:195], v[132:135], v[76:79]
    ds_read_b64_tr_b16 a[96:97], v13 offset:24576
    v_mfma_f32_16x16x32_bf16 v[80:83], a[196:199], v[132:135], v[80:83]
    buffer_load_dwordx4 v8, s[8:11], s31 offen  lds
    v_mfma_f32_16x16x32_bf16 v[84:87], a[200:203], v[132:135], v[84:87]
    s_waitcnt lgkmcnt(3)
    ds_read_b64_tr_b16 a[98:99], v13 offset:25344
    v_mfma_f32_16x16x32_bf16 v[88:91], a[192:195], v[136:139], v[88:91]
    ds_read_b64_tr_b16 a[100:101], v14 offset:24576
    v_mfma_f32_16x16x32_bf16 v[92:95], a[196:199], v[136:139], v[92:95]
    ds_read_b128 v[140:143], v18 offset:13888
    v_mfma_f32_16x16x32_bf16 v[96:99], a[200:203], v[136:139], v[96:99]
    s_waitcnt lgkmcnt(4)
    ds_read_b64_tr_b16 a[102:103], v14 offset:25344
    v_mfma_f32_16x16x32_bf16 v[64:67], v[232:235], v[132:135], v[64:67]
    ds_read_b64_tr_b16 a[104:105], v15 offset:24576
    v_mfma_f32_16x16x32_bf16 v[68:71], v[236:239], v[132:135], v[68:71]
    ds_read_b64_tr_b16 a[106:107], v15 offset:25344
    v_mfma_f32_16x16x32_bf16 v[72:75], v[240:243], v[132:135], v[72:75]
    ds_read_b128 v[112:115], v18 offset:128
    v_mfma_f32_16x16x32_bf16 v[76:79], v[232:235], v[136:139], v[76:79]
    ds_read_b64_tr_b16 a[204:205], v13 offset:30720
    v_mfma_f32_16x16x32_bf16 v[80:83], v[236:239], v[136:139], v[80:83]
    ds_read_b128 v[116:119], v18 offset:3584
    v_mfma_f32_16x16x32_bf16 v[84:87], v[240:243], v[136:139], v[84:87]
    s_waitcnt lgkmcnt(5)
    ds_read_b64_tr_b16 a[206:207], v13 offset:31488
    v_mfma_f32_16x16x32_bf16 v[88:91], v[232:235], v[140:143], v[88:91]
    ds_read_b64_tr_b16 a[208:209], v14 offset:30720
    v_mfma_f32_16x16x32_bf16 v[92:95], v[236:239], v[140:143], v[92:95]
    ds_read_b128 v[120:123], v18 offset:7040
    v_mfma_f32_16x16x32_bf16 v[96:99], v[240:243], v[140:143], v[96:99]
    s_waitcnt vmcnt(9) lgkmcnt(5)
    s_barrier
    v_mfma_f32_16x16x32_bf16 v[64:67], a[96:99], v[112:115], v[64:67]
    ds_read_b64_tr_b16 a[210:211], v14 offset:31488
    v_mfma_f32_16x16x32_bf16 v[68:71], a[100:103], v[112:115], v[68:71]
    ds_read_b64_tr_b16 a[212:213], v15 offset:30720
    v_mfma_f32_16x16x32_bf16 v[72:75], a[104:107], v[112:115], v[72:75]
    s_waitcnt lgkmcnt(4)
    ds_read_b64_tr_b16 a[214:215], v15 offset:31488
    v_mfma_f32_16x16x32_bf16 v[76:79], a[96:99], v[116:119], v[76:79]
    ds_read_b64_tr_b16 v[244:245], v13 offset:36864
    v_mfma_f32_16x16x32_bf16 v[80:83], a[100:103], v[116:119], v[80:83]
    ds_read_b64_tr_b16 v[246:247], v13 offset:37632
    v_mfma_f32_16x16x32_bf16 v[84:87], a[104:107], v[116:119], v[84:87]
    s_waitcnt lgkmcnt(5)
    ds_read_b64_tr_b16 v[248:249], v14 offset:36864
    v_mfma_f32_16x16x32_bf16 v[88:91], a[96:99], v[120:123], v[88:91]
    ds_read_b128 v[124:127], v18 offset:10496
    v_mfma_f32_16x16x32_bf16 v[92:95], a[100:103], v[120:123], v[92:95]
    ds_read_b64_tr_b16 v[250:251], v14 offset:37632
    v_mfma_f32_16x16x32_bf16 v[96:99], a[104:107], v[120:123], v[96:99]
    s_waitcnt lgkmcnt(5)
    ds_read_b64_tr_b16 v[252:253], v15 offset:36864
    v_mfma_f32_16x16x32_bf16 v[64:67], a[204:207], v[116:119], v[64:67]
    ds_read_b64_tr_b16 v[254:255], v15 offset:37632
    v_mfma_f32_16x16x32_bf16 v[68:71], a[208:211], v[116:119], v[68:71]
    v_mfma_f32_16x16x32_bf16 v[72:75], a[212:215], v[116:119], v[72:75]
    v_mfma_f32_16x16x32_bf16 v[76:79], a[204:207], v[120:123], v[76:79]
    ds_read_b128 v[128:131], v18 offset:13952
    v_mfma_f32_16x16x32_bf16 v[80:83], a[208:211], v[120:123], v[80:83]
    v_mfma_f32_16x16x32_bf16 v[84:87], a[212:215], v[120:123], v[84:87]
    s_waitcnt lgkmcnt(2)
    v_mfma_f32_16x16x32_bf16 v[88:91], a[204:207], v[124:127], v[88:91]
    ds_read_b128 v[132:135], v40 offset:20736
    v_mfma_f32_16x16x32_bf16 v[92:95], a[208:211], v[124:127], v[92:95]
    v_mfma_f32_16x16x32_bf16 v[96:99], a[212:215], v[124:127], v[96:99]
    s_waitcnt lgkmcnt(2)
    v_mfma_f32_16x16x32_bf16 v[64:67], v[244:247], v[120:123], v[64:67]
    ds_read_b128 v[136:139], v40 offset:20800
    v_mfma_f32_16x16x32_bf16 v[68:71], v[248:251], v[120:123], v[68:71]
    v_mfma_f32_16x16x32_bf16 v[72:75], v[252:255], v[120:123], v[72:75]
    v_mfma_f32_16x16x32_bf16 v[76:79], v[244:247], v[124:127], v[76:79]
    ds_read_b128 v[140:143], v40 offset:20864
    v_mfma_f32_16x16x32_bf16 v[80:83], v[248:251], v[124:127], v[80:83]
    v_mfma_f32_16x16x32_bf16 v[84:87], v[252:255], v[124:127], v[84:87]
    s_waitcnt lgkmcnt(2)
    v_mfma_f32_16x16x32_bf16 v[88:91], v[244:247], v[128:131], v[88:91]
    ds_read_b128 v[112:115], v41 offset:20736
    v_mfma_f32_16x16x32_bf16 v[92:95], v[248:251], v[128:131], v[92:95]
    v_mfma_f32_16x16x32_bf16 v[96:99], v[252:255], v[128:131], v[96:99]
    v_mfma_f32_16x16x32_bf16 v[100:103], a[0:3], v[132:135], 0
    ds_read_b128 v[116:119], v41 offset:20800
    v_cvt_pk_bf16_f32 v72, v72, v73
    v_mfma_f32_16x16x32_bf16 v[104:107], a[4:7], v[132:135], 0
    v_cvt_pk_bf16_f32 v73, v74, v75
    v_cvt_pk_bf16_f32 v84, v84, v85
    v_mfma_f32_16x16x32_bf16 v[108:111], a[8:11], v[132:135], 0
    s_waitcnt lgkmcnt(2)
    ds_write_b64 v38, v[72:73] offset:0
    v_mfma_f32_16x16x32_bf16 v[100:103], a[12:15], v[136:139], v[100:103]
    ds_read_b128 v[120:123], v41 offset:20864
    v_mfma_f32_16x16x32_bf16 v[104:107], a[16:19], v[136:139], v[104:107]
    v_cvt_pk_bf16_f32 v85, v86, v87
    v_cvt_pk_bf16_f32 v96, v96, v97
    v_mfma_f32_16x16x32_bf16 v[108:111], a[20:23], v[136:139], v[108:111]
    ds_write_b64 v38, v[84:85] offset:2048
    v_mfma_f32_16x16x32_bf16 v[100:103], a[24:27], v[140:143], v[100:103]
    ds_read_b128 v[124:127], v42 offset:20736
    v_mfma_f32_16x16x32_bf16 v[104:107], a[28:31], v[140:143], v[104:107]
    v_cvt_pk_bf16_f32 v97, v98, v99
    v_cvt_pk_bf16_f32 v64, v64, v65
    v_mfma_f32_16x16x32_bf16 v[108:111], a[32:35], v[140:143], v[108:111]
    s_waitcnt lgkmcnt(3)
    ds_write_b64 v38, v[96:97] offset:4096
    v_mfma_f32_16x16x32_bf16 v[100:103], a[36:39], v[112:115], v[100:103]
    ds_read_b128 v[128:131], v42 offset:20800
    v_mfma_f32_16x16x32_bf16 v[104:107], a[40:43], v[112:115], v[104:107]
    v_cvt_pk_bf16_f32 v65, v66, v67
    v_cvt_pk_bf16_f32 v66, v68, v69
    v_mfma_f32_16x16x32_bf16 v[108:111], a[44:47], v[112:115], v[108:111]
    v_cvt_pk_bf16_f32 v67, v70, v71
    v_cvt_pk_bf16_f32 v76, v76, v77
    v_mfma_f32_16x16x32_bf16 v[100:103], a[48:51], v[116:119], v[100:103]
    ds_read_b128 v[132:135], v42 offset:20864
    v_cvt_pk_bf16_f32 v77, v78, v79
    v_mfma_f32_16x16x32_bf16 v[104:107], a[52:55], v[116:119], v[104:107]
    v_permlane16_swap_b32 v64, v66
    v_mfma_f32_16x16x32_bf16 v[108:111], a[56:59], v[116:119], v[108:111]
    s_waitcnt lgkmcnt(2)
    v_permlane16_swap_b32 v65, v67
    v_mfma_f32_16x16x32_bf16 v[100:103], a[60:63], v[120:123], v[100:103]
    ds_read_b128 v[136:139], v40 offset:24192
    v_cvt_pk_bf16_f32 v78, v80, v81
    v_mfma_f32_16x16x32_bf16 v[104:107], a[64:67], v[120:123], v[104:107]
    buffer_store_dwordx4 v[64:67], v19, s[20:23], s56 offen sc1
    v_cvt_pk_bf16_f32 v79, v82, v83
    v_cvt_pk_bf16_f32 v88, v88, v89
    v_cvt_pk_bf16_f32 v89, v90, v91
    v_mfma_f32_16x16x32_bf16 v[108:111], a[68:71], v[120:123], v[108:111]
    v_permlane16_swap_b32 v76, v78
    v_mfma_f32_16x16x32_bf16 v[100:103], a[72:75], v[124:127], v[100:103]
    ds_read_b128 v[140:143], v40 offset:24256
    v_cvt_pk_bf16_f32 v90, v92, v93
    v_mfma_f32_16x16x32_bf16 v[104:107], a[76:79], v[124:127], v[104:107]
    v_permlane16_swap_b32 v77, v79
    v_mfma_f32_16x16x32_bf16 v[108:111], a[80:83], v[124:127], v[108:111]
    s_waitcnt lgkmcnt(2)
    v_permlane16_swap_b32 v88, v90
    v_mfma_f32_16x16x32_bf16 v[100:103], a[84:87], v[128:131], v[100:103]
    ds_read_b128 v[112:115], v40 offset:24320
    v_cvt_pk_bf16_f32 v91, v94, v95
    v_mfma_f32_16x16x32_bf16 v[104:107], a[88:91], v[128:131], v[104:107]
    v_mfma_f32_16x16x32_bf16 v[108:111], a[92:95], v[128:131], v[108:111]
    v_permlane16_swap_b32 v89, v91
    v_mfma_f32_16x16x32_bf16 v[100:103], a[96:99], v[132:135], v[100:103]
    ds_read_b128 v[116:119], v41 offset:24192
    v_mfma_f32_16x16x32_bf16 v[104:107], a[100:103], v[132:135], v[104:107]
    buffer_store_dwordx4 v[76:79], v19, s[20:23], s4 offen sc1
    v_mfma_f32_16x16x32_bf16 v[108:111], a[104:107], v[132:135], v[108:111]
    s_waitcnt lgkmcnt(2)
    v_mfma_f32_16x16x32_bf16 v[100:103], a[108:111], v[136:139], v[100:103]
    ds_read_b128 v[120:123], v41 offset:24256
    v_mfma_f32_16x16x32_bf16 v[104:107], a[112:115], v[136:139], v[104:107]
    v_mfma_f32_16x16x32_bf16 v[108:111], a[116:119], v[136:139], v[108:111]
    s_waitcnt vmcnt(5) lgkmcnt(2)
    s_barrier
    v_mfma_f32_16x16x32_bf16 v[100:103], a[120:123], v[140:143], v[100:103]
L_pgX1:
  s_cbranch_execz L_retX
    ds_read_b128 v[124:127], v41 offset:24320
    v_mfma_f32_16x16x32_bf16 v[104:107], a[124:127], v[140:143], v[104:107]
    ds_read_b64 v[6:7], v39 offset:0
    v_mfma_f32_16x16x32_bf16 v[108:111], a[128:131], v[140:143], v[108:111]
    v_mfma_f32_16x16x32_bf16 v[100:103], a[132:135], v[112:115], v[100:103]
    ds_read_b128 v[128:131], v42 offset:24192
    v_mfma_f32_16x16x32_bf16 v[104:107], a[136:139], v[112:115], v[104:107]
    v_mfma_f32_16x16x32_bf16 v[108:111], a[140:143], v[112:115], v[108:111]
    s_waitcnt lgkmcnt(3)
    v_mfma_f32_16x16x32_bf16 v[100:103], a[144:147], v[116:119], v[100:103]
    ds_read_b128 v[132:135], v42 offset:24256
    v_mfma_f32_16x16x32_bf16 v[104:107], a[148:151], v[116:119], v[104:107]
    v_mfma_f32_16x16x32_bf16 v[108:111], a[152:155], v[116:119], v[108:111]
    s_waitcnt lgkmcnt(2)
    v_mfma_f32_16x16x32_bf16 v[100:103], a[156:159], v[120:123], v[100:103]
    ds_read_b128 v[136:139], v42 offset:24320
    v_mfma_f32_16x16x32_bf16 v[104:107], a[160:163], v[120:123], v[104:107]
    buffer_store_dwordx2 v[6:7], v20, s[20:23], s56 offen sc1
    v_mfma_f32_16x16x32_bf16 v[108:111], a[164:167], v[120:123], v[108:111]
    v_mfma_f32_16x16x32_bf16 v[100:103], a[168:171], v[124:127], v[100:103]
    ds_read_b128 v[140:143], v40 offset:27648
    v_mfma_f32_16x16x32_bf16 v[104:107], a[172:175], v[124:127], v[104:107]
    v_mfma_f32_16x16x32_bf16 v[108:111], a[176:179], v[124:127], v[108:111]
    s_waitcnt lgkmcnt(2)
    v_mfma_f32_16x16x32_bf16 v[100:103], a[180:183], v[128:131], v[100:103]
    ds_read_b128 v[112:115], v40 offset:27712
    v_mfma_f32_16x16x32_bf16 v[104:107], a[184:187], v[128:131], v[104:107]
    v_mfma_f32_16x16x32_bf16 v[108:111], a[188:191], v[128:131], v[108:111]
    v_mfma_f32_16x16x32_bf16 v[100:103], a[192:195], v[132:135], v[100:103]
    ds_read_b128 v[116:119], v40 offset:27776
    v_mfma_f32_16x16x32_bf16 v[104:107], a[196:199], v[132:135], v[104:107]
    buffer_store_dwordx4 v[88:91], v19, s[20:23], s5 offen sc1
    v_mfma_f32_16x16x32_bf16 v[108:111], a[200:203], v[132:135], v[108:111]
    s_waitcnt lgkmcnt(2)
    v_mfma_f32_16x16x32_bf16 v[100:103], a[204:207], v[136:139], v[100:103]
    ds_read_b128 v[120:123], v41 offset:27648
    v_mfma_f32_16x16x32_bf16 v[104:107], a[208:211], v[136:139], v[104:107]
    v_mfma_f32_16x16x32_bf16 v[108:111], a[212:215], v[136:139], v[108:111]
    v_mfma_f32_16x16x32_bf16 v[100:103], a[216:219], v[140:143], v[100:103]
    ds_read_b128 v[124:127], v41 offset:27712
    v_mfma_f32_16x16x32_bf16 v[104:107], a[220:223], v[140:143], v[104:107]
    ds_read_b64 v[8:9], v39 offset:2048
    v_mfma_f32_16x16x32_bf16 v[108:111], a[224:227], v[140:143], v[108:111]
    s_waitcnt lgkmcnt(3)
    v_mfma_f32_16x16x32_bf16 v[100:103], a[228:231], v[112:115], v[100:103]
    ds_read_b128 v[128:131], v41 offset:27776
    v_mfma_f32_16x16x32_bf16 v[104:107], a[232:235], v[112:115], v[104:107]
    v_mfma_f32_16x16x32_bf16 v[108:111], a[236:239], v[112:115], v[108:111]
    v_mfma_f32_16x16x32_bf16 v[100:103], a[240:243], v[116:119], v[100:103]
    ds_read_b128 v[132:135], v42 offset:27648
    v_mfma_f32_16x16x32_bf16 v[104:107], a[244:247], v[116:119], v[104:107]
    v_mfma_f32_16x16x32_bf16 v[108:111], a[248:251], v[116:119], v[108:111]
    s_waitcnt lgkmcnt(2)
    v_mfma_f32_16x16x32_bf16 v[100:103], a[252:255], v[120:123], v[100:103]
    ds_read_b128 v[136:139], v42 offset:27712
    v_mfma_f32_16x16x32_bf16 v[104:107], v[188:191], v[120:123], v[104:107]
    buffer_store_dwordx2 v[8:9], v20, s[20:23], s4 offen sc1
    v_mfma_f32_16x16x32_bf16 v[108:111], v[192:195], v[120:123], v[108:111]
    v_mfma_f32_16x16x32_bf16 v[100:103], v[196:199], v[124:127], v[100:103]
    ds_read_b128 v[140:143], v42 offset:27776
    v_mfma_f32_16x16x32_bf16 v[104:107], v[200:203], v[124:127], v[104:107]
    v_mfma_f32_16x16x32_bf16 v[108:111], v[204:207], v[124:127], v[108:111]
    s_waitcnt lgkmcnt(2)
    v_mfma_f32_16x16x32_bf16 v[100:103], v[208:211], v[128:131], v[100:103]
    ds_read_b128 v[112:115], v40 offset:27648
    v_mfma_f32_16x16x32_bf16 v[104:107], v[212:215], v[128:131], v[104:107]
    v_mfma_f32_16x16x32_bf16 v[108:111], v[216:219], v[128:131], v[108:111]
    v_mfma_f32_16x16x32_bf16 v[100:103], v[220:223], v[132:135], v[100:103]
    ds_read_b128 v[116:119], v40 offset:27712
    v_mfma_f32_16x16x32_bf16 v[104:107], v[224:227], v[132:135], v[104:107]
    v_mfma_f32_16x16x32_bf16 v[108:111], v[228:231], v[132:135], v[108:111]
    s_waitcnt lgkmcnt(2)
    v_mfma_f32_16x16x32_bf16 v[100:103], v[232:235], v[136:139], v[100:103]
    ds_read_b128 v[120:123], v40 offset:27776
    v_mfma_f32_16x16x32_bf16 v[104:107], v[236:239], v[136:139], v[104:107]
    v_mfma_f32_16x16x32_bf16 v[108:111], v[240:243], v[136:139], v[108:111]
    v_mfma_f32_16x16x32_bf16 v[100:103], v[244:247], v[140:143], v[100:103]
    ds_read_b128 v[124:127], v41 offset:27648
    v_mfma_f32_16x16x32_bf16 v[104:107], v[248:251], v[140:143], v[104:107]
    ds_read_b64 v[10:11], v39 offset:4096
    v_mfma_f32_16x16x32_bf16 v[108:111], v[252:255], v[140:143], v[108:111]
    s_waitcnt lgkmcnt(3)
    v_mfma_f32_16x16x32_bf16 v[64:67], a[0:3], v[112:115], 0
    ds_read_b128 v[128:131], v41 offset:27712
    v_mfma_f32_16x16x32_bf16 v[68:71], a[4:7], v[112:115], 0
    v_cvt_pk_bf16_f32 v100, v100, v101
    v_cvt_pk_bf16_f32 v101, v102, v103
    v_mfma_f32_16x16x32_bf16 v[72:75], a[8:11], v[112:115], 0
    v_cvt_pk_bf16_f32 v102, v104, v105
    v_cvt_pk_bf16_f32 v108, v108, v109
    v_mfma_f32_16x16x32_bf16 v[64:67], a[12:15], v[116:119], v[64:67]
    ds_read_b128 v[132:135], v41 offset:27776
    v_cvt_pk_bf16_f32 v109, v110, v111
    v_mfma_f32_16x16x32_bf16 v[68:71], a[16:19], v[116:119], v[68:71]
    ds_write_b64 v38, v[108:109] offset:6144
    v_mfma_f32_16x16x32_bf16 v[72:75], a[20:23], v[116:119], v[72:75]
    s_waitcnt lgkmcnt(3)
    v_permlane16_swap_b32 v100, v102
    v_mfma_f32_16x16x32_bf16 v[64:67], a[24:27], v[120:123], v[64:67]
    ds_read_b128 v[136:139], v42 offset:27648
    v_cvt_pk_bf16_f32 v103, v106, v107
    v_mfma_f32_16x16x32_bf16 v[68:71], a[28:31], v[120:123], v[68:71]
    buffer_store_dwordx2 v[10:11], v20, s[20:23], s5 offen sc1
    v_mfma_f32_16x16x32_bf16 v[72:75], a[32:35], v[120:123], v[72:75]
    v_permlane16_swap_b32 v101, v103
    v_mfma_f32_16x16x32_bf16 v[64:67], a[36:39], v[124:127], v[64:67]
    ds_read_b128 v[140:143], v42 offset:27712
    v_mfma_f32_16x16x32_bf16 v[68:71], a[40:43], v[124:127], v[68:71]
    v_mfma_f32_16x16x32_bf16 v[72:75], a[44:47], v[124:127], v[72:75]
    s_waitcnt lgkmcnt(2)
    v_mfma_f32_16x16x32_bf16 v[64:67], a[48:51], v[128:131], v[64:67]
    ds_read_b128 v[112:115], v42 offset:27776
    v_mfma_f32_16x16x32_bf16 v[68:71], a[52:55], v[128:131], v[68:71]
    buffer_store_dwordx4 v[100:103], v21, s[20:23], s74 offen sc1
    v_mfma_f32_16x16x32_bf16 v[72:75], a[56:59], v[128:131], v[72:75]
    v_mfma_f32_16x16x32_bf16 v[64:67], a[60:63], v[132:135], v[64:67]
    ds_read_b128 v[116:119], v40 offset:31104
    v_mfma_f32_16x16x32_bf16 v[68:71], a[64:67], v[132:135], v[68:71]
    v_mfma_f32_16x16x32_bf16 v[72:75], a[68:71], v[132:135], v[72:75]
    s_waitcnt lgkmcnt(2)
    v_mfma_f32_16x16x32_bf16 v[64:67], a[72:75], v[136:139], v[64:67]
    ds_read_b128 v[120:123], v40 offset:31168
    v_mfma_f32_16x16x32_bf16 v[68:71], a[76:79], v[136:139], v[68:71]
    v_mfma_f32_16x16x32_bf16 v[72:75], a[80:83], v[136:139], v[72:75]
    v_mfma_f32_16x16x32_bf16 v[64:67], a[84:87], v[140:143], v[64:67]
    ds_read_b128 v[124:127], v40 offset:31232
    v_mfma_f32_16x16x32_bf16 v[68:71], a[88:91], v[140:143], v[68:71]
    v_mfma_f32_16x16x32_bf16 v[72:75], a[92:95], v[140:143], v[72:75]
    s_waitcnt vmcnt(13) lgkmcnt(2)
    v_mfma_f32_16x16x32_bf16 v[64:67], a[96:99], v[112:115], v[64:67]
    ds_read_b128 v[128:131], v41 offset:31104
    v_and_b32 v180, s96, v180
    v_mfma_f32_16x16x32_bf16 v[68:71], a[100:103], v[112:115], v[68:71]
    v_and_b32 v181, s96, v181
    v_and_b32 v182, s96, v182
    v_mfma_f32_16x16x32_bf16 v[72:75], a[104:107], v[112:115], v[72:75]
    v_and_b32 v183, s96, v183
    v_pk_max_u16 v180, v180, v181
    v_mfma_f32_16x16x32_bf16 v[64:67], a[108:111], v[116:119], v[64:67]
    ds_read_b128 v[132:135], v41 offset:31168
    v_pk_max_u16 v182, v182, v183
    v_mfma_f32_16x16x32_bf16 v[68:71], a[112:115], v[116:119], v[68:71]
    v_pk_max_u16 v180, v180, s37
    v_pk_max_u16 v180, v180, v182
    v_mfma_f32_16x16x32_bf16 v[72:75], a[116:119], v[116:119], v[72:75]
    s_waitcnt lgkmcnt(2)
    v_cmp_ne_u32 s[80:81], s37, v180
    v_and_b32 v184, s96, v184
    v_mfma_f32_16x16x32_bf16 v[64:67], a[120:123], v[120:123], v[64:67]
    ds_read_b128 v[136:139], v41 offset:31232
    v_and_b32 v185, s96, v185
    v_mfma_f32_16x16x32_bf16 v[68:71], a[124:127], v[120:123], v[68:71]
    v_and_b32 v186, s96, v186
    v_and_b32 v187, s96, v187
    v_mfma_f32_16x16x32_bf16 v[72:75], a[128:131], v[120:123], v[72:75]
    v_pk_max_u16 v184, v184, v185
    v_pk_max_u16 v186, v186, v187
    v_mfma_f32_16x16x32_bf16 v[64:67], a[132:135], v[124:127], v[64:67]
    ds_read_b128 v[140:143], v42 offset:31104
    v_pk_max_u16 v184, v184, s37
    v_mfma_f32_16x16x32_bf16 v[68:71], a[136:139], v[124:127], v[68:71]
    v_pk_max_u16 v184, v184, v186
    v_cmp_ne_u32 s[82:83], s37, v184
    v_mfma_f32_16x16x32_bf16 v[72:75], a[140:143], v[124:127], v[72:75]
    s_waitcnt lgkmcnt(2)
    v_mfma_f32_16x16x32_bf16 v[64:67], a[144:147], v[128:131], v[64:67]
    ds_read_b128 v[112:115], v42 offset:31168
    v_mfma_f32_16x16x32_bf16 v[68:71], a[148:151], v[128:131], v[68:71]
    s_or_b64 vcc, s[80:81], s[82:83]
    s_cbranch_scc1 L_afailX
L_afailX_back:
    v_mfma_f32_16x16x32_bf16 v[72:75], a[152:155], v[128:131], v[72:75]
    v_mfma_f32_16x16x32_bf16 v[64:67], a[156:159], v[132:135], v[64:67]
    ds_read_b128 v[116:119], v42 offset:31232
    v_mfma_f32_16x16x32_bf16 v[68:71], a[160:163], v[132:135], v[68:71]
    v_mfma_f32_16x16x32_bf16 v[72:75], a[164:167], v[132:135], v[72:75]
    s_waitcnt lgkmcnt(2)
    v_mfma_f32_16x16x32_bf16 v[64:67], a[168:171], v[136:139], v[64:67]
    ds_read_b128 v[120:123], v40 offset:34560
    v_mfma_f32_16x16x32_bf16 v[68:71], a[172:175], v[136:139], v[68:71]
    v_mfma_f32_16x16x32_bf16 v[72:75], a[176:179], v[136:139], v[72:75]
    v_mfma_f32_16x16x32_bf16 v[64:67], a[180:183], v[140:143], v[64:67]
    ds_read_b128 v[124:127], v40 offset:34624
    v_mfma_f32_16x16x32_bf16 v[68:71], a[184:187], v[140:143], v[68:71]
    v_mfma_f32_16x16x32_bf16 v[72:75], a[188:191], v[140:143], v[72:75]
    s_waitcnt lgkmcnt(2)
    v_mfma_f32_16x16x32_bf16 v[64:67], a[192:195], v[112:115], v[64:67]
    ds_read_b128 v[128:131], v40 offset:34688
    v_mfma_f32_16x16x32_bf16 v[68:71], a[196:199], v[112:115], v[68:71]
    v_mfma_f32_16x16x32_bf16 v[72:75], a[200:203], v[112:115], v[72:75]
    v_mfma_f32_16x16x32_bf16 v[64:67], a[204:207], v[116:119], v[64:67]
    ds_read_b128 v[132:135], v41 offset:34560
    v_mfma_f32_16x16x32_bf16 v[68:71], a[208:211], v[116:119], v[68:71]
    v_mfma_f32_16x16x32_bf16 v[72:75], a[212:215], v[116:119], v[72:75]
    s_waitcnt lgkmcnt(2)
    v_mfma_f32_16x16x32_bf16 v[64:67], a[216:219], v[120:123], v[64:67]
    ds_read_b128 v[136:139], v41 offset:34624
    v_mfma_f32_16x16x32_bf16 v[68:71], a[220:223], v[120:123], v[68:71]
    v_mfma_f32_16x16x32_bf16 v[72:75], a[224:227], v[120:123], v[72:75]
    v_mfma_f32_16x16x32_bf16 v[64:67], a[228:231], v[124:127], v[64:67]
    ds_read_b128 v[140:143], v41 offset:34688
    v_mfma_f32_16x16x32_bf16 v[68:71], a[232:235], v[124:127], v[68:71]
    v_mfma_f32_16x16x32_bf16 v[72:75], a[236:239], v[124:127], v[72:75]
    s_waitcnt lgkmcnt(2)
    v_mfma_f32_16x16x32_bf16 v[64:67], a[240:243], v[128:131], v[64:67]
    ds_read_b128 v[112:115], v42 offset:34560
    v_mfma_f32_16x16x32_bf16 v[68:71], a[244:247], v[128:131], v[68:71]
    v_mfma_f32_16x16x32_bf16 v[72:75], a[248:251], v[128:131], v[72:75]
    v_mfma_f32_16x16x32_bf16 v[64:67], a[252:255], v[132:135], v[64:67]
    ds_read_b128 v[116:119], v42 offset:34624
    v_mfma_f32_16x16x32_bf16 v[68:71], v[188:191], v[132:135], v[68:71]
    v_mfma_f32_16x16x32_bf16 v[72:75], v[192:195], v[132:135], v[72:75]
    s_waitcnt lgkmcnt(2)
    v_mfma_f32_16x16x32_bf16 v[64:67], v[196:199], v[136:139], v[64:67]
    ds_read_b128 v[120:123], v42 offset:34688
    v_mfma_f32_16x16x32_bf16 v[68:71], v[200:203], v[136:139], v[68:71]
    v_mfma_f32_16x16x32_bf16 v[72:75], v[204:207], v[136:139], v[72:75]
    v_mfma_f32_16x16x32_bf16 v[64:67], v[208:211], v[140:143], v[64:67]
    ds_read_b128 v[124:127], v40 offset:34560
    v_mfma_f32_16x16x32_bf16 v[68:71], v[212:215], v[140:143], v[68:71]
    v_mfma_f32_16x16x32_bf16 v[72:75], v[216:219], v[140:143], v[72:75]
    s_waitcnt lgkmcnt(2)
    v_mfma_f32_16x16x32_bf16 v[64:67], v[220:223], v[112:115], v[64:67]
    ds_read_b128 v[128:131], v40 offset:34624
    v_mfma_f32_16x16x32_bf16 v[68:71], v[224:227], v[112:115], v[68:71]
    v_mfma_f32_16x16x32_bf16 v[72:75], v[228:231], v[112:115], v[72:75]
    v_mfma_f32_16x16x32_bf16 v[64:67], v[232:235], v[116:119], v[64:67]
    ds_read_b128 v[132:135], v40 offset:34688
    v_mfma_f32_16x16x32_bf16 v[68:71], v[236:239], v[116:119], v[68:71]
    v_mfma_f32_16x16x32_bf16 v[72:75], v[240:243], v[116:119], v[72:75]
    s_waitcnt lgkmcnt(2)
    v_mfma_f32_16x16x32_bf16 v[64:67], v[244:247], v[120:123], v[64:67]
    ds_read_b128 v[136:139], v41 offset:34560
    v_mfma_f32_16x16x32_bf16 v[68:71], v[248:251], v[120:123], v[68:71]
    v_mfma_f32_16x16x32_bf16 v[72:75], v[252:255], v[120:123], v[72:75]
    v_mfma_f32_16x16x32_bf16 v[76:79], a[0:3], v[124:127], 0
    ds_read_b128 v[140:143], v41 offset:34624
    v_mfma_f32_16x16x32_bf16 v[80:83], a[4:7], v[124:127], 0
    v_mfma_f32_16x16x32_bf16 v[84:87], a[8:11], v[124:127], 0
    s_waitcnt lgkmcnt(2)
    v_cvt_pk_bf16_f32 v64, v64, v65
    v_cvt_pk_bf16_f32 v65, v66, v67
    v_mfma_f32_16x16x32_bf16 v[76:79], a[12:15], v[128:131], v[76:79]
    ds_read_b128 v[112:115], v41 offset:34688
    v_cvt_pk_bf16_f32 v72, v72, v73
    v_mfma_f32_16x16x32_bf16 v[80:83], a[16:19], v[128:131], v[80:83]
    v_cvt_pk_bf16_f32 v73, v74, v75
    v_cvt_pk_bf16_f32 v66, v68, v69
    v_mfma_f32_16x16x32_bf16 v[84:87], a[20:23], v[128:131], v[84:87]
    ds_write_b64 v38, v[72:73] offset:8192
    v_mfma_f32_16x16x32_bf16 v[76:79], a[24:27], v[132:135], v[76:79]
    ds_read_b128 v[116:119], v42 offset:34560
    v_mfma_f32_16x16x32_bf16 v[80:83], a[28:31], v[132:135], v[80:83]
    v_permlane16_swap_b32 v64, v66
    v_mfma_f32_16x16x32_bf16 v[84:87], a[32:35], v[132:135], v[84:87]
    s_waitcnt lgkmcnt(3)
    v_cvt_pk_bf16_f32 v67, v70, v71
    v_mfma_f32_16x16x32_bf16 v[76:79], a[36:39], v[136:139], v[76:79]
    ds_read_b128 v[120:123], v42 offset:34624
    v_mfma_f32_16x16x32_bf16 v[80:83], a[40:43], v[136:139], v[80:83]
    v_permlane16_swap_b32 v65, v67
    v_mfma_f32_16x16x32_bf16 v[84:87], a[44:47], v[136:139], v[84:87]
    buffer_store_dwordx4 v[64:67], v21, s[20:23], s75 offen sc1
    v_mfma_f32_16x16x32_bf16 v[76:79], a[48:51], v[140:143], v[76:79]
    ds_read_b128 v[124:127], v42 offset:34688
    v_mfma_f32_16x16x32_bf16 v[80:83], a[52:55], v[140:143], v[80:83]
    v_mfma_f32_16x16x32_bf16 v[84:87], a[56:59], v[140:143], v[84:87]
    s_waitcnt lgkmcnt(2)
    v_mfma_f32_16x16x32_bf16 v[76:79], a[60:63], v[112:115], v[76:79]
    ds_read_b128 v[128:131], v40 offset:38016
    v_mfma_f32_16x16x32_bf16 v[80:83], a[64:67], v[112:115], v[80:83]
    v_mfma_f32_16x16x32_bf16 v[84:87], a[68:71], v[112:115], v[84:87]
    v_mfma_f32_16x16x32_bf16 v[76:79], a[72:75], v[116:119], v[76:79]
    ds_read_b128 v[132:135], v40 offset:38080
    v_mfma_f32_16x16x32_bf16 v[80:83], a[76:79], v[116:119], v[80:83]
    v_mfma_f32_16x16x32_bf16 v[84:87], a[80:83], v[116:119], v[84:87]
    s_waitcnt lgkmcnt(2)
    v_mfma_f32_16x16x32_bf16 v[76:79], a[84:87], v[120:123], v[76:79]
    ds_read_b128 v[136:139], v40 offset:38144
    v_mfma_f32_16x16x32_bf16 v[80:83], a[88:91], v[120:123], v[80:83]
    v_mfma_f32_16x16x32_bf16 v[84:87], a[92:95], v[120:123], v[84:87]
    s_waitcnt vmcnt(9) lgkmcnt(2)
    s_barrier
    v_mfma_f32_16x16x32_bf16 v[76:79], a[96:99], v[124:127], v[76:79]
    ds_read_b128 v[140:143], v41 offset:38016
    v_mfma_f32_16x16x32_bf16 v[80:83], a[100:103], v[124:127], v[80:83]
    ds_read_b32 v35, v34
    v_mfma_f32_16x16x32_bf16 v[84:87], a[104:107], v[124:127], v[84:87]
    ds_read_b64 v[12:13], v39 offset:6144
    v_mfma_f32_16x16x32_bf16 v[76:79], a[108:111], v[128:131], v[76:79]
    ds_read_b128 v[112:115], v41 offset:38080
    v_mfma_f32_16x16x32_bf16 v[80:83], a[112:115], v[128:131], v[80:83]
    ds_read_b64 v[14:15], v39 offset:8192
    v_mfma_f32_16x16x32_bf16 v[84:87], a[116:119], v[128:131], v[84:87]
    s_waitcnt lgkmcnt(5)
    v_mfma_f32_16x16x32_bf16 v[76:79], a[120:123], v[132:135], v[76:79]
    ds_read_b128 v[116:119], v41 offset:38144
    v_mfma_f32_16x16x32_bf16 v[80:83], a[124:127], v[132:135], v[80:83]
    v_mfma_f32_16x16x32_bf16 v[84:87], a[128:131], v[132:135], v[84:87]
    s_waitcnt lgkmcnt(3)
    v_readfirstlane_b32 s63, v35
    v_mfma_f32_16x16x32_bf16 v[76:79], a[132:135], v[136:139], v[76:79]
    ds_read_b128 v[120:123], v42 offset:38016
    v_mfma_f32_16x16x32_bf16 v[80:83], a[136:139], v[136:139], v[80:83]
    buffer_store_dwordx2 v[12:13], v22, s[20:23], s74 offen sc1
    v_mfma_f32_16x16x32_bf16 v[84:87], a[140:143], v[136:139], v[84:87]
    s_waitcnt lgkmcnt(2)
    v_mfma_f32_16x16x32_bf16 v[76:79], a[144:147], v[140:143], v[76:79]
    ds_read_b128 v[124:127], v42 offset:38080
    v_mfma_f32_16x16x32_bf16 v[80:83], a[148:151], v[140:143], v[80:83]
    v_mfma_f32_16x16x32_bf16 v[84:87], a[152:155], v[140:143], v[84:87]
    buffer_store_dwordx2 v[14:15], v22, s[20:23], s75 offen sc1
    v_mfma_f32_16x16x32_bf16 v[76:79], a[156:159], v[112:115], v[76:79]
    ds_read_b128 v[128:131], v42 offset:38144
    v_mfma_f32_16x16x32_bf16 v[80:83], a[160:163], v[112:115], v[80:83]
    v_mfma_f32_16x16x32_bf16 v[84:87], a[164:167], v[112:115], v[84:87]
    s_waitcnt lgkmcnt(2)
    v_mfma_f32_16x16x32_bf16 v[76:79], a[168:171], v[116:119], v[76:79]
    ds_read_b128 v[132:135], v40 offset:41472
    v_mfma_f32_16x16x32_bf16 v[80:83], a[172:175], v[116:119], v[80:83]
    v_mfma_f32_16x16x32_bf16 v[84:87], a[176:179], v[116:119], v[84:87]
    v_mfma_f32_16x16x32_bf16 v[76:79], a[180:183], v[120:123], v[76:79]
    ds_read_b128 v[136:139], v40 offset:41536
    v_mfma_f32_16x16x32_bf16 v[80:83], a[184:187], v[120:123], v[80:83]
    v_mfma_f32_16x16x32_bf16 v[84:87], a[188:191], v[120:123], v[84:87]
    s_waitcnt lgkmcnt(2)
    v_mfma_f32_16x16x32_bf16 v[76:79], a[192:195], v[124:127], v[76:79]
    ds_read_b128 v[140:143], v40 offset:41600
    v_mfma_f32_16x16x32_bf16 v[80:83], a[196:199], v[124:127], v[80:83]
    v_mfma_f32_16x16x32_bf16 v[84:87], a[200:203], v[124:127], v[84:87]
    v_mfma_f32_16x16x32_bf16 v[76:79], a[204:207], v[128:131], v[76:79]
    ds_read_b128 v[112:115], v41 offset:41472
    v_mfma_f32_16x16x32_bf16 v[80:83], a[208:211], v[128:131], v[80:83]
    v_mfma_f32_16x16x32_bf16 v[84:87], a[212:215], v[128:131], v[84:87]
    s_waitcnt lgkmcnt(2)
    v_mfma_f32_16x16x32_bf16 v[76:79], a[216:219], v[132:135], v[76:79]
    ds_read_b128 v[116:119], v41 offset:41536
    v_mfma_f32_16x16x32_bf16 v[80:83], a[220:223], v[132:135], v[80:83]
    v_mfma_f32_16x16x32_bf16 v[84:87], a[224:227], v[132:135], v[84:87]
    v_mfma_f32_16x16x32_bf16 v[76:79], a[228:231], v[136:139], v[76:79]
    ds_read_b128 v[120:123], v41 offset:41600
    v_mfma_f32_16x16x32_bf16 v[80:83], a[232:235], v[136:139], v[80:83]
    v_mfma_f32_16x16x32_bf16 v[84:87], a[236:239], v[136:139], v[84:87]
    s_waitcnt lgkmcnt(2)
    v_mfma_f32_16x16x32_bf16 v[76:79], a[240:243], v[140:143], v[76:79]
    ds_read_b128 v[124:127], v42 offset:41472
    v_mfma_f32_16x16x32_bf16 v[80:83], a[244:247], v[140:143], v[80:83]
    v_mfma_f32_16x16x32_bf16 v[84:87], a[248:251], v[140:143], v[84:87]
    v_mfma_f32_16x16x32_bf16 v[76:79], a[252:255], v[112:115], v[76:79]
    ds_read_b128 v[128:131], v42 offset:41536
    v_mfma_f32_16x16x32_bf16 v[80:83], v[188:191], v[112:115], v[80:83]
    v_mfma_f32_16x16x32_bf16 v[84:87], v[192:195], v[112:115], v[84:87]
    s_waitcnt lgkmcnt(2)
    v_mfma_f32_16x16x32_bf16 v[76:79], v[196:199], v[116:119], v[76:79]
    ds_read_b128 v[132:135], v42 offset:41600
    v_mfma_f32_16x16x32_bf16 v[80:83], v[200:203], v[116:119], v[80:83]
    v_mfma_f32_16x16x32_bf16 v[84:87], v[204:207], v[116:119], v[84:87]
    v_mfma_f32_16x16x32_bf16 v[76:79], v[208:211], v[120:123], v[76:79]
    ds_read_b128 v[136:139], v40 offset:41472
    v_mfma_f32_16x16x32_bf16 v[80:83], v[212:215], v[120:123], v[80:83]
    v_mfma_f32_16x16x32_bf16 v[84:87], v[216:219], v[120:123], v[84:87]
    s_waitcnt lgkmcnt(2)
    v_mfma_f32_16x16x32_bf16 v[76:79], v[220:223], v[124:127], v[76:79]
    ds_read_b128 v[140:143], v40 offset:41536
    v_mfma_f32_16x16x32_bf16 v[80:83], v[224:227], v[124:127], v[80:83]
    v_mfma_f32_16x16x32_bf16 v[84:87], v[228:231], v[124:127], v[84:87]
    v_mfma_f32_16x16x32_bf16 v[76:79], v[232:235], v[128:131], v[76:79]
    ds_read_b128 v[112:115], v40 offset:41600
    v_mfma_f32_16x16x32_bf16 v[80:83], v[236:239], v[128:131], v[80:83]
    v_mfma_f32_16x16x32_bf16 v[84:87], v[240:243], v[128:131], v[84:87]
    s_waitcnt lgkmcnt(2)
    v_mfma_f32_16x16x32_bf16 v[76:79], v[244:247], v[132:135], v[76:79]
    ds_read_b128 v[116:119], v41 offset:41472
    v_mfma_f32_16x16x32_bf16 v[80:83], v[248:251], v[132:135], v[80:83]
    v_mfma_f32_16x16x32_bf16 v[84:87], v[252:255], v[132:135], v[84:87]
    v_mfma_f32_16x16x32_bf16 v[88:91], a[0:3], v[136:139], 0
    ds_read_b128 v[120:123], v41 offset:41536
    v_mfma_f32_16x16x32_bf16 v[92:95], a[4:7], v[136:139], 0
    v_mfma_f32_16x16x32_bf16 v[96:99], a[8:11], v[136:139], 0
    s_waitcnt lgkmcnt(2)
    v_cvt_pk_bf16_f32 v76, v76, v77
    v_cvt_pk_bf16_f32 v77, v78, v79
    v_mfma_f32_16x16x32_bf16 v[88:91], a[12:15], v[140:143], v[88:91]
    ds_read_b128 v[124:127], v41 offset:41600
    v_cvt_pk_bf16_f32 v84, v84, v85
    v_mfma_f32_16x16x32_bf16 v[92:95], a[16:19], v[140:143], v[92:95]
    v_cvt_pk_bf16_f32 v85, v86, v87
    v_cvt_pk_bf16_f32 v78, v80, v81
    v_mfma_f32_16x16x32_bf16 v[96:99], a[20:23], v[140:143], v[96:99]
    ds_write_b64 v38, v[84:85] offset:10240
    v_mfma_f32_16x16x32_bf16 v[88:91], a[24:27], v[112:115], v[88:91]
    ds_read_b128 v[128:131], v42 offset:41472
    v_mfma_f32_16x16x32_bf16 v[92:95], a[28:31], v[112:115], v[92:95]
    v_permlane16_swap_b32 v76, v78
    v_mfma_f32_16x16x32_bf16 v[96:99], a[32:35], v[112:115], v[96:99]
    s_waitcnt lgkmcnt(3)
    v_cvt_pk_bf16_f32 v79, v82, v83
    v_mfma_f32_16x16x32_bf16 v[88:91], a[36:39], v[116:119], v[88:91]
    ds_read_b128 v[132:135], v42 offset:41536
    v_mfma_f32_16x16x32_bf16 v[92:95], a[40:43], v[116:119], v[92:95]
    v_permlane16_swap_b32 v77, v79
    v_mfma_f32_16x16x32_bf16 v[96:99], a[44:47], v[116:119], v[96:99]
    buffer_store_dwordx4 v[76:79], v21, s[20:23], s76 offen sc1
    v_mfma_f32_16x16x32_bf16 v[88:91], a[48:51], v[120:123], v[88:91]
    ds_read_b128 v[136:139], v42 offset:41600
    v_mfma_f32_16x16x32_bf16 v[92:95], a[52:55], v[120:123], v[92:95]
    v_mfma_f32_16x16x32_bf16 v[96:99], a[56:59], v[120:123], v[96:99]
    s_waitcnt lgkmcnt(2)
    v_mfma_f32_16x16x32_bf16 v[88:91], a[60:63], v[124:127], v[88:91]
    ds_read_b128 v[140:143], v40 offset:44928
    v_mfma_f32_16x16x32_bf16 v[92:95], a[64:67], v[124:127], v[92:95]
    v_mfma_f32_16x16x32_bf16 v[96:99], a[68:71], v[124:127], v[96:99]
    v_mfma_f32_16x16x32_bf16 v[88:91], a[72:75], v[128:131], v[88:91]
    ds_read_b128 v[112:115], v40 offset:44992
    v_mfma_f32_16x16x32_bf16 v[92:95], a[76:79], v[128:131], v[92:95]
    v_mfma_f32_16x16x32_bf16 v[96:99], a[80:83], v[128:131], v[96:99]
    s_waitcnt lgkmcnt(2)
    v_mfma_f32_16x16x32_bf16 v[88:91], a[84:87], v[132:135], v[88:91]
    ds_read_b128 v[116:119], v40 offset:45056
    v_mfma_f32_16x16x32_bf16 v[92:95], a[88:91], v[132:135], v[92:95]
    v_mfma_f32_16x16x32_bf16 v[96:99], a[92:95], v[132:135], v[96:99]
    s_waitcnt vmcnt(11) lgkmcnt(2)
    s_barrier
    v_mfma_f32_16x16x32_bf16 v[88:91], a[96:99], v[136:139], v[88:91]
    ds_read_b128 v[120:123], v41 offset:44928
    v_mfma_f32_16x16x32_bf16 v[92:95], a[100:103], v[136:139], v[92:95]
    ds_read_b64 v[62:63], v39 offset:10240
    v_mfma_f32_16x16x32_bf16 v[96:99], a[104:107], v[136:139], v[96:99]
    v_mfma_f32_16x16x32_bf16 v[88:91], a[108:111], v[140:143], v[88:91]
    ds_read_b128 v[124:127], v41 offset:44992
    v_mfma_f32_16x16x32_bf16 v[92:95], a[112:115], v[140:143], v[92:95]
    v_mfma_f32_16x16x32_bf16 v[96:99], a[116:119], v[140:143], v[96:99]
    s_waitcnt lgkmcnt(3)
    v_mfma_f32_16x16x32_bf16 v[88:91], a[120:123], v[112:115], v[88:91]
    ds_read_b128 v[128:131], v41 offset:45056
    v_mfma_f32_16x16x32_bf16 v[92:95], a[124:127], v[112:115], v[92:95]
    v_mfma_f32_16x16x32_bf16 v[96:99], a[128:131], v[112:115], v[96:99]
    s_waitcnt lgkmcnt(2)
    v_mfma_f32_16x16x32_bf16 v[88:91], a[132:135], v[116:119], v[88:91]
    ds_read_b128 v[132:135], v42 offset:44928
    v_mfma_f32_16x16x32_bf16 v[92:95], a[136:139], v[116:119], v[92:95]
    buffer_store_dwordx2 v[62:63], v22, s[20:23], s76 offen sc1
    v_mfma_f32_16x16x32_bf16 v[96:99], a[140:143], v[116:119], v[96:99]
    v_mfma_f32_16x16x32_bf16 v[88:91], a[144:147], v[120:123], v[88:91]
    ds_read_b128 v[136:139], v42 offset:44992
    v_mfma_f32_16x16x32_bf16 v[92:95], a[148:151], v[120:123], v[92:95]
    v_mfma_f32_16x16x32_bf16 v[96:99], a[152:155], v[120:123], v[96:99]
    s_waitcnt lgkmcnt(2)
    v_mfma_f32_16x16x32_bf16 v[88:91], a[156:159], v[124:127], v[88:91]
    ds_read_b128 v[140:143], v42 offset:45056
    v_mfma_f32_16x16x32_bf16 v[92:95], a[160:163], v[124:127], v[92:95]
    v_mfma_f32_16x16x32_bf16 v[96:99], a[164:167], v[124:127], v[96:99]
    v_mfma_f32_16x16x32_bf16 v[88:91], a[168:171], v[128:131], v[88:91]
    ds_read_b128 v[112:115], v40 offset:48384
    v_mfma_f32_16x16x32_bf16 v[92:95], a[172:175], v[128:131], v[92:95]
    v_mfma_f32_16x16x32_bf16 v[96:99], a[176:179], v[128:131], v[96:99]
    s_waitcnt lgkmcnt(2)
    v_mfma_f32_16x16x32_bf16 v[88:91], a[180:183], v[132:135], v[88:91]
    ds_read_b128 v[116:119], v40 offset:48448
    v_mfma_f32_16x16x32_bf16 v[92:95], a[184:187], v[132:135], v[92:95]
    v_mfma_f32_16x16x32_bf16 v[96:99], a[188:191], v[132:135], v[96:99]
    v_mfma_f32_16x16x32_bf16 v[88:91], a[192:195], v[136:139], v[88:91]
    ds_read_b128 v[120:123], v40 offset:48512
    v_mfma_f32_16x16x32_bf16 v[92:95], a[196:199], v[136:139], v[92:95]
    v_mfma_f32_16x16x32_bf16 v[96:99], a[200:203], v[136:139], v[96:99]
    s_waitcnt lgkmcnt(2)
    v_mfma_f32_16x16x32_bf16 v[88:91], a[204:207], v[140:143], v[88:91]
    ds_read_b128 v[124:127], v41 offset:48384
    v_mfma_f32_16x16x32_bf16 v[92:95], a[208:211], v[140:143], v[92:95]
    ds_read_b128 v[128:131], v41 offset:48448
    v_mfma_f32_16x16x32_bf16 v[96:99], a[212:215], v[140:143], v[96:99]
    ds_read_b128 v[132:135], v41 offset:48512
    v_mfma_f32_16x16x32_bf16 v[88:91], a[216:219], v[112:115], v[88:91]
    ds_read_b128 v[136:139], v42 offset:48384
    v_mfma_f32_16x16x32_bf16 v[92:95], a[220:223], v[112:115], v[92:95]
    ds_read_b128 v[140:143], v42 offset:48448
    v_mfma_f32_16x16x32_bf16 v[96:99], a[224:227], v[112:115], v[96:99]
    s_waitcnt lgkmcnt(5)
    ds_read_b128 v[112:115], v42 offset:48512
    v_mfma_f32_16x16x32_bf16 v[88:91], a[228:231], v[116:119], v[88:91]
    v_mfma_f32_16x16x32_bf16 v[92:95], a[232:235], v[116:119], v[92:95]
    v_mfma_f32_16x16x32_bf16 v[96:99], a[236:239], v[116:119], v[96:99]
    v_mfma_f32_16x16x32_bf16 v[88:91], a[240:243], v[120:123], v[88:91]
    v_mfma_f32_16x16x32_bf16 v[92:95], a[244:247], v[120:123], v[92:95]
    v_mfma_f32_16x16x32_bf16 v[96:99], a[248:251], v[120:123], v[96:99]
    s_waitcnt lgkmcnt(0)
    v_mfma_f32_16x16x32_bf16 v[96:99], v[192:195], v[124:127], v[96:99]
    v_mfma_f32_16x16x32_bf16 v[96:99], v[204:207], v[128:131], v[96:99]
    v_mfma_f32_16x16x32_bf16 v[96:99], v[216:219], v[132:135], v[96:99]
    v_mfma_f32_16x16x32_bf16 v[96:99], v[228:231], v[136:139], v[96:99]
    v_mfma_f32_16x16x32_bf16 v[96:99], v[240:243], v[140:143], v[96:99]
    v_mfma_f32_16x16x32_bf16 v[96:99], v[252:255], v[112:115], v[96:99]
    s_nop 2
    v_mfma_f32_16x16x32_bf16 v[88:91], a[252:255], v[124:127], v[88:91]
    s_nop 2
    v_mfma_f32_16x16x32_bf16 v[88:91], v[196:199], v[128:131], v[88:91]
    v_cvt_pk_bf16_f32 v96, v96, v97
    v_cvt_pk_bf16_f32 v97, v98, v99
    v_mfma_f32_16x16x32_bf16 v[88:91], v[208:211], v[132:135], v[88:91]
    ds_write_b64 v38, v[96:97] offset:12288
    v_mfma_f32_16x16x32_bf16 v[88:91], v[220:223], v[136:139], v[88:91]
    v_mfma_f32_16x16x32_bf16 v[88:91], v[232:235], v[140:143], v[88:91]
    v_mfma_f32_16x16x32_bf16 v[88:91], v[244:247], v[112:115], v[88:91]
    v_mfma_f32_16x16x32_bf16 v[92:95], v[188:191], v[124:127], v[92:95]
    s_waitcnt lgkmcnt(0)
    s_barrier
    v_mfma_f32_16x16x32_bf16 v[92:95], v[200:203], v[128:131], v[92:95]
    ds_read_b64 v[50:51], v39 offset:12288
    v_mfma_f32_16x16x32_bf16 v[92:95], v[212:215], v[132:135], v[92:95]
    s_nop 0
    v_mfma_f32_16x16x32_bf16 v[92:95], v[224:227], v[136:139], v[92:95]
    v_mfma_f32_16x16x32_bf16 v[92:95], v[236:239], v[140:143], v[92:95]
    v_cvt_pk_bf16_f32 v88, v88, v89
    v_cvt_pk_bf16_f32 v89, v90, v91
    v_mfma_f32_16x16x32_bf16 v[92:95], v[248:251], v[112:115], v[92:95]
    s_waitcnt lgkmcnt(0)
    buffer_store_dwordx2 v[50:51], v22, s[20:23], s77 offen sc1
    s_nop 5
    v_cvt_pk_bf16_f32 v90, v92, v93
    v_cvt_pk_bf16_f32 v91, v94, v95
    s_nop 0
    v_permlane16_swap_b32 v88, v90
    v_permlane16_swap_b32 v89, v91
    buffer_store_dwordx4 v[88:91], v21, s[20:23], s77 offen sc1
L_check:
    s_cmp_lg_u32 s63, 0
    s_cbranch_scc1 L_slow
    s_endpgm
L_x_end:
L_more:
    ds_read2_b32 v[176:177], v24 offset0:64 offset1:96
    ds_read_b64 v[178:179], v25 offset:264
    s_waitcnt lgkmcnt(0)
    v_xor_b32 v172, v176, v26
    v_xor_b32 v174, v177, v26
    v_xor_b32 v173, v176, v27
    v_xor_b32 v175, v177, v27
    ds_read_b64_tr_b16 v[144:145], v172 offset:0
    ds_read_b64_tr_b16 v[146:147], v174 offset:0
    ds_read_b64_tr_b16 v[148:149], v173 offset:0
    ds_read_b64_tr_b16 v[150:151], v175 offset:0
    ds_read_b64_tr_b16 v[152:153], v172 offset:64
    ds_read_b64_tr_b16 v[154:155], v174 offset:64
    v_cndmask_b32 v169, 0, v179, s[88:89]
    v_cndmask_b32 v171, 0, v179, s[92:93]
    v_cndmask_b32 v168, 0, v178, s[88:89]
    v_cndmask_b32 v170, 0, v178, s[92:93]
    v_cndmask_b32 v169, v169, v178, s[90:91]
    v_cndmask_b32 v171, v171, v178, s[94:95]
    ds_read_b64_tr_b16 v[156:157], v173 offset:64
    ds_read_b64_tr_b16 v[158:159], v175 offset:64
    ds_read_b64_tr_b16 v[160:161], v172 offset:128
    ds_read_b64_tr_b16 v[162:163], v174 offset:128
    ds_read_b64_tr_b16 v[164:165], v173 offset:128
    ds_read_b64_tr_b16 v[166:167], v175 offset:128
    s_waitcnt lgkmcnt(0)
    v_mfma_f32_16x16x32_bf16 v[144:147], v[144:147], v[168:171], 0
    v_mfma_f32_16x16x32_bf16 v[148:151], v[148:151], v[168:171], 0
    v_mfma_f32_16x16x32_bf16 v[152:155], v[152:155], v[168:171], 0
    v_mfma_f32_16x16x32_bf16 v[156:159], v[156:159], v[168:171], 0
    v_mfma_f32_16x16x32_bf16 v[160:163], v[160:163], v[168:171], 0
    v_mfma_f32_16x16x32_bf16 v[164:167], v[164:167], v[168:171], 0
    s_nop 3
    v_cvt_pk_bf16_f32 v144, v144, v145
    v_cvt_pk_bf16_f32 v145, v146, v147
    ds_write_b64 v28, v[144:145] offset:12288
    v_cvt_pk_bf16_f32 v148, v148, v149
    v_cvt_pk_bf16_f32 v149, v150, v151
    ds_write_b64 v29, v[148:149] offset:12288
    v_cvt_pk_bf16_f32 v152, v152, v153
    v_cvt_pk_bf16_f32 v153, v154, v155
    ds_write_b64 v28, v[152:153] offset:12352
    v_cvt_pk_bf16_f32 v156, v156, v157
    v_cvt_pk_bf16_f32 v157, v158, v159
    ds_write_b64 v29, v[156:157] offset:12352
    v_cvt_pk_bf16_f32 v160, v160, v161
    v_cvt_pk_bf16_f32 v161, v162, v163
    ds_write_b64 v28, v[160:161] offset:12416
    v_cvt_pk_bf16_f32 v164, v164, v165
    v_cvt_pk_bf16_f32 v165, v166, v167
    ds_write_b64 v29, v[164:165] offset:12416
    s_waitcnt lgkmcnt(0)
    s_branch L_more_back
L_hot_end:
L_bfail1:
    v_mov_b32 v163, s60
    ds_write_b32 v110, v163 offset:4
    s_mov_b64 s[80:81], 0
    s_mov_b64 s[88:89], 0
    s_mov_b64 s[82:83], 0
    s_mov_b64 s[90:91], 0
    s_mov_b64 s[84:85], 0
    s_mov_b64 s[92:93], 0
    s_mov_b64 s[86:87], 0
    s_mov_b64 s[94:95], 0
    s_mov_b64 s[98:99], 0
    s_mov_b32 s62, 0
    s_branch L_bfail1_back
L_bfail2:
    v_mov_b32 v144, s38
    ds_or_b32 v34, v144
    s_branch L_bfail2_back
L_afailX:
    v_mul_u32_u24 v32, 1821, v0
    v_lshrrev_b32 v32, 16, v32
    v_lshlrev_b32 v32, v32, 1
    v_lshlrev_b32 v33, 7, v32
    s_mov_b64 exec, s[80:81]
    ds_or_b32 v34, v32
    s_mov_b64 exec, s[82:83]
    ds_or_b32 v34, v33
    s_mov_b64 exec, -1
    s_waitcnt lgkmcnt(0)
    s_branch L_afailX_back
L_afailY:
    v_mul_u32_u24 v32, 1821, v0
    v_lshrrev_b32 v32, 16, v32
    v_lshlrev_b32 v32, v32, 1
    v_lshlrev_b32 v33, 7, v32
    s_mov_b64 exec, s[80:81]
    ds_or_b32 v34, v32
    s_mov_b64 exec, s[82:83]
    ds_or_b32 v34, v33
    s_mov_b64 exec, -1
    s_waitcnt lgkmcnt(0)
    s_branch L_afailY_back
L_slow:
    s_waitcnt vmcnt(0) lgkmcnt(0)
    s_barrier
    s_ff1_i32_b32 s80, s63
    s_bitset0_b32 s63, s80
    s_mul_i32 s81, s80, 224
    s_add_u32 s81, s81, s45
    s_mov_b32 s82, 1
    s_cmp_lt_u32 s80, 16
    s_cbranch_scc1 L_s1
    s_bfe_u32 s40, s80, 0x10002
    s_add_u32 s40, s40, s53
    s_and_b32 s41, s80, 3
    s_lshl_b32 s41, s41, 4
    s_cmp_eq_u32 s47, 0
    s_cselect_b32 s82, 1, 224
    s_cselect_b32 s81, 224, 1
    s_mul_i32 s81, s81, s40
    s_mul_i32 s41, s41, s82
    s_add_u32 s81, s81, s41
L_s1:
    s_movk_i32 s43, 224
    v_mul_u32_u24 v79, s82, v2
    v_lshl_add_u32 v49, s2, 2, v3
    v_lshl_add_u32 v49, v49, 3, 64
    v_mad_u32_u24 v49, v79, s42, v49
    v_add_u32 v79, s81, v79
    v_lshrrev_b32 v80, 4, v0
    v_min_u32 v80, 8, v80
    v_mul_u32_u24 v85, 36, v79
    v_lshl_add_u32 v85, v80, 2, v85
    buffer_load_dword v85, v85, s[12:15], 0 offen
    v_mul_u32_u24 v81, 74899, v79
    v_lshrrev_b32 v81, 24, v81
    v_mul_u32_u24 v82, 224, v81
    v_sub_u32 v82, v79, v82
    v_mul_u32_u24 v83, 11, v80
    v_lshrrev_b32 v83, 5, v83
    v_mad_i32_i24 v84, v83, -3, v80
    v_add3_u32 v81, v81, v83, -1
    v_add3_u32 v82, v82, v84, -1
    v_cvt_f32_i32 v81, v81
    v_cvt_f32_i32 v82, v82
    s_waitcnt vmcnt(0)
    v_lshlrev_b32 v65, 16, v85
    v_and_b32 v66, 0xffff0000, v85
    v_add_f32 v65, v81, v65
    v_add_f32 v66, v82, v66
    v_cvt_pk_bf16_f32 v64, v65, v66
    v_pk_max_i16 v64, v64, 0
    v_pk_min_i16 v64, v64, s60
    v_lshlrev_b32 v65, 16, v64
    v_and_b32 v66, 0xffff0000, v64
    v_fract_f32 v71, v65
    v_fract_f32 v72, v66
    v_ceil_f32 v68, v65
    v_ceil_f32 v70, v66
    v_sub_f32 v73, 1.0, v71
    v_sub_f32 v74, 1.0, v72
    v_cvt_u32_f32 v67, v65
    v_cvt_u32_f32 v69, v66
    v_cvt_pk_bf16_f32 v74, v73, v74
    v_cvt_u32_f32 v68, v68
    v_cvt_u32_f32 v70, v70
    v_lshlrev_b32 v73, 16, v74
    v_and_b32 v74, 0xffff0000, v74
    v_mul_f32 v78, v71, v72
    v_mul_f32 v76, v73, v72
    v_mul_f32 v77, v71, v74
    v_mul_f32 v75, v73, v74
    v_mad_u32_u24 v88, v67, s43, v69
    v_mul_u32_u24 v88, 192, v88
    v_mad_u32_u24 v89, v67, s43, v70
    v_mul_u32_u24 v89, 192, v89
    v_mad_u32_u24 v90, v68, s43, v69
    v_mul_u32_u24 v90, 192, v90
    v_mad_u32_u24 v91, v68, s43, v70
    v_mul_u32_u24 v91, 192, v91
    v_cvt_pk_bf16_f32 v92, v75, v76
    v_cvt_pk_bf16_f32 v93, v77, v78
    v_lshlrev_b32 v79, 5, v0
    v_add_u32 v79, 61440, v79
    ds_write_b128 v79, v[88:91]
    ds_write_b64 v79, v[92:93] offset:16
    s_mov_b32 s83, 0
    s_waitcnt lgkmcnt(0)
    s_barrier
L_s2:
    s_add_u32 s40, s83, 0
    v_add_u32 v96, s40, v0
    v_mul_u32_u24 v70, 5462, v96
    v_lshrrev_b32 v70, 16, v70
    v_mad_i32_i24 v71, v70, -12, v96
    v_lshlrev_b32 v70, 5, v70
    v_add_u32 v70, 61440, v70
    ds_read_b128 v[64:67], v70
    ds_read_b64 v[68:69], v70 offset:16
    v_lshlrev_b32 v96, 4, v96
    s_add_u32 s40, s83, 256
    v_add_u32 v97, s40, v0
    v_mul_u32_u24 v78, 5462, v97
    v_lshrrev_b32 v78, 16, v78
    v_mad_i32_i24 v79, v78, -12, v97
    v_lshlrev_b32 v78, 5, v78
    v_add_u32 v78, 61440, v78
    ds_read_b128 v[72:75], v78
    ds_read_b64 v[76:77], v78 offset:16
    v_lshlrev_b32 v97, 4, v97
    s_add_u32 s40, s83, 512
    v_add_u32 v98, s40, v0
    v_mul_u32_u24 v86, 5462, v98
    v_lshrrev_b32 v86, 16, v86
    v_mad_i32_i24 v87, v86, -12, v98
    v_lshlrev_b32 v86, 5, v86
    v_add_u32 v86, 61440, v86
    ds_read_b128 v[80:83], v86
    ds_read_b64 v[84:85], v86 offset:16
    v_lshlrev_b32 v98, 4, v98
    s_add_u32 s40, s83, 768
    v_add_u32 v99, s40, v0
    v_mul_u32_u24 v94, 5462, v99
    v_lshrrev_b32 v94, 16, v94
    v_mad_i32_i24 v95, v94, -12, v99
    v_lshlrev_b32 v94, 5, v94
    v_add_u32 v94, 61440, v94
    ds_read_b128 v[88:91], v94
    ds_read_b64 v[92:93], v94 offset:16
    v_lshlrev_b32 v99, 4, v99
    s_waitcnt lgkmcnt(0)
    v_lshl_add_u32 v64, v71, 4, v64
    buffer_load_dwordx4 v[100:103], v64, s[8:11], 0 offen
    v_lshl_add_u32 v65, v71, 4, v65
    buffer_load_dwordx4 v[104:107], v65, s[8:11], 0 offen
    v_lshl_add_u32 v66, v71, 4, v66
    buffer_load_dwordx4 v[108:111], v66, s[8:11], 0 offen
    v_lshl_add_u32 v67, v71, 4, v67
    buffer_load_dwordx4 v[112:115], v67, s[8:11], 0 offen
    v_lshl_add_u32 v72, v79, 4, v72
    buffer_load_dwordx4 v[116:119], v72, s[8:11], 0 offen
    v_lshl_add_u32 v73, v79, 4, v73
    buffer_load_dwordx4 v[120:123], v73, s[8:11], 0 offen
    v_lshl_add_u32 v74, v79, 4, v74
    buffer_load_dwordx4 v[124:127], v74, s[8:11], 0 offen
    v_lshl_add_u32 v75, v79, 4, v75
    buffer_load_dwordx4 v[128:131], v75, s[8:11], 0 offen
    v_lshl_add_u32 v80, v87, 4, v80
    buffer_load_dwordx4 v[132:135], v80, s[8:11], 0 offen
    v_lshl_add_u32 v81, v87, 4, v81
    buffer_load_dwordx4 v[136:139], v81, s[8:11], 0 offen
    v_lshl_add_u32 v82, v87, 4, v82
    buffer_load_dwordx4 v[140:143], v82, s[8:11], 0 offen
    v_lshl_add_u32 v83, v87, 4, v83
    buffer_load_dwordx4 v[144:147], v83, s[8:11], 0 offen
    v_lshl_add_u32 v88, v95, 4, v88
    buffer_load_dwordx4 v[148:151], v88, s[8:11], 0 offen
    v_lshl_add_u32 v89, v95, 4, v89
    buffer_load_dwordx4 v[152:155], v89, s[8:11], 0 offen
    v_lshl_add_u32 v90, v95, 4, v90
    buffer_load_dwordx4 v[156:159], v90, s[8:11], 0 offen
    v_lshl_add_u32 v91, v95, 4, v91
    buffer_load_dwordx4 v[160:163], v91, s[8:11], 0 offen
    s_waitcnt vmcnt(12)
    v_lshlrev_b32 v172, 16, v68
    v_lshlrev_b32 v173, 16, v100
    v_and_b32 v174, 0xffff0000, v100
    v_mul_f32 v164, v172, v173
    v_mul_f32 v165, v172, v174
    v_lshlrev_b32 v173, 16, v101
    v_and_b32 v174, 0xffff0000, v101
    v_mul_f32 v166, v172, v173
    v_mul_f32 v167, v172, v174
    v_lshlrev_b32 v173, 16, v102
    v_and_b32 v174, 0xffff0000, v102
    v_mul_f32 v168, v172, v173
    v_mul_f32 v169, v172, v174
    v_lshlrev_b32 v173, 16, v103
    v_and_b32 v174, 0xffff0000, v103
    v_mul_f32 v170, v172, v173
    v_mul_f32 v171, v172, v174
    v_and_b32 v172, 0xffff0000, v68
    v_lshlrev_b32 v173, 16, v104
    v_and_b32 v174, 0xffff0000, v104
    v_fmac_f32 v164, v172, v173
    v_fmac_f32 v165, v172, v174
    v_lshlrev_b32 v173, 16, v105
    v_and_b32 v174, 0xffff0000, v105
    v_fmac_f32 v166, v172, v173
    v_fmac_f32 v167, v172, v174
    v_lshlrev_b32 v173, 16, v106
    v_and_b32 v174, 0xffff0000, v106
    v_fmac_f32 v168, v172, v173
    v_fmac_f32 v169, v172, v174
    v_lshlrev_b32 v173, 16, v107
    v_and_b32 v174, 0xffff0000, v107
    v_fmac_f32 v170, v172, v173
    v_fmac_f32 v171, v172, v174
    v_lshlrev_b32 v172, 16, v69
    v_lshlrev_b32 v173, 16, v108
    v_and_b32 v174, 0xffff0000, v108
    v_fmac_f32 v164, v172, v173
    v_fmac_f32 v165, v172, v174
    v_lshlrev_b32 v173, 16, v109
    v_and_b32 v174, 0xffff0000, v109
    v_fmac_f32 v166, v172, v173
    v_fmac_f32 v167, v172, v174
    v_lshlrev_b32 v173, 16, v110
    v_and_b32 v174, 0xffff0000, v110
    v_fmac_f32 v168, v172, v173
    v_fmac_f32 v169, v172, v174
    v_lshlrev_b32 v173, 16, v111
    v_and_b32 v174, 0xffff0000, v111
    v_fmac_f32 v170, v172, v173
    v_fmac_f32 v171, v172, v174
    v_and_b32 v172, 0xffff0000, v69
    v_lshlrev_b32 v173, 16, v112
    v_and_b32 v174, 0xffff0000, v112
    v_fmac_f32 v164, v172, v173
    v_fmac_f32 v165, v172, v174
    v_lshlrev_b32 v173, 16, v113
    v_and_b32 v174, 0xffff0000, v113
    v_fmac_f32 v166, v172, v173
    v_fmac_f32 v167, v172, v174
    v_lshlrev_b32 v173, 16, v114
    v_and_b32 v174, 0xffff0000, v114
    v_fmac_f32 v168, v172, v173
    v_fmac_f32 v169, v172, v174
    v_lshlrev_b32 v173, 16, v115
    v_and_b32 v174, 0xffff0000, v115
    v_fmac_f32 v170, v172, v173
    v_fmac_f32 v171, v172, v174
    v_cvt_pk_bf16_f32 v176, v164, v165
    v_cvt_pk_bf16_f32 v177, v166, v167
    v_cvt_pk_bf16_f32 v178, v168, v169
    v_cvt_pk_bf16_f32 v179, v170, v171
    ds_write_b128 v96, v[176:179]
    s_waitcnt vmcnt(8)
    v_lshlrev_b32 v172, 16, v76
    v_lshlrev_b32 v173, 16, v116
    v_and_b32 v174, 0xffff0000, v116
    v_mul_f32 v164, v172, v173
    v_mul_f32 v165, v172, v174
    v_lshlrev_b32 v173, 16, v117
    v_and_b32 v174, 0xffff0000, v117
    v_mul_f32 v166, v172, v173
    v_mul_f32 v167, v172, v174
    v_lshlrev_b32 v173, 16, v118
    v_and_b32 v174, 0xffff0000, v118
    v_mul_f32 v168, v172, v173
    v_mul_f32 v169, v172, v174
    v_lshlrev_b32 v173, 16, v119
    v_and_b32 v174, 0xffff0000, v119
    v_mul_f32 v170, v172, v173
    v_mul_f32 v171, v172, v174
    v_and_b32 v172, 0xffff0000, v76
    v_lshlrev_b32 v173, 16, v120
    v_and_b32 v174, 0xffff0000, v120
    v_fmac_f32 v164, v172, v173
    v_fmac_f32 v165, v172, v174
    v_lshlrev_b32 v173, 16, v121
    v_and_b32 v174, 0xffff0000, v121
    v_fmac_f32 v166, v172, v173
    v_fmac_f32 v167, v172, v174
    v_lshlrev_b32 v173, 16, v122
    v_and_b32 v174, 0xffff0000, v122
    v_fmac_f32 v168, v172, v173
    v_fmac_f32 v169, v172, v174
    v_lshlrev_b32 v173, 16, v123
    v_and_b32 v174, 0xffff0000, v123
    v_fmac_f32 v170, v172, v173
    v_fmac_f32 v171, v172, v174
    v_lshlrev_b32 v172, 16, v77
    v_lshlrev_b32 v173, 16, v124
    v_and_b32 v174, 0xffff0000, v124
    v_fmac_f32 v164, v172, v173
    v_fmac_f32 v165, v172, v174
    v_lshlrev_b32 v173, 16, v125
    v_and_b32 v174, 0xffff0000, v125
    v_fmac_f32 v166, v172, v173
    v_fmac_f32 v167, v172, v174
    v_lshlrev_b32 v173, 16, v126
    v_and_b32 v174, 0xffff0000, v126
    v_fmac_f32 v168, v172, v173
    v_fmac_f32 v169, v172, v174
    v_lshlrev_b32 v173, 16, v127
    v_and_b32 v174, 0xffff0000, v127
    v_fmac_f32 v170, v172, v173
    v_fmac_f32 v171, v172, v174
    v_and_b32 v172, 0xffff0000, v77
    v_lshlrev_b32 v173, 16, v128
    v_and_b32 v174, 0xffff0000, v128
    v_fmac_f32 v164, v172, v173
    v_fmac_f32 v165, v172, v174
    v_lshlrev_b32 v173, 16, v129
    v_and_b32 v174, 0xffff0000, v129
    v_fmac_f32 v166, v172, v173
    v_fmac_f32 v167, v172, v174
    v_lshlrev_b32 v173, 16, v130
    v_and_b32 v174, 0xffff0000, v130
    v_fmac_f32 v168, v172, v173
    v_fmac_f32 v169, v172, v174
    v_lshlrev_b32 v173, 16, v131
    v_and_b32 v174, 0xffff0000, v131
    v_fmac_f32 v170, v172, v173
    v_fmac_f32 v171, v172, v174
    v_cvt_pk_bf16_f32 v176, v164, v165
    v_cvt_pk_bf16_f32 v177, v166, v167
    v_cvt_pk_bf16_f32 v178, v168, v169
    v_cvt_pk_bf16_f32 v179, v170, v171
    ds_write_b128 v97, v[176:179]
    s_waitcnt vmcnt(4)
    v_lshlrev_b32 v172, 16, v84
    v_lshlrev_b32 v173, 16, v132
    v_and_b32 v174, 0xffff0000, v132
    v_mul_f32 v164, v172, v173
    v_mul_f32 v165, v172, v174
    v_lshlrev_b32 v173, 16, v133
    v_and_b32 v174, 0xffff0000, v133
    v_mul_f32 v166, v172, v173
    v_mul_f32 v167, v172, v174
    v_lshlrev_b32 v173, 16, v134
    v_and_b32 v174, 0xffff0000, v134
    v_mul_f32 v168, v172, v173
    v_mul_f32 v169, v172, v174
    v_lshlrev_b32 v173, 16, v135
    v_and_b32 v174, 0xffff0000, v135
    v_mul_f32 v170, v172, v173
    v_mul_f32 v171, v172, v174
    v_and_b32 v172, 0xffff0000, v84
    v_lshlrev_b32 v173, 16, v136
    v_and_b32 v174, 0xffff0000, v136
    v_fmac_f32 v164, v172, v173
    v_fmac_f32 v165, v172, v174
    v_lshlrev_b32 v173, 16, v137
    v_and_b32 v174, 0xffff0000, v137
    v_fmac_f32 v166, v172, v173
    v_fmac_f32 v167, v172, v174
    v_lshlrev_b32 v173, 16, v138
    v_and_b32 v174, 0xffff0000, v138
    v_fmac_f32 v168, v172, v173
    v_fmac_f32 v169, v172, v174
    v_lshlrev_b32 v173, 16, v139
    v_and_b32 v174, 0xffff0000, v139
    v_fmac_f32 v170, v172, v173
    v_fmac_f32 v171, v172, v174
    v_lshlrev_b32 v172, 16, v85
    v_lshlrev_b32 v173, 16, v140
    v_and_b32 v174, 0xffff0000, v140
    v_fmac_f32 v164, v172, v173
    v_fmac_f32 v165, v172, v174
    v_lshlrev_b32 v173, 16, v141
    v_and_b32 v174, 0xffff0000, v141
    v_fmac_f32 v166, v172, v173
    v_fmac_f32 v167, v172, v174
    v_lshlrev_b32 v173, 16, v142
    v_and_b32 v174, 0xffff0000, v142
    v_fmac_f32 v168, v172, v173
    v_fmac_f32 v169, v172, v174
    v_lshlrev_b32 v173, 16, v143
    v_and_b32 v174, 0xffff0000, v143
    v_fmac_f32 v170, v172, v173
    v_fmac_f32 v171, v172, v174
    v_and_b32 v172, 0xffff0000, v85
    v_lshlrev_b32 v173, 16, v144
    v_and_b32 v174, 0xffff0000, v144
    v_fmac_f32 v164, v172, v173
    v_fmac_f32 v165, v172, v174
    v_lshlrev_b32 v173, 16, v145
    v_and_b32 v174, 0xffff0000, v145
    v_fmac_f32 v166, v172, v173
    v_fmac_f32 v167, v172, v174
    v_lshlrev_b32 v173, 16, v146
    v_and_b32 v174, 0xffff0000, v146
    v_fmac_f32 v168, v172, v173
    v_fmac_f32 v169, v172, v174
    v_lshlrev_b32 v173, 16, v147
    v_and_b32 v174, 0xffff0000, v147
    v_fmac_f32 v170, v172, v173
    v_fmac_f32 v171, v172, v174
    v_cvt_pk_bf16_f32 v176, v164, v165
    v_cvt_pk_bf16_f32 v177, v166, v167
    v_cvt_pk_bf16_f32 v178, v168, v169
    v_cvt_pk_bf16_f32 v179, v170, v171
    ds_write_b128 v98, v[176:179]
    s_waitcnt vmcnt(0)
    v_lshlrev_b32 v172, 16, v92
    v_lshlrev_b32 v173, 16, v148
    v_and_b32 v174, 0xffff0000, v148
    v_mul_f32 v164, v172, v173
    v_mul_f32 v165, v172, v174
    v_lshlrev_b32 v173, 16, v149
    v_and_b32 v174, 0xffff0000, v149
    v_mul_f32 v166, v172, v173
    v_mul_f32 v167, v172, v174
    v_lshlrev_b32 v173, 16, v150
    v_and_b32 v174, 0xffff0000, v150
    v_mul_f32 v168, v172, v173
    v_mul_f32 v169, v172, v174
    v_lshlrev_b32 v173, 16, v151
    v_and_b32 v174, 0xffff0000, v151
    v_mul_f32 v170, v172, v173
    v_mul_f32 v171, v172, v174
    v_and_b32 v172, 0xffff0000, v92
    v_lshlrev_b32 v173, 16, v152
    v_and_b32 v174, 0xffff0000, v152
    v_fmac_f32 v164, v172, v173
    v_fmac_f32 v165, v172, v174
    v_lshlrev_b32 v173, 16, v153
    v_and_b32 v174, 0xffff0000, v153
    v_fmac_f32 v166, v172, v173
    v_fmac_f32 v167, v172, v174
    v_lshlrev_b32 v173, 16, v154
    v_and_b32 v174, 0xffff0000, v154
    v_fmac_f32 v168, v172, v173
    v_fmac_f32 v169, v172, v174
    v_lshlrev_b32 v173, 16, v155
    v_and_b32 v174, 0xffff0000, v155
    v_fmac_f32 v170, v172, v173
    v_fmac_f32 v171, v172, v174
    v_lshlrev_b32 v172, 16, v93
    v_lshlrev_b32 v173, 16, v156
    v_and_b32 v174, 0xffff0000, v156
    v_fmac_f32 v164, v172, v173
    v_fmac_f32 v165, v172, v174
    v_lshlrev_b32 v173, 16, v157
    v_and_b32 v174, 0xffff0000, v157
    v_fmac_f32 v166, v172, v173
    v_fmac_f32 v167, v172, v174
    v_lshlrev_b32 v173, 16, v158
    v_and_b32 v174, 0xffff0000, v158
    v_fmac_f32 v168, v172, v173
    v_fmac_f32 v169, v172, v174
    v_lshlrev_b32 v173, 16, v159
    v_and_b32 v174, 0xffff0000, v159
    v_fmac_f32 v170, v172, v173
    v_fmac_f32 v171, v172, v174
    v_and_b32 v172, 0xffff0000, v93
    v_lshlrev_b32 v173, 16, v160
    v_and_b32 v174, 0xffff0000, v160
    v_fmac_f32 v164, v172, v173
    v_fmac_f32 v165, v172, v174
    v_lshlrev_b32 v173, 16, v161
    v_and_b32 v174, 0xffff0000, v161
    v_fmac_f32 v166, v172, v173
    v_fmac_f32 v167, v172, v174
    v_lshlrev_b32 v173, 16, v162
    v_and_b32 v174, 0xffff0000, v162
    v_fmac_f32 v168, v172, v173
    v_fmac_f32 v169, v172, v174
    v_lshlrev_b32 v173, 16, v163
    v_and_b32 v174, 0xffff0000, v163
    v_fmac_f32 v170, v172, v173
    v_fmac_f32 v171, v172, v174
    v_cvt_pk_bf16_f32 v176, v164, v165
    v_cvt_pk_bf16_f32 v177, v166, v167
    v_cvt_pk_bf16_f32 v178, v168, v169
    v_cvt_pk_bf16_f32 v179, v170, v171
    ds_write_b128 v99, v[176:179]
    s_add_u32 s83, s83, 1024
    s_cmp_lt_u32 s83, 1728
    s_cbranch_scc1 L_s2
    s_waitcnt lgkmcnt(0)
    s_barrier
    s_cmp_ge_u32 s3, 2
    s_cbranch_scc1 L_s3
    v_mad_u32_u24 v40, v2, s42, v4
    ds_read_b128 v[112:115], v40 offset:0
    ds_read_b128 v[116:119], v40 offset:64
    ds_read_b128 v[120:123], v40 offset:128
    s_waitcnt lgkmcnt(0)
    v_mfma_f32_16x16x32_bf16 v[64:67], a[0:3], v[112:115], 0
    v_mfma_f32_16x16x32_bf16 v[68:71], a[4:7], v[112:115], 0
    v_mfma_f32_16x16x32_bf16 v[72:75], a[8:11], v[112:115], 0
    v_mfma_f32_16x16x32_bf16 v[64:67], a[12:15], v[116:119], v[64:67]
    v_mfma_f32_16x16x32_bf16 v[68:71], a[16:19], v[116:119], v[68:71]
    v_mfma_f32_16x16x32_bf16 v[72:75], a[20:23], v[116:119], v[72:75]
    v_mfma_f32_16x16x32_bf16 v[64:67], a[24:27], v[120:123], v[64:67]
    v_mfma_f32_16x16x32_bf16 v[68:71], a[28:31], v[120:123], v[68:71]
    v_mfma_f32_16x16x32_bf16 v[72:75], a[32:35], v[120:123], v[72:75]
    s_nop 1
    ds_read_b128 v[112:115], v40 offset:3072
    ds_read_b128 v[116:119], v40 offset:3136
    ds_read_b128 v[120:123], v40 offset:3200
    s_waitcnt lgkmcnt(0)
    v_mfma_f32_16x16x32_bf16 v[64:67], a[36:39], v[112:115], v[64:67]
    v_mfma_f32_16x16x32_bf16 v[68:71], a[40:43], v[112:115], v[68:71]
    v_mfma_f32_16x16x32_bf16 v[72:75], a[44:47], v[112:115], v[72:75]
    v_mfma_f32_16x16x32_bf16 v[64:67], a[48:51], v[116:119], v[64:67]
    v_mfma_f32_16x16x32_bf16 v[68:71], a[52:55], v[116:119], v[68:71]
    v_mfma_f32_16x16x32_bf16 v[72:75], a[56:59], v[116:119], v[72:75]
    v_mfma_f32_16x16x32_bf16 v[64:67], a[60:63], v[120:123], v[64:67]
    v_mfma_f32_16x16x32_bf16 v[68:71], a[64:67], v[120:123], v[68:71]
    v_mfma_f32_16x16x32_bf16 v[72:75], a[68:71], v[120:123], v[72:75]
    s_nop 1
    ds_read_b128 v[112:115], v40 offset:6144
    ds_read_b128 v[116:119], v40 offset:6208
    ds_read_b128 v[120:123], v40 offset:6272
    s_waitcnt lgkmcnt(0)
    v_mfma_f32_16x16x32_bf16 v[64:67], a[72:75], v[112:115], v[64:67]
    v_mfma_f32_16x16x32_bf16 v[68:71], a[76:79], v[112:115], v[68:71]
    v_mfma_f32_16x16x32_bf16 v[72:75], a[80:83], v[112:115], v[72:75]
    v_mfma_f32_16x16x32_bf16 v[64:67], a[84:87], v[116:119], v[64:67]
    v_mfma_f32_16x16x32_bf16 v[68:71], a[88:91], v[116:119], v[68:71]
    v_mfma_f32_16x16x32_bf16 v[72:75], a[92:95], v[116:119], v[72:75]
    v_mfma_f32_16x16x32_bf16 v[64:67], a[96:99], v[120:123], v[64:67]
    v_mfma_f32_16x16x32_bf16 v[68:71], a[100:103], v[120:123], v[68:71]
    v_mfma_f32_16x16x32_bf16 v[72:75], a[104:107], v[120:123], v[72:75]
    s_nop 1
    ds_read_b128 v[112:115], v40 offset:9216
    ds_read_b128 v[116:119], v40 offset:9280
    ds_read_b128 v[120:123], v40 offset:9344
    s_waitcnt lgkmcnt(0)
    v_mfma_f32_16x16x32_bf16 v[64:67], a[108:111], v[112:115], v[64:67]
    v_mfma_f32_16x16x32_bf16 v[68:71], a[112:115], v[112:115], v[68:71]
    v_mfma_f32_16x16x32_bf16 v[72:75], a[116:119], v[112:115], v[72:75]
    v_mfma_f32_16x16x32_bf16 v[64:67], a[120:123], v[116:119], v[64:67]
    v_mfma_f32_16x16x32_bf16 v[68:71], a[124:127], v[116:119], v[68:71]
    v_mfma_f32_16x16x32_bf16 v[72:75], a[128:131], v[116:119], v[72:75]
    v_mfma_f32_16x16x32_bf16 v[64:67], a[132:135], v[120:123], v[64:67]
    v_mfma_f32_16x16x32_bf16 v[68:71], a[136:139], v[120:123], v[68:71]
    v_mfma_f32_16x16x32_bf16 v[72:75], a[140:143], v[120:123], v[72:75]
    s_nop 1
    ds_read_b128 v[112:115], v40 offset:12288
    ds_read_b128 v[116:119], v40 offset:12352
    ds_read_b128 v[120:123], v40 offset:12416
    s_waitcnt lgkmcnt(0)
    v_mfma_f32_16x16x32_bf16 v[64:67], a[144:147], v[112:115], v[64:67]
    v_mfma_f32_16x16x32_bf16 v[68:71], a[148:151], v[112:115], v[68:71]
    v_mfma_f32_16x16x32_bf16 v[72:75], a[152:155], v[112:115], v[72:75]
    v_mfma_f32_16x16x32_bf16 v[64:67], a[156:159], v[116:119], v[64:67]
    v_mfma_f32_16x16x32_bf16 v[68:71], a[160:163], v[116:119], v[68:71]
    v_mfma_f32_16x16x32_bf16 v[72:75], a[164:167], v[116:119], v[72:75]
    v_mfma_f32_16x16x32_bf16 v[64:67], a[168:171], v[120:123], v[64:67]
    v_mfma_f32_16x16x32_bf16 v[68:71], a[172:175], v[120:123], v[68:71]
    v_mfma_f32_16x16x32_bf16 v[72:75], a[176:179], v[120:123], v[72:75]
    s_nop 1
    ds_read_b128 v[112:115], v40 offset:15360
    ds_read_b128 v[116:119], v40 offset:15424
    ds_read_b128 v[120:123], v40 offset:15488
    s_waitcnt lgkmcnt(0)
    v_mfma_f32_16x16x32_bf16 v[64:67], a[180:183], v[112:115], v[64:67]
    v_mfma_f32_16x16x32_bf16 v[68:71], a[184:187], v[112:115], v[68:71]
    v_mfma_f32_16x16x32_bf16 v[72:75], a[188:191], v[112:115], v[72:75]
    v_mfma_f32_16x16x32_bf16 v[64:67], a[192:195], v[116:119], v[64:67]
    v_mfma_f32_16x16x32_bf16 v[68:71], a[196:199], v[116:119], v[68:71]
    v_mfma_f32_16x16x32_bf16 v[72:75], a[200:203], v[116:119], v[72:75]
    v_mfma_f32_16x16x32_bf16 v[64:67], a[204:207], v[120:123], v[64:67]
    v_mfma_f32_16x16x32_bf16 v[68:71], a[208:211], v[120:123], v[68:71]
    v_mfma_f32_16x16x32_bf16 v[72:75], a[212:215], v[120:123], v[72:75]
    s_nop 1
    ds_read_b128 v[112:115], v40 offset:18432
    ds_read_b128 v[116:119], v40 offset:18496
    ds_read_b128 v[120:123], v40 offset:18560
    s_waitcnt lgkmcnt(0)
    v_mfma_f32_16x16x32_bf16 v[64:67], a[216:219], v[112:115], v[64:67]
    v_mfma_f32_16x16x32_bf16 v[68:71], a[220:223], v[112:115], v[68:71]
    v_mfma_f32_16x16x32_bf16 v[72:75], a[224:227], v[112:115], v[72:75]
    v_mfma_f32_16x16x32_bf16 v[64:67], a[228:231], v[116:119], v[64:67]
    v_mfma_f32_16x16x32_bf16 v[68:71], a[232:235], v[116:119], v[68:71]
    v_mfma_f32_16x16x32_bf16 v[72:75], a[236:239], v[116:119], v[72:75]
    v_mfma_f32_16x16x32_bf16 v[64:67], a[240:243], v[120:123], v[64:67]
    v_mfma_f32_16x16x32_bf16 v[68:71], a[244:247], v[120:123], v[68:71]
    v_mfma_f32_16x16x32_bf16 v[72:75], a[248:251], v[120:123], v[72:75]
    s_nop 1
    ds_read_b128 v[112:115], v40 offset:21504
    ds_read_b128 v[116:119], v40 offset:21568
    ds_read_b128 v[120:123], v40 offset:21632
    s_waitcnt lgkmcnt(0)
    v_mfma_f32_16x16x32_bf16 v[64:67], a[252:255], v[112:115], v[64:67]
    v_mfma_f32_16x16x32_bf16 v[68:71], v[188:191], v[112:115], v[68:71]
    v_mfma_f32_16x16x32_bf16 v[72:75], v[192:195], v[112:115], v[72:75]
    v_mfma_f32_16x16x32_bf16 v[64:67], v[196:199], v[116:119], v[64:67]
    v_mfma_f32_16x16x32_bf16 v[68:71], v[200:203], v[116:119], v[68:71]
    v_mfma_f32_16x16x32_bf16 v[72:75], v[204:207], v[116:119], v[72:75]
    v_mfma_f32_16x16x32_bf16 v[64:67], v[208:211], v[120:123], v[64:67]
    v_mfma_f32_16x16x32_bf16 v[68:71], v[212:215], v[120:123], v[68:71]
    v_mfma_f32_16x16x32_bf16 v[72:75], v[216:219], v[120:123], v[72:75]
    s_nop 1
    ds_read_b128 v[112:115], v40 offset:24576
    ds_read_b128 v[116:119], v40 offset:24640
    ds_read_b128 v[120:123], v40 offset:24704
    s_waitcnt lgkmcnt(0)
    v_mfma_f32_16x16x32_bf16 v[64:67], v[220:223], v[112:115], v[64:67]
    v_mfma_f32_16x16x32_bf16 v[68:71], v[224:227], v[112:115], v[68:71]
    v_mfma_f32_16x16x32_bf16 v[72:75], v[228:231], v[112:115], v[72:75]
    v_mfma_f32_16x16x32_bf16 v[64:67], v[232:235], v[116:119], v[64:67]
    v_mfma_f32_16x16x32_bf16 v[68:71], v[236:239], v[116:119], v[68:71]
    v_mfma_f32_16x16x32_bf16 v[72:75], v[240:243], v[116:119], v[72:75]
    v_mfma_f32_16x16x32_bf16 v[64:67], v[244:247], v[120:123], v[64:67]
    v_mfma_f32_16x16x32_bf16 v[68:71], v[248:251], v[120:123], v[68:71]
    v_mfma_f32_16x16x32_bf16 v[72:75], v[252:255], v[120:123], v[72:75]
    s_nop 1
    s_mul_i32 s81, s81, 192
    s_cmp_lt_u32 s80, 16
    s_cselect_b64 vcc, -1, 0
    v_cndmask_b32 v40, v21, v19, vcc
    s_nop 5
    v_cvt_pk_bf16_f32 v64, v64, v65
    v_cvt_pk_bf16_f32 v65, v66, v67
    v_cvt_pk_bf16_f32 v66, v68, v69
    v_cvt_pk_bf16_f32 v67, v70, v71
    v_cvt_pk_bf16_f32 v72, v72, v73
    v_cvt_pk_bf16_f32 v73, v74, v75
    v_permlane16_swap_b32 v64, v66
    v_permlane16_swap_b32 v65, v67
    buffer_store_dwordx4 v[64:67], v40, s[20:23], s81 offen sc1
    buffer_store_dwordx2 v[72:73], v49, s[20:23], s81 offen sc1
L_s3:
    s_branch L_check
L_code_end:
L_end:
    s_endpgm
.section .rodata,"a"
.p2align 6
.amdhsa_kernel standalone__deformable_dcnv1__vision_kernel
  .amdhsa_next_free_vgpr 512
  .amdhsa_next_free_sgpr 102
  .amdhsa_accum_offset 256
  .amdhsa_group_segment_fixed_size 0
  .amdhsa_kernarg_size 48
  .amdhsa_user_sgpr_count 2
  .amdhsa_user_sgpr_kernarg_segment_ptr 1
  .amdhsa_system_sgpr_workgroup_id_x 1
  .amdhsa_float_denorm_mode_32 3
.end_amdhsa_kernel
```
